```python
import torch

def _softmax(x, axis=-1):
    return torch.softmax(x, dim=axis)
def _gelu(x):
    return torch.nn.functional.gelu(x, approximate="tanh")
def _silu(x):
    return torch.nn.functional.silu(x)
def _sigmoid(x):
    return torch.sigmoid(x)
def _layernorm(x, axis=-1, eps=1e-5):
    m = x.mean(dim=axis, keepdim=True)
    v = x.var(dim=axis, keepdim=True, unbiased=False)
    return (x - m) / torch.sqrt(v + eps)
def _scatter_add(tgt, idx, src, axis=0):
    return tgt.clone().index_add_(axis, idx, src)
def _segment_sum(src, seg, n):
    out = torch.zeros((n,) + src.shape[1:], dtype=src.dtype)
    return out.index_add_(0, seg, src)
def _pad(x, pw):
    flat = tuple(v for pair in reversed(pw) for v in pair)
    return torch.nn.functional.pad(x, flat)

kernel_name = 'parallel_sum__sliding_local_dilated__mixer_token_mlp__prompt'

def setup_inputs():

    _w = (lambda a: (lambda t: t.to(torch.bfloat16) if t.is_floating_point() else t)(torch.as_tensor(a)))
    def _A_setup():
        B, S, D = 1, 2048, 448
        return {
            "x": _w((lambda *s: torch.randn(*s, dtype=torch.bfloat16) * 0.05)(B, S, D)),
            "wqkv": _w((lambda *s: torch.randn(*s, dtype=torch.bfloat16) * 0.05)(D, 3 * D)),
            "wo": _w((lambda *s: torch.randn(*s, dtype=torch.bfloat16) * 0.05)(D, D)),
        }
    _A_in = _A_setup()

    def _B_setup():
        B, S, D, F = 1, 2048, 448, 1792
        return {
            "x": _w((lambda *s: torch.randn(*s, dtype=torch.bfloat16) * 0.05)(B, S, D)),
            "w1": _w((lambda *s: torch.randn(*s, dtype=torch.bfloat16) * 1.6)(S, F) * (S ** -0.5)),
            "b1": _w((lambda *s: torch.randn(*s, dtype=torch.bfloat16) * 12.8)(F) * 0.02),
            "w2": _w((lambda *s: torch.randn(*s, dtype=torch.bfloat16) * 0.4)(F, S) * (F ** -0.5)),
            "b2": _w((lambda *s: torch.randn(*s, dtype=torch.bfloat16) * 6.4)(S) * 0.02),
        }
    _B_in = _B_setup()

    return {
        "A_x": _A_in["x"],
        "A_wqkv": _A_in["wqkv"],
        "A_wo": _A_in["wo"],
        "B_x": _B_in["x"],
        "B_w1": _B_in["w1"],
        "B_b1": _B_in["b1"],
        "B_w2": _B_in["w2"],
        "B_b2": _B_in["b2"],
    }

def reference(A_x, A_wqkv, A_wo, B_x, B_w1, B_b1, B_w2, B_b2):
    def _A_ref(x, wqkv, wo):
        B, S, D = x.shape
        H = 16; Dh = D // H
        W, dil = 8, 2
        qkv = (lambda x, *d: x.permute(*d))((x @ wqkv).reshape(B, S, 3, H, Dh), 2, 0, 3, 1, 4)
        q, k, v = qkv[0], qkv[1], qkv[2]
        scale = Dh ** -0.5
        pos = torch.arange(S)
        off = torch.arange(W) * dil
        idx = pos[:, None] - off[None, :]
        mask = idx >= 0
        idx_c = torch.where(mask, idx, 0).reshape(-1)
        kg = k[:, :, idx_c, :].reshape(B, H, S, W, Dh)
        vg = v[:, :, idx_c, :].reshape(B, H, S, W, Dh)
        logits = torch.einsum("bhsd,bhswd->bhsw", q, kg) * scale
        logits = torch.where(mask[None, None, :, :], logits, -1e9)
        attn = _softmax(logits, axis=-1)
        o = torch.einsum("bhsw,bhswd->bhsd", attn, vg)
        return (lambda x, *d: x.permute(*d))(o, 0, 2, 1, 3).reshape(B, S, D) @ wo

    def _B_ref(x, w1, b1, w2, b2):
        B, S, D = x.shape
        h = _layernorm(x, axis=-1)
        u = torch.einsum("bsd,sf->bdf", h, w1) + b1
        u = _gelu(u)
        y = torch.einsum("bdf,fs->bds", u, w2) + b2
        return (lambda x, *d: x.permute(*d))(y, 0, 2, 1)

    x = A_x
    xn = _layernorm(x, axis=-1)
    return x + _A_ref(xn, A_wqkv, A_wo) + _B_ref(xn, B_w1, B_b1, B_w2, B_b2)
```

```asm
; @launch grid=(256,1,1) block=(256,1,1) lds=163840
.amdgcn_target "amdgcn-amd-amdhsa--gfx950"
.text
.globl parallel_sum__sliding_local_dilated__mixer_token_mlp__prompt_kernel
.p2align 8
.type parallel_sum__sliding_local_dilated__mixer_token_mlp__prompt_kernel,@function
parallel_sum__sliding_local_dilated__mixer_token_mlp__prompt_kernel:
    s_cmp_ge_u32 s2, 256
    s_cbranch_scc1 L_end
    s_load_dwordx2 s[8:9], s[0:1], 0
    s_load_dwordx2 s[12:13], s[0:1], 8
    s_load_dwordx2 s[28:29], s[0:1], 80
    s_load_dwordx2 s[44:45], s[0:1], 72
    s_load_dwordx2 s[20:21], s[0:1], 32
    s_load_dwordx2 s[16:17], s[0:1], 16
    s_load_dwordx2 s[24:25], s[0:1], 48
    s_load_dwordx2 s[32:33], s[0:1], 64
    s_load_dwordx2 s[36:37], s[0:1], 40
    s_load_dwordx2 s[40:41], s[0:1], 56
    s_memrealtime s[78:79]
    s_getpc_b64 s[4:5]
L_pc:
    s_and_b32 s3, s2, 0xf8
    v_lshrrev_b32 v5, 5, v0
    v_add_lshl_u32 v5, s3, v5, 7
    v_min_u32 v5, L_end-L_pc-4, v5
    global_load_dword v12, v5, s[4:5]
    v_and_b32 v1, 63, v0
    v_lshrrev_b32 v5, 6, v0
    v_and_b32 v2, 15, v0
    v_readfirstlane_b32 s48, v5
    v_lshrrev_b32 v3, 4, v1
    v_lshlrev_b32 v4, 4, v1
    s_mov_b32 s10, 1835008
    s_mov_b32 s11, 0x20000
    s_mov_b32 s14, 1204224
    s_mov_b32 s15, 0x20000
    s_mov_b32 s18, 401408
    s_mov_b32 s19, 0x20000
    s_mov_b32 s22, 7340032
    s_mov_b32 s23, 0x20000
    s_mov_b32 s26, 7340032
    s_mov_b32 s27, 0x20000
    s_mov_b32 s30, 8388608
    s_mov_b32 s31, 0x20000
    s_mov_b32 s34, 1835008
    s_mov_b32 s35, 0x20000
    s_mov_b32 s38, 3584
    s_mov_b32 s39, 0x20000
    s_mov_b32 s42, 4096
    s_mov_b32 s43, 0x20000
    s_mov_b32 s46, 256
    s_mov_b32 s47, 0x20000
    s_and_b32 s61, s2, 7
    s_lshr_b32 s62, s2, 3
    s_lshr_b32 s6, s61, 1
    s_and_b32 s7, s61, 1
    s_lshl_b32 s49, s6, 2
    s_lshr_b32 s3, s62, 3
    s_add_u32 s49, s49, s3
    s_lshl_b32 s50, s7, 3
    s_and_b32 s3, s62, 7
    s_add_u32 s50, s50, s3
    v_lshrrev_b32 v16, 3, v1
    v_and_b32 v17, 7, v1
    v_xor_b32 v5, v17, v3
    v_lshlrev_b32 v5, 4, v5
    v_mul_u32_u24 v6, 896, v16
    v_add_u32 v13, v5, v6
    v_xor_b32 v5, 64, v5
    v_add_u32 v5, 7168, v5
    v_add_u32 v14, v5, v6
    s_lshl_b32 s3, s49, 2
    s_add_u32 s3, s3, s48
    s_mul_i32 s64, s3, 28672
    s_mul_i32 s65, s48, 14336
    s_waitcnt lgkmcnt(0)
    s_lshl_b32 s3, s48, 8
    s_add_u32 s3, s3, s2
    s_cmp_lt_u32 s3, 8
    s_cselect_b32 s3, 0, 268435456
    s_or_b32 s78, s78, 1
    v_mov_b32 v10, s78
    v_mov_b32 v11, 0
    v_lshlrev_b32 v7, 8, v1
    buffer_atomic_cmpswap v[10:11], v7, s[44:47], s3 offen sc1
    s_add_u32 m0, s65, 71680
    s_nop 0
    buffer_load_dwordx4 v13, s[8:11], s64 offen lds
    s_add_u32 m0, s65, 72704
    s_nop 0
    buffer_load_dwordx4 v14, s[8:11], s64 offen lds
    s_add_u32 m0, s65, 73600
    s_nop 0
    buffer_load_dwordx4 v13, s[8:11], s64 offen offset:128 lds
    s_add_u32 m0, s65, 74624
    s_nop 0
    buffer_load_dwordx4 v14, s[8:11], s64 offen offset:128 lds
    s_add_u32 m0, s65, 75520
    s_nop 0
    buffer_load_dwordx4 v13, s[8:11], s64 offen offset:256 lds
    s_add_u32 m0, s65, 76544
    s_nop 0
    buffer_load_dwordx4 v14, s[8:11], s64 offen offset:256 lds
    s_add_u32 m0, s65, 77440
    s_nop 0
    buffer_load_dwordx4 v13, s[8:11], s64 offen offset:384 lds
    s_add_u32 m0, s65, 78464
    s_nop 0
    buffer_load_dwordx4 v14, s[8:11], s64 offen offset:384 lds
    s_add_u32 m0, s65, 79360
    s_nop 0
    buffer_load_dwordx4 v13, s[8:11], s64 offen offset:512 lds
    s_add_u32 m0, s65, 80384
    s_nop 0
    buffer_load_dwordx4 v14, s[8:11], s64 offen offset:512 lds
    s_add_u32 m0, s65, 81280
    s_nop 0
    buffer_load_dwordx4 v13, s[8:11], s64 offen offset:640 lds
    s_add_u32 m0, s65, 82304
    s_nop 0
    buffer_load_dwordx4 v14, s[8:11], s64 offen offset:640 lds
    s_add_u32 m0, s65, 83200
    s_nop 0
    buffer_load_dwordx4 v13, s[8:11], s64 offen offset:768 lds
    s_add_u32 m0, s65, 84224
    s_nop 0
    buffer_load_dwordx4 v14, s[8:11], s64 offen offset:768 lds
    s_add_u32 s64, s64, 14336
    s_add_u32 m0, s65, 14336
    s_nop 0
    buffer_load_dwordx4 v13, s[8:11], s64 offen lds
    s_add_u32 m0, s65, 15360
    s_nop 0
    buffer_load_dwordx4 v14, s[8:11], s64 offen lds
    s_add_u32 m0, s65, 16256
    s_nop 0
    buffer_load_dwordx4 v13, s[8:11], s64 offen offset:128 lds
    s_add_u32 m0, s65, 17280
    s_nop 0
    buffer_load_dwordx4 v14, s[8:11], s64 offen offset:128 lds
    s_add_u32 m0, s65, 18176
    s_nop 0
    buffer_load_dwordx4 v13, s[8:11], s64 offen offset:256 lds
    s_add_u32 m0, s65, 19200
    s_nop 0
    buffer_load_dwordx4 v14, s[8:11], s64 offen offset:256 lds
    s_add_u32 m0, s65, 20096
    s_nop 0
    buffer_load_dwordx4 v13, s[8:11], s64 offen offset:384 lds
    s_add_u32 m0, s65, 21120
    s_nop 0
    buffer_load_dwordx4 v14, s[8:11], s64 offen offset:384 lds
    s_add_u32 m0, s65, 22016
    s_nop 0
    buffer_load_dwordx4 v13, s[8:11], s64 offen offset:512 lds
    s_add_u32 m0, s65, 23040
    s_nop 0
    buffer_load_dwordx4 v14, s[8:11], s64 offen offset:512 lds
    s_add_u32 m0, s65, 23936
    s_nop 0
    buffer_load_dwordx4 v13, s[8:11], s64 offen offset:640 lds
    s_add_u32 m0, s65, 24960
    s_nop 0
    buffer_load_dwordx4 v14, s[8:11], s64 offen offset:640 lds
    s_add_u32 m0, s65, 25856
    s_nop 0
    buffer_load_dwordx4 v13, s[8:11], s64 offen offset:768 lds
    s_add_u32 m0, s65, 26880
    s_nop 0
    buffer_load_dwordx4 v14, s[8:11], s64 offen offset:768 lds
    s_lshl_b32 s3, s49, 7
    s_max_u32 s3, s3, 16
    s_sub_u32 s3, s3, 16
    s_mul_i32 s64, s3, 896
    s_lshr_b32 s4, s48, 1
    s_and_b32 s5, s48, 1
    s_lshl_b32 s3, s4, 9
    s_add_u32 s64, s64, s3
    s_cmp_eq_u32 s5, 1
    s_cselect_b64 vcc, -1, 0
    v_cndmask_b32 v15, v13, v14, vcc
    s_lshl_b32 s66, s4, 13
    s_lshl_b32 s3, s5, 10
    s_add_u32 s66, s66, s3
    s_add_u32 m0, s66, 0
    s_nop 0
    buffer_load_dwordx4 v15, s[8:11], s64 offen lds
    s_add_u32 m0, s66, 1920
    s_nop 0
    buffer_load_dwordx4 v15, s[8:11], s64 offen offset:128 lds
    s_add_u32 m0, s66, 3840
    s_nop 0
    buffer_load_dwordx4 v15, s[8:11], s64 offen offset:256 lds
    s_cmp_eq_u32 s4, 1
    s_cselect_b32 s66, 151936, s66
    s_add_u32 m0, s66, 5760
    s_nop 0
    buffer_load_dwordx4 v15, s[8:11], s64 offen offset:384 lds
    v_bfe_u32 v19, v1, 2, 2
    v_and_b32 v20, 3, v1
    v_and_b32 v5, 1, v3
    v_lshlrev_b32 v5, 1, v5
    v_xor_b32 v5, v5, v20
    v_lshlrev_b32 v5, 4, v5
    v_min_u32 v5, 40, v5
    v_lshl_add_u32 v6, v3, 3, v19
    v_mul_u32_u24 v6, 2688, v6
    v_add_u32 v18, v5, v6
    s_lshl_b32 s3, s4, 3
    s_add_u32 s3, s3, s5
    s_mul_i32 s67, s3, 10752
    s_mul_i32 s3, s50, 56
    s_add_u32 s67, s67, s3
    s_mul_i32 s68, s48, 7168
    s_add_u32 s3, s67, 0
    s_add_u32 m0, s68, 129024
    s_nop 0
    buffer_load_dwordx4 v18, s[12:15], s3 offen lds
    s_add_u32 s3, s67, 896
    s_add_u32 m0, s68, 130048
    s_nop 0
    buffer_load_dwordx4 v18, s[12:15], s3 offen lds
    s_add_u32 s3, s67, 1792
    s_add_u32 m0, s68, 131072
    s_nop 0
    buffer_load_dwordx4 v18, s[12:15], s3 offen lds
    s_add_u32 s3, s67, 172032
    s_add_u32 m0, s68, 132096
    s_nop 0
    buffer_load_dwordx4 v18, s[12:15], s3 offen lds
    s_add_u32 s3, s67, 172928
    s_add_u32 m0, s68, 133120
    s_nop 0
    buffer_load_dwordx4 v18, s[12:15], s3 offen lds
    s_add_u32 s3, s67, 173824
    s_add_u32 m0, s68, 134144
    s_nop 0
    buffer_load_dwordx4 v18, s[12:15], s3 offen lds
    s_add_u32 s3, s67, 344064
    s_add_u32 m0, s68, 135168
    s_nop 0
    buffer_load_dwordx4 v18, s[12:15], s3 offen lds
    s_mul_i32 s3, s7, 25
    s_add_u32 s3, s3, s62
    s_mul_i32 s51, s3, 37
    s_lshr_b32 s51, s51, 8
    s_mul_i32 s52, s51, 7
    s_sub_u32 s52, s3, s52
    s_mul_i32 s3, s6, 7
    s_add_u32 s51, s51, s3
    s_add_u32 s3, s62, s7
    s_cmp_lt_u32 s3, 25
    s_cselect_b32 s55, 1, 0
    s_cselect_b32 s22, 7340032, 0
    s_cmp_lt_u32 s62, 28
    s_cselect_b32 s56, 1, 0
    s_mul_i32 s53, s62, 37
    s_lshr_b32 s53, s53, 8
    s_mul_i32 s3, s53, 7
    s_sub_u32 s54, s62, s3
    s_lshl_b32 s3, s61, 2
    s_add_u32 s53, s53, s3
    s_lshl_b32 s58, s48, 12
    v_lshrrev_b32 v5, 2, v1
    v_lshlrev_b32 v5, 7, v5
    v_lshl_add_u32 v5, v20, 3, v5
    v_and_b32 v6, 3, v16
    v_lshl_add_u32 v21, v6, 5, v5
    v_xor_b32 v22, 32, v21
    v_xor_b32 v23, 64, v21
    v_xor_b32 v24, 96, v21
    s_lshl_b32 s3, s48, 5
    v_xor_b32 v33, s3, v21
    v_add_u32 v25, 65536, v21
    v_add_u32 v26, 65536, v22
    v_add_u32 v27, 65536, v23
    v_add_u32 v28, 65536, v24
    v_add_u32 v34, 65536, v33
    v_add_u32 v36, 65536, v4
    v_add_u32 v29, 131072, v21
    v_add_u32 v30, 131072, v22
    v_add_u32 v31, 131072, v23
    v_add_u32 v32, 131072, v24
    v_add_u32 v35, 131072, v33
    v_add_u32 v37, 131072, v4
    v_lshlrev_b32 v5, 1, v3
    v_xor_b32 v5, v5, v17
    v_lshlrev_b32 v38, 4, v5
    v_mul_u32_u24 v5, 3584, v16
    v_add_u32 v39, v5, v38
    v_add_u32 v40, 27648, v39
    v_add_u32 v41, 55296, v39
    v_add_u32 v42, 82944, v39
    v_mov_b32 v44, 0x3f803f80
    v_mov_b32 v45, 0x3f803f80
    v_mov_b32 v46, 0x3f803f80
    v_mov_b32 v47, 0x3f803f80
    v_mov_b32 v48, 1.0
    v_cmp_gt_u32 vcc, 16, v1
    s_nop 1
    v_cndmask_b32 v49, 0, v48, vcc
    v_lshrrev_b32 v5, 1, v2
    v_xor_b32 v6, v5, v3
    v_lshlrev_b32 v6, 4, v6
    v_lshl_add_u32 v6, v2, 7, v6
    v_add_u32 v7, s65, v6
    v_cmp_eq_u32 vcc, 0, v2
    v_add_u32 v60, 71680, v7
    v_add_u32 v62, 14336, v7
    v_cndmask_b32 v58, v7, v6, vcc
    v_xor_b32 v59, 64, v58
    v_xor_b32 v61, 64, v60
    v_xor_b32 v63, 64, v62
    s_min_u32 s3, s50, 13
    s_and_b32 s6, s3, 1
    s_lshl_b32 s6, s6, 6
    s_lshr_b32 s3, s3, 1
    s_lshl_b32 s3, s3, 11
    v_xor_b32 v64, s6, v60
    v_add_u32 v64, s3, v64
    v_xor_b32 v65, s6, v62
    v_add_u32 v65, s3, v65
    v_lshlrev_b32 v6, 2, v3
    v_sub_u32 v5, v5, v6
    v_and_b32 v6, 1, v1
    v_lshlrev_b32 v6, 4, v6
    v_mov_b32 v7, 0x3f80
    v_lshlrev_b32 v6, v6, v7
    v_cmp_eq_i32 vcc, 0, v5
    s_nop 1
    v_cndmask_b32 v50, 0, v6, vcc
    v_cmp_eq_i32 vcc, 1, v5
    s_nop 1
    v_cndmask_b32 v51, 0, v6, vcc
    v_cmp_eq_i32 vcc, 2, v5
    s_nop 1
    v_cndmask_b32 v52, 0, v6, vcc
    v_cmp_eq_i32 vcc, 3, v5
    s_nop 1
    v_cndmask_b32 v53, 0, v6, vcc
    v_cmp_eq_i32 vcc, -8, v5
    s_nop 1
    v_cndmask_b32 v54, 0, v6, vcc
    v_cmp_eq_i32 vcc, -7, v5
    s_nop 1
    v_cndmask_b32 v55, 0, v6, vcc
    v_cmp_eq_i32 vcc, -6, v5
    s_nop 1
    v_cndmask_b32 v56, 0, v6, vcc
    v_cmp_eq_i32 vcc, -5, v5
    s_nop 1
    v_cndmask_b32 v57, 0, v6, vcc
    v_lshrrev_b32 v5, 2, v1
    v_lshlrev_b32 v5, 6, v5
    v_and_b32 v6, 1, v3
    v_lshl_add_u32 v5, v6, 5, v5
    v_add_u32 v5, 65536, v5
    v_lshl_add_u32 v66, v20, 3, v5
    v_lshrrev_b32 v6, 1, v20
    v_xor_b32 v6, v6, v20
    v_xor_b32 v5, 32, v5
    v_lshl_add_u32 v67, v6, 3, v5
    v_add_u32 v68, 65536, v66
    v_add_u32 v69, 65536, v67
    s_sub_u32 s6, 3, s4
    s_lshl_b32 s3, s4, 13
    s_cmp_eq_u32 s5, 1
    s_cselect_b32 s6, 0, s6
    s_cselect_b32 s3, 159744, s3
    v_min_u32 v5, s6, v16
    v_lshlrev_b32 v5, 11, v5
    v_lshl_add_u32 v5, v17, 4, v5
    v_add_u32 v70, s3, v5
    s_mov_b32 s70, 0x00100001
    s_mov_b32 s71, 0x10000100
    s_mov_b32 s72, 0x00200002
    s_mov_b32 s73, 0x20000200
    s_mov_b32 s74, 0x00400004
    s_mov_b32 s75, 0x40000400
    s_mov_b32 s76, 0x00800008
    s_mov_b32 s77, 0x80000800
    s_waitcnt vmcnt(25)
    ds_read_b128 a[200:203], v64
    ds_read_b128 a[56:59], v60 offset:0
    ds_read_b128 a[60:63], v61 offset:0
    ds_read_b128 a[64:67], v60 offset:2048
    ds_read_b128 a[68:71], v61 offset:2048
    ds_read_b128 a[72:75], v60 offset:4096
    ds_read_b128 a[76:79], v61 offset:4096
    ds_read_b128 a[80:83], v60 offset:6144
    ds_read_b128 a[84:87], v61 offset:6144
    ds_read_b128 a[88:91], v60 offset:8192
    ds_read_b128 a[92:95], v61 offset:8192
    ds_read_b128 a[96:99], v60 offset:10240
    ds_read_b128 a[100:103], v61 offset:10240
    ds_read_b128 a[104:107], v60 offset:12288
    ds_read_b128 a[108:111], v61 offset:12288
    s_waitcnt lgkmcnt(13)
    v_mfma_f32_16x16x32_bf16 v[76:79], a[56:59], a[56:59], 0
    v_mfma_f32_16x16x32_bf16 v[88:91], v[44:47], a[56:59], 0
    s_waitcnt lgkmcnt(12)
    v_mfma_f32_16x16x32_bf16 v[76:79], a[60:63], a[60:63], v[76:79]
    v_mfma_f32_16x16x32_bf16 v[88:91], v[44:47], a[60:63], v[88:91]
    s_waitcnt lgkmcnt(11)
    v_mfma_f32_16x16x32_bf16 v[76:79], a[64:67], a[64:67], v[76:79]
    v_mfma_f32_16x16x32_bf16 v[88:91], v[44:47], a[64:67], v[88:91]
    s_waitcnt lgkmcnt(10)
    v_mfma_f32_16x16x32_bf16 v[76:79], a[68:71], a[68:71], v[76:79]
    v_mfma_f32_16x16x32_bf16 v[88:91], v[44:47], a[68:71], v[88:91]
    s_waitcnt lgkmcnt(9)
    v_mfma_f32_16x16x32_bf16 v[76:79], a[72:75], a[72:75], v[76:79]
    v_mfma_f32_16x16x32_bf16 v[88:91], v[44:47], a[72:75], v[88:91]
    s_waitcnt lgkmcnt(8)
    v_mfma_f32_16x16x32_bf16 v[76:79], a[76:79], a[76:79], v[76:79]
    v_mfma_f32_16x16x32_bf16 v[88:91], v[44:47], a[76:79], v[88:91]
    s_waitcnt lgkmcnt(7)
    v_mfma_f32_16x16x32_bf16 v[76:79], a[80:83], a[80:83], v[76:79]
    v_mfma_f32_16x16x32_bf16 v[88:91], v[44:47], a[80:83], v[88:91]
    s_waitcnt lgkmcnt(6)
    v_mfma_f32_16x16x32_bf16 v[76:79], a[84:87], a[84:87], v[76:79]
    v_mfma_f32_16x16x32_bf16 v[88:91], v[44:47], a[84:87], v[88:91]
    s_waitcnt lgkmcnt(5)
    v_mfma_f32_16x16x32_bf16 v[76:79], a[88:91], a[88:91], v[76:79]
    v_mfma_f32_16x16x32_bf16 v[88:91], v[44:47], a[88:91], v[88:91]
    s_waitcnt lgkmcnt(4)
    v_mfma_f32_16x16x32_bf16 v[76:79], a[92:95], a[92:95], v[76:79]
    v_mfma_f32_16x16x32_bf16 v[88:91], v[44:47], a[92:95], v[88:91]
    s_waitcnt lgkmcnt(3)
    v_mfma_f32_16x16x32_bf16 v[76:79], a[96:99], a[96:99], v[76:79]
    v_mfma_f32_16x16x32_bf16 v[88:91], v[44:47], a[96:99], v[88:91]
    s_waitcnt lgkmcnt(2)
    v_mfma_f32_16x16x32_bf16 v[76:79], a[100:103], a[100:103], v[76:79]
    v_mfma_f32_16x16x32_bf16 v[88:91], v[44:47], a[100:103], v[88:91]
    s_waitcnt lgkmcnt(1)
    v_mfma_f32_16x16x32_bf16 v[76:79], a[104:107], a[104:107], v[76:79]
    v_mfma_f32_16x16x32_bf16 v[88:91], v[44:47], a[104:107], v[88:91]
    s_waitcnt lgkmcnt(0)
    v_mfma_f32_16x16x32_bf16 v[76:79], a[108:111], a[108:111], v[76:79]
    v_mfma_f32_16x16x32_bf16 v[88:91], v[44:47], a[108:111], v[88:91]
    s_add_u32 s3, s67, 344960
    s_add_u32 m0, s65, 71680
    s_nop 0
    buffer_load_dwordx4 v18, s[12:15], s3 offen lds
    s_add_u32 s3, s67, 345856
    s_add_u32 m0, s65, 72704
    s_nop 0
    buffer_load_dwordx4 v18, s[12:15], s3 offen lds
    s_add_u32 s3, s67, 516096
    s_add_u32 m0, s65, 73728
    s_nop 0
    buffer_load_dwordx4 v18, s[12:15], s3 offen lds
    s_add_u32 s3, s67, 516992
    s_add_u32 m0, s65, 74752
    s_nop 0
    buffer_load_dwordx4 v18, s[12:15], s3 offen lds
    s_add_u32 s3, s67, 517888
    s_add_u32 m0, s65, 75776
    s_nop 0
    buffer_load_dwordx4 v18, s[12:15], s3 offen lds
    s_waitcnt vmcnt(16)
    ds_read_b128 a[204:207], v65
    ds_read_b128 a[112:115], v62 offset:0
    ds_read_b128 a[116:119], v63 offset:0
    ds_read_b128 a[120:123], v62 offset:2048
    ds_read_b128 a[124:127], v63 offset:2048
    ds_read_b128 a[128:131], v62 offset:4096
    ds_read_b128 a[132:135], v63 offset:4096
    ds_read_b128 a[136:139], v62 offset:6144
    ds_read_b128 a[140:143], v63 offset:6144
    ds_read_b128 a[144:147], v62 offset:8192
    ds_read_b128 a[148:151], v63 offset:8192
    ds_read_b128 a[152:155], v62 offset:10240
    ds_read_b128 a[156:159], v63 offset:10240
    ds_read_b128 a[160:163], v62 offset:12288
    ds_read_b128 a[164:167], v63 offset:12288
    s_waitcnt lgkmcnt(13)
    v_mfma_f32_16x16x32_bf16 v[80:83], a[112:115], a[112:115], 0
    v_mfma_f32_16x16x32_bf16 v[92:95], v[44:47], a[112:115], 0
    s_waitcnt lgkmcnt(12)
    v_mfma_f32_16x16x32_bf16 v[80:83], a[116:119], a[116:119], v[80:83]
    v_mfma_f32_16x16x32_bf16 v[92:95], v[44:47], a[116:119], v[92:95]
    s_waitcnt lgkmcnt(11)
    v_mfma_f32_16x16x32_bf16 v[80:83], a[120:123], a[120:123], v[80:83]
    v_mfma_f32_16x16x32_bf16 v[92:95], v[44:47], a[120:123], v[92:95]
    s_waitcnt lgkmcnt(10)
    v_mfma_f32_16x16x32_bf16 v[80:83], a[124:127], a[124:127], v[80:83]
    v_mfma_f32_16x16x32_bf16 v[92:95], v[44:47], a[124:127], v[92:95]
    s_waitcnt lgkmcnt(9)
    v_mfma_f32_16x16x32_bf16 v[80:83], a[128:131], a[128:131], v[80:83]
    v_mfma_f32_16x16x32_bf16 v[92:95], v[44:47], a[128:131], v[92:95]
    s_waitcnt lgkmcnt(8)
    v_mfma_f32_16x16x32_bf16 v[80:83], a[132:135], a[132:135], v[80:83]
    v_mfma_f32_16x16x32_bf16 v[92:95], v[44:47], a[132:135], v[92:95]
    s_waitcnt lgkmcnt(7)
    v_mfma_f32_16x16x32_bf16 v[80:83], a[136:139], a[136:139], v[80:83]
    v_mfma_f32_16x16x32_bf16 v[92:95], v[44:47], a[136:139], v[92:95]
    s_waitcnt lgkmcnt(6)
    v_mfma_f32_16x16x32_bf16 v[80:83], a[140:143], a[140:143], v[80:83]
    v_mfma_f32_16x16x32_bf16 v[92:95], v[44:47], a[140:143], v[92:95]
    s_waitcnt lgkmcnt(5)
    v_mfma_f32_16x16x32_bf16 v[80:83], a[144:147], a[144:147], v[80:83]
    v_mfma_f32_16x16x32_bf16 v[92:95], v[44:47], a[144:147], v[92:95]
    s_waitcnt lgkmcnt(4)
    v_mfma_f32_16x16x32_bf16 v[80:83], a[148:151], a[148:151], v[80:83]
    v_mfma_f32_16x16x32_bf16 v[92:95], v[44:47], a[148:151], v[92:95]
    s_waitcnt lgkmcnt(3)
    v_mfma_f32_16x16x32_bf16 v[80:83], a[152:155], a[152:155], v[80:83]
    v_mfma_f32_16x16x32_bf16 v[92:95], v[44:47], a[152:155], v[92:95]
    s_waitcnt lgkmcnt(2)
    v_mfma_f32_16x16x32_bf16 v[80:83], a[156:159], a[156:159], v[80:83]
    v_mfma_f32_16x16x32_bf16 v[92:95], v[44:47], a[156:159], v[92:95]
    s_waitcnt lgkmcnt(1)
    v_mfma_f32_16x16x32_bf16 v[80:83], a[160:163], a[160:163], v[80:83]
    v_mfma_f32_16x16x32_bf16 v[92:95], v[44:47], a[160:163], v[92:95]
    s_waitcnt lgkmcnt(0)
    v_mfma_f32_16x16x32_bf16 v[80:83], a[164:167], a[164:167], v[80:83]
    v_mfma_f32_16x16x32_bf16 v[92:95], v[44:47], a[164:167], v[92:95]
    s_waitcnt vmcnt(12)
    ds_write_b128 v70, v[44:47]
    s_waitcnt lgkmcnt(0)
    s_barrier
    ds_read_b128 a[0:3], v58 offset:0
    ds_read_b128 a[4:7], v59 offset:0
    ds_read_b128 a[8:11], v58 offset:2048
    ds_read_b128 a[12:15], v59 offset:2048
    ds_read_b128 a[16:19], v58 offset:4096
    ds_read_b128 a[20:23], v59 offset:4096
    ds_read_b128 a[24:27], v58 offset:6144
    ds_read_b128 a[28:31], v59 offset:6144
    ds_read_b128 a[32:35], v58 offset:8192
    ds_read_b128 a[36:39], v59 offset:8192
    ds_read_b128 a[40:43], v58 offset:10240
    ds_read_b128 a[44:47], v59 offset:10240
    ds_read_b128 a[48:51], v58 offset:12288
    ds_read_b128 a[52:55], v59 offset:12288
    v_mfma_f32_16x16x32_bf16 v[96:99], a[200:203], v[50:53], 0
    v_mfma_f32_16x16x32_bf16 v[100:103], a[200:203], v[54:57], 0
    v_mfma_f32_16x16x32_bf16 v[104:107], a[204:207], v[50:53], 0
    v_mfma_f32_16x16x32_bf16 v[108:111], a[204:207], v[54:57], 0
    s_mov_b32 s78, 0x3727c5ac
    s_mov_b32 s79, 0x3b124925
    v_cndmask_b32 v162, 0, v76, s[70:71]
    v_cndmask_b32 v162, v162, v77, s[72:73]
    v_cndmask_b32 v162, v162, v78, s[74:75]
    v_cndmask_b32 v162, v162, v79, s[76:77]
    v_cndmask_b32 v166, 0, v80, s[70:71]
    v_cndmask_b32 v166, v166, v81, s[72:73]
    v_cndmask_b32 v166, v166, v82, s[74:75]
    v_cndmask_b32 v166, v166, v83, s[76:77]
    v_mfma_f32_16x16x4_f32 v[76:79], v48, v162, 0
    s_nop 0
    v_mfma_f32_16x16x4_f32 v[80:83], v48, v166, 0
    v_mul_f32 v163, s79, v88
    v_mul_f32 v167, s79, v92
    v_mul_f32 v164, v163, v163
    v_mul_f32 v168, v167, v167
    s_nop 3
    v_fma_f32 v164, v76, s79, -v164
    s_nop 0
    v_fma_f32 v168, v80, s79, -v168
    v_max_f32 v164, 0, v164
    v_max_f32 v168, 0, v168
    v_add_f32 v165, s78, v164
    v_add_f32 v169, s78, v168
    v_rsq_f32 v113, v165
    v_rsq_f32 v114, v169
    v_mul_f32_e64 v116, -v163, v113
    v_mul_f32_e64 v117, -v167, v114
    v_mul_f32 v165, v113, v113
    v_mul_f32 v169, v114, v114
    v_fma_f32 v165, v165, v164, s78
    v_fma_f32 v169, v169, v168, s78
    v_rsq_f32 v165, v165
    v_rsq_f32 v169, v169
    v_mul_f32 v163, v113, v165
    v_mul_f32 v164, v116, v165
    v_mul_f32 v167, v114, v169
    v_mul_f32 v168, v117, v169
    v_mfma_f32_16x16x4_f32 v[142:145], v163, v49, 0
    v_mfma_f32_16x16x4_f32 v[150:153], v164, v49, 0
    v_mfma_f32_16x16x4_f32 v[146:149], v167, v49, 0
    v_mfma_f32_16x16x4_f32 v[154:157], v168, v49, 0
    s_nop 7
    v_fma_f32 v96, v96, v142, v150
    v_fma_f32 v97, v97, v143, v151
    v_fma_f32 v98, v98, v144, v152
    v_fma_f32 v99, v99, v145, v153
    v_cvt_pk_bf16_f32 v170, v96, v97
    v_cvt_pk_bf16_f32 v171, v98, v99
    v_fma_f32 v104, v104, v146, v154
    v_fma_f32 v105, v105, v147, v155
    v_fma_f32 v106, v106, v148, v156
    v_fma_f32 v107, v107, v149, v157
    v_cvt_pk_bf16_f32 v172, v104, v105
    v_cvt_pk_bf16_f32 v173, v106, v107
    v_fma_f32 v100, v100, v142, v150
    v_fma_f32 v101, v101, v143, v151
    v_fma_f32 v102, v102, v144, v152
    v_fma_f32 v103, v103, v145, v153
    v_cvt_pk_bf16_f32 v174, v100, v101
    v_cvt_pk_bf16_f32 v175, v102, v103
    v_fma_f32 v108, v108, v146, v154
    v_fma_f32 v109, v109, v147, v155
    v_fma_f32 v110, v110, v148, v156
    v_fma_f32 v111, v111, v149, v157
    v_cvt_pk_bf16_f32 v176, v108, v109
    v_cvt_pk_bf16_f32 v177, v110, v111
    s_lshl_b32 s59, s49, 2
    s_add_u32 s59, s59, s48
    s_lshl_b32 s3, s50, 7
    s_add_u32 s3, s3, s59
    s_lshl_b32 s3, s3, 10
    s_cmp_lt_u32 s50, 14
    s_cselect_b32 s60, 0, 268435456
    s_add_u32 s3, s3, s60
    buffer_store_dwordx4 v[170:173], v4, s[28:31], s3 offen sc1
    s_add_u32 s3, s3, 65536
    buffer_store_dwordx4 v[174:177], v4, s[28:31], s3 offen sc1
    v_mov_b32 v179, 0
    buffer_load_dword v178, v179, s[44:47], 0 offen sc1
    s_add_u32 s3, s67, 688128
    s_add_u32 m0, s65, 76800
    s_nop 0
    buffer_load_dwordx4 v18, s[12:15], s3 offen lds
    s_add_u32 s3, s67, 689024
    s_add_u32 m0, s65, 77824
    s_nop 0
    buffer_load_dwordx4 v18, s[12:15], s3 offen lds
    s_add_u32 s3, s67, 689920
    s_add_u32 m0, s65, 78848
    s_nop 0
    buffer_load_dwordx4 v18, s[12:15], s3 offen lds
    s_add_u32 s3, s67, 860160
    s_add_u32 m0, s65, 79872
    s_nop 0
    buffer_load_dwordx4 v18, s[12:15], s3 offen lds
    s_add_u32 s3, s67, 861056
    s_add_u32 m0, s65, 80896
    s_nop 0
    buffer_load_dwordx4 v18, s[12:15], s3 offen lds
    s_add_u32 s3, s67, 861952
    s_add_u32 m0, s65, 81920
    s_nop 0
    buffer_load_dwordx4 v18, s[12:15], s3 offen lds
    s_add_u32 s3, s67, 1032192
    s_add_u32 m0, s65, 82944
    s_nop 0
    buffer_load_dwordx4 v18, s[12:15], s3 offen lds
    s_add_u32 s3, s67, 1033088
    s_add_u32 m0, s65, 83968
    s_nop 0
    buffer_load_dwordx4 v18, s[12:15], s3 offen lds
    s_add_u32 s3, s67, 1033984
    s_add_u32 m0, s65, 84992
    s_nop 0
    buffer_load_dwordx4 v18, s[12:15], s3 offen lds
    s_waitcnt lgkmcnt(13)
    v_mfma_f32_16x16x32_bf16 v[72:75], a[0:3], a[0:3], 0
    v_mfma_f32_16x16x32_bf16 v[84:87], v[44:47], a[0:3], 0
    s_waitcnt lgkmcnt(12)
    v_mfma_f32_16x16x32_bf16 v[72:75], a[4:7], a[4:7], v[72:75]
    v_mfma_f32_16x16x32_bf16 v[84:87], v[44:47], a[4:7], v[84:87]
    s_waitcnt lgkmcnt(11)
    v_mfma_f32_16x16x32_bf16 v[72:75], a[8:11], a[8:11], v[72:75]
    v_mfma_f32_16x16x32_bf16 v[84:87], v[44:47], a[8:11], v[84:87]
    s_waitcnt lgkmcnt(10)
    v_mfma_f32_16x16x32_bf16 v[72:75], a[12:15], a[12:15], v[72:75]
    v_mfma_f32_16x16x32_bf16 v[84:87], v[44:47], a[12:15], v[84:87]
    s_waitcnt lgkmcnt(9)
    v_mfma_f32_16x16x32_bf16 v[72:75], a[16:19], a[16:19], v[72:75]
    v_mfma_f32_16x16x32_bf16 v[84:87], v[44:47], a[16:19], v[84:87]
    s_waitcnt lgkmcnt(8)
    v_mfma_f32_16x16x32_bf16 v[72:75], a[20:23], a[20:23], v[72:75]
    v_mfma_f32_16x16x32_bf16 v[84:87], v[44:47], a[20:23], v[84:87]
    s_waitcnt lgkmcnt(7)
    v_mfma_f32_16x16x32_bf16 v[72:75], a[24:27], a[24:27], v[72:75]
    v_mfma_f32_16x16x32_bf16 v[84:87], v[44:47], a[24:27], v[84:87]
    s_waitcnt lgkmcnt(6)
    v_mfma_f32_16x16x32_bf16 v[72:75], a[28:31], a[28:31], v[72:75]
    v_mfma_f32_16x16x32_bf16 v[84:87], v[44:47], a[28:31], v[84:87]
    s_waitcnt lgkmcnt(5)
    v_mfma_f32_16x16x32_bf16 v[72:75], a[32:35], a[32:35], v[72:75]
    v_mfma_f32_16x16x32_bf16 v[84:87], v[44:47], a[32:35], v[84:87]
    s_waitcnt lgkmcnt(4)
    v_mfma_f32_16x16x32_bf16 v[72:75], a[36:39], a[36:39], v[72:75]
    v_mfma_f32_16x16x32_bf16 v[84:87], v[44:47], a[36:39], v[84:87]
    s_waitcnt lgkmcnt(3)
    v_mfma_f32_16x16x32_bf16 v[72:75], a[40:43], a[40:43], v[72:75]
    v_mfma_f32_16x16x32_bf16 v[84:87], v[44:47], a[40:43], v[84:87]
    s_waitcnt lgkmcnt(2)
    v_mfma_f32_16x16x32_bf16 v[72:75], a[44:47], a[44:47], v[72:75]
    v_mfma_f32_16x16x32_bf16 v[84:87], v[44:47], a[44:47], v[84:87]
    s_waitcnt lgkmcnt(1)
    v_mfma_f32_16x16x32_bf16 v[72:75], a[48:51], a[48:51], v[72:75]
    v_mfma_f32_16x16x32_bf16 v[84:87], v[44:47], a[48:51], v[84:87]
    s_waitcnt lgkmcnt(0)
    v_mfma_f32_16x16x32_bf16 v[72:75], a[52:55], a[52:55], v[72:75]
    v_mfma_f32_16x16x32_bf16 v[84:87], v[44:47], a[52:55], v[84:87]
    s_nop 6
    v_cndmask_b32 v158, 0, v72, s[70:71]
    v_cndmask_b32 v158, v158, v73, s[72:73]
    v_cndmask_b32 v158, v158, v74, s[74:75]
    v_cndmask_b32 v158, v158, v75, s[76:77]
    s_nop 1
    v_mfma_f32_16x16x4_f32 v[72:75], v48, v158, 0
    v_mul_f32 v159, s79, v84
    v_mul_f32 v160, v159, v159
    s_nop 7
    v_fma_f32 v160, v72, s79, -v160
    v_max_f32 v160, 0, v160
    v_add_f32 v161, s78, v160
    v_rsq_f32 v112, v161
    s_nop 0
    v_mul_f32_e64 v115, -v159, v112
    v_mfma_f32_16x16x4_f32 v[118:121], v112, v49, 0
    s_nop 0
    v_mfma_f32_16x16x4_f32 v[130:133], v115, v49, 0
    v_mfma_f32_16x16x4_f32 v[122:125], v113, v49, 0
    v_mfma_f32_16x16x4_f32 v[134:137], v116, v49, 0
    v_mfma_f32_16x16x4_f32 v[126:129], v114, v49, 0
    v_mfma_f32_16x16x4_f32 v[138:141], v117, v49, 0
    s_mul_i32 s61, s52, 37
    s_lshr_b32 s61, s61, 4
    s_mul_i32 s69, s48, 114688
    s_lshl_b32 s3, s51, 7
    s_add_u32 s69, s69, s3
    s_waitcnt vmcnt(21)
    s_barrier
    s_add_u32 s3, s61, 0
    s_and_b32 s3, s3, 15
    s_mul_i32 s3, s3, 458752
    s_add_u32 s3, s3, s69
    s_add_u32 m0, s58, 0
    s_nop 0
    buffer_load_dwordx4 v39, s[20:23], s3 offen lds
    buffer_load_dwordx4 v40, s[20:23], s3 offen offset:1024 lds
    buffer_load_dwordx4 v41, s[20:23], s3 offen offset:2048 lds
    buffer_load_dwordx4 v42, s[20:23], s3 offen offset:3072 lds
    s_add_u32 s3, s61, 1
    s_and_b32 s3, s3, 15
    s_mul_i32 s3, s3, 458752
    s_add_u32 s3, s3, s69
    s_add_u32 m0, s58, 16384
    s_nop 0
    buffer_load_dwordx4 v39, s[20:23], s3 offen lds
    buffer_load_dwordx4 v40, s[20:23], s3 offen offset:1024 lds
    buffer_load_dwordx4 v41, s[20:23], s3 offen offset:2048 lds
    buffer_load_dwordx4 v42, s[20:23], s3 offen offset:3072 lds
    s_add_u32 s3, s61, 2
    s_and_b32 s3, s3, 15
    s_mul_i32 s3, s3, 458752
    s_add_u32 s3, s3, s69
    s_add_u32 m0, s58, 32768
    s_nop 0
    buffer_load_dwordx4 v39, s[20:23], s3 offen lds
    buffer_load_dwordx4 v40, s[20:23], s3 offen offset:1024 lds
    buffer_load_dwordx4 v41, s[20:23], s3 offen offset:2048 lds
    buffer_load_dwordx4 v42, s[20:23], s3 offen offset:3072 lds
    s_add_u32 s3, s61, 3
    s_and_b32 s3, s3, 15
    s_mul_i32 s3, s3, 458752
    s_add_u32 s3, s3, s69
    s_add_u32 m0, s58, 49152
    s_nop 0
    buffer_load_dwordx4 v39, s[20:23], s3 offen lds
    buffer_load_dwordx4 v40, s[20:23], s3 offen offset:1024 lds
    buffer_load_dwordx4 v41, s[20:23], s3 offen offset:2048 lds
    buffer_load_dwordx4 v42, s[20:23], s3 offen offset:3072 lds
    ds_read_b64_tr_b16 a[168:169], v66 offset:63488
    ds_read_b64_tr_b16 a[170:171], v68 offset:5120
    ds_read_b64_tr_b16 a[172:173], v67 offset:63488
    ds_read_b64_tr_b16 a[174:175], v69 offset:5120
    ds_read_b64_tr_b16 a[176:177], v66 offset:64512
    ds_read_b64_tr_b16 a[178:179], v68 offset:6144
    ds_read_b64_tr_b16 a[180:181], v67 offset:64512
    ds_read_b64_tr_b16 a[182:183], v69 offset:6144
    s_waitcnt lgkmcnt(6)
    v_mfma_f32_16x16x32_bf16 v[188:191], a[168:171], a[56:59], 0
    ds_read_b64_tr_b16 a[184:185], v68 offset:0
    ds_read_b64_tr_b16 a[186:187], v68 offset:7168
    v_mfma_f32_16x16x32_bf16 v[196:199], a[168:171], a[112:115], 0
    v_mfma_f32_16x16x32_bf16 v[180:183], a[168:171], v[44:47], 0
    s_waitcnt lgkmcnt(6)
    v_mfma_f32_16x16x32_bf16 v[192:195], a[172:175], a[56:59], 0
    ds_read_b64_tr_b16 a[188:189], v69 offset:0
    ds_read_b64_tr_b16 a[190:191], v69 offset:7168
    v_mfma_f32_16x16x32_bf16 v[200:203], a[172:175], a[112:115], 0
    v_mfma_f32_16x16x32_bf16 v[184:187], a[172:175], v[44:47], 0
    s_waitcnt lgkmcnt(6)
    v_mfma_f32_16x16x32_bf16 v[204:207], a[176:179], a[0:3], 0
    ds_read_b64_tr_b16 a[192:193], v68 offset:12288
    ds_read_b64_tr_b16 a[194:195], v68 offset:19456
    v_mfma_f32_16x16x32_bf16 v[212:215], a[176:179], a[56:59], 0
    v_mfma_f32_16x16x32_bf16 v[220:223], a[176:179], a[112:115], 0
    s_waitcnt lgkmcnt(6)
    v_mfma_f32_16x16x32_bf16 v[208:211], a[180:183], a[0:3], 0
    ds_read_b64_tr_b16 a[196:197], v69 offset:12288
    ds_read_b64_tr_b16 a[198:199], v69 offset:19456
    v_mfma_f32_16x16x32_bf16 v[216:219], a[180:183], a[56:59], 0
    v_mfma_f32_16x16x32_bf16 v[224:227], a[180:183], a[112:115], 0
    s_waitcnt lgkmcnt(6)
    v_mfma_f32_16x16x32_bf16 v[228:231], a[0:3], a[184:187], 0
    ds_read_b64_tr_b16 a[168:169], v68 offset:13312
    ds_read_b64_tr_b16 a[170:171], v68 offset:20480
    v_mfma_f32_16x16x32_bf16 v[236:239], a[56:59], a[184:187], 0
    v_mfma_f32_16x16x32_bf16 v[244:247], a[112:115], a[184:187], 0
    s_waitcnt lgkmcnt(6)
    v_mfma_f32_16x16x32_bf16 v[232:235], a[0:3], a[188:191], 0
    ds_read_b64_tr_b16 a[172:173], v69 offset:13312
    ds_read_b64_tr_b16 a[174:175], v69 offset:20480
    v_mfma_f32_16x16x32_bf16 v[240:243], a[56:59], a[188:191], 0
    v_mfma_f32_16x16x32_bf16 v[248:251], a[112:115], a[188:191], 0
    s_waitcnt lgkmcnt(6)
    v_mfma_f32_16x16x32_bf16 v[188:191], a[192:195], a[60:63], v[188:191]
    ds_read_b64_tr_b16 a[176:177], v68 offset:14336
    ds_read_b64_tr_b16 a[178:179], v68 offset:21504
    v_mfma_f32_16x16x32_bf16 v[196:199], a[192:195], a[116:119], v[196:199]
    v_mfma_f32_16x16x32_bf16 v[180:183], a[192:195], v[44:47], v[180:183]
    s_waitcnt lgkmcnt(6)
    v_mfma_f32_16x16x32_bf16 v[192:195], a[196:199], a[60:63], v[192:195]
    ds_read_b64_tr_b16 a[180:181], v69 offset:14336
    ds_read_b64_tr_b16 a[182:183], v69 offset:21504
    v_mfma_f32_16x16x32_bf16 v[200:203], a[196:199], a[116:119], v[200:203]
    v_mfma_f32_16x16x32_bf16 v[184:187], a[196:199], v[44:47], v[184:187]
    s_waitcnt lgkmcnt(6)
    v_mfma_f32_16x16x32_bf16 v[204:207], a[168:171], a[4:7], v[204:207]
    s_waitcnt vmcnt(34)
    s_barrier
    ds_read_b64_tr_b16 a[184:185], v68 offset:1024
    ds_read_b64_tr_b16 a[186:187], v68 offset:8192
    v_mfma_f32_16x16x32_bf16 v[212:215], a[168:171], a[60:63], v[212:215]
    v_mfma_f32_16x16x32_bf16 v[220:223], a[168:171], a[116:119], v[220:223]
    s_waitcnt lgkmcnt(6)
    v_mfma_f32_16x16x32_bf16 v[208:211], a[172:175], a[4:7], v[208:211]
    ds_read_b64_tr_b16 a[188:189], v69 offset:1024
    ds_read_b64_tr_b16 a[190:191], v69 offset:8192
    v_mfma_f32_16x16x32_bf16 v[216:219], a[172:175], a[60:63], v[216:219]
    v_mfma_f32_16x16x32_bf16 v[224:227], a[172:175], a[116:119], v[224:227]
    s_waitcnt lgkmcnt(6)
    v_mfma_f32_16x16x32_bf16 v[228:231], a[4:7], a[176:179], v[228:231]
    ds_read_b64_tr_b16 a[192:193], v68 offset:2048
    ds_read_b64_tr_b16 a[194:195], v68 offset:9216
    v_mfma_f32_16x16x32_bf16 v[236:239], a[60:63], a[176:179], v[236:239]
    v_mfma_f32_16x16x32_bf16 v[244:247], a[116:119], a[176:179], v[244:247]
    s_waitcnt lgkmcnt(6)
    v_mfma_f32_16x16x32_bf16 v[232:235], a[4:7], a[180:183], v[232:235]
    ds_read_b64_tr_b16 a[196:197], v69 offset:2048
    ds_read_b64_tr_b16 a[198:199], v69 offset:9216
    v_mfma_f32_16x16x32_bf16 v[240:243], a[60:63], a[180:183], v[240:243]
    v_mfma_f32_16x16x32_bf16 v[248:251], a[116:119], a[180:183], v[248:251]
    s_waitcnt lgkmcnt(6)
    v_mfma_f32_16x16x32_bf16 v[188:191], a[184:187], a[64:67], v[188:191]
    ds_read_b64_tr_b16 a[168:169], v68 offset:3072
    ds_read_b64_tr_b16 a[170:171], v68 offset:10240
    v_mfma_f32_16x16x32_bf16 v[196:199], a[184:187], a[120:123], v[196:199]
    v_mfma_f32_16x16x32_bf16 v[180:183], a[184:187], v[44:47], v[180:183]
    s_waitcnt lgkmcnt(6)
    v_mfma_f32_16x16x32_bf16 v[192:195], a[188:191], a[64:67], v[192:195]
    ds_read_b64_tr_b16 a[172:173], v69 offset:3072
    ds_read_b64_tr_b16 a[174:175], v69 offset:10240
    v_mfma_f32_16x16x32_bf16 v[200:203], a[188:191], a[120:123], v[200:203]
    v_mfma_f32_16x16x32_bf16 v[184:187], a[188:191], v[44:47], v[184:187]
    s_waitcnt lgkmcnt(6)
    v_mfma_f32_16x16x32_bf16 v[204:207], a[192:195], a[8:11], v[204:207]
    ds_read_b64_tr_b16 a[176:177], v68 offset:15360
    ds_read_b64_tr_b16 a[178:179], v68 offset:22528
    v_mfma_f32_16x16x32_bf16 v[212:215], a[192:195], a[64:67], v[212:215]
    v_mfma_f32_16x16x32_bf16 v[220:223], a[192:195], a[120:123], v[220:223]
    s_waitcnt lgkmcnt(6)
    v_mfma_f32_16x16x32_bf16 v[208:211], a[196:199], a[8:11], v[208:211]
    ds_read_b64_tr_b16 a[180:181], v69 offset:15360
    ds_read_b64_tr_b16 a[182:183], v69 offset:22528
    v_mfma_f32_16x16x32_bf16 v[216:219], a[196:199], a[64:67], v[216:219]
    v_mfma_f32_16x16x32_bf16 v[224:227], a[196:199], a[120:123], v[224:227]
    s_waitcnt lgkmcnt(6)
    v_mfma_f32_16x16x32_bf16 v[228:231], a[8:11], a[168:171], v[228:231]
    ds_read_b64_tr_b16 a[184:185], v68 offset:16384
    ds_read_b64_tr_b16 a[186:187], v68 offset:23552
    v_mfma_f32_16x16x32_bf16 v[236:239], a[64:67], a[168:171], v[236:239]
    v_mfma_f32_16x16x32_bf16 v[244:247], a[120:123], a[168:171], v[244:247]
    s_waitcnt lgkmcnt(6)
    v_mfma_f32_16x16x32_bf16 v[232:235], a[8:11], a[172:175], v[232:235]
    ds_read_b64_tr_b16 a[188:189], v69 offset:16384
    ds_read_b64_tr_b16 a[190:191], v69 offset:23552
    v_mfma_f32_16x16x32_bf16 v[240:243], a[64:67], a[172:175], v[240:243]
    v_mfma_f32_16x16x32_bf16 v[248:251], a[120:123], a[172:175], v[248:251]
    s_waitcnt lgkmcnt(6)
    v_mfma_f32_16x16x32_bf16 v[188:191], a[176:179], a[68:71], v[188:191]
    ds_read_b64_tr_b16 a[192:193], v68 offset:17408
    ds_read_b64_tr_b16 a[194:195], v68 offset:24576
    v_mfma_f32_16x16x32_bf16 v[196:199], a[176:179], a[124:127], v[196:199]
    v_mfma_f32_16x16x32_bf16 v[180:183], a[176:179], v[44:47], v[180:183]
    s_waitcnt lgkmcnt(6)
    v_mfma_f32_16x16x32_bf16 v[192:195], a[180:183], a[68:71], v[192:195]
    ds_read_b64_tr_b16 a[196:197], v69 offset:17408
    ds_read_b64_tr_b16 a[198:199], v69 offset:24576
    v_mfma_f32_16x16x32_bf16 v[200:203], a[180:183], a[124:127], v[200:203]
    v_mfma_f32_16x16x32_bf16 v[184:187], a[180:183], v[44:47], v[184:187]
    s_waitcnt lgkmcnt(6)
    v_mfma_f32_16x16x32_bf16 v[204:207], a[184:187], a[12:15], v[204:207]
    s_waitcnt vmcnt(31)
    s_barrier
    ds_read_b64_tr_b16 a[168:169], v68 offset:4096
    ds_read_b64_tr_b16 a[170:171], v68 offset:11264
    v_mfma_f32_16x16x32_bf16 v[212:215], a[184:187], a[68:71], v[212:215]
    v_mfma_f32_16x16x32_bf16 v[220:223], a[184:187], a[124:127], v[220:223]
    s_waitcnt lgkmcnt(6)
    v_mfma_f32_16x16x32_bf16 v[208:211], a[188:191], a[12:15], v[208:211]
    ds_read_b64_tr_b16 a[172:173], v69 offset:4096
    ds_read_b64_tr_b16 a[174:175], v69 offset:11264
    v_mfma_f32_16x16x32_bf16 v[216:219], a[188:191], a[68:71], v[216:219]
    v_mfma_f32_16x16x32_bf16 v[224:227], a[188:191], a[124:127], v[224:227]
    s_waitcnt lgkmcnt(6)
    v_mfma_f32_16x16x32_bf16 v[228:231], a[12:15], a[192:195], v[228:231]
    ds_read_b64_tr_b16 a[176:177], v66 offset:6144
    ds_read_b64_tr_b16 a[178:179], v66 offset:20480
    v_mfma_f32_16x16x32_bf16 v[236:239], a[68:71], a[192:195], v[236:239]
    v_mfma_f32_16x16x32_bf16 v[244:247], a[124:127], a[192:195], v[244:247]
    s_waitcnt lgkmcnt(6)
    v_mfma_f32_16x16x32_bf16 v[232:235], a[12:15], a[196:199], v[232:235]
    ds_read_b64_tr_b16 a[180:181], v67 offset:6144
    ds_read_b64_tr_b16 a[182:183], v67 offset:20480
    v_mfma_f32_16x16x32_bf16 v[240:243], a[68:71], a[196:199], v[240:243]
    v_mfma_f32_16x16x32_bf16 v[248:251], a[124:127], a[196:199], v[248:251]
    s_waitcnt lgkmcnt(6)
    v_mfma_f32_16x16x32_bf16 v[188:191], a[168:171], a[72:75], v[188:191]
    ds_read_b64_tr_b16 a[184:185], v66 offset:7168
    ds_read_b64_tr_b16 a[186:187], v66 offset:21504
    v_mfma_f32_16x16x32_bf16 v[196:199], a[168:171], a[128:131], v[196:199]
    v_mfma_f32_16x16x32_bf16 v[180:183], a[168:171], v[44:47], v[180:183]
    s_waitcnt lgkmcnt(6)
    v_mfma_f32_16x16x32_bf16 v[192:195], a[172:175], a[72:75], v[192:195]
    ds_read_b64_tr_b16 a[188:189], v67 offset:7168
    ds_read_b64_tr_b16 a[190:191], v67 offset:21504
    v_mfma_f32_16x16x32_bf16 v[200:203], a[172:175], a[128:131], v[200:203]
    v_mfma_f32_16x16x32_bf16 v[184:187], a[172:175], v[44:47], v[184:187]
    s_waitcnt lgkmcnt(6)
    v_mfma_f32_16x16x32_bf16 v[204:207], a[176:179], a[16:19], v[204:207]
    ds_read_b64_tr_b16 a[192:193], v68 offset:18432
    ds_read_b64_tr_b16 a[194:195], v68 offset:25600
    v_mfma_f32_16x16x32_bf16 v[212:215], a[176:179], a[72:75], v[212:215]
    v_mfma_f32_16x16x32_bf16 v[220:223], a[176:179], a[128:131], v[220:223]
    s_waitcnt lgkmcnt(6)
    v_mfma_f32_16x16x32_bf16 v[208:211], a[180:183], a[16:19], v[208:211]
    ds_read_b64_tr_b16 a[196:197], v69 offset:18432
    ds_read_b64_tr_b16 a[198:199], v69 offset:25600
    v_mfma_f32_16x16x32_bf16 v[216:219], a[180:183], a[72:75], v[216:219]
    v_mfma_f32_16x16x32_bf16 v[224:227], a[180:183], a[128:131], v[224:227]
    s_waitcnt lgkmcnt(6)
    v_mfma_f32_16x16x32_bf16 v[228:231], a[16:19], a[184:187], v[228:231]
    ds_read_b64_tr_b16 a[168:169], v66 offset:34816
    ds_read_b64_tr_b16 a[170:171], v66 offset:49152
    v_mfma_f32_16x16x32_bf16 v[236:239], a[72:75], a[184:187], v[236:239]
    v_mfma_f32_16x16x32_bf16 v[244:247], a[128:131], a[184:187], v[244:247]
    s_waitcnt lgkmcnt(6)
    v_mfma_f32_16x16x32_bf16 v[232:235], a[16:19], a[188:191], v[232:235]
    ds_read_b64_tr_b16 a[172:173], v67 offset:34816
    ds_read_b64_tr_b16 a[174:175], v67 offset:49152
    v_mfma_f32_16x16x32_bf16 v[240:243], a[72:75], a[188:191], v[240:243]
    v_mfma_f32_16x16x32_bf16 v[248:251], a[128:131], a[188:191], v[248:251]
    s_waitcnt lgkmcnt(6)
    v_mfma_f32_16x16x32_bf16 v[188:191], a[192:195], a[76:79], v[188:191]
    ds_read_b64_tr_b16 a[176:177], v66 offset:35840
    ds_read_b64_tr_b16 a[178:179], v66 offset:50176
    v_mfma_f32_16x16x32_bf16 v[196:199], a[192:195], a[132:135], v[196:199]
    v_mfma_f32_16x16x32_bf16 v[180:183], a[192:195], v[44:47], v[180:183]
    s_waitcnt lgkmcnt(6)
    v_mfma_f32_16x16x32_bf16 v[192:195], a[196:199], a[76:79], v[192:195]
    ds_read_b64_tr_b16 a[180:181], v67 offset:35840
    ds_read_b64_tr_b16 a[182:183], v67 offset:50176
    v_mfma_f32_16x16x32_bf16 v[200:203], a[196:199], a[132:135], v[200:203]
    v_mfma_f32_16x16x32_bf16 v[184:187], a[196:199], v[44:47], v[184:187]
    s_waitcnt lgkmcnt(6)
    v_mfma_f32_16x16x32_bf16 v[204:207], a[168:171], a[20:23], v[204:207]
    s_waitcnt vmcnt(28)
    s_barrier
    ds_read_b64_tr_b16 a[184:185], v66 offset:8192
    ds_read_b64_tr_b16 a[186:187], v66 offset:22528
    v_mfma_f32_16x16x32_bf16 v[212:215], a[168:171], a[76:79], v[212:215]
    v_mfma_f32_16x16x32_bf16 v[220:223], a[168:171], a[132:135], v[220:223]
    s_waitcnt lgkmcnt(6)
    v_mfma_f32_16x16x32_bf16 v[208:211], a[172:175], a[20:23], v[208:211]
    ds_read_b64_tr_b16 a[188:189], v67 offset:8192
    ds_read_b64_tr_b16 a[190:191], v67 offset:22528
    v_mfma_f32_16x16x32_bf16 v[216:219], a[172:175], a[76:79], v[216:219]
    v_mfma_f32_16x16x32_bf16 v[224:227], a[172:175], a[132:135], v[224:227]
    s_waitcnt lgkmcnt(6)
    v_mfma_f32_16x16x32_bf16 v[228:231], a[20:23], a[176:179], v[228:231]
    ds_read_b64_tr_b16 a[192:193], v66 offset:9216
    ds_read_b64_tr_b16 a[194:195], v66 offset:23552
    v_mfma_f32_16x16x32_bf16 v[236:239], a[76:79], a[176:179], v[236:239]
    v_mfma_f32_16x16x32_bf16 v[244:247], a[132:135], a[176:179], v[244:247]
    s_waitcnt lgkmcnt(6)
    v_mfma_f32_16x16x32_bf16 v[232:235], a[20:23], a[180:183], v[232:235]
    ds_read_b64_tr_b16 a[196:197], v67 offset:9216
    ds_read_b64_tr_b16 a[198:199], v67 offset:23552
    v_mfma_f32_16x16x32_bf16 v[240:243], a[76:79], a[180:183], v[240:243]
    v_mfma_f32_16x16x32_bf16 v[248:251], a[132:135], a[180:183], v[248:251]
    s_waitcnt lgkmcnt(6)
    v_mfma_f32_16x16x32_bf16 v[188:191], a[184:187], a[80:83], v[188:191]
    ds_read_b64_tr_b16 a[168:169], v66 offset:10240
    ds_read_b64_tr_b16 a[170:171], v66 offset:24576
    v_mfma_f32_16x16x32_bf16 v[196:199], a[184:187], a[136:139], v[196:199]
    v_mfma_f32_16x16x32_bf16 v[180:183], a[184:187], v[44:47], v[180:183]
    s_waitcnt lgkmcnt(6)
    v_mfma_f32_16x16x32_bf16 v[192:195], a[188:191], a[80:83], v[192:195]
    ds_read_b64_tr_b16 a[172:173], v67 offset:10240
    ds_read_b64_tr_b16 a[174:175], v67 offset:24576
    v_mfma_f32_16x16x32_bf16 v[200:203], a[188:191], a[136:139], v[200:203]
    v_mfma_f32_16x16x32_bf16 v[184:187], a[188:191], v[44:47], v[184:187]
    s_waitcnt lgkmcnt(6)
    v_mfma_f32_16x16x32_bf16 v[204:207], a[192:195], a[24:27], v[204:207]
    ds_read_b64_tr_b16 a[176:177], v66 offset:36864
    ds_read_b64_tr_b16 a[178:179], v66 offset:51200
    v_mfma_f32_16x16x32_bf16 v[212:215], a[192:195], a[80:83], v[212:215]
    v_mfma_f32_16x16x32_bf16 v[220:223], a[192:195], a[136:139], v[220:223]
    s_waitcnt lgkmcnt(6)
    v_mfma_f32_16x16x32_bf16 v[208:211], a[196:199], a[24:27], v[208:211]
    ds_read_b64_tr_b16 a[180:181], v67 offset:36864
    ds_read_b64_tr_b16 a[182:183], v67 offset:51200
    v_mfma_f32_16x16x32_bf16 v[216:219], a[196:199], a[80:83], v[216:219]
    v_mfma_f32_16x16x32_bf16 v[224:227], a[196:199], a[136:139], v[224:227]
    s_waitcnt lgkmcnt(6)
    v_mfma_f32_16x16x32_bf16 v[228:231], a[24:27], a[168:171], v[228:231]
    ds_read_b64_tr_b16 a[184:185], v66 offset:37888
    ds_read_b64_tr_b16 a[186:187], v66 offset:52224
    v_mfma_f32_16x16x32_bf16 v[236:239], a[80:83], a[168:171], v[236:239]
    v_mfma_f32_16x16x32_bf16 v[244:247], a[136:139], a[168:171], v[244:247]
    s_waitcnt lgkmcnt(6)
    v_mfma_f32_16x16x32_bf16 v[232:235], a[24:27], a[172:175], v[232:235]
    ds_read_b64_tr_b16 a[188:189], v67 offset:37888
    ds_read_b64_tr_b16 a[190:191], v67 offset:52224
    v_mfma_f32_16x16x32_bf16 v[240:243], a[80:83], a[172:175], v[240:243]
    v_mfma_f32_16x16x32_bf16 v[248:251], a[136:139], a[172:175], v[248:251]
    s_waitcnt lgkmcnt(6)
    v_mfma_f32_16x16x32_bf16 v[188:191], a[176:179], a[84:87], v[188:191]
    ds_read_b64_tr_b16 a[192:193], v66 offset:38912
    ds_read_b64_tr_b16 a[194:195], v66 offset:53248
    v_mfma_f32_16x16x32_bf16 v[196:199], a[176:179], a[140:143], v[196:199]
    v_mfma_f32_16x16x32_bf16 v[180:183], a[176:179], v[44:47], v[180:183]
    s_waitcnt lgkmcnt(6)
    v_mfma_f32_16x16x32_bf16 v[192:195], a[180:183], a[84:87], v[192:195]
    ds_read_b64_tr_b16 a[196:197], v67 offset:38912
    ds_read_b64_tr_b16 a[198:199], v67 offset:53248
    v_mfma_f32_16x16x32_bf16 v[200:203], a[180:183], a[140:143], v[200:203]
    v_mfma_f32_16x16x32_bf16 v[184:187], a[180:183], v[44:47], v[184:187]
    s_waitcnt lgkmcnt(6)
    v_mfma_f32_16x16x32_bf16 v[204:207], a[184:187], a[28:31], v[204:207]
    s_waitcnt vmcnt(22)
    s_barrier
    v_readfirstlane_b32 s57, v178
    s_nop 0
    s_cmp_lg_u32 s57, 0
    s_cbranch_scc1 L_nonce_ok
    s_mov_b32 s63, 0
L_nonce:
    buffer_load_dword v178, v179, s[44:47], 0 offen sc1
    s_add_u32 s63, s63, 1
    s_waitcnt vmcnt(0)
    v_readfirstlane_b32 s57, v178
    s_cmp_ge_u32 s63, 20000
    s_cbranch_scc1 L_nonce_ok
    s_cmp_eq_u32 s57, 0
    s_cbranch_scc1 L_nonce
L_nonce_ok:
    s_lshl_b32 s3, s50, 6
    s_add_u32 s3, s3, s59
    s_lshl_b32 s3, s3, 2
    s_add_u32 s3, s3, s60
    s_add_u32 s3, s3, 6291456
    v_lshlrev_b32 v8, 24, v1
    buffer_store_dword v178, v8, s[28:31], s3 offen sc1
    ds_read_b64_tr_b16 a[168:169], v66 offset:11264
    ds_read_b64_tr_b16 a[170:171], v66 offset:25600
    v_mfma_f32_16x16x32_bf16 v[212:215], a[184:187], a[84:87], v[212:215]
    v_mfma_f32_16x16x32_bf16 v[220:223], a[184:187], a[140:143], v[220:223]
    s_waitcnt lgkmcnt(6)
    v_mfma_f32_16x16x32_bf16 v[208:211], a[188:191], a[28:31], v[208:211]
    ds_read_b64_tr_b16 a[172:173], v67 offset:11264
    ds_read_b64_tr_b16 a[174:175], v67 offset:25600
    v_mfma_f32_16x16x32_bf16 v[216:219], a[188:191], a[84:87], v[216:219]
    v_mfma_f32_16x16x32_bf16 v[224:227], a[188:191], a[140:143], v[224:227]
    s_waitcnt lgkmcnt(6)
    v_mfma_f32_16x16x32_bf16 v[228:231], a[28:31], a[192:195], v[228:231]
    ds_read_b64_tr_b16 a[176:177], v66 offset:12288
    ds_read_b64_tr_b16 a[178:179], v66 offset:26624
    v_mfma_f32_16x16x32_bf16 v[236:239], a[84:87], a[192:195], v[236:239]
    v_mfma_f32_16x16x32_bf16 v[244:247], a[140:143], a[192:195], v[244:247]
    s_waitcnt lgkmcnt(6)
    v_mfma_f32_16x16x32_bf16 v[232:235], a[28:31], a[196:199], v[232:235]
    ds_read_b64_tr_b16 a[180:181], v67 offset:12288
    ds_read_b64_tr_b16 a[182:183], v67 offset:26624
    v_mfma_f32_16x16x32_bf16 v[240:243], a[84:87], a[196:199], v[240:243]
    v_mfma_f32_16x16x32_bf16 v[248:251], a[140:143], a[196:199], v[248:251]
    s_waitcnt lgkmcnt(6)
    v_mfma_f32_16x16x32_bf16 v[188:191], a[168:171], a[88:91], v[188:191]
    ds_read_b64_tr_b16 a[184:185], v66 offset:13312
    ds_read_b64_tr_b16 a[186:187], v66 offset:27648
    v_mfma_f32_16x16x32_bf16 v[196:199], a[168:171], a[144:147], v[196:199]
    v_mfma_f32_16x16x32_bf16 v[180:183], a[168:171], v[44:47], v[180:183]
    s_waitcnt lgkmcnt(6)
    v_mfma_f32_16x16x32_bf16 v[192:195], a[172:175], a[88:91], v[192:195]
    ds_read_b64_tr_b16 a[188:189], v67 offset:13312
    ds_read_b64_tr_b16 a[190:191], v67 offset:27648
    v_mfma_f32_16x16x32_bf16 v[200:203], a[172:175], a[144:147], v[200:203]
    v_mfma_f32_16x16x32_bf16 v[184:187], a[172:175], v[44:47], v[184:187]
    s_waitcnt lgkmcnt(6)
    v_mfma_f32_16x16x32_bf16 v[204:207], a[176:179], a[32:35], v[204:207]
    ds_read_b64_tr_b16 a[192:193], v66 offset:39936
    ds_read_b64_tr_b16 a[194:195], v66 offset:54272
    v_mfma_f32_16x16x32_bf16 v[212:215], a[176:179], a[88:91], v[212:215]
    v_mfma_f32_16x16x32_bf16 v[220:223], a[176:179], a[144:147], v[220:223]
    s_waitcnt lgkmcnt(6)
    v_mfma_f32_16x16x32_bf16 v[208:211], a[180:183], a[32:35], v[208:211]
    ds_read_b64_tr_b16 a[196:197], v67 offset:39936
    ds_read_b64_tr_b16 a[198:199], v67 offset:54272
    v_mfma_f32_16x16x32_bf16 v[216:219], a[180:183], a[88:91], v[216:219]
    v_mfma_f32_16x16x32_bf16 v[224:227], a[180:183], a[144:147], v[224:227]
    s_waitcnt lgkmcnt(6)
    v_mfma_f32_16x16x32_bf16 v[228:231], a[32:35], a[184:187], v[228:231]
    ds_read_b64_tr_b16 a[168:169], v66 offset:40960
    ds_read_b64_tr_b16 a[170:171], v66 offset:55296
    v_mfma_f32_16x16x32_bf16 v[236:239], a[88:91], a[184:187], v[236:239]
    v_mfma_f32_16x16x32_bf16 v[244:247], a[144:147], a[184:187], v[244:247]
    s_waitcnt lgkmcnt(6)
    v_mfma_f32_16x16x32_bf16 v[232:235], a[32:35], a[188:191], v[232:235]
    ds_read_b64_tr_b16 a[172:173], v67 offset:40960
    ds_read_b64_tr_b16 a[174:175], v67 offset:55296
    v_mfma_f32_16x16x32_bf16 v[240:243], a[88:91], a[188:191], v[240:243]
    v_mfma_f32_16x16x32_bf16 v[248:251], a[144:147], a[188:191], v[248:251]
    s_waitcnt lgkmcnt(6)
    v_mfma_f32_16x16x32_bf16 v[188:191], a[192:195], a[92:95], v[188:191]
    ds_read_b64_tr_b16 a[176:177], v66 offset:41984
    ds_read_b64_tr_b16 a[178:179], v66 offset:56320
    v_mfma_f32_16x16x32_bf16 v[196:199], a[192:195], a[148:151], v[196:199]
    v_mfma_f32_16x16x32_bf16 v[180:183], a[192:195], v[44:47], v[180:183]
    s_waitcnt lgkmcnt(6)
    v_mfma_f32_16x16x32_bf16 v[192:195], a[196:199], a[92:95], v[192:195]
    ds_read_b64_tr_b16 a[180:181], v67 offset:41984
    ds_read_b64_tr_b16 a[182:183], v67 offset:56320
    v_mfma_f32_16x16x32_bf16 v[200:203], a[196:199], a[148:151], v[200:203]
    v_mfma_f32_16x16x32_bf16 v[184:187], a[196:199], v[44:47], v[184:187]
    s_waitcnt lgkmcnt(6)
    v_mfma_f32_16x16x32_bf16 v[204:207], a[168:171], a[36:39], v[204:207]
    s_waitcnt vmcnt(20)
    s_barrier
    ds_read_b64_tr_b16 a[184:185], v66 offset:14336
    ds_read_b64_tr_b16 a[186:187], v66 offset:28672
    v_mfma_f32_16x16x32_bf16 v[212:215], a[168:171], a[92:95], v[212:215]
    v_mfma_f32_16x16x32_bf16 v[220:223], a[168:171], a[148:151], v[220:223]
    s_waitcnt lgkmcnt(6)
    v_mfma_f32_16x16x32_bf16 v[208:211], a[172:175], a[36:39], v[208:211]
    ds_read_b64_tr_b16 a[188:189], v67 offset:14336
    ds_read_b64_tr_b16 a[190:191], v67 offset:28672
    v_mfma_f32_16x16x32_bf16 v[216:219], a[172:175], a[92:95], v[216:219]
    v_mfma_f32_16x16x32_bf16 v[224:227], a[172:175], a[148:151], v[224:227]
    s_waitcnt lgkmcnt(6)
    v_mfma_f32_16x16x32_bf16 v[228:231], a[36:39], a[176:179], v[228:231]
    ds_read_b64_tr_b16 a[192:193], v66 offset:15360
    ds_read_b64_tr_b16 a[194:195], v66 offset:29696
    v_mfma_f32_16x16x32_bf16 v[236:239], a[92:95], a[176:179], v[236:239]
    v_mfma_f32_16x16x32_bf16 v[244:247], a[148:151], a[176:179], v[244:247]
    s_waitcnt lgkmcnt(6)
    v_mfma_f32_16x16x32_bf16 v[232:235], a[36:39], a[180:183], v[232:235]
    ds_read_b64_tr_b16 a[196:197], v67 offset:15360
    ds_read_b64_tr_b16 a[198:199], v67 offset:29696
    v_mfma_f32_16x16x32_bf16 v[240:243], a[92:95], a[180:183], v[240:243]
    v_mfma_f32_16x16x32_bf16 v[248:251], a[148:151], a[180:183], v[248:251]
    s_waitcnt lgkmcnt(6)
    v_mfma_f32_16x16x32_bf16 v[188:191], a[184:187], a[96:99], v[188:191]
    ds_read_b64_tr_b16 a[168:169], v66 offset:16384
    ds_read_b64_tr_b16 a[170:171], v66 offset:30720
    v_mfma_f32_16x16x32_bf16 v[196:199], a[184:187], a[152:155], v[196:199]
    v_mfma_f32_16x16x32_bf16 v[180:183], a[184:187], v[44:47], v[180:183]
    s_waitcnt lgkmcnt(6)
    v_mfma_f32_16x16x32_bf16 v[192:195], a[188:191], a[96:99], v[192:195]
    ds_read_b64_tr_b16 a[172:173], v67 offset:16384
    ds_read_b64_tr_b16 a[174:175], v67 offset:30720
    v_mfma_f32_16x16x32_bf16 v[200:203], a[188:191], a[152:155], v[200:203]
    v_mfma_f32_16x16x32_bf16 v[184:187], a[188:191], v[44:47], v[184:187]
    s_waitcnt lgkmcnt(6)
    v_mfma_f32_16x16x32_bf16 v[204:207], a[192:195], a[40:43], v[204:207]
    ds_read_b64_tr_b16 a[176:177], v66 offset:43008
    ds_read_b64_tr_b16 a[178:179], v66 offset:57344
    v_mfma_f32_16x16x32_bf16 v[212:215], a[192:195], a[96:99], v[212:215]
    v_mfma_f32_16x16x32_bf16 v[220:223], a[192:195], a[152:155], v[220:223]
    s_waitcnt lgkmcnt(6)
    v_mfma_f32_16x16x32_bf16 v[208:211], a[196:199], a[40:43], v[208:211]
    ds_read_b64_tr_b16 a[180:181], v67 offset:43008
    ds_read_b64_tr_b16 a[182:183], v67 offset:57344
    v_mfma_f32_16x16x32_bf16 v[216:219], a[196:199], a[96:99], v[216:219]
    v_mfma_f32_16x16x32_bf16 v[224:227], a[196:199], a[152:155], v[224:227]
    s_waitcnt lgkmcnt(6)
    v_mfma_f32_16x16x32_bf16 v[228:231], a[40:43], a[168:171], v[228:231]
    ds_read_b64_tr_b16 a[184:185], v66 offset:44032
    ds_read_b64_tr_b16 a[186:187], v66 offset:58368
    v_mfma_f32_16x16x32_bf16 v[236:239], a[96:99], a[168:171], v[236:239]
    v_mfma_f32_16x16x32_bf16 v[244:247], a[152:155], a[168:171], v[244:247]
    s_waitcnt lgkmcnt(6)
    v_mfma_f32_16x16x32_bf16 v[232:235], a[40:43], a[172:175], v[232:235]
    ds_read_b64_tr_b16 a[188:189], v67 offset:44032
    ds_read_b64_tr_b16 a[190:191], v67 offset:58368
    v_mfma_f32_16x16x32_bf16 v[240:243], a[96:99], a[172:175], v[240:243]
    v_mfma_f32_16x16x32_bf16 v[248:251], a[152:155], a[172:175], v[248:251]
    s_waitcnt lgkmcnt(6)
    v_mfma_f32_16x16x32_bf16 v[188:191], a[176:179], a[100:103], v[188:191]
    ds_read_b64_tr_b16 a[192:193], v66 offset:45056
    ds_read_b64_tr_b16 a[194:195], v66 offset:59392
    v_mfma_f32_16x16x32_bf16 v[196:199], a[176:179], a[156:159], v[196:199]
    v_mfma_f32_16x16x32_bf16 v[180:183], a[176:179], v[44:47], v[180:183]
    s_waitcnt lgkmcnt(6)
    v_mfma_f32_16x16x32_bf16 v[192:195], a[180:183], a[100:103], v[192:195]
    ds_read_b64_tr_b16 a[196:197], v67 offset:45056
    ds_read_b64_tr_b16 a[198:199], v67 offset:59392
    v_mfma_f32_16x16x32_bf16 v[200:203], a[180:183], a[156:159], v[200:203]
    v_mfma_f32_16x16x32_bf16 v[184:187], a[180:183], v[44:47], v[184:187]
    s_waitcnt lgkmcnt(6)
    v_mfma_f32_16x16x32_bf16 v[204:207], a[184:187], a[44:47], v[204:207]
    s_waitcnt vmcnt(17)
    s_barrier
    ds_read_b64_tr_b16 a[168:169], v66 offset:17408
    ds_read_b64_tr_b16 a[170:171], v66 offset:31744
    v_mfma_f32_16x16x32_bf16 v[212:215], a[184:187], a[100:103], v[212:215]
    v_mfma_f32_16x16x32_bf16 v[220:223], a[184:187], a[156:159], v[220:223]
    s_waitcnt lgkmcnt(6)
    v_mfma_f32_16x16x32_bf16 v[208:211], a[188:191], a[44:47], v[208:211]
    ds_read_b64_tr_b16 a[172:173], v67 offset:17408
    ds_read_b64_tr_b16 a[174:175], v67 offset:31744
    v_mfma_f32_16x16x32_bf16 v[216:219], a[188:191], a[100:103], v[216:219]
    v_mfma_f32_16x16x32_bf16 v[224:227], a[188:191], a[156:159], v[224:227]
    s_waitcnt lgkmcnt(6)
    v_mfma_f32_16x16x32_bf16 v[228:231], a[44:47], a[192:195], v[228:231]
    ds_read_b64_tr_b16 a[176:177], v66 offset:18432
    ds_read_b64_tr_b16 a[178:179], v66 offset:32768
    v_mfma_f32_16x16x32_bf16 v[236:239], a[100:103], a[192:195], v[236:239]
    v_mfma_f32_16x16x32_bf16 v[244:247], a[156:159], a[192:195], v[244:247]
    s_waitcnt lgkmcnt(6)
    v_mfma_f32_16x16x32_bf16 v[232:235], a[44:47], a[196:199], v[232:235]
    ds_read_b64_tr_b16 a[180:181], v67 offset:18432
    ds_read_b64_tr_b16 a[182:183], v67 offset:32768
    v_mfma_f32_16x16x32_bf16 v[240:243], a[100:103], a[196:199], v[240:243]
    v_mfma_f32_16x16x32_bf16 v[248:251], a[156:159], a[196:199], v[248:251]
    s_waitcnt lgkmcnt(6)
    v_mfma_f32_16x16x32_bf16 v[188:191], a[168:171], a[104:107], v[188:191]
    ds_read_b64_tr_b16 a[184:185], v66 offset:19456
    ds_read_b64_tr_b16 a[186:187], v66 offset:33792
    v_mfma_f32_16x16x32_bf16 v[196:199], a[168:171], a[160:163], v[196:199]
    v_mfma_f32_16x16x32_bf16 v[180:183], a[168:171], v[44:47], v[180:183]
    s_waitcnt lgkmcnt(6)
    v_mfma_f32_16x16x32_bf16 v[192:195], a[172:175], a[104:107], v[192:195]
    ds_read_b64_tr_b16 a[188:189], v67 offset:19456
    ds_read_b64_tr_b16 a[190:191], v67 offset:33792
    v_mfma_f32_16x16x32_bf16 v[200:203], a[172:175], a[160:163], v[200:203]
    v_mfma_f32_16x16x32_bf16 v[184:187], a[172:175], v[44:47], v[184:187]
    s_waitcnt lgkmcnt(6)
    v_mfma_f32_16x16x32_bf16 v[204:207], a[176:179], a[48:51], v[204:207]
    ds_read_b64_tr_b16 a[192:193], v66 offset:46080
    ds_read_b64_tr_b16 a[194:195], v66 offset:60416
    v_mfma_f32_16x16x32_bf16 v[212:215], a[176:179], a[104:107], v[212:215]
    v_mfma_f32_16x16x32_bf16 v[220:223], a[176:179], a[160:163], v[220:223]
    s_waitcnt lgkmcnt(6)
    v_mfma_f32_16x16x32_bf16 v[208:211], a[180:183], a[48:51], v[208:211]
    ds_read_b64_tr_b16 a[196:197], v67 offset:46080
    ds_read_b64_tr_b16 a[198:199], v67 offset:60416
    v_mfma_f32_16x16x32_bf16 v[216:219], a[180:183], a[104:107], v[216:219]
    v_mfma_f32_16x16x32_bf16 v[224:227], a[180:183], a[160:163], v[224:227]
    s_waitcnt lgkmcnt(6)
    v_mfma_f32_16x16x32_bf16 v[228:231], a[48:51], a[184:187], v[228:231]
    ds_read_b64_tr_b16 a[168:169], v66 offset:47104
    ds_read_b64_tr_b16 a[170:171], v66 offset:61440
    v_mfma_f32_16x16x32_bf16 v[236:239], a[104:107], a[184:187], v[236:239]
    v_mfma_f32_16x16x32_bf16 v[244:247], a[160:163], a[184:187], v[244:247]
    s_waitcnt lgkmcnt(6)
    v_mfma_f32_16x16x32_bf16 v[232:235], a[48:51], a[188:191], v[232:235]
    ds_read_b64_tr_b16 a[172:173], v67 offset:47104
    ds_read_b64_tr_b16 a[174:175], v67 offset:61440
    v_mfma_f32_16x16x32_bf16 v[240:243], a[104:107], a[188:191], v[240:243]
    v_mfma_f32_16x16x32_bf16 v[248:251], a[160:163], a[188:191], v[248:251]
    s_waitcnt lgkmcnt(6)
    v_mfma_f32_16x16x32_bf16 v[188:191], a[192:195], a[108:111], v[188:191]
    ds_read_b64_tr_b16 a[176:177], v66 offset:48128
    ds_read_b64_tr_b16 a[178:179], v66 offset:62464
    v_mfma_f32_16x16x32_bf16 v[196:199], a[192:195], a[164:167], v[196:199]
    v_mfma_f32_16x16x32_bf16 v[180:183], a[192:195], v[44:47], v[180:183]
    s_waitcnt lgkmcnt(6)
    v_mfma_f32_16x16x32_bf16 v[192:195], a[196:199], a[108:111], v[192:195]
    ds_read_b64_tr_b16 a[180:181], v67 offset:48128
    ds_read_b64_tr_b16 a[182:183], v67 offset:62464
    v_mfma_f32_16x16x32_bf16 v[200:203], a[196:199], a[164:167], v[200:203]
    v_mfma_f32_16x16x32_bf16 v[184:187], a[196:199], v[44:47], v[184:187]
    s_waitcnt lgkmcnt(6)
    v_mfma_f32_16x16x32_bf16 v[204:207], a[168:171], a[52:55], v[204:207]
    v_mfma_f32_16x16x32_bf16 v[212:215], a[168:171], a[108:111], v[212:215]
    v_mfma_f32_16x16x32_bf16 v[220:223], a[168:171], a[164:167], v[220:223]
    s_waitcnt lgkmcnt(4)
    v_mfma_f32_16x16x32_bf16 v[208:211], a[172:175], a[52:55], v[208:211]
    v_mfma_f32_16x16x32_bf16 v[216:219], a[172:175], a[108:111], v[216:219]
    v_mfma_f32_16x16x32_bf16 v[224:227], a[172:175], a[164:167], v[224:227]
    s_waitcnt lgkmcnt(2)
    v_mfma_f32_16x16x32_bf16 v[228:231], a[52:55], a[176:179], v[228:231]
    v_mfma_f32_16x16x32_bf16 v[236:239], a[108:111], a[176:179], v[236:239]
    v_mfma_f32_16x16x32_bf16 v[244:247], a[164:167], a[176:179], v[244:247]
    s_waitcnt lgkmcnt(0)
    v_mfma_f32_16x16x32_bf16 v[232:235], a[52:55], a[180:183], v[232:235]
    v_mfma_f32_16x16x32_bf16 v[240:243], a[108:111], a[180:183], v[240:243]
    v_mfma_f32_16x16x32_bf16 v[248:251], a[164:167], a[180:183], v[248:251]
    s_barrier
    s_add_u32 s3, s61, 4
    s_and_b32 s3, s3, 15
    s_mul_i32 s3, s3, 458752
    s_add_u32 s3, s3, s69
    s_add_u32 m0, s58, 65536
    s_nop 0
    buffer_load_dwordx4 v39, s[20:23], s3 offen lds
    buffer_load_dwordx4 v40, s[20:23], s3 offen offset:1024 lds
    buffer_load_dwordx4 v41, s[20:23], s3 offen offset:2048 lds
    buffer_load_dwordx4 v42, s[20:23], s3 offen offset:3072 lds
    s_add_u32 s3, s61, 5
    s_and_b32 s3, s3, 15
    s_mul_i32 s3, s3, 458752
    s_add_u32 s3, s3, s69
    s_add_u32 m0, s58, 81920
    s_nop 0
    buffer_load_dwordx4 v39, s[20:23], s3 offen lds
    buffer_load_dwordx4 v40, s[20:23], s3 offen offset:1024 lds
    buffer_load_dwordx4 v41, s[20:23], s3 offen offset:2048 lds
    buffer_load_dwordx4 v42, s[20:23], s3 offen offset:3072 lds
    s_add_u32 s3, s61, 6
    s_and_b32 s3, s3, 15
    s_mul_i32 s3, s3, 458752
    s_add_u32 s3, s3, s69
    s_add_u32 m0, s58, 98304
    s_nop 0
    buffer_load_dwordx4 v39, s[20:23], s3 offen lds
    buffer_load_dwordx4 v40, s[20:23], s3 offen offset:1024 lds
    buffer_load_dwordx4 v41, s[20:23], s3 offen offset:2048 lds
    buffer_load_dwordx4 v42, s[20:23], s3 offen offset:3072 lds
    s_add_u32 s3, s61, 7
    s_and_b32 s3, s3, 15
    s_mul_i32 s3, s3, 458752
    s_add_u32 s3, s3, s69
    s_add_u32 m0, s58, 114688
    s_nop 0
    buffer_load_dwordx4 v39, s[20:23], s3 offen lds
    buffer_load_dwordx4 v40, s[20:23], s3 offen offset:1024 lds
    buffer_load_dwordx4 v41, s[20:23], s3 offen offset:2048 lds
    buffer_load_dwordx4 v42, s[20:23], s3 offen offset:3072 lds
    s_add_u32 s3, s61, 8
    s_and_b32 s3, s3, 15
    s_mul_i32 s3, s3, 458752
    s_add_u32 s3, s3, s69
    s_add_u32 m0, s58, 131072
    s_nop 0
    buffer_load_dwordx4 v39, s[20:23], s3 offen lds
    buffer_load_dwordx4 v40, s[20:23], s3 offen offset:1024 lds
    buffer_load_dwordx4 v41, s[20:23], s3 offen offset:2048 lds
    buffer_load_dwordx4 v42, s[20:23], s3 offen offset:3072 lds
    s_add_u32 s3, s61, 9
    s_and_b32 s3, s3, 15
    s_mul_i32 s3, s3, 458752
    s_add_u32 s3, s3, s69
    s_add_u32 m0, s58, 147456
    s_nop 0
    buffer_load_dwordx4 v39, s[20:23], s3 offen lds
    buffer_load_dwordx4 v40, s[20:23], s3 offen offset:1024 lds
    buffer_load_dwordx4 v41, s[20:23], s3 offen offset:2048 lds
    buffer_load_dwordx4 v42, s[20:23], s3 offen offset:3072 lds
    s_mov_b32 s70, 0xaaaaaaaa
    s_mov_b32 s71, 0xaaaaaaaa
    s_mov_b32 s72, 0xfff0ffff
    s_mov_b32 s73, 0xf000ff00
    s_mov_b32 s74, 0xffc0fffc
    s_mov_b32 s75, 0xc000fc00
    s_mov_b32 s76, 0x00000000
    s_mov_b32 s77, 0xffff0000
    s_cmp_eq_u32 s59, 0
    s_cselect_b64 s[64:65], 0, -1
    v_mfma_f32_16x16x4_f32 v[72:75], v49, v228, 0
    v_mfma_f32_16x16x4_f32 v[76:79], v49, v232, 0
    v_mov_b32_dpp v170, v204 row_newbcast:0 row_mask:0xf bank_mask:0xf
    v_mov_b32_dpp v171, v205 row_newbcast:0 row_mask:0xf bank_mask:0xf
    v_mov_b32_dpp v172, v206 row_newbcast:0 row_mask:0xf bank_mask:0xf
    v_mov_b32_dpp v173, v207 row_newbcast:0 row_mask:0xf bank_mask:0xf
    v_mov_b32_dpp v174, v208 row_newbcast:0 row_mask:0xf bank_mask:0xf
    v_mov_b32_dpp v175, v209 row_newbcast:0 row_mask:0xf bank_mask:0xf
    v_mov_b32_dpp v176, v210 row_newbcast:0 row_mask:0xf bank_mask:0xf
    v_mov_b32_dpp v177, v211 row_newbcast:0 row_mask:0xf bank_mask:0xf
    v_mul_f32 v188, v113, v188
    v_fmac_f32 v188, v116, v180
    v_mul_f32 v189, v113, v189
    v_fmac_f32 v189, v116, v181
    v_mul_f32 v190, v113, v190
    v_fmac_f32 v190, v116, v182
    v_mul_f32 v191, v113, v191
    v_fmac_f32 v191, v116, v183
    v_cvt_pk_bf16_f32 v50, v188, v189
    v_cvt_pk_bf16_f32 v51, v190, v191
    v_mul_f32 v192, v113, v192
    v_fmac_f32 v192, v116, v184
    v_mul_f32 v193, v113, v193
    v_fmac_f32 v193, v116, v185
    v_mul_f32 v194, v113, v194
    v_fmac_f32 v194, v116, v186
    v_mul_f32 v195, v113, v195
    v_fmac_f32 v195, v116, v187
    v_cvt_pk_bf16_f32 v52, v192, v193
    v_cvt_pk_bf16_f32 v53, v194, v195
    v_cndmask_b32 v52, v52, 0, s[76:77]
    v_cndmask_b32 v53, v53, 0, s[76:77]
    v_mul_f32 v196, v114, v196
    v_fmac_f32 v196, v117, v180
    v_mul_f32 v197, v114, v197
    v_fmac_f32 v197, v117, v181
    v_mul_f32 v198, v114, v198
    v_fmac_f32 v198, v117, v182
    v_mul_f32 v199, v114, v199
    v_fmac_f32 v199, v117, v183
    v_cvt_pk_bf16_f32 v54, v196, v197
    v_cvt_pk_bf16_f32 v55, v198, v199
    v_mul_f32 v200, v114, v200
    v_fmac_f32 v200, v117, v184
    v_mul_f32 v201, v114, v201
    v_fmac_f32 v201, v117, v185
    v_mul_f32 v202, v114, v202
    v_fmac_f32 v202, v117, v186
    v_mul_f32 v203, v114, v203
    v_fmac_f32 v203, v117, v187
    v_cvt_pk_bf16_f32 v56, v200, v201
    v_cvt_pk_bf16_f32 v57, v202, v203
    v_cndmask_b32 v56, v56, 0, s[76:77]
    v_cndmask_b32 v57, v57, 0, s[76:77]
    v_mul_f32 v204, v112, v204
    v_fmac_f32 v204, v115, v170
    v_mul_f32 v205, v112, v205
    v_fmac_f32 v205, v115, v171
    v_mul_f32 v206, v112, v206
    v_fmac_f32 v206, v115, v172
    v_mul_f32 v207, v112, v207
    v_fmac_f32 v207, v115, v173
    v_cvt_pk_bf16_f32 v142, v204, v205
    v_cvt_pk_bf16_f32 v143, v206, v207
    v_mul_f32 v208, v112, v208
    v_fmac_f32 v208, v115, v174
    v_mul_f32 v209, v112, v209
    v_fmac_f32 v209, v115, v175
    v_mul_f32 v210, v112, v210
    v_fmac_f32 v210, v115, v176
    v_mul_f32 v211, v112, v211
    v_fmac_f32 v211, v115, v177
    v_cvt_pk_bf16_f32 v144, v208, v209
    v_cvt_pk_bf16_f32 v145, v210, v211
    v_mul_f32 v212, v113, v212
    v_fmac_f32 v212, v116, v170
    v_mul_f32 v213, v113, v213
    v_fmac_f32 v213, v116, v171
    v_mul_f32 v214, v113, v214
    v_fmac_f32 v214, v116, v172
    v_mul_f32 v215, v113, v215
    v_fmac_f32 v215, v116, v173
    v_cvt_pk_bf16_f32 v146, v212, v213
    v_cvt_pk_bf16_f32 v147, v214, v215
    v_mul_f32 v216, v113, v216
    v_fmac_f32 v216, v116, v174
    v_mul_f32 v217, v113, v217
    v_fmac_f32 v217, v116, v175
    v_mul_f32 v218, v113, v218
    v_fmac_f32 v218, v116, v176
    v_mul_f32 v219, v113, v219
    v_fmac_f32 v219, v116, v177
    v_cvt_pk_bf16_f32 v148, v216, v217
    v_cvt_pk_bf16_f32 v149, v218, v219
    v_mul_f32 v220, v114, v220
    v_fmac_f32 v220, v117, v170
    v_mul_f32 v221, v114, v221
    v_fmac_f32 v221, v117, v171
    v_mul_f32 v222, v114, v222
    v_fmac_f32 v222, v117, v172
    v_mul_f32 v223, v114, v223
    v_fmac_f32 v223, v117, v173
    v_cvt_pk_bf16_f32 v80, v220, v221
    v_cvt_pk_bf16_f32 v81, v222, v223
    v_mul_f32 v224, v114, v224
    v_fmac_f32 v224, v117, v174
    v_mul_f32 v225, v114, v225
    v_fmac_f32 v225, v117, v175
    v_mul_f32 v226, v114, v226
    v_fmac_f32 v226, v117, v176
    v_mul_f32 v227, v114, v227
    v_fmac_f32 v227, v117, v177
    v_cvt_pk_bf16_f32 v82, v224, v225
    v_cvt_pk_bf16_f32 v83, v226, v227
    v_mfma_f32_16x16x32_bf16 v[96:99], v[142:145], v[50:53], 0
    v_mfma_f32_16x16x32_bf16 v[100:103], v[146:149], v[50:53], 0
    v_mfma_f32_16x16x32_bf16 v[104:107], v[146:149], v[54:57], 0
    v_mfma_f32_16x16x32_bf16 v[108:111], v[80:83], v[54:57], 0
    v_mul_f32 v228, v118, v228
    v_fmac_f32 v228, v130, v72
    v_mul_f32 v229, v119, v229
    v_fmac_f32 v229, v131, v72
    v_mul_f32 v230, v120, v230
    v_fmac_f32 v230, v132, v72
    v_mul_f32 v231, v121, v231
    v_fmac_f32 v231, v133, v72
    v_cvt_pk_bf16_f32 v84, v228, v229
    v_cvt_pk_bf16_f32 v85, v230, v231
    v_mul_f32 v236, v122, v236
    v_fmac_f32 v236, v134, v72
    v_mul_f32 v237, v123, v237
    v_fmac_f32 v237, v135, v72
    v_mul_f32 v238, v124, v238
    v_fmac_f32 v238, v136, v72
    v_mul_f32 v239, v125, v239
    v_fmac_f32 v239, v137, v72
    v_cvt_pk_bf16_f32 v86, v236, v237
    v_cvt_pk_bf16_f32 v87, v238, v239
    v_mul_f32 v244, v126, v244
    v_fmac_f32 v244, v138, v72
    v_mul_f32 v245, v127, v245
    v_fmac_f32 v245, v139, v72
    v_mul_f32 v246, v128, v246
    v_fmac_f32 v246, v140, v72
    v_mul_f32 v247, v129, v247
    v_fmac_f32 v247, v141, v72
    v_cvt_pk_bf16_f32 v88, v244, v245
    v_cvt_pk_bf16_f32 v89, v246, v247
    v_mul_f32 v232, v118, v232
    v_fmac_f32 v232, v130, v76
    v_mul_f32 v233, v119, v233
    v_fmac_f32 v233, v131, v76
    v_mul_f32 v234, v120, v234
    v_fmac_f32 v234, v132, v76
    v_mul_f32 v235, v121, v235
    v_fmac_f32 v235, v133, v76
    v_cvt_pk_bf16_f32 v90, v232, v233
    v_cvt_pk_bf16_f32 v91, v234, v235
    v_mul_f32 v240, v122, v240
    v_fmac_f32 v240, v134, v76
    v_mul_f32 v241, v123, v241
    v_fmac_f32 v241, v135, v76
    v_mul_f32 v242, v124, v242
    v_fmac_f32 v242, v136, v76
    v_mul_f32 v243, v125, v243
    v_fmac_f32 v243, v137, v76
    v_cvt_pk_bf16_f32 v92, v240, v241
    v_cvt_pk_bf16_f32 v93, v242, v243
    v_mul_f32 v248, v126, v248
    v_fmac_f32 v248, v138, v76
    v_mul_f32 v249, v127, v249
    v_fmac_f32 v249, v139, v76
    v_mul_f32 v250, v128, v250
    v_fmac_f32 v250, v140, v76
    v_mul_f32 v251, v129, v251
    v_fmac_f32 v251, v141, v76
    v_cvt_pk_bf16_f32 v94, v248, v249
    v_cvt_pk_bf16_f32 v95, v250, v251
    v_mov_b32 v5, 0xffff
    v_mov_b32 v6, 0xffff0000
    v_cndmask_b32 v5, v5, v6, s[70:71]
    v_cndmask_b32 v44, v5, 0, s[72:73]
    v_cndmask_b32 v46, 0, v5, s[72:73]
    v_cndmask_b32 v45, v5, 0, s[74:75]
    v_cndmask_b32 v47, 0, v5, s[74:75]
    v_mov_b32 v70, 0xf149f2ca
    s_mov_b32 s78, 0x3e8b97f6
    v_cndmask_b32 v158, v96, v97, s[70:71]
    v_cndmask_b32 v158, v70, v158, s[64:65]
    v_cndmask_b32 v161, v100, v101, s[70:71]
    v_cndmask_b32 v158, v158, v161, s[72:73]
    v_cndmask_b32 v162, v104, v105, s[70:71]
    v_cndmask_b32 v165, v108, v109, s[70:71]
    v_cndmask_b32 v162, v162, v165, s[72:73]
    v_cndmask_b32 v159, v98, v99, s[70:71]
    v_cndmask_b32 v159, v70, v159, s[64:65]
    v_cndmask_b32 v161, v102, v103, s[70:71]
    v_cndmask_b32 v159, v159, v161, s[74:75]
    v_cndmask_b32 v163, v106, v107, s[70:71]
    v_cndmask_b32 v165, v110, v111, s[70:71]
    v_cndmask_b32 v163, v163, v165, s[74:75]
    v_max_f32 v160, v158, v159
    v_max_f32 v164, v162, v163
    v_mov_b32 v161, v160
    v_mov_b32 v165, v164
    s_nop 0
    v_permlane16_swap_b32 v160, v161
    v_permlane16_swap_b32 v164, v165
    v_max_f32 v160, v160, v161
    v_max_f32 v164, v164, v165
    v_mov_b32 v161, v160
    v_mov_b32 v165, v164
    s_nop 0
    v_permlane32_swap_b32 v160, v161
    v_permlane32_swap_b32 v164, v165
    v_max_f32 v160, v160, v161
    v_max_f32 v164, v164, v165
    v_sub_f32 v158, v158, v160
    v_sub_f32 v159, v159, v160
    v_sub_f32 v162, v162, v164
    v_sub_f32 v163, v163, v164
    v_mul_f32 v158, s78, v158
    v_mul_f32 v159, s78, v159
    v_mul_f32 v162, s78, v162
    v_mul_f32 v163, s78, v163
    v_exp_f32 v158, v158
    v_exp_f32 v159, v159
    v_exp_f32 v162, v162
    v_exp_f32 v163, v163
    v_add_f32 v160, v158, v159
    v_add_f32 v164, v162, v163
    v_mov_b32 v161, v160
    v_mov_b32 v165, v164
    s_nop 0
    v_permlane16_swap_b32 v160, v161
    v_permlane16_swap_b32 v164, v165
    v_add_f32 v160, v160, v161
    v_add_f32 v164, v164, v165
    v_mov_b32 v161, v160
    v_mov_b32 v165, v164
    s_nop 0
    v_permlane32_swap_b32 v160, v161
    v_permlane32_swap_b32 v164, v165
    v_add_f32 v160, v160, v161
    v_add_f32 v164, v164, v165
    v_rcp_f32 v160, v160
    v_rcp_f32 v164, v164
    v_mul_f32 v158, v158, v160
    v_mul_f32 v159, v159, v160
    v_mul_f32 v162, v162, v164
    v_mul_f32 v163, v163, v164
    v_cvt_pk_bf16_f32 v158, v158, v158
    v_cvt_pk_bf16_f32 v159, v159, v159
    v_cvt_pk_bf16_f32 v162, v162, v162
    v_cvt_pk_bf16_f32 v163, v163, v163
    v_and_b32 v150, v158, v44
    v_and_b32 v151, v159, v45
    v_and_b32 v152, v158, v46
    v_and_b32 v153, v159, v47
    v_and_b32 v154, v162, v44
    v_and_b32 v155, v163, v45
    v_and_b32 v156, v162, v46
    v_and_b32 v157, v163, v47
    v_mfma_f32_16x16x32_bf16 v[188:191], v[84:87], v[150:153], 0
    v_mfma_f32_16x16x32_bf16 v[192:195], v[90:93], v[150:153], 0
    v_mfma_f32_16x16x32_bf16 v[196:199], v[86:89], v[154:157], 0
    v_mfma_f32_16x16x32_bf16 v[200:203], v[92:95], v[154:157], 0
    s_lshl_b32 s3, s59, 5
    s_add_u32 s3, s3, s50
    s_lshl_b32 s3, s3, 10
    s_add_u32 s3, s3, 4194304
    s_nop 0
    v_cvt_pk_bf16_f32 v170, v188, v189
    v_cvt_pk_bf16_f32 v171, v190, v191
    v_cvt_pk_bf16_f32 v172, v192, v193
    v_cvt_pk_bf16_f32 v173, v194, v195
    v_cndmask_b32 v172, v172, 0, s[76:77]
    v_cndmask_b32 v173, v173, 0, s[76:77]
    buffer_store_dwordx4 v[170:173], v4, s[28:31], s3 offen sc1
    v_cvt_pk_bf16_f32 v174, v196, v197
    v_cvt_pk_bf16_f32 v175, v198, v199
    v_cvt_pk_bf16_f32 v176, v200, v201
    v_cvt_pk_bf16_f32 v177, v202, v203
    v_cndmask_b32 v176, v176, 0, s[76:77]
    v_cndmask_b32 v177, v177, 0, s[76:77]
    s_add_u32 s3, s3, 16384
    buffer_store_dwordx4 v[174:177], v4, s[28:31], s3 offen sc1
    v_mov_b32 v43, s57
    s_lshl_b32 s64, s59, 5
    s_add_u32 s64, s64, s50
    s_lshl_b32 s64, s64, 2
    s_add_u32 s64, s64, 6307840
    v_lshl_add_u32 v92, v16, 12, v38
    v_add_u32 v93, 31744, v92
    v_add_u32 v94, 63488, v92
    v_add_u32 v95, 95232, v92
    v_mul_u32_u24 v5, 896, v16
    v_add_u32 v96, v5, v38
    v_add_u32 v97, 6144, v96
    v_lshl_add_u32 v118, v17, 4, v5
    s_lshl_b32 s65, s48, 17
    s_lshl_b32 s3, s53, 7
    s_add_u32 s65, s65, s3
    s_lshl_b32 s3, s54, 2
    s_add_u32 s3, s3, s48
    s_mul_i32 s66, s3, 57344
    s_add_u32 s66, s66, 2097152
    s_lshl_b32 s3, s53, 2
    s_add_u32 s3, s3, s48
    s_lshl_b32 s67, s3, 14
    s_add_u32 s67, s67, 4192256
    s_mul_i32 s68, s4, 25088
    s_mul_i32 s3, s5, 14336
    s_add_u32 s68, s68, s3
    s_lshl_b32 s3, s54, 7
    s_add_u32 s68, s68, s3
    s_lshl_b32 s70, s54, 1
    s_cmp_eq_u32 s55, 0
    s_cbranch_scc1 L_nog1
    v_lshlrev_b32 v5, 3, v3
    s_lshl_b32 s3, s51, 7
    buffer_load_dwordx2 v[100:101], v5, s[36:39], s3 offen offset:0
    buffer_load_dwordx2 v[102:103], v5, s[36:39], s3 offen offset:32
    buffer_load_dwordx2 v[104:105], v5, s[36:39], s3 offen offset:64
    buffer_load_dwordx2 v[106:107], v5, s[36:39], s3 offen offset:96
    s_lshl_b32 s3, s52, 1
    s_add_u32 s3, s3, s4
    s_lshl_b32 s3, s3, 8
    s_add_u32 s3, s3, 6291456
    v_lshlrev_b32 v98, 2, v1
    s_mov_b32 s63, 0
L_poll0:
    buffer_load_dword v99, v98, s[28:31], s3 offen sc1
    s_add_u32 s63, s63, 1
    s_waitcnt vmcnt(0)
    v_cmp_ne_u32 vcc, s57, v99
    s_cbranch_vccz L_pollok0
    s_sleep 4
    s_cmp_lt_u32 s63, 20000
    s_cbranch_scc1 L_poll0
L_pollok0:
    buffer_store_dword v43, v8, s[28:31], s64 offen sc1
    s_lshl_b32 s3, s52, 2
    s_add_u32 s3, s3, s48
    s_lshl_b32 s62, s3, 16
    s_mul_i32 s59, s3, 57344
    s_lshl_b32 s71, s3, 5
    s_add_u32 s71, s71, s51
    s_lshl_b32 s71, s71, 2
    s_add_u32 s71, s71, 6299648
    s_lshl_b32 s3, s51, 11
    s_add_u32 s59, s59, s3
    s_add_u32 s59, s59, 2097152
    s_add_u32 s3, s61, 0
    s_and_b32 s3, s3, 15
    s_lshl_b32 s3, s3, 12
    s_add_u32 s3, s3, s62
    buffer_load_dwordx4 a[0:3], v4, s[28:31], s3 offen offset:0 sc1
    buffer_load_dwordx4 a[4:7], v4, s[28:31], s3 offen offset:1024 sc1
    buffer_load_dwordx4 a[8:11], v4, s[28:31], s3 offen offset:2048 sc1
    buffer_load_dwordx4 a[12:15], v4, s[28:31], s3 offen offset:3072 sc1
    s_add_u32 s3, s61, 1
    s_and_b32 s3, s3, 15
    s_lshl_b32 s3, s3, 12
    s_add_u32 s3, s3, s62
    buffer_load_dwordx4 a[16:19], v4, s[28:31], s3 offen offset:0 sc1
    buffer_load_dwordx4 a[20:23], v4, s[28:31], s3 offen offset:1024 sc1
    buffer_load_dwordx4 a[24:27], v4, s[28:31], s3 offen offset:2048 sc1
    buffer_load_dwordx4 a[28:31], v4, s[28:31], s3 offen offset:3072 sc1
    s_add_u32 s3, s61, 2
    s_and_b32 s3, s3, 15
    s_lshl_b32 s3, s3, 12
    s_add_u32 s3, s3, s62
    buffer_load_dwordx4 a[32:35], v4, s[28:31], s3 offen offset:0 sc1
    buffer_load_dwordx4 a[36:39], v4, s[28:31], s3 offen offset:1024 sc1
    buffer_load_dwordx4 a[40:43], v4, s[28:31], s3 offen offset:2048 sc1
    buffer_load_dwordx4 a[44:47], v4, s[28:31], s3 offen offset:3072 sc1
    s_add_u32 s3, s61, 3
    s_and_b32 s3, s3, 15
    s_lshl_b32 s3, s3, 12
    s_add_u32 s3, s3, s62
    buffer_load_dwordx4 a[48:51], v4, s[28:31], s3 offen offset:0 sc1
    buffer_load_dwordx4 a[52:55], v4, s[28:31], s3 offen offset:1024 sc1
    buffer_load_dwordx4 a[56:59], v4, s[28:31], s3 offen offset:2048 sc1
    buffer_load_dwordx4 a[60:63], v4, s[28:31], s3 offen offset:3072 sc1
    v_lshlrev_b32 v44, 16, v100
    v_and_b32 v45, 0xffff0000, v100
    v_lshlrev_b32 v46, 16, v101
    v_and_b32 v47, 0xffff0000, v101
    v_lshlrev_b32 v48, 16, v102
    v_and_b32 v49, 0xffff0000, v102
    v_lshlrev_b32 v50, 16, v103
    v_and_b32 v51, 0xffff0000, v103
    v_lshlrev_b32 v52, 16, v104
    v_and_b32 v53, 0xffff0000, v104
    v_lshlrev_b32 v54, 16, v105
    v_and_b32 v55, 0xffff0000, v105
    v_lshlrev_b32 v56, 16, v106
    v_and_b32 v57, 0xffff0000, v106
    v_lshlrev_b32 v58, 16, v107
    v_and_b32 v59, 0xffff0000, v107
    s_barrier
    s_add_u32 s3, s61, 4
    s_and_b32 s3, s3, 15
    s_lshl_b32 s3, s3, 12
    s_add_u32 s3, s3, s62
    buffer_load_dwordx4 a[64:67], v4, s[28:31], s3 offen offset:0 sc1
    buffer_load_dwordx4 a[68:71], v4, s[28:31], s3 offen offset:1024 sc1
    buffer_load_dwordx4 a[72:75], v4, s[28:31], s3 offen offset:2048 sc1
    buffer_load_dwordx4 a[76:79], v4, s[28:31], s3 offen offset:3072 sc1
    ds_read_b64_tr_b16 v[60:61], v21 offset:0
    ds_read_b64_tr_b16 v[62:63], v21 offset:2048
    ds_read_b64_tr_b16 v[64:65], v22 offset:0
    ds_read_b64_tr_b16 v[66:67], v22 offset:2048
    ds_read_b64_tr_b16 v[68:69], v23 offset:0
    ds_read_b64_tr_b16 v[70:71], v23 offset:2048
    ds_read_b64_tr_b16 v[72:73], v24 offset:0
    ds_read_b64_tr_b16 v[74:75], v24 offset:2048
    ds_read_b64_tr_b16 v[76:77], v21 offset:4096
    ds_read_b64_tr_b16 v[78:79], v21 offset:6144
    ds_read_b64_tr_b16 v[80:81], v22 offset:4096
    ds_read_b64_tr_b16 v[82:83], v22 offset:6144
    s_waitcnt vmcnt(19) lgkmcnt(10)
    v_mfma_f32_16x16x32_bf16 v[44:47], v[60:63], a[0:3], v[44:47]
    ds_read_b64_tr_b16 v[84:85], v23 offset:4096
    ds_read_b64_tr_b16 v[86:87], v23 offset:6144
    s_waitcnt lgkmcnt(10)
    v_mfma_f32_16x16x32_bf16 v[48:51], v[64:67], a[0:3], v[48:51]
    ds_read_b64_tr_b16 v[88:89], v24 offset:4096
    ds_read_b64_tr_b16 v[90:91], v24 offset:6144
    s_waitcnt lgkmcnt(10)
    v_mfma_f32_16x16x32_bf16 v[52:55], v[68:71], a[0:3], v[52:55]
    ds_read_b64_tr_b16 v[60:61], v21 offset:8192
    ds_read_b64_tr_b16 v[62:63], v21 offset:10240
    s_waitcnt lgkmcnt(10)
    v_mfma_f32_16x16x32_bf16 v[56:59], v[72:75], a[0:3], v[56:59]
    ds_read_b64_tr_b16 v[64:65], v22 offset:8192
    ds_read_b64_tr_b16 v[66:67], v22 offset:10240
    s_waitcnt vmcnt(18) lgkmcnt(10)
    v_mfma_f32_16x16x32_bf16 v[44:47], v[76:79], a[4:7], v[44:47]
    ds_read_b64_tr_b16 v[68:69], v23 offset:8192
    ds_read_b64_tr_b16 v[70:71], v23 offset:10240
    s_waitcnt lgkmcnt(10)
    v_mfma_f32_16x16x32_bf16 v[48:51], v[80:83], a[4:7], v[48:51]
    ds_read_b64_tr_b16 v[72:73], v24 offset:8192
    ds_read_b64_tr_b16 v[74:75], v24 offset:10240
    s_waitcnt lgkmcnt(10)
    v_mfma_f32_16x16x32_bf16 v[52:55], v[84:87], a[4:7], v[52:55]
    ds_read_b64_tr_b16 v[76:77], v21 offset:12288
    ds_read_b64_tr_b16 v[78:79], v21 offset:14336
    s_waitcnt lgkmcnt(10)
    v_mfma_f32_16x16x32_bf16 v[56:59], v[88:91], a[4:7], v[56:59]
    ds_read_b64_tr_b16 v[80:81], v22 offset:12288
    ds_read_b64_tr_b16 v[82:83], v22 offset:14336
    s_waitcnt vmcnt(17) lgkmcnt(10)
    v_mfma_f32_16x16x32_bf16 v[44:47], v[60:63], a[8:11], v[44:47]
    ds_read_b64_tr_b16 v[84:85], v23 offset:12288
    ds_read_b64_tr_b16 v[86:87], v23 offset:14336
    s_waitcnt lgkmcnt(10)
    v_mfma_f32_16x16x32_bf16 v[48:51], v[64:67], a[8:11], v[48:51]
    ds_read_b64_tr_b16 v[88:89], v24 offset:12288
    ds_read_b64_tr_b16 v[90:91], v24 offset:14336
    s_waitcnt lgkmcnt(10)
    v_mfma_f32_16x16x32_bf16 v[52:55], v[68:71], a[8:11], v[52:55]
    s_barrier
    s_add_u32 s3, s61, 5
    s_and_b32 s3, s3, 15
    s_lshl_b32 s3, s3, 12
    s_add_u32 s3, s3, s62
    buffer_load_dwordx4 a[80:83], v4, s[28:31], s3 offen offset:0 sc1
    buffer_load_dwordx4 a[84:87], v4, s[28:31], s3 offen offset:1024 sc1
    buffer_load_dwordx4 a[88:91], v4, s[28:31], s3 offen offset:2048 sc1
    buffer_load_dwordx4 a[92:95], v4, s[28:31], s3 offen offset:3072 sc1
    ds_read_b64_tr_b16 v[60:61], v21 offset:16384
    ds_read_b64_tr_b16 v[62:63], v21 offset:18432
    s_waitcnt lgkmcnt(10)
    v_mfma_f32_16x16x32_bf16 v[56:59], v[72:75], a[8:11], v[56:59]
    ds_read_b64_tr_b16 v[64:65], v22 offset:16384
    ds_read_b64_tr_b16 v[66:67], v22 offset:18432
    s_waitcnt vmcnt(20) lgkmcnt(10)
    v_mfma_f32_16x16x32_bf16 v[44:47], v[76:79], a[12:15], v[44:47]
    ds_read_b64_tr_b16 v[68:69], v23 offset:16384
    ds_read_b64_tr_b16 v[70:71], v23 offset:18432
    s_waitcnt lgkmcnt(10)
    v_mfma_f32_16x16x32_bf16 v[48:51], v[80:83], a[12:15], v[48:51]
    ds_read_b64_tr_b16 v[72:73], v24 offset:16384
    ds_read_b64_tr_b16 v[74:75], v24 offset:18432
    s_waitcnt lgkmcnt(10)
    v_mfma_f32_16x16x32_bf16 v[52:55], v[84:87], a[12:15], v[52:55]
    ds_read_b64_tr_b16 v[76:77], v21 offset:20480
    ds_read_b64_tr_b16 v[78:79], v21 offset:22528
    s_waitcnt lgkmcnt(10)
    v_mfma_f32_16x16x32_bf16 v[56:59], v[88:91], a[12:15], v[56:59]
    ds_read_b64_tr_b16 v[80:81], v22 offset:20480
    ds_read_b64_tr_b16 v[82:83], v22 offset:22528
    s_waitcnt vmcnt(19) lgkmcnt(10)
    v_mfma_f32_16x16x32_bf16 v[44:47], v[60:63], a[16:19], v[44:47]
    ds_read_b64_tr_b16 v[84:85], v23 offset:20480
    ds_read_b64_tr_b16 v[86:87], v23 offset:22528
    s_waitcnt lgkmcnt(10)
    v_mfma_f32_16x16x32_bf16 v[48:51], v[64:67], a[16:19], v[48:51]
    ds_read_b64_tr_b16 v[88:89], v24 offset:20480
    ds_read_b64_tr_b16 v[90:91], v24 offset:22528
    s_waitcnt lgkmcnt(10)
    v_mfma_f32_16x16x32_bf16 v[52:55], v[68:71], a[16:19], v[52:55]
    ds_read_b64_tr_b16 v[60:61], v21 offset:24576
    ds_read_b64_tr_b16 v[62:63], v21 offset:26624
    s_waitcnt lgkmcnt(10)
    v_mfma_f32_16x16x32_bf16 v[56:59], v[72:75], a[16:19], v[56:59]
    ds_read_b64_tr_b16 v[64:65], v22 offset:24576
    ds_read_b64_tr_b16 v[66:67], v22 offset:26624
    s_waitcnt vmcnt(18) lgkmcnt(10)
    v_mfma_f32_16x16x32_bf16 v[44:47], v[76:79], a[20:23], v[44:47]
    ds_read_b64_tr_b16 v[68:69], v23 offset:24576
    ds_read_b64_tr_b16 v[70:71], v23 offset:26624
    s_waitcnt lgkmcnt(10)
    v_mfma_f32_16x16x32_bf16 v[48:51], v[80:83], a[20:23], v[48:51]
    ds_read_b64_tr_b16 v[72:73], v24 offset:24576
    ds_read_b64_tr_b16 v[74:75], v24 offset:26624
    s_waitcnt lgkmcnt(10)
    v_mfma_f32_16x16x32_bf16 v[52:55], v[84:87], a[20:23], v[52:55]
    ds_read_b64_tr_b16 v[76:77], v21 offset:28672
    ds_read_b64_tr_b16 v[78:79], v21 offset:30720
    s_waitcnt lgkmcnt(10)
    v_mfma_f32_16x16x32_bf16 v[56:59], v[88:91], a[20:23], v[56:59]
    ds_read_b64_tr_b16 v[80:81], v22 offset:28672
    ds_read_b64_tr_b16 v[82:83], v22 offset:30720
    s_waitcnt vmcnt(17) lgkmcnt(10)
    v_mfma_f32_16x16x32_bf16 v[44:47], v[60:63], a[24:27], v[44:47]
    ds_read_b64_tr_b16 v[84:85], v23 offset:28672
    ds_read_b64_tr_b16 v[86:87], v23 offset:30720
    s_waitcnt lgkmcnt(10)
    v_mfma_f32_16x16x32_bf16 v[48:51], v[64:67], a[24:27], v[48:51]
    ds_read_b64_tr_b16 v[88:89], v24 offset:28672
    ds_read_b64_tr_b16 v[90:91], v24 offset:30720
    s_waitcnt lgkmcnt(10)
    v_mfma_f32_16x16x32_bf16 v[52:55], v[68:71], a[24:27], v[52:55]
    s_barrier
    s_add_u32 s3, s61, 6
    s_and_b32 s3, s3, 15
    s_lshl_b32 s3, s3, 12
    s_add_u32 s3, s3, s62
    buffer_load_dwordx4 a[96:99], v4, s[28:31], s3 offen offset:0 sc1
    buffer_load_dwordx4 a[100:103], v4, s[28:31], s3 offen offset:1024 sc1
    buffer_load_dwordx4 a[104:107], v4, s[28:31], s3 offen offset:2048 sc1
    buffer_load_dwordx4 a[108:111], v4, s[28:31], s3 offen offset:3072 sc1
    s_add_u32 s3, s61, 10
    s_and_b32 s3, s3, 15
    s_mul_i32 s3, s3, 458752
    s_add_u32 s3, s3, s69
    s_add_u32 m0, s58, 0
    s_nop 0
    buffer_load_dwordx4 v39, s[20:23], s3 offen lds
    buffer_load_dwordx4 v40, s[20:23], s3 offen offset:1024 lds
    buffer_load_dwordx4 v41, s[20:23], s3 offen offset:2048 lds
    buffer_load_dwordx4 v42, s[20:23], s3 offen offset:3072 lds
    ds_read_b64_tr_b16 v[60:61], v21 offset:32768
    ds_read_b64_tr_b16 v[62:63], v21 offset:34816
    s_waitcnt lgkmcnt(10)
    v_mfma_f32_16x16x32_bf16 v[56:59], v[72:75], a[24:27], v[56:59]
    ds_read_b64_tr_b16 v[64:65], v22 offset:32768
    ds_read_b64_tr_b16 v[66:67], v22 offset:34816
    s_waitcnt vmcnt(24) lgkmcnt(10)
    v_mfma_f32_16x16x32_bf16 v[44:47], v[76:79], a[28:31], v[44:47]
    ds_read_b64_tr_b16 v[68:69], v23 offset:32768
    ds_read_b64_tr_b16 v[70:71], v23 offset:34816
    s_waitcnt lgkmcnt(10)
    v_mfma_f32_16x16x32_bf16 v[48:51], v[80:83], a[28:31], v[48:51]
    ds_read_b64_tr_b16 v[72:73], v24 offset:32768
    ds_read_b64_tr_b16 v[74:75], v24 offset:34816
    s_waitcnt lgkmcnt(10)
    v_mfma_f32_16x16x32_bf16 v[52:55], v[84:87], a[28:31], v[52:55]
    ds_read_b64_tr_b16 v[76:77], v21 offset:36864
    ds_read_b64_tr_b16 v[78:79], v21 offset:38912
    s_waitcnt lgkmcnt(10)
    v_mfma_f32_16x16x32_bf16 v[56:59], v[88:91], a[28:31], v[56:59]
    ds_read_b64_tr_b16 v[80:81], v22 offset:36864
    ds_read_b64_tr_b16 v[82:83], v22 offset:38912
    s_waitcnt vmcnt(23) lgkmcnt(10)
    v_mfma_f32_16x16x32_bf16 v[44:47], v[60:63], a[32:35], v[44:47]
    ds_read_b64_tr_b16 v[84:85], v23 offset:36864
    ds_read_b64_tr_b16 v[86:87], v23 offset:38912
    s_waitcnt lgkmcnt(10)
    v_mfma_f32_16x16x32_bf16 v[48:51], v[64:67], a[32:35], v[48:51]
    ds_read_b64_tr_b16 v[88:89], v24 offset:36864
    ds_read_b64_tr_b16 v[90:91], v24 offset:38912
    s_waitcnt lgkmcnt(10)
    v_mfma_f32_16x16x32_bf16 v[52:55], v[68:71], a[32:35], v[52:55]
    ds_read_b64_tr_b16 v[60:61], v21 offset:40960
    ds_read_b64_tr_b16 v[62:63], v21 offset:43008
    s_waitcnt lgkmcnt(10)
    v_mfma_f32_16x16x32_bf16 v[56:59], v[72:75], a[32:35], v[56:59]
    ds_read_b64_tr_b16 v[64:65], v22 offset:40960
    ds_read_b64_tr_b16 v[66:67], v22 offset:43008
    s_waitcnt vmcnt(22) lgkmcnt(10)
    v_mfma_f32_16x16x32_bf16 v[44:47], v[76:79], a[36:39], v[44:47]
    ds_read_b64_tr_b16 v[68:69], v23 offset:40960
    ds_read_b64_tr_b16 v[70:71], v23 offset:43008
    s_waitcnt lgkmcnt(10)
    v_mfma_f32_16x16x32_bf16 v[48:51], v[80:83], a[36:39], v[48:51]
    ds_read_b64_tr_b16 v[72:73], v24 offset:40960
    ds_read_b64_tr_b16 v[74:75], v24 offset:43008
    s_waitcnt lgkmcnt(10)
    v_mfma_f32_16x16x32_bf16 v[52:55], v[84:87], a[36:39], v[52:55]
    ds_read_b64_tr_b16 v[76:77], v21 offset:45056
    ds_read_b64_tr_b16 v[78:79], v21 offset:47104
    s_waitcnt lgkmcnt(10)
    v_mfma_f32_16x16x32_bf16 v[56:59], v[88:91], a[36:39], v[56:59]
    ds_read_b64_tr_b16 v[80:81], v22 offset:45056
    ds_read_b64_tr_b16 v[82:83], v22 offset:47104
    s_waitcnt vmcnt(21) lgkmcnt(10)
    v_mfma_f32_16x16x32_bf16 v[44:47], v[60:63], a[40:43], v[44:47]
    ds_read_b64_tr_b16 v[84:85], v23 offset:45056
    ds_read_b64_tr_b16 v[86:87], v23 offset:47104
    s_waitcnt lgkmcnt(10)
    v_mfma_f32_16x16x32_bf16 v[48:51], v[64:67], a[40:43], v[48:51]
    ds_read_b64_tr_b16 v[88:89], v24 offset:45056
    ds_read_b64_tr_b16 v[90:91], v24 offset:47104
    s_waitcnt lgkmcnt(10)
    v_mfma_f32_16x16x32_bf16 v[52:55], v[68:71], a[40:43], v[52:55]
    s_barrier
    s_add_u32 s3, s61, 7
    s_and_b32 s3, s3, 15
    s_lshl_b32 s3, s3, 12
    s_add_u32 s3, s3, s62
    buffer_load_dwordx4 a[112:115], v4, s[28:31], s3 offen offset:0 sc1
    buffer_load_dwordx4 a[116:119], v4, s[28:31], s3 offen offset:1024 sc1
    buffer_load_dwordx4 a[120:123], v4, s[28:31], s3 offen offset:2048 sc1
    buffer_load_dwordx4 a[124:127], v4, s[28:31], s3 offen offset:3072 sc1
    s_add_u32 s3, s61, 11
    s_and_b32 s3, s3, 15
    s_mul_i32 s3, s3, 458752
    s_add_u32 s3, s3, s69
    s_add_u32 m0, s58, 16384
    s_nop 0
    buffer_load_dwordx4 v39, s[20:23], s3 offen lds
    buffer_load_dwordx4 v40, s[20:23], s3 offen offset:1024 lds
    buffer_load_dwordx4 v41, s[20:23], s3 offen offset:2048 lds
    buffer_load_dwordx4 v42, s[20:23], s3 offen offset:3072 lds
    ds_read_b64_tr_b16 v[60:61], v21 offset:49152
    ds_read_b64_tr_b16 v[62:63], v21 offset:51200
    s_waitcnt lgkmcnt(10)
    v_mfma_f32_16x16x32_bf16 v[56:59], v[72:75], a[40:43], v[56:59]
    ds_read_b64_tr_b16 v[64:65], v22 offset:49152
    ds_read_b64_tr_b16 v[66:67], v22 offset:51200
    s_waitcnt vmcnt(28) lgkmcnt(10)
    v_mfma_f32_16x16x32_bf16 v[44:47], v[76:79], a[44:47], v[44:47]
    ds_read_b64_tr_b16 v[68:69], v23 offset:49152
    ds_read_b64_tr_b16 v[70:71], v23 offset:51200
    s_waitcnt lgkmcnt(10)
    v_mfma_f32_16x16x32_bf16 v[48:51], v[80:83], a[44:47], v[48:51]
    ds_read_b64_tr_b16 v[72:73], v24 offset:49152
    ds_read_b64_tr_b16 v[74:75], v24 offset:51200
    s_waitcnt lgkmcnt(10)
    v_mfma_f32_16x16x32_bf16 v[52:55], v[84:87], a[44:47], v[52:55]
    ds_read_b64_tr_b16 v[76:77], v21 offset:53248
    ds_read_b64_tr_b16 v[78:79], v21 offset:55296
    s_waitcnt lgkmcnt(10)
    v_mfma_f32_16x16x32_bf16 v[56:59], v[88:91], a[44:47], v[56:59]
    ds_read_b64_tr_b16 v[80:81], v22 offset:53248
    ds_read_b64_tr_b16 v[82:83], v22 offset:55296
    s_waitcnt vmcnt(27) lgkmcnt(10)
    v_mfma_f32_16x16x32_bf16 v[44:47], v[60:63], a[48:51], v[44:47]
    ds_read_b64_tr_b16 v[84:85], v23 offset:53248
    ds_read_b64_tr_b16 v[86:87], v23 offset:55296
    s_waitcnt lgkmcnt(10)
    v_mfma_f32_16x16x32_bf16 v[48:51], v[64:67], a[48:51], v[48:51]
    ds_read_b64_tr_b16 v[88:89], v24 offset:53248
    ds_read_b64_tr_b16 v[90:91], v24 offset:55296
    s_waitcnt lgkmcnt(10)
    v_mfma_f32_16x16x32_bf16 v[52:55], v[68:71], a[48:51], v[52:55]
    ds_read_b64_tr_b16 v[60:61], v21 offset:57344
    ds_read_b64_tr_b16 v[62:63], v21 offset:59392
    s_waitcnt lgkmcnt(10)
    v_mfma_f32_16x16x32_bf16 v[56:59], v[72:75], a[48:51], v[56:59]
    ds_read_b64_tr_b16 v[64:65], v22 offset:57344
    ds_read_b64_tr_b16 v[66:67], v22 offset:59392
    s_waitcnt vmcnt(26) lgkmcnt(10)
    v_mfma_f32_16x16x32_bf16 v[44:47], v[76:79], a[52:55], v[44:47]
    ds_read_b64_tr_b16 v[68:69], v23 offset:57344
    ds_read_b64_tr_b16 v[70:71], v23 offset:59392
    s_waitcnt lgkmcnt(10)
    v_mfma_f32_16x16x32_bf16 v[48:51], v[80:83], a[52:55], v[48:51]
    ds_read_b64_tr_b16 v[72:73], v24 offset:57344
    ds_read_b64_tr_b16 v[74:75], v24 offset:59392
    s_waitcnt lgkmcnt(10)
    v_mfma_f32_16x16x32_bf16 v[52:55], v[84:87], a[52:55], v[52:55]
    ds_read_b64_tr_b16 v[76:77], v21 offset:61440
    ds_read_b64_tr_b16 v[78:79], v21 offset:63488
    s_waitcnt lgkmcnt(10)
    v_mfma_f32_16x16x32_bf16 v[56:59], v[88:91], a[52:55], v[56:59]
    ds_read_b64_tr_b16 v[80:81], v22 offset:61440
    ds_read_b64_tr_b16 v[82:83], v22 offset:63488
    s_waitcnt vmcnt(25) lgkmcnt(10)
    v_mfma_f32_16x16x32_bf16 v[44:47], v[60:63], a[56:59], v[44:47]
    ds_read_b64_tr_b16 v[84:85], v23 offset:61440
    ds_read_b64_tr_b16 v[86:87], v23 offset:63488
    s_waitcnt lgkmcnt(10)
    v_mfma_f32_16x16x32_bf16 v[48:51], v[64:67], a[56:59], v[48:51]
    ds_read_b64_tr_b16 v[88:89], v24 offset:61440
    ds_read_b64_tr_b16 v[90:91], v24 offset:63488
    s_waitcnt lgkmcnt(10)
    v_mfma_f32_16x16x32_bf16 v[52:55], v[68:71], a[56:59], v[52:55]
    s_barrier
    s_add_u32 s3, s61, 8
    s_and_b32 s3, s3, 15
    s_lshl_b32 s3, s3, 12
    s_add_u32 s3, s3, s62
    buffer_load_dwordx4 a[128:131], v4, s[28:31], s3 offen offset:0 sc1
    buffer_load_dwordx4 a[132:135], v4, s[28:31], s3 offen offset:1024 sc1
    buffer_load_dwordx4 a[136:139], v4, s[28:31], s3 offen offset:2048 sc1
    buffer_load_dwordx4 a[140:143], v4, s[28:31], s3 offen offset:3072 sc1
    s_add_u32 s3, s61, 12
    s_and_b32 s3, s3, 15
    s_mul_i32 s3, s3, 458752
    s_add_u32 s3, s3, s69
    s_add_u32 m0, s58, 32768
    s_nop 0
    buffer_load_dwordx4 v39, s[20:23], s3 offen lds
    buffer_load_dwordx4 v40, s[20:23], s3 offen offset:1024 lds
    buffer_load_dwordx4 v41, s[20:23], s3 offen offset:2048 lds
    buffer_load_dwordx4 v42, s[20:23], s3 offen offset:3072 lds
    ds_read_b64_tr_b16 v[60:61], v25 offset:0
    ds_read_b64_tr_b16 v[62:63], v25 offset:2048
    s_waitcnt lgkmcnt(10)
    v_mfma_f32_16x16x32_bf16 v[56:59], v[72:75], a[56:59], v[56:59]
    ds_read_b64_tr_b16 v[64:65], v26 offset:0
    ds_read_b64_tr_b16 v[66:67], v26 offset:2048
    s_waitcnt vmcnt(32) lgkmcnt(10)
    v_mfma_f32_16x16x32_bf16 v[44:47], v[76:79], a[60:63], v[44:47]
    ds_read_b64_tr_b16 v[68:69], v27 offset:0
    ds_read_b64_tr_b16 v[70:71], v27 offset:2048
    s_waitcnt lgkmcnt(10)
    v_mfma_f32_16x16x32_bf16 v[48:51], v[80:83], a[60:63], v[48:51]
    ds_read_b64_tr_b16 v[72:73], v28 offset:0
    ds_read_b64_tr_b16 v[74:75], v28 offset:2048
    s_waitcnt lgkmcnt(10)
    v_mfma_f32_16x16x32_bf16 v[52:55], v[84:87], a[60:63], v[52:55]
    ds_read_b64_tr_b16 v[76:77], v25 offset:4096
    ds_read_b64_tr_b16 v[78:79], v25 offset:6144
    s_waitcnt lgkmcnt(10)
    v_mfma_f32_16x16x32_bf16 v[56:59], v[88:91], a[60:63], v[56:59]
    ds_read_b64_tr_b16 v[80:81], v26 offset:4096
    ds_read_b64_tr_b16 v[82:83], v26 offset:6144
    s_waitcnt vmcnt(31) lgkmcnt(10)
    v_mfma_f32_16x16x32_bf16 v[44:47], v[60:63], a[64:67], v[44:47]
    ds_read_b64_tr_b16 v[84:85], v27 offset:4096
    ds_read_b64_tr_b16 v[86:87], v27 offset:6144
    s_waitcnt lgkmcnt(10)
    v_mfma_f32_16x16x32_bf16 v[48:51], v[64:67], a[64:67], v[48:51]
    ds_read_b64_tr_b16 v[88:89], v28 offset:4096
    ds_read_b64_tr_b16 v[90:91], v28 offset:6144
    s_waitcnt lgkmcnt(10)
    v_mfma_f32_16x16x32_bf16 v[52:55], v[68:71], a[64:67], v[52:55]
    ds_read_b64_tr_b16 v[60:61], v25 offset:8192
    ds_read_b64_tr_b16 v[62:63], v25 offset:10240
    s_waitcnt lgkmcnt(10)
    v_mfma_f32_16x16x32_bf16 v[56:59], v[72:75], a[64:67], v[56:59]
    ds_read_b64_tr_b16 v[64:65], v26 offset:8192
    ds_read_b64_tr_b16 v[66:67], v26 offset:10240
    s_waitcnt vmcnt(30) lgkmcnt(10)
    v_mfma_f32_16x16x32_bf16 v[44:47], v[76:79], a[68:71], v[44:47]
    ds_read_b64_tr_b16 v[68:69], v27 offset:8192
    ds_read_b64_tr_b16 v[70:71], v27 offset:10240
    s_waitcnt lgkmcnt(10)
    v_mfma_f32_16x16x32_bf16 v[48:51], v[80:83], a[68:71], v[48:51]
    ds_read_b64_tr_b16 v[72:73], v28 offset:8192
    ds_read_b64_tr_b16 v[74:75], v28 offset:10240
    s_waitcnt lgkmcnt(10)
    v_mfma_f32_16x16x32_bf16 v[52:55], v[84:87], a[68:71], v[52:55]
    ds_read_b64_tr_b16 v[76:77], v25 offset:12288
    ds_read_b64_tr_b16 v[78:79], v25 offset:14336
    s_waitcnt lgkmcnt(10)
    v_mfma_f32_16x16x32_bf16 v[56:59], v[88:91], a[68:71], v[56:59]
    ds_read_b64_tr_b16 v[80:81], v26 offset:12288
    ds_read_b64_tr_b16 v[82:83], v26 offset:14336
    s_waitcnt vmcnt(29) lgkmcnt(10)
    v_mfma_f32_16x16x32_bf16 v[44:47], v[60:63], a[72:75], v[44:47]
    ds_read_b64_tr_b16 v[84:85], v27 offset:12288
    ds_read_b64_tr_b16 v[86:87], v27 offset:14336
    s_waitcnt lgkmcnt(10)
    v_mfma_f32_16x16x32_bf16 v[48:51], v[64:67], a[72:75], v[48:51]
    ds_read_b64_tr_b16 v[88:89], v28 offset:12288
    ds_read_b64_tr_b16 v[90:91], v28 offset:14336
    s_waitcnt lgkmcnt(10)
    v_mfma_f32_16x16x32_bf16 v[52:55], v[68:71], a[72:75], v[52:55]
    s_barrier
    s_add_u32 s3, s61, 9
    s_and_b32 s3, s3, 15
    s_lshl_b32 s3, s3, 12
    s_add_u32 s3, s3, s62
    buffer_load_dwordx4 a[144:147], v4, s[28:31], s3 offen offset:0 sc1
    buffer_load_dwordx4 a[148:151], v4, s[28:31], s3 offen offset:1024 sc1
    buffer_load_dwordx4 a[152:155], v4, s[28:31], s3 offen offset:2048 sc1
    buffer_load_dwordx4 a[156:159], v4, s[28:31], s3 offen offset:3072 sc1
    s_add_u32 s3, s61, 13
    s_and_b32 s3, s3, 15
    s_mul_i32 s3, s3, 458752
    s_add_u32 s3, s3, s69
    s_add_u32 m0, s58, 49152
    s_nop 0
    buffer_load_dwordx4 v39, s[20:23], s3 offen lds
    buffer_load_dwordx4 v40, s[20:23], s3 offen offset:1024 lds
    buffer_load_dwordx4 v41, s[20:23], s3 offen offset:2048 lds
    buffer_load_dwordx4 v42, s[20:23], s3 offen offset:3072 lds
    ds_read_b64_tr_b16 v[60:61], v25 offset:16384
    ds_read_b64_tr_b16 v[62:63], v25 offset:18432
    s_waitcnt lgkmcnt(10)
    v_mfma_f32_16x16x32_bf16 v[56:59], v[72:75], a[72:75], v[56:59]
    ds_read_b64_tr_b16 v[64:65], v26 offset:16384
    ds_read_b64_tr_b16 v[66:67], v26 offset:18432
    s_waitcnt vmcnt(36) lgkmcnt(10)
    v_mfma_f32_16x16x32_bf16 v[44:47], v[76:79], a[76:79], v[44:47]
    ds_read_b64_tr_b16 v[68:69], v27 offset:16384
    ds_read_b64_tr_b16 v[70:71], v27 offset:18432
    s_waitcnt lgkmcnt(10)
    v_mfma_f32_16x16x32_bf16 v[48:51], v[80:83], a[76:79], v[48:51]
    ds_read_b64_tr_b16 v[72:73], v28 offset:16384
    ds_read_b64_tr_b16 v[74:75], v28 offset:18432
    s_waitcnt lgkmcnt(10)
    v_mfma_f32_16x16x32_bf16 v[52:55], v[84:87], a[76:79], v[52:55]
    ds_read_b64_tr_b16 v[76:77], v25 offset:20480
    ds_read_b64_tr_b16 v[78:79], v25 offset:22528
    s_waitcnt lgkmcnt(10)
    v_mfma_f32_16x16x32_bf16 v[56:59], v[88:91], a[76:79], v[56:59]
    ds_read_b64_tr_b16 v[80:81], v26 offset:20480
    ds_read_b64_tr_b16 v[82:83], v26 offset:22528
    s_waitcnt vmcnt(35) lgkmcnt(10)
    v_mfma_f32_16x16x32_bf16 v[44:47], v[60:63], a[80:83], v[44:47]
    ds_read_b64_tr_b16 v[84:85], v27 offset:20480
    ds_read_b64_tr_b16 v[86:87], v27 offset:22528
    s_waitcnt lgkmcnt(10)
    v_mfma_f32_16x16x32_bf16 v[48:51], v[64:67], a[80:83], v[48:51]
    ds_read_b64_tr_b16 v[88:89], v28 offset:20480
    ds_read_b64_tr_b16 v[90:91], v28 offset:22528
    s_waitcnt lgkmcnt(10)
    v_mfma_f32_16x16x32_bf16 v[52:55], v[68:71], a[80:83], v[52:55]
    ds_read_b64_tr_b16 v[60:61], v25 offset:24576
    ds_read_b64_tr_b16 v[62:63], v25 offset:26624
    s_waitcnt lgkmcnt(10)
    v_mfma_f32_16x16x32_bf16 v[56:59], v[72:75], a[80:83], v[56:59]
    ds_read_b64_tr_b16 v[64:65], v26 offset:24576
    ds_read_b64_tr_b16 v[66:67], v26 offset:26624
    s_waitcnt vmcnt(34) lgkmcnt(10)
    v_mfma_f32_16x16x32_bf16 v[44:47], v[76:79], a[84:87], v[44:47]
    ds_read_b64_tr_b16 v[68:69], v27 offset:24576
    ds_read_b64_tr_b16 v[70:71], v27 offset:26624
    s_waitcnt lgkmcnt(10)
    v_mfma_f32_16x16x32_bf16 v[48:51], v[80:83], a[84:87], v[48:51]
    ds_read_b64_tr_b16 v[72:73], v28 offset:24576
    ds_read_b64_tr_b16 v[74:75], v28 offset:26624
    s_waitcnt lgkmcnt(10)
    v_mfma_f32_16x16x32_bf16 v[52:55], v[84:87], a[84:87], v[52:55]
    ds_read_b64_tr_b16 v[76:77], v25 offset:28672
    ds_read_b64_tr_b16 v[78:79], v25 offset:30720
    s_waitcnt lgkmcnt(10)
    v_mfma_f32_16x16x32_bf16 v[56:59], v[88:91], a[84:87], v[56:59]
    ds_read_b64_tr_b16 v[80:81], v26 offset:28672
    ds_read_b64_tr_b16 v[82:83], v26 offset:30720
    s_waitcnt vmcnt(33) lgkmcnt(10)
    v_mfma_f32_16x16x32_bf16 v[44:47], v[60:63], a[88:91], v[44:47]
    ds_read_b64_tr_b16 v[84:85], v27 offset:28672
    ds_read_b64_tr_b16 v[86:87], v27 offset:30720
    s_waitcnt lgkmcnt(10)
    v_mfma_f32_16x16x32_bf16 v[48:51], v[64:67], a[88:91], v[48:51]
    ds_read_b64_tr_b16 v[88:89], v28 offset:28672
    ds_read_b64_tr_b16 v[90:91], v28 offset:30720
    s_waitcnt lgkmcnt(10)
    v_mfma_f32_16x16x32_bf16 v[52:55], v[68:71], a[88:91], v[52:55]
    s_barrier
    s_add_u32 s3, s61, 10
    s_and_b32 s3, s3, 15
    s_lshl_b32 s3, s3, 12
    s_add_u32 s3, s3, s62
    buffer_load_dwordx4 a[160:163], v4, s[28:31], s3 offen offset:0 sc1
    buffer_load_dwordx4 a[164:167], v4, s[28:31], s3 offen offset:1024 sc1
    buffer_load_dwordx4 a[168:171], v4, s[28:31], s3 offen offset:2048 sc1
    buffer_load_dwordx4 a[172:175], v4, s[28:31], s3 offen offset:3072 sc1
    s_add_u32 s3, s61, 14
    s_and_b32 s3, s3, 15
    s_mul_i32 s3, s3, 458752
    s_add_u32 s3, s3, s69
    s_add_u32 m0, s58, 65536
    s_nop 0
    buffer_load_dwordx4 v39, s[20:23], s3 offen lds
    buffer_load_dwordx4 v40, s[20:23], s3 offen offset:1024 lds
    buffer_load_dwordx4 v41, s[20:23], s3 offen offset:2048 lds
    buffer_load_dwordx4 v42, s[20:23], s3 offen offset:3072 lds
    ds_read_b64_tr_b16 v[60:61], v25 offset:32768
    ds_read_b64_tr_b16 v[62:63], v25 offset:34816
    s_waitcnt lgkmcnt(10)
    v_mfma_f32_16x16x32_bf16 v[56:59], v[72:75], a[88:91], v[56:59]
    ds_read_b64_tr_b16 v[64:65], v26 offset:32768
    ds_read_b64_tr_b16 v[66:67], v26 offset:34816
    s_waitcnt vmcnt(40) lgkmcnt(10)
    v_mfma_f32_16x16x32_bf16 v[44:47], v[76:79], a[92:95], v[44:47]
    ds_read_b64_tr_b16 v[68:69], v27 offset:32768
    ds_read_b64_tr_b16 v[70:71], v27 offset:34816
    s_waitcnt lgkmcnt(10)
    v_mfma_f32_16x16x32_bf16 v[48:51], v[80:83], a[92:95], v[48:51]
    ds_read_b64_tr_b16 v[72:73], v28 offset:32768
    ds_read_b64_tr_b16 v[74:75], v28 offset:34816
    s_waitcnt lgkmcnt(10)
    v_mfma_f32_16x16x32_bf16 v[52:55], v[84:87], a[92:95], v[52:55]
    ds_read_b64_tr_b16 v[76:77], v25 offset:36864
    ds_read_b64_tr_b16 v[78:79], v25 offset:38912
    s_waitcnt lgkmcnt(10)
    v_mfma_f32_16x16x32_bf16 v[56:59], v[88:91], a[92:95], v[56:59]
    ds_read_b64_tr_b16 v[80:81], v26 offset:36864
    ds_read_b64_tr_b16 v[82:83], v26 offset:38912
    s_waitcnt vmcnt(39) lgkmcnt(10)
    v_mfma_f32_16x16x32_bf16 v[44:47], v[60:63], a[96:99], v[44:47]
    ds_read_b64_tr_b16 v[84:85], v27 offset:36864
    ds_read_b64_tr_b16 v[86:87], v27 offset:38912
    s_waitcnt lgkmcnt(10)
    v_mfma_f32_16x16x32_bf16 v[48:51], v[64:67], a[96:99], v[48:51]
    ds_read_b64_tr_b16 v[88:89], v28 offset:36864
    ds_read_b64_tr_b16 v[90:91], v28 offset:38912
    s_waitcnt lgkmcnt(10)
    v_mfma_f32_16x16x32_bf16 v[52:55], v[68:71], a[96:99], v[52:55]
    ds_read_b64_tr_b16 v[60:61], v25 offset:40960
    ds_read_b64_tr_b16 v[62:63], v25 offset:43008
    s_waitcnt lgkmcnt(10)
    v_mfma_f32_16x16x32_bf16 v[56:59], v[72:75], a[96:99], v[56:59]
    ds_read_b64_tr_b16 v[64:65], v26 offset:40960
    ds_read_b64_tr_b16 v[66:67], v26 offset:43008
    s_waitcnt vmcnt(38) lgkmcnt(10)
    v_mfma_f32_16x16x32_bf16 v[44:47], v[76:79], a[100:103], v[44:47]
    ds_read_b64_tr_b16 v[68:69], v27 offset:40960
    ds_read_b64_tr_b16 v[70:71], v27 offset:43008
    s_waitcnt lgkmcnt(10)
    v_mfma_f32_16x16x32_bf16 v[48:51], v[80:83], a[100:103], v[48:51]
    ds_read_b64_tr_b16 v[72:73], v28 offset:40960
    ds_read_b64_tr_b16 v[74:75], v28 offset:43008
    s_waitcnt lgkmcnt(10)
    v_mfma_f32_16x16x32_bf16 v[52:55], v[84:87], a[100:103], v[52:55]
    ds_read_b64_tr_b16 v[76:77], v25 offset:45056
    ds_read_b64_tr_b16 v[78:79], v25 offset:47104
    s_waitcnt lgkmcnt(10)
    v_mfma_f32_16x16x32_bf16 v[56:59], v[88:91], a[100:103], v[56:59]
    ds_read_b64_tr_b16 v[80:81], v26 offset:45056
    ds_read_b64_tr_b16 v[82:83], v26 offset:47104
    s_waitcnt vmcnt(37) lgkmcnt(10)
    v_mfma_f32_16x16x32_bf16 v[44:47], v[60:63], a[104:107], v[44:47]
    ds_read_b64_tr_b16 v[84:85], v27 offset:45056
    ds_read_b64_tr_b16 v[86:87], v27 offset:47104
    s_waitcnt lgkmcnt(10)
    v_mfma_f32_16x16x32_bf16 v[48:51], v[64:67], a[104:107], v[48:51]
    ds_read_b64_tr_b16 v[88:89], v28 offset:45056
    ds_read_b64_tr_b16 v[90:91], v28 offset:47104
    s_waitcnt lgkmcnt(10)
    v_mfma_f32_16x16x32_bf16 v[52:55], v[68:71], a[104:107], v[52:55]
    s_barrier
    s_add_u32 s3, s61, 11
    s_and_b32 s3, s3, 15
    s_lshl_b32 s3, s3, 12
    s_add_u32 s3, s3, s62
    buffer_load_dwordx4 a[176:179], v4, s[28:31], s3 offen offset:0 sc1
    buffer_load_dwordx4 a[180:183], v4, s[28:31], s3 offen offset:1024 sc1
    buffer_load_dwordx4 a[184:187], v4, s[28:31], s3 offen offset:2048 sc1
    buffer_load_dwordx4 a[188:191], v4, s[28:31], s3 offen offset:3072 sc1
    s_add_u32 s3, s61, 15
    s_and_b32 s3, s3, 15
    s_mul_i32 s3, s3, 458752
    s_add_u32 s3, s3, s69
    s_add_u32 m0, s58, 81920
    s_nop 0
    buffer_load_dwordx4 v39, s[20:23], s3 offen lds
    buffer_load_dwordx4 v40, s[20:23], s3 offen offset:1024 lds
    buffer_load_dwordx4 v41, s[20:23], s3 offen offset:2048 lds
    buffer_load_dwordx4 v42, s[20:23], s3 offen offset:3072 lds
    ds_read_b64_tr_b16 v[60:61], v25 offset:49152
    ds_read_b64_tr_b16 v[62:63], v25 offset:51200
    s_waitcnt lgkmcnt(10)
    v_mfma_f32_16x16x32_bf16 v[56:59], v[72:75], a[104:107], v[56:59]
    ds_read_b64_tr_b16 v[64:65], v26 offset:49152
    ds_read_b64_tr_b16 v[66:67], v26 offset:51200
    s_waitcnt vmcnt(44) lgkmcnt(10)
    v_mfma_f32_16x16x32_bf16 v[44:47], v[76:79], a[108:111], v[44:47]
    ds_read_b64_tr_b16 v[68:69], v27 offset:49152
    ds_read_b64_tr_b16 v[70:71], v27 offset:51200
    s_waitcnt lgkmcnt(10)
    v_mfma_f32_16x16x32_bf16 v[48:51], v[80:83], a[108:111], v[48:51]
    ds_read_b64_tr_b16 v[72:73], v28 offset:49152
    ds_read_b64_tr_b16 v[74:75], v28 offset:51200
    s_waitcnt lgkmcnt(10)
    v_mfma_f32_16x16x32_bf16 v[52:55], v[84:87], a[108:111], v[52:55]
    ds_read_b64_tr_b16 v[76:77], v25 offset:53248
    ds_read_b64_tr_b16 v[78:79], v25 offset:55296
    s_waitcnt lgkmcnt(10)
    v_mfma_f32_16x16x32_bf16 v[56:59], v[88:91], a[108:111], v[56:59]
    ds_read_b64_tr_b16 v[80:81], v26 offset:53248
    ds_read_b64_tr_b16 v[82:83], v26 offset:55296
    s_waitcnt vmcnt(39) lgkmcnt(10)
    v_mfma_f32_16x16x32_bf16 v[44:47], v[60:63], a[112:115], v[44:47]
    ds_read_b64_tr_b16 v[84:85], v27 offset:53248
    ds_read_b64_tr_b16 v[86:87], v27 offset:55296
    s_waitcnt lgkmcnt(10)
    v_mfma_f32_16x16x32_bf16 v[48:51], v[64:67], a[112:115], v[48:51]
    ds_read_b64_tr_b16 v[88:89], v28 offset:53248
    ds_read_b64_tr_b16 v[90:91], v28 offset:55296
    s_waitcnt lgkmcnt(10)
    v_mfma_f32_16x16x32_bf16 v[52:55], v[68:71], a[112:115], v[52:55]
    ds_read_b64_tr_b16 v[60:61], v25 offset:57344
    ds_read_b64_tr_b16 v[62:63], v25 offset:59392
    s_waitcnt lgkmcnt(10)
    v_mfma_f32_16x16x32_bf16 v[56:59], v[72:75], a[112:115], v[56:59]
    ds_read_b64_tr_b16 v[64:65], v26 offset:57344
    ds_read_b64_tr_b16 v[66:67], v26 offset:59392
    s_waitcnt vmcnt(38) lgkmcnt(10)
    v_mfma_f32_16x16x32_bf16 v[44:47], v[76:79], a[116:119], v[44:47]
    ds_read_b64_tr_b16 v[68:69], v27 offset:57344
    ds_read_b64_tr_b16 v[70:71], v27 offset:59392
    s_waitcnt lgkmcnt(10)
    v_mfma_f32_16x16x32_bf16 v[48:51], v[80:83], a[116:119], v[48:51]
    ds_read_b64_tr_b16 v[72:73], v28 offset:57344
    ds_read_b64_tr_b16 v[74:75], v28 offset:59392
    s_waitcnt lgkmcnt(10)
    v_mfma_f32_16x16x32_bf16 v[52:55], v[84:87], a[116:119], v[52:55]
    ds_read_b64_tr_b16 v[76:77], v25 offset:61440
    ds_read_b64_tr_b16 v[78:79], v25 offset:63488
    s_waitcnt lgkmcnt(10)
    v_mfma_f32_16x16x32_bf16 v[56:59], v[88:91], a[116:119], v[56:59]
    ds_read_b64_tr_b16 v[80:81], v26 offset:61440
    ds_read_b64_tr_b16 v[82:83], v26 offset:63488
    s_waitcnt vmcnt(37) lgkmcnt(10)
    v_mfma_f32_16x16x32_bf16 v[44:47], v[60:63], a[120:123], v[44:47]
    ds_read_b64_tr_b16 v[84:85], v27 offset:61440
    ds_read_b64_tr_b16 v[86:87], v27 offset:63488
    s_waitcnt lgkmcnt(10)
    v_mfma_f32_16x16x32_bf16 v[48:51], v[64:67], a[120:123], v[48:51]
    ds_read_b64_tr_b16 v[88:89], v28 offset:61440
    ds_read_b64_tr_b16 v[90:91], v28 offset:63488
    s_waitcnt lgkmcnt(10)
    v_mfma_f32_16x16x32_bf16 v[52:55], v[68:71], a[120:123], v[52:55]
    s_barrier
    s_add_u32 s3, s61, 12
    s_and_b32 s3, s3, 15
    s_lshl_b32 s3, s3, 12
    s_add_u32 s3, s3, s62
    buffer_load_dwordx4 a[192:195], v4, s[28:31], s3 offen offset:0 sc1
    buffer_load_dwordx4 a[196:199], v4, s[28:31], s3 offen offset:1024 sc1
    buffer_load_dwordx4 a[200:203], v4, s[28:31], s3 offen offset:2048 sc1
    buffer_load_dwordx4 a[204:207], v4, s[28:31], s3 offen offset:3072 sc1
    ds_read_b64_tr_b16 v[60:61], v29 offset:0
    ds_read_b64_tr_b16 v[62:63], v29 offset:2048
    s_waitcnt lgkmcnt(10)
    v_mfma_f32_16x16x32_bf16 v[56:59], v[72:75], a[120:123], v[56:59]
    ds_read_b64_tr_b16 v[64:65], v30 offset:0
    ds_read_b64_tr_b16 v[66:67], v30 offset:2048
    s_waitcnt vmcnt(40) lgkmcnt(10)
    v_mfma_f32_16x16x32_bf16 v[44:47], v[76:79], a[124:127], v[44:47]
    ds_read_b64_tr_b16 v[68:69], v31 offset:0
    ds_read_b64_tr_b16 v[70:71], v31 offset:2048
    s_waitcnt lgkmcnt(10)
    v_mfma_f32_16x16x32_bf16 v[48:51], v[80:83], a[124:127], v[48:51]
    ds_read_b64_tr_b16 v[72:73], v32 offset:0
    ds_read_b64_tr_b16 v[74:75], v32 offset:2048
    s_waitcnt lgkmcnt(10)
    v_mfma_f32_16x16x32_bf16 v[52:55], v[84:87], a[124:127], v[52:55]
    ds_read_b64_tr_b16 v[76:77], v29 offset:4096
    ds_read_b64_tr_b16 v[78:79], v29 offset:6144
    s_waitcnt lgkmcnt(10)
    v_mfma_f32_16x16x32_bf16 v[56:59], v[88:91], a[124:127], v[56:59]
    ds_read_b64_tr_b16 v[80:81], v30 offset:4096
    ds_read_b64_tr_b16 v[82:83], v30 offset:6144
    s_waitcnt vmcnt(35) lgkmcnt(10)
    v_mfma_f32_16x16x32_bf16 v[44:47], v[60:63], a[128:131], v[44:47]
    ds_read_b64_tr_b16 v[84:85], v31 offset:4096
    ds_read_b64_tr_b16 v[86:87], v31 offset:6144
    s_waitcnt lgkmcnt(10)
    v_mfma_f32_16x16x32_bf16 v[48:51], v[64:67], a[128:131], v[48:51]
    ds_read_b64_tr_b16 v[88:89], v32 offset:4096
    ds_read_b64_tr_b16 v[90:91], v32 offset:6144
    s_waitcnt lgkmcnt(10)
    v_mfma_f32_16x16x32_bf16 v[52:55], v[68:71], a[128:131], v[52:55]
    ds_read_b64_tr_b16 v[60:61], v29 offset:8192
    ds_read_b64_tr_b16 v[62:63], v29 offset:10240
    s_waitcnt lgkmcnt(10)
    v_mfma_f32_16x16x32_bf16 v[56:59], v[72:75], a[128:131], v[56:59]
    ds_read_b64_tr_b16 v[64:65], v30 offset:8192
    ds_read_b64_tr_b16 v[66:67], v30 offset:10240
    s_waitcnt vmcnt(34) lgkmcnt(10)
    v_mfma_f32_16x16x32_bf16 v[44:47], v[76:79], a[132:135], v[44:47]
    ds_read_b64_tr_b16 v[68:69], v31 offset:8192
    ds_read_b64_tr_b16 v[70:71], v31 offset:10240
    s_waitcnt lgkmcnt(10)
    v_mfma_f32_16x16x32_bf16 v[48:51], v[80:83], a[132:135], v[48:51]
    ds_read_b64_tr_b16 v[72:73], v32 offset:8192
    ds_read_b64_tr_b16 v[74:75], v32 offset:10240
    s_waitcnt lgkmcnt(10)
    v_mfma_f32_16x16x32_bf16 v[52:55], v[84:87], a[132:135], v[52:55]
    ds_read_b64_tr_b16 v[76:77], v29 offset:12288
    ds_read_b64_tr_b16 v[78:79], v29 offset:14336
    s_waitcnt lgkmcnt(10)
    v_mfma_f32_16x16x32_bf16 v[56:59], v[88:91], a[132:135], v[56:59]
    ds_read_b64_tr_b16 v[80:81], v30 offset:12288
    ds_read_b64_tr_b16 v[82:83], v30 offset:14336
    s_waitcnt vmcnt(33) lgkmcnt(10)
    v_mfma_f32_16x16x32_bf16 v[44:47], v[60:63], a[136:139], v[44:47]
    ds_read_b64_tr_b16 v[84:85], v31 offset:12288
    ds_read_b64_tr_b16 v[86:87], v31 offset:14336
    s_waitcnt lgkmcnt(10)
    v_mfma_f32_16x16x32_bf16 v[48:51], v[64:67], a[136:139], v[48:51]
    ds_read_b64_tr_b16 v[88:89], v32 offset:12288
    ds_read_b64_tr_b16 v[90:91], v32 offset:14336
    s_waitcnt lgkmcnt(10)
    v_mfma_f32_16x16x32_bf16 v[52:55], v[68:71], a[136:139], v[52:55]
    s_barrier
    s_add_u32 s3, s61, 13
    s_and_b32 s3, s3, 15
    s_lshl_b32 s3, s3, 12
    s_add_u32 s3, s3, s62
    buffer_load_dwordx4 a[208:211], v4, s[28:31], s3 offen offset:0 sc1
    buffer_load_dwordx4 a[212:215], v4, s[28:31], s3 offen offset:1024 sc1
    buffer_load_dwordx4 a[216:219], v4, s[28:31], s3 offen offset:2048 sc1
    buffer_load_dwordx4 a[220:223], v4, s[28:31], s3 offen offset:3072 sc1
    ds_read_b64_tr_b16 v[60:61], v29 offset:16384
    ds_read_b64_tr_b16 v[62:63], v29 offset:18432
    s_waitcnt lgkmcnt(10)
    v_mfma_f32_16x16x32_bf16 v[56:59], v[72:75], a[136:139], v[56:59]
    ds_read_b64_tr_b16 v[64:65], v30 offset:16384
    ds_read_b64_tr_b16 v[66:67], v30 offset:18432
    s_waitcnt vmcnt(36) lgkmcnt(10)
    v_mfma_f32_16x16x32_bf16 v[44:47], v[76:79], a[140:143], v[44:47]
    ds_read_b64_tr_b16 v[68:69], v31 offset:16384
    ds_read_b64_tr_b16 v[70:71], v31 offset:18432
    s_waitcnt lgkmcnt(10)
    v_mfma_f32_16x16x32_bf16 v[48:51], v[80:83], a[140:143], v[48:51]
    ds_read_b64_tr_b16 v[72:73], v32 offset:16384
    ds_read_b64_tr_b16 v[74:75], v32 offset:18432
    s_waitcnt lgkmcnt(10)
    v_mfma_f32_16x16x32_bf16 v[52:55], v[84:87], a[140:143], v[52:55]
    ds_read_b64_tr_b16 v[76:77], v29 offset:20480
    ds_read_b64_tr_b16 v[78:79], v29 offset:22528
    s_waitcnt lgkmcnt(10)
    v_mfma_f32_16x16x32_bf16 v[56:59], v[88:91], a[140:143], v[56:59]
    ds_read_b64_tr_b16 v[80:81], v30 offset:20480
    ds_read_b64_tr_b16 v[82:83], v30 offset:22528
    s_waitcnt vmcnt(31) lgkmcnt(10)
    v_mfma_f32_16x16x32_bf16 v[44:47], v[60:63], a[144:147], v[44:47]
    ds_read_b64_tr_b16 v[84:85], v31 offset:20480
    ds_read_b64_tr_b16 v[86:87], v31 offset:22528
    s_waitcnt lgkmcnt(10)
    v_mfma_f32_16x16x32_bf16 v[48:51], v[64:67], a[144:147], v[48:51]
    ds_read_b64_tr_b16 v[88:89], v32 offset:20480
    ds_read_b64_tr_b16 v[90:91], v32 offset:22528
    s_waitcnt lgkmcnt(10)
    v_mfma_f32_16x16x32_bf16 v[52:55], v[68:71], a[144:147], v[52:55]
    ds_read_b64_tr_b16 v[60:61], v29 offset:24576
    ds_read_b64_tr_b16 v[62:63], v29 offset:26624
    s_waitcnt lgkmcnt(10)
    v_mfma_f32_16x16x32_bf16 v[56:59], v[72:75], a[144:147], v[56:59]
    ds_read_b64_tr_b16 v[64:65], v30 offset:24576
    ds_read_b64_tr_b16 v[66:67], v30 offset:26624
    s_waitcnt vmcnt(30) lgkmcnt(10)
    v_mfma_f32_16x16x32_bf16 v[44:47], v[76:79], a[148:151], v[44:47]
    ds_read_b64_tr_b16 v[68:69], v31 offset:24576
    ds_read_b64_tr_b16 v[70:71], v31 offset:26624
    s_waitcnt lgkmcnt(10)
    v_mfma_f32_16x16x32_bf16 v[48:51], v[80:83], a[148:151], v[48:51]
    ds_read_b64_tr_b16 v[72:73], v32 offset:24576
    ds_read_b64_tr_b16 v[74:75], v32 offset:26624
    s_waitcnt lgkmcnt(10)
    v_mfma_f32_16x16x32_bf16 v[52:55], v[84:87], a[148:151], v[52:55]
    ds_read_b64_tr_b16 v[76:77], v29 offset:28672
    ds_read_b64_tr_b16 v[78:79], v29 offset:30720
    s_waitcnt lgkmcnt(10)
    v_mfma_f32_16x16x32_bf16 v[56:59], v[88:91], a[148:151], v[56:59]
    ds_read_b64_tr_b16 v[80:81], v30 offset:28672
    ds_read_b64_tr_b16 v[82:83], v30 offset:30720
    s_waitcnt vmcnt(29) lgkmcnt(10)
    v_mfma_f32_16x16x32_bf16 v[44:47], v[60:63], a[152:155], v[44:47]
    ds_read_b64_tr_b16 v[84:85], v31 offset:28672
    ds_read_b64_tr_b16 v[86:87], v31 offset:30720
    s_waitcnt lgkmcnt(10)
    v_mfma_f32_16x16x32_bf16 v[48:51], v[64:67], a[152:155], v[48:51]
    ds_read_b64_tr_b16 v[88:89], v32 offset:28672
    ds_read_b64_tr_b16 v[90:91], v32 offset:30720
    s_waitcnt lgkmcnt(10)
    v_mfma_f32_16x16x32_bf16 v[52:55], v[68:71], a[152:155], v[52:55]
    s_barrier
    s_add_u32 s3, s61, 14
    s_and_b32 s3, s3, 15
    s_lshl_b32 s3, s3, 12
    s_add_u32 s3, s3, s62
    buffer_load_dwordx4 a[224:227], v4, s[28:31], s3 offen offset:0 sc1
    buffer_load_dwordx4 a[228:231], v4, s[28:31], s3 offen offset:1024 sc1
    buffer_load_dwordx4 a[232:235], v4, s[28:31], s3 offen offset:2048 sc1
    buffer_load_dwordx4 a[236:239], v4, s[28:31], s3 offen offset:3072 sc1
    ds_read_b64_tr_b16 v[60:61], v21 offset:0
    ds_read_b64_tr_b16 v[62:63], v21 offset:2048
    s_waitcnt lgkmcnt(10)
    v_mfma_f32_16x16x32_bf16 v[56:59], v[72:75], a[152:155], v[56:59]
    ds_read_b64_tr_b16 v[64:65], v22 offset:0
    ds_read_b64_tr_b16 v[66:67], v22 offset:2048
    s_waitcnt vmcnt(32) lgkmcnt(10)
    v_mfma_f32_16x16x32_bf16 v[44:47], v[76:79], a[156:159], v[44:47]
    ds_read_b64_tr_b16 v[68:69], v23 offset:0
    ds_read_b64_tr_b16 v[70:71], v23 offset:2048
    s_waitcnt lgkmcnt(10)
    v_mfma_f32_16x16x32_bf16 v[48:51], v[80:83], a[156:159], v[48:51]
    ds_read_b64_tr_b16 v[72:73], v24 offset:0
    ds_read_b64_tr_b16 v[74:75], v24 offset:2048
    s_waitcnt lgkmcnt(10)
    v_mfma_f32_16x16x32_bf16 v[52:55], v[84:87], a[156:159], v[52:55]
    ds_read_b64_tr_b16 v[76:77], v21 offset:4096
    ds_read_b64_tr_b16 v[78:79], v21 offset:6144
    s_waitcnt lgkmcnt(10)
    v_mfma_f32_16x16x32_bf16 v[56:59], v[88:91], a[156:159], v[56:59]
    ds_read_b64_tr_b16 v[80:81], v22 offset:4096
    ds_read_b64_tr_b16 v[82:83], v22 offset:6144
    s_waitcnt vmcnt(27) lgkmcnt(10)
    v_mfma_f32_16x16x32_bf16 v[44:47], v[60:63], a[160:163], v[44:47]
    ds_read_b64_tr_b16 v[84:85], v23 offset:4096
    ds_read_b64_tr_b16 v[86:87], v23 offset:6144
    s_waitcnt lgkmcnt(10)
    v_mfma_f32_16x16x32_bf16 v[48:51], v[64:67], a[160:163], v[48:51]
    ds_read_b64_tr_b16 v[88:89], v24 offset:4096
    ds_read_b64_tr_b16 v[90:91], v24 offset:6144
    s_waitcnt lgkmcnt(10)
    v_mfma_f32_16x16x32_bf16 v[52:55], v[68:71], a[160:163], v[52:55]
    ds_read_b64_tr_b16 v[60:61], v21 offset:8192
    ds_read_b64_tr_b16 v[62:63], v21 offset:10240
    s_waitcnt lgkmcnt(10)
    v_mfma_f32_16x16x32_bf16 v[56:59], v[72:75], a[160:163], v[56:59]
    ds_read_b64_tr_b16 v[64:65], v22 offset:8192
    ds_read_b64_tr_b16 v[66:67], v22 offset:10240
    s_waitcnt vmcnt(26) lgkmcnt(10)
    v_mfma_f32_16x16x32_bf16 v[44:47], v[76:79], a[164:167], v[44:47]
    ds_read_b64_tr_b16 v[68:69], v23 offset:8192
    ds_read_b64_tr_b16 v[70:71], v23 offset:10240
    s_waitcnt lgkmcnt(10)
    v_mfma_f32_16x16x32_bf16 v[48:51], v[80:83], a[164:167], v[48:51]
    ds_read_b64_tr_b16 v[72:73], v24 offset:8192
    ds_read_b64_tr_b16 v[74:75], v24 offset:10240
    s_waitcnt lgkmcnt(10)
    v_mfma_f32_16x16x32_bf16 v[52:55], v[84:87], a[164:167], v[52:55]
    ds_read_b64_tr_b16 v[76:77], v21 offset:12288
    ds_read_b64_tr_b16 v[78:79], v21 offset:14336
    s_waitcnt lgkmcnt(10)
    v_mfma_f32_16x16x32_bf16 v[56:59], v[88:91], a[164:167], v[56:59]
    ds_read_b64_tr_b16 v[80:81], v22 offset:12288
    ds_read_b64_tr_b16 v[82:83], v22 offset:14336
    s_waitcnt vmcnt(25) lgkmcnt(10)
    v_mfma_f32_16x16x32_bf16 v[44:47], v[60:63], a[168:171], v[44:47]
    ds_read_b64_tr_b16 v[84:85], v23 offset:12288
    ds_read_b64_tr_b16 v[86:87], v23 offset:14336
    s_waitcnt lgkmcnt(10)
    v_mfma_f32_16x16x32_bf16 v[48:51], v[64:67], a[168:171], v[48:51]
    ds_read_b64_tr_b16 v[88:89], v24 offset:12288
    ds_read_b64_tr_b16 v[90:91], v24 offset:14336
    s_waitcnt lgkmcnt(10)
    v_mfma_f32_16x16x32_bf16 v[52:55], v[68:71], a[168:171], v[52:55]
    s_barrier
    s_add_u32 s3, s61, 15
    s_and_b32 s3, s3, 15
    s_lshl_b32 s3, s3, 12
    s_add_u32 s3, s3, s62
    buffer_load_dwordx4 a[240:243], v4, s[28:31], s3 offen offset:0 sc1
    buffer_load_dwordx4 a[244:247], v4, s[28:31], s3 offen offset:1024 sc1
    buffer_load_dwordx4 a[248:251], v4, s[28:31], s3 offen offset:2048 sc1
    buffer_load_dwordx4 a[252:255], v4, s[28:31], s3 offen offset:3072 sc1
    ds_read_b64_tr_b16 v[60:61], v21 offset:16384
    ds_read_b64_tr_b16 v[62:63], v21 offset:18432
    s_waitcnt lgkmcnt(10)
    v_mfma_f32_16x16x32_bf16 v[56:59], v[72:75], a[168:171], v[56:59]
    ds_read_b64_tr_b16 v[64:65], v22 offset:16384
    ds_read_b64_tr_b16 v[66:67], v22 offset:18432
    s_waitcnt vmcnt(28) lgkmcnt(10)
    v_mfma_f32_16x16x32_bf16 v[44:47], v[76:79], a[172:175], v[44:47]
    ds_read_b64_tr_b16 v[68:69], v23 offset:16384
    ds_read_b64_tr_b16 v[70:71], v23 offset:18432
    s_waitcnt lgkmcnt(10)
    v_mfma_f32_16x16x32_bf16 v[48:51], v[80:83], a[172:175], v[48:51]
    ds_read_b64_tr_b16 v[72:73], v24 offset:16384
    ds_read_b64_tr_b16 v[74:75], v24 offset:18432
    s_waitcnt lgkmcnt(10)
    v_mfma_f32_16x16x32_bf16 v[52:55], v[84:87], a[172:175], v[52:55]
    ds_read_b64_tr_b16 v[76:77], v21 offset:20480
    ds_read_b64_tr_b16 v[78:79], v21 offset:22528
    s_waitcnt lgkmcnt(10)
    v_mfma_f32_16x16x32_bf16 v[56:59], v[88:91], a[172:175], v[56:59]
    ds_read_b64_tr_b16 v[80:81], v22 offset:20480
    ds_read_b64_tr_b16 v[82:83], v22 offset:22528
    s_waitcnt vmcnt(23) lgkmcnt(10)
    v_mfma_f32_16x16x32_bf16 v[44:47], v[60:63], a[176:179], v[44:47]
    ds_read_b64_tr_b16 v[84:85], v23 offset:20480
    ds_read_b64_tr_b16 v[86:87], v23 offset:22528
    s_waitcnt lgkmcnt(10)
    v_mfma_f32_16x16x32_bf16 v[48:51], v[64:67], a[176:179], v[48:51]
    ds_read_b64_tr_b16 v[88:89], v24 offset:20480
    ds_read_b64_tr_b16 v[90:91], v24 offset:22528
    s_waitcnt lgkmcnt(10)
    v_mfma_f32_16x16x32_bf16 v[52:55], v[68:71], a[176:179], v[52:55]
    ds_read_b64_tr_b16 v[60:61], v21 offset:24576
    ds_read_b64_tr_b16 v[62:63], v21 offset:26624
    s_waitcnt lgkmcnt(10)
    v_mfma_f32_16x16x32_bf16 v[56:59], v[72:75], a[176:179], v[56:59]
    ds_read_b64_tr_b16 v[64:65], v22 offset:24576
    ds_read_b64_tr_b16 v[66:67], v22 offset:26624
    s_waitcnt vmcnt(22) lgkmcnt(10)
    v_mfma_f32_16x16x32_bf16 v[44:47], v[76:79], a[180:183], v[44:47]
    ds_read_b64_tr_b16 v[68:69], v23 offset:24576
    ds_read_b64_tr_b16 v[70:71], v23 offset:26624
    s_waitcnt lgkmcnt(10)
    v_mfma_f32_16x16x32_bf16 v[48:51], v[80:83], a[180:183], v[48:51]
    ds_read_b64_tr_b16 v[72:73], v24 offset:24576
    ds_read_b64_tr_b16 v[74:75], v24 offset:26624
    s_waitcnt lgkmcnt(10)
    v_mfma_f32_16x16x32_bf16 v[52:55], v[84:87], a[180:183], v[52:55]
    ds_read_b64_tr_b16 v[76:77], v21 offset:28672
    ds_read_b64_tr_b16 v[78:79], v21 offset:30720
    s_waitcnt lgkmcnt(10)
    v_mfma_f32_16x16x32_bf16 v[56:59], v[88:91], a[180:183], v[56:59]
    ds_read_b64_tr_b16 v[80:81], v22 offset:28672
    ds_read_b64_tr_b16 v[82:83], v22 offset:30720
    s_waitcnt vmcnt(21) lgkmcnt(10)
    v_mfma_f32_16x16x32_bf16 v[44:47], v[60:63], a[184:187], v[44:47]
    ds_read_b64_tr_b16 v[84:85], v23 offset:28672
    ds_read_b64_tr_b16 v[86:87], v23 offset:30720
    s_waitcnt lgkmcnt(10)
    v_mfma_f32_16x16x32_bf16 v[48:51], v[64:67], a[184:187], v[48:51]
    ds_read_b64_tr_b16 v[88:89], v24 offset:28672
    ds_read_b64_tr_b16 v[90:91], v24 offset:30720
    s_waitcnt lgkmcnt(10)
    v_mfma_f32_16x16x32_bf16 v[52:55], v[68:71], a[184:187], v[52:55]
    s_barrier
    s_lshl_b32 s3, s53, 1
    s_add_u32 s3, s3, s4
    s_lshl_b32 s3, s3, 7
    s_add_u32 s3, s3, 6307840
    v_lshlrev_b32 v98, 2, v2
    s_mov_b32 s63, 0
L_poll1:
    buffer_load_dword v99, v98, s[28:31], s3 offen sc1
    s_add_u32 s63, s63, 1
    s_waitcnt vmcnt(0)
    v_cmp_ne_u32 vcc, s57, v99
    s_cbranch_vccz L_pollok1
    s_sleep 8
    s_cmp_lt_u32 s63, 20000
    s_cbranch_scc1 L_poll1
L_pollok1:
    s_add_u32 s3, s68, 0
    s_add_u32 m0, s58, 98304
    s_nop 0
    buffer_load_dwordx4 v96, s[16:19], s3 offen lds
    buffer_load_dwordx4 v97, s[16:19], s3 offen offset:1024 lds
    s_add_u32 s3, s67, 0
    buffer_load_dwordx4 v4, s[28:31], s3 offen offset:2048 sc1 lds
    buffer_load_dwordx4 v4, s[28:31], s3 offen offset:3072 sc1 lds
    ds_read_b64_tr_b16 v[60:61], v21 offset:32768
    ds_read_b64_tr_b16 v[62:63], v21 offset:34816
    s_waitcnt lgkmcnt(10)
    v_mfma_f32_16x16x32_bf16 v[56:59], v[72:75], a[184:187], v[56:59]
    ds_read_b64_tr_b16 v[64:65], v22 offset:32768
    ds_read_b64_tr_b16 v[66:67], v22 offset:34816
    s_waitcnt lgkmcnt(10)
    v_mfma_f32_16x16x32_bf16 v[44:47], v[76:79], a[188:191], v[44:47]
    ds_read_b64_tr_b16 v[68:69], v23 offset:32768
    ds_read_b64_tr_b16 v[70:71], v23 offset:34816
    s_waitcnt lgkmcnt(10)
    v_mfma_f32_16x16x32_bf16 v[48:51], v[80:83], a[188:191], v[48:51]
    ds_read_b64_tr_b16 v[72:73], v24 offset:32768
    ds_read_b64_tr_b16 v[74:75], v24 offset:34816
    s_waitcnt lgkmcnt(10)
    v_mfma_f32_16x16x32_bf16 v[52:55], v[84:87], a[188:191], v[52:55]
    ds_read_b64_tr_b16 v[76:77], v21 offset:36864
    ds_read_b64_tr_b16 v[78:79], v21 offset:38912
    s_waitcnt lgkmcnt(10)
    v_mfma_f32_16x16x32_bf16 v[56:59], v[88:91], a[188:191], v[56:59]
    ds_read_b64_tr_b16 v[80:81], v22 offset:36864
    ds_read_b64_tr_b16 v[82:83], v22 offset:38912
    s_waitcnt lgkmcnt(10)
    v_mfma_f32_16x16x32_bf16 v[44:47], v[60:63], a[192:195], v[44:47]
    ds_read_b64_tr_b16 v[84:85], v23 offset:36864
    ds_read_b64_tr_b16 v[86:87], v23 offset:38912
    s_waitcnt lgkmcnt(10)
    v_mfma_f32_16x16x32_bf16 v[48:51], v[64:67], a[192:195], v[48:51]
    ds_read_b64_tr_b16 v[88:89], v24 offset:36864
    ds_read_b64_tr_b16 v[90:91], v24 offset:38912
    s_waitcnt lgkmcnt(10)
    v_mfma_f32_16x16x32_bf16 v[52:55], v[68:71], a[192:195], v[52:55]
    ds_read_b64_tr_b16 v[60:61], v21 offset:40960
    ds_read_b64_tr_b16 v[62:63], v21 offset:43008
    s_waitcnt lgkmcnt(10)
    v_mfma_f32_16x16x32_bf16 v[56:59], v[72:75], a[192:195], v[56:59]
    ds_read_b64_tr_b16 v[64:65], v22 offset:40960
    ds_read_b64_tr_b16 v[66:67], v22 offset:43008
    s_waitcnt lgkmcnt(10)
    v_mfma_f32_16x16x32_bf16 v[44:47], v[76:79], a[196:199], v[44:47]
    ds_read_b64_tr_b16 v[68:69], v23 offset:40960
    ds_read_b64_tr_b16 v[70:71], v23 offset:43008
    s_waitcnt lgkmcnt(10)
    v_mfma_f32_16x16x32_bf16 v[48:51], v[80:83], a[196:199], v[48:51]
    ds_read_b64_tr_b16 v[72:73], v24 offset:40960
    ds_read_b64_tr_b16 v[74:75], v24 offset:43008
    s_waitcnt lgkmcnt(10)
    v_mfma_f32_16x16x32_bf16 v[52:55], v[84:87], a[196:199], v[52:55]
    ds_read_b64_tr_b16 v[76:77], v21 offset:45056
    ds_read_b64_tr_b16 v[78:79], v21 offset:47104
    s_waitcnt lgkmcnt(10)
    v_mfma_f32_16x16x32_bf16 v[56:59], v[88:91], a[196:199], v[56:59]
    ds_read_b64_tr_b16 v[80:81], v22 offset:45056
    ds_read_b64_tr_b16 v[82:83], v22 offset:47104
    s_waitcnt lgkmcnt(10)
    v_mfma_f32_16x16x32_bf16 v[44:47], v[60:63], a[200:203], v[44:47]
    ds_read_b64_tr_b16 v[84:85], v23 offset:45056
    ds_read_b64_tr_b16 v[86:87], v23 offset:47104
    s_waitcnt lgkmcnt(10)
    v_mfma_f32_16x16x32_bf16 v[48:51], v[64:67], a[200:203], v[48:51]
    ds_read_b64_tr_b16 v[88:89], v24 offset:45056
    ds_read_b64_tr_b16 v[90:91], v24 offset:47104
    s_waitcnt lgkmcnt(10)
    v_mfma_f32_16x16x32_bf16 v[52:55], v[68:71], a[200:203], v[52:55]
    s_barrier
    s_add_u32 s3, s68, 50176
    s_add_u32 m0, s58, 114688
    s_nop 0
    buffer_load_dwordx4 v96, s[16:19], s3 offen lds
    buffer_load_dwordx4 v97, s[16:19], s3 offen offset:1024 lds
    s_add_u32 s3, s67, 2048
    buffer_load_dwordx4 v4, s[28:31], s3 offen offset:2048 sc1 lds
    buffer_load_dwordx4 v4, s[28:31], s3 offen offset:3072 sc1 lds
    ds_read_b64_tr_b16 v[60:61], v21 offset:49152
    ds_read_b64_tr_b16 v[62:63], v21 offset:51200
    s_waitcnt lgkmcnt(10)
    v_mfma_f32_16x16x32_bf16 v[56:59], v[72:75], a[200:203], v[56:59]
    ds_read_b64_tr_b16 v[64:65], v22 offset:49152
    ds_read_b64_tr_b16 v[66:67], v22 offset:51200
    s_waitcnt lgkmcnt(10)
    v_mfma_f32_16x16x32_bf16 v[44:47], v[76:79], a[204:207], v[44:47]
    ds_read_b64_tr_b16 v[68:69], v23 offset:49152
    ds_read_b64_tr_b16 v[70:71], v23 offset:51200
    s_waitcnt lgkmcnt(10)
    v_mfma_f32_16x16x32_bf16 v[48:51], v[80:83], a[204:207], v[48:51]
    ds_read_b64_tr_b16 v[72:73], v24 offset:49152
    ds_read_b64_tr_b16 v[74:75], v24 offset:51200
    s_waitcnt lgkmcnt(10)
    v_mfma_f32_16x16x32_bf16 v[52:55], v[84:87], a[204:207], v[52:55]
    ds_read_b64_tr_b16 v[76:77], v21 offset:53248
    ds_read_b64_tr_b16 v[78:79], v21 offset:55296
    s_waitcnt lgkmcnt(10)
    v_mfma_f32_16x16x32_bf16 v[56:59], v[88:91], a[204:207], v[56:59]
    ds_read_b64_tr_b16 v[80:81], v22 offset:53248
    ds_read_b64_tr_b16 v[82:83], v22 offset:55296
    s_waitcnt lgkmcnt(10)
    v_mfma_f32_16x16x32_bf16 v[44:47], v[60:63], a[208:211], v[44:47]
    ds_read_b64_tr_b16 v[84:85], v23 offset:53248
    ds_read_b64_tr_b16 v[86:87], v23 offset:55296
    s_waitcnt lgkmcnt(10)
    v_mfma_f32_16x16x32_bf16 v[48:51], v[64:67], a[208:211], v[48:51]
    ds_read_b64_tr_b16 v[88:89], v24 offset:53248
    ds_read_b64_tr_b16 v[90:91], v24 offset:55296
    s_waitcnt lgkmcnt(10)
    v_mfma_f32_16x16x32_bf16 v[52:55], v[68:71], a[208:211], v[52:55]
    ds_read_b64_tr_b16 v[60:61], v21 offset:57344
    ds_read_b64_tr_b16 v[62:63], v21 offset:59392
    s_waitcnt lgkmcnt(10)
    v_mfma_f32_16x16x32_bf16 v[56:59], v[72:75], a[208:211], v[56:59]
    ds_read_b64_tr_b16 v[64:65], v22 offset:57344
    ds_read_b64_tr_b16 v[66:67], v22 offset:59392
    s_waitcnt lgkmcnt(10)
    v_mfma_f32_16x16x32_bf16 v[44:47], v[76:79], a[212:215], v[44:47]
    ds_read_b64_tr_b16 v[68:69], v23 offset:57344
    ds_read_b64_tr_b16 v[70:71], v23 offset:59392
    s_waitcnt lgkmcnt(10)
    v_mfma_f32_16x16x32_bf16 v[48:51], v[80:83], a[212:215], v[48:51]
    ds_read_b64_tr_b16 v[72:73], v24 offset:57344
    ds_read_b64_tr_b16 v[74:75], v24 offset:59392
    s_waitcnt lgkmcnt(10)
    v_mfma_f32_16x16x32_bf16 v[52:55], v[84:87], a[212:215], v[52:55]
    ds_read_b64_tr_b16 v[76:77], v21 offset:61440
    ds_read_b64_tr_b16 v[78:79], v21 offset:63488
    s_waitcnt lgkmcnt(10)
    v_mfma_f32_16x16x32_bf16 v[56:59], v[88:91], a[212:215], v[56:59]
    ds_read_b64_tr_b16 v[80:81], v22 offset:61440
    ds_read_b64_tr_b16 v[82:83], v22 offset:63488
    s_waitcnt lgkmcnt(10)
    v_mfma_f32_16x16x32_bf16 v[44:47], v[60:63], a[216:219], v[44:47]
    ds_read_b64_tr_b16 v[84:85], v23 offset:61440
    ds_read_b64_tr_b16 v[86:87], v23 offset:63488
    s_waitcnt lgkmcnt(10)
    v_mfma_f32_16x16x32_bf16 v[48:51], v[64:67], a[216:219], v[48:51]
    ds_read_b64_tr_b16 v[88:89], v24 offset:61440
    ds_read_b64_tr_b16 v[90:91], v24 offset:63488
    s_waitcnt lgkmcnt(10)
    v_mfma_f32_16x16x32_bf16 v[52:55], v[68:71], a[216:219], v[52:55]
    s_barrier
    s_add_u32 s3, s68, 100352
    s_add_u32 m0, s58, 131072
    s_nop 0
    buffer_load_dwordx4 v96, s[16:19], s3 offen lds
    buffer_load_dwordx4 v97, s[16:19], s3 offen offset:1024 lds
    s_add_u32 s3, s67, 4096
    buffer_load_dwordx4 v4, s[28:31], s3 offen offset:2048 sc1 lds
    buffer_load_dwordx4 v4, s[28:31], s3 offen offset:3072 sc1 lds
    ds_read_b64_tr_b16 v[60:61], v25 offset:0
    ds_read_b64_tr_b16 v[62:63], v25 offset:2048
    s_waitcnt lgkmcnt(10)
    v_mfma_f32_16x16x32_bf16 v[56:59], v[72:75], a[216:219], v[56:59]
    ds_read_b64_tr_b16 v[64:65], v26 offset:0
    ds_read_b64_tr_b16 v[66:67], v26 offset:2048
    s_waitcnt lgkmcnt(10)
    v_mfma_f32_16x16x32_bf16 v[44:47], v[76:79], a[220:223], v[44:47]
    ds_read_b64_tr_b16 v[68:69], v27 offset:0
    ds_read_b64_tr_b16 v[70:71], v27 offset:2048
    s_waitcnt lgkmcnt(10)
    v_mfma_f32_16x16x32_bf16 v[48:51], v[80:83], a[220:223], v[48:51]
    ds_read_b64_tr_b16 v[72:73], v28 offset:0
    ds_read_b64_tr_b16 v[74:75], v28 offset:2048
    s_waitcnt lgkmcnt(10)
    v_mfma_f32_16x16x32_bf16 v[52:55], v[84:87], a[220:223], v[52:55]
    ds_read_b64_tr_b16 v[76:77], v25 offset:4096
    ds_read_b64_tr_b16 v[78:79], v25 offset:6144
    s_waitcnt lgkmcnt(10)
    v_mfma_f32_16x16x32_bf16 v[56:59], v[88:91], a[220:223], v[56:59]
    ds_read_b64_tr_b16 v[80:81], v26 offset:4096
    ds_read_b64_tr_b16 v[82:83], v26 offset:6144
    s_waitcnt lgkmcnt(10)
    v_mfma_f32_16x16x32_bf16 v[44:47], v[60:63], a[224:227], v[44:47]
    ds_read_b64_tr_b16 v[84:85], v27 offset:4096
    ds_read_b64_tr_b16 v[86:87], v27 offset:6144
    s_waitcnt lgkmcnt(10)
    v_mfma_f32_16x16x32_bf16 v[48:51], v[64:67], a[224:227], v[48:51]
    ds_read_b64_tr_b16 v[88:89], v28 offset:4096
    ds_read_b64_tr_b16 v[90:91], v28 offset:6144
    s_waitcnt lgkmcnt(10)
    v_mfma_f32_16x16x32_bf16 v[52:55], v[68:71], a[224:227], v[52:55]
    ds_read_b64_tr_b16 v[60:61], v25 offset:8192
    ds_read_b64_tr_b16 v[62:63], v25 offset:10240
    s_waitcnt lgkmcnt(10)
    v_mfma_f32_16x16x32_bf16 v[56:59], v[72:75], a[224:227], v[56:59]
    ds_read_b64_tr_b16 v[64:65], v26 offset:8192
    ds_read_b64_tr_b16 v[66:67], v26 offset:10240
    s_waitcnt lgkmcnt(10)
    v_mfma_f32_16x16x32_bf16 v[44:47], v[76:79], a[228:231], v[44:47]
    ds_read_b64_tr_b16 v[68:69], v27 offset:8192
    ds_read_b64_tr_b16 v[70:71], v27 offset:10240
    s_waitcnt lgkmcnt(10)
    v_mfma_f32_16x16x32_bf16 v[48:51], v[80:83], a[228:231], v[48:51]
    ds_read_b64_tr_b16 v[72:73], v28 offset:8192
    ds_read_b64_tr_b16 v[74:75], v28 offset:10240
    s_waitcnt lgkmcnt(10)
    v_mfma_f32_16x16x32_bf16 v[52:55], v[84:87], a[228:231], v[52:55]
    ds_read_b64_tr_b16 v[76:77], v25 offset:12288
    ds_read_b64_tr_b16 v[78:79], v25 offset:14336
    s_waitcnt lgkmcnt(10)
    v_mfma_f32_16x16x32_bf16 v[56:59], v[88:91], a[228:231], v[56:59]
    ds_read_b64_tr_b16 v[80:81], v26 offset:12288
    ds_read_b64_tr_b16 v[82:83], v26 offset:14336
    s_waitcnt lgkmcnt(10)
    v_mfma_f32_16x16x32_bf16 v[44:47], v[60:63], a[232:235], v[44:47]
    ds_read_b64_tr_b16 v[84:85], v27 offset:12288
    ds_read_b64_tr_b16 v[86:87], v27 offset:14336
    s_waitcnt lgkmcnt(10)
    v_mfma_f32_16x16x32_bf16 v[48:51], v[64:67], a[232:235], v[48:51]
    ds_read_b64_tr_b16 v[88:89], v28 offset:12288
    ds_read_b64_tr_b16 v[90:91], v28 offset:14336
    s_waitcnt lgkmcnt(10)
    v_mfma_f32_16x16x32_bf16 v[52:55], v[68:71], a[232:235], v[52:55]
    s_barrier
    s_add_u32 s3, s68, 150528
    s_add_u32 m0, s58, 147456
    s_nop 0
    buffer_load_dwordx4 v96, s[16:19], s3 offen lds
    buffer_load_dwordx4 v97, s[16:19], s3 offen offset:1024 lds
    s_add_u32 s3, s67, 6144
    buffer_load_dwordx4 v4, s[28:31], s3 offen offset:2048 sc1 lds
    buffer_load_dwordx4 v4, s[28:31], s3 offen offset:3072 sc1 lds
    ds_read_b64_tr_b16 v[60:61], v25 offset:16384
    ds_read_b64_tr_b16 v[62:63], v25 offset:18432
    s_waitcnt lgkmcnt(10)
    v_mfma_f32_16x16x32_bf16 v[56:59], v[72:75], a[232:235], v[56:59]
    ds_read_b64_tr_b16 v[64:65], v26 offset:16384
    ds_read_b64_tr_b16 v[66:67], v26 offset:18432
    s_waitcnt lgkmcnt(10)
    v_mfma_f32_16x16x32_bf16 v[44:47], v[76:79], a[236:239], v[44:47]
    ds_read_b64_tr_b16 v[68:69], v27 offset:16384
    ds_read_b64_tr_b16 v[70:71], v27 offset:18432
    s_waitcnt lgkmcnt(10)
    v_mfma_f32_16x16x32_bf16 v[48:51], v[80:83], a[236:239], v[48:51]
    ds_read_b64_tr_b16 v[72:73], v28 offset:16384
    ds_read_b64_tr_b16 v[74:75], v28 offset:18432
    s_waitcnt lgkmcnt(10)
    v_mfma_f32_16x16x32_bf16 v[52:55], v[84:87], a[236:239], v[52:55]
    ds_read_b64_tr_b16 v[76:77], v25 offset:20480
    ds_read_b64_tr_b16 v[78:79], v25 offset:22528
    s_waitcnt lgkmcnt(10)
    v_mfma_f32_16x16x32_bf16 v[56:59], v[88:91], a[236:239], v[56:59]
    ds_read_b64_tr_b16 v[80:81], v26 offset:20480
    ds_read_b64_tr_b16 v[82:83], v26 offset:22528
    s_waitcnt lgkmcnt(10)
    v_mfma_f32_16x16x32_bf16 v[44:47], v[60:63], a[240:243], v[44:47]
    ds_read_b64_tr_b16 v[84:85], v27 offset:20480
    ds_read_b64_tr_b16 v[86:87], v27 offset:22528
    s_waitcnt lgkmcnt(10)
    v_mfma_f32_16x16x32_bf16 v[48:51], v[64:67], a[240:243], v[48:51]
    ds_read_b64_tr_b16 v[88:89], v28 offset:20480
    ds_read_b64_tr_b16 v[90:91], v28 offset:22528
    s_waitcnt lgkmcnt(10)
    v_mfma_f32_16x16x32_bf16 v[52:55], v[68:71], a[240:243], v[52:55]
    ds_read_b64_tr_b16 v[60:61], v25 offset:24576
    ds_read_b64_tr_b16 v[62:63], v25 offset:26624
    s_waitcnt lgkmcnt(10)
    v_mfma_f32_16x16x32_bf16 v[56:59], v[72:75], a[240:243], v[56:59]
    ds_read_b64_tr_b16 v[64:65], v26 offset:24576
    ds_read_b64_tr_b16 v[66:67], v26 offset:26624
    s_waitcnt lgkmcnt(10)
    v_mfma_f32_16x16x32_bf16 v[44:47], v[76:79], a[244:247], v[44:47]
    ds_read_b64_tr_b16 v[68:69], v27 offset:24576
    ds_read_b64_tr_b16 v[70:71], v27 offset:26624
    s_waitcnt lgkmcnt(10)
    v_mfma_f32_16x16x32_bf16 v[48:51], v[80:83], a[244:247], v[48:51]
    ds_read_b64_tr_b16 v[72:73], v28 offset:24576
    ds_read_b64_tr_b16 v[74:75], v28 offset:26624
    s_waitcnt lgkmcnt(10)
    v_mfma_f32_16x16x32_bf16 v[52:55], v[84:87], a[244:247], v[52:55]
    ds_read_b64_tr_b16 v[76:77], v25 offset:28672
    ds_read_b64_tr_b16 v[78:79], v25 offset:30720
    s_waitcnt lgkmcnt(10)
    v_mfma_f32_16x16x32_bf16 v[56:59], v[88:91], a[244:247], v[56:59]
    ds_read_b64_tr_b16 v[80:81], v26 offset:28672
    ds_read_b64_tr_b16 v[82:83], v26 offset:30720
    s_waitcnt lgkmcnt(10)
    v_mfma_f32_16x16x32_bf16 v[44:47], v[60:63], a[248:251], v[44:47]
    ds_read_b64_tr_b16 v[84:85], v27 offset:28672
    ds_read_b64_tr_b16 v[86:87], v27 offset:30720
    s_waitcnt lgkmcnt(10)
    v_mfma_f32_16x16x32_bf16 v[48:51], v[64:67], a[248:251], v[48:51]
    ds_read_b64_tr_b16 v[88:89], v28 offset:28672
    ds_read_b64_tr_b16 v[90:91], v28 offset:30720
    s_waitcnt lgkmcnt(10)
    v_mfma_f32_16x16x32_bf16 v[52:55], v[68:71], a[248:251], v[52:55]
    s_waitcnt lgkmcnt(8)
    v_mfma_f32_16x16x32_bf16 v[56:59], v[72:75], a[248:251], v[56:59]
    s_waitcnt lgkmcnt(6)
    v_mfma_f32_16x16x32_bf16 v[44:47], v[76:79], a[252:255], v[44:47]
    s_waitcnt lgkmcnt(4)
    v_mfma_f32_16x16x32_bf16 v[48:51], v[80:83], a[252:255], v[48:51]
    s_waitcnt lgkmcnt(2)
    v_mfma_f32_16x16x32_bf16 v[52:55], v[84:87], a[252:255], v[52:55]
    s_waitcnt lgkmcnt(0)
    v_mfma_f32_16x16x32_bf16 v[56:59], v[88:91], a[252:255], v[56:59]
    s_mov_b32 s73, 0xbdd2d3e8
    v_mov_b32 v5, 0xc0135761
    v_mul_f32 v128, v44, v44
    v_mul_f32 v129, v45, v45
    v_mul_f32 v130, v46, v46
    v_mul_f32 v131, v47, v47
    v_mul_f32 v132, v48, v48
    v_mul_f32 v133, v49, v49
    v_mul_f32 v134, v50, v50
    v_mul_f32 v135, v51, v51
    v_fma_f32 v128, v128, s73, v5
    v_fma_f32 v129, v129, s73, v5
    v_fma_f32 v130, v130, s73, v5
    v_fma_f32 v131, v131, s73, v5
    v_fma_f32 v132, v132, s73, v5
    v_fma_f32 v133, v133, s73, v5
    v_fma_f32 v134, v134, s73, v5
    v_fma_f32 v135, v135, s73, v5
    v_mul_f32 v128, v128, v44
    v_mul_f32 v129, v129, v45
    v_mul_f32 v130, v130, v46
    v_mul_f32 v131, v131, v47
    v_mul_f32 v132, v132, v48
    v_mul_f32 v133, v133, v49
    v_mul_f32 v134, v134, v50
    v_mul_f32 v135, v135, v51
    v_exp_f32 v128, v128
    v_exp_f32 v129, v129
    v_exp_f32 v130, v130
    v_exp_f32 v131, v131
    v_exp_f32 v132, v132
    v_exp_f32 v133, v133
    v_exp_f32 v134, v134
    v_exp_f32 v135, v135
    v_add_f32 v128, 1.0, v128
    v_add_f32 v129, 1.0, v129
    v_add_f32 v130, 1.0, v130
    v_add_f32 v131, 1.0, v131
    v_add_f32 v132, 1.0, v132
    v_add_f32 v133, 1.0, v133
    v_add_f32 v134, 1.0, v134
    v_add_f32 v135, 1.0, v135
    v_rcp_f32 v128, v128
    v_rcp_f32 v129, v129
    v_rcp_f32 v130, v130
    v_rcp_f32 v131, v131
    v_rcp_f32 v132, v132
    v_rcp_f32 v133, v133
    v_rcp_f32 v134, v134
    v_rcp_f32 v135, v135
    v_mul_f32 v128, v128, v44
    v_mul_f32 v129, v129, v45
    v_mul_f32 v130, v130, v46
    v_mul_f32 v131, v131, v47
    v_mul_f32 v132, v132, v48
    v_mul_f32 v133, v133, v49
    v_mul_f32 v134, v134, v50
    v_mul_f32 v135, v135, v51
    v_cvt_pk_bf16_f32 v120, v128, v129
    v_cvt_pk_bf16_f32 v121, v130, v131
    v_cvt_pk_bf16_f32 v122, v132, v133
    v_cvt_pk_bf16_f32 v123, v134, v135
    buffer_store_dwordx4 v[120:123], v4, s[28:31], s59 offen offset:0 sc1
    v_mul_f32 v136, v52, v52
    v_mul_f32 v137, v53, v53
    v_mul_f32 v138, v54, v54
    v_mul_f32 v139, v55, v55
    v_mul_f32 v140, v56, v56
    v_mul_f32 v141, v57, v57
    v_mul_f32 v142, v58, v58
    v_mul_f32 v143, v59, v59
    v_fma_f32 v136, v136, s73, v5
    v_fma_f32 v137, v137, s73, v5
    v_fma_f32 v138, v138, s73, v5
    v_fma_f32 v139, v139, s73, v5
    v_fma_f32 v140, v140, s73, v5
    v_fma_f32 v141, v141, s73, v5
    v_fma_f32 v142, v142, s73, v5
    v_fma_f32 v143, v143, s73, v5
    v_mul_f32 v136, v136, v52
    v_mul_f32 v137, v137, v53
    v_mul_f32 v138, v138, v54
    v_mul_f32 v139, v139, v55
    v_mul_f32 v140, v140, v56
    v_mul_f32 v141, v141, v57
    v_mul_f32 v142, v142, v58
    v_mul_f32 v143, v143, v59
    v_exp_f32 v136, v136
    v_exp_f32 v137, v137
    v_exp_f32 v138, v138
    v_exp_f32 v139, v139
    v_exp_f32 v140, v140
    v_exp_f32 v141, v141
    v_exp_f32 v142, v142
    v_exp_f32 v143, v143
    v_add_f32 v136, 1.0, v136
    v_add_f32 v137, 1.0, v137
    v_add_f32 v138, 1.0, v138
    v_add_f32 v139, 1.0, v139
    v_add_f32 v140, 1.0, v140
    v_add_f32 v141, 1.0, v141
    v_add_f32 v142, 1.0, v142
    v_add_f32 v143, 1.0, v143
    v_rcp_f32 v136, v136
    v_rcp_f32 v137, v137
    v_rcp_f32 v138, v138
    v_rcp_f32 v139, v139
    v_rcp_f32 v140, v140
    v_rcp_f32 v141, v141
    v_rcp_f32 v142, v142
    v_rcp_f32 v143, v143
    v_mul_f32 v136, v136, v52
    v_mul_f32 v137, v137, v53
    v_mul_f32 v138, v138, v54
    v_mul_f32 v139, v139, v55
    v_mul_f32 v140, v140, v56
    v_mul_f32 v141, v141, v57
    v_mul_f32 v142, v142, v58
    v_mul_f32 v143, v143, v59
    v_cvt_pk_bf16_f32 v124, v136, v137
    v_cvt_pk_bf16_f32 v125, v138, v139
    v_cvt_pk_bf16_f32 v126, v140, v141
    v_cvt_pk_bf16_f32 v127, v142, v143
    buffer_store_dwordx4 v[124:127], v4, s[28:31], s59 offen offset:1024 sc1
    s_branch L_f
L_nog1:
    s_waitcnt vmcnt(0) lgkmcnt(0)
    buffer_store_dword v43, v8, s[28:31], s64 offen sc1
    s_cmp_eq_u32 s56, 0
    s_cbranch_scc1 L_fin
    s_mov_b32 s71, 268435456
    s_barrier
    s_lshl_b32 s3, s53, 1
    s_add_u32 s3, s3, s4
    s_lshl_b32 s3, s3, 7
    s_add_u32 s3, s3, 6307840
    v_lshlrev_b32 v98, 2, v2
    s_mov_b32 s63, 0
L_poll2:
    buffer_load_dword v99, v98, s[28:31], s3 offen sc1
    s_add_u32 s63, s63, 1
    s_waitcnt vmcnt(0)
    v_cmp_ne_u32 vcc, s57, v99
    s_cbranch_vccz L_pollok2
    s_sleep 8
    s_cmp_lt_u32 s63, 20000
    s_cbranch_scc1 L_poll2
L_pollok2:
    s_add_u32 s3, s68, 0
    s_add_u32 m0, s58, 98304
    s_nop 0
    buffer_load_dwordx4 v96, s[16:19], s3 offen lds
    buffer_load_dwordx4 v97, s[16:19], s3 offen offset:1024 lds
    s_add_u32 s3, s67, 0
    buffer_load_dwordx4 v4, s[28:31], s3 offen offset:2048 sc1 lds
    buffer_load_dwordx4 v4, s[28:31], s3 offen offset:3072 sc1 lds
    s_add_u32 s3, s68, 50176
    s_add_u32 m0, s58, 114688
    s_nop 0
    buffer_load_dwordx4 v96, s[16:19], s3 offen lds
    buffer_load_dwordx4 v97, s[16:19], s3 offen offset:1024 lds
    s_add_u32 s3, s67, 2048
    buffer_load_dwordx4 v4, s[28:31], s3 offen offset:2048 sc1 lds
    buffer_load_dwordx4 v4, s[28:31], s3 offen offset:3072 sc1 lds
    s_add_u32 s3, s68, 100352
    s_add_u32 m0, s58, 131072
    s_nop 0
    buffer_load_dwordx4 v96, s[16:19], s3 offen lds
    buffer_load_dwordx4 v97, s[16:19], s3 offen offset:1024 lds
    s_add_u32 s3, s67, 4096
    buffer_load_dwordx4 v4, s[28:31], s3 offen offset:2048 sc1 lds
    buffer_load_dwordx4 v4, s[28:31], s3 offen offset:3072 sc1 lds
    s_add_u32 s3, s68, 150528
    s_add_u32 m0, s58, 147456
    s_nop 0
    buffer_load_dwordx4 v96, s[16:19], s3 offen lds
    buffer_load_dwordx4 v97, s[16:19], s3 offen offset:1024 lds
    s_add_u32 s3, s67, 6144
    buffer_load_dwordx4 v4, s[28:31], s3 offen offset:2048 sc1 lds
    buffer_load_dwordx4 v4, s[28:31], s3 offen offset:3072 sc1 lds
    s_waitcnt vmcnt(0) lgkmcnt(0)
    s_nop 3
L_f:
    s_add_u32 s3, s68, 200704
    s_add_u32 m0, s58, 0
    s_nop 0
    buffer_load_dwordx4 v96, s[16:19], s3 offen lds
    buffer_load_dwordx4 v97, s[16:19], s3 offen offset:1024 lds
    s_add_u32 s3, s67, 8192
    buffer_load_dwordx4 v4, s[28:31], s3 offen offset:2048 sc1 lds
    buffer_load_dwordx4 v4, s[28:31], s3 offen offset:3072 sc1 lds
    s_add_u32 s3, s68, 250880
    s_add_u32 m0, s58, 16384
    s_nop 0
    buffer_load_dwordx4 v96, s[16:19], s3 offen lds
    buffer_load_dwordx4 v97, s[16:19], s3 offen offset:1024 lds
    s_add_u32 s3, s67, 10240
    buffer_load_dwordx4 v4, s[28:31], s3 offen offset:2048 sc1 lds
    buffer_load_dwordx4 v4, s[28:31], s3 offen offset:3072 sc1 lds
    s_add_u32 s3, s68, 301056
    s_add_u32 m0, s58, 32768
    s_nop 0
    buffer_load_dwordx4 v96, s[16:19], s3 offen lds
    buffer_load_dwordx4 v97, s[16:19], s3 offen offset:1024 lds
    s_add_u32 s3, s67, 12288
    buffer_load_dwordx4 v4, s[28:31], s3 offen offset:2048 sc1 lds
    buffer_load_dwordx4 v4, s[28:31], s3 offen offset:3072 sc1 lds
    s_add_u32 s3, s68, 351232
    s_add_u32 m0, s58, 49152
    s_nop 0
    buffer_load_dwordx4 v96, s[16:19], s3 offen lds
    buffer_load_dwordx4 v97, s[16:19], s3 offen offset:1024 lds
    s_add_u32 s3, s67, 14336
    buffer_load_dwordx4 v4, s[28:31], s3 offen offset:2048 sc1 lds
    buffer_load_dwordx4 v4, s[28:31], s3 offen offset:3072 sc1 lds
    s_lshl_b32 s3, s53, 2
    s_add_u32 s3, s3, s48
    s_lshl_b32 s60, s3, 5
    s_mul_i32 s59, s3, 14336
    s_lshl_b32 s3, s54, 7
    s_add_u32 s59, s59, s3
    s_add_u32 s62, s59, 7168
    v_lshlrev_b32 v5, 1, v16
    s_waitcnt vmcnt(30)
    s_barrier
    s_add_u32 s3, s70, 0
    s_sub_u32 s6, s3, 14
    s_cmp_ge_u32 s3, 14
    s_cselect_b32 s3, s6, s3
    s_lshl_b32 s3, s3, 19
    s_add_u32 s3, s3, s65
    s_add_u32 m0, s58, 65536
    s_nop 0
    buffer_load_dwordx4 v92, s[24:27], s3 offen lds
    buffer_load_dwordx4 v93, s[24:27], s3 offen offset:1024 lds
    buffer_load_dwordx4 v94, s[24:27], s3 offen offset:2048 lds
    buffer_load_dwordx4 v95, s[24:27], s3 offen offset:3072 lds
    ds_read_b64_tr_b16 v[144:145], v34 offset:32768
    ds_read_b64_tr_b16 v[146:147], v34 offset:36864
    ds_read_b128 v[60:63], v36 offset:34816
    ds_read_b128 v[64:67], v36 offset:38912
    ds_read_b128 v[68:71], v36 offset:43008
    ds_read_b128 v[72:75], v36 offset:47104
    s_waitcnt lgkmcnt(3)
    v_mfma_f32_16x16x32_bf16 v[44:47], v[144:147], v[60:63], 0
    ds_read_b64_tr_b16 v[148:149], v34 offset:40960
    ds_read_b64_tr_b16 v[150:151], v34 offset:45056
    ds_read_b128 v[76:79], v36 offset:35840
    s_waitcnt lgkmcnt(5)
    v_mfma_f32_16x16x32_bf16 v[48:51], v[144:147], v[64:67], 0
    ds_read_b128 v[80:83], v36 offset:39936
    s_waitcnt lgkmcnt(5)
    v_mfma_f32_16x16x32_bf16 v[52:55], v[144:147], v[68:71], 0
    ds_read_b128 v[84:87], v36 offset:44032
    s_waitcnt lgkmcnt(5)
    v_mfma_f32_16x16x32_bf16 v[56:59], v[144:147], v[72:75], 0
    ds_read_b128 v[88:91], v36 offset:48128
    s_waitcnt lgkmcnt(3)
    v_mfma_f32_16x16x32_bf16 v[44:47], v[148:151], v[76:79], v[44:47]
    s_waitcnt vmcnt(30)
    s_barrier
    s_add_u32 s3, s70, 1
    s_sub_u32 s6, s3, 14
    s_cmp_ge_u32 s3, 14
    s_cselect_b32 s3, s6, s3
    s_lshl_b32 s3, s3, 19
    s_add_u32 s3, s3, s65
    s_add_u32 m0, s58, 81920
    s_nop 0
    buffer_load_dwordx4 v92, s[24:27], s3 offen lds
    buffer_load_dwordx4 v93, s[24:27], s3 offen offset:1024 lds
    buffer_load_dwordx4 v94, s[24:27], s3 offen offset:2048 lds
    buffer_load_dwordx4 v95, s[24:27], s3 offen offset:3072 lds
    ds_read_b64_tr_b16 v[144:145], v34 offset:49152
    ds_read_b64_tr_b16 v[146:147], v34 offset:53248
    ds_read_b128 v[60:63], v36 offset:51200
    s_waitcnt lgkmcnt(5)
    v_mfma_f32_16x16x32_bf16 v[48:51], v[148:151], v[80:83], v[48:51]
    ds_read_b128 v[64:67], v36 offset:55296
    s_waitcnt lgkmcnt(5)
    v_mfma_f32_16x16x32_bf16 v[52:55], v[148:151], v[84:87], v[52:55]
    ds_read_b128 v[68:71], v36 offset:59392
    s_waitcnt lgkmcnt(5)
    v_mfma_f32_16x16x32_bf16 v[56:59], v[148:151], v[88:91], v[56:59]
    ds_read_b128 v[72:75], v36 offset:63488
    s_waitcnt lgkmcnt(3)
    v_mfma_f32_16x16x32_bf16 v[44:47], v[144:147], v[60:63], v[44:47]
    ds_read_b64_tr_b16 v[148:149], v34 offset:57344
    ds_read_b64_tr_b16 v[150:151], v34 offset:61440
    ds_read_b128 v[76:79], v36 offset:52224
    s_waitcnt lgkmcnt(5)
    v_mfma_f32_16x16x32_bf16 v[48:51], v[144:147], v[64:67], v[48:51]
    ds_read_b128 v[80:83], v36 offset:56320
    s_waitcnt lgkmcnt(5)
    v_mfma_f32_16x16x32_bf16 v[52:55], v[144:147], v[68:71], v[52:55]
    ds_read_b128 v[84:87], v36 offset:60416
    s_waitcnt lgkmcnt(5)
    v_mfma_f32_16x16x32_bf16 v[56:59], v[144:147], v[72:75], v[56:59]
    ds_read_b128 v[88:91], v36 offset:64512
    s_waitcnt lgkmcnt(3)
    v_mfma_f32_16x16x32_bf16 v[44:47], v[148:151], v[76:79], v[44:47]
    s_waitcnt vmcnt(30)
    s_barrier
    s_add_u32 s3, s70, 2
    s_sub_u32 s6, s3, 14
    s_cmp_ge_u32 s3, 14
    s_cselect_b32 s3, s6, s3
    s_lshl_b32 s3, s3, 19
    s_add_u32 s3, s3, s65
    s_add_u32 m0, s58, 98304
    s_nop 0
    buffer_load_dwordx4 v92, s[24:27], s3 offen lds
    buffer_load_dwordx4 v93, s[24:27], s3 offen offset:1024 lds
    buffer_load_dwordx4 v94, s[24:27], s3 offen offset:2048 lds
    buffer_load_dwordx4 v95, s[24:27], s3 offen offset:3072 lds
    ds_read_b64_tr_b16 v[144:145], v35 offset:0
    ds_read_b64_tr_b16 v[146:147], v35 offset:4096
    ds_read_b128 v[60:63], v37 offset:2048
    s_waitcnt lgkmcnt(5)
    v_mfma_f32_16x16x32_bf16 v[48:51], v[148:151], v[80:83], v[48:51]
    ds_read_b128 v[64:67], v37 offset:6144
    s_waitcnt lgkmcnt(5)
    v_mfma_f32_16x16x32_bf16 v[52:55], v[148:151], v[84:87], v[52:55]
    ds_read_b128 v[68:71], v37 offset:10240
    s_waitcnt lgkmcnt(5)
    v_mfma_f32_16x16x32_bf16 v[56:59], v[148:151], v[88:91], v[56:59]
    ds_read_b128 v[72:75], v37 offset:14336
    s_waitcnt lgkmcnt(3)
    v_mfma_f32_16x16x32_bf16 v[44:47], v[144:147], v[60:63], v[44:47]
    ds_read_b64_tr_b16 v[148:149], v35 offset:8192
    ds_read_b64_tr_b16 v[150:151], v35 offset:12288
    ds_read_b128 v[76:79], v37 offset:3072
    s_waitcnt lgkmcnt(5)
    v_mfma_f32_16x16x32_bf16 v[48:51], v[144:147], v[64:67], v[48:51]
    ds_read_b128 v[80:83], v37 offset:7168
    s_waitcnt lgkmcnt(5)
    v_mfma_f32_16x16x32_bf16 v[52:55], v[144:147], v[68:71], v[52:55]
    ds_read_b128 v[84:87], v37 offset:11264
    s_waitcnt lgkmcnt(5)
    v_mfma_f32_16x16x32_bf16 v[56:59], v[144:147], v[72:75], v[56:59]
    ds_read_b128 v[88:91], v37 offset:15360
    s_waitcnt lgkmcnt(3)
    v_mfma_f32_16x16x32_bf16 v[44:47], v[148:151], v[76:79], v[44:47]
    s_waitcnt vmcnt(30)
    s_barrier
    s_add_u32 s3, s70, 3
    s_sub_u32 s6, s3, 14
    s_cmp_ge_u32 s3, 14
    s_cselect_b32 s3, s6, s3
    s_lshl_b32 s3, s3, 19
    s_add_u32 s3, s3, s65
    s_add_u32 m0, s58, 114688
    s_nop 0
    buffer_load_dwordx4 v92, s[24:27], s3 offen lds
    buffer_load_dwordx4 v93, s[24:27], s3 offen offset:1024 lds
    buffer_load_dwordx4 v94, s[24:27], s3 offen offset:2048 lds
    buffer_load_dwordx4 v95, s[24:27], s3 offen offset:3072 lds
    ds_read_b64_tr_b16 v[144:145], v35 offset:16384
    ds_read_b64_tr_b16 v[146:147], v35 offset:20480
    ds_read_b128 v[60:63], v37 offset:18432
    s_waitcnt lgkmcnt(5)
    v_mfma_f32_16x16x32_bf16 v[48:51], v[148:151], v[80:83], v[48:51]
    ds_read_b128 v[64:67], v37 offset:22528
    s_waitcnt lgkmcnt(5)
    v_mfma_f32_16x16x32_bf16 v[52:55], v[148:151], v[84:87], v[52:55]
    ds_read_b128 v[68:71], v37 offset:26624
    s_waitcnt lgkmcnt(5)
    v_mfma_f32_16x16x32_bf16 v[56:59], v[148:151], v[88:91], v[56:59]
    ds_read_b128 v[72:75], v37 offset:30720
    s_waitcnt lgkmcnt(3)
    v_mfma_f32_16x16x32_bf16 v[44:47], v[144:147], v[60:63], v[44:47]
    ds_read_b64_tr_b16 v[148:149], v35 offset:24576
    ds_read_b64_tr_b16 v[150:151], v35 offset:28672
    ds_read_b128 v[76:79], v37 offset:19456
    s_waitcnt lgkmcnt(5)
    v_mfma_f32_16x16x32_bf16 v[48:51], v[144:147], v[64:67], v[48:51]
    ds_read_b128 v[80:83], v37 offset:23552
    s_waitcnt lgkmcnt(5)
    v_mfma_f32_16x16x32_bf16 v[52:55], v[144:147], v[68:71], v[52:55]
    ds_read_b128 v[84:87], v37 offset:27648
    s_waitcnt lgkmcnt(5)
    v_mfma_f32_16x16x32_bf16 v[56:59], v[144:147], v[72:75], v[56:59]
    ds_read_b128 v[88:91], v37 offset:31744
    s_waitcnt lgkmcnt(3)
    v_mfma_f32_16x16x32_bf16 v[44:47], v[148:151], v[76:79], v[44:47]
    s_waitcnt vmcnt(28)
    buffer_store_dword v43, v8, s[28:31], s71 offen sc1
    s_barrier
    s_add_u32 s3, s70, 4
    s_sub_u32 s6, s3, 14
    s_cmp_ge_u32 s3, 14
    s_cselect_b32 s3, s6, s3
    s_lshl_b32 s3, s3, 19
    s_add_u32 s3, s3, s65
    s_add_u32 m0, s58, 131072
    s_nop 0
    buffer_load_dwordx4 v92, s[24:27], s3 offen lds
    buffer_load_dwordx4 v93, s[24:27], s3 offen offset:1024 lds
    buffer_load_dwordx4 v94, s[24:27], s3 offen offset:2048 lds
    buffer_load_dwordx4 v95, s[24:27], s3 offen offset:3072 lds
    ds_read_b64_tr_b16 v[144:145], v33 offset:0
    ds_read_b64_tr_b16 v[146:147], v33 offset:4096
    ds_read_b128 v[60:63], v4 offset:2048
    s_waitcnt lgkmcnt(5)
    v_mfma_f32_16x16x32_bf16 v[48:51], v[148:151], v[80:83], v[48:51]
    ds_read_b128 v[64:67], v4 offset:6144
    s_waitcnt lgkmcnt(5)
    v_mfma_f32_16x16x32_bf16 v[52:55], v[148:151], v[84:87], v[52:55]
    ds_read_b128 v[68:71], v4 offset:10240
    s_waitcnt lgkmcnt(5)
    v_mfma_f32_16x16x32_bf16 v[56:59], v[148:151], v[88:91], v[56:59]
    ds_read_b128 v[72:75], v4 offset:14336
    s_waitcnt lgkmcnt(3)
    v_mfma_f32_16x16x32_bf16 v[44:47], v[144:147], v[60:63], v[44:47]
    ds_read_b64_tr_b16 v[148:149], v33 offset:8192
    ds_read_b64_tr_b16 v[150:151], v33 offset:12288
    ds_read_b128 v[76:79], v4 offset:3072
    s_waitcnt lgkmcnt(5)
    v_mfma_f32_16x16x32_bf16 v[48:51], v[144:147], v[64:67], v[48:51]
    ds_read_b128 v[80:83], v4 offset:7168
    s_waitcnt lgkmcnt(5)
    v_mfma_f32_16x16x32_bf16 v[52:55], v[144:147], v[68:71], v[52:55]
    ds_read_b128 v[84:87], v4 offset:11264
    s_waitcnt lgkmcnt(5)
    v_mfma_f32_16x16x32_bf16 v[56:59], v[144:147], v[72:75], v[56:59]
    ds_read_b128 v[88:91], v4 offset:15360
    s_waitcnt lgkmcnt(3)
    v_mfma_f32_16x16x32_bf16 v[44:47], v[148:151], v[76:79], v[44:47]
    s_waitcnt vmcnt(29)
    s_barrier
    s_add_u32 s3, s70, 5
    s_sub_u32 s6, s3, 14
    s_cmp_ge_u32 s3, 14
    s_cselect_b32 s3, s6, s3
    s_lshl_b32 s3, s3, 19
    s_add_u32 s3, s3, s65
    s_add_u32 m0, s58, 147456
    s_nop 0
    buffer_load_dwordx4 v92, s[24:27], s3 offen lds
    buffer_load_dwordx4 v93, s[24:27], s3 offen offset:1024 lds
    buffer_load_dwordx4 v94, s[24:27], s3 offen offset:2048 lds
    buffer_load_dwordx4 v95, s[24:27], s3 offen offset:3072 lds
    ds_read_b64_tr_b16 v[144:145], v33 offset:16384
    ds_read_b64_tr_b16 v[146:147], v33 offset:20480
    ds_read_b128 v[60:63], v4 offset:18432
    s_waitcnt lgkmcnt(5)
    v_mfma_f32_16x16x32_bf16 v[48:51], v[148:151], v[80:83], v[48:51]
    ds_read_b128 v[64:67], v4 offset:22528
    s_waitcnt lgkmcnt(5)
    v_mfma_f32_16x16x32_bf16 v[52:55], v[148:151], v[84:87], v[52:55]
    ds_read_b128 v[68:71], v4 offset:26624
    s_waitcnt lgkmcnt(5)
    v_mfma_f32_16x16x32_bf16 v[56:59], v[148:151], v[88:91], v[56:59]
    ds_read_b128 v[72:75], v4 offset:30720
    s_waitcnt lgkmcnt(3)
    v_mfma_f32_16x16x32_bf16 v[44:47], v[144:147], v[60:63], v[44:47]
    ds_read_b64_tr_b16 v[148:149], v33 offset:24576
    ds_read_b64_tr_b16 v[150:151], v33 offset:28672
    ds_read_b128 v[76:79], v4 offset:19456
    s_waitcnt lgkmcnt(5)
    v_mfma_f32_16x16x32_bf16 v[48:51], v[144:147], v[64:67], v[48:51]
    ds_read_b128 v[80:83], v4 offset:23552
    s_waitcnt lgkmcnt(5)
    v_mfma_f32_16x16x32_bf16 v[52:55], v[144:147], v[68:71], v[52:55]
    ds_read_b128 v[84:87], v4 offset:27648
    s_waitcnt lgkmcnt(5)
    v_mfma_f32_16x16x32_bf16 v[56:59], v[144:147], v[72:75], v[56:59]
    ds_read_b128 v[88:91], v4 offset:31744
    s_waitcnt lgkmcnt(3)
    v_mfma_f32_16x16x32_bf16 v[44:47], v[148:151], v[76:79], v[44:47]
    s_waitcnt vmcnt(29)
    s_barrier
    s_add_u32 s3, s70, 6
    s_sub_u32 s6, s3, 14
    s_cmp_ge_u32 s3, 14
    s_cselect_b32 s3, s6, s3
    s_lshl_b32 s3, s3, 19
    s_add_u32 s3, s3, s65
    s_add_u32 m0, s58, 0
    s_nop 0
    buffer_load_dwordx4 v92, s[24:27], s3 offen lds
    buffer_load_dwordx4 v93, s[24:27], s3 offen offset:1024 lds
    buffer_load_dwordx4 v94, s[24:27], s3 offen offset:2048 lds
    buffer_load_dwordx4 v95, s[24:27], s3 offen offset:3072 lds
    ds_read_b64_tr_b16 v[144:145], v33 offset:32768
    ds_read_b64_tr_b16 v[146:147], v33 offset:36864
    ds_read_b128 v[60:63], v4 offset:34816
    s_waitcnt lgkmcnt(5)
    v_mfma_f32_16x16x32_bf16 v[48:51], v[148:151], v[80:83], v[48:51]
    ds_read_b128 v[64:67], v4 offset:38912
    s_waitcnt lgkmcnt(5)
    v_mfma_f32_16x16x32_bf16 v[52:55], v[148:151], v[84:87], v[52:55]
    ds_read_b128 v[68:71], v4 offset:43008
    s_waitcnt lgkmcnt(5)
    v_mfma_f32_16x16x32_bf16 v[56:59], v[148:151], v[88:91], v[56:59]
    ds_read_b128 v[72:75], v4 offset:47104
    s_waitcnt lgkmcnt(3)
    v_mfma_f32_16x16x32_bf16 v[44:47], v[144:147], v[60:63], v[44:47]
    ds_read_b64_tr_b16 v[148:149], v33 offset:40960
    ds_read_b64_tr_b16 v[150:151], v33 offset:45056
    ds_read_b128 v[76:79], v4 offset:35840
    s_waitcnt lgkmcnt(5)
    v_mfma_f32_16x16x32_bf16 v[48:51], v[144:147], v[64:67], v[48:51]
    ds_read_b128 v[80:83], v4 offset:39936
    s_waitcnt lgkmcnt(5)
    v_mfma_f32_16x16x32_bf16 v[52:55], v[144:147], v[68:71], v[52:55]
    ds_read_b128 v[84:87], v4 offset:44032
    s_waitcnt lgkmcnt(5)
    v_mfma_f32_16x16x32_bf16 v[56:59], v[144:147], v[72:75], v[56:59]
    ds_read_b128 v[88:91], v4 offset:48128
    s_waitcnt lgkmcnt(3)
    v_mfma_f32_16x16x32_bf16 v[44:47], v[148:151], v[76:79], v[44:47]
    s_waitcnt vmcnt(29)
    s_barrier
    s_add_u32 s3, s70, 7
    s_sub_u32 s6, s3, 14
    s_cmp_ge_u32 s3, 14
    s_cselect_b32 s3, s6, s3
    s_lshl_b32 s3, s3, 19
    s_add_u32 s3, s3, s65
    s_add_u32 m0, s58, 16384
    s_nop 0
    buffer_load_dwordx4 v92, s[24:27], s3 offen lds
    buffer_load_dwordx4 v93, s[24:27], s3 offen offset:1024 lds
    buffer_load_dwordx4 v94, s[24:27], s3 offen offset:2048 lds
    buffer_load_dwordx4 v95, s[24:27], s3 offen offset:3072 lds
    ds_read_b64_tr_b16 v[144:145], v33 offset:49152
    ds_read_b64_tr_b16 v[146:147], v33 offset:53248
    ds_read_b128 v[60:63], v4 offset:51200
    s_waitcnt lgkmcnt(5)
    v_mfma_f32_16x16x32_bf16 v[48:51], v[148:151], v[80:83], v[48:51]
    ds_read_b128 v[64:67], v4 offset:55296
    s_waitcnt lgkmcnt(5)
    v_mfma_f32_16x16x32_bf16 v[52:55], v[148:151], v[84:87], v[52:55]
    ds_read_b128 v[68:71], v4 offset:59392
    s_waitcnt lgkmcnt(5)
    v_mfma_f32_16x16x32_bf16 v[56:59], v[148:151], v[88:91], v[56:59]
    ds_read_b128 v[72:75], v4 offset:63488
    s_waitcnt lgkmcnt(3)
    v_mfma_f32_16x16x32_bf16 v[44:47], v[144:147], v[60:63], v[44:47]
    ds_read_b64_tr_b16 v[148:149], v33 offset:57344
    ds_read_b64_tr_b16 v[150:151], v33 offset:61440
    ds_read_b128 v[76:79], v4 offset:52224
    s_waitcnt lgkmcnt(5)
    v_mfma_f32_16x16x32_bf16 v[48:51], v[144:147], v[64:67], v[48:51]
    ds_read_b128 v[80:83], v4 offset:56320
    s_waitcnt lgkmcnt(5)
    v_mfma_f32_16x16x32_bf16 v[52:55], v[144:147], v[68:71], v[52:55]
    ds_read_b128 v[84:87], v4 offset:60416
    s_waitcnt lgkmcnt(5)
    v_mfma_f32_16x16x32_bf16 v[56:59], v[144:147], v[72:75], v[56:59]
    ds_read_b128 v[88:91], v4 offset:64512
    s_waitcnt lgkmcnt(3)
    v_mfma_f32_16x16x32_bf16 v[44:47], v[148:151], v[76:79], v[44:47]
    s_waitcnt lgkmcnt(2)
    v_mfma_f32_16x16x32_bf16 v[48:51], v[148:151], v[80:83], v[48:51]
    s_waitcnt lgkmcnt(1)
    v_mfma_f32_16x16x32_bf16 v[52:55], v[148:151], v[84:87], v[52:55]
    s_waitcnt lgkmcnt(0)
    v_mfma_f32_16x16x32_bf16 v[56:59], v[148:151], v[88:91], v[56:59]
    s_barrier
    s_add_u32 s3, s70, 8
    s_sub_u32 s6, s3, 14
    s_cmp_ge_u32 s3, 14
    s_cselect_b32 s3, s6, s3
    s_lshl_b32 s3, s3, 19
    s_add_u32 s3, s3, s65
    s_add_u32 m0, s58, 32768
    s_nop 0
    buffer_load_dwordx4 v92, s[24:27], s3 offen lds
    buffer_load_dwordx4 v93, s[24:27], s3 offen offset:1024 lds
    buffer_load_dwordx4 v94, s[24:27], s3 offen offset:2048 lds
    buffer_load_dwordx4 v95, s[24:27], s3 offen offset:3072 lds
    s_add_u32 s3, s70, 9
    s_sub_u32 s6, s3, 14
    s_cmp_ge_u32 s3, 14
    s_cselect_b32 s3, s6, s3
    s_lshl_b32 s3, s3, 19
    s_add_u32 s3, s3, s65
    s_add_u32 m0, s58, 49152
    s_nop 0
    buffer_load_dwordx4 v92, s[24:27], s3 offen lds
    buffer_load_dwordx4 v93, s[24:27], s3 offen offset:1024 lds
    buffer_load_dwordx4 v94, s[24:27], s3 offen offset:2048 lds
    buffer_load_dwordx4 v95, s[24:27], s3 offen offset:3072 lds
    buffer_load_dwordx4 v[108:111], v118, s[8:11], s59 offen
    buffer_load_ushort v116, v5, s[40:43], s60 offen offset:0
    buffer_load_dwordx4 v[112:115], v118, s[8:11], s62 offen
    buffer_load_ushort v117, v5, s[40:43], s60 offen offset:16
    s_lshl_b32 s3, s54, 2
    s_add_u32 s3, s3, s48
    s_lshl_b32 s3, s3, 7
    s_add_u32 s3, s3, 6299648
    v_min_u32 v98, 27, v1
    v_lshlrev_b32 v98, 2, v98
    s_mov_b32 s63, 0
L_poll3:
    buffer_load_dword v99, v98, s[28:31], s3 offen sc1
    s_add_u32 s63, s63, 1
    s_waitcnt vmcnt(0)
    v_cmp_ne_u32 vcc, s57, v99
    s_cbranch_vccz L_pollok3
    s_sleep 8
    s_cmp_lt_u32 s63, 20000
    s_cbranch_scc1 L_poll3
L_pollok3:
    s_add_u32 s3, s70, 0
    s_sub_u32 s6, s3, 14
    s_cmp_ge_u32 s3, 14
    s_cselect_b32 s3, s6, s3
    s_lshl_b32 s3, s3, 12
    s_add_u32 s3, s3, s66
    buffer_load_dwordx4 a[0:3], v4, s[28:31], s3 offen offset:0 sc1
    buffer_load_dwordx4 a[4:7], v4, s[28:31], s3 offen offset:1024 sc1
    buffer_load_dwordx4 a[8:11], v4, s[28:31], s3 offen offset:2048 sc1
    buffer_load_dwordx4 a[12:15], v4, s[28:31], s3 offen offset:3072 sc1
    s_add_u32 s3, s70, 1
    s_sub_u32 s6, s3, 14
    s_cmp_ge_u32 s3, 14
    s_cselect_b32 s3, s6, s3
    s_lshl_b32 s3, s3, 12
    s_add_u32 s3, s3, s66
    buffer_load_dwordx4 a[16:19], v4, s[28:31], s3 offen offset:0 sc1
    buffer_load_dwordx4 a[20:23], v4, s[28:31], s3 offen offset:1024 sc1
    buffer_load_dwordx4 a[24:27], v4, s[28:31], s3 offen offset:2048 sc1
    buffer_load_dwordx4 a[28:31], v4, s[28:31], s3 offen offset:3072 sc1
    s_add_u32 s3, s70, 2
    s_sub_u32 s6, s3, 14
    s_cmp_ge_u32 s3, 14
    s_cselect_b32 s3, s6, s3
    s_lshl_b32 s3, s3, 12
    s_add_u32 s3, s3, s66
    buffer_load_dwordx4 a[32:35], v4, s[28:31], s3 offen offset:0 sc1
    buffer_load_dwordx4 a[36:39], v4, s[28:31], s3 offen offset:1024 sc1
    buffer_load_dwordx4 a[40:43], v4, s[28:31], s3 offen offset:2048 sc1
    buffer_load_dwordx4 a[44:47], v4, s[28:31], s3 offen offset:3072 sc1
    s_add_u32 s3, s70, 3
    s_sub_u32 s6, s3, 14
    s_cmp_ge_u32 s3, 14
    s_cselect_b32 s3, s6, s3
    s_lshl_b32 s3, s3, 12
    s_add_u32 s3, s3, s66
    buffer_load_dwordx4 a[48:51], v4, s[28:31], s3 offen offset:0 sc1
    buffer_load_dwordx4 a[52:55], v4, s[28:31], s3 offen offset:1024 sc1
    buffer_load_dwordx4 a[56:59], v4, s[28:31], s3 offen offset:2048 sc1
    buffer_load_dwordx4 a[60:63], v4, s[28:31], s3 offen offset:3072 sc1
    s_barrier
    s_add_u32 s3, s70, 4
    s_sub_u32 s6, s3, 14
    s_cmp_ge_u32 s3, 14
    s_cselect_b32 s3, s6, s3
    s_lshl_b32 s3, s3, 12
    s_add_u32 s3, s3, s66
    buffer_load_dwordx4 a[64:67], v4, s[28:31], s3 offen offset:0 sc1
    buffer_load_dwordx4 a[68:71], v4, s[28:31], s3 offen offset:1024 sc1
    buffer_load_dwordx4 a[72:75], v4, s[28:31], s3 offen offset:2048 sc1
    buffer_load_dwordx4 a[76:79], v4, s[28:31], s3 offen offset:3072 sc1
    ds_read_b64_tr_b16 v[60:61], v25 offset:0
    ds_read_b64_tr_b16 v[62:63], v25 offset:2048
    ds_read_b64_tr_b16 v[64:65], v26 offset:0
    ds_read_b64_tr_b16 v[66:67], v26 offset:2048
    ds_read_b64_tr_b16 v[68:69], v27 offset:0
    ds_read_b64_tr_b16 v[70:71], v27 offset:2048
    ds_read_b64_tr_b16 v[72:73], v28 offset:0
    ds_read_b64_tr_b16 v[74:75], v28 offset:2048
    ds_read_b64_tr_b16 v[76:77], v25 offset:4096
    ds_read_b64_tr_b16 v[78:79], v25 offset:6144
    ds_read_b64_tr_b16 v[80:81], v26 offset:4096
    ds_read_b64_tr_b16 v[82:83], v26 offset:6144
    s_waitcnt vmcnt(19) lgkmcnt(10)
    v_mfma_f32_16x16x32_bf16 v[44:47], a[0:3], v[60:63], v[44:47]
    ds_read_b64_tr_b16 v[84:85], v27 offset:4096
    ds_read_b64_tr_b16 v[86:87], v27 offset:6144
    s_waitcnt lgkmcnt(10)
    v_mfma_f32_16x16x32_bf16 v[48:51], a[0:3], v[64:67], v[48:51]
    ds_read_b64_tr_b16 v[88:89], v28 offset:4096
    ds_read_b64_tr_b16 v[90:91], v28 offset:6144
    s_waitcnt lgkmcnt(10)
    v_mfma_f32_16x16x32_bf16 v[52:55], a[0:3], v[68:71], v[52:55]
    ds_read_b64_tr_b16 v[60:61], v25 offset:8192
    ds_read_b64_tr_b16 v[62:63], v25 offset:10240
    s_waitcnt lgkmcnt(10)
    v_mfma_f32_16x16x32_bf16 v[56:59], a[0:3], v[72:75], v[56:59]
    ds_read_b64_tr_b16 v[64:65], v26 offset:8192
    ds_read_b64_tr_b16 v[66:67], v26 offset:10240
    s_waitcnt vmcnt(18) lgkmcnt(10)
    v_mfma_f32_16x16x32_bf16 v[44:47], a[4:7], v[76:79], v[44:47]
    ds_read_b64_tr_b16 v[68:69], v27 offset:8192
    ds_read_b64_tr_b16 v[70:71], v27 offset:10240
    s_waitcnt lgkmcnt(10)
    v_mfma_f32_16x16x32_bf16 v[48:51], a[4:7], v[80:83], v[48:51]
    ds_read_b64_tr_b16 v[72:73], v28 offset:8192
    ds_read_b64_tr_b16 v[74:75], v28 offset:10240
    s_waitcnt lgkmcnt(10)
    v_mfma_f32_16x16x32_bf16 v[52:55], a[4:7], v[84:87], v[52:55]
    ds_read_b64_tr_b16 v[76:77], v25 offset:12288
    ds_read_b64_tr_b16 v[78:79], v25 offset:14336
    s_waitcnt lgkmcnt(10)
    v_mfma_f32_16x16x32_bf16 v[56:59], a[4:7], v[88:91], v[56:59]
    ds_read_b64_tr_b16 v[80:81], v26 offset:12288
    ds_read_b64_tr_b16 v[82:83], v26 offset:14336
    s_waitcnt vmcnt(17) lgkmcnt(10)
    v_mfma_f32_16x16x32_bf16 v[44:47], a[8:11], v[60:63], v[44:47]
    ds_read_b64_tr_b16 v[84:85], v27 offset:12288
    ds_read_b64_tr_b16 v[86:87], v27 offset:14336
    s_waitcnt lgkmcnt(10)
    v_mfma_f32_16x16x32_bf16 v[48:51], a[8:11], v[64:67], v[48:51]
    ds_read_b64_tr_b16 v[88:89], v28 offset:12288
    ds_read_b64_tr_b16 v[90:91], v28 offset:14336
    s_waitcnt lgkmcnt(10)
    v_mfma_f32_16x16x32_bf16 v[52:55], a[8:11], v[68:71], v[52:55]
    s_barrier
    s_add_u32 s3, s70, 5
    s_sub_u32 s6, s3, 14
    s_cmp_ge_u32 s3, 14
    s_cselect_b32 s3, s6, s3
    s_lshl_b32 s3, s3, 12
    s_add_u32 s3, s3, s66
    buffer_load_dwordx4 a[80:83], v4, s[28:31], s3 offen offset:0 sc1
    buffer_load_dwordx4 a[84:87], v4, s[28:31], s3 offen offset:1024 sc1
    buffer_load_dwordx4 a[88:91], v4, s[28:31], s3 offen offset:2048 sc1
    buffer_load_dwordx4 a[92:95], v4, s[28:31], s3 offen offset:3072 sc1
    ds_read_b64_tr_b16 v[60:61], v25 offset:16384
    ds_read_b64_tr_b16 v[62:63], v25 offset:18432
    s_waitcnt lgkmcnt(10)
    v_mfma_f32_16x16x32_bf16 v[56:59], a[8:11], v[72:75], v[56:59]
    ds_read_b64_tr_b16 v[64:65], v26 offset:16384
    ds_read_b64_tr_b16 v[66:67], v26 offset:18432
    s_waitcnt vmcnt(20) lgkmcnt(10)
    v_mfma_f32_16x16x32_bf16 v[44:47], a[12:15], v[76:79], v[44:47]
    ds_read_b64_tr_b16 v[68:69], v27 offset:16384
    ds_read_b64_tr_b16 v[70:71], v27 offset:18432
    s_waitcnt lgkmcnt(10)
    v_mfma_f32_16x16x32_bf16 v[48:51], a[12:15], v[80:83], v[48:51]
    ds_read_b64_tr_b16 v[72:73], v28 offset:16384
    ds_read_b64_tr_b16 v[74:75], v28 offset:18432
    s_waitcnt lgkmcnt(10)
    v_mfma_f32_16x16x32_bf16 v[52:55], a[12:15], v[84:87], v[52:55]
    ds_read_b64_tr_b16 v[76:77], v25 offset:20480
    ds_read_b64_tr_b16 v[78:79], v25 offset:22528
    s_waitcnt lgkmcnt(10)
    v_mfma_f32_16x16x32_bf16 v[56:59], a[12:15], v[88:91], v[56:59]
    ds_read_b64_tr_b16 v[80:81], v26 offset:20480
    ds_read_b64_tr_b16 v[82:83], v26 offset:22528
    s_waitcnt vmcnt(19) lgkmcnt(10)
    v_mfma_f32_16x16x32_bf16 v[44:47], a[16:19], v[60:63], v[44:47]
    ds_read_b64_tr_b16 v[84:85], v27 offset:20480
    ds_read_b64_tr_b16 v[86:87], v27 offset:22528
    s_waitcnt lgkmcnt(10)
    v_mfma_f32_16x16x32_bf16 v[48:51], a[16:19], v[64:67], v[48:51]
    ds_read_b64_tr_b16 v[88:89], v28 offset:20480
    ds_read_b64_tr_b16 v[90:91], v28 offset:22528
    s_waitcnt lgkmcnt(10)
    v_mfma_f32_16x16x32_bf16 v[52:55], a[16:19], v[68:71], v[52:55]
    ds_read_b64_tr_b16 v[60:61], v25 offset:24576
    ds_read_b64_tr_b16 v[62:63], v25 offset:26624
    s_waitcnt lgkmcnt(10)
    v_mfma_f32_16x16x32_bf16 v[56:59], a[16:19], v[72:75], v[56:59]
    ds_read_b64_tr_b16 v[64:65], v26 offset:24576
    ds_read_b64_tr_b16 v[66:67], v26 offset:26624
    s_waitcnt vmcnt(18) lgkmcnt(10)
    v_mfma_f32_16x16x32_bf16 v[44:47], a[20:23], v[76:79], v[44:47]
    ds_read_b64_tr_b16 v[68:69], v27 offset:24576
    ds_read_b64_tr_b16 v[70:71], v27 offset:26624
    s_waitcnt lgkmcnt(10)
    v_mfma_f32_16x16x32_bf16 v[48:51], a[20:23], v[80:83], v[48:51]
    ds_read_b64_tr_b16 v[72:73], v28 offset:24576
    ds_read_b64_tr_b16 v[74:75], v28 offset:26624
    s_waitcnt lgkmcnt(10)
    v_mfma_f32_16x16x32_bf16 v[52:55], a[20:23], v[84:87], v[52:55]
    ds_read_b64_tr_b16 v[76:77], v25 offset:28672
    ds_read_b64_tr_b16 v[78:79], v25 offset:30720
    s_waitcnt lgkmcnt(10)
    v_mfma_f32_16x16x32_bf16 v[56:59], a[20:23], v[88:91], v[56:59]
    ds_read_b64_tr_b16 v[80:81], v26 offset:28672
    ds_read_b64_tr_b16 v[82:83], v26 offset:30720
    s_waitcnt vmcnt(17) lgkmcnt(10)
    v_mfma_f32_16x16x32_bf16 v[44:47], a[24:27], v[60:63], v[44:47]
    ds_read_b64_tr_b16 v[84:85], v27 offset:28672
    ds_read_b64_tr_b16 v[86:87], v27 offset:30720
    s_waitcnt lgkmcnt(10)
    v_mfma_f32_16x16x32_bf16 v[48:51], a[24:27], v[64:67], v[48:51]
    ds_read_b64_tr_b16 v[88:89], v28 offset:28672
    ds_read_b64_tr_b16 v[90:91], v28 offset:30720
    s_waitcnt lgkmcnt(10)
    v_mfma_f32_16x16x32_bf16 v[52:55], a[24:27], v[68:71], v[52:55]
    s_barrier
    s_add_u32 s3, s70, 6
    s_sub_u32 s6, s3, 14
    s_cmp_ge_u32 s3, 14
    s_cselect_b32 s3, s6, s3
    s_lshl_b32 s3, s3, 12
    s_add_u32 s3, s3, s66
    buffer_load_dwordx4 a[96:99], v4, s[28:31], s3 offen offset:0 sc1
    buffer_load_dwordx4 a[100:103], v4, s[28:31], s3 offen offset:1024 sc1
    buffer_load_dwordx4 a[104:107], v4, s[28:31], s3 offen offset:2048 sc1
    buffer_load_dwordx4 a[108:111], v4, s[28:31], s3 offen offset:3072 sc1
    s_add_u32 s3, s70, 10
    s_sub_u32 s6, s3, 14
    s_cmp_ge_u32 s3, 14
    s_cselect_b32 s3, s6, s3
    s_lshl_b32 s3, s3, 19
    s_add_u32 s3, s3, s65
    s_add_u32 m0, s58, 65536
    s_nop 0
    buffer_load_dwordx4 v92, s[24:27], s3 offen lds
    buffer_load_dwordx4 v93, s[24:27], s3 offen offset:1024 lds
    buffer_load_dwordx4 v94, s[24:27], s3 offen offset:2048 lds
    buffer_load_dwordx4 v95, s[24:27], s3 offen offset:3072 lds
    ds_read_b64_tr_b16 v[60:61], v25 offset:32768
    ds_read_b64_tr_b16 v[62:63], v25 offset:34816
    s_waitcnt lgkmcnt(10)
    v_mfma_f32_16x16x32_bf16 v[56:59], a[24:27], v[72:75], v[56:59]
    ds_read_b64_tr_b16 v[64:65], v26 offset:32768
    ds_read_b64_tr_b16 v[66:67], v26 offset:34816
    s_waitcnt vmcnt(24) lgkmcnt(10)
    v_mfma_f32_16x16x32_bf16 v[44:47], a[28:31], v[76:79], v[44:47]
    ds_read_b64_tr_b16 v[68:69], v27 offset:32768
    ds_read_b64_tr_b16 v[70:71], v27 offset:34816
    s_waitcnt lgkmcnt(10)
    v_mfma_f32_16x16x32_bf16 v[48:51], a[28:31], v[80:83], v[48:51]
    ds_read_b64_tr_b16 v[72:73], v28 offset:32768
    ds_read_b64_tr_b16 v[74:75], v28 offset:34816
    s_waitcnt lgkmcnt(10)
    v_mfma_f32_16x16x32_bf16 v[52:55], a[28:31], v[84:87], v[52:55]
    ds_read_b64_tr_b16 v[76:77], v25 offset:36864
    ds_read_b64_tr_b16 v[78:79], v25 offset:38912
    s_waitcnt lgkmcnt(10)
    v_mfma_f32_16x16x32_bf16 v[56:59], a[28:31], v[88:91], v[56:59]
    ds_read_b64_tr_b16 v[80:81], v26 offset:36864
    ds_read_b64_tr_b16 v[82:83], v26 offset:38912
    s_waitcnt vmcnt(23) lgkmcnt(10)
    v_mfma_f32_16x16x32_bf16 v[44:47], a[32:35], v[60:63], v[44:47]
    ds_read_b64_tr_b16 v[84:85], v27 offset:36864
    ds_read_b64_tr_b16 v[86:87], v27 offset:38912
    s_waitcnt lgkmcnt(10)
    v_mfma_f32_16x16x32_bf16 v[48:51], a[32:35], v[64:67], v[48:51]
    ds_read_b64_tr_b16 v[88:89], v28 offset:36864
    ds_read_b64_tr_b16 v[90:91], v28 offset:38912
    s_waitcnt lgkmcnt(10)
    v_mfma_f32_16x16x32_bf16 v[52:55], a[32:35], v[68:71], v[52:55]
    ds_read_b64_tr_b16 v[60:61], v25 offset:40960
    ds_read_b64_tr_b16 v[62:63], v25 offset:43008
    s_waitcnt lgkmcnt(10)
    v_mfma_f32_16x16x32_bf16 v[56:59], a[32:35], v[72:75], v[56:59]
    ds_read_b64_tr_b16 v[64:65], v26 offset:40960
    ds_read_b64_tr_b16 v[66:67], v26 offset:43008
    s_waitcnt vmcnt(22) lgkmcnt(10)
    v_mfma_f32_16x16x32_bf16 v[44:47], a[36:39], v[76:79], v[44:47]
    ds_read_b64_tr_b16 v[68:69], v27 offset:40960
    ds_read_b64_tr_b16 v[70:71], v27 offset:43008
    s_waitcnt lgkmcnt(10)
    v_mfma_f32_16x16x32_bf16 v[48:51], a[36:39], v[80:83], v[48:51]
    ds_read_b64_tr_b16 v[72:73], v28 offset:40960
    ds_read_b64_tr_b16 v[74:75], v28 offset:43008
    s_waitcnt lgkmcnt(10)
    v_mfma_f32_16x16x32_bf16 v[52:55], a[36:39], v[84:87], v[52:55]
    ds_read_b64_tr_b16 v[76:77], v25 offset:45056
    ds_read_b64_tr_b16 v[78:79], v25 offset:47104
    s_waitcnt lgkmcnt(10)
    v_mfma_f32_16x16x32_bf16 v[56:59], a[36:39], v[88:91], v[56:59]
    ds_read_b64_tr_b16 v[80:81], v26 offset:45056
    ds_read_b64_tr_b16 v[82:83], v26 offset:47104
    s_waitcnt vmcnt(21) lgkmcnt(10)
    v_mfma_f32_16x16x32_bf16 v[44:47], a[40:43], v[60:63], v[44:47]
    ds_read_b64_tr_b16 v[84:85], v27 offset:45056
    ds_read_b64_tr_b16 v[86:87], v27 offset:47104
    s_waitcnt lgkmcnt(10)
    v_mfma_f32_16x16x32_bf16 v[48:51], a[40:43], v[64:67], v[48:51]
    ds_read_b64_tr_b16 v[88:89], v28 offset:45056
    ds_read_b64_tr_b16 v[90:91], v28 offset:47104
    s_waitcnt lgkmcnt(10)
    v_mfma_f32_16x16x32_bf16 v[52:55], a[40:43], v[68:71], v[52:55]
    s_barrier
    s_add_u32 s3, s70, 7
    s_sub_u32 s6, s3, 14
    s_cmp_ge_u32 s3, 14
    s_cselect_b32 s3, s6, s3
    s_lshl_b32 s3, s3, 12
    s_add_u32 s3, s3, s66
    buffer_load_dwordx4 a[112:115], v4, s[28:31], s3 offen offset:0 sc1
    buffer_load_dwordx4 a[116:119], v4, s[28:31], s3 offen offset:1024 sc1
    buffer_load_dwordx4 a[120:123], v4, s[28:31], s3 offen offset:2048 sc1
    buffer_load_dwordx4 a[124:127], v4, s[28:31], s3 offen offset:3072 sc1
    s_add_u32 s3, s70, 11
    s_sub_u32 s6, s3, 14
    s_cmp_ge_u32 s3, 14
    s_cselect_b32 s3, s6, s3
    s_lshl_b32 s3, s3, 19
    s_add_u32 s3, s3, s65
    s_add_u32 m0, s58, 81920
    s_nop 0
    buffer_load_dwordx4 v92, s[24:27], s3 offen lds
    buffer_load_dwordx4 v93, s[24:27], s3 offen offset:1024 lds
    buffer_load_dwordx4 v94, s[24:27], s3 offen offset:2048 lds
    buffer_load_dwordx4 v95, s[24:27], s3 offen offset:3072 lds
    ds_read_b64_tr_b16 v[60:61], v25 offset:49152
    ds_read_b64_tr_b16 v[62:63], v25 offset:51200
    s_waitcnt lgkmcnt(10)
    v_mfma_f32_16x16x32_bf16 v[56:59], a[40:43], v[72:75], v[56:59]
    ds_read_b64_tr_b16 v[64:65], v26 offset:49152
    ds_read_b64_tr_b16 v[66:67], v26 offset:51200
    s_waitcnt vmcnt(28) lgkmcnt(10)
    v_mfma_f32_16x16x32_bf16 v[44:47], a[44:47], v[76:79], v[44:47]
    ds_read_b64_tr_b16 v[68:69], v27 offset:49152
    ds_read_b64_tr_b16 v[70:71], v27 offset:51200
    s_waitcnt lgkmcnt(10)
    v_mfma_f32_16x16x32_bf16 v[48:51], a[44:47], v[80:83], v[48:51]
    ds_read_b64_tr_b16 v[72:73], v28 offset:49152
    ds_read_b64_tr_b16 v[74:75], v28 offset:51200
    s_waitcnt lgkmcnt(10)
    v_mfma_f32_16x16x32_bf16 v[52:55], a[44:47], v[84:87], v[52:55]
    ds_read_b64_tr_b16 v[76:77], v25 offset:53248
    ds_read_b64_tr_b16 v[78:79], v25 offset:55296
    s_waitcnt lgkmcnt(10)
    v_mfma_f32_16x16x32_bf16 v[56:59], a[44:47], v[88:91], v[56:59]
    ds_read_b64_tr_b16 v[80:81], v26 offset:53248
    ds_read_b64_tr_b16 v[82:83], v26 offset:55296
    s_waitcnt vmcnt(27) lgkmcnt(10)
    v_mfma_f32_16x16x32_bf16 v[44:47], a[48:51], v[60:63], v[44:47]
    ds_read_b64_tr_b16 v[84:85], v27 offset:53248
    ds_read_b64_tr_b16 v[86:87], v27 offset:55296
    s_waitcnt lgkmcnt(10)
    v_mfma_f32_16x16x32_bf16 v[48:51], a[48:51], v[64:67], v[48:51]
    ds_read_b64_tr_b16 v[88:89], v28 offset:53248
    ds_read_b64_tr_b16 v[90:91], v28 offset:55296
    s_waitcnt lgkmcnt(10)
    v_mfma_f32_16x16x32_bf16 v[52:55], a[48:51], v[68:71], v[52:55]
    ds_read_b64_tr_b16 v[60:61], v25 offset:57344
    ds_read_b64_tr_b16 v[62:63], v25 offset:59392
    s_waitcnt lgkmcnt(10)
    v_mfma_f32_16x16x32_bf16 v[56:59], a[48:51], v[72:75], v[56:59]
    ds_read_b64_tr_b16 v[64:65], v26 offset:57344
    ds_read_b64_tr_b16 v[66:67], v26 offset:59392
    s_waitcnt vmcnt(26) lgkmcnt(10)
    v_mfma_f32_16x16x32_bf16 v[44:47], a[52:55], v[76:79], v[44:47]
    ds_read_b64_tr_b16 v[68:69], v27 offset:57344
    ds_read_b64_tr_b16 v[70:71], v27 offset:59392
    s_waitcnt lgkmcnt(10)
    v_mfma_f32_16x16x32_bf16 v[48:51], a[52:55], v[80:83], v[48:51]
    ds_read_b64_tr_b16 v[72:73], v28 offset:57344
    ds_read_b64_tr_b16 v[74:75], v28 offset:59392
    s_waitcnt lgkmcnt(10)
    v_mfma_f32_16x16x32_bf16 v[52:55], a[52:55], v[84:87], v[52:55]
    ds_read_b64_tr_b16 v[76:77], v25 offset:61440
    ds_read_b64_tr_b16 v[78:79], v25 offset:63488
    s_waitcnt lgkmcnt(10)
    v_mfma_f32_16x16x32_bf16 v[56:59], a[52:55], v[88:91], v[56:59]
    ds_read_b64_tr_b16 v[80:81], v26 offset:61440
    ds_read_b64_tr_b16 v[82:83], v26 offset:63488
    s_waitcnt vmcnt(25) lgkmcnt(10)
    v_mfma_f32_16x16x32_bf16 v[44:47], a[56:59], v[60:63], v[44:47]
    ds_read_b64_tr_b16 v[84:85], v27 offset:61440
    ds_read_b64_tr_b16 v[86:87], v27 offset:63488
    s_waitcnt lgkmcnt(10)
    v_mfma_f32_16x16x32_bf16 v[48:51], a[56:59], v[64:67], v[48:51]
    ds_read_b64_tr_b16 v[88:89], v28 offset:61440
    ds_read_b64_tr_b16 v[90:91], v28 offset:63488
    s_waitcnt lgkmcnt(10)
    v_mfma_f32_16x16x32_bf16 v[52:55], a[56:59], v[68:71], v[52:55]
    s_barrier
    s_add_u32 s3, s70, 8
    s_sub_u32 s6, s3, 14
    s_cmp_ge_u32 s3, 14
    s_cselect_b32 s3, s6, s3
    s_lshl_b32 s3, s3, 12
    s_add_u32 s3, s3, s66
    buffer_load_dwordx4 a[128:131], v4, s[28:31], s3 offen offset:0 sc1
    buffer_load_dwordx4 a[132:135], v4, s[28:31], s3 offen offset:1024 sc1
    buffer_load_dwordx4 a[136:139], v4, s[28:31], s3 offen offset:2048 sc1
    buffer_load_dwordx4 a[140:143], v4, s[28:31], s3 offen offset:3072 sc1
    s_add_u32 s3, s70, 12
    s_sub_u32 s6, s3, 14
    s_cmp_ge_u32 s3, 14
    s_cselect_b32 s3, s6, s3
    s_lshl_b32 s3, s3, 19
    s_add_u32 s3, s3, s65
    s_add_u32 m0, s58, 98304
    s_nop 0
    buffer_load_dwordx4 v92, s[24:27], s3 offen lds
    buffer_load_dwordx4 v93, s[24:27], s3 offen offset:1024 lds
    buffer_load_dwordx4 v94, s[24:27], s3 offen offset:2048 lds
    buffer_load_dwordx4 v95, s[24:27], s3 offen offset:3072 lds
    ds_read_b64_tr_b16 v[60:61], v29 offset:0
    ds_read_b64_tr_b16 v[62:63], v29 offset:2048
    s_waitcnt lgkmcnt(10)
    v_mfma_f32_16x16x32_bf16 v[56:59], a[56:59], v[72:75], v[56:59]
    ds_read_b64_tr_b16 v[64:65], v30 offset:0
    ds_read_b64_tr_b16 v[66:67], v30 offset:2048
    s_waitcnt vmcnt(32) lgkmcnt(10)
    v_mfma_f32_16x16x32_bf16 v[44:47], a[60:63], v[76:79], v[44:47]
    ds_read_b64_tr_b16 v[68:69], v31 offset:0
    ds_read_b64_tr_b16 v[70:71], v31 offset:2048
    s_waitcnt lgkmcnt(10)
    v_mfma_f32_16x16x32_bf16 v[48:51], a[60:63], v[80:83], v[48:51]
    ds_read_b64_tr_b16 v[72:73], v32 offset:0
    ds_read_b64_tr_b16 v[74:75], v32 offset:2048
    s_waitcnt lgkmcnt(10)
    v_mfma_f32_16x16x32_bf16 v[52:55], a[60:63], v[84:87], v[52:55]
    ds_read_b64_tr_b16 v[76:77], v29 offset:4096
    ds_read_b64_tr_b16 v[78:79], v29 offset:6144
    s_waitcnt lgkmcnt(10)
    v_mfma_f32_16x16x32_bf16 v[56:59], a[60:63], v[88:91], v[56:59]
    ds_read_b64_tr_b16 v[80:81], v30 offset:4096
    ds_read_b64_tr_b16 v[82:83], v30 offset:6144
    s_waitcnt vmcnt(31) lgkmcnt(10)
    v_mfma_f32_16x16x32_bf16 v[44:47], a[64:67], v[60:63], v[44:47]
    ds_read_b64_tr_b16 v[84:85], v31 offset:4096
    ds_read_b64_tr_b16 v[86:87], v31 offset:6144
    s_waitcnt lgkmcnt(10)
    v_mfma_f32_16x16x32_bf16 v[48:51], a[64:67], v[64:67], v[48:51]
    ds_read_b64_tr_b16 v[88:89], v32 offset:4096
    ds_read_b64_tr_b16 v[90:91], v32 offset:6144
    s_waitcnt lgkmcnt(10)
    v_mfma_f32_16x16x32_bf16 v[52:55], a[64:67], v[68:71], v[52:55]
    ds_read_b64_tr_b16 v[60:61], v29 offset:8192
    ds_read_b64_tr_b16 v[62:63], v29 offset:10240
    s_waitcnt lgkmcnt(10)
    v_mfma_f32_16x16x32_bf16 v[56:59], a[64:67], v[72:75], v[56:59]
    ds_read_b64_tr_b16 v[64:65], v30 offset:8192
    ds_read_b64_tr_b16 v[66:67], v30 offset:10240
    s_waitcnt vmcnt(30) lgkmcnt(10)
    v_mfma_f32_16x16x32_bf16 v[44:47], a[68:71], v[76:79], v[44:47]
    ds_read_b64_tr_b16 v[68:69], v31 offset:8192
    ds_read_b64_tr_b16 v[70:71], v31 offset:10240
    s_waitcnt lgkmcnt(10)
    v_mfma_f32_16x16x32_bf16 v[48:51], a[68:71], v[80:83], v[48:51]
    ds_read_b64_tr_b16 v[72:73], v32 offset:8192
    ds_read_b64_tr_b16 v[74:75], v32 offset:10240
    s_waitcnt lgkmcnt(10)
    v_mfma_f32_16x16x32_bf16 v[52:55], a[68:71], v[84:87], v[52:55]
    ds_read_b64_tr_b16 v[76:77], v29 offset:12288
    ds_read_b64_tr_b16 v[78:79], v29 offset:14336
    s_waitcnt lgkmcnt(10)
    v_mfma_f32_16x16x32_bf16 v[56:59], a[68:71], v[88:91], v[56:59]
    ds_read_b64_tr_b16 v[80:81], v30 offset:12288
    ds_read_b64_tr_b16 v[82:83], v30 offset:14336
    s_waitcnt vmcnt(29) lgkmcnt(10)
    v_mfma_f32_16x16x32_bf16 v[44:47], a[72:75], v[60:63], v[44:47]
    ds_read_b64_tr_b16 v[84:85], v31 offset:12288
    ds_read_b64_tr_b16 v[86:87], v31 offset:14336
    s_waitcnt lgkmcnt(10)
    v_mfma_f32_16x16x32_bf16 v[48:51], a[72:75], v[64:67], v[48:51]
    ds_read_b64_tr_b16 v[88:89], v32 offset:12288
    ds_read_b64_tr_b16 v[90:91], v32 offset:14336
    s_waitcnt lgkmcnt(10)
    v_mfma_f32_16x16x32_bf16 v[52:55], a[72:75], v[68:71], v[52:55]
    s_barrier
    s_add_u32 s3, s70, 9
    s_sub_u32 s6, s3, 14
    s_cmp_ge_u32 s3, 14
    s_cselect_b32 s3, s6, s3
    s_lshl_b32 s3, s3, 12
    s_add_u32 s3, s3, s66
    buffer_load_dwordx4 a[144:147], v4, s[28:31], s3 offen offset:0 sc1
    buffer_load_dwordx4 a[148:151], v4, s[28:31], s3 offen offset:1024 sc1
    buffer_load_dwordx4 a[152:155], v4, s[28:31], s3 offen offset:2048 sc1
    buffer_load_dwordx4 a[156:159], v4, s[28:31], s3 offen offset:3072 sc1
    s_add_u32 s3, s70, 13
    s_sub_u32 s6, s3, 14
    s_cmp_ge_u32 s3, 14
    s_cselect_b32 s3, s6, s3
    s_lshl_b32 s3, s3, 19
    s_add_u32 s3, s3, s65
    s_add_u32 m0, s58, 114688
    s_nop 0
    buffer_load_dwordx4 v92, s[24:27], s3 offen lds
    buffer_load_dwordx4 v93, s[24:27], s3 offen offset:1024 lds
    buffer_load_dwordx4 v94, s[24:27], s3 offen offset:2048 lds
    buffer_load_dwordx4 v95, s[24:27], s3 offen offset:3072 lds
    ds_read_b64_tr_b16 v[60:61], v29 offset:16384
    ds_read_b64_tr_b16 v[62:63], v29 offset:18432
    s_waitcnt lgkmcnt(10)
    v_mfma_f32_16x16x32_bf16 v[56:59], a[72:75], v[72:75], v[56:59]
    ds_read_b64_tr_b16 v[64:65], v30 offset:16384
    ds_read_b64_tr_b16 v[66:67], v30 offset:18432
    s_waitcnt vmcnt(36) lgkmcnt(10)
    v_mfma_f32_16x16x32_bf16 v[44:47], a[76:79], v[76:79], v[44:47]
    ds_read_b64_tr_b16 v[68:69], v31 offset:16384
    ds_read_b64_tr_b16 v[70:71], v31 offset:18432
    s_waitcnt lgkmcnt(10)
    v_mfma_f32_16x16x32_bf16 v[48:51], a[76:79], v[80:83], v[48:51]
    ds_read_b64_tr_b16 v[72:73], v32 offset:16384
    ds_read_b64_tr_b16 v[74:75], v32 offset:18432
    s_waitcnt lgkmcnt(10)
    v_mfma_f32_16x16x32_bf16 v[52:55], a[76:79], v[84:87], v[52:55]
    ds_read_b64_tr_b16 v[76:77], v29 offset:20480
    ds_read_b64_tr_b16 v[78:79], v29 offset:22528
    s_waitcnt lgkmcnt(10)
    v_mfma_f32_16x16x32_bf16 v[56:59], a[76:79], v[88:91], v[56:59]
    ds_read_b64_tr_b16 v[80:81], v30 offset:20480
    ds_read_b64_tr_b16 v[82:83], v30 offset:22528
    s_waitcnt vmcnt(35) lgkmcnt(10)
    v_mfma_f32_16x16x32_bf16 v[44:47], a[80:83], v[60:63], v[44:47]
    ds_read_b64_tr_b16 v[84:85], v31 offset:20480
    ds_read_b64_tr_b16 v[86:87], v31 offset:22528
    s_waitcnt lgkmcnt(10)
    v_mfma_f32_16x16x32_bf16 v[48:51], a[80:83], v[64:67], v[48:51]
    ds_read_b64_tr_b16 v[88:89], v32 offset:20480
    ds_read_b64_tr_b16 v[90:91], v32 offset:22528
    s_waitcnt lgkmcnt(10)
    v_mfma_f32_16x16x32_bf16 v[52:55], a[80:83], v[68:71], v[52:55]
    ds_read_b64_tr_b16 v[60:61], v29 offset:24576
    ds_read_b64_tr_b16 v[62:63], v29 offset:26624
    s_waitcnt lgkmcnt(10)
    v_mfma_f32_16x16x32_bf16 v[56:59], a[80:83], v[72:75], v[56:59]
    ds_read_b64_tr_b16 v[64:65], v30 offset:24576
    ds_read_b64_tr_b16 v[66:67], v30 offset:26624
    s_waitcnt vmcnt(34) lgkmcnt(10)
    v_mfma_f32_16x16x32_bf16 v[44:47], a[84:87], v[76:79], v[44:47]
    ds_read_b64_tr_b16 v[68:69], v31 offset:24576
    ds_read_b64_tr_b16 v[70:71], v31 offset:26624
    s_waitcnt lgkmcnt(10)
    v_mfma_f32_16x16x32_bf16 v[48:51], a[84:87], v[80:83], v[48:51]
    ds_read_b64_tr_b16 v[72:73], v32 offset:24576
    ds_read_b64_tr_b16 v[74:75], v32 offset:26624
    s_waitcnt lgkmcnt(10)
    v_mfma_f32_16x16x32_bf16 v[52:55], a[84:87], v[84:87], v[52:55]
    ds_read_b64_tr_b16 v[76:77], v29 offset:28672
    ds_read_b64_tr_b16 v[78:79], v29 offset:30720
    s_waitcnt lgkmcnt(10)
    v_mfma_f32_16x16x32_bf16 v[56:59], a[84:87], v[88:91], v[56:59]
    ds_read_b64_tr_b16 v[80:81], v30 offset:28672
    ds_read_b64_tr_b16 v[82:83], v30 offset:30720
    s_waitcnt vmcnt(33) lgkmcnt(10)
    v_mfma_f32_16x16x32_bf16 v[44:47], a[88:91], v[60:63], v[44:47]
    ds_read_b64_tr_b16 v[84:85], v31 offset:28672
    ds_read_b64_tr_b16 v[86:87], v31 offset:30720
    s_waitcnt lgkmcnt(10)
    v_mfma_f32_16x16x32_bf16 v[48:51], a[88:91], v[64:67], v[48:51]
    ds_read_b64_tr_b16 v[88:89], v32 offset:28672
    ds_read_b64_tr_b16 v[90:91], v32 offset:30720
    s_waitcnt lgkmcnt(10)
    v_mfma_f32_16x16x32_bf16 v[52:55], a[88:91], v[68:71], v[52:55]
    s_barrier
    s_add_u32 s3, s70, 10
    s_sub_u32 s6, s3, 14
    s_cmp_ge_u32 s3, 14
    s_cselect_b32 s3, s6, s3
    s_lshl_b32 s3, s3, 12
    s_add_u32 s3, s3, s66
    buffer_load_dwordx4 a[160:163], v4, s[28:31], s3 offen offset:0 sc1
    buffer_load_dwordx4 a[164:167], v4, s[28:31], s3 offen offset:1024 sc1
    buffer_load_dwordx4 a[168:171], v4, s[28:31], s3 offen offset:2048 sc1
    buffer_load_dwordx4 a[172:175], v4, s[28:31], s3 offen offset:3072 sc1
    ds_read_b64_tr_b16 v[60:61], v21 offset:0
    ds_read_b64_tr_b16 v[62:63], v21 offset:2048
    s_waitcnt lgkmcnt(10)
    v_mfma_f32_16x16x32_bf16 v[56:59], a[88:91], v[72:75], v[56:59]
    ds_read_b64_tr_b16 v[64:65], v22 offset:0
    ds_read_b64_tr_b16 v[66:67], v22 offset:2048
    s_waitcnt vmcnt(36) lgkmcnt(10)
    v_mfma_f32_16x16x32_bf16 v[44:47], a[92:95], v[76:79], v[44:47]
    ds_read_b64_tr_b16 v[68:69], v23 offset:0
    ds_read_b64_tr_b16 v[70:71], v23 offset:2048
    s_waitcnt lgkmcnt(10)
    v_mfma_f32_16x16x32_bf16 v[48:51], a[92:95], v[80:83], v[48:51]
    ds_read_b64_tr_b16 v[72:73], v24 offset:0
    ds_read_b64_tr_b16 v[74:75], v24 offset:2048
    s_waitcnt lgkmcnt(10)
    v_mfma_f32_16x16x32_bf16 v[52:55], a[92:95], v[84:87], v[52:55]
    ds_read_b64_tr_b16 v[76:77], v21 offset:4096
    ds_read_b64_tr_b16 v[78:79], v21 offset:6144
    s_waitcnt lgkmcnt(10)
    v_mfma_f32_16x16x32_bf16 v[56:59], a[92:95], v[88:91], v[56:59]
    ds_read_b64_tr_b16 v[80:81], v22 offset:4096
    ds_read_b64_tr_b16 v[82:83], v22 offset:6144
    s_waitcnt vmcnt(35) lgkmcnt(10)
    v_mfma_f32_16x16x32_bf16 v[44:47], a[96:99], v[60:63], v[44:47]
    ds_read_b64_tr_b16 v[84:85], v23 offset:4096
    ds_read_b64_tr_b16 v[86:87], v23 offset:6144
    s_waitcnt lgkmcnt(10)
    v_mfma_f32_16x16x32_bf16 v[48:51], a[96:99], v[64:67], v[48:51]
    ds_read_b64_tr_b16 v[88:89], v24 offset:4096
    ds_read_b64_tr_b16 v[90:91], v24 offset:6144
    s_waitcnt lgkmcnt(10)
    v_mfma_f32_16x16x32_bf16 v[52:55], a[96:99], v[68:71], v[52:55]
    ds_read_b64_tr_b16 v[60:61], v21 offset:8192
    ds_read_b64_tr_b16 v[62:63], v21 offset:10240
    s_waitcnt lgkmcnt(10)
    v_mfma_f32_16x16x32_bf16 v[56:59], a[96:99], v[72:75], v[56:59]
    ds_read_b64_tr_b16 v[64:65], v22 offset:8192
    ds_read_b64_tr_b16 v[66:67], v22 offset:10240
    s_waitcnt vmcnt(34) lgkmcnt(10)
    v_mfma_f32_16x16x32_bf16 v[44:47], a[100:103], v[76:79], v[44:47]
    ds_read_b64_tr_b16 v[68:69], v23 offset:8192
    ds_read_b64_tr_b16 v[70:71], v23 offset:10240
    s_waitcnt lgkmcnt(10)
    v_mfma_f32_16x16x32_bf16 v[48:51], a[100:103], v[80:83], v[48:51]
    ds_read_b64_tr_b16 v[72:73], v24 offset:8192
    ds_read_b64_tr_b16 v[74:75], v24 offset:10240
    s_waitcnt lgkmcnt(10)
    v_mfma_f32_16x16x32_bf16 v[52:55], a[100:103], v[84:87], v[52:55]
    ds_read_b64_tr_b16 v[76:77], v21 offset:12288
    ds_read_b64_tr_b16 v[78:79], v21 offset:14336
    s_waitcnt lgkmcnt(10)
    v_mfma_f32_16x16x32_bf16 v[56:59], a[100:103], v[88:91], v[56:59]
    ds_read_b64_tr_b16 v[80:81], v22 offset:12288
    ds_read_b64_tr_b16 v[82:83], v22 offset:14336
    s_waitcnt vmcnt(33) lgkmcnt(10)
    v_mfma_f32_16x16x32_bf16 v[44:47], a[104:107], v[60:63], v[44:47]
    ds_read_b64_tr_b16 v[84:85], v23 offset:12288
    ds_read_b64_tr_b16 v[86:87], v23 offset:14336
    s_waitcnt lgkmcnt(10)
    v_mfma_f32_16x16x32_bf16 v[48:51], a[104:107], v[64:67], v[48:51]
    ds_read_b64_tr_b16 v[88:89], v24 offset:12288
    ds_read_b64_tr_b16 v[90:91], v24 offset:14336
    s_waitcnt lgkmcnt(10)
    v_mfma_f32_16x16x32_bf16 v[52:55], a[104:107], v[68:71], v[52:55]
    s_barrier
    s_add_u32 s3, s70, 11
    s_sub_u32 s6, s3, 14
    s_cmp_ge_u32 s3, 14
    s_cselect_b32 s3, s6, s3
    s_lshl_b32 s3, s3, 12
    s_add_u32 s3, s3, s66
    buffer_load_dwordx4 a[176:179], v4, s[28:31], s3 offen offset:0 sc1
    buffer_load_dwordx4 a[180:183], v4, s[28:31], s3 offen offset:1024 sc1
    buffer_load_dwordx4 a[184:187], v4, s[28:31], s3 offen offset:2048 sc1
    buffer_load_dwordx4 a[188:191], v4, s[28:31], s3 offen offset:3072 sc1
    ds_read_b64_tr_b16 v[60:61], v21 offset:16384
    ds_read_b64_tr_b16 v[62:63], v21 offset:18432
    s_waitcnt lgkmcnt(10)
    v_mfma_f32_16x16x32_bf16 v[56:59], a[104:107], v[72:75], v[56:59]
    ds_read_b64_tr_b16 v[64:65], v22 offset:16384
    ds_read_b64_tr_b16 v[66:67], v22 offset:18432
    s_waitcnt vmcnt(36) lgkmcnt(10)
    v_mfma_f32_16x16x32_bf16 v[44:47], a[108:111], v[76:79], v[44:47]
    ds_read_b64_tr_b16 v[68:69], v23 offset:16384
    ds_read_b64_tr_b16 v[70:71], v23 offset:18432
    s_waitcnt lgkmcnt(10)
    v_mfma_f32_16x16x32_bf16 v[48:51], a[108:111], v[80:83], v[48:51]
    ds_read_b64_tr_b16 v[72:73], v24 offset:16384
    ds_read_b64_tr_b16 v[74:75], v24 offset:18432
    s_waitcnt lgkmcnt(10)
    v_mfma_f32_16x16x32_bf16 v[52:55], a[108:111], v[84:87], v[52:55]
    ds_read_b64_tr_b16 v[76:77], v21 offset:20480
    ds_read_b64_tr_b16 v[78:79], v21 offset:22528
    s_waitcnt lgkmcnt(10)
    v_mfma_f32_16x16x32_bf16 v[56:59], a[108:111], v[88:91], v[56:59]
    ds_read_b64_tr_b16 v[80:81], v22 offset:20480
    ds_read_b64_tr_b16 v[82:83], v22 offset:22528
    s_waitcnt vmcnt(31) lgkmcnt(10)
    v_mfma_f32_16x16x32_bf16 v[44:47], a[112:115], v[60:63], v[44:47]
    ds_read_b64_tr_b16 v[84:85], v23 offset:20480
    ds_read_b64_tr_b16 v[86:87], v23 offset:22528
    s_waitcnt lgkmcnt(10)
    v_mfma_f32_16x16x32_bf16 v[48:51], a[112:115], v[64:67], v[48:51]
    ds_read_b64_tr_b16 v[88:89], v24 offset:20480
    ds_read_b64_tr_b16 v[90:91], v24 offset:22528
    s_waitcnt lgkmcnt(10)
    v_mfma_f32_16x16x32_bf16 v[52:55], a[112:115], v[68:71], v[52:55]
    ds_read_b64_tr_b16 v[60:61], v21 offset:24576
    ds_read_b64_tr_b16 v[62:63], v21 offset:26624
    s_waitcnt lgkmcnt(10)
    v_mfma_f32_16x16x32_bf16 v[56:59], a[112:115], v[72:75], v[56:59]
    ds_read_b64_tr_b16 v[64:65], v22 offset:24576
    ds_read_b64_tr_b16 v[66:67], v22 offset:26624
    s_waitcnt vmcnt(30) lgkmcnt(10)
    v_mfma_f32_16x16x32_bf16 v[44:47], a[116:119], v[76:79], v[44:47]
    ds_read_b64_tr_b16 v[68:69], v23 offset:24576
    ds_read_b64_tr_b16 v[70:71], v23 offset:26624
    s_waitcnt lgkmcnt(10)
    v_mfma_f32_16x16x32_bf16 v[48:51], a[116:119], v[80:83], v[48:51]
    ds_read_b64_tr_b16 v[72:73], v24 offset:24576
    ds_read_b64_tr_b16 v[74:75], v24 offset:26624
    s_waitcnt lgkmcnt(10)
    v_mfma_f32_16x16x32_bf16 v[52:55], a[116:119], v[84:87], v[52:55]
    ds_read_b64_tr_b16 v[76:77], v21 offset:28672
    ds_read_b64_tr_b16 v[78:79], v21 offset:30720
    s_waitcnt lgkmcnt(10)
    v_mfma_f32_16x16x32_bf16 v[56:59], a[116:119], v[88:91], v[56:59]
    ds_read_b64_tr_b16 v[80:81], v22 offset:28672
    ds_read_b64_tr_b16 v[82:83], v22 offset:30720
    s_waitcnt vmcnt(29) lgkmcnt(10)
    v_mfma_f32_16x16x32_bf16 v[44:47], a[120:123], v[60:63], v[44:47]
    ds_read_b64_tr_b16 v[84:85], v23 offset:28672
    ds_read_b64_tr_b16 v[86:87], v23 offset:30720
    s_waitcnt lgkmcnt(10)
    v_mfma_f32_16x16x32_bf16 v[48:51], a[120:123], v[64:67], v[48:51]
    ds_read_b64_tr_b16 v[88:89], v24 offset:28672
    ds_read_b64_tr_b16 v[90:91], v24 offset:30720
    s_waitcnt lgkmcnt(10)
    v_mfma_f32_16x16x32_bf16 v[52:55], a[120:123], v[68:71], v[52:55]
    s_barrier
    s_add_u32 s3, s70, 12
    s_sub_u32 s6, s3, 14
    s_cmp_ge_u32 s3, 14
    s_cselect_b32 s3, s6, s3
    s_lshl_b32 s3, s3, 12
    s_add_u32 s3, s3, s66
    buffer_load_dwordx4 a[192:195], v4, s[28:31], s3 offen offset:0 sc1
    buffer_load_dwordx4 a[196:199], v4, s[28:31], s3 offen offset:1024 sc1
    buffer_load_dwordx4 a[200:203], v4, s[28:31], s3 offen offset:2048 sc1
    buffer_load_dwordx4 a[204:207], v4, s[28:31], s3 offen offset:3072 sc1
    ds_read_b64_tr_b16 v[60:61], v21 offset:32768
    ds_read_b64_tr_b16 v[62:63], v21 offset:34816
    s_waitcnt lgkmcnt(10)
    v_mfma_f32_16x16x32_bf16 v[56:59], a[120:123], v[72:75], v[56:59]
    ds_read_b64_tr_b16 v[64:65], v22 offset:32768
    ds_read_b64_tr_b16 v[66:67], v22 offset:34816
    s_waitcnt vmcnt(32) lgkmcnt(10)
    v_mfma_f32_16x16x32_bf16 v[44:47], a[124:127], v[76:79], v[44:47]
    ds_read_b64_tr_b16 v[68:69], v23 offset:32768
    ds_read_b64_tr_b16 v[70:71], v23 offset:34816
    s_waitcnt lgkmcnt(10)
    v_mfma_f32_16x16x32_bf16 v[48:51], a[124:127], v[80:83], v[48:51]
    ds_read_b64_tr_b16 v[72:73], v24 offset:32768
    ds_read_b64_tr_b16 v[74:75], v24 offset:34816
    s_waitcnt lgkmcnt(10)
    v_mfma_f32_16x16x32_bf16 v[52:55], a[124:127], v[84:87], v[52:55]
    ds_read_b64_tr_b16 v[76:77], v21 offset:36864
    ds_read_b64_tr_b16 v[78:79], v21 offset:38912
    s_waitcnt lgkmcnt(10)
    v_mfma_f32_16x16x32_bf16 v[56:59], a[124:127], v[88:91], v[56:59]
    ds_read_b64_tr_b16 v[80:81], v22 offset:36864
    ds_read_b64_tr_b16 v[82:83], v22 offset:38912
    s_waitcnt vmcnt(27) lgkmcnt(10)
    v_mfma_f32_16x16x32_bf16 v[44:47], a[128:131], v[60:63], v[44:47]
    ds_read_b64_tr_b16 v[84:85], v23 offset:36864
    ds_read_b64_tr_b16 v[86:87], v23 offset:38912
    s_waitcnt lgkmcnt(10)
    v_mfma_f32_16x16x32_bf16 v[48:51], a[128:131], v[64:67], v[48:51]
    ds_read_b64_tr_b16 v[88:89], v24 offset:36864
    ds_read_b64_tr_b16 v[90:91], v24 offset:38912
    s_waitcnt lgkmcnt(10)
    v_mfma_f32_16x16x32_bf16 v[52:55], a[128:131], v[68:71], v[52:55]
    ds_read_b64_tr_b16 v[60:61], v21 offset:40960
    ds_read_b64_tr_b16 v[62:63], v21 offset:43008
    s_waitcnt lgkmcnt(10)
    v_mfma_f32_16x16x32_bf16 v[56:59], a[128:131], v[72:75], v[56:59]
    ds_read_b64_tr_b16 v[64:65], v22 offset:40960
    ds_read_b64_tr_b16 v[66:67], v22 offset:43008
    s_waitcnt vmcnt(26) lgkmcnt(10)
    v_mfma_f32_16x16x32_bf16 v[44:47], a[132:135], v[76:79], v[44:47]
    ds_read_b64_tr_b16 v[68:69], v23 offset:40960
    ds_read_b64_tr_b16 v[70:71], v23 offset:43008
    s_waitcnt lgkmcnt(10)
    v_mfma_f32_16x16x32_bf16 v[48:51], a[132:135], v[80:83], v[48:51]
    ds_read_b64_tr_b16 v[72:73], v24 offset:40960
    ds_read_b64_tr_b16 v[74:75], v24 offset:43008
    s_waitcnt lgkmcnt(10)
    v_mfma_f32_16x16x32_bf16 v[52:55], a[132:135], v[84:87], v[52:55]
    ds_read_b64_tr_b16 v[76:77], v21 offset:45056
    ds_read_b64_tr_b16 v[78:79], v21 offset:47104
    s_waitcnt lgkmcnt(10)
    v_mfma_f32_16x16x32_bf16 v[56:59], a[132:135], v[88:91], v[56:59]
    ds_read_b64_tr_b16 v[80:81], v22 offset:45056
    ds_read_b64_tr_b16 v[82:83], v22 offset:47104
    s_waitcnt vmcnt(25) lgkmcnt(10)
    v_mfma_f32_16x16x32_bf16 v[44:47], a[136:139], v[60:63], v[44:47]
    ds_read_b64_tr_b16 v[84:85], v23 offset:45056
    ds_read_b64_tr_b16 v[86:87], v23 offset:47104
    s_waitcnt lgkmcnt(10)
    v_mfma_f32_16x16x32_bf16 v[48:51], a[136:139], v[64:67], v[48:51]
    ds_read_b64_tr_b16 v[88:89], v24 offset:45056
    ds_read_b64_tr_b16 v[90:91], v24 offset:47104
    s_waitcnt lgkmcnt(10)
    v_mfma_f32_16x16x32_bf16 v[52:55], a[136:139], v[68:71], v[52:55]
    s_barrier
    s_add_u32 s3, s70, 13
    s_sub_u32 s6, s3, 14
    s_cmp_ge_u32 s3, 14
    s_cselect_b32 s3, s6, s3
    s_lshl_b32 s3, s3, 12
    s_add_u32 s3, s3, s66
    buffer_load_dwordx4 a[208:211], v4, s[28:31], s3 offen offset:0 sc1
    buffer_load_dwordx4 a[212:215], v4, s[28:31], s3 offen offset:1024 sc1
    buffer_load_dwordx4 a[216:219], v4, s[28:31], s3 offen offset:2048 sc1
    buffer_load_dwordx4 a[220:223], v4, s[28:31], s3 offen offset:3072 sc1
    ds_read_b64_tr_b16 v[60:61], v21 offset:49152
    ds_read_b64_tr_b16 v[62:63], v21 offset:51200
    s_waitcnt lgkmcnt(10)
    v_mfma_f32_16x16x32_bf16 v[56:59], a[136:139], v[72:75], v[56:59]
    ds_read_b64_tr_b16 v[64:65], v22 offset:49152
    ds_read_b64_tr_b16 v[66:67], v22 offset:51200
    s_waitcnt vmcnt(28) lgkmcnt(10)
    v_mfma_f32_16x16x32_bf16 v[44:47], a[140:143], v[76:79], v[44:47]
    ds_read_b64_tr_b16 v[68:69], v23 offset:49152
    ds_read_b64_tr_b16 v[70:71], v23 offset:51200
    s_waitcnt lgkmcnt(10)
    v_mfma_f32_16x16x32_bf16 v[48:51], a[140:143], v[80:83], v[48:51]
    ds_read_b64_tr_b16 v[72:73], v24 offset:49152
    ds_read_b64_tr_b16 v[74:75], v24 offset:51200
    s_waitcnt lgkmcnt(10)
    v_mfma_f32_16x16x32_bf16 v[52:55], a[140:143], v[84:87], v[52:55]
    ds_read_b64_tr_b16 v[76:77], v21 offset:53248
    ds_read_b64_tr_b16 v[78:79], v21 offset:55296
    s_waitcnt lgkmcnt(10)
    v_mfma_f32_16x16x32_bf16 v[56:59], a[140:143], v[88:91], v[56:59]
    ds_read_b64_tr_b16 v[80:81], v22 offset:53248
    ds_read_b64_tr_b16 v[82:83], v22 offset:55296
    s_waitcnt vmcnt(23) lgkmcnt(10)
    v_mfma_f32_16x16x32_bf16 v[44:47], a[144:147], v[60:63], v[44:47]
    ds_read_b64_tr_b16 v[84:85], v23 offset:53248
    ds_read_b64_tr_b16 v[86:87], v23 offset:55296
    s_waitcnt lgkmcnt(10)
    v_mfma_f32_16x16x32_bf16 v[48:51], a[144:147], v[64:67], v[48:51]
    ds_read_b64_tr_b16 v[88:89], v24 offset:53248
    ds_read_b64_tr_b16 v[90:91], v24 offset:55296
    s_waitcnt lgkmcnt(10)
    v_mfma_f32_16x16x32_bf16 v[52:55], a[144:147], v[68:71], v[52:55]
    ds_read_b64_tr_b16 v[60:61], v21 offset:57344
    ds_read_b64_tr_b16 v[62:63], v21 offset:59392
    s_waitcnt lgkmcnt(10)
    v_mfma_f32_16x16x32_bf16 v[56:59], a[144:147], v[72:75], v[56:59]
    ds_read_b64_tr_b16 v[64:65], v22 offset:57344
    ds_read_b64_tr_b16 v[66:67], v22 offset:59392
    s_waitcnt vmcnt(22) lgkmcnt(10)
    v_mfma_f32_16x16x32_bf16 v[44:47], a[148:151], v[76:79], v[44:47]
    ds_read_b64_tr_b16 v[68:69], v23 offset:57344
    ds_read_b64_tr_b16 v[70:71], v23 offset:59392
    s_waitcnt lgkmcnt(10)
    v_mfma_f32_16x16x32_bf16 v[48:51], a[148:151], v[80:83], v[48:51]
    ds_read_b64_tr_b16 v[72:73], v24 offset:57344
    ds_read_b64_tr_b16 v[74:75], v24 offset:59392
    s_waitcnt lgkmcnt(10)
    v_mfma_f32_16x16x32_bf16 v[52:55], a[148:151], v[84:87], v[52:55]
    ds_read_b64_tr_b16 v[76:77], v21 offset:61440
    ds_read_b64_tr_b16 v[78:79], v21 offset:63488
    s_waitcnt lgkmcnt(10)
    v_mfma_f32_16x16x32_bf16 v[56:59], a[148:151], v[88:91], v[56:59]
    ds_read_b64_tr_b16 v[80:81], v22 offset:61440
    ds_read_b64_tr_b16 v[82:83], v22 offset:63488
    s_waitcnt vmcnt(21) lgkmcnt(10)
    v_mfma_f32_16x16x32_bf16 v[44:47], a[152:155], v[60:63], v[44:47]
    ds_read_b64_tr_b16 v[84:85], v23 offset:61440
    ds_read_b64_tr_b16 v[86:87], v23 offset:63488
    s_waitcnt lgkmcnt(10)
    v_mfma_f32_16x16x32_bf16 v[48:51], a[152:155], v[64:67], v[48:51]
    ds_read_b64_tr_b16 v[88:89], v24 offset:61440
    ds_read_b64_tr_b16 v[90:91], v24 offset:63488
    s_waitcnt lgkmcnt(10)
    v_mfma_f32_16x16x32_bf16 v[52:55], a[152:155], v[68:71], v[52:55]
    s_barrier
    ds_read_b64_tr_b16 v[60:61], v25 offset:0
    ds_read_b64_tr_b16 v[62:63], v25 offset:2048
    s_waitcnt lgkmcnt(10)
    v_mfma_f32_16x16x32_bf16 v[56:59], a[152:155], v[72:75], v[56:59]
    ds_read_b64_tr_b16 v[64:65], v26 offset:0
    ds_read_b64_tr_b16 v[66:67], v26 offset:2048
    s_waitcnt vmcnt(20) lgkmcnt(10)
    v_mfma_f32_16x16x32_bf16 v[44:47], a[156:159], v[76:79], v[44:47]
    ds_read_b64_tr_b16 v[68:69], v27 offset:0
    ds_read_b64_tr_b16 v[70:71], v27 offset:2048
    s_waitcnt lgkmcnt(10)
    v_mfma_f32_16x16x32_bf16 v[48:51], a[156:159], v[80:83], v[48:51]
    ds_read_b64_tr_b16 v[72:73], v28 offset:0
    ds_read_b64_tr_b16 v[74:75], v28 offset:2048
    s_waitcnt lgkmcnt(10)
    v_mfma_f32_16x16x32_bf16 v[52:55], a[156:159], v[84:87], v[52:55]
    ds_read_b64_tr_b16 v[76:77], v25 offset:4096
    ds_read_b64_tr_b16 v[78:79], v25 offset:6144
    s_waitcnt lgkmcnt(10)
    v_mfma_f32_16x16x32_bf16 v[56:59], a[156:159], v[88:91], v[56:59]
    ds_read_b64_tr_b16 v[80:81], v26 offset:4096
    ds_read_b64_tr_b16 v[82:83], v26 offset:6144
    s_waitcnt vmcnt(15) lgkmcnt(10)
    v_mfma_f32_16x16x32_bf16 v[44:47], a[160:163], v[60:63], v[44:47]
    ds_read_b64_tr_b16 v[84:85], v27 offset:4096
    ds_read_b64_tr_b16 v[86:87], v27 offset:6144
    s_waitcnt lgkmcnt(10)
    v_mfma_f32_16x16x32_bf16 v[48:51], a[160:163], v[64:67], v[48:51]
    ds_read_b64_tr_b16 v[88:89], v28 offset:4096
    ds_read_b64_tr_b16 v[90:91], v28 offset:6144
    s_waitcnt lgkmcnt(10)
    v_mfma_f32_16x16x32_bf16 v[52:55], a[160:163], v[68:71], v[52:55]
    ds_read_b64_tr_b16 v[60:61], v25 offset:8192
    ds_read_b64_tr_b16 v[62:63], v25 offset:10240
    s_waitcnt lgkmcnt(10)
    v_mfma_f32_16x16x32_bf16 v[56:59], a[160:163], v[72:75], v[56:59]
    ds_read_b64_tr_b16 v[64:65], v26 offset:8192
    ds_read_b64_tr_b16 v[66:67], v26 offset:10240
    s_waitcnt vmcnt(14) lgkmcnt(10)
    v_mfma_f32_16x16x32_bf16 v[44:47], a[164:167], v[76:79], v[44:47]
    ds_read_b64_tr_b16 v[68:69], v27 offset:8192
    ds_read_b64_tr_b16 v[70:71], v27 offset:10240
    s_waitcnt lgkmcnt(10)
    v_mfma_f32_16x16x32_bf16 v[48:51], a[164:167], v[80:83], v[48:51]
    ds_read_b64_tr_b16 v[72:73], v28 offset:8192
    ds_read_b64_tr_b16 v[74:75], v28 offset:10240
    s_waitcnt lgkmcnt(10)
    v_mfma_f32_16x16x32_bf16 v[52:55], a[164:167], v[84:87], v[52:55]
    ds_read_b64_tr_b16 v[76:77], v25 offset:12288
    ds_read_b64_tr_b16 v[78:79], v25 offset:14336
    s_waitcnt lgkmcnt(10)
    v_mfma_f32_16x16x32_bf16 v[56:59], a[164:167], v[88:91], v[56:59]
    ds_read_b64_tr_b16 v[80:81], v26 offset:12288
    ds_read_b64_tr_b16 v[82:83], v26 offset:14336
    s_waitcnt vmcnt(13) lgkmcnt(10)
    v_mfma_f32_16x16x32_bf16 v[44:47], a[168:171], v[60:63], v[44:47]
    ds_read_b64_tr_b16 v[84:85], v27 offset:12288
    ds_read_b64_tr_b16 v[86:87], v27 offset:14336
    s_waitcnt lgkmcnt(10)
    v_mfma_f32_16x16x32_bf16 v[48:51], a[168:171], v[64:67], v[48:51]
    ds_read_b64_tr_b16 v[88:89], v28 offset:12288
    ds_read_b64_tr_b16 v[90:91], v28 offset:14336
    s_waitcnt lgkmcnt(10)
    v_mfma_f32_16x16x32_bf16 v[52:55], a[168:171], v[68:71], v[52:55]
    s_barrier
    ds_read_b64_tr_b16 v[60:61], v25 offset:16384
    ds_read_b64_tr_b16 v[62:63], v25 offset:18432
    s_waitcnt lgkmcnt(10)
    v_mfma_f32_16x16x32_bf16 v[56:59], a[168:171], v[72:75], v[56:59]
    ds_read_b64_tr_b16 v[64:65], v26 offset:16384
    ds_read_b64_tr_b16 v[66:67], v26 offset:18432
    s_waitcnt vmcnt(12) lgkmcnt(10)
    v_mfma_f32_16x16x32_bf16 v[44:47], a[172:175], v[76:79], v[44:47]
    ds_read_b64_tr_b16 v[68:69], v27 offset:16384
    ds_read_b64_tr_b16 v[70:71], v27 offset:18432
    s_waitcnt lgkmcnt(10)
    v_mfma_f32_16x16x32_bf16 v[48:51], a[172:175], v[80:83], v[48:51]
    ds_read_b64_tr_b16 v[72:73], v28 offset:16384
    ds_read_b64_tr_b16 v[74:75], v28 offset:18432
    s_waitcnt lgkmcnt(10)
    v_mfma_f32_16x16x32_bf16 v[52:55], a[172:175], v[84:87], v[52:55]
    ds_read_b64_tr_b16 v[76:77], v25 offset:20480
    ds_read_b64_tr_b16 v[78:79], v25 offset:22528
    s_waitcnt lgkmcnt(10)
    v_mfma_f32_16x16x32_bf16 v[56:59], a[172:175], v[88:91], v[56:59]
    ds_read_b64_tr_b16 v[80:81], v26 offset:20480
    ds_read_b64_tr_b16 v[82:83], v26 offset:22528
    s_waitcnt vmcnt(11) lgkmcnt(10)
    v_mfma_f32_16x16x32_bf16 v[44:47], a[176:179], v[60:63], v[44:47]
    ds_read_b64_tr_b16 v[84:85], v27 offset:20480
    ds_read_b64_tr_b16 v[86:87], v27 offset:22528
    s_waitcnt lgkmcnt(10)
    v_mfma_f32_16x16x32_bf16 v[48:51], a[176:179], v[64:67], v[48:51]
    ds_read_b64_tr_b16 v[88:89], v28 offset:20480
    ds_read_b64_tr_b16 v[90:91], v28 offset:22528
    s_waitcnt lgkmcnt(10)
    v_mfma_f32_16x16x32_bf16 v[52:55], a[176:179], v[68:71], v[52:55]
    ds_read_b64_tr_b16 v[60:61], v25 offset:24576
    ds_read_b64_tr_b16 v[62:63], v25 offset:26624
    s_waitcnt lgkmcnt(10)
    v_mfma_f32_16x16x32_bf16 v[56:59], a[176:179], v[72:75], v[56:59]
    ds_read_b64_tr_b16 v[64:65], v26 offset:24576
    ds_read_b64_tr_b16 v[66:67], v26 offset:26624
    s_waitcnt vmcnt(10) lgkmcnt(10)
    v_mfma_f32_16x16x32_bf16 v[44:47], a[180:183], v[76:79], v[44:47]
    ds_read_b64_tr_b16 v[68:69], v27 offset:24576
    ds_read_b64_tr_b16 v[70:71], v27 offset:26624
    s_waitcnt lgkmcnt(10)
    v_mfma_f32_16x16x32_bf16 v[48:51], a[180:183], v[80:83], v[48:51]
    ds_read_b64_tr_b16 v[72:73], v28 offset:24576
    ds_read_b64_tr_b16 v[74:75], v28 offset:26624
    s_waitcnt lgkmcnt(10)
    v_mfma_f32_16x16x32_bf16 v[52:55], a[180:183], v[84:87], v[52:55]
    ds_read_b64_tr_b16 v[76:77], v25 offset:28672
    ds_read_b64_tr_b16 v[78:79], v25 offset:30720
    s_waitcnt lgkmcnt(10)
    v_mfma_f32_16x16x32_bf16 v[56:59], a[180:183], v[88:91], v[56:59]
    ds_read_b64_tr_b16 v[80:81], v26 offset:28672
    ds_read_b64_tr_b16 v[82:83], v26 offset:30720
    s_waitcnt vmcnt(9) lgkmcnt(10)
    v_mfma_f32_16x16x32_bf16 v[44:47], a[184:187], v[60:63], v[44:47]
    ds_read_b64_tr_b16 v[84:85], v27 offset:28672
    ds_read_b64_tr_b16 v[86:87], v27 offset:30720
    s_waitcnt lgkmcnt(10)
    v_mfma_f32_16x16x32_bf16 v[48:51], a[184:187], v[64:67], v[48:51]
    ds_read_b64_tr_b16 v[88:89], v28 offset:28672
    ds_read_b64_tr_b16 v[90:91], v28 offset:30720
    s_waitcnt lgkmcnt(10)
    v_mfma_f32_16x16x32_bf16 v[52:55], a[184:187], v[68:71], v[52:55]
    s_barrier
    ds_read_b64_tr_b16 v[60:61], v25 offset:32768
    ds_read_b64_tr_b16 v[62:63], v25 offset:34816
    s_waitcnt lgkmcnt(10)
    v_mfma_f32_16x16x32_bf16 v[56:59], a[184:187], v[72:75], v[56:59]
    ds_read_b64_tr_b16 v[64:65], v26 offset:32768
    ds_read_b64_tr_b16 v[66:67], v26 offset:34816
    s_waitcnt vmcnt(8) lgkmcnt(10)
    v_mfma_f32_16x16x32_bf16 v[44:47], a[188:191], v[76:79], v[44:47]
    ds_read_b64_tr_b16 v[68:69], v27 offset:32768
    ds_read_b64_tr_b16 v[70:71], v27 offset:34816
    s_waitcnt lgkmcnt(10)
    v_mfma_f32_16x16x32_bf16 v[48:51], a[188:191], v[80:83], v[48:51]
    ds_read_b64_tr_b16 v[72:73], v28 offset:32768
    ds_read_b64_tr_b16 v[74:75], v28 offset:34816
    s_waitcnt lgkmcnt(10)
    v_mfma_f32_16x16x32_bf16 v[52:55], a[188:191], v[84:87], v[52:55]
    ds_read_b64_tr_b16 v[76:77], v25 offset:36864
    ds_read_b64_tr_b16 v[78:79], v25 offset:38912
    s_waitcnt lgkmcnt(10)
    v_mfma_f32_16x16x32_bf16 v[56:59], a[188:191], v[88:91], v[56:59]
    ds_read_b64_tr_b16 v[80:81], v26 offset:36864
    ds_read_b64_tr_b16 v[82:83], v26 offset:38912
    s_waitcnt vmcnt(7) lgkmcnt(10)
    v_mfma_f32_16x16x32_bf16 v[44:47], a[192:195], v[60:63], v[44:47]
    ds_read_b64_tr_b16 v[84:85], v27 offset:36864
    ds_read_b64_tr_b16 v[86:87], v27 offset:38912
    s_waitcnt lgkmcnt(10)
    v_mfma_f32_16x16x32_bf16 v[48:51], a[192:195], v[64:67], v[48:51]
    ds_read_b64_tr_b16 v[88:89], v28 offset:36864
    ds_read_b64_tr_b16 v[90:91], v28 offset:38912
    s_waitcnt lgkmcnt(10)
    v_mfma_f32_16x16x32_bf16 v[52:55], a[192:195], v[68:71], v[52:55]
    ds_read_b64_tr_b16 v[60:61], v25 offset:40960
    ds_read_b64_tr_b16 v[62:63], v25 offset:43008
    s_waitcnt lgkmcnt(10)
    v_mfma_f32_16x16x32_bf16 v[56:59], a[192:195], v[72:75], v[56:59]
    ds_read_b64_tr_b16 v[64:65], v26 offset:40960
    ds_read_b64_tr_b16 v[66:67], v26 offset:43008
    s_waitcnt vmcnt(6) lgkmcnt(10)
    v_mfma_f32_16x16x32_bf16 v[44:47], a[196:199], v[76:79], v[44:47]
    ds_read_b64_tr_b16 v[68:69], v27 offset:40960
    ds_read_b64_tr_b16 v[70:71], v27 offset:43008
    s_waitcnt lgkmcnt(10)
    v_mfma_f32_16x16x32_bf16 v[48:51], a[196:199], v[80:83], v[48:51]
    ds_read_b64_tr_b16 v[72:73], v28 offset:40960
    ds_read_b64_tr_b16 v[74:75], v28 offset:43008
    s_waitcnt lgkmcnt(10)
    v_mfma_f32_16x16x32_bf16 v[52:55], a[196:199], v[84:87], v[52:55]
    ds_read_b64_tr_b16 v[76:77], v25 offset:45056
    ds_read_b64_tr_b16 v[78:79], v25 offset:47104
    s_waitcnt lgkmcnt(10)
    v_mfma_f32_16x16x32_bf16 v[56:59], a[196:199], v[88:91], v[56:59]
    ds_read_b64_tr_b16 v[80:81], v26 offset:45056
    ds_read_b64_tr_b16 v[82:83], v26 offset:47104
    s_waitcnt vmcnt(5) lgkmcnt(10)
    v_mfma_f32_16x16x32_bf16 v[44:47], a[200:203], v[60:63], v[44:47]
    ds_read_b64_tr_b16 v[84:85], v27 offset:45056
    ds_read_b64_tr_b16 v[86:87], v27 offset:47104
    s_waitcnt lgkmcnt(10)
    v_mfma_f32_16x16x32_bf16 v[48:51], a[200:203], v[64:67], v[48:51]
    ds_read_b64_tr_b16 v[88:89], v28 offset:45056
    ds_read_b64_tr_b16 v[90:91], v28 offset:47104
    s_waitcnt lgkmcnt(10)
    v_mfma_f32_16x16x32_bf16 v[52:55], a[200:203], v[68:71], v[52:55]
    s_barrier
    ds_read_b64_tr_b16 v[60:61], v25 offset:49152
    ds_read_b64_tr_b16 v[62:63], v25 offset:51200
    s_waitcnt lgkmcnt(10)
    v_mfma_f32_16x16x32_bf16 v[56:59], a[200:203], v[72:75], v[56:59]
    ds_read_b64_tr_b16 v[64:65], v26 offset:49152
    ds_read_b64_tr_b16 v[66:67], v26 offset:51200
    s_waitcnt vmcnt(4) lgkmcnt(10)
    v_mfma_f32_16x16x32_bf16 v[44:47], a[204:207], v[76:79], v[44:47]
    ds_read_b64_tr_b16 v[68:69], v27 offset:49152
    ds_read_b64_tr_b16 v[70:71], v27 offset:51200
    s_waitcnt lgkmcnt(10)
    v_mfma_f32_16x16x32_bf16 v[48:51], a[204:207], v[80:83], v[48:51]
    ds_read_b64_tr_b16 v[72:73], v28 offset:49152
    ds_read_b64_tr_b16 v[74:75], v28 offset:51200
    s_waitcnt lgkmcnt(10)
    v_mfma_f32_16x16x32_bf16 v[52:55], a[204:207], v[84:87], v[52:55]
    ds_read_b64_tr_b16 v[76:77], v25 offset:53248
    ds_read_b64_tr_b16 v[78:79], v25 offset:55296
    s_waitcnt lgkmcnt(10)
    v_mfma_f32_16x16x32_bf16 v[56:59], a[204:207], v[88:91], v[56:59]
    ds_read_b64_tr_b16 v[80:81], v26 offset:53248
    ds_read_b64_tr_b16 v[82:83], v26 offset:55296
    s_waitcnt vmcnt(3) lgkmcnt(10)
    v_mfma_f32_16x16x32_bf16 v[44:47], a[208:211], v[60:63], v[44:47]
    ds_read_b64_tr_b16 v[84:85], v27 offset:53248
    ds_read_b64_tr_b16 v[86:87], v27 offset:55296
    s_waitcnt lgkmcnt(10)
    v_mfma_f32_16x16x32_bf16 v[48:51], a[208:211], v[64:67], v[48:51]
    ds_read_b64_tr_b16 v[88:89], v28 offset:53248
    ds_read_b64_tr_b16 v[90:91], v28 offset:55296
    s_waitcnt lgkmcnt(10)
    v_mfma_f32_16x16x32_bf16 v[52:55], a[208:211], v[68:71], v[52:55]
    ds_read_b64_tr_b16 v[60:61], v25 offset:57344
    ds_read_b64_tr_b16 v[62:63], v25 offset:59392
    s_waitcnt lgkmcnt(10)
    v_mfma_f32_16x16x32_bf16 v[56:59], a[208:211], v[72:75], v[56:59]
    ds_read_b64_tr_b16 v[64:65], v26 offset:57344
    ds_read_b64_tr_b16 v[66:67], v26 offset:59392
    s_waitcnt vmcnt(2) lgkmcnt(10)
    v_mfma_f32_16x16x32_bf16 v[44:47], a[212:215], v[76:79], v[44:47]
    ds_read_b64_tr_b16 v[68:69], v27 offset:57344
    ds_read_b64_tr_b16 v[70:71], v27 offset:59392
    s_waitcnt lgkmcnt(10)
    v_mfma_f32_16x16x32_bf16 v[48:51], a[212:215], v[80:83], v[48:51]
    ds_read_b64_tr_b16 v[72:73], v28 offset:57344
    ds_read_b64_tr_b16 v[74:75], v28 offset:59392
    s_waitcnt lgkmcnt(10)
    v_mfma_f32_16x16x32_bf16 v[52:55], a[212:215], v[84:87], v[52:55]
    ds_read_b64_tr_b16 v[76:77], v25 offset:61440
    ds_read_b64_tr_b16 v[78:79], v25 offset:63488
    s_waitcnt lgkmcnt(10)
    v_mfma_f32_16x16x32_bf16 v[56:59], a[212:215], v[88:91], v[56:59]
    ds_read_b64_tr_b16 v[80:81], v26 offset:61440
    ds_read_b64_tr_b16 v[82:83], v26 offset:63488
    s_waitcnt vmcnt(1) lgkmcnt(10)
    v_mfma_f32_16x16x32_bf16 v[44:47], a[216:219], v[60:63], v[44:47]
    ds_read_b64_tr_b16 v[84:85], v27 offset:61440
    ds_read_b64_tr_b16 v[86:87], v27 offset:63488
    s_waitcnt lgkmcnt(10)
    v_mfma_f32_16x16x32_bf16 v[48:51], a[216:219], v[64:67], v[48:51]
    ds_read_b64_tr_b16 v[88:89], v28 offset:61440
    ds_read_b64_tr_b16 v[90:91], v28 offset:63488
    s_waitcnt lgkmcnt(10)
    v_mfma_f32_16x16x32_bf16 v[52:55], a[216:219], v[68:71], v[52:55]
    s_waitcnt lgkmcnt(8)
    v_mfma_f32_16x16x32_bf16 v[56:59], a[216:219], v[72:75], v[56:59]
    s_waitcnt vmcnt(0) lgkmcnt(6)
    v_mfma_f32_16x16x32_bf16 v[44:47], a[220:223], v[76:79], v[44:47]
    s_waitcnt lgkmcnt(4)
    v_mfma_f32_16x16x32_bf16 v[48:51], a[220:223], v[80:83], v[48:51]
    s_waitcnt lgkmcnt(2)
    v_mfma_f32_16x16x32_bf16 v[52:55], a[220:223], v[84:87], v[52:55]
    s_waitcnt lgkmcnt(0)
    v_mfma_f32_16x16x32_bf16 v[56:59], a[220:223], v[88:91], v[56:59]
    s_lshl_b32 s3, s48, 2
    v_add_u32 v6, s3, v3
    v_xor_b32 v6, v6, v17
    v_lshlrev_b32 v6, 4, v6
    v_lshl_add_u32 v6, v2, 8, v6
    v_lshlrev_b32 v7, 1, v17
    v_xor_b32 v7, v7, v16
    v_lshlrev_b32 v7, 4, v7
    v_lshl_add_u32 v7, v16, 8, v7
    v_add_u32 v7, s58, v7
    v_xor_b32 v98, 16, v7
    ds_write_b128 v6, v[44:47] offset:0
    ds_write_b128 v6, v[48:51] offset:4096
    ds_write_b128 v6, v[52:55] offset:8192
    ds_write_b128 v6, v[56:59] offset:12288
    v_lshlrev_b32 v116, 16, v116
    v_lshlrev_b32 v60, 16, v108
    v_and_b32 v61, 0xffff0000, v108
    v_add_f32 v60, v60, v116
    v_add_f32 v61, v61, v116
    v_lshlrev_b32 v62, 16, v109
    v_and_b32 v63, 0xffff0000, v109
    v_add_f32 v62, v62, v116
    v_add_f32 v63, v63, v116
    v_lshlrev_b32 v64, 16, v110
    v_and_b32 v65, 0xffff0000, v110
    v_add_f32 v64, v64, v116
    v_add_f32 v65, v65, v116
    v_lshlrev_b32 v66, 16, v111
    v_and_b32 v67, 0xffff0000, v111
    v_add_f32 v66, v66, v116
    v_add_f32 v67, v67, v116
    v_lshlrev_b32 v117, 16, v117
    v_lshlrev_b32 v68, 16, v112
    v_and_b32 v69, 0xffff0000, v112
    v_add_f32 v68, v68, v117
    v_add_f32 v69, v69, v117
    v_lshlrev_b32 v70, 16, v113
    v_and_b32 v71, 0xffff0000, v113
    v_add_f32 v70, v70, v117
    v_add_f32 v71, v71, v117
    v_lshlrev_b32 v72, 16, v114
    v_and_b32 v73, 0xffff0000, v114
    v_add_f32 v72, v72, v117
    v_add_f32 v73, v73, v117
    v_lshlrev_b32 v74, 16, v115
    v_and_b32 v75, 0xffff0000, v115
    v_add_f32 v74, v74, v117
    v_add_f32 v75, v75, v117
    s_waitcnt lgkmcnt(0)
    s_barrier
    ds_read_b128 v[128:131], v7 offset:0
    ds_read_b128 v[132:135], v98 offset:0
    ds_read_b128 v[136:139], v7 offset:2048
    ds_read_b128 v[140:143], v98 offset:2048
    s_waitcnt lgkmcnt(3)
    v_add_f32 v128, v128, v60
    v_add_f32 v129, v129, v61
    v_add_f32 v130, v130, v62
    v_add_f32 v131, v131, v63
    v_cvt_pk_bf16_f32 v120, v128, v129
    v_cvt_pk_bf16_f32 v121, v130, v131
    s_waitcnt lgkmcnt(2)
    v_add_f32 v132, v132, v64
    v_add_f32 v133, v133, v65
    v_add_f32 v134, v134, v66
    v_add_f32 v135, v135, v67
    v_cvt_pk_bf16_f32 v122, v132, v133
    v_cvt_pk_bf16_f32 v123, v134, v135
    buffer_store_dwordx4 v[120:123], v118, s[32:35], s59 offen
    s_waitcnt lgkmcnt(1)
    v_add_f32 v136, v136, v68
    v_add_f32 v137, v137, v69
    v_add_f32 v138, v138, v70
    v_add_f32 v139, v139, v71
    v_cvt_pk_bf16_f32 v124, v136, v137
    v_cvt_pk_bf16_f32 v125, v138, v139
    s_waitcnt lgkmcnt(0)
    v_add_f32 v140, v140, v72
    v_add_f32 v141, v141, v73
    v_add_f32 v142, v142, v74
    v_add_f32 v143, v143, v75
    v_cvt_pk_bf16_f32 v126, v140, v141
    v_cvt_pk_bf16_f32 v127, v142, v143
    buffer_store_dwordx4 v[124:127], v118, s[32:35], s62 offen
L_fin:
L_end:
    s_endpgm
.section .rodata,"a"
.p2align 6
.amdhsa_kernel parallel_sum__sliding_local_dilated__mixer_token_mlp__prompt_kernel
  .amdhsa_next_free_vgpr 512
  .amdhsa_next_free_sgpr 102
  .amdhsa_accum_offset 256
  .amdhsa_group_segment_fixed_size 0
  .amdhsa_kernarg_size 88
  .amdhsa_user_sgpr_count 2
  .amdhsa_user_sgpr_kernarg_segment_ptr 1
  .amdhsa_system_sgpr_workgroup_id_x 1
.end_amdhsa_kernel
```

```asm
; @launch grid=(256,1,1) block=(256,1,1) lds=163840
.amdgcn_target "amdgcn-amd-amdhsa--gfx950"
.text
.globl parallel_sum__sliding_local_dilated__mixer_token_mlp__prompt_kernel
.p2align 8
.type parallel_sum__sliding_local_dilated__mixer_token_mlp__prompt_kernel,@function
parallel_sum__sliding_local_dilated__mixer_token_mlp__prompt_kernel:
    s_cmp_ge_u32 s2, 256
    s_cbranch_scc1 L_end
    s_load_dwordx2 s[8:9], s[0:1], 0
    s_load_dwordx2 s[12:13], s[0:1], 8
    s_load_dwordx2 s[28:29], s[0:1], 80
    s_load_dwordx2 s[44:45], s[0:1], 72
    s_load_dwordx2 s[20:21], s[0:1], 32
    s_load_dwordx2 s[16:17], s[0:1], 16
    s_load_dwordx2 s[24:25], s[0:1], 48
    s_load_dwordx2 s[32:33], s[0:1], 64
    s_load_dwordx2 s[36:37], s[0:1], 40
    s_load_dwordx2 s[40:41], s[0:1], 56
    s_memrealtime s[78:79]
    s_getpc_b64 s[4:5]
L_pc:
    s_and_b32 s3, s2, 0xf8
    v_lshrrev_b32 v8, 5, v0
    v_add_lshl_u32 v8, s3, v8, 7
    v_min_u32 v8, L_end-L_pc-4, v8
    global_load_dword v25, v8, s[4:5]
    v_lshrrev_b32 v8, 6, v0
    v_and_b32 v1, 63, v0
    v_readfirstlane_b32 s48, v8
    v_lshrrev_b32 v3, 4, v1
    v_lshrrev_b32 v5, 3, v1
    v_and_b32 v6, 7, v1
    v_xor_b32 v8, v6, v3
    v_lshlrev_b32 v8, 4, v8
    v_mul_u32_u24 v9, 896, v5
    v_add_u32 v38, v8, v9
    v_xor_b32 v8, 64, v8
    v_add_u32 v8, 7168, v8
    v_add_u32 v39, v8, v9
    s_mov_b32 s10, 1835008
    s_mov_b32 s11, 0x20000
    s_bfe_u32 s6, s2, 0x20001
    s_lshr_b32 s3, s2, 6
    s_lshl_b32 s49, s6, 2
    s_add_u32 s49, s49, s3
    s_lshl_b32 s59, s49, 2
    s_add_u32 s59, s59, s48
    s_mul_i32 s64, s59, 28672
    s_mul_i32 s67, s48, 14336
    s_add_u32 s65, s64, 14336
    s_waitcnt lgkmcnt(0)
    s_add_u32 m0, s67, 71680
    s_nop 0
    buffer_load_dwordx4 v38, s[8:11], s64 offen lds
    s_add_u32 m0, s67, 72704
    s_nop 0
    buffer_load_dwordx4 v39, s[8:11], s64 offen lds
    s_add_u32 m0, s67, 73600
    s_nop 0
    buffer_load_dwordx4 v38, s[8:11], s64 offen offset:128 lds
    s_add_u32 m0, s67, 74624
    s_nop 0
    buffer_load_dwordx4 v39, s[8:11], s64 offen offset:128 lds
    s_mov_b32 s46, 256
    s_mov_b32 s47, 0x20000
    s_lshl_b32 s3, s48, 8
    s_add_u32 s3, s3, s2
    s_cmp_lt_u32 s3, 8
    s_cselect_b32 s3, 0, 268435456
    s_or_b32 s78, s78, 1
    v_mov_b32 v36, s78
    v_mov_b32 v37, 0
    v_lshlrev_b32 v7, 24, v1
    buffer_atomic_cmpswap v[36:37], v7, s[44:47], s3 offen sc1
    v_and_b32 v2, 15, v0
    s_and_b32 s62, s2, 7
    s_lshr_b32 s63, s2, 3
    s_and_b32 s7, s2, 1
    s_lshl_b32 s50, s7, 3
    s_and_b32 s3, s63, 7
    s_add_u32 s50, s50, s3
    v_lshlrev_b32 v4, 4, v1
    s_add_u32 m0, s67, 75520
    s_nop 0
    buffer_load_dwordx4 v38, s[8:11], s64 offen offset:256 lds
    s_lshl_b32 s3, s49, 7
    s_max_u32 s3, s3, 16
    s_sub_u32 s3, s3, 16
    s_mul_i32 s66, s3, 896
    s_lshr_b32 s4, s48, 1
    s_and_b32 s5, s48, 1
    s_lshl_b32 s3, s4, 9
    s_add_u32 s66, s66, s3
    s_cmp_eq_u32 s5, 1
    s_cselect_b64 vcc, -1, 0
    v_cndmask_b32 v40, v38, v39, vcc
    s_lshl_b32 s68, s4, 13
    s_lshl_b32 s3, s5, 10
    s_add_u32 s68, s68, s3
    s_cmp_eq_u32 s4, 1
    s_cselect_b32 s69, 151936, s68
    v_bfe_u32 v42, v1, 2, 2
    s_add_u32 m0, s67, 76544
    s_nop 0
    buffer_load_dwordx4 v39, s[8:11], s64 offen offset:256 lds
    v_and_b32 v43, 3, v1
    v_and_b32 v8, 1, v3
    v_lshlrev_b32 v8, 1, v8
    v_xor_b32 v8, v8, v43
    v_lshlrev_b32 v8, 4, v8
    v_min_u32 v8, 40, v8
    v_lshl_add_u32 v9, v3, 3, v42
    v_mul_u32_u24 v9, 2688, v9
    v_add_u32 v41, v8, v9
    s_lshl_b32 s3, s4, 3
    s_add_u32 s3, s3, s5
    s_mul_i32 s100, s3, 10752
    s_mul_i32 s3, s50, 56
    s_add_u32 s100, s100, s3
    s_mul_i32 s101, s48, 7168
    s_lshl_b32 s58, s48, 12
    v_mov_b32 v44, 0x3f803f80
    s_add_u32 m0, s67, 77440
    s_nop 0
    buffer_load_dwordx4 v38, s[8:11], s64 offen offset:384 lds
    s_mov_b32 s14, 1204224
    s_mov_b32 s15, 0x20000
    v_mov_b32 v45, 0x3f803f80
    s_mov_b32 s18, 401408
    s_mov_b32 s19, 0x20000
    v_mov_b32 v46, 0x3f803f80
    s_mov_b32 s26, 7340032
    s_mov_b32 s27, 0x20000
    v_mov_b32 v47, 0x3f803f80
    s_mov_b32 s30, 8388608
    s_mov_b32 s31, 0x20000
    v_mov_b32 v48, 1.0
    s_mov_b32 s34, 1835008
    s_mov_b32 s35, 0x20000
    v_cmp_gt_u32 vcc, 16, v1
    s_mov_b32 s38, 3584
    s_mov_b32 s39, 0x20000
    v_lshrrev_b32 v8, 1, v2
    s_add_u32 m0, s67, 78464
    s_nop 0
    buffer_load_dwordx4 v39, s[8:11], s64 offen offset:384 lds
    s_mov_b32 s42, 4096
    s_mov_b32 s43, 0x20000
    v_xor_b32 v9, v8, v3
    s_mov_b32 s23, 0x20000
    v_cndmask_b32 v49, 0, v48, vcc
    s_mul_i32 s52, s7, 25
    s_add_u32 s52, s52, s63
    s_mul_i32 s51, s52, 37
    s_lshr_b32 s51, s51, 8
    v_lshlrev_b32 v9, 4, v9
    s_mul_i32 s53, s51, 7
    s_sub_u32 s52, s52, s53
    v_lshl_add_u32 v9, v2, 7, v9
    s_mul_i32 s53, s6, 7
    s_add_u32 s51, s51, s53
    v_add_u32 v10, s67, v9
    s_add_u32 m0, s67, 79360
    s_nop 0
    buffer_load_dwordx4 v38, s[8:11], s64 offen offset:512 lds
    s_add_u32 s53, s63, s7
    s_cmp_lt_u32 s53, 25
    s_cselect_b32 s55, 1, 0
    s_cselect_b32 s22, 7340032, 0
    v_cmp_eq_u32 vcc, 0, v2
    s_cmp_lt_u32 s63, 28
    s_cselect_b32 s56, 1, 0
    v_add_u32 v60, 71680, v10
    s_mul_i32 s53, s63, 37
    s_lshr_b32 s53, s53, 8
    s_mul_i32 s54, s53, 7
    s_sub_u32 s54, s63, s54
    v_add_u32 v62, 14336, v10
    s_lshl_b32 s61, s62, 2
    s_add_u32 s53, s53, s61
    v_cndmask_b32 v58, v10, v9, vcc
    s_add_u32 m0, s67, 80384
    s_nop 0
    buffer_load_dwordx4 v39, s[8:11], s64 offen offset:512 lds
    s_cmp_lt_u32 s50, 14
    s_cselect_b32 s60, 0, 268435456
    v_xor_b32 v61, 64, v60
    s_mov_b32 s70, 0x00100001
    s_mov_b32 s71, 0x10000100
    v_xor_b32 v63, 64, v62
    s_mov_b32 s72, 0x00200002
    s_mov_b32 s73, 0x20000200
    v_xor_b32 v59, 64, v58
    s_mov_b32 s74, 0x00400004
    s_mov_b32 s75, 0x40000400
    v_lshlrev_b32 v9, 2, v3
    s_mov_b32 s76, 0x00800008
    s_mov_b32 s77, 0x80000800
    v_sub_u32 v8, v8, v9
    s_mov_b32 s78, 0x3727c5ac
    s_mov_b32 s79, 0x3b124925
    v_and_b32 v9, 1, v1
    s_add_u32 m0, s67, 81280
    s_nop 0
    buffer_load_dwordx4 v38, s[8:11], s64 offen offset:640 lds
    v_lshlrev_b32 v9, 4, v9
    v_mov_b32 v10, 0x3f80
    v_lshlrev_b32 v9, v9, v10
    s_min_u32 s3, s50, 13
    s_and_b32 s6, s3, 1
    s_lshl_b32 s6, s6, 6
    s_lshr_b32 s3, s3, 1
    s_lshl_b32 s3, s3, 11
    v_xor_b32 v64, s6, v60
    v_xor_b32 v65, s6, v62
    v_add_u32 v64, s3, v64
    v_add_u32 v65, s3, v65
    v_cmp_eq_i32 vcc, 0, v8
    v_cmp_eq_i32 s[6:7], 1, v8
    s_nop 0
    v_cndmask_b32 v50, 0, v9, vcc
    v_cndmask_b32 v51, 0, v9, s[6:7]
    s_add_u32 m0, s67, 82304
    s_nop 0
    buffer_load_dwordx4 v39, s[8:11], s64 offen offset:640 lds
    v_cmp_eq_i32 vcc, 2, v8
    v_cmp_eq_i32 s[6:7], 3, v8
    s_nop 0
    v_cndmask_b32 v52, 0, v9, vcc
    v_cndmask_b32 v53, 0, v9, s[6:7]
    v_cmp_eq_i32 vcc, -8, v8
    v_cmp_eq_i32 s[6:7], -7, v8
    s_nop 0
    v_cndmask_b32 v54, 0, v9, vcc
    v_cndmask_b32 v55, 0, v9, s[6:7]
    v_cmp_eq_i32 vcc, -6, v8
    v_cmp_eq_i32 s[6:7], -5, v8
    s_nop 0
    v_cndmask_b32 v56, 0, v9, vcc
    v_cndmask_b32 v57, 0, v9, s[6:7]
    v_lshrrev_b32 v8, 2, v1
    v_lshlrev_b32 v8, 6, v8
    v_and_b32 v9, 1, v3
    v_lshl_add_u32 v8, v9, 5, v8
    s_add_u32 m0, s67, 83200
    s_nop 0
    buffer_load_dwordx4 v38, s[8:11], s64 offen offset:768 lds
    v_add_u32 v8, 65536, v8
    v_lshl_add_u32 v66, v43, 3, v8
    v_lshrrev_b32 v9, 1, v43
    v_xor_b32 v9, v9, v43
    v_xor_b32 v8, 32, v8
    v_lshl_add_u32 v67, v9, 3, v8
    v_add_u32 v68, 65536, v66
    v_add_u32 v69, 65536, v67
    s_sub_u32 s6, 3, s4
    s_lshl_b32 s3, s4, 13
    s_cmp_eq_u32 s5, 1
    s_cselect_b32 s6, 0, s6
    s_cselect_b32 s3, 159744, s3
    v_min_u32 v8, s6, v5
    v_lshlrev_b32 v8, 11, v8
    v_lshl_add_u32 v8, v6, 4, v8
    s_add_u32 m0, s67, 84224
    s_nop 0
    buffer_load_dwordx4 v39, s[8:11], s64 offen offset:768 lds
    v_add_u32 v70, s3, v8
    v_and_b32 v8, 1, v3
    v_lshlrev_b32 v9, 2, v8
    v_xor_b32 v9, v9, v6
    v_lshlrev_b32 v23, 4, v9
    v_mul_u32_u24 v9, 3584, v5
    s_mul_i32 s3, s48, 114688
    s_lshl_b32 s6, s51, 7
    s_add_u32 s3, s3, s6
    v_add3_u32 v18, v9, v23, s3
    v_add_u32 v19, 27648, v18
    v_add_u32 v20, 55296, v18
    v_add_u32 v21, 82944, v18
    s_mul_i32 s0, s52, 37
    s_lshr_b32 s0, s0, 4
    s_add_u32 s0, s0, 15
    s_lshl_b32 s0, s0, 12
    s_mov_b32 s1, s0
    s_add_u32 m0, s67, 14336
    s_nop 0
    buffer_load_dwordx4 v38, s[8:11], s65 offen lds
    s_add_u32 m0, s67, 15360
    s_nop 0
    buffer_load_dwordx4 v39, s[8:11], s65 offen lds
    s_add_u32 m0, s67, 16256
    s_nop 0
    buffer_load_dwordx4 v38, s[8:11], s65 offen offset:128 lds
    s_add_u32 m0, s67, 17280
    s_nop 0
    buffer_load_dwordx4 v39, s[8:11], s65 offen offset:128 lds
    s_add_u32 m0, s67, 18176
    s_nop 0
    buffer_load_dwordx4 v38, s[8:11], s65 offen offset:256 lds
    s_add_u32 m0, s67, 19200
    s_nop 0
    buffer_load_dwordx4 v39, s[8:11], s65 offen offset:256 lds
    s_add_u32 m0, s67, 20096
    s_nop 0
    buffer_load_dwordx4 v38, s[8:11], s65 offen offset:384 lds
    s_add_u32 m0, s67, 21120
    s_nop 0
    buffer_load_dwordx4 v39, s[8:11], s65 offen offset:384 lds
    s_add_u32 m0, s67, 22016
    s_nop 0
    buffer_load_dwordx4 v38, s[8:11], s65 offen offset:512 lds
    s_add_u32 m0, s67, 23040
    s_nop 0
    buffer_load_dwordx4 v39, s[8:11], s65 offen offset:512 lds
    s_add_u32 m0, s67, 23936
    s_nop 0
    buffer_load_dwordx4 v38, s[8:11], s65 offen offset:640 lds
    s_add_u32 m0, s67, 24960
    s_nop 0
    buffer_load_dwordx4 v39, s[8:11], s65 offen offset:640 lds
    s_add_u32 m0, s67, 25856
    s_nop 0
    buffer_load_dwordx4 v38, s[8:11], s65 offen offset:768 lds
    s_add_u32 m0, s67, 26880
    s_nop 0
    buffer_load_dwordx4 v39, s[8:11], s65 offen offset:768 lds
    s_waitcnt vmcnt(14)
    ds_read_b128 a[200:203], v64
    ds_read_b128 a[56:59], v60 offset:0
    ds_read_b128 a[60:63], v61 offset:0
    ds_read_b128 a[64:67], v60 offset:2048
    ds_read_b128 a[68:71], v61 offset:2048
    ds_read_b128 a[72:75], v60 offset:4096
    ds_read_b128 a[76:79], v61 offset:4096
    ds_read_b128 a[80:83], v60 offset:6144
    ds_read_b128 a[84:87], v61 offset:6144
    ds_read_b128 a[88:91], v60 offset:8192
    ds_read_b128 a[92:95], v61 offset:8192
    ds_read_b128 a[96:99], v60 offset:10240
    ds_read_b128 a[100:103], v61 offset:10240
    ds_read_b128 a[104:107], v60 offset:12288
    ds_read_b128 a[108:111], v61 offset:12288
    s_waitcnt lgkmcnt(13)
    v_mfma_f32_16x16x32_bf16 v[76:79], a[56:59], a[56:59], 0
    s_add_u32 m0, s68, 0
    s_nop 0
    buffer_load_dwordx4 v40, s[8:11], s66 offen lds
    v_mfma_f32_16x16x32_bf16 v[88:91], v[44:47], a[56:59], 0
    s_waitcnt lgkmcnt(12)
    v_mfma_f32_16x16x32_bf16 v[76:79], a[60:63], a[60:63], v[76:79]
    v_mfma_f32_16x16x32_bf16 v[88:91], v[44:47], a[60:63], v[88:91]
    s_waitcnt lgkmcnt(11)
    v_mfma_f32_16x16x32_bf16 v[76:79], a[64:67], a[64:67], v[76:79]
    s_add_u32 m0, s68, 1920
    s_nop 0
    buffer_load_dwordx4 v40, s[8:11], s66 offen offset:128 lds
    v_mfma_f32_16x16x32_bf16 v[88:91], v[44:47], a[64:67], v[88:91]
    s_waitcnt lgkmcnt(10)
    v_mfma_f32_16x16x32_bf16 v[76:79], a[68:71], a[68:71], v[76:79]
    v_mfma_f32_16x16x32_bf16 v[88:91], v[44:47], a[68:71], v[88:91]
    s_waitcnt lgkmcnt(9)
    v_mfma_f32_16x16x32_bf16 v[76:79], a[72:75], a[72:75], v[76:79]
    s_add_u32 m0, s68, 3840
    s_nop 0
    buffer_load_dwordx4 v40, s[8:11], s66 offen offset:256 lds
    v_mfma_f32_16x16x32_bf16 v[88:91], v[44:47], a[72:75], v[88:91]
    s_waitcnt lgkmcnt(8)
    v_mfma_f32_16x16x32_bf16 v[76:79], a[76:79], a[76:79], v[76:79]
    v_mfma_f32_16x16x32_bf16 v[88:91], v[44:47], a[76:79], v[88:91]
    s_waitcnt lgkmcnt(7)
    v_mfma_f32_16x16x32_bf16 v[76:79], a[80:83], a[80:83], v[76:79]
    s_add_u32 m0, s69, 5760
    s_nop 0
    buffer_load_dwordx4 v40, s[8:11], s66 offen offset:384 lds
    v_mfma_f32_16x16x32_bf16 v[88:91], v[44:47], a[80:83], v[88:91]
    s_waitcnt lgkmcnt(6)
    v_mfma_f32_16x16x32_bf16 v[76:79], a[84:87], a[84:87], v[76:79]
    v_mfma_f32_16x16x32_bf16 v[88:91], v[44:47], a[84:87], v[88:91]
    s_waitcnt lgkmcnt(5)
    v_mfma_f32_16x16x32_bf16 v[76:79], a[88:91], a[88:91], v[76:79]
    s_add_u32 m0, s101, 129024
    s_add_u32 s62, s100, 0
    buffer_load_dwordx4 v41, s[12:15], s62 offen lds
    v_mfma_f32_16x16x32_bf16 v[88:91], v[44:47], a[88:91], v[88:91]
    s_waitcnt lgkmcnt(4)
    v_mfma_f32_16x16x32_bf16 v[76:79], a[92:95], a[92:95], v[76:79]
    v_mfma_f32_16x16x32_bf16 v[88:91], v[44:47], a[92:95], v[88:91]
    s_waitcnt lgkmcnt(3)
    v_mfma_f32_16x16x32_bf16 v[76:79], a[96:99], a[96:99], v[76:79]
    v_mfma_f32_16x16x32_bf16 v[88:91], v[44:47], a[96:99], v[88:91]
    s_waitcnt lgkmcnt(2)
    v_mfma_f32_16x16x32_bf16 v[76:79], a[100:103], a[100:103], v[76:79]
    v_mfma_f32_16x16x32_bf16 v[88:91], v[44:47], a[100:103], v[88:91]
    s_waitcnt lgkmcnt(1)
    v_mfma_f32_16x16x32_bf16 v[76:79], a[104:107], a[104:107], v[76:79]
    s_add_u32 m0, s101, 130048
    s_add_u32 s62, s100, 896
    buffer_load_dwordx4 v41, s[12:15], s62 offen lds
    v_mfma_f32_16x16x32_bf16 v[88:91], v[44:47], a[104:107], v[88:91]
    s_waitcnt lgkmcnt(0)
    v_mfma_f32_16x16x32_bf16 v[76:79], a[108:111], a[108:111], v[76:79]
    v_mfma_f32_16x16x32_bf16 v[88:91], v[44:47], a[108:111], v[88:91]
    s_waitcnt vmcnt(6)
    ds_read_b128 a[204:207], v65
    ds_read_b128 a[112:115], v62 offset:0
    ds_read_b128 a[116:119], v63 offset:0
    ds_read_b128 a[120:123], v62 offset:2048
    ds_read_b128 a[124:127], v63 offset:2048
    ds_read_b128 a[128:131], v62 offset:4096
    ds_read_b128 a[132:135], v63 offset:4096
    ds_read_b128 a[136:139], v62 offset:6144
    ds_read_b128 a[140:143], v63 offset:6144
    ds_read_b128 a[144:147], v62 offset:8192
    ds_read_b128 a[148:151], v63 offset:8192
    ds_read_b128 a[152:155], v62 offset:10240
    ds_read_b128 a[156:159], v63 offset:10240
    ds_read_b128 a[160:163], v62 offset:12288
    ds_read_b128 a[164:167], v63 offset:12288
    s_waitcnt lgkmcnt(13)
    v_mfma_f32_16x16x32_bf16 v[80:83], a[112:115], a[112:115], 0
    v_cndmask_b32 v162, 0, v76, s[70:71]
    s_add_u32 m0, s101, 131072
    s_add_u32 s62, s100, 1792
    buffer_load_dwordx4 v41, s[12:15], s62 offen lds
    v_mfma_f32_16x16x32_bf16 v[92:95], v[44:47], a[112:115], 0
    v_cndmask_b32 v162, v162, v77, s[72:73]
    s_waitcnt lgkmcnt(12)
    v_mfma_f32_16x16x32_bf16 v[80:83], a[116:119], a[116:119], v[80:83]
    v_cndmask_b32 v162, v162, v78, s[74:75]
    v_mfma_f32_16x16x32_bf16 v[92:95], v[44:47], a[116:119], v[92:95]
    v_cndmask_b32 v162, v162, v79, s[76:77]
    s_waitcnt lgkmcnt(11)
    v_mfma_f32_16x16x32_bf16 v[80:83], a[120:123], a[120:123], v[80:83]
    v_mul_f32_e64 v114, -v88, s79
    v_mfma_f32_16x16x32_bf16 v[92:95], v[44:47], a[120:123], v[92:95]
    v_mul_f32 v164, v114, v114
    s_waitcnt lgkmcnt(10)
    v_mfma_f32_16x16x32_bf16 v[80:83], a[124:127], a[124:127], v[80:83]
    v_mfma_f32_16x16x4_f32 v[76:79], v48, v162, 0
    s_add_u32 m0, s101, 132096
    s_add_u32 s62, s100, 172032
    buffer_load_dwordx4 v41, s[12:15], s62 offen lds
    v_mfma_f32_16x16x32_bf16 v[92:95], v[44:47], a[124:127], v[92:95]
    s_waitcnt lgkmcnt(9)
    v_mfma_f32_16x16x32_bf16 v[80:83], a[128:131], a[128:131], v[80:83]
    v_mfma_f32_16x16x32_bf16 v[92:95], v[44:47], a[128:131], v[92:95]
    s_waitcnt lgkmcnt(8)
    v_mfma_f32_16x16x32_bf16 v[80:83], a[132:135], a[132:135], v[80:83]
    s_nop 0
    v_fma_f32 v164, v76, s79, -v164
    v_mfma_f32_16x16x32_bf16 v[92:95], v[44:47], a[132:135], v[92:95]
    v_max_f32 v164, 0, v164
    s_waitcnt lgkmcnt(7)
    v_mfma_f32_16x16x32_bf16 v[80:83], a[136:139], a[136:139], v[80:83]
    v_add_f32 v165, s78, v164
    v_mfma_f32_16x16x32_bf16 v[92:95], v[44:47], a[136:139], v[92:95]
    v_rsq_f32 v115, v165
    s_add_u32 m0, s101, 133120
    s_add_u32 s62, s100, 172928
    buffer_load_dwordx4 v41, s[12:15], s62 offen lds
    s_waitcnt lgkmcnt(6)
    v_mfma_f32_16x16x32_bf16 v[80:83], a[140:143], a[140:143], v[80:83]
    v_mul_f32 v165, v115, v115
    v_mfma_f32_16x16x32_bf16 v[92:95], v[44:47], a[140:143], v[92:95]
    v_fma_f32 v165, v165, v164, s78
    s_waitcnt lgkmcnt(5)
    v_mfma_f32_16x16x32_bf16 v[80:83], a[144:147], a[144:147], v[80:83]
    v_rsq_f32 v165, v165
    v_mfma_f32_16x16x32_bf16 v[92:95], v[44:47], a[144:147], v[92:95]
    v_mul_f32 v163, v115, v165
    s_waitcnt lgkmcnt(4)
    v_mfma_f32_16x16x32_bf16 v[80:83], a[148:151], a[148:151], v[80:83]
    v_mul_f32 v164, v114, v163
    v_mfma_f32_16x16x32_bf16 v[92:95], v[44:47], a[148:151], v[92:95]
    v_mfma_f32_16x16x4_f32 v[142:145], v163, v49, 0
    s_add_u32 m0, s101, 134144
    s_add_u32 s62, s100, 173824
    buffer_load_dwordx4 v41, s[12:15], s62 offen lds
    s_waitcnt lgkmcnt(3)
    v_mfma_f32_16x16x32_bf16 v[80:83], a[152:155], a[152:155], v[80:83]
    v_mfma_f32_16x16x4_f32 v[150:153], v164, v49, 0
    v_mfma_f32_16x16x32_bf16 v[92:95], v[44:47], a[152:155], v[92:95]
    s_waitcnt lgkmcnt(2)
    v_mfma_f32_16x16x32_bf16 v[80:83], a[156:159], a[156:159], v[80:83]
    v_mfma_f32_16x16x32_bf16 v[92:95], v[44:47], a[156:159], v[92:95]
    s_waitcnt lgkmcnt(1)
    v_mfma_f32_16x16x32_bf16 v[80:83], a[160:163], a[160:163], v[80:83]
    v_mfma_f32_16x16x32_bf16 v[92:95], v[44:47], a[160:163], v[92:95]
    s_add_u32 m0, s101, 135168
    s_add_u32 s62, s100, 344064
    buffer_load_dwordx4 v41, s[12:15], s62 offen lds
    s_waitcnt lgkmcnt(0)
    v_mfma_f32_16x16x32_bf16 v[80:83], a[164:167], a[164:167], v[80:83]
    v_mfma_f32_16x16x32_bf16 v[92:95], v[44:47], a[164:167], v[92:95]
    s_waitcnt vmcnt(7)
    ds_write_b128 v70, v[44:47]
    s_waitcnt lgkmcnt(0)
    s_barrier
    ds_read_b128 a[0:3], v58 offset:0
    v_mfma_f32_16x16x32_bf16 v[96:99], a[200:203], v[50:53], 0
    ds_read_b128 a[4:7], v59 offset:0
    v_mfma_f32_16x16x32_bf16 v[100:103], a[200:203], v[54:57], 0
    ds_read_b128 a[8:11], v58 offset:2048
    v_mfma_f32_16x16x32_bf16 v[104:107], a[204:207], v[50:53], 0
    ds_read_b128 a[12:15], v59 offset:2048
    v_mfma_f32_16x16x32_bf16 v[108:111], a[204:207], v[54:57], 0
    ds_read_b128 a[16:19], v58 offset:4096
    v_cndmask_b32 v158, 0, v80, s[70:71]
    s_add_u32 m0, s67, 71680
    s_add_u32 s62, s100, 344960
    buffer_load_dwordx4 v41, s[12:15], s62 offen lds
    ds_read_b128 a[20:23], v59 offset:4096
    v_cndmask_b32 v158, v158, v81, s[72:73]
    ds_read_b128 a[24:27], v58 offset:6144
    v_cndmask_b32 v158, v158, v82, s[74:75]
    ds_read_b128 a[28:31], v59 offset:6144
    v_cndmask_b32 v158, v158, v83, s[76:77]
    ds_read_b128 a[32:35], v58 offset:8192
    v_mul_f32_e64 v116, -v92, s79
    ds_read_b128 a[36:39], v59 offset:8192
    v_mul_f32 v160, v116, v116
    ds_read_b128 a[40:43], v58 offset:10240
    v_mfma_f32_16x16x4_f32 v[80:83], v48, v158, 0
    ds_read_b128 a[44:47], v59 offset:10240
    ds_read_b128 a[48:51], v58 offset:12288
    ds_read_b128 a[52:55], v59 offset:12288
    s_lshl_b32 s3, s50, 7
    s_add_u32 s3, s3, s59
    s_lshl_b32 s3, s3, 10
    s_add_u32 s3, s3, s60
    s_add_u32 s61, s3, 65536
    s_nop 1
    v_fma_f32 v160, v80, s79, -v160
    v_max_f32 v160, 0, v160
    v_add_f32 v161, s78, v160
    v_rsq_f32 v117, v161
    s_add_u32 m0, s67, 72704
    s_add_u32 s62, s100, 345856
    buffer_load_dwordx4 v41, s[12:15], s62 offen lds
    v_mul_f32 v161, v117, v117
    v_fma_f32 v161, v161, v160, s78
    v_rsq_f32 v161, v161
    s_nop 0
    v_mul_f32 v159, v117, v161
    v_mul_f32 v160, v116, v159
    s_nop 0
    v_mfma_f32_16x16x4_f32 v[146:149], v159, v49, 0
    v_mfma_f32_16x16x4_f32 v[154:157], v160, v49, 0
    v_pk_fma_f32 v[96:97], v[96:97], v[142:143], v[150:151]
    v_pk_fma_f32 v[98:99], v[98:99], v[144:145], v[152:153]
    v_cvt_pk_bf16_f32 v28, v96, v97
    v_cvt_pk_bf16_f32 v29, v98, v99
    v_pk_fma_f32 v[100:101], v[100:101], v[142:143], v[150:151]
    v_pk_fma_f32 v[102:103], v[102:103], v[144:145], v[152:153]
    v_cvt_pk_bf16_f32 v32, v100, v101
    v_cvt_pk_bf16_f32 v33, v102, v103
    s_waitcnt lgkmcnt(13)
    v_mfma_f32_16x16x32_bf16 v[72:75], a[0:3], a[0:3], 0
    s_add_u32 m0, s67, 73728
    s_add_u32 s62, s100, 516096
    buffer_load_dwordx4 v41, s[12:15], s62 offen lds
    v_mfma_f32_16x16x32_bf16 v[84:87], v[44:47], a[0:3], 0
    v_pk_fma_f32 v[104:105], v[104:105], v[146:147], v[154:155]
    v_pk_fma_f32 v[106:107], v[106:107], v[148:149], v[156:157]
    v_cvt_pk_bf16_f32 v30, v104, v105
    v_cvt_pk_bf16_f32 v31, v106, v107
    v_pk_fma_f32 v[108:109], v[108:109], v[146:147], v[154:155]
    v_pk_fma_f32 v[110:111], v[110:111], v[148:149], v[156:157]
    v_cvt_pk_bf16_f32 v34, v108, v109
    v_cvt_pk_bf16_f32 v35, v110, v111
    buffer_store_dwordx4 v[28:31], v4, s[28:31], s3 offen sc1
    buffer_store_dwordx4 v[32:35], v4, s[28:31], s61 offen sc1
    v_mov_b32 v11, 0
    buffer_load_dword v24, v11, s[44:47], 0 offen sc1
    s_waitcnt lgkmcnt(12)
    v_mfma_f32_16x16x32_bf16 v[72:75], a[4:7], a[4:7], v[72:75]
    v_mfma_f32_16x16x32_bf16 v[84:87], v[44:47], a[4:7], v[84:87]
    s_waitcnt lgkmcnt(11)
    v_mfma_f32_16x16x32_bf16 v[72:75], a[8:11], a[8:11], v[72:75]
    v_mfma_f32_16x16x32_bf16 v[84:87], v[44:47], a[8:11], v[84:87]
    s_add_u32 m0, s67, 74752
    s_add_u32 s62, s100, 516992
    buffer_load_dwordx4 v41, s[12:15], s62 offen lds
    s_waitcnt lgkmcnt(10)
    v_mfma_f32_16x16x32_bf16 v[72:75], a[12:15], a[12:15], v[72:75]
    v_mfma_f32_16x16x32_bf16 v[84:87], v[44:47], a[12:15], v[84:87]
    s_waitcnt lgkmcnt(9)
    v_mfma_f32_16x16x32_bf16 v[72:75], a[16:19], a[16:19], v[72:75]
    v_mfma_f32_16x16x32_bf16 v[84:87], v[44:47], a[16:19], v[84:87]
    s_waitcnt lgkmcnt(8)
    v_mfma_f32_16x16x32_bf16 v[72:75], a[20:23], a[20:23], v[72:75]
    v_mfma_f32_16x16x32_bf16 v[84:87], v[44:47], a[20:23], v[84:87]
    s_waitcnt lgkmcnt(7)
    v_mfma_f32_16x16x32_bf16 v[72:75], a[24:27], a[24:27], v[72:75]
    v_mfma_f32_16x16x32_bf16 v[84:87], v[44:47], a[24:27], v[84:87]
    s_add_u32 m0, s67, 75776
    s_add_u32 s62, s100, 517888
    buffer_load_dwordx4 v41, s[12:15], s62 offen lds
    s_waitcnt lgkmcnt(6)
    v_mfma_f32_16x16x32_bf16 v[72:75], a[28:31], a[28:31], v[72:75]
    v_mfma_f32_16x16x32_bf16 v[84:87], v[44:47], a[28:31], v[84:87]
    s_waitcnt lgkmcnt(5)
    v_mfma_f32_16x16x32_bf16 v[72:75], a[32:35], a[32:35], v[72:75]
    v_mfma_f32_16x16x32_bf16 v[84:87], v[44:47], a[32:35], v[84:87]
    s_waitcnt lgkmcnt(4)
    v_mfma_f32_16x16x32_bf16 v[72:75], a[36:39], a[36:39], v[72:75]
    v_mfma_f32_16x16x32_bf16 v[84:87], v[44:47], a[36:39], v[84:87]
    s_waitcnt lgkmcnt(3)
    v_mfma_f32_16x16x32_bf16 v[72:75], a[40:43], a[40:43], v[72:75]
    v_mfma_f32_16x16x32_bf16 v[84:87], v[44:47], a[40:43], v[84:87]
    s_add_u32 m0, s67, 76800
    s_add_u32 s62, s100, 688128
    buffer_load_dwordx4 v41, s[12:15], s62 offen lds
    s_waitcnt lgkmcnt(2)
    v_mfma_f32_16x16x32_bf16 v[72:75], a[44:47], a[44:47], v[72:75]
    v_mfma_f32_16x16x32_bf16 v[84:87], v[44:47], a[44:47], v[84:87]
    s_waitcnt lgkmcnt(1)
    v_mfma_f32_16x16x32_bf16 v[72:75], a[48:51], a[48:51], v[72:75]
    v_mfma_f32_16x16x32_bf16 v[84:87], v[44:47], a[48:51], v[84:87]
    s_waitcnt lgkmcnt(0)
    v_mfma_f32_16x16x32_bf16 v[72:75], a[52:55], a[52:55], v[72:75]
    v_mfma_f32_16x16x32_bf16 v[84:87], v[44:47], a[52:55], v[84:87]
    s_waitcnt vmcnt(13)
    s_barrier
    ds_read_b64_tr_b16 a[168:169], v66 offset:63488
    ds_read_b64_tr_b16 a[170:171], v68 offset:5120
    ds_read_b64_tr_b16 a[172:173], v67 offset:63488
    ds_read_b64_tr_b16 a[174:175], v69 offset:5120
    ds_read_b64_tr_b16 a[176:177], v66 offset:64512
    ds_read_b64_tr_b16 a[178:179], v68 offset:6144
    ds_read_b64_tr_b16 a[180:181], v67 offset:64512
    ds_read_b64_tr_b16 a[182:183], v69 offset:6144
    ds_read_b64_tr_b16 a[184:185], v68 offset:0
    ds_read_b64_tr_b16 a[186:187], v68 offset:7168
    s_waitcnt lgkmcnt(6)
    v_mfma_f32_16x16x32_bf16 v[174:177], a[168:171], a[56:59], 0
    ds_read_b64_tr_b16 a[188:189], v69 offset:0
    ds_read_b64_tr_b16 a[190:191], v69 offset:7168
    v_mfma_f32_16x16x32_bf16 v[182:185], a[168:171], a[112:115], 0
    s_add_u32 m0, s67, 77824
    s_add_u32 s62, s100, 689024
    buffer_load_dwordx4 v41, s[12:15], s62 offen lds
    v_mfma_f32_16x16x32_bf16 v[166:169], a[168:171], v[44:47], 0
    v_mfma_f32_16x16x32_bf16 v[178:181], a[172:175], a[56:59], 0
    ds_read_b64_tr_b16 a[192:193], v68 offset:12288
    ds_read_b64_tr_b16 a[194:195], v68 offset:19456
    v_mfma_f32_16x16x32_bf16 v[186:189], a[172:175], a[112:115], 0
    v_mfma_f32_16x16x32_bf16 v[170:173], a[172:175], v[44:47], 0
    v_cndmask_b32 v158, 0, v72, s[70:71]
    s_waitcnt lgkmcnt(6)
    v_mfma_f32_16x16x32_bf16 v[190:193], a[176:179], a[0:3], 0
    ds_read_b64_tr_b16 a[196:197], v69 offset:12288
    ds_read_b64_tr_b16 a[198:199], v69 offset:19456
    v_mfma_f32_16x16x32_bf16 v[198:201], a[176:179], a[56:59], 0
    v_cndmask_b32 v158, v158, v73, s[72:73]
    v_mfma_f32_16x16x32_bf16 v[206:209], a[176:179], a[112:115], 0
    v_cndmask_b32 v158, v158, v74, s[74:75]
    v_mfma_f32_16x16x32_bf16 v[194:197], a[180:183], a[0:3], 0
    s_add_u32 m0, s67, 78848
    s_add_u32 s62, s100, 689920
    buffer_load_dwordx4 v41, s[12:15], s62 offen lds
    ds_read_b64_tr_b16 a[168:169], v68 offset:13312
    ds_read_b64_tr_b16 a[170:171], v68 offset:20480
    v_mfma_f32_16x16x32_bf16 v[202:205], a[180:183], a[56:59], 0
    v_cndmask_b32 v158, v158, v75, s[76:77]
    v_mfma_f32_16x16x32_bf16 v[210:213], a[180:183], a[112:115], 0
    v_mul_f32_e64 v112, -v84, s79
    s_waitcnt lgkmcnt(6)
    v_mfma_f32_16x16x32_bf16 v[214:217], a[0:3], a[184:187], 0
    ds_read_b64_tr_b16 a[172:173], v69 offset:13312
    ds_read_b64_tr_b16 a[174:175], v69 offset:20480
    v_mfma_f32_16x16x32_bf16 v[222:225], a[56:59], a[184:187], 0
    v_mul_f32 v160, v112, v112
    v_mfma_f32_16x16x32_bf16 v[230:233], a[112:115], a[184:187], 0
    v_mfma_f32_16x16x4_f32 v[72:75], v48, v158, 0
    v_mfma_f32_16x16x32_bf16 v[218:221], a[0:3], a[188:191], 0
    s_add_u32 m0, s67, 79872
    s_add_u32 s62, s100, 860160
    buffer_load_dwordx4 v41, s[12:15], s62 offen lds
    ds_read_b64_tr_b16 a[176:177], v68 offset:14336
    ds_read_b64_tr_b16 a[178:179], v68 offset:21504
    v_mfma_f32_16x16x32_bf16 v[226:229], a[56:59], a[188:191], 0
    v_mfma_f32_16x16x32_bf16 v[234:237], a[112:115], a[188:191], 0
    s_waitcnt lgkmcnt(6)
    v_mfma_f32_16x16x32_bf16 v[174:177], a[192:195], a[60:63], v[174:177]
    ds_read_b64_tr_b16 a[180:181], v69 offset:14336
    ds_read_b64_tr_b16 a[182:183], v69 offset:21504
    v_mfma_f32_16x16x32_bf16 v[182:185], a[192:195], a[116:119], v[182:185]
    v_mfma_f32_16x16x32_bf16 v[166:169], a[192:195], v[44:47], v[166:169]
    v_fma_f32 v160, v72, s79, -v160
    v_mfma_f32_16x16x32_bf16 v[178:181], a[196:199], a[60:63], v[178:181]
    s_waitcnt vmcnt(13)
    s_barrier
    ds_read_b64_tr_b16 a[184:185], v68 offset:1024
    ds_read_b64_tr_b16 a[186:187], v68 offset:8192
    v_mfma_f32_16x16x32_bf16 v[186:189], a[196:199], a[116:119], v[186:189]
    v_max_f32 v160, 0, v160
    v_mfma_f32_16x16x32_bf16 v[170:173], a[196:199], v[44:47], v[170:173]
    s_add_u32 m0, s67, 80896
    s_add_u32 s62, s100, 861056
    buffer_load_dwordx4 v41, s[12:15], s62 offen lds
    v_add_f32 v161, s78, v160
    s_waitcnt lgkmcnt(6)
    v_mfma_f32_16x16x32_bf16 v[190:193], a[168:171], a[4:7], v[190:193]
    ds_read_b64_tr_b16 a[188:189], v69 offset:1024
    ds_read_b64_tr_b16 a[190:191], v69 offset:8192
    v_mfma_f32_16x16x32_bf16 v[198:201], a[168:171], a[60:63], v[198:201]
    v_rsq_f32 v113, v161
    v_mfma_f32_16x16x32_bf16 v[206:209], a[168:171], a[116:119], v[206:209]
    v_mfma_f32_16x16x32_bf16 v[194:197], a[172:175], a[4:7], v[194:197]
    ds_read_b64_tr_b16 a[192:193], v68 offset:2048
    ds_read_b64_tr_b16 a[194:195], v68 offset:9216
    v_mfma_f32_16x16x32_bf16 v[202:205], a[172:175], a[60:63], v[202:205]
    v_mfma_f32_16x16x4_f32 v[122:125], v115, v49, 0
    v_mfma_f32_16x16x32_bf16 v[210:213], a[172:175], a[116:119], v[210:213]
    s_add_u32 m0, s67, 81920
    s_add_u32 s62, s100, 861952
    buffer_load_dwordx4 v41, s[12:15], s62 offen lds
    s_waitcnt lgkmcnt(6)
    v_mfma_f32_16x16x32_bf16 v[214:217], a[4:7], a[176:179], v[214:217]
    ds_read_b64_tr_b16 a[196:197], v69 offset:2048
    ds_read_b64_tr_b16 a[198:199], v69 offset:9216
    v_mfma_f32_16x16x32_bf16 v[222:225], a[60:63], a[176:179], v[222:225]
    v_mfma_f32_16x16x4_f32 v[134:137], v114, v49, 0
    v_mfma_f32_16x16x32_bf16 v[230:233], a[116:119], a[176:179], v[230:233]
    v_mfma_f32_16x16x32_bf16 v[218:221], a[4:7], a[180:183], v[218:221]
    ds_read_b64_tr_b16 a[168:169], v68 offset:3072
    ds_read_b64_tr_b16 a[170:171], v68 offset:10240
    v_mfma_f32_16x16x32_bf16 v[226:229], a[60:63], a[180:183], v[226:229]
    v_mfma_f32_16x16x4_f32 v[126:129], v117, v49, 0
    s_add_u32 m0, s67, 82944
    s_add_u32 s62, s100, 1032192
    buffer_load_dwordx4 v41, s[12:15], s62 offen lds
    v_mfma_f32_16x16x32_bf16 v[234:237], a[116:119], a[180:183], v[234:237]
    s_waitcnt lgkmcnt(6)
    v_mfma_f32_16x16x32_bf16 v[174:177], a[184:187], a[64:67], v[174:177]
    ds_read_b64_tr_b16 a[172:173], v69 offset:3072
    ds_read_b64_tr_b16 a[174:175], v69 offset:10240
    v_mfma_f32_16x16x32_bf16 v[182:185], a[184:187], a[120:123], v[182:185]
    v_mfma_f32_16x16x4_f32 v[138:141], v116, v49, 0
    v_mfma_f32_16x16x32_bf16 v[166:169], a[184:187], v[44:47], v[166:169]
    v_mfma_f32_16x16x32_bf16 v[178:181], a[188:191], a[64:67], v[178:181]
    ds_read_b64_tr_b16 a[176:177], v68 offset:15360
    ds_read_b64_tr_b16 a[178:179], v68 offset:22528
    v_mfma_f32_16x16x32_bf16 v[186:189], a[188:191], a[120:123], v[186:189]
    s_add_u32 m0, s67, 83968
    s_add_u32 s62, s100, 1033088
    buffer_load_dwordx4 v41, s[12:15], s62 offen lds
    v_mfma_f32_16x16x4_f32 v[118:121], v113, v49, 0
    v_mfma_f32_16x16x32_bf16 v[170:173], a[188:191], v[44:47], v[170:173]
    s_waitcnt lgkmcnt(6)
    v_mfma_f32_16x16x32_bf16 v[190:193], a[192:195], a[8:11], v[190:193]
    ds_read_b64_tr_b16 a[180:181], v69 offset:15360
    ds_read_b64_tr_b16 a[182:183], v69 offset:22528
    v_mfma_f32_16x16x32_bf16 v[198:201], a[192:195], a[64:67], v[198:201]
    v_mfma_f32_16x16x4_f32 v[130:133], v112, v49, 0
    v_mfma_f32_16x16x32_bf16 v[206:209], a[192:195], a[120:123], v[206:209]
    s_add_u32 m0, s67, 84992
    s_add_u32 s62, s100, 1033984
    buffer_load_dwordx4 v41, s[12:15], s62 offen lds
    v_mfma_f32_16x16x32_bf16 v[194:197], a[196:199], a[8:11], v[194:197]
    ds_read_b64_tr_b16 a[184:185], v68 offset:16384
    ds_read_b64_tr_b16 a[186:187], v68 offset:23552
    v_mfma_f32_16x16x32_bf16 v[202:205], a[196:199], a[64:67], v[202:205]
    s_mov_b32 s70, 0xaaaaaaaa
    v_mfma_f32_16x16x32_bf16 v[210:213], a[196:199], a[120:123], v[210:213]
    s_mov_b32 s71, 0xaaaaaaaa
    s_waitcnt lgkmcnt(6)
    v_mfma_f32_16x16x32_bf16 v[214:217], a[8:11], a[168:171], v[214:217]
    ds_read_b64_tr_b16 a[188:189], v69 offset:16384
    ds_read_b64_tr_b16 a[190:191], v69 offset:23552
    v_mfma_f32_16x16x32_bf16 v[222:225], a[64:67], a[168:171], v[222:225]
    s_mov_b32 s72, 0xfff0ffff
    v_mfma_f32_16x16x32_bf16 v[230:233], a[120:123], a[168:171], v[230:233]
    s_mov_b32 s73, 0xf000ff00
    v_mfma_f32_16x16x32_bf16 v[218:221], a[8:11], a[172:175], v[218:221]
    s_add_u32 m0, s58, 0
    s_add_u32 s0, s0, 4096
    s_and_b32 s0, s0, 0xffff
    s_mul_i32 s62, s0, 112
    buffer_load_dwordx4 v18, s[20:23], s62 offen lds
    ds_read_b64_tr_b16 a[192:193], v68 offset:17408
    ds_read_b64_tr_b16 a[194:195], v68 offset:24576
    v_mfma_f32_16x16x32_bf16 v[226:229], a[64:67], a[172:175], v[226:229]
    s_mov_b32 s74, 0xffc0fffc
    v_mfma_f32_16x16x32_bf16 v[234:237], a[120:123], a[172:175], v[234:237]
    s_mov_b32 s75, 0xc000fc00
    s_waitcnt lgkmcnt(6)
    v_mfma_f32_16x16x32_bf16 v[174:177], a[176:179], a[68:71], v[174:177]
    ds_read_b64_tr_b16 a[196:197], v69 offset:17408
    ds_read_b64_tr_b16 a[198:199], v69 offset:24576
    v_mfma_f32_16x16x32_bf16 v[182:185], a[176:179], a[124:127], v[182:185]
    buffer_load_dwordx4 v19, s[20:23], s62 offen offset:1024 lds
    s_mov_b32 s76, 0x00000000
    v_mfma_f32_16x16x32_bf16 v[166:169], a[176:179], v[44:47], v[166:169]
    s_mov_b32 s77, 0xffff0000
    v_mfma_f32_16x16x32_bf16 v[178:181], a[180:183], a[68:71], v[178:181]
    s_waitcnt vmcnt(17)
    s_barrier
    ds_read_b64_tr_b16 a[168:169], v68 offset:4096
    ds_read_b64_tr_b16 a[170:171], v68 offset:11264
    v_mfma_f32_16x16x32_bf16 v[186:189], a[180:183], a[124:127], v[186:189]
    s_cmp_eq_u32 s59, 0
    s_cselect_b64 s[80:81], 0, -1
    v_mfma_f32_16x16x32_bf16 v[170:173], a[180:183], v[44:47], v[170:173]
    buffer_load_dwordx4 v20, s[20:23], s62 offen offset:2048 lds
    v_mov_b32 v8, 0xffff
    s_waitcnt lgkmcnt(6)
    v_mfma_f32_16x16x32_bf16 v[190:193], a[184:187], a[12:15], v[190:193]
    ds_read_b64_tr_b16 a[172:173], v69 offset:4096
    ds_read_b64_tr_b16 a[174:175], v69 offset:11264
    v_mfma_f32_16x16x32_bf16 v[198:201], a[184:187], a[68:71], v[198:201]
    v_mov_b32 v9, 0xffff0000
    v_mfma_f32_16x16x32_bf16 v[206:209], a[184:187], a[124:127], v[206:209]
    v_cndmask_b32 v8, v8, v9, s[70:71]
    v_mfma_f32_16x16x32_bf16 v[194:197], a[188:191], a[12:15], v[194:197]
    buffer_load_dwordx4 v21, s[20:23], s62 offen offset:3072 lds
    ds_read_b64_tr_b16 a[176:177], v66 offset:6144
    ds_read_b64_tr_b16 a[178:179], v66 offset:20480
    v_mfma_f32_16x16x32_bf16 v[202:205], a[188:191], a[68:71], v[202:205]
    v_cndmask_b32 v238, v8, 0, s[72:73]
    v_mfma_f32_16x16x32_bf16 v[210:213], a[188:191], a[124:127], v[210:213]
    v_cndmask_b32 v240, 0, v8, s[72:73]
    s_waitcnt lgkmcnt(6)
    v_mfma_f32_16x16x32_bf16 v[214:217], a[12:15], a[192:195], v[214:217]
    ds_read_b64_tr_b16 a[180:181], v67 offset:6144
    ds_read_b64_tr_b16 a[182:183], v67 offset:20480
    v_mfma_f32_16x16x32_bf16 v[222:225], a[68:71], a[192:195], v[222:225]
    s_add_u32 m0, s58, 16384
    s_add_u32 s0, s0, 4096
    s_and_b32 s0, s0, 0xffff
    s_mul_i32 s62, s0, 112
    buffer_load_dwordx4 v18, s[20:23], s62 offen lds
    v_cndmask_b32 v239, v8, 0, s[74:75]
    v_mfma_f32_16x16x32_bf16 v[230:233], a[124:127], a[192:195], v[230:233]
    v_cndmask_b32 v241, 0, v8, s[74:75]
    v_mfma_f32_16x16x32_bf16 v[218:221], a[12:15], a[196:199], v[218:221]
    ds_read_b64_tr_b16 a[184:185], v66 offset:7168
    ds_read_b64_tr_b16 a[186:187], v66 offset:21504
    v_mfma_f32_16x16x32_bf16 v[226:229], a[68:71], a[196:199], v[226:229]
    v_mov_b32 v70, 0xf149f2ca
    v_mfma_f32_16x16x32_bf16 v[234:237], a[124:127], a[196:199], v[234:237]
    buffer_load_dwordx4 v19, s[20:23], s62 offen offset:1024 lds
    v_mul_f32 v246, 0x3e8b97f6, v115
    s_waitcnt lgkmcnt(6)
    v_mfma_f32_16x16x32_bf16 v[174:177], a[168:171], a[72:75], v[174:177]
    ds_read_b64_tr_b16 a[188:189], v67 offset:7168
    ds_read_b64_tr_b16 a[190:191], v67 offset:21504
    v_mfma_f32_16x16x32_bf16 v[182:185], a[168:171], a[128:131], v[182:185]
    v_cndmask_b32 v242, v118, v119, s[70:71]
    v_mfma_f32_16x16x32_bf16 v[166:169], a[168:171], v[44:47], v[166:169]
    v_cndmask_b32 v9, v122, v123, s[70:71]
    v_mfma_f32_16x16x32_bf16 v[178:181], a[172:175], a[72:75], v[178:181]
    buffer_load_dwordx4 v20, s[20:23], s62 offen offset:2048 lds
    ds_read_b64_tr_b16 a[192:193], v68 offset:18432
    ds_read_b64_tr_b16 a[194:195], v68 offset:25600
    v_mfma_f32_16x16x32_bf16 v[186:189], a[172:175], a[128:131], v[186:189]
    v_cndmask_b32 v242, v242, v9, s[72:73]
    v_mfma_f32_16x16x32_bf16 v[170:173], a[172:175], v[44:47], v[170:173]
    v_cndmask_b32 v243, v120, v121, s[70:71]
    s_waitcnt lgkmcnt(6)
    v_mfma_f32_16x16x32_bf16 v[190:193], a[176:179], a[16:19], v[190:193]
    ds_read_b64_tr_b16 a[196:197], v69 offset:18432
    ds_read_b64_tr_b16 a[198:199], v69 offset:25600
    v_mfma_f32_16x16x32_bf16 v[198:201], a[176:179], a[72:75], v[198:201]
    buffer_load_dwordx4 v21, s[20:23], s62 offen offset:3072 lds
    v_cndmask_b32 v9, v124, v125, s[70:71]
    v_mfma_f32_16x16x32_bf16 v[206:209], a[176:179], a[128:131], v[206:209]
    v_cndmask_b32 v243, v243, v9, s[74:75]
    v_mfma_f32_16x16x32_bf16 v[194:197], a[180:183], a[16:19], v[194:197]
    ds_read_b64_tr_b16 a[168:169], v66 offset:34816
    ds_read_b64_tr_b16 a[170:171], v66 offset:49152
    v_mfma_f32_16x16x32_bf16 v[202:205], a[180:183], a[72:75], v[202:205]
    v_mul_f32 v247, 0x3e8b97f6, v117
    v_mfma_f32_16x16x32_bf16 v[210:213], a[180:183], a[128:131], v[210:213]
    s_add_u32 m0, s58, 32768
    s_add_u32 s0, s0, 4096
    s_and_b32 s0, s0, 0xffff
    s_mul_i32 s62, s0, 112
    buffer_load_dwordx4 v18, s[20:23], s62 offen lds
    v_cndmask_b32 v244, v122, v123, s[70:71]
    s_waitcnt lgkmcnt(6)
    v_mfma_f32_16x16x32_bf16 v[214:217], a[16:19], a[184:187], v[214:217]
    ds_read_b64_tr_b16 a[172:173], v67 offset:34816
    ds_read_b64_tr_b16 a[174:175], v67 offset:49152
    v_mfma_f32_16x16x32_bf16 v[222:225], a[72:75], a[184:187], v[222:225]
    v_cndmask_b32 v9, v126, v127, s[70:71]
    v_mfma_f32_16x16x32_bf16 v[230:233], a[128:131], a[184:187], v[230:233]
    v_cndmask_b32 v244, v244, v9, s[72:73]
    v_mfma_f32_16x16x32_bf16 v[218:221], a[16:19], a[188:191], v[218:221]
    buffer_load_dwordx4 v19, s[20:23], s62 offen offset:1024 lds
    ds_read_b64_tr_b16 a[176:177], v66 offset:35840
    ds_read_b64_tr_b16 a[178:179], v66 offset:50176
    v_mfma_f32_16x16x32_bf16 v[226:229], a[72:75], a[188:191], v[226:229]
    v_cndmask_b32 v245, v124, v125, s[70:71]
    v_mfma_f32_16x16x32_bf16 v[234:237], a[128:131], a[188:191], v[234:237]
    v_cndmask_b32 v9, v128, v129, s[70:71]
    s_waitcnt lgkmcnt(6)
    v_mfma_f32_16x16x32_bf16 v[174:177], a[192:195], a[76:79], v[174:177]
    ds_read_b64_tr_b16 a[180:181], v67 offset:35840
    ds_read_b64_tr_b16 a[182:183], v67 offset:50176
    v_mfma_f32_16x16x32_bf16 v[182:185], a[192:195], a[132:135], v[182:185]
    buffer_load_dwordx4 v20, s[20:23], s62 offen offset:2048 lds
    v_cndmask_b32 v245, v245, v9, s[74:75]
    v_mfma_f32_16x16x32_bf16 v[166:169], a[192:195], v[44:47], v[166:169]
    v_lshrrev_b32 v8, 5, v1
    v_mfma_f32_16x16x32_bf16 v[178:181], a[196:199], a[76:79], v[178:181]
    s_waitcnt vmcnt(20)
    s_barrier
    v_readfirstlane_b32 s57, v24
    s_lshl_b32 s6, s50, 6
    s_cmp_lg_u32 s57, 0
    s_cbranch_scc1 L_nonce_ok
    s_mov_b32 s61, 0
    v_mov_b32 v25, 0
L_nonce:
    buffer_load_dword v24, v25, s[44:47], 0 offen sc1
    s_add_u32 s61, s61, 1
    s_waitcnt vmcnt(0)
    v_readfirstlane_b32 s57, v24
    s_cmp_ge_u32 s61, 20000
    s_cbranch_scc1 L_nonce_ok
    s_cmp_eq_u32 s57, 0
    s_cbranch_scc1 L_nonce
L_nonce_ok:
    s_add_u32 s6, s6, s59
    s_lshl_b32 s6, s6, 2
    s_add_u32 s6, s6, s60
    s_add_u32 s6, s6, 6291456
    buffer_store_dword v24, v7, s[28:31], s6 offen sc1
    ds_read_b64_tr_b16 a[184:185], v66 offset:8192
    buffer_load_dwordx4 v21, s[20:23], s62 offen offset:3072 lds
    ds_read_b64_tr_b16 a[186:187], v66 offset:22528
    v_mfma_f32_16x16x32_bf16 v[186:189], a[196:199], a[132:135], v[186:189]
    v_lshl_add_u32 v9, v8, 2, v42
    v_mfma_f32_16x16x32_bf16 v[170:173], a[196:199], v[44:47], v[170:173]
    v_lshlrev_b32 v9, 7, v9
    s_waitcnt lgkmcnt(6)
    v_mfma_f32_16x16x32_bf16 v[190:193], a[168:171], a[20:23], v[190:193]
    ds_read_b64_tr_b16 a[188:189], v67 offset:8192
    ds_read_b64_tr_b16 a[190:191], v67 offset:22528
    v_mfma_f32_16x16x32_bf16 v[198:201], a[168:171], a[76:79], v[198:201]
    s_add_u32 m0, s58, 49152
    s_add_u32 s0, s0, 4096
    s_and_b32 s0, s0, 0xffff
    s_mul_i32 s62, s0, 112
    buffer_load_dwordx4 v18, s[20:23], s62 offen lds
    v_lshl_add_u32 v9, v43, 3, v9
    v_mfma_f32_16x16x32_bf16 v[206:209], a[168:171], a[132:135], v[206:209]
    v_and_b32 v10, 2, v42
    v_mfma_f32_16x16x32_bf16 v[194:197], a[172:175], a[20:23], v[194:197]
    ds_read_b64_tr_b16 a[192:193], v66 offset:9216
    ds_read_b64_tr_b16 a[194:195], v66 offset:23552
    v_mfma_f32_16x16x32_bf16 v[202:205], a[172:175], a[76:79], v[202:205]
    v_and_b32 v11, 1, v3
    v_mfma_f32_16x16x32_bf16 v[210:213], a[172:175], a[132:135], v[210:213]
    buffer_load_dwordx4 v19, s[20:23], s62 offen offset:1024 lds
    v_add_u32 v10, v10, v11
    s_waitcnt lgkmcnt(6)
    v_mfma_f32_16x16x32_bf16 v[214:217], a[20:23], a[176:179], v[214:217]
    ds_read_b64_tr_b16 a[196:197], v67 offset:9216
    ds_read_b64_tr_b16 a[198:199], v67 offset:23552
    v_mfma_f32_16x16x32_bf16 v[222:225], a[76:79], a[176:179], v[222:225]
    v_lshl_add_u32 v9, v10, 5, v9
    v_mfma_f32_16x16x32_bf16 v[230:233], a[132:135], a[176:179], v[230:233]
    s_mul_i32 s3, s4, 8256
    v_mfma_f32_16x16x32_bf16 v[218:221], a[20:23], a[180:183], v[218:221]
    buffer_load_dwordx4 v20, s[20:23], s62 offen offset:2048 lds
    ds_read_b64_tr_b16 a[168:169], v66 offset:10240
    ds_read_b64_tr_b16 a[170:171], v66 offset:24576
    v_mfma_f32_16x16x32_bf16 v[226:229], a[76:79], a[180:183], v[226:229]
    v_xor_b32 v12, s3, v9
    v_mfma_f32_16x16x32_bf16 v[234:237], a[132:135], a[180:183], v[234:237]
    v_xor_b32 v13, 64, v12
    s_waitcnt lgkmcnt(6)
    v_mfma_f32_16x16x32_bf16 v[174:177], a[184:187], a[80:83], v[174:177]
    ds_read_b64_tr_b16 a[172:173], v67 offset:10240
    ds_read_b64_tr_b16 a[174:175], v67 offset:24576
    v_mfma_f32_16x16x32_bf16 v[182:185], a[184:187], a[136:139], v[182:185]
    buffer_load_dwordx4 v21, s[20:23], s62 offen offset:3072 lds
    v_add_u32 v14, 65536, v12
    v_mfma_f32_16x16x32_bf16 v[166:169], a[184:187], v[44:47], v[166:169]
    v_add_u32 v15, 65536, v13
    v_mfma_f32_16x16x32_bf16 v[178:181], a[188:191], a[80:83], v[178:181]
    ds_read_b64_tr_b16 a[176:177], v66 offset:36864
    ds_read_b64_tr_b16 a[178:179], v66 offset:51200
    v_mfma_f32_16x16x32_bf16 v[186:189], a[188:191], a[136:139], v[186:189]
    v_add_u32 v16, 131072, v12
    v_mfma_f32_16x16x32_bf16 v[170:173], a[188:191], v[44:47], v[170:173]
    v_add_u32 v17, 131072, v13
    s_waitcnt lgkmcnt(6)
    v_mfma_f32_16x16x32_bf16 v[190:193], a[192:195], a[24:27], v[190:193]
    ds_read_b64_tr_b16 a[180:181], v67 offset:36864
    ds_read_b64_tr_b16 a[182:183], v67 offset:51200
    v_mfma_f32_16x16x32_bf16 v[198:201], a[192:195], a[80:83], v[198:201]
    v_lshlrev_b32 v11, 16, v11
    v_mfma_f32_16x16x32_bf16 v[206:209], a[192:195], a[136:139], v[206:209]
    v_lshl_add_u32 v11, v8, 8, v11
    v_mfma_f32_16x16x32_bf16 v[194:197], a[196:199], a[24:27], v[194:197]
    ds_read_b64_tr_b16 a[184:185], v66 offset:37888
    ds_read_b64_tr_b16 a[186:187], v66 offset:52224
    v_mfma_f32_16x16x32_bf16 v[202:205], a[196:199], a[80:83], v[202:205]
    v_lshl_add_u32 v11, v2, 4, v11
    v_mfma_f32_16x16x32_bf16 v[210:213], a[196:199], a[136:139], v[210:213]
    s_lshl_b32 s63, s52, 1
    s_add_u32 s63, s63, s5
    s_lshl_b32 s3, s63, 6
    s_add_u32 s3, s3, s4
    s_lshl_b32 s3, s3, 11
    v_add_u32 v22, s3, v11
    s_waitcnt lgkmcnt(6)
    v_mfma_f32_16x16x32_bf16 v[214:217], a[24:27], a[168:171], v[214:217]
    ds_read_b64_tr_b16 a[188:189], v67 offset:37888
    ds_read_b64_tr_b16 a[190:191], v67 offset:52224
    v_mfma_f32_16x16x32_bf16 v[222:225], a[80:83], a[168:171], v[222:225]
    s_mul_i32 s82, s63, 56
    s_lshl_b32 s3, s51, 1
    s_add_u32 s3, s3, s4
    s_add_u32 s82, s82, s3
    s_lshl_b32 s82, s82, 11
    s_add_u32 s82, s82, 2097152
    v_mfma_f32_16x16x32_bf16 v[230:233], a[136:139], a[168:171], v[230:233]
    s_lshl_b32 s63, s63, 8
    s_add_u32 s63, s63, 6291456
    v_mfma_f32_16x16x32_bf16 v[218:221], a[24:27], a[172:175], v[218:221]
    ds_read_b64_tr_b16 a[192:193], v66 offset:38912
    ds_read_b64_tr_b16 a[194:195], v66 offset:53248
    v_mfma_f32_16x16x32_bf16 v[226:229], a[80:83], a[172:175], v[226:229]
    v_lshlrev_b32 v26, 2, v1
    v_mfma_f32_16x16x32_bf16 v[234:237], a[136:139], a[172:175], v[234:237]
    s_waitcnt lgkmcnt(6)
    v_mfma_f32_16x16x32_bf16 v[174:177], a[176:179], a[84:87], v[174:177]
    ds_read_b64_tr_b16 a[196:197], v67 offset:38912
    ds_read_b64_tr_b16 a[198:199], v67 offset:53248
    v_mfma_f32_16x16x32_bf16 v[182:185], a[176:179], a[140:143], v[182:185]
    v_mfma_f32_16x16x32_bf16 v[166:169], a[176:179], v[44:47], v[166:169]
    v_mfma_f32_16x16x32_bf16 v[178:181], a[180:183], a[84:87], v[178:181]
    s_waitcnt vmcnt(23)
    s_barrier
    ds_read_b64_tr_b16 a[168:169], v66 offset:11264
    ds_read_b64_tr_b16 a[170:171], v66 offset:25600
    v_mfma_f32_16x16x32_bf16 v[186:189], a[180:183], a[140:143], v[186:189]
    v_mfma_f32_16x16x32_bf16 v[170:173], a[180:183], v[44:47], v[170:173]
    s_waitcnt lgkmcnt(6)
    v_mfma_f32_16x16x32_bf16 v[190:193], a[184:187], a[28:31], v[190:193]
    ds_read_b64_tr_b16 a[172:173], v67 offset:11264
    ds_read_b64_tr_b16 a[174:175], v67 offset:25600
    v_mfma_f32_16x16x32_bf16 v[198:201], a[184:187], a[84:87], v[198:201]
    v_mfma_f32_16x16x32_bf16 v[206:209], a[184:187], a[140:143], v[206:209]
    v_mfma_f32_16x16x32_bf16 v[194:197], a[188:191], a[28:31], v[194:197]
    ds_read_b64_tr_b16 a[176:177], v66 offset:12288
    ds_read_b64_tr_b16 a[178:179], v66 offset:26624
    v_mfma_f32_16x16x32_bf16 v[202:205], a[188:191], a[84:87], v[202:205]
    v_mfma_f32_16x16x32_bf16 v[210:213], a[188:191], a[140:143], v[210:213]
    s_waitcnt lgkmcnt(6)
    v_mfma_f32_16x16x32_bf16 v[214:217], a[28:31], a[192:195], v[214:217]
    ds_read_b64_tr_b16 a[180:181], v67 offset:12288
    ds_read_b64_tr_b16 a[182:183], v67 offset:26624
    v_mfma_f32_16x16x32_bf16 v[222:225], a[84:87], a[192:195], v[222:225]
    v_mfma_f32_16x16x32_bf16 v[230:233], a[140:143], a[192:195], v[230:233]
    v_mfma_f32_16x16x32_bf16 v[218:221], a[28:31], a[196:199], v[218:221]
    ds_read_b64_tr_b16 a[184:185], v66 offset:13312
    ds_read_b64_tr_b16 a[186:187], v66 offset:27648
    v_mfma_f32_16x16x32_bf16 v[226:229], a[84:87], a[196:199], v[226:229]
    v_mfma_f32_16x16x32_bf16 v[234:237], a[140:143], a[196:199], v[234:237]
    s_waitcnt lgkmcnt(6)
    v_mfma_f32_16x16x32_bf16 v[174:177], a[168:171], a[88:91], v[174:177]
    ds_read_b64_tr_b16 a[188:189], v67 offset:13312
    ds_read_b64_tr_b16 a[190:191], v67 offset:27648
    v_mfma_f32_16x16x32_bf16 v[182:185], a[168:171], a[144:147], v[182:185]
    v_mfma_f32_16x16x32_bf16 v[166:169], a[168:171], v[44:47], v[166:169]
    v_mfma_f32_16x16x32_bf16 v[178:181], a[172:175], a[88:91], v[178:181]
    ds_read_b64_tr_b16 a[192:193], v66 offset:39936
    ds_read_b64_tr_b16 a[194:195], v66 offset:54272
    v_mfma_f32_16x16x32_bf16 v[186:189], a[172:175], a[144:147], v[186:189]
    v_mfma_f32_16x16x32_bf16 v[170:173], a[172:175], v[44:47], v[170:173]
    s_waitcnt lgkmcnt(6)
    v_mfma_f32_16x16x32_bf16 v[190:193], a[176:179], a[32:35], v[190:193]
    ds_read_b64_tr_b16 a[196:197], v67 offset:39936
    ds_read_b64_tr_b16 a[198:199], v67 offset:54272
    v_mfma_f32_16x16x32_bf16 v[198:201], a[176:179], a[88:91], v[198:201]
    v_mfma_f32_16x16x32_bf16 v[206:209], a[176:179], a[144:147], v[206:209]
    v_mfma_f32_16x16x32_bf16 v[194:197], a[180:183], a[32:35], v[194:197]
    ds_read_b64_tr_b16 a[168:169], v66 offset:40960
    ds_read_b64_tr_b16 a[170:171], v66 offset:55296
    v_mfma_f32_16x16x32_bf16 v[202:205], a[180:183], a[88:91], v[202:205]
    v_mfma_f32_16x16x32_bf16 v[210:213], a[180:183], a[144:147], v[210:213]
    s_waitcnt lgkmcnt(6)
    v_mfma_f32_16x16x32_bf16 v[214:217], a[32:35], a[184:187], v[214:217]
    ds_read_b64_tr_b16 a[172:173], v67 offset:40960
    ds_read_b64_tr_b16 a[174:175], v67 offset:55296
    v_mfma_f32_16x16x32_bf16 v[222:225], a[88:91], a[184:187], v[222:225]
    v_mfma_f32_16x16x32_bf16 v[230:233], a[144:147], a[184:187], v[230:233]
    v_mfma_f32_16x16x32_bf16 v[218:221], a[32:35], a[188:191], v[218:221]
    ds_read_b64_tr_b16 a[176:177], v66 offset:41984
    ds_read_b64_tr_b16 a[178:179], v66 offset:56320
    v_mfma_f32_16x16x32_bf16 v[226:229], a[88:91], a[188:191], v[226:229]
    v_mfma_f32_16x16x32_bf16 v[234:237], a[144:147], a[188:191], v[234:237]
    s_waitcnt lgkmcnt(6)
    v_mfma_f32_16x16x32_bf16 v[174:177], a[192:195], a[92:95], v[174:177]
    ds_read_b64_tr_b16 a[180:181], v67 offset:41984
    ds_read_b64_tr_b16 a[182:183], v67 offset:56320
    v_mfma_f32_16x16x32_bf16 v[182:185], a[192:195], a[148:151], v[182:185]
    v_mfma_f32_16x16x32_bf16 v[166:169], a[192:195], v[44:47], v[166:169]
    v_mfma_f32_16x16x32_bf16 v[178:181], a[196:199], a[92:95], v[178:181]
    s_waitcnt vmcnt(20)
    s_barrier
    ds_read_b64_tr_b16 a[184:185], v66 offset:14336
    ds_read_b64_tr_b16 a[186:187], v66 offset:28672
    v_mfma_f32_16x16x32_bf16 v[186:189], a[196:199], a[148:151], v[186:189]
    v_mfma_f32_16x16x32_bf16 v[170:173], a[196:199], v[44:47], v[170:173]
    s_waitcnt lgkmcnt(6)
    v_mfma_f32_16x16x32_bf16 v[190:193], a[168:171], a[36:39], v[190:193]
    ds_read_b64_tr_b16 a[188:189], v67 offset:14336
    ds_read_b64_tr_b16 a[190:191], v67 offset:28672
    v_mfma_f32_16x16x32_bf16 v[198:201], a[168:171], a[92:95], v[198:201]
    v_mfma_f32_16x16x32_bf16 v[206:209], a[168:171], a[148:151], v[206:209]
    v_mfma_f32_16x16x32_bf16 v[194:197], a[172:175], a[36:39], v[194:197]
    ds_read_b64_tr_b16 a[192:193], v66 offset:15360
    ds_read_b64_tr_b16 a[194:195], v66 offset:29696
    v_mfma_f32_16x16x32_bf16 v[202:205], a[172:175], a[92:95], v[202:205]
    v_mfma_f32_16x16x32_bf16 v[210:213], a[172:175], a[148:151], v[210:213]
    s_waitcnt lgkmcnt(6)
    v_mfma_f32_16x16x32_bf16 v[214:217], a[36:39], a[176:179], v[214:217]
    ds_read_b64_tr_b16 a[196:197], v67 offset:15360
    ds_read_b64_tr_b16 a[198:199], v67 offset:29696
    v_mfma_f32_16x16x32_bf16 v[222:225], a[92:95], a[176:179], v[222:225]
    v_mfma_f32_16x16x32_bf16 v[230:233], a[148:151], a[176:179], v[230:233]
    v_mfma_f32_16x16x32_bf16 v[218:221], a[36:39], a[180:183], v[218:221]
    ds_read_b64_tr_b16 a[168:169], v66 offset:16384
    ds_read_b64_tr_b16 a[170:171], v66 offset:30720
    v_mfma_f32_16x16x32_bf16 v[226:229], a[92:95], a[180:183], v[226:229]
    v_mfma_f32_16x16x32_bf16 v[234:237], a[148:151], a[180:183], v[234:237]
    s_waitcnt lgkmcnt(6)
    v_mfma_f32_16x16x32_bf16 v[174:177], a[184:187], a[96:99], v[174:177]
    ds_read_b64_tr_b16 a[172:173], v67 offset:16384
    ds_read_b64_tr_b16 a[174:175], v67 offset:30720
    v_mfma_f32_16x16x32_bf16 v[182:185], a[184:187], a[152:155], v[182:185]
    v_mfma_f32_16x16x32_bf16 v[166:169], a[184:187], v[44:47], v[166:169]
    v_mfma_f32_16x16x32_bf16 v[178:181], a[188:191], a[96:99], v[178:181]
    ds_read_b64_tr_b16 a[176:177], v66 offset:43008
    ds_read_b64_tr_b16 a[178:179], v66 offset:57344
    v_mfma_f32_16x16x32_bf16 v[186:189], a[188:191], a[152:155], v[186:189]
    v_mfma_f32_16x16x32_bf16 v[170:173], a[188:191], v[44:47], v[170:173]
    s_waitcnt lgkmcnt(6)
    v_mfma_f32_16x16x32_bf16 v[190:193], a[192:195], a[40:43], v[190:193]
    ds_read_b64_tr_b16 a[180:181], v67 offset:43008
    ds_read_b64_tr_b16 a[182:183], v67 offset:57344
    v_mfma_f32_16x16x32_bf16 v[198:201], a[192:195], a[96:99], v[198:201]
    v_mfma_f32_16x16x32_bf16 v[206:209], a[192:195], a[152:155], v[206:209]
    v_mfma_f32_16x16x32_bf16 v[194:197], a[196:199], a[40:43], v[194:197]
    ds_read_b64_tr_b16 a[184:185], v66 offset:44032
    ds_read_b64_tr_b16 a[186:187], v66 offset:58368
    v_mfma_f32_16x16x32_bf16 v[202:205], a[196:199], a[96:99], v[202:205]
    v_mfma_f32_16x16x32_bf16 v[210:213], a[196:199], a[152:155], v[210:213]
    s_waitcnt lgkmcnt(6)
    v_mfma_f32_16x16x32_bf16 v[214:217], a[40:43], a[168:171], v[214:217]
    ds_read_b64_tr_b16 a[188:189], v67 offset:44032
    ds_read_b64_tr_b16 a[190:191], v67 offset:58368
    v_mfma_f32_16x16x32_bf16 v[222:225], a[96:99], a[168:171], v[222:225]
    v_mfma_f32_16x16x32_bf16 v[230:233], a[152:155], a[168:171], v[230:233]
    v_mfma_f32_16x16x32_bf16 v[218:221], a[40:43], a[172:175], v[218:221]
    ds_read_b64_tr_b16 a[192:193], v66 offset:45056
    ds_read_b64_tr_b16 a[194:195], v66 offset:59392
    v_mfma_f32_16x16x32_bf16 v[226:229], a[96:99], a[172:175], v[226:229]
    v_mfma_f32_16x16x32_bf16 v[234:237], a[152:155], a[172:175], v[234:237]
    s_waitcnt lgkmcnt(6)
    v_mfma_f32_16x16x32_bf16 v[174:177], a[176:179], a[100:103], v[174:177]
    ds_read_b64_tr_b16 a[196:197], v67 offset:45056
    ds_read_b64_tr_b16 a[198:199], v67 offset:59392
    v_mfma_f32_16x16x32_bf16 v[182:185], a[176:179], a[156:159], v[182:185]
    v_mfma_f32_16x16x32_bf16 v[166:169], a[176:179], v[44:47], v[166:169]
    v_mfma_f32_16x16x32_bf16 v[178:181], a[180:183], a[100:103], v[178:181]
    s_waitcnt vmcnt(17)
    s_barrier
    ds_read_b64_tr_b16 a[168:169], v66 offset:17408
    ds_read_b64_tr_b16 a[170:171], v66 offset:31744
    v_mfma_f32_16x16x32_bf16 v[186:189], a[180:183], a[156:159], v[186:189]
    v_mfma_f32_16x16x32_bf16 v[170:173], a[180:183], v[44:47], v[170:173]
    s_waitcnt lgkmcnt(6)
    v_mfma_f32_16x16x32_bf16 v[190:193], a[184:187], a[44:47], v[190:193]
    ds_read_b64_tr_b16 a[172:173], v67 offset:17408
    ds_read_b64_tr_b16 a[174:175], v67 offset:31744
    v_mfma_f32_16x16x32_bf16 v[198:201], a[184:187], a[100:103], v[198:201]
    v_mfma_f32_16x16x32_bf16 v[206:209], a[184:187], a[156:159], v[206:209]
    v_mfma_f32_16x16x32_bf16 v[194:197], a[188:191], a[44:47], v[194:197]
    ds_read_b64_tr_b16 a[176:177], v66 offset:18432
    ds_read_b64_tr_b16 a[178:179], v66 offset:32768
    v_mfma_f32_16x16x32_bf16 v[202:205], a[188:191], a[100:103], v[202:205]
    v_mfma_f32_16x16x32_bf16 v[210:213], a[188:191], a[156:159], v[210:213]
    s_waitcnt lgkmcnt(6)
    v_mfma_f32_16x16x32_bf16 v[214:217], a[44:47], a[192:195], v[214:217]
    ds_read_b64_tr_b16 a[180:181], v67 offset:18432
    ds_read_b64_tr_b16 a[182:183], v67 offset:32768
    v_mfma_f32_16x16x32_bf16 v[222:225], a[100:103], a[192:195], v[222:225]
    v_mfma_f32_16x16x32_bf16 v[230:233], a[156:159], a[192:195], v[230:233]
    v_mfma_f32_16x16x32_bf16 v[218:221], a[44:47], a[196:199], v[218:221]
    ds_read_b64_tr_b16 a[184:185], v66 offset:19456
    ds_read_b64_tr_b16 a[186:187], v66 offset:33792
    v_mfma_f32_16x16x32_bf16 v[226:229], a[100:103], a[196:199], v[226:229]
    v_mfma_f32_16x16x32_bf16 v[234:237], a[156:159], a[196:199], v[234:237]
    s_waitcnt lgkmcnt(6)
    v_mfma_f32_16x16x32_bf16 v[174:177], a[168:171], a[104:107], v[174:177]
    ds_read_b64_tr_b16 a[188:189], v67 offset:19456
    ds_read_b64_tr_b16 a[190:191], v67 offset:33792
    v_mfma_f32_16x16x32_bf16 v[182:185], a[168:171], a[160:163], v[182:185]
    v_mfma_f32_16x16x32_bf16 v[166:169], a[168:171], v[44:47], v[166:169]
    v_mfma_f32_16x16x32_bf16 v[178:181], a[172:175], a[104:107], v[178:181]
    ds_read_b64_tr_b16 a[192:193], v66 offset:46080
    ds_read_b64_tr_b16 a[194:195], v66 offset:60416
    v_mfma_f32_16x16x32_bf16 v[186:189], a[172:175], a[160:163], v[186:189]
    v_mfma_f32_16x16x32_bf16 v[170:173], a[172:175], v[44:47], v[170:173]
    s_waitcnt lgkmcnt(6)
    v_mfma_f32_16x16x32_bf16 v[190:193], a[176:179], a[48:51], v[190:193]
    ds_read_b64_tr_b16 a[196:197], v67 offset:46080
    ds_read_b64_tr_b16 a[198:199], v67 offset:60416
    v_mfma_f32_16x16x32_bf16 v[198:201], a[176:179], a[104:107], v[198:201]
    v_mfma_f32_16x16x32_bf16 v[206:209], a[176:179], a[160:163], v[206:209]
    v_mfma_f32_16x16x32_bf16 v[194:197], a[180:183], a[48:51], v[194:197]
    ds_read_b64_tr_b16 a[168:169], v66 offset:47104
    ds_read_b64_tr_b16 a[170:171], v66 offset:61440
    v_mfma_f32_16x16x32_bf16 v[202:205], a[180:183], a[104:107], v[202:205]
    v_mfma_f32_16x16x32_bf16 v[210:213], a[180:183], a[160:163], v[210:213]
    s_waitcnt lgkmcnt(6)
    v_mfma_f32_16x16x32_bf16 v[214:217], a[48:51], a[184:187], v[214:217]
    ds_read_b64_tr_b16 a[172:173], v67 offset:47104
    ds_read_b64_tr_b16 a[174:175], v67 offset:61440
    v_mfma_f32_16x16x32_bf16 v[222:225], a[104:107], a[184:187], v[222:225]
    v_mfma_f32_16x16x32_bf16 v[230:233], a[160:163], a[184:187], v[230:233]
    v_mfma_f32_16x16x32_bf16 v[218:221], a[48:51], a[188:191], v[218:221]
    ds_read_b64_tr_b16 a[176:177], v66 offset:48128
    ds_read_b64_tr_b16 a[178:179], v66 offset:62464
    v_mfma_f32_16x16x32_bf16 v[226:229], a[104:107], a[188:191], v[226:229]
    v_mfma_f32_16x16x32_bf16 v[234:237], a[160:163], a[188:191], v[234:237]
    s_waitcnt lgkmcnt(6)
    v_mfma_f32_16x16x32_bf16 v[174:177], a[192:195], a[108:111], v[174:177]
    ds_read_b64_tr_b16 a[180:181], v67 offset:48128
    ds_read_b64_tr_b16 a[182:183], v67 offset:62464
    v_mfma_f32_16x16x32_bf16 v[182:185], a[192:195], a[164:167], v[182:185]
    v_mfma_f32_16x16x32_bf16 v[166:169], a[192:195], v[44:47], v[166:169]
    v_mfma_f32_16x16x32_bf16 v[178:181], a[196:199], a[108:111], v[178:181]
    v_mfma_f32_16x16x32_bf16 v[186:189], a[196:199], a[164:167], v[186:189]
    v_mfma_f32_16x16x32_bf16 v[170:173], a[196:199], v[44:47], v[170:173]
    s_waitcnt lgkmcnt(4)
    v_mfma_f32_16x16x32_bf16 v[190:193], a[168:171], a[52:55], v[190:193]
    v_mfma_f32_16x16x32_bf16 v[198:201], a[168:171], a[108:111], v[198:201]
    v_mfma_f32_16x16x32_bf16 v[206:209], a[168:171], a[164:167], v[206:209]
    v_mfma_f32_16x16x32_bf16 v[194:197], a[172:175], a[52:55], v[194:197]
    v_mfma_f32_16x16x32_bf16 v[202:205], a[172:175], a[108:111], v[202:205]
    v_mfma_f32_16x16x32_bf16 v[210:213], a[172:175], a[164:167], v[210:213]
    s_waitcnt lgkmcnt(0)
    v_mfma_f32_16x16x32_bf16 v[214:217], a[52:55], a[176:179], v[214:217]
    v_mfma_f32_16x16x32_bf16 v[222:225], a[108:111], a[176:179], v[222:225]
    v_mfma_f32_16x16x32_bf16 v[230:233], a[164:167], a[176:179], v[230:233]
    v_mfma_f32_16x16x32_bf16 v[218:221], a[52:55], a[180:183], v[218:221]
    v_mfma_f32_16x16x32_bf16 v[226:229], a[108:111], a[180:183], v[226:229]
    v_mfma_f32_16x16x32_bf16 v[234:237], a[164:167], a[180:183], v[234:237]
    s_barrier
    v_mov_b32_dpp v28, v190 row_newbcast:0 row_mask:0xf bank_mask:0xf
    s_add_u32 m0, s58, 65536
    s_add_u32 s0, s0, 4096
    s_and_b32 s0, s0, 0xffff
    s_mul_i32 s62, s0, 112
    buffer_load_dwordx4 v18, s[20:23], s62 offen lds
    v_mov_b32_dpp v29, v191 row_newbcast:0 row_mask:0xf bank_mask:0xf
    v_mov_b32_dpp v30, v192 row_newbcast:0 row_mask:0xf bank_mask:0xf
    v_mov_b32_dpp v31, v193 row_newbcast:0 row_mask:0xf bank_mask:0xf
    v_mov_b32_dpp v32, v194 row_newbcast:0 row_mask:0xf bank_mask:0xf
    v_mov_b32_dpp v33, v195 row_newbcast:0 row_mask:0xf bank_mask:0xf
    v_mov_b32_dpp v34, v196 row_newbcast:0 row_mask:0xf bank_mask:0xf
    v_mov_b32_dpp v35, v197 row_newbcast:0 row_mask:0xf bank_mask:0xf
    v_mfma_f32_16x16x4_f32 v[72:75], v49, v214, 0
    v_mfma_f32_16x16x4_f32 v[76:79], v49, v218, 0
    buffer_load_dwordx4 v19, s[20:23], s62 offen offset:1024 lds
    v_pk_fma_f32 v[174:175], v[114:115], v[166:167], v[174:175] op_sel_hi:[0,1,1]
    v_pk_fma_f32 v[176:177], v[114:115], v[168:169], v[176:177] op_sel_hi:[0,1,1]
    v_pk_fma_f32 v[178:179], v[114:115], v[170:171], v[178:179] op_sel_hi:[0,1,1]
    v_pk_fma_f32 v[180:181], v[114:115], v[172:173], v[180:181] op_sel_hi:[0,1,1]
    v_cvt_pk_bf16_f32 v50, v174, v175
    v_cvt_pk_bf16_f32 v51, v176, v177
    v_cvt_pk_bf16_f32 v52, v178, v179
    v_cvt_pk_bf16_f32 v53, v180, v181
    v_cndmask_b32 v52, v52, 0, s[76:77]
    v_cndmask_b32 v53, v53, 0, s[76:77]
    v_pk_fma_f32 v[182:183], v[116:117], v[166:167], v[182:183] op_sel_hi:[0,1,1]
    v_pk_fma_f32 v[184:185], v[116:117], v[168:169], v[184:185] op_sel_hi:[0,1,1]
    v_pk_fma_f32 v[186:187], v[116:117], v[170:171], v[186:187] op_sel_hi:[0,1,1]
    v_pk_fma_f32 v[188:189], v[116:117], v[172:173], v[188:189] op_sel_hi:[0,1,1]
    v_cvt_pk_bf16_f32 v54, v182, v183
    v_cvt_pk_bf16_f32 v55, v184, v185
    buffer_load_dwordx4 v20, s[20:23], s62 offen offset:2048 lds
    v_cvt_pk_bf16_f32 v56, v186, v187
    v_cvt_pk_bf16_f32 v57, v188, v189
    v_cndmask_b32 v56, v56, 0, s[76:77]
    v_cndmask_b32 v57, v57, 0, s[76:77]
    v_pk_fma_f32 v[190:191], v[112:113], v[28:29], v[190:191] op_sel_hi:[0,1,1]
    v_pk_fma_f32 v[192:193], v[112:113], v[30:31], v[192:193] op_sel_hi:[0,1,1]
    v_pk_fma_f32 v[194:195], v[112:113], v[32:33], v[194:195] op_sel_hi:[0,1,1]
    v_pk_fma_f32 v[196:197], v[112:113], v[34:35], v[196:197] op_sel_hi:[0,1,1]
    v_cvt_pk_bf16_f32 v142, v190, v191
    v_cvt_pk_bf16_f32 v143, v192, v193
    v_cvt_pk_bf16_f32 v144, v194, v195
    v_cvt_pk_bf16_f32 v145, v196, v197
    v_pk_fma_f32 v[198:199], v[114:115], v[28:29], v[198:199] op_sel_hi:[0,1,1]
    v_pk_fma_f32 v[200:201], v[114:115], v[30:31], v[200:201] op_sel_hi:[0,1,1]
    v_pk_fma_f32 v[202:203], v[114:115], v[32:33], v[202:203] op_sel_hi:[0,1,1]
    v_pk_fma_f32 v[204:205], v[114:115], v[34:35], v[204:205] op_sel_hi:[0,1,1]
    buffer_load_dwordx4 v21, s[20:23], s62 offen offset:3072 lds
    v_cvt_pk_bf16_f32 v146, v198, v199
    v_cvt_pk_bf16_f32 v147, v200, v201
    v_cvt_pk_bf16_f32 v148, v202, v203
    v_cvt_pk_bf16_f32 v149, v204, v205
    v_pk_fma_f32 v[206:207], v[116:117], v[28:29], v[206:207] op_sel_hi:[0,1,1]
    v_pk_fma_f32 v[208:209], v[116:117], v[30:31], v[208:209] op_sel_hi:[0,1,1]
    v_pk_fma_f32 v[210:211], v[116:117], v[32:33], v[210:211] op_sel_hi:[0,1,1]
    v_pk_fma_f32 v[212:213], v[116:117], v[34:35], v[212:213] op_sel_hi:[0,1,1]
    v_cvt_pk_bf16_f32 v80, v206, v207
    v_cvt_pk_bf16_f32 v81, v208, v209
    v_cvt_pk_bf16_f32 v82, v210, v211
    v_cvt_pk_bf16_f32 v83, v212, v213
    v_mfma_f32_16x16x32_bf16 v[96:99], v[142:145], v[50:53], 0
    s_add_u32 m0, s58, 81920
    s_add_u32 s0, s0, 4096
    s_and_b32 s0, s0, 0xffff
    s_mul_i32 s62, s0, 112
    buffer_load_dwordx4 v18, s[20:23], s62 offen lds
    v_mfma_f32_16x16x32_bf16 v[100:103], v[146:149], v[50:53], 0
    v_mfma_f32_16x16x32_bf16 v[104:107], v[146:149], v[54:57], 0
    v_mfma_f32_16x16x32_bf16 v[108:111], v[80:83], v[54:57], 0
    v_pk_fma_f32 v[214:215], v[130:131], v[72:73], v[214:215]
    v_pk_fma_f32 v[216:217], v[132:133], v[72:73], v[216:217]
    v_cvt_pk_bf16_f32 v84, v214, v215
    v_cvt_pk_bf16_f32 v85, v216, v217
    buffer_load_dwordx4 v19, s[20:23], s62 offen offset:1024 lds
    v_pk_fma_f32 v[222:223], v[134:135], v[72:73], v[222:223]
    v_pk_fma_f32 v[224:225], v[136:137], v[72:73], v[224:225]
    v_cvt_pk_bf16_f32 v86, v222, v223
    v_cvt_pk_bf16_f32 v87, v224, v225
    v_cndmask_b32 v158, v96, v97, s[70:71]
    v_cndmask_b32 v158, v70, v158, s[80:81]
    v_cndmask_b32 v161, v100, v101, s[70:71]
    v_cndmask_b32 v158, v158, v161, s[72:73]
    v_mul_f32 v158, v158, v242
    v_cndmask_b32 v159, v98, v99, s[70:71]
    v_cndmask_b32 v159, v70, v159, s[80:81]
    v_cndmask_b32 v161, v102, v103, s[70:71]
    v_cndmask_b32 v159, v159, v161, s[74:75]
    v_mul_f32 v159, v159, v243
    v_cndmask_b32 v162, v104, v105, s[70:71]
    v_cndmask_b32 v165, v108, v109, s[70:71]
    buffer_load_dwordx4 v20, s[20:23], s62 offen offset:2048 lds
    v_cndmask_b32 v162, v162, v165, s[72:73]
    v_mul_f32 v162, v162, v244
    v_cndmask_b32 v163, v106, v107, s[70:71]
    v_cndmask_b32 v165, v110, v111, s[70:71]
    v_cndmask_b32 v163, v163, v165, s[74:75]
    v_mul_f32 v163, v163, v245
    v_max_f32 v160, v158, v159
    v_max_f32 v164, v162, v163
    v_mov_b32 v161, v160
    v_mov_b32 v165, v164
    v_pk_fma_f32 v[230:231], v[138:139], v[72:73], v[230:231]
    v_pk_fma_f32 v[232:233], v[140:141], v[72:73], v[232:233]
    v_permlane16_swap_b32 v160, v161
    v_permlane16_swap_b32 v164, v165
    v_max_f32 v160, v160, v161
    v_max_f32 v164, v164, v165
    buffer_load_dwordx4 v21, s[20:23], s62 offen offset:3072 lds
    v_mov_b32 v161, v160
    v_mov_b32 v165, v164
    v_cvt_pk_bf16_f32 v88, v230, v231
    v_cvt_pk_bf16_f32 v89, v232, v233
    v_permlane32_swap_b32 v160, v161
    v_permlane32_swap_b32 v164, v165
    v_max_f32 v160, v160, v161
    v_max_f32 v164, v164, v165
    v_sub_f32 v158, v158, v160
    v_sub_f32 v159, v159, v160
    v_sub_f32 v162, v162, v164
    v_sub_f32 v163, v163, v164
    v_mul_f32 v158, v246, v158
    v_mul_f32 v159, v246, v159
    v_mul_f32 v162, v247, v162
    v_mul_f32 v163, v247, v163
    s_add_u32 m0, s58, 98304
    s_add_u32 s0, s0, 4096
    s_and_b32 s0, s0, 0xffff
    s_mul_i32 s62, s0, 112
    buffer_load_dwordx4 v18, s[20:23], s62 offen lds
    v_exp_f32 v158, v158
    v_exp_f32 v159, v159
    v_exp_f32 v162, v162
    v_exp_f32 v163, v163
    v_add_f32 v160, v158, v159
    v_add_f32 v164, v162, v163
    v_mov_b32 v161, v160
    v_mov_b32 v165, v164
    v_pk_fma_f32 v[218:219], v[130:131], v[76:77], v[218:219]
    v_pk_fma_f32 v[220:221], v[132:133], v[76:77], v[220:221]
    v_permlane16_swap_b32 v160, v161
    v_permlane16_swap_b32 v164, v165
    buffer_load_dwordx4 v19, s[20:23], s62 offen offset:1024 lds
    v_add_f32 v160, v160, v161
    v_add_f32 v164, v164, v165
    v_mov_b32 v161, v160
    v_mov_b32 v165, v164
    v_cvt_pk_bf16_f32 v90, v218, v219
    v_cvt_pk_bf16_f32 v91, v220, v221
    v_permlane32_swap_b32 v160, v161
    v_permlane32_swap_b32 v164, v165
    v_add_f32 v160, v160, v161
    v_add_f32 v164, v164, v165
    v_rcp_f32 v160, v160
    v_rcp_f32 v164, v164
    v_mul_f32 v158, v158, v242
    v_mul_f32 v159, v159, v243
    buffer_load_dwordx4 v20, s[20:23], s62 offen offset:2048 lds
    v_mul_f32 v162, v162, v244
    v_mul_f32 v163, v163, v245
    v_mul_f32 v158, v158, v160
    v_mul_f32 v159, v159, v160
    v_mul_f32 v162, v162, v164
    v_mul_f32 v163, v163, v164
    v_cvt_pk_bf16_f32 v158, v158, v158
    v_cvt_pk_bf16_f32 v159, v159, v159
    v_cvt_pk_bf16_f32 v162, v162, v162
    v_cvt_pk_bf16_f32 v163, v163, v163
    v_and_b32 v150, v158, v238
    v_and_b32 v151, v159, v239
    v_and_b32 v152, v158, v240
    v_and_b32 v153, v159, v241
    v_and_b32 v154, v162, v238
    v_and_b32 v155, v163, v239
    buffer_load_dwordx4 v21, s[20:23], s62 offen offset:3072 lds
    v_and_b32 v156, v162, v240
    v_and_b32 v157, v163, v241
    v_pk_fma_f32 v[226:227], v[134:135], v[76:77], v[226:227]
    v_pk_fma_f32 v[228:229], v[136:137], v[76:77], v[228:229]
    v_cvt_pk_bf16_f32 v92, v226, v227
    v_cvt_pk_bf16_f32 v93, v228, v229
    v_pk_fma_f32 v[234:235], v[138:139], v[76:77], v[234:235]
    v_pk_fma_f32 v[236:237], v[140:141], v[76:77], v[236:237]
    v_cvt_pk_bf16_f32 v94, v234, v235
    v_cvt_pk_bf16_f32 v95, v236, v237
    v_mfma_f32_16x16x32_bf16 v[174:177], v[84:87], v[150:153], 0
    v_mfma_f32_16x16x32_bf16 v[178:181], v[90:93], v[150:153], 0
    s_add_u32 m0, s58, 114688
    s_add_u32 s0, s0, 4096
    s_and_b32 s0, s0, 0xffff
    s_mul_i32 s62, s0, 112
    buffer_load_dwordx4 v18, s[20:23], s62 offen lds
    v_mfma_f32_16x16x32_bf16 v[182:185], v[86:89], v[154:157], 0
    v_mfma_f32_16x16x32_bf16 v[186:189], v[92:95], v[154:157], 0
    s_lshl_b32 s67, s59, 5
    s_add_u32 s67, s67, s50
    s_lshl_b32 s100, s67, 10
    s_add_u32 s100, s100, 4194304
    s_add_u32 s101, s100, 16384
    s_lshl_b32 s67, s67, 2
    s_add_u32 s67, s67, 6307840
    buffer_load_dwordx4 v19, s[20:23], s62 offen offset:1024 lds
    buffer_load_dwordx4 v20, s[20:23], s62 offen offset:2048 lds
    buffer_load_dwordx4 v21, s[20:23], s62 offen offset:3072 lds
    buffer_load_dword v25, v26, s[28:31], s63 offen sc1
    v_cvt_pk_bf16_f32 v28, v174, v175
    v_cvt_pk_bf16_f32 v29, v176, v177
    v_cvt_pk_bf16_f32 v30, v178, v179
    v_cvt_pk_bf16_f32 v31, v180, v181
    v_cndmask_b32 v30, v30, 0, s[76:77]
    v_cndmask_b32 v31, v31, 0, s[76:77]
    v_cvt_pk_bf16_f32 v32, v182, v183
    v_cvt_pk_bf16_f32 v33, v184, v185
    v_cvt_pk_bf16_f32 v34, v186, v187
    v_cvt_pk_bf16_f32 v35, v188, v189
    v_cndmask_b32 v34, v34, 0, s[76:77]
    v_cndmask_b32 v35, v35, 0, s[76:77]
    s_cmp_eq_u32 s55, 0
    s_cbranch_scc1 L_nog1
    s_waitcnt vmcnt(0)
    v_cmp_ne_u32 vcc, s57, v25
    s_cbranch_vccz L_pollok0
    s_mov_b32 s61, 0
L_poll0:
    s_sleep 4
    buffer_load_dword v25, v26, s[28:31], s63 offen sc1
    s_add_u32 s61, s61, 1
    s_waitcnt vmcnt(0)
    v_cmp_ne_u32 vcc, s57, v25
    s_cbranch_vccz L_pollok0
    s_cmp_lt_u32 s61, 20000
    s_cbranch_scc1 L_poll0
L_pollok0:
    s_add_u32 s1, s1, 4096
    s_and_b32 s1, s1, 0xffff
    buffer_load_dwordx4 a[0:3], v22, s[28:31], s1 offen offset:0 sc1
    buffer_load_dwordx4 a[4:7], v22, s[28:31], s1 offen offset:512 sc1
    buffer_load_dwordx4 a[8:11], v22, s[28:31], s1 offen offset:1024 sc1
    buffer_load_dwordx4 a[12:15], v22, s[28:31], s1 offen offset:1536 sc1
    v_lshrrev_b32 v8, 5, v1
    v_lshlrev_b32 v8, 3, v8
    s_lshl_b32 s3, s51, 1
    s_add_u32 s3, s3, s4
    s_lshl_b32 s3, s3, 6
    buffer_load_dwordx2 v[122:123], v8, s[36:39], s3 offen offset:0
    buffer_load_dwordx2 v[124:125], v8, s[36:39], s3 offen offset:16
    buffer_load_dwordx2 v[126:127], v8, s[36:39], s3 offen offset:32
    buffer_load_dwordx2 v[128:129], v8, s[36:39], s3 offen offset:48
    s_add_u32 s1, s1, 4096
    s_and_b32 s1, s1, 0xffff
    buffer_load_dwordx4 a[16:19], v22, s[28:31], s1 offen offset:0 sc1
    buffer_load_dwordx4 a[20:23], v22, s[28:31], s1 offen offset:512 sc1
    buffer_load_dwordx4 a[24:27], v22, s[28:31], s1 offen offset:1024 sc1
    buffer_load_dwordx4 a[28:31], v22, s[28:31], s1 offen offset:1536 sc1
    s_add_u32 s1, s1, 4096
    s_and_b32 s1, s1, 0xffff
    buffer_load_dwordx4 a[32:35], v22, s[28:31], s1 offen offset:0 sc1
    buffer_load_dwordx4 a[36:39], v22, s[28:31], s1 offen offset:512 sc1
    buffer_load_dwordx4 a[40:43], v22, s[28:31], s1 offen offset:1024 sc1
    buffer_load_dwordx4 a[44:47], v22, s[28:31], s1 offen offset:1536 sc1
    s_lshl_b32 s69, s52, 1
    s_add_u32 s69, s69, s5
    s_lshl_b32 s69, s69, 1
    s_and_b32 s3, s51, 1
    s_add_u32 s69, s69, s3
    s_lshl_b32 s69, s69, 5
    s_and_b32 s3, s51, 30
    s_add_u32 s69, s69, s3
    s_add_u32 s69, s69, s4
    s_lshl_b32 s69, s69, 2
    s_add_u32 s69, s69, 6299648
    v_add_u32 v119, s58, v4
    s_add_u32 m0, s58, 131072
    s_add_u32 s0, s0, 4096
    s_and_b32 s0, s0, 0xffff
    s_mul_i32 s62, s0, 112
    buffer_load_dwordx4 v18, s[20:23], s62 offen lds
    buffer_load_dwordx4 v19, s[20:23], s62 offen offset:1024 lds
    buffer_load_dwordx4 v20, s[20:23], s62 offen offset:2048 lds
    buffer_load_dwordx4 v21, s[20:23], s62 offen offset:3072 lds
    buffer_store_dwordx4 v[28:31], v4, s[28:31], s100 offen sc1
    buffer_store_dwordx4 v[32:35], v4, s[28:31], s101 offen sc1
    s_waitcnt vmcnt(17)
    v_lshlrev_b32 v36, 16, v122
    v_and_b32 v37, 0xffff0000, v122
    v_lshlrev_b32 v38, 16, v123
    v_and_b32 v39, 0xffff0000, v123
    s_waitcnt vmcnt(16)
    v_lshlrev_b32 v40, 16, v124
    v_and_b32 v41, 0xffff0000, v124
    v_lshlrev_b32 v42, 16, v125
    v_and_b32 v43, 0xffff0000, v125
    s_waitcnt vmcnt(15)
    v_lshlrev_b32 v44, 16, v126
    v_and_b32 v45, 0xffff0000, v126
    v_lshlrev_b32 v46, 16, v127
    v_and_b32 v47, 0xffff0000, v127
    s_waitcnt vmcnt(14)
    v_lshlrev_b32 v48, 16, v128
    v_and_b32 v49, 0xffff0000, v128
    v_lshlrev_b32 v50, 16, v129
    v_and_b32 v51, 0xffff0000, v129
    s_barrier
    ds_read_b64_tr_b16 v[68:69], v12 offset:0
    s_add_u32 s1, s1, 4096
    s_and_b32 s1, s1, 0xffff
    buffer_load_dwordx4 a[48:51], v22, s[28:31], s1 offen offset:0 sc1
    ds_read_b64_tr_b16 v[70:71], v12 offset:2048
    ds_read_b64_tr_b16 v[72:73], v13 offset:0
    ds_read_b64_tr_b16 v[74:75], v13 offset:2048
    ds_read_b64_tr_b16 v[76:77], v12 offset:1024
    ds_read_b64_tr_b16 v[78:79], v12 offset:3072
    ds_read_b64_tr_b16 v[80:81], v13 offset:1024
    ds_read_b64_tr_b16 v[82:83], v13 offset:3072
    ds_read_b64_tr_b16 v[84:85], v12 offset:4096
    ds_read_b64_tr_b16 v[86:87], v12 offset:6144
    ds_read_b64_tr_b16 v[88:89], v13 offset:4096
    ds_read_b64_tr_b16 v[90:91], v13 offset:6144
    s_waitcnt lgkmcnt(8)
    v_mfma_f32_32x32x16_bf16 v[36:51], v[68:71], a[0:3], v[36:51]
    buffer_load_dwordx4 a[52:55], v22, s[28:31], s1 offen offset:512 sc1
    ds_read_b64_tr_b16 v[92:93], v12 offset:5120
    ds_read_b64_tr_b16 v[94:95], v12 offset:7168
    s_lshl_b32 s3, s48, 17
    s_lshl_b32 s6, s53, 7
    s_add_u32 s3, s3, s6
    v_lshl_add_u32 v8, v5, 12, v23
    v_mfma_f32_32x32x16_bf16 v[52:67], v[72:75], a[0:3], 0
    buffer_load_dwordx4 a[56:59], v22, s[28:31], s1 offen offset:1024 sc1
    ds_read_b64_tr_b16 v[96:97], v13 offset:5120
    ds_read_b64_tr_b16 v[98:99], v13 offset:7168
    v_add_u32 v109, s3, v8
    s_waitcnt lgkmcnt(8)
    v_mfma_f32_32x32x16_bf16 v[36:51], v[76:79], a[4:7], v[36:51]
    buffer_load_dwordx4 a[60:63], v22, s[28:31], s1 offen offset:1536 sc1
    ds_read_b64_tr_b16 v[68:69], v12 offset:16384
    ds_read_b64_tr_b16 v[70:71], v12 offset:18432
    v_add_u32 v110, 31744, v109
    v_mfma_f32_32x32x16_bf16 v[52:67], v[80:83], a[4:7], v[52:67]
    s_add_u32 m0, s58, 147456
    s_add_u32 s0, s0, 4096
    s_and_b32 s0, s0, 0xffff
    s_mul_i32 s62, s0, 112
    buffer_load_dwordx4 v18, s[20:23], s62 offen lds
    ds_read_b64_tr_b16 v[72:73], v13 offset:16384
    ds_read_b64_tr_b16 v[74:75], v13 offset:18432
    v_add_u32 v111, 63488, v109
    s_waitcnt lgkmcnt(8)
    v_mfma_f32_32x32x16_bf16 v[36:51], v[84:87], a[8:11], v[36:51]
    buffer_load_dwordx4 v19, s[20:23], s62 offen offset:1024 lds
    ds_read_b64_tr_b16 v[76:77], v12 offset:17408
    ds_read_b64_tr_b16 v[78:79], v12 offset:19456
    v_add_u32 v112, 95232, v109
    v_mfma_f32_32x32x16_bf16 v[52:67], v[88:91], a[8:11], v[52:67]
    buffer_load_dwordx4 v20, s[20:23], s62 offen offset:2048 lds
    ds_read_b64_tr_b16 v[80:81], v13 offset:17408
    ds_read_b64_tr_b16 v[82:83], v13 offset:19456
    v_mul_u32_u24 v8, 896, v5
    s_waitcnt lgkmcnt(8)
    v_mfma_f32_32x32x16_bf16 v[36:51], v[92:95], a[12:15], v[36:51]
    buffer_load_dwordx4 v21, s[20:23], s62 offen offset:3072 lds
    ds_read_b64_tr_b16 v[84:85], v12 offset:20480
    ds_read_b64_tr_b16 v[86:87], v12 offset:22528
    v_add_u32 v113, v8, v23
    v_mfma_f32_32x32x16_bf16 v[52:67], v[96:99], a[12:15], v[52:67]
    s_add_u32 s1, s1, 4096
    s_and_b32 s1, s1, 0xffff
    buffer_load_dwordx4 a[64:67], v22, s[28:31], s1 offen offset:0 sc1
    ds_read_b64_tr_b16 v[88:89], v13 offset:20480
    ds_read_b64_tr_b16 v[90:91], v13 offset:22528
    v_add_u32 v114, 6144, v113
    s_waitcnt vmcnt(22) lgkmcnt(8)
    v_mfma_f32_32x32x16_bf16 v[36:51], v[68:71], a[16:19], v[36:51]
    buffer_load_dwordx4 a[68:71], v22, s[28:31], s1 offen offset:512 sc1
    ds_read_b64_tr_b16 v[92:93], v12 offset:21504
    ds_read_b64_tr_b16 v[94:95], v12 offset:23552
    v_lshl_add_u32 v118, v6, 4, v8
    v_mfma_f32_32x32x16_bf16 v[52:67], v[72:75], a[16:19], v[52:67]
    buffer_load_dwordx4 a[72:75], v22, s[28:31], s1 offen offset:1024 sc1
    ds_read_b64_tr_b16 v[96:97], v13 offset:21504
    ds_read_b64_tr_b16 v[98:99], v13 offset:23552
    s_mul_i32 s66, s4, 25088
    s_mul_i32 s3, s5, 14336
    s_add_u32 s66, s66, s3
    s_waitcnt vmcnt(23) lgkmcnt(8)
    v_mfma_f32_32x32x16_bf16 v[36:51], v[76:79], a[20:23], v[36:51]
    buffer_load_dwordx4 a[76:79], v22, s[28:31], s1 offen offset:1536 sc1
    ds_read_b64_tr_b16 v[68:69], v12 offset:32768
    ds_read_b64_tr_b16 v[70:71], v12 offset:34816
    s_lshl_b32 s3, s54, 7
    s_add_u32 s66, s66, s3
    v_mfma_f32_32x32x16_bf16 v[52:67], v[80:83], a[20:23], v[52:67]
    s_add_u32 s1, s1, 4096
    s_and_b32 s1, s1, 0xffff
    buffer_load_dwordx4 a[80:83], v22, s[28:31], s1 offen offset:0 sc1
    ds_read_b64_tr_b16 v[72:73], v13 offset:32768
    ds_read_b64_tr_b16 v[74:75], v13 offset:34816
    s_lshl_b32 s68, s53, 1
    s_add_u32 s68, s68, s5
    s_lshl_b32 s63, s68, 7
    s_add_u32 s63, s63, 6307840
    s_waitcnt vmcnt(24) lgkmcnt(8)
    v_mfma_f32_32x32x16_bf16 v[36:51], v[84:87], a[24:27], v[36:51]
    buffer_load_dwordx4 a[84:87], v22, s[28:31], s1 offen offset:512 sc1
    ds_read_b64_tr_b16 v[76:77], v12 offset:33792
    ds_read_b64_tr_b16 v[78:79], v12 offset:35840
    s_lshl_b32 s68, s68, 5
    s_add_u32 s68, s68, s4
    s_lshl_b32 s68, s68, 10
    s_add_u32 s68, s68, 4192256
    v_mfma_f32_32x32x16_bf16 v[52:67], v[88:91], a[24:27], v[52:67]
    buffer_load_dwordx4 a[88:91], v22, s[28:31], s1 offen offset:1024 sc1
    ds_read_b64_tr_b16 v[80:81], v13 offset:33792
    ds_read_b64_tr_b16 v[82:83], v13 offset:35840
    v_add_u32 v116, 15360, v4
    s_waitcnt vmcnt(25) lgkmcnt(8)
    v_mfma_f32_32x32x16_bf16 v[36:51], v[92:95], a[28:31], v[36:51]
    buffer_load_dwordx4 a[92:95], v22, s[28:31], s1 offen offset:1536 sc1
    ds_read_b64_tr_b16 v[84:85], v12 offset:36864
    ds_read_b64_tr_b16 v[86:87], v12 offset:38912
    v_lshlrev_b32 v26, 2, v2
    v_mfma_f32_32x32x16_bf16 v[52:67], v[96:99], a[28:31], v[52:67]
    s_add_u32 s1, s1, 4096
    s_and_b32 s1, s1, 0xffff
    buffer_load_dwordx4 a[96:99], v22, s[28:31], s1 offen offset:0 sc1
    ds_read_b64_tr_b16 v[88:89], v13 offset:36864
    ds_read_b64_tr_b16 v[90:91], v13 offset:38912
    s_xor_b32 s3, s4, s5
    s_lshl_b32 s3, s3, 6
    v_xor_b32 v100, s3, v12
    s_waitcnt vmcnt(26) lgkmcnt(8)
    v_mfma_f32_32x32x16_bf16 v[36:51], v[68:71], a[32:35], v[36:51]
    buffer_load_dwordx4 a[100:103], v22, s[28:31], s1 offen offset:512 sc1
    ds_read_b64_tr_b16 v[92:93], v12 offset:37888
    ds_read_b64_tr_b16 v[94:95], v12 offset:39936
    v_add_u32 v101, 65536, v100
    v_mfma_f32_32x32x16_bf16 v[52:67], v[72:75], a[32:35], v[52:67]
    buffer_load_dwordx4 a[104:107], v22, s[28:31], s1 offen offset:1024 sc1
    ds_read_b64_tr_b16 v[96:97], v13 offset:37888
    ds_read_b64_tr_b16 v[98:99], v13 offset:39936
    v_add_u32 v102, 131072, v100
    s_waitcnt vmcnt(27) lgkmcnt(8)
    v_mfma_f32_32x32x16_bf16 v[36:51], v[76:79], a[36:39], v[36:51]
    buffer_load_dwordx4 a[108:111], v22, s[28:31], s1 offen offset:1536 sc1
    ds_read_b64_tr_b16 v[68:69], v12 offset:49152
    ds_read_b64_tr_b16 v[70:71], v12 offset:51200
    v_and_b32 v8, 1, v3
    v_mfma_f32_32x32x16_bf16 v[52:67], v[80:83], a[36:39], v[52:67]
    s_add_u32 s1, s1, 4096
    s_and_b32 s1, s1, 0xffff
    buffer_load_dwordx4 a[112:115], v22, s[28:31], s1 offen offset:0 sc1
    ds_read_b64_tr_b16 v[72:73], v13 offset:49152
    ds_read_b64_tr_b16 v[74:75], v13 offset:51200
    v_lshrrev_b32 v9, 5, v1
    s_waitcnt vmcnt(28) lgkmcnt(8)
    v_mfma_f32_32x32x16_bf16 v[36:51], v[84:87], a[40:43], v[36:51]
    buffer_load_dwordx4 a[116:119], v22, s[28:31], s1 offen offset:512 sc1
    ds_read_b64_tr_b16 v[76:77], v12 offset:50176
    ds_read_b64_tr_b16 v[78:79], v12 offset:52224
    v_lshlrev_b32 v8, 10, v8
    v_mfma_f32_32x32x16_bf16 v[52:67], v[88:91], a[40:43], v[52:67]
    buffer_load_dwordx4 a[120:123], v22, s[28:31], s1 offen offset:1024 sc1
    ds_read_b64_tr_b16 v[80:81], v13 offset:50176
    ds_read_b64_tr_b16 v[82:83], v13 offset:52224
    v_lshl_add_u32 v8, v9, 8, v8
    s_waitcnt vmcnt(29) lgkmcnt(8)
    v_mfma_f32_32x32x16_bf16 v[36:51], v[92:95], a[44:47], v[36:51]
    buffer_load_dwordx4 a[124:127], v22, s[28:31], s1 offen offset:1536 sc1
    ds_read_b64_tr_b16 v[84:85], v12 offset:53248
    ds_read_b64_tr_b16 v[86:87], v12 offset:55296
    v_lshl_add_u32 v8, v2, 4, v8
    v_mfma_f32_32x32x16_bf16 v[52:67], v[96:99], a[44:47], v[52:67]
    s_add_u32 s1, s1, 4096
    s_and_b32 s1, s1, 0xffff
    buffer_load_dwordx4 a[128:131], v22, s[28:31], s1 offen offset:0 sc1
    ds_read_b64_tr_b16 v[88:89], v13 offset:53248
    ds_read_b64_tr_b16 v[90:91], v13 offset:55296
    s_mul_i32 s3, s4, 12288
    s_add_u32 s3, s3, 2048
    v_add_u32 v103, s3, v8
    s_waitcnt vmcnt(24) lgkmcnt(8)
    v_mfma_f32_32x32x16_bf16 v[36:51], v[68:71], a[48:51], v[36:51]
    buffer_load_dwordx4 a[132:135], v22, s[28:31], s1 offen offset:512 sc1
    ds_read_b64_tr_b16 v[92:93], v12 offset:54272
    ds_read_b64_tr_b16 v[94:95], v12 offset:56320
    v_xor_b32 v104, 4096, v103
    v_mfma_f32_32x32x16_bf16 v[52:67], v[72:75], a[48:51], v[52:67]
    buffer_load_dwordx4 a[136:139], v22, s[28:31], s1 offen offset:1024 sc1
    ds_read_b64_tr_b16 v[96:97], v13 offset:54272
    ds_read_b64_tr_b16 v[98:99], v13 offset:56320
    v_add_u32 v105, 65536, v103
    s_waitcnt vmcnt(25) lgkmcnt(8)
    v_mfma_f32_32x32x16_bf16 v[36:51], v[76:79], a[52:55], v[36:51]
    buffer_load_dwordx4 a[140:143], v22, s[28:31], s1 offen offset:1536 sc1
    s_barrier
    ds_read_b64_tr_b16 v[68:69], v14 offset:0
    ds_read_b64_tr_b16 v[70:71], v14 offset:2048
    v_add_u32 v106, 65536, v104
    v_mfma_f32_32x32x16_bf16 v[52:67], v[80:83], a[52:55], v[52:67]
    s_add_u32 s1, s1, 4096
    s_and_b32 s1, s1, 0xffff
    buffer_load_dwordx4 a[144:147], v22, s[28:31], s1 offen offset:0 sc1
    ds_read_b64_tr_b16 v[72:73], v15 offset:0
    ds_read_b64_tr_b16 v[74:75], v15 offset:2048
    v_add_u32 v107, 131072, v103
    s_waitcnt vmcnt(26) lgkmcnt(8)
    v_mfma_f32_32x32x16_bf16 v[36:51], v[84:87], a[56:59], v[36:51]
    buffer_load_dwordx4 a[148:151], v22, s[28:31], s1 offen offset:512 sc1
    ds_read_b64_tr_b16 v[76:77], v14 offset:1024
    ds_read_b64_tr_b16 v[78:79], v14 offset:3072
    v_add_u32 v108, 131072, v104
    v_mfma_f32_32x32x16_bf16 v[52:67], v[88:91], a[56:59], v[52:67]
    buffer_load_dwordx4 a[152:155], v22, s[28:31], s1 offen offset:1024 sc1
    ds_read_b64_tr_b16 v[80:81], v15 offset:1024
    ds_read_b64_tr_b16 v[82:83], v15 offset:3072
    s_lshl_b32 s3, s54, 1
    s_add_u32 s3, s3, s5
    s_mul_i32 s3, s3, 28
    s_add_u32 s3, s3, s4
    s_lshl_b32 s3, s3, 12
    s_add_u32 s3, s3, 2097152
    v_add_u32 v117, s3, v4
    s_waitcnt vmcnt(27) lgkmcnt(8)
    v_mfma_f32_32x32x16_bf16 v[36:51], v[92:95], a[60:63], v[36:51]
    buffer_load_dwordx4 a[156:159], v22, s[28:31], s1 offen offset:1536 sc1
    ds_read_b64_tr_b16 v[84:85], v14 offset:4096
    ds_read_b64_tr_b16 v[86:87], v14 offset:6144
    s_lshl_b32 s64, s54, 20
    s_lshl_b32 s65, s54, 14
    v_mfma_f32_32x32x16_bf16 v[52:67], v[96:99], a[60:63], v[52:67]
    s_add_u32 s1, s1, 4096
    s_and_b32 s1, s1, 0xffff
    buffer_load_dwordx4 a[160:163], v22, s[28:31], s1 offen offset:0 sc1
    ds_read_b64_tr_b16 v[88:89], v15 offset:4096
    ds_read_b64_tr_b16 v[90:91], v15 offset:6144
    s_lshl_b32 s3, s53, 2
    s_add_u32 s3, s3, s48
    s_lshl_b32 s79, s3, 5
    s_mul_i32 s83, s3, 14336
    s_waitcnt vmcnt(24) lgkmcnt(8)
    v_mfma_f32_32x32x16_bf16 v[36:51], v[68:71], a[64:67], v[36:51]
    buffer_load_dwordx4 a[164:167], v22, s[28:31], s1 offen offset:512 sc1
    ds_read_b64_tr_b16 v[92:93], v14 offset:5120
    ds_read_b64_tr_b16 v[94:95], v14 offset:7168
    s_lshl_b32 s3, s54, 7
    s_add_u32 s83, s83, s3
    s_add_u32 s78, s83, 7168
    v_mfma_f32_32x32x16_bf16 v[52:67], v[72:75], a[64:67], v[52:67]
    buffer_load_dwordx4 a[168:171], v22, s[28:31], s1 offen offset:1024 sc1
    ds_read_b64_tr_b16 v[96:97], v15 offset:5120
    ds_read_b64_tr_b16 v[98:99], v15 offset:7168
    v_lshlrev_b32 v120, 1, v5
    s_waitcnt vmcnt(25) lgkmcnt(8)
    v_mfma_f32_32x32x16_bf16 v[36:51], v[76:79], a[68:71], v[36:51]
    buffer_load_dwordx4 a[172:175], v22, s[28:31], s1 offen offset:1536 sc1
    buffer_store_dword v24, v7, s[28:31], s67 offen sc1
    ds_read_b64_tr_b16 v[68:69], v14 offset:16384
    ds_read_b64_tr_b16 v[70:71], v14 offset:18432
    s_lshl_b32 s3, s5, 3
    v_add_u32 v8, s3, v9
    v_mfma_f32_32x32x16_bf16 v[52:67], v[80:83], a[68:71], v[52:67]
    s_add_u32 m0, s58, 0
    s_add_u32 s0, s0, 4096
    s_and_b32 s0, s0, 0xffff
    s_mul_i32 s62, s0, 112
    buffer_load_dwordx4 v18, s[20:23], s62 offen lds
    ds_read_b64_tr_b16 v[72:73], v15 offset:16384
    ds_read_b64_tr_b16 v[74:75], v15 offset:18432
    v_xor_b32 v8, v8, v6
    s_waitcnt vmcnt(27) lgkmcnt(8)
    v_mfma_f32_32x32x16_bf16 v[36:51], v[84:87], a[72:75], v[36:51]
    buffer_load_dwordx4 v19, s[20:23], s62 offen offset:1024 lds
    ds_read_b64_tr_b16 v[76:77], v14 offset:17408
    ds_read_b64_tr_b16 v[78:79], v14 offset:19456
    v_and_b32 v9, 31, v1
    v_mfma_f32_32x32x16_bf16 v[52:67], v[88:91], a[72:75], v[52:67]
    buffer_load_dwordx4 v20, s[20:23], s62 offen offset:2048 lds
    ds_read_b64_tr_b16 v[80:81], v15 offset:17408
    ds_read_b64_tr_b16 v[82:83], v15 offset:19456
    v_lshlrev_b32 v8, 4, v8
    s_waitcnt vmcnt(28) lgkmcnt(8)
    v_mfma_f32_32x32x16_bf16 v[36:51], v[92:95], a[76:79], v[36:51]
    buffer_load_dwordx4 v21, s[20:23], s62 offen offset:3072 lds
    ds_read_b64_tr_b16 v[84:85], v14 offset:20480
    ds_read_b64_tr_b16 v[86:87], v14 offset:22528
    v_lshl_add_u32 v8, v9, 8, v8
    v_mfma_f32_32x32x16_bf16 v[52:67], v[96:99], a[76:79], v[52:67]
    s_add_u32 s1, s1, 4096
    s_and_b32 s1, s1, 0xffff
    buffer_load_dwordx4 a[176:179], v22, s[28:31], s1 offen offset:0 sc1
    ds_read_b64_tr_b16 v[88:89], v15 offset:20480
    ds_read_b64_tr_b16 v[90:91], v15 offset:22528
    s_lshl_b32 s3, s4, 14
    v_add_u32 v174, s3, v8
    s_waitcnt vmcnt(29) lgkmcnt(8)
    v_mfma_f32_32x32x16_bf16 v[36:51], v[68:71], a[80:83], v[36:51]
    buffer_load_dwordx4 a[180:183], v22, s[28:31], s1 offen offset:512 sc1
    ds_read_b64_tr_b16 v[92:93], v14 offset:21504
    ds_read_b64_tr_b16 v[94:95], v14 offset:23552
    v_xor_b32 v175, 32, v174
    v_mfma_f32_32x32x16_bf16 v[52:67], v[72:75], a[80:83], v[52:67]
    buffer_load_dwordx4 a[184:187], v22, s[28:31], s1 offen offset:1024 sc1
    ds_read_b64_tr_b16 v[96:97], v15 offset:21504
    ds_read_b64_tr_b16 v[98:99], v15 offset:23552
    v_xor_b32 v176, 64, v174
    s_waitcnt vmcnt(30) lgkmcnt(8)
    v_mfma_f32_32x32x16_bf16 v[36:51], v[76:79], a[84:87], v[36:51]
    buffer_load_dwordx4 a[188:191], v22, s[28:31], s1 offen offset:1536 sc1
    ds_read_b64_tr_b16 v[68:69], v14 offset:32768
    ds_read_b64_tr_b16 v[70:71], v14 offset:34816
    v_xor_b32 v177, 96, v174
    v_mfma_f32_32x32x16_bf16 v[52:67], v[80:83], a[84:87], v[52:67]
    s_add_u32 m0, s58, 16384
    s_add_u32 s0, s0, 4096
    s_and_b32 s0, s0, 0xffff
    s_mul_i32 s62, s0, 112
    buffer_load_dwordx4 v18, s[20:23], s62 offen lds
    ds_read_b64_tr_b16 v[72:73], v15 offset:32768
    ds_read_b64_tr_b16 v[74:75], v15 offset:34816
    v_lshlrev_b32 v8, 1, v6
    s_waitcnt vmcnt(31) lgkmcnt(8)
    v_mfma_f32_32x32x16_bf16 v[36:51], v[84:87], a[88:91], v[36:51]
    buffer_load_dwordx4 v19, s[20:23], s62 offen offset:1024 lds
    ds_read_b64_tr_b16 v[76:77], v14 offset:33792
    ds_read_b64_tr_b16 v[78:79], v14 offset:35840
    v_xor_b32 v8, v8, v5
    v_mfma_f32_32x32x16_bf16 v[52:67], v[88:91], a[88:91], v[52:67]
    buffer_load_dwordx4 v20, s[20:23], s62 offen offset:2048 lds
    ds_read_b64_tr_b16 v[80:81], v15 offset:33792
    ds_read_b64_tr_b16 v[82:83], v15 offset:35840
    v_lshlrev_b32 v8, 4, v8
    s_waitcnt vmcnt(32) lgkmcnt(8)
    v_mfma_f32_32x32x16_bf16 v[36:51], v[92:95], a[92:95], v[36:51]
    buffer_load_dwordx4 v21, s[20:23], s62 offen offset:3072 lds
    ds_read_b64_tr_b16 v[84:85], v14 offset:36864
    ds_read_b64_tr_b16 v[86:87], v14 offset:38912
    v_lshl_add_u32 v8, v5, 8, v8
    v_mfma_f32_32x32x16_bf16 v[52:67], v[96:99], a[92:95], v[52:67]
    s_add_u32 s1, s1, 4096
    s_and_b32 s1, s1, 0xffff
    buffer_load_dwordx4 a[192:195], v22, s[28:31], s1 offen offset:0 sc1
    ds_read_b64_tr_b16 v[88:89], v15 offset:36864
    ds_read_b64_tr_b16 v[90:91], v15 offset:38912
    v_add_u32 v178, s58, v8
    s_waitcnt vmcnt(33) lgkmcnt(8)
    v_mfma_f32_32x32x16_bf16 v[36:51], v[68:71], a[96:99], v[36:51]
    buffer_load_dwordx4 a[196:199], v22, s[28:31], s1 offen offset:512 sc1
    ds_read_b64_tr_b16 v[92:93], v14 offset:37888
    ds_read_b64_tr_b16 v[94:95], v14 offset:39936
    v_xor_b32 v179, 16, v178
    v_mfma_f32_32x32x16_bf16 v[52:67], v[72:75], a[96:99], v[52:67]
    buffer_load_dwordx4 a[200:203], v22, s[28:31], s1 offen offset:1024 sc1
    ds_read_b64_tr_b16 v[96:97], v15 offset:37888
    ds_read_b64_tr_b16 v[98:99], v15 offset:39936
    v_xor_b32 v180, 24576, v178
    s_waitcnt vmcnt(34) lgkmcnt(8)
    v_mfma_f32_32x32x16_bf16 v[36:51], v[76:79], a[100:103], v[36:51]
    buffer_load_dwordx4 a[204:207], v22, s[28:31], s1 offen offset:1536 sc1
    s_barrier
    ds_read_b64_tr_b16 v[68:69], v14 offset:49152
    ds_read_b64_tr_b16 v[70:71], v14 offset:51200
    v_xor_b32 v181, 24592, v178
    v_mfma_f32_32x32x16_bf16 v[52:67], v[80:83], a[100:103], v[52:67]
    s_add_u32 m0, s58, 32768
    s_add_u32 s0, s0, 4096
    s_and_b32 s0, s0, 0xffff
    s_mul_i32 s62, s0, 112
    buffer_load_dwordx4 v18, s[20:23], s62 offen lds
    ds_read_b64_tr_b16 v[72:73], v15 offset:49152
    ds_read_b64_tr_b16 v[74:75], v15 offset:51200
    s_mov_b32 s70, 0xbdd2d3e8
    s_mov_b32 s71, 0xbdd2d3e8
    s_waitcnt vmcnt(35) lgkmcnt(8)
    v_mfma_f32_32x32x16_bf16 v[36:51], v[84:87], a[104:107], v[36:51]
    buffer_load_dwordx4 v19, s[20:23], s62 offen offset:1024 lds
    ds_read_b64_tr_b16 v[76:77], v14 offset:50176
    ds_read_b64_tr_b16 v[78:79], v14 offset:52224
    s_mov_b32 s72, 1.0
    s_mov_b32 s73, 1.0
    v_mfma_f32_32x32x16_bf16 v[52:67], v[88:91], a[104:107], v[52:67]
    buffer_load_dwordx4 v20, s[20:23], s62 offen offset:2048 lds
    ds_read_b64_tr_b16 v[80:81], v15 offset:50176
    ds_read_b64_tr_b16 v[82:83], v15 offset:52224
    v_mov_b32 v172, 0xc0135761
    s_waitcnt vmcnt(36) lgkmcnt(8)
    v_mfma_f32_32x32x16_bf16 v[36:51], v[92:95], a[108:111], v[36:51]
    buffer_load_dwordx4 v21, s[20:23], s62 offen offset:3072 lds
    ds_read_b64_tr_b16 v[84:85], v14 offset:53248
    ds_read_b64_tr_b16 v[86:87], v14 offset:55296
    v_mov_b32 v173, 0xc0135761
    v_mfma_f32_32x32x16_bf16 v[52:67], v[96:99], a[108:111], v[52:67]
    s_add_u32 s1, s1, 4096
    s_and_b32 s1, s1, 0xffff
    buffer_load_dwordx4 a[208:211], v22, s[28:31], s1 offen offset:0 sc1
    ds_read_b64_tr_b16 v[88:89], v15 offset:53248
    ds_read_b64_tr_b16 v[90:91], v15 offset:55296
    s_waitcnt vmcnt(37) lgkmcnt(8)
    v_mfma_f32_32x32x16_bf16 v[36:51], v[68:71], a[112:115], v[36:51]
    buffer_load_dwordx4 a[212:215], v22, s[28:31], s1 offen offset:512 sc1
    ds_read_b64_tr_b16 v[92:93], v14 offset:54272
    ds_read_b64_tr_b16 v[94:95], v14 offset:56320
    v_mfma_f32_32x32x16_bf16 v[52:67], v[72:75], a[112:115], v[52:67]
    buffer_load_dwordx4 a[216:219], v22, s[28:31], s1 offen offset:1024 sc1
    ds_read_b64_tr_b16 v[96:97], v15 offset:54272
    ds_read_b64_tr_b16 v[98:99], v15 offset:56320
    s_waitcnt vmcnt(38) lgkmcnt(8)
    v_mfma_f32_32x32x16_bf16 v[36:51], v[76:79], a[116:119], v[36:51]
    buffer_load_dwordx4 a[220:223], v22, s[28:31], s1 offen offset:1536 sc1
    ds_read_b64_tr_b16 v[68:69], v16 offset:0
    ds_read_b64_tr_b16 v[70:71], v16 offset:2048
    v_mfma_f32_32x32x16_bf16 v[52:67], v[80:83], a[116:119], v[52:67]
    s_add_u32 m0, s58, 49152
    s_add_u32 s0, s0, 4096
    s_and_b32 s0, s0, 0xffff
    s_mul_i32 s62, s0, 112
    buffer_load_dwordx4 v18, s[20:23], s62 offen lds
    ds_read_b64_tr_b16 v[72:73], v17 offset:0
    ds_read_b64_tr_b16 v[74:75], v17 offset:2048
    s_waitcnt vmcnt(39) lgkmcnt(8)
    v_mfma_f32_32x32x16_bf16 v[36:51], v[84:87], a[120:123], v[36:51]
    buffer_load_dwordx4 v19, s[20:23], s62 offen offset:1024 lds
    ds_read_b64_tr_b16 v[76:77], v16 offset:1024
    ds_read_b64_tr_b16 v[78:79], v16 offset:3072
    v_mfma_f32_32x32x16_bf16 v[52:67], v[88:91], a[120:123], v[52:67]
    buffer_load_dwordx4 v20, s[20:23], s62 offen offset:2048 lds
    ds_read_b64_tr_b16 v[80:81], v17 offset:1024
    ds_read_b64_tr_b16 v[82:83], v17 offset:3072
    s_waitcnt vmcnt(40) lgkmcnt(8)
    v_mfma_f32_32x32x16_bf16 v[36:51], v[92:95], a[124:127], v[36:51]
    buffer_load_dwordx4 v21, s[20:23], s62 offen offset:3072 lds
    ds_read_b64_tr_b16 v[84:85], v16 offset:4096
    ds_read_b64_tr_b16 v[86:87], v16 offset:6144
    v_mfma_f32_32x32x16_bf16 v[52:67], v[96:99], a[124:127], v[52:67]
    s_add_u32 s1, s1, 4096
    s_and_b32 s1, s1, 0xffff
    buffer_load_dwordx4 a[224:227], v22, s[28:31], s1 offen offset:0 sc1
    ds_read_b64_tr_b16 v[88:89], v17 offset:4096
    ds_read_b64_tr_b16 v[90:91], v17 offset:6144
    s_waitcnt vmcnt(41) lgkmcnt(8)
    v_mfma_f32_32x32x16_bf16 v[36:51], v[68:71], a[128:131], v[36:51]
    buffer_load_dwordx4 a[228:231], v22, s[28:31], s1 offen offset:512 sc1
    ds_read_b64_tr_b16 v[92:93], v16 offset:5120
    ds_read_b64_tr_b16 v[94:95], v16 offset:7168
    v_mfma_f32_32x32x16_bf16 v[52:67], v[72:75], a[128:131], v[52:67]
    buffer_load_dwordx4 a[232:235], v22, s[28:31], s1 offen offset:1024 sc1
    ds_read_b64_tr_b16 v[96:97], v17 offset:5120
    ds_read_b64_tr_b16 v[98:99], v17 offset:7168
    s_waitcnt vmcnt(42) lgkmcnt(8)
    v_mfma_f32_32x32x16_bf16 v[36:51], v[76:79], a[132:135], v[36:51]
    buffer_load_dwordx4 a[236:239], v22, s[28:31], s1 offen offset:1536 sc1
    ds_read_b64_tr_b16 v[68:69], v16 offset:16384
    ds_read_b64_tr_b16 v[70:71], v16 offset:18432
    v_mfma_f32_32x32x16_bf16 v[52:67], v[80:83], a[132:135], v[52:67]
    s_add_u32 m0, s58, 65536
    s_add_u32 s0, s0, 4096
    s_and_b32 s0, s0, 0xffff
    s_mul_i32 s62, s0, 112
    buffer_load_dwordx4 v18, s[20:23], s62 offen lds
    ds_read_b64_tr_b16 v[72:73], v17 offset:16384
    ds_read_b64_tr_b16 v[74:75], v17 offset:18432
    s_waitcnt vmcnt(43) lgkmcnt(8)
    v_mfma_f32_32x32x16_bf16 v[36:51], v[84:87], a[136:139], v[36:51]
    buffer_load_dwordx4 v19, s[20:23], s62 offen offset:1024 lds
    ds_read_b64_tr_b16 v[76:77], v16 offset:17408
    ds_read_b64_tr_b16 v[78:79], v16 offset:19456
    v_mfma_f32_32x32x16_bf16 v[52:67], v[88:91], a[136:139], v[52:67]
    buffer_load_dwordx4 v20, s[20:23], s62 offen offset:2048 lds
    ds_read_b64_tr_b16 v[80:81], v17 offset:17408
    ds_read_b64_tr_b16 v[82:83], v17 offset:19456
    s_waitcnt vmcnt(44) lgkmcnt(8)
    v_mfma_f32_32x32x16_bf16 v[36:51], v[92:95], a[140:143], v[36:51]
    buffer_load_dwordx4 v21, s[20:23], s62 offen offset:3072 lds
    ds_read_b64_tr_b16 v[84:85], v16 offset:20480
    ds_read_b64_tr_b16 v[86:87], v16 offset:22528
    v_mfma_f32_32x32x16_bf16 v[52:67], v[96:99], a[140:143], v[52:67]
    s_add_u32 s1, s1, 4096
    s_and_b32 s1, s1, 0xffff
    buffer_load_dwordx4 a[240:243], v22, s[28:31], s1 offen offset:0 sc1
    ds_read_b64_tr_b16 v[88:89], v17 offset:20480
    ds_read_b64_tr_b16 v[90:91], v17 offset:22528
    s_waitcnt vmcnt(45) lgkmcnt(8)
    v_mfma_f32_32x32x16_bf16 v[36:51], v[68:71], a[144:147], v[36:51]
    buffer_load_dwordx4 a[244:247], v22, s[28:31], s1 offen offset:512 sc1
    ds_read_b64_tr_b16 v[92:93], v16 offset:21504
    ds_read_b64_tr_b16 v[94:95], v16 offset:23552
    v_mfma_f32_32x32x16_bf16 v[52:67], v[72:75], a[144:147], v[52:67]
    buffer_load_dwordx4 a[248:251], v22, s[28:31], s1 offen offset:1024 sc1
    ds_read_b64_tr_b16 v[96:97], v17 offset:21504
    ds_read_b64_tr_b16 v[98:99], v17 offset:23552
    s_waitcnt vmcnt(46) lgkmcnt(8)
    v_mfma_f32_32x32x16_bf16 v[36:51], v[76:79], a[148:151], v[36:51]
    buffer_load_dwordx4 a[252:255], v22, s[28:31], s1 offen offset:1536 sc1
    s_waitcnt vmcnt(20)
    s_barrier
    ds_read_b64_tr_b16 v[68:69], v12 offset:0
    ds_read_b64_tr_b16 v[70:71], v12 offset:2048
    v_mfma_f32_32x32x16_bf16 v[52:67], v[80:83], a[148:151], v[52:67]
    s_add_u32 m0, s58, 81920
    s_add_u32 s0, s0, 4096
    s_and_b32 s0, s0, 0xffff
    s_mul_i32 s62, s0, 112
    buffer_load_dwordx4 v18, s[20:23], s62 offen lds
    ds_read_b64_tr_b16 v[72:73], v13 offset:0
    ds_read_b64_tr_b16 v[74:75], v13 offset:2048
    s_waitcnt lgkmcnt(8)
    v_mfma_f32_32x32x16_bf16 v[36:51], v[84:87], a[152:155], v[36:51]
    buffer_load_dwordx4 v19, s[20:23], s62 offen offset:1024 lds
    ds_read_b64_tr_b16 v[76:77], v12 offset:1024
    ds_read_b64_tr_b16 v[78:79], v12 offset:3072
    v_mfma_f32_32x32x16_bf16 v[52:67], v[88:91], a[152:155], v[52:67]
    buffer_load_dwordx4 v20, s[20:23], s62 offen offset:2048 lds
    ds_read_b64_tr_b16 v[80:81], v13 offset:1024
    ds_read_b64_tr_b16 v[82:83], v13 offset:3072
    s_waitcnt lgkmcnt(8)
    v_mfma_f32_32x32x16_bf16 v[36:51], v[92:95], a[156:159], v[36:51]
    buffer_load_dwordx4 v21, s[20:23], s62 offen offset:3072 lds
    ds_read_b64_tr_b16 v[84:85], v12 offset:4096
    ds_read_b64_tr_b16 v[86:87], v12 offset:6144
    v_mfma_f32_32x32x16_bf16 v[52:67], v[96:99], a[156:159], v[52:67]
    buffer_load_dword v25, v26, s[28:31], s63 offen sc1
    ds_read_b64_tr_b16 v[88:89], v13 offset:4096
    ds_read_b64_tr_b16 v[90:91], v13 offset:6144
    s_waitcnt lgkmcnt(8)
    v_mfma_f32_32x32x16_bf16 v[36:51], v[68:71], a[160:163], v[36:51]
    ds_read_b64_tr_b16 v[92:93], v12 offset:5120
    ds_read_b64_tr_b16 v[94:95], v12 offset:7168
    v_mfma_f32_32x32x16_bf16 v[52:67], v[72:75], a[160:163], v[52:67]
    ds_read_b64_tr_b16 v[96:97], v13 offset:5120
    ds_read_b64_tr_b16 v[98:99], v13 offset:7168
    s_waitcnt lgkmcnt(8)
    v_mfma_f32_32x32x16_bf16 v[36:51], v[76:79], a[164:167], v[36:51]
    ds_read_b64_tr_b16 v[68:69], v12 offset:16384
    ds_read_b64_tr_b16 v[70:71], v12 offset:18432
    v_mfma_f32_32x32x16_bf16 v[52:67], v[80:83], a[164:167], v[52:67]
    ds_read_b64_tr_b16 v[72:73], v13 offset:16384
    ds_read_b64_tr_b16 v[74:75], v13 offset:18432
    s_waitcnt lgkmcnt(8)
    v_mfma_f32_32x32x16_bf16 v[36:51], v[84:87], a[168:171], v[36:51]
    ds_read_b64_tr_b16 v[76:77], v12 offset:17408
    ds_read_b64_tr_b16 v[78:79], v12 offset:19456
    v_mfma_f32_32x32x16_bf16 v[52:67], v[88:91], a[168:171], v[52:67]
    ds_read_b64_tr_b16 v[80:81], v13 offset:17408
    ds_read_b64_tr_b16 v[82:83], v13 offset:19456
    s_waitcnt lgkmcnt(8)
    v_mfma_f32_32x32x16_bf16 v[36:51], v[92:95], a[172:175], v[36:51]
    ds_read_b64_tr_b16 v[84:85], v12 offset:20480
    ds_read_b64_tr_b16 v[86:87], v12 offset:22528
    v_mfma_f32_32x32x16_bf16 v[52:67], v[96:99], a[172:175], v[52:67]
    ds_read_b64_tr_b16 v[88:89], v13 offset:20480
    ds_read_b64_tr_b16 v[90:91], v13 offset:22528
    s_waitcnt lgkmcnt(8)
    v_mfma_f32_32x32x16_bf16 v[36:51], v[68:71], a[176:179], v[36:51]
    ds_read_b64_tr_b16 v[92:93], v12 offset:21504
    ds_read_b64_tr_b16 v[94:95], v12 offset:23552
    v_mfma_f32_32x32x16_bf16 v[52:67], v[72:75], a[176:179], v[52:67]
    ds_read_b64_tr_b16 v[96:97], v13 offset:21504
    ds_read_b64_tr_b16 v[98:99], v13 offset:23552
    s_waitcnt lgkmcnt(8)
    v_mfma_f32_32x32x16_bf16 v[36:51], v[76:79], a[180:183], v[36:51]
    s_waitcnt vmcnt(0)
    v_cmp_ne_u32 vcc, s57, v25
    s_cbranch_vccz L_pollok1
    s_mov_b32 s61, 0
L_poll1:
    s_sleep 8
    buffer_load_dword v25, v26, s[28:31], s63 offen sc1
    s_add_u32 s61, s61, 1
    s_waitcnt vmcnt(0)
    v_cmp_ne_u32 vcc, s57, v25
    s_cbranch_vccz L_pollok1
    s_cmp_lt_u32 s61, 20000
    s_cbranch_scc1 L_poll1
L_pollok1:
    ds_read_b64_tr_b16 v[68:69], v12 offset:32768
    s_add_u32 m0, s58, 98304
    s_add_u32 s62, s66, 0
    buffer_load_dwordx4 v113, s[16:19], s62 offen lds
    ds_read_b64_tr_b16 v[70:71], v12 offset:34816
    v_mfma_f32_32x32x16_bf16 v[52:67], v[80:83], a[180:183], v[52:67]
    ds_read_b64_tr_b16 v[72:73], v13 offset:32768
    ds_read_b64_tr_b16 v[74:75], v13 offset:34816
    s_waitcnt lgkmcnt(8)
    v_mfma_f32_32x32x16_bf16 v[36:51], v[84:87], a[184:187], v[36:51]
    buffer_load_dwordx4 v114, s[16:19], s62 offen offset:1024 lds
    ds_read_b64_tr_b16 v[76:77], v12 offset:33792
    ds_read_b64_tr_b16 v[78:79], v12 offset:35840
    v_mfma_f32_32x32x16_bf16 v[52:67], v[88:91], a[184:187], v[52:67]
    ds_read_b64_tr_b16 v[80:81], v13 offset:33792
    ds_read_b64_tr_b16 v[82:83], v13 offset:35840
    s_waitcnt lgkmcnt(8)
    v_mfma_f32_32x32x16_bf16 v[36:51], v[92:95], a[188:191], v[36:51]
    s_add_u32 s62, s68, 0
    buffer_load_dwordx4 v4, s[28:31], s62 offen offset:2048 sc1 lds
    ds_read_b64_tr_b16 v[84:85], v12 offset:36864
    ds_read_b64_tr_b16 v[86:87], v12 offset:38912
    v_mfma_f32_32x32x16_bf16 v[52:67], v[96:99], a[188:191], v[52:67]
    ds_read_b64_tr_b16 v[88:89], v13 offset:36864
    ds_read_b64_tr_b16 v[90:91], v13 offset:38912
    s_waitcnt lgkmcnt(8)
    v_mfma_f32_32x32x16_bf16 v[36:51], v[68:71], a[192:195], v[36:51]
    buffer_load_dwordx4 v116, s[28:31], s62 offen offset:3072 sc1 lds
    ds_read_b64_tr_b16 v[92:93], v12 offset:37888
    ds_read_b64_tr_b16 v[94:95], v12 offset:39936
    v_mfma_f32_32x32x16_bf16 v[52:67], v[72:75], a[192:195], v[52:67]
    ds_read_b64_tr_b16 v[96:97], v13 offset:37888
    ds_read_b64_tr_b16 v[98:99], v13 offset:39936
    s_waitcnt lgkmcnt(8)
    v_mfma_f32_32x32x16_bf16 v[36:51], v[76:79], a[196:199], v[36:51]
    s_barrier
    ds_read_b64_tr_b16 v[68:69], v12 offset:49152
    s_add_u32 m0, s58, 114688
    s_add_u32 s62, s66, 50176
    buffer_load_dwordx4 v113, s[16:19], s62 offen lds
    ds_read_b64_tr_b16 v[70:71], v12 offset:51200
    v_mfma_f32_32x32x16_bf16 v[52:67], v[80:83], a[196:199], v[52:67]
    ds_read_b64_tr_b16 v[72:73], v13 offset:49152
    ds_read_b64_tr_b16 v[74:75], v13 offset:51200
    s_waitcnt lgkmcnt(8)
    v_mfma_f32_32x32x16_bf16 v[36:51], v[84:87], a[200:203], v[36:51]
    buffer_load_dwordx4 v114, s[16:19], s62 offen offset:1024 lds
    ds_read_b64_tr_b16 v[76:77], v12 offset:50176
    ds_read_b64_tr_b16 v[78:79], v12 offset:52224
    v_mfma_f32_32x32x16_bf16 v[52:67], v[88:91], a[200:203], v[52:67]
    ds_read_b64_tr_b16 v[80:81], v13 offset:50176
    ds_read_b64_tr_b16 v[82:83], v13 offset:52224
    s_waitcnt lgkmcnt(8)
    v_mfma_f32_32x32x16_bf16 v[36:51], v[92:95], a[204:207], v[36:51]
    s_add_u32 s62, s68, 2048
    buffer_load_dwordx4 v4, s[28:31], s62 offen offset:2048 sc1 lds
    ds_read_b64_tr_b16 v[84:85], v12 offset:53248
    ds_read_b64_tr_b16 v[86:87], v12 offset:55296
    v_mfma_f32_32x32x16_bf16 v[52:67], v[96:99], a[204:207], v[52:67]
    ds_read_b64_tr_b16 v[88:89], v13 offset:53248
    ds_read_b64_tr_b16 v[90:91], v13 offset:55296
    s_waitcnt lgkmcnt(8)
    v_mfma_f32_32x32x16_bf16 v[36:51], v[68:71], a[208:211], v[36:51]
    buffer_load_dwordx4 v116, s[28:31], s62 offen offset:3072 sc1 lds
    ds_read_b64_tr_b16 v[92:93], v12 offset:54272
    ds_read_b64_tr_b16 v[94:95], v12 offset:56320
    v_mfma_f32_32x32x16_bf16 v[52:67], v[72:75], a[208:211], v[52:67]
    ds_read_b64_tr_b16 v[96:97], v13 offset:54272
    ds_read_b64_tr_b16 v[98:99], v13 offset:56320
    s_waitcnt lgkmcnt(8)
    v_mfma_f32_32x32x16_bf16 v[36:51], v[76:79], a[212:215], v[36:51]
    ds_read_b64_tr_b16 v[68:69], v14 offset:0
    s_add_u32 m0, s58, 131072
    s_add_u32 s62, s66, 100352
    buffer_load_dwordx4 v113, s[16:19], s62 offen lds
    ds_read_b64_tr_b16 v[70:71], v14 offset:2048
    v_mfma_f32_32x32x16_bf16 v[52:67], v[80:83], a[212:215], v[52:67]
    ds_read_b64_tr_b16 v[72:73], v15 offset:0
    ds_read_b64_tr_b16 v[74:75], v15 offset:2048
    s_waitcnt lgkmcnt(8)
    v_mfma_f32_32x32x16_bf16 v[36:51], v[84:87], a[216:219], v[36:51]
    buffer_load_dwordx4 v114, s[16:19], s62 offen offset:1024 lds
    ds_read_b64_tr_b16 v[76:77], v14 offset:1024
    ds_read_b64_tr_b16 v[78:79], v14 offset:3072
    v_mfma_f32_32x32x16_bf16 v[52:67], v[88:91], a[216:219], v[52:67]
    ds_read_b64_tr_b16 v[80:81], v15 offset:1024
    ds_read_b64_tr_b16 v[82:83], v15 offset:3072
    s_waitcnt lgkmcnt(8)
    v_mfma_f32_32x32x16_bf16 v[36:51], v[92:95], a[220:223], v[36:51]
    s_add_u32 s62, s68, 4096
    buffer_load_dwordx4 v4, s[28:31], s62 offen offset:2048 sc1 lds
    ds_read_b64_tr_b16 v[84:85], v14 offset:4096
    ds_read_b64_tr_b16 v[86:87], v14 offset:6144
    v_mfma_f32_32x32x16_bf16 v[52:67], v[96:99], a[220:223], v[52:67]
    ds_read_b64_tr_b16 v[88:89], v15 offset:4096
    ds_read_b64_tr_b16 v[90:91], v15 offset:6144
    s_waitcnt lgkmcnt(8)
    v_mfma_f32_32x32x16_bf16 v[36:51], v[68:71], a[224:227], v[36:51]
    buffer_load_dwordx4 v116, s[28:31], s62 offen offset:3072 sc1 lds
    ds_read_b64_tr_b16 v[92:93], v14 offset:5120
    ds_read_b64_tr_b16 v[94:95], v14 offset:7168
    v_mfma_f32_32x32x16_bf16 v[52:67], v[72:75], a[224:227], v[52:67]
    ds_read_b64_tr_b16 v[96:97], v15 offset:5120
    ds_read_b64_tr_b16 v[98:99], v15 offset:7168
    s_waitcnt lgkmcnt(8)
    v_mfma_f32_32x32x16_bf16 v[36:51], v[76:79], a[228:231], v[36:51]
    ds_read_b64_tr_b16 v[68:69], v14 offset:16384
    s_add_u32 m0, s58, 147456
    s_add_u32 s62, s66, 150528
    buffer_load_dwordx4 v113, s[16:19], s62 offen lds
    ds_read_b64_tr_b16 v[70:71], v14 offset:18432
    v_mfma_f32_32x32x16_bf16 v[52:67], v[80:83], a[228:231], v[52:67]
    ds_read_b64_tr_b16 v[72:73], v15 offset:16384
    ds_read_b64_tr_b16 v[74:75], v15 offset:18432
    s_waitcnt lgkmcnt(8)
    v_mfma_f32_32x32x16_bf16 v[36:51], v[84:87], a[232:235], v[36:51]
    buffer_load_dwordx4 v114, s[16:19], s62 offen offset:1024 lds
    ds_read_b64_tr_b16 v[76:77], v14 offset:17408
    ds_read_b64_tr_b16 v[78:79], v14 offset:19456
    v_mfma_f32_32x32x16_bf16 v[52:67], v[88:91], a[232:235], v[52:67]
    ds_read_b64_tr_b16 v[80:81], v15 offset:17408
    ds_read_b64_tr_b16 v[82:83], v15 offset:19456
    s_waitcnt lgkmcnt(8)
    v_mfma_f32_32x32x16_bf16 v[36:51], v[92:95], a[236:239], v[36:51]
    s_add_u32 s62, s68, 6144
    buffer_load_dwordx4 v4, s[28:31], s62 offen offset:2048 sc1 lds
    ds_read_b64_tr_b16 v[84:85], v14 offset:20480
    ds_read_b64_tr_b16 v[86:87], v14 offset:22528
    v_mfma_f32_32x32x16_bf16 v[52:67], v[96:99], a[236:239], v[52:67]
    ds_read_b64_tr_b16 v[88:89], v15 offset:20480
    ds_read_b64_tr_b16 v[90:91], v15 offset:22528
    s_waitcnt lgkmcnt(8)
    v_mfma_f32_32x32x16_bf16 v[36:51], v[68:71], a[240:243], v[36:51]
    buffer_load_dwordx4 v116, s[28:31], s62 offen offset:3072 sc1 lds
    ds_read_b64_tr_b16 v[92:93], v14 offset:21504
    ds_read_b64_tr_b16 v[94:95], v14 offset:23552
    v_mfma_f32_32x32x16_bf16 v[52:67], v[72:75], a[240:243], v[52:67]
    ds_read_b64_tr_b16 v[96:97], v15 offset:21504
    ds_read_b64_tr_b16 v[98:99], v15 offset:23552
    s_waitcnt lgkmcnt(8)
    v_mfma_f32_32x32x16_bf16 v[36:51], v[76:79], a[244:247], v[36:51]
    v_mfma_f32_32x32x16_bf16 v[52:67], v[80:83], a[244:247], v[52:67]
    s_waitcnt lgkmcnt(4)
    v_mfma_f32_32x32x16_bf16 v[36:51], v[84:87], a[248:251], v[36:51]
    v_mfma_f32_32x32x16_bf16 v[52:67], v[88:91], a[248:251], v[52:67]
    s_waitcnt lgkmcnt(0)
    v_mfma_f32_32x32x16_bf16 v[36:51], v[92:95], a[252:255], v[36:51]
    v_mfma_f32_32x32x16_bf16 v[52:67], v[96:99], a[252:255], v[52:67]
    s_nop 11
    ds_write_b128 v119, v[52:55] offset:16384
    s_add_u32 m0, s58, 0
    s_add_u32 s62, s66, 200704
    buffer_load_dwordx4 v113, s[16:19], s62 offen lds
    ds_write_b128 v119, v[56:59] offset:17408
    ds_write_b128 v119, v[60:63] offset:18432
    ds_write_b128 v119, v[64:67] offset:19456
    v_xor_b32 v119, 8192, v119
    s_waitcnt lgkmcnt(0)
    s_barrier
    ds_read_b128 v[140:143], v119 offset:16384
    ds_read_b128 v[144:147], v119 offset:17408
    ds_read_b128 v[148:151], v119 offset:18432
    ds_read_b128 v[152:155], v119 offset:19456
    s_waitcnt lgkmcnt(3)
    v_pk_add_f32 v[36:37], v[36:37], v[140:141]
    v_pk_add_f32 v[38:39], v[38:39], v[142:143]
    s_waitcnt lgkmcnt(2)
    v_pk_add_f32 v[40:41], v[40:41], v[144:145]
    v_pk_add_f32 v[42:43], v[42:43], v[146:147]
    v_pk_mul_f32 v[140:141], v[36:37], v[36:37]
    v_pk_mul_f32 v[142:143], v[38:39], v[38:39]
    v_pk_mul_f32 v[144:145], v[40:41], v[40:41]
    buffer_load_dwordx4 v114, s[16:19], s62 offen offset:1024 lds
    v_pk_mul_f32 v[146:147], v[42:43], v[42:43]
    v_pk_fma_f32 v[140:141], v[140:141], s[70:71], v[172:173]
    v_pk_fma_f32 v[142:143], v[142:143], s[70:71], v[172:173]
    v_pk_fma_f32 v[144:145], v[144:145], s[70:71], v[172:173]
    v_pk_fma_f32 v[146:147], v[146:147], s[70:71], v[172:173]
    v_pk_mul_f32 v[140:141], v[140:141], v[36:37]
    v_pk_mul_f32 v[142:143], v[142:143], v[38:39]
    v_pk_mul_f32 v[144:145], v[144:145], v[40:41]
    v_pk_mul_f32 v[146:147], v[146:147], v[42:43]
    v_exp_f32 v140, v140
    v_exp_f32 v141, v141
    v_exp_f32 v142, v142
    v_exp_f32 v143, v143
    s_add_u32 s62, s68, 8192
    buffer_load_dwordx4 v4, s[28:31], s62 offen offset:2048 sc1 lds
    v_exp_f32 v144, v144
    v_exp_f32 v145, v145
    v_exp_f32 v146, v146
    v_exp_f32 v147, v147
    v_pk_add_f32 v[140:141], v[140:141], s[72:73]
    v_pk_add_f32 v[142:143], v[142:143], s[72:73]
    v_pk_add_f32 v[144:145], v[144:145], s[72:73]
    v_pk_add_f32 v[146:147], v[146:147], s[72:73]
    v_rcp_f32 v140, v140
    v_rcp_f32 v141, v141
    buffer_load_dwordx4 v116, s[28:31], s62 offen offset:3072 sc1 lds
    v_rcp_f32 v142, v142
    v_rcp_f32 v143, v143
    v_rcp_f32 v144, v144
    v_rcp_f32 v145, v145
    v_rcp_f32 v146, v146
    v_rcp_f32 v147, v147
    v_pk_mul_f32 v[140:141], v[140:141], v[36:37]
    v_pk_mul_f32 v[142:143], v[142:143], v[38:39]
    v_pk_mul_f32 v[144:145], v[144:145], v[40:41]
    v_pk_mul_f32 v[146:147], v[146:147], v[42:43]
    v_cvt_pk_bf16_f32 v28, v140, v141
    v_cvt_pk_bf16_f32 v29, v142, v143
    v_cvt_pk_bf16_f32 v30, v144, v145
    v_cvt_pk_bf16_f32 v31, v146, v147
    buffer_store_dwordx4 v[28:31], v4, s[28:31], s82 offen offset:0 sc1
    s_waitcnt lgkmcnt(1)
    v_pk_add_f32 v[44:45], v[44:45], v[148:149]
    v_pk_add_f32 v[46:47], v[46:47], v[150:151]
    s_waitcnt lgkmcnt(0)
    v_pk_add_f32 v[48:49], v[48:49], v[152:153]
    v_pk_add_f32 v[50:51], v[50:51], v[154:155]
    v_pk_mul_f32 v[148:149], v[44:45], v[44:45]
    v_pk_mul_f32 v[150:151], v[46:47], v[46:47]
    v_pk_mul_f32 v[152:153], v[48:49], v[48:49]
    v_pk_mul_f32 v[154:155], v[50:51], v[50:51]
    v_pk_fma_f32 v[148:149], v[148:149], s[70:71], v[172:173]
    v_pk_fma_f32 v[150:151], v[150:151], s[70:71], v[172:173]
    v_pk_fma_f32 v[152:153], v[152:153], s[70:71], v[172:173]
    v_pk_fma_f32 v[154:155], v[154:155], s[70:71], v[172:173]
    v_pk_mul_f32 v[148:149], v[148:149], v[44:45]
    v_pk_mul_f32 v[150:151], v[150:151], v[46:47]
    v_pk_mul_f32 v[152:153], v[152:153], v[48:49]
    v_pk_mul_f32 v[154:155], v[154:155], v[50:51]
    v_exp_f32 v148, v148
    v_exp_f32 v149, v149
    v_exp_f32 v150, v150
    v_exp_f32 v151, v151
    v_exp_f32 v152, v152
    v_exp_f32 v153, v153
    v_exp_f32 v154, v154
    v_exp_f32 v155, v155
    v_pk_add_f32 v[148:149], v[148:149], s[72:73]
    v_pk_add_f32 v[150:151], v[150:151], s[72:73]
    v_pk_add_f32 v[152:153], v[152:153], s[72:73]
    v_pk_add_f32 v[154:155], v[154:155], s[72:73]
    v_rcp_f32 v148, v148
    v_rcp_f32 v149, v149
    v_rcp_f32 v150, v150
    v_rcp_f32 v151, v151
    v_rcp_f32 v152, v152
    v_rcp_f32 v153, v153
    v_rcp_f32 v154, v154
    v_rcp_f32 v155, v155
    v_pk_mul_f32 v[148:149], v[148:149], v[44:45]
    v_pk_mul_f32 v[150:151], v[150:151], v[46:47]
    v_pk_mul_f32 v[152:153], v[152:153], v[48:49]
    v_pk_mul_f32 v[154:155], v[154:155], v[50:51]
    v_cvt_pk_bf16_f32 v32, v148, v149
    v_cvt_pk_bf16_f32 v33, v150, v151
    v_cvt_pk_bf16_f32 v34, v152, v153
    v_cvt_pk_bf16_f32 v35, v154, v155
    buffer_store_dwordx4 v[32:35], v4, s[28:31], s82 offen offset:1024 sc1
    s_branch L_f
L_nog1:
    s_nop 1
    buffer_store_dwordx4 v[28:31], v4, s[28:31], s100 offen sc1
    buffer_store_dwordx4 v[32:35], v4, s[28:31], s101 offen sc1
    s_waitcnt vmcnt(0) lgkmcnt(0)
    buffer_store_dword v24, v7, s[28:31], s67 offen sc1
    s_cmp_eq_u32 s56, 0
    s_cbranch_scc1 L_fin
    s_mov_b32 s69, 268435456
    s_lshl_b32 s3, s48, 17
    s_lshl_b32 s6, s53, 7
    s_add_u32 s3, s3, s6
    v_lshl_add_u32 v8, v5, 12, v23
    v_add_u32 v109, s3, v8
    v_add_u32 v110, 31744, v109
    v_add_u32 v111, 63488, v109
    v_add_u32 v112, 95232, v109
    v_mul_u32_u24 v8, 896, v5
    v_add_u32 v113, v8, v23
    v_add_u32 v114, 6144, v113
    v_lshl_add_u32 v118, v6, 4, v8
    s_mul_i32 s66, s4, 25088
    s_mul_i32 s3, s5, 14336
    s_add_u32 s66, s66, s3
    s_lshl_b32 s3, s54, 7
    s_add_u32 s66, s66, s3
    s_lshl_b32 s68, s53, 1
    s_add_u32 s68, s68, s5
    s_lshl_b32 s63, s68, 7
    s_add_u32 s63, s63, 6307840
    s_lshl_b32 s68, s68, 5
    s_add_u32 s68, s68, s4
    s_lshl_b32 s68, s68, 10
    s_add_u32 s68, s68, 4192256
    v_add_u32 v116, 15360, v4
    v_lshlrev_b32 v26, 2, v2
    s_xor_b32 s3, s4, s5
    s_lshl_b32 s3, s3, 6
    v_xor_b32 v100, s3, v12
    v_add_u32 v101, 65536, v100
    v_add_u32 v102, 131072, v100
    v_and_b32 v8, 1, v3
    v_lshrrev_b32 v9, 5, v1
    v_lshlrev_b32 v8, 10, v8
    v_lshl_add_u32 v8, v9, 8, v8
    v_lshl_add_u32 v8, v2, 4, v8
    s_mul_i32 s3, s4, 12288
    s_add_u32 s3, s3, 2048
    v_add_u32 v103, s3, v8
    v_xor_b32 v104, 4096, v103
    v_add_u32 v105, 65536, v103
    v_add_u32 v106, 65536, v104
    v_add_u32 v107, 131072, v103
    v_add_u32 v108, 131072, v104
    s_lshl_b32 s3, s54, 1
    s_add_u32 s3, s3, s5
    s_mul_i32 s3, s3, 28
    s_add_u32 s3, s3, s4
    s_lshl_b32 s3, s3, 12
    s_add_u32 s3, s3, 2097152
    v_add_u32 v117, s3, v4
    s_lshl_b32 s64, s54, 20
    s_lshl_b32 s65, s54, 14
    s_lshl_b32 s3, s53, 2
    s_add_u32 s3, s3, s48
    s_lshl_b32 s79, s3, 5
    s_mul_i32 s83, s3, 14336
    s_lshl_b32 s3, s54, 7
    s_add_u32 s83, s83, s3
    s_add_u32 s78, s83, 7168
    v_lshlrev_b32 v120, 1, v5
    s_lshl_b32 s3, s5, 3
    v_add_u32 v8, s3, v9
    v_xor_b32 v8, v8, v6
    v_and_b32 v9, 31, v1
    v_lshlrev_b32 v8, 4, v8
    v_lshl_add_u32 v8, v9, 8, v8
    s_lshl_b32 s3, s4, 14
    v_add_u32 v174, s3, v8
    v_xor_b32 v175, 32, v174
    v_xor_b32 v176, 64, v174
    v_xor_b32 v177, 96, v174
    v_lshlrev_b32 v8, 1, v6
    v_xor_b32 v8, v8, v5
    v_lshlrev_b32 v8, 4, v8
    v_lshl_add_u32 v8, v5, 8, v8
    v_add_u32 v178, s58, v8
    v_xor_b32 v179, 16, v178
    v_xor_b32 v180, 24576, v178
    v_xor_b32 v181, 24592, v178
    buffer_load_dword v25, v26, s[28:31], s63 offen sc1
    s_waitcnt vmcnt(0)
    v_cmp_ne_u32 vcc, s57, v25
    s_cbranch_vccz L_pollok2
    s_mov_b32 s61, 0
L_poll2:
    s_sleep 16
    buffer_load_dword v25, v26, s[28:31], s63 offen sc1
    s_add_u32 s61, s61, 1
    s_waitcnt vmcnt(0)
    v_cmp_ne_u32 vcc, s57, v25
    s_cbranch_vccz L_pollok2
    s_cmp_lt_u32 s61, 20000
    s_cbranch_scc1 L_poll2
L_pollok2:
    s_add_u32 m0, s58, 98304
    s_add_u32 s62, s66, 0
    buffer_load_dwordx4 v113, s[16:19], s62 offen lds
    buffer_load_dwordx4 v114, s[16:19], s62 offen offset:1024 lds
    s_add_u32 s62, s68, 0
    buffer_load_dwordx4 v4, s[28:31], s62 offen offset:2048 sc1 lds
    buffer_load_dwordx4 v116, s[28:31], s62 offen offset:3072 sc1 lds
    s_add_u32 m0, s58, 114688
    s_add_u32 s62, s66, 50176
    buffer_load_dwordx4 v113, s[16:19], s62 offen lds
    buffer_load_dwordx4 v114, s[16:19], s62 offen offset:1024 lds
    s_add_u32 s62, s68, 2048
    buffer_load_dwordx4 v4, s[28:31], s62 offen offset:2048 sc1 lds
    buffer_load_dwordx4 v116, s[28:31], s62 offen offset:3072 sc1 lds
    s_add_u32 m0, s58, 131072
    s_add_u32 s62, s66, 100352
    buffer_load_dwordx4 v113, s[16:19], s62 offen lds
    buffer_load_dwordx4 v114, s[16:19], s62 offen offset:1024 lds
    s_add_u32 s62, s68, 4096
    buffer_load_dwordx4 v4, s[28:31], s62 offen offset:2048 sc1 lds
    buffer_load_dwordx4 v116, s[28:31], s62 offen offset:3072 sc1 lds
    s_add_u32 m0, s58, 147456
    s_add_u32 s62, s66, 150528
    buffer_load_dwordx4 v113, s[16:19], s62 offen lds
    buffer_load_dwordx4 v114, s[16:19], s62 offen offset:1024 lds
    s_add_u32 s62, s68, 6144
    buffer_load_dwordx4 v4, s[28:31], s62 offen offset:2048 sc1 lds
    buffer_load_dwordx4 v116, s[28:31], s62 offen offset:3072 sc1 lds
    s_add_u32 m0, s58, 0
    s_add_u32 s62, s66, 200704
    buffer_load_dwordx4 v113, s[16:19], s62 offen lds
    buffer_load_dwordx4 v114, s[16:19], s62 offen offset:1024 lds
    s_add_u32 s62, s68, 8192
    buffer_load_dwordx4 v4, s[28:31], s62 offen offset:2048 sc1 lds
    buffer_load_dwordx4 v116, s[28:31], s62 offen offset:3072 sc1 lds
    s_waitcnt vmcnt(0) lgkmcnt(0)
    s_nop 3
L_f:
    s_waitcnt vmcnt(2)
    s_barrier
    ds_read_b64_tr_b16 v[182:183], v101 offset:32768
    s_add_u32 m0, s58, 16384
    s_add_u32 s62, s66, 250880
    buffer_load_dwordx4 v113, s[16:19], s62 offen lds
    ds_read_b64_tr_b16 v[184:185], v101 offset:36864
    ds_read_b128 v[68:71], v105 offset:32768
    ds_read_b128 v[72:75], v106 offset:32768
    ds_read_b64_tr_b16 v[186:187], v101 offset:33792
    ds_read_b64_tr_b16 v[188:189], v101 offset:37888
    ds_read_b128 v[76:79], v105 offset:33280
    ds_read_b128 v[80:83], v106 offset:33280
    s_waitcnt lgkmcnt(5)
    v_mfma_f32_32x32x16_bf16 v[36:51], v[182:185], v[68:71], 0
    buffer_load_dwordx4 v114, s[16:19], s62 offen offset:1024 lds
    ds_read_b64_tr_b16 v[190:191], v101 offset:49152
    ds_read_b64_tr_b16 v[192:193], v101 offset:53248
    ds_read_b128 v[84:87], v105 offset:49152
    s_waitcnt lgkmcnt(7)
    v_mfma_f32_32x32x16_bf16 v[52:67], v[182:185], v[72:75], 0
    s_add_u32 s62, s68, 10240
    buffer_load_dwordx4 v4, s[28:31], s62 offen offset:2048 sc1 lds
    ds_read_b128 v[88:91], v106 offset:49152
    s_waitcnt lgkmcnt(5)
    v_mfma_f32_32x32x16_bf16 v[36:51], v[186:189], v[76:79], v[36:51]
    buffer_load_dwordx4 v116, s[28:31], s62 offen offset:3072 sc1 lds
    ds_read_b64_tr_b16 v[194:195], v101 offset:50176
    ds_read_b64_tr_b16 v[196:197], v101 offset:54272
    ds_read_b128 v[92:95], v105 offset:49664
    s_waitcnt lgkmcnt(7)
    v_mfma_f32_32x32x16_bf16 v[52:67], v[186:189], v[80:83], v[52:67]
    s_add_u32 m0, s58, 32768
    s_add_u32 s62, s66, 301056
    buffer_load_dwordx4 v113, s[16:19], s62 offen lds
    ds_read_b128 v[96:99], v106 offset:49664
    s_waitcnt lgkmcnt(5)
    v_mfma_f32_32x32x16_bf16 v[36:51], v[190:193], v[84:87], v[36:51]
    buffer_load_dwordx4 v114, s[16:19], s62 offen offset:1024 lds
    ds_read_b64_tr_b16 v[182:183], v102 offset:0
    ds_read_b64_tr_b16 v[184:185], v102 offset:4096
    ds_read_b128 v[68:71], v107 offset:0
    s_waitcnt lgkmcnt(7)
    v_mfma_f32_32x32x16_bf16 v[52:67], v[190:193], v[88:91], v[52:67]
    s_add_u32 s62, s68, 12288
    buffer_load_dwordx4 v4, s[28:31], s62 offen offset:2048 sc1 lds
    ds_read_b128 v[72:75], v108 offset:0
    s_waitcnt lgkmcnt(5)
    v_mfma_f32_32x32x16_bf16 v[36:51], v[194:197], v[92:95], v[36:51]
    buffer_load_dwordx4 v116, s[28:31], s62 offen offset:3072 sc1 lds
    ds_read_b64_tr_b16 v[186:187], v102 offset:1024
    ds_read_b64_tr_b16 v[188:189], v102 offset:5120
    ds_read_b128 v[76:79], v107 offset:512
    s_waitcnt lgkmcnt(7)
    v_mfma_f32_32x32x16_bf16 v[52:67], v[194:197], v[96:99], v[52:67]
    s_add_u32 m0, s58, 49152
    s_add_u32 s62, s66, 351232
    buffer_load_dwordx4 v113, s[16:19], s62 offen lds
    ds_read_b128 v[80:83], v108 offset:512
    s_waitcnt lgkmcnt(5)
    v_mfma_f32_32x32x16_bf16 v[36:51], v[182:185], v[68:71], v[36:51]
    buffer_load_dwordx4 v114, s[16:19], s62 offen offset:1024 lds
    ds_read_b64_tr_b16 v[190:191], v102 offset:16384
    ds_read_b64_tr_b16 v[192:193], v102 offset:20480
    ds_read_b128 v[84:87], v107 offset:16384
    s_waitcnt lgkmcnt(7)
    v_mfma_f32_32x32x16_bf16 v[52:67], v[182:185], v[72:75], v[52:67]
    s_add_u32 s62, s68, 14336
    buffer_load_dwordx4 v4, s[28:31], s62 offen offset:2048 sc1 lds
    ds_read_b128 v[88:91], v108 offset:16384
    s_waitcnt lgkmcnt(5)
    v_mfma_f32_32x32x16_bf16 v[36:51], v[186:189], v[76:79], v[36:51]
    buffer_load_dwordx4 v116, s[28:31], s62 offen offset:3072 sc1 lds
    ds_read_b64_tr_b16 v[194:195], v102 offset:17408
    ds_read_b64_tr_b16 v[196:197], v102 offset:21504
    ds_read_b128 v[92:95], v107 offset:16896
    s_waitcnt lgkmcnt(7)
    v_mfma_f32_32x32x16_bf16 v[52:67], v[186:189], v[80:83], v[52:67]
    s_add_u32 m0, s58, 65536
    s_nop 0
    buffer_load_dwordx4 v109, s[24:27], s64 offen lds
    ds_read_b128 v[96:99], v108 offset:16896
    s_waitcnt lgkmcnt(5)
    v_mfma_f32_32x32x16_bf16 v[36:51], v[190:193], v[84:87], v[36:51]
    buffer_load_dwordx4 v110, s[24:27], s64 offen offset:1024 lds
    ds_read_b64_tr_b16 v[182:183], v100 offset:0
    ds_read_b64_tr_b16 v[184:185], v100 offset:4096
    ds_read_b128 v[68:71], v103 offset:0
    s_waitcnt lgkmcnt(7)
    v_mfma_f32_32x32x16_bf16 v[52:67], v[190:193], v[88:91], v[52:67]
    buffer_load_dwordx4 v111, s[24:27], s64 offen offset:2048 lds
    ds_read_b128 v[72:75], v104 offset:0
    s_waitcnt lgkmcnt(5)
    v_mfma_f32_32x32x16_bf16 v[36:51], v[194:197], v[92:95], v[36:51]
    buffer_load_dwordx4 v112, s[24:27], s64 offen offset:3072 lds
    ds_read_b64_tr_b16 v[186:187], v100 offset:1024
    ds_read_b64_tr_b16 v[188:189], v100 offset:5120
    ds_read_b128 v[76:79], v103 offset:512
    s_waitcnt lgkmcnt(7)
    v_mfma_f32_32x32x16_bf16 v[52:67], v[194:197], v[96:99], v[52:67]
    s_add_u32 m0, s58, 81920
    s_add_u32 s64, s64, 524288
    s_cmp_eq_u32 s64, 7340032
    s_cselect_b32 s64, 0, s64
    buffer_load_dwordx4 v109, s[24:27], s64 offen lds
    ds_read_b128 v[80:83], v104 offset:512
    s_waitcnt lgkmcnt(5)
    v_mfma_f32_32x32x16_bf16 v[36:51], v[182:185], v[68:71], v[36:51]
    buffer_load_dwordx4 v110, s[24:27], s64 offen offset:1024 lds
    s_waitcnt lgkmcnt(4)
    v_mfma_f32_32x32x16_bf16 v[52:67], v[182:185], v[72:75], v[52:67]
    buffer_load_dwordx4 v111, s[24:27], s64 offen offset:2048 lds
    s_waitcnt lgkmcnt(1)
    v_mfma_f32_32x32x16_bf16 v[36:51], v[186:189], v[76:79], v[36:51]
    buffer_load_dwordx4 v112, s[24:27], s64 offen offset:3072 lds
    s_waitcnt lgkmcnt(0)
    v_mfma_f32_32x32x16_bf16 v[52:67], v[186:189], v[80:83], v[52:67]
    s_barrier
    s_add_u32 m0, s58, 98304
    s_add_u32 s64, s64, 524288
    s_cmp_eq_u32 s64, 7340032
    s_cselect_b32 s64, 0, s64
    buffer_load_dwordx4 v109, s[24:27], s64 offen lds
    buffer_load_dwordx4 v110, s[24:27], s64 offen offset:1024 lds
    buffer_load_dwordx4 v111, s[24:27], s64 offen offset:2048 lds
    buffer_load_dwordx4 v112, s[24:27], s64 offen offset:3072 lds
    s_waitcnt vmcnt(24)
    buffer_store_dword v24, v7, s[28:31], s69 offen sc1
    s_add_u32 m0, s58, 114688
    s_add_u32 s64, s64, 524288
    s_cmp_eq_u32 s64, 7340032
    s_cselect_b32 s64, 0, s64
    buffer_load_dwordx4 v109, s[24:27], s64 offen lds
    buffer_load_dwordx4 v110, s[24:27], s64 offen offset:1024 lds
    buffer_load_dwordx4 v111, s[24:27], s64 offen offset:2048 lds
    buffer_load_dwordx4 v112, s[24:27], s64 offen offset:3072 lds
    s_waitcnt vmcnt(17)
    s_barrier
    ds_read_b64_tr_b16 v[182:183], v100 offset:16384
    ds_read_b64_tr_b16 v[184:185], v100 offset:20480
    ds_read_b128 v[68:71], v103 offset:16384
    ds_read_b128 v[72:75], v104 offset:16384
    ds_read_b64_tr_b16 v[186:187], v100 offset:17408
    ds_read_b64_tr_b16 v[188:189], v100 offset:21504
    ds_read_b128 v[76:79], v103 offset:16896
    ds_read_b128 v[80:83], v104 offset:16896
    s_waitcnt lgkmcnt(5)
    v_mfma_f32_32x32x16_bf16 v[36:51], v[182:185], v[68:71], v[36:51]
    s_add_u32 m0, s58, 131072
    s_add_u32 s64, s64, 524288
    s_cmp_eq_u32 s64, 7340032
    s_cselect_b32 s64, 0, s64
    buffer_load_dwordx4 v109, s[24:27], s64 offen lds
    ds_read_b64_tr_b16 v[190:191], v100 offset:32768
    ds_read_b64_tr_b16 v[192:193], v100 offset:36864
    ds_read_b128 v[84:87], v103 offset:32768
    s_waitcnt lgkmcnt(7)
    v_mfma_f32_32x32x16_bf16 v[52:67], v[182:185], v[72:75], v[52:67]
    buffer_load_dwordx4 v110, s[24:27], s64 offen offset:1024 lds
    ds_read_b128 v[88:91], v104 offset:32768
    s_waitcnt lgkmcnt(5)
    v_mfma_f32_32x32x16_bf16 v[36:51], v[186:189], v[76:79], v[36:51]
    buffer_load_dwordx4 v111, s[24:27], s64 offen offset:2048 lds
    ds_read_b64_tr_b16 v[194:195], v100 offset:33792
    ds_read_b64_tr_b16 v[196:197], v100 offset:37888
    ds_read_b128 v[92:95], v103 offset:33280
    s_waitcnt lgkmcnt(7)
    v_mfma_f32_32x32x16_bf16 v[52:67], v[186:189], v[80:83], v[52:67]
    buffer_load_dwordx4 v112, s[24:27], s64 offen offset:3072 lds
    ds_read_b128 v[96:99], v104 offset:33280
    s_waitcnt lgkmcnt(5)
    v_mfma_f32_32x32x16_bf16 v[36:51], v[190:193], v[84:87], v[36:51]
    s_add_u32 m0, s58, 147456
    s_add_u32 s64, s64, 524288
    s_cmp_eq_u32 s64, 7340032
    s_cselect_b32 s64, 0, s64
    buffer_load_dwordx4 v109, s[24:27], s64 offen lds
    ds_read_b64_tr_b16 v[182:183], v100 offset:49152
    ds_read_b64_tr_b16 v[184:185], v100 offset:53248
    ds_read_b128 v[68:71], v103 offset:49152
    s_waitcnt lgkmcnt(7)
    v_mfma_f32_32x32x16_bf16 v[52:67], v[190:193], v[88:91], v[52:67]
    buffer_load_dwordx4 v110, s[24:27], s64 offen offset:1024 lds
    ds_read_b128 v[72:75], v104 offset:49152
    s_waitcnt lgkmcnt(5)
    v_mfma_f32_32x32x16_bf16 v[36:51], v[194:197], v[92:95], v[36:51]
    buffer_load_dwordx4 v111, s[24:27], s64 offen offset:2048 lds
    ds_read_b64_tr_b16 v[186:187], v100 offset:50176
    ds_read_b64_tr_b16 v[188:189], v100 offset:54272
    ds_read_b128 v[76:79], v103 offset:49664
    s_waitcnt lgkmcnt(7)
    v_mfma_f32_32x32x16_bf16 v[52:67], v[194:197], v[96:99], v[52:67]
    buffer_load_dwordx4 v112, s[24:27], s64 offen offset:3072 lds
    ds_read_b128 v[80:83], v104 offset:49664
    s_waitcnt lgkmcnt(5)
    v_mfma_f32_32x32x16_bf16 v[36:51], v[182:185], v[68:71], v[36:51]
    s_add_u32 m0, s58, 0
    s_add_u32 s64, s64, 524288
    s_cmp_eq_u32 s64, 7340032
    s_cselect_b32 s64, 0, s64
    buffer_load_dwordx4 v109, s[24:27], s64 offen lds
    s_waitcnt lgkmcnt(4)
    v_mfma_f32_32x32x16_bf16 v[52:67], v[182:185], v[72:75], v[52:67]
    buffer_load_dwordx4 v110, s[24:27], s64 offen offset:1024 lds
    s_waitcnt lgkmcnt(1)
    v_mfma_f32_32x32x16_bf16 v[36:51], v[186:189], v[76:79], v[36:51]
    buffer_load_dwordx4 v111, s[24:27], s64 offen offset:2048 lds
    s_waitcnt lgkmcnt(0)
    v_mfma_f32_32x32x16_bf16 v[52:67], v[186:189], v[80:83], v[52:67]
    buffer_load_dwordx4 v112, s[24:27], s64 offen offset:3072 lds
    s_barrier
    s_lshl_b32 s63, s54, 1
    s_add_u32 s63, s63, s5
    s_lshl_b32 s63, s63, 1
    s_add_u32 s63, s63, s4
    s_lshl_b32 s63, s63, 7
    s_add_u32 s63, s63, 6299648
    v_min_u32 v26, 27, v1
    v_lshlrev_b32 v26, 2, v26
    s_add_u32 m0, s58, 16384
    s_add_u32 s64, s64, 524288
    s_cmp_eq_u32 s64, 7340032
    s_cselect_b32 s64, 0, s64
    buffer_load_dwordx4 v109, s[24:27], s64 offen lds
    buffer_load_dwordx4 v110, s[24:27], s64 offen offset:1024 lds
    buffer_load_dwordx4 v111, s[24:27], s64 offen offset:2048 lds
    buffer_load_dwordx4 v112, s[24:27], s64 offen offset:3072 lds
    s_add_u32 m0, s58, 32768
    s_add_u32 s64, s64, 524288
    s_cmp_eq_u32 s64, 7340032
    s_cselect_b32 s64, 0, s64
    buffer_load_dwordx4 v109, s[24:27], s64 offen lds
    buffer_load_dwordx4 v110, s[24:27], s64 offen offset:1024 lds
    buffer_load_dwordx4 v111, s[24:27], s64 offen offset:2048 lds
    buffer_load_dwordx4 v112, s[24:27], s64 offen offset:3072 lds
    buffer_load_dword v25, v26, s[28:31], s63 offen sc1
    s_add_u32 m0, s58, 49152
    s_add_u32 s64, s64, 524288
    s_cmp_eq_u32 s64, 7340032
    s_cselect_b32 s64, 0, s64
    buffer_load_dwordx4 v109, s[24:27], s64 offen lds
    buffer_load_dwordx4 v110, s[24:27], s64 offen offset:1024 lds
    buffer_load_dwordx4 v111, s[24:27], s64 offen offset:2048 lds
    buffer_load_dwordx4 v112, s[24:27], s64 offen offset:3072 lds
    buffer_load_dwordx4 v[130:133], v118, s[8:11], s83 offen
    buffer_load_ushort v138, v120, s[40:43], s79 offen offset:0
    buffer_load_dwordx4 v[134:137], v118, s[8:11], s78 offen
    buffer_load_ushort v139, v120, s[40:43], s79 offen offset:16
    s_waitcnt vmcnt(8)
    v_cmp_ne_u32 vcc, s57, v25
    s_cbranch_vccz L_pollok3
    s_mov_b32 s61, 0
L_poll3:
    s_sleep 8
    buffer_load_dword v25, v26, s[28:31], s63 offen sc1
    s_add_u32 s61, s61, 1
    s_waitcnt vmcnt(0)
    v_cmp_ne_u32 vcc, s57, v25
    s_cbranch_vccz L_pollok3
    s_cmp_lt_u32 s61, 20000
    s_cbranch_scc1 L_poll3
L_pollok3:
    buffer_load_dwordx4 a[0:3], v117, s[28:31], s65 offen offset:0 sc1
    buffer_load_dwordx4 a[4:7], v117, s[28:31], s65 offen offset:1024 sc1
    buffer_load_dwordx4 a[8:11], v117, s[28:31], s65 offen offset:2048 sc1
    buffer_load_dwordx4 a[12:15], v117, s[28:31], s65 offen offset:3072 sc1
    s_add_u32 s65, s65, 8192
    s_cmp_eq_u32 s65, 114688
    s_cselect_b32 s65, 0, s65
    buffer_load_dwordx4 a[16:19], v117, s[28:31], s65 offen offset:0 sc1
    buffer_load_dwordx4 a[20:23], v117, s[28:31], s65 offen offset:1024 sc1
    buffer_load_dwordx4 a[24:27], v117, s[28:31], s65 offen offset:2048 sc1
    buffer_load_dwordx4 a[28:31], v117, s[28:31], s65 offen offset:3072 sc1
    s_add_u32 s65, s65, 8192
    s_cmp_eq_u32 s65, 114688
    s_cselect_b32 s65, 0, s65
    buffer_load_dwordx4 a[32:35], v117, s[28:31], s65 offen offset:0 sc1
    buffer_load_dwordx4 a[36:39], v117, s[28:31], s65 offen offset:1024 sc1
    buffer_load_dwordx4 a[40:43], v117, s[28:31], s65 offen offset:2048 sc1
    buffer_load_dwordx4 a[44:47], v117, s[28:31], s65 offen offset:3072 sc1
    s_waitcnt vmcnt(16)
    s_barrier
    ds_read_b64_tr_b16 v[68:69], v14 offset:0
    s_add_u32 s65, s65, 8192
    s_cmp_eq_u32 s65, 114688
    s_cselect_b32 s65, 0, s65
    buffer_load_dwordx4 a[48:51], v117, s[28:31], s65 offen offset:0 sc1
    ds_read_b64_tr_b16 v[70:71], v14 offset:1024
    ds_read_b64_tr_b16 v[72:73], v15 offset:0
    ds_read_b64_tr_b16 v[74:75], v15 offset:1024
    ds_read_b64_tr_b16 v[76:77], v14 offset:2048
    ds_read_b64_tr_b16 v[78:79], v14 offset:3072
    ds_read_b64_tr_b16 v[80:81], v15 offset:2048
    ds_read_b64_tr_b16 v[82:83], v15 offset:3072
    ds_read_b64_tr_b16 v[84:85], v14 offset:4096
    ds_read_b64_tr_b16 v[86:87], v14 offset:5120
    ds_read_b64_tr_b16 v[88:89], v15 offset:4096
    ds_read_b64_tr_b16 v[90:91], v15 offset:5120
    s_waitcnt vmcnt(12) lgkmcnt(8)
    v_mfma_f32_32x32x16_bf16 v[36:51], a[0:3], v[68:71], v[36:51]
    ds_read_b64_tr_b16 v[92:93], v14 offset:6144
    ds_read_b64_tr_b16 v[94:95], v14 offset:7168
    v_mfma_f32_32x32x16_bf16 v[52:67], a[0:3], v[72:75], v[52:67]
    buffer_load_dwordx4 a[52:55], v117, s[28:31], s65 offen offset:1024 sc1
    ds_read_b64_tr_b16 v[96:97], v15 offset:6144
    ds_read_b64_tr_b16 v[98:99], v15 offset:7168
    s_waitcnt vmcnt(12) lgkmcnt(8)
    v_mfma_f32_32x32x16_bf16 v[36:51], a[4:7], v[76:79], v[36:51]
    ds_read_b64_tr_b16 v[68:69], v14 offset:16384
    ds_read_b64_tr_b16 v[70:71], v14 offset:17408
    v_mfma_f32_32x32x16_bf16 v[52:67], a[4:7], v[80:83], v[52:67]
    buffer_load_dwordx4 a[56:59], v117, s[28:31], s65 offen offset:2048 sc1
    ds_read_b64_tr_b16 v[72:73], v15 offset:16384
    ds_read_b64_tr_b16 v[74:75], v15 offset:17408
    s_waitcnt vmcnt(12) lgkmcnt(8)
    v_mfma_f32_32x32x16_bf16 v[36:51], a[8:11], v[84:87], v[36:51]
    ds_read_b64_tr_b16 v[76:77], v14 offset:18432
    ds_read_b64_tr_b16 v[78:79], v14 offset:19456
    v_mfma_f32_32x32x16_bf16 v[52:67], a[8:11], v[88:91], v[52:67]
    buffer_load_dwordx4 a[60:63], v117, s[28:31], s65 offen offset:3072 sc1
    ds_read_b64_tr_b16 v[80:81], v15 offset:18432
    ds_read_b64_tr_b16 v[82:83], v15 offset:19456
    s_waitcnt vmcnt(12) lgkmcnt(8)
    v_mfma_f32_32x32x16_bf16 v[36:51], a[12:15], v[92:95], v[36:51]
    ds_read_b64_tr_b16 v[84:85], v14 offset:20480
    ds_read_b64_tr_b16 v[86:87], v14 offset:21504
    v_mfma_f32_32x32x16_bf16 v[52:67], a[12:15], v[96:99], v[52:67]
    s_add_u32 s65, s65, 8192
    s_cmp_eq_u32 s65, 114688
    s_cselect_b32 s65, 0, s65
    buffer_load_dwordx4 a[64:67], v117, s[28:31], s65 offen offset:0 sc1
    ds_read_b64_tr_b16 v[88:89], v15 offset:20480
    ds_read_b64_tr_b16 v[90:91], v15 offset:21504
    s_waitcnt vmcnt(12) lgkmcnt(8)
    v_mfma_f32_32x32x16_bf16 v[36:51], a[16:19], v[68:71], v[36:51]
    ds_read_b64_tr_b16 v[92:93], v14 offset:22528
    ds_read_b64_tr_b16 v[94:95], v14 offset:23552
    v_mfma_f32_32x32x16_bf16 v[52:67], a[16:19], v[72:75], v[52:67]
    buffer_load_dwordx4 a[68:71], v117, s[28:31], s65 offen offset:1024 sc1
    ds_read_b64_tr_b16 v[96:97], v15 offset:22528
    ds_read_b64_tr_b16 v[98:99], v15 offset:23552
    s_waitcnt vmcnt(12) lgkmcnt(8)
    v_mfma_f32_32x32x16_bf16 v[36:51], a[20:23], v[76:79], v[36:51]
    ds_read_b64_tr_b16 v[68:69], v14 offset:32768
    ds_read_b64_tr_b16 v[70:71], v14 offset:33792
    v_mfma_f32_32x32x16_bf16 v[52:67], a[20:23], v[80:83], v[52:67]
    buffer_load_dwordx4 a[72:75], v117, s[28:31], s65 offen offset:2048 sc1
    ds_read_b64_tr_b16 v[72:73], v15 offset:32768
    ds_read_b64_tr_b16 v[74:75], v15 offset:33792
    s_waitcnt vmcnt(12) lgkmcnt(8)
    v_mfma_f32_32x32x16_bf16 v[36:51], a[24:27], v[84:87], v[36:51]
    ds_read_b64_tr_b16 v[76:77], v14 offset:34816
    ds_read_b64_tr_b16 v[78:79], v14 offset:35840
    v_mfma_f32_32x32x16_bf16 v[52:67], a[24:27], v[88:91], v[52:67]
    buffer_load_dwordx4 a[76:79], v117, s[28:31], s65 offen offset:3072 sc1
    ds_read_b64_tr_b16 v[80:81], v15 offset:34816
    ds_read_b64_tr_b16 v[82:83], v15 offset:35840
    s_waitcnt vmcnt(12) lgkmcnt(8)
    v_mfma_f32_32x32x16_bf16 v[36:51], a[28:31], v[92:95], v[36:51]
    ds_read_b64_tr_b16 v[84:85], v14 offset:36864
    ds_read_b64_tr_b16 v[86:87], v14 offset:37888
    v_mfma_f32_32x32x16_bf16 v[52:67], a[28:31], v[96:99], v[52:67]
    s_add_u32 s65, s65, 8192
    s_cmp_eq_u32 s65, 114688
    s_cselect_b32 s65, 0, s65
    buffer_load_dwordx4 a[80:83], v117, s[28:31], s65 offen offset:0 sc1
    ds_read_b64_tr_b16 v[88:89], v15 offset:36864
    ds_read_b64_tr_b16 v[90:91], v15 offset:37888
    s_waitcnt vmcnt(12) lgkmcnt(8)
    v_mfma_f32_32x32x16_bf16 v[36:51], a[32:35], v[68:71], v[36:51]
    ds_read_b64_tr_b16 v[92:93], v14 offset:38912
    ds_read_b64_tr_b16 v[94:95], v14 offset:39936
    v_lshlrev_b32 v138, 16, v138
    v_mfma_f32_32x32x16_bf16 v[52:67], a[32:35], v[72:75], v[52:67]
    buffer_load_dwordx4 a[84:87], v117, s[28:31], s65 offen offset:1024 sc1
    ds_read_b64_tr_b16 v[96:97], v15 offset:38912
    ds_read_b64_tr_b16 v[98:99], v15 offset:39936
    v_lshlrev_b32 v156, 16, v130
    s_waitcnt vmcnt(12) lgkmcnt(8)
    v_mfma_f32_32x32x16_bf16 v[36:51], a[36:39], v[76:79], v[36:51]
    s_barrier
    ds_read_b64_tr_b16 v[68:69], v14 offset:49152
    ds_read_b64_tr_b16 v[70:71], v14 offset:50176
    v_and_b32 v157, 0xffff0000, v130
    v_mfma_f32_32x32x16_bf16 v[52:67], a[36:39], v[80:83], v[52:67]
    buffer_load_dwordx4 a[88:91], v117, s[28:31], s65 offen offset:2048 sc1
    ds_read_b64_tr_b16 v[72:73], v15 offset:49152
    ds_read_b64_tr_b16 v[74:75], v15 offset:50176
    v_add_f32 v156, v156, v138
    s_waitcnt vmcnt(12) lgkmcnt(8)
    v_mfma_f32_32x32x16_bf16 v[36:51], a[40:43], v[84:87], v[36:51]
    ds_read_b64_tr_b16 v[76:77], v14 offset:51200
    ds_read_b64_tr_b16 v[78:79], v14 offset:52224
    v_add_f32 v157, v157, v138
    v_mfma_f32_32x32x16_bf16 v[52:67], a[40:43], v[88:91], v[52:67]
    buffer_load_dwordx4 a[92:95], v117, s[28:31], s65 offen offset:3072 sc1
    ds_read_b64_tr_b16 v[80:81], v15 offset:51200
    ds_read_b64_tr_b16 v[82:83], v15 offset:52224
    v_lshlrev_b32 v158, 16, v131
    s_waitcnt vmcnt(12) lgkmcnt(8)
    v_mfma_f32_32x32x16_bf16 v[36:51], a[44:47], v[92:95], v[36:51]
    ds_read_b64_tr_b16 v[84:85], v14 offset:53248
    ds_read_b64_tr_b16 v[86:87], v14 offset:54272
    v_and_b32 v159, 0xffff0000, v131
    v_mfma_f32_32x32x16_bf16 v[52:67], a[44:47], v[96:99], v[52:67]
    s_add_u32 s65, s65, 8192
    s_cmp_eq_u32 s65, 114688
    s_cselect_b32 s65, 0, s65
    buffer_load_dwordx4 a[96:99], v117, s[28:31], s65 offen offset:0 sc1
    ds_read_b64_tr_b16 v[88:89], v15 offset:53248
    ds_read_b64_tr_b16 v[90:91], v15 offset:54272
    v_add_f32 v158, v158, v138
    s_waitcnt vmcnt(12) lgkmcnt(8)
    v_mfma_f32_32x32x16_bf16 v[36:51], a[48:51], v[68:71], v[36:51]
    buffer_load_dwordx4 a[100:103], v117, s[28:31], s65 offen offset:1024 sc1
    ds_read_b64_tr_b16 v[92:93], v14 offset:55296
    ds_read_b64_tr_b16 v[94:95], v14 offset:56320
    v_add_f32 v159, v159, v138
    v_mfma_f32_32x32x16_bf16 v[52:67], a[48:51], v[72:75], v[52:67]
    buffer_load_dwordx4 a[104:107], v117, s[28:31], s65 offen offset:2048 sc1
    ds_read_b64_tr_b16 v[96:97], v15 offset:55296
    ds_read_b64_tr_b16 v[98:99], v15 offset:56320
    v_lshlrev_b32 v160, 16, v132
    s_waitcnt vmcnt(13) lgkmcnt(8)
    v_mfma_f32_32x32x16_bf16 v[36:51], a[52:55], v[76:79], v[36:51]
    buffer_load_dwordx4 a[108:111], v117, s[28:31], s65 offen offset:3072 sc1
    ds_read_b64_tr_b16 v[68:69], v16 offset:0
    ds_read_b64_tr_b16 v[70:71], v16 offset:1024
    v_and_b32 v161, 0xffff0000, v132
    v_mfma_f32_32x32x16_bf16 v[52:67], a[52:55], v[80:83], v[52:67]
    s_add_u32 m0, s58, 65536
    s_add_u32 s64, s64, 524288
    s_cmp_eq_u32 s64, 7340032
    s_cselect_b32 s64, 0, s64
    buffer_load_dwordx4 v109, s[24:27], s64 offen lds
    ds_read_b64_tr_b16 v[72:73], v17 offset:0
    ds_read_b64_tr_b16 v[74:75], v17 offset:1024
    v_add_f32 v160, v160, v138
    s_waitcnt vmcnt(14) lgkmcnt(8)
    v_mfma_f32_32x32x16_bf16 v[36:51], a[56:59], v[84:87], v[36:51]
    buffer_load_dwordx4 v110, s[24:27], s64 offen offset:1024 lds
    ds_read_b64_tr_b16 v[76:77], v16 offset:2048
    ds_read_b64_tr_b16 v[78:79], v16 offset:3072
    v_add_f32 v161, v161, v138
    v_mfma_f32_32x32x16_bf16 v[52:67], a[56:59], v[88:91], v[52:67]
    buffer_load_dwordx4 v111, s[24:27], s64 offen offset:2048 lds
    ds_read_b64_tr_b16 v[80:81], v17 offset:2048
    ds_read_b64_tr_b16 v[82:83], v17 offset:3072
    v_lshlrev_b32 v162, 16, v133
    s_waitcnt vmcnt(15) lgkmcnt(8)
    v_mfma_f32_32x32x16_bf16 v[36:51], a[60:63], v[92:95], v[36:51]
    buffer_load_dwordx4 v112, s[24:27], s64 offen offset:3072 lds
    ds_read_b64_tr_b16 v[84:85], v16 offset:4096
    ds_read_b64_tr_b16 v[86:87], v16 offset:5120
    v_and_b32 v163, 0xffff0000, v133
    v_mfma_f32_32x32x16_bf16 v[52:67], a[60:63], v[96:99], v[52:67]
    s_add_u32 s65, s65, 8192
    s_cmp_eq_u32 s65, 114688
    s_cselect_b32 s65, 0, s65
    buffer_load_dwordx4 a[112:115], v117, s[28:31], s65 offen offset:0 sc1
    ds_read_b64_tr_b16 v[88:89], v17 offset:4096
    ds_read_b64_tr_b16 v[90:91], v17 offset:5120
    v_add_f32 v162, v162, v138
    s_waitcnt vmcnt(16) lgkmcnt(8)
    v_mfma_f32_32x32x16_bf16 v[36:51], a[64:67], v[68:71], v[36:51]
    buffer_load_dwordx4 a[116:119], v117, s[28:31], s65 offen offset:1024 sc1
    ds_read_b64_tr_b16 v[92:93], v16 offset:6144
    ds_read_b64_tr_b16 v[94:95], v16 offset:7168
    v_add_f32 v163, v163, v138
    v_mfma_f32_32x32x16_bf16 v[52:67], a[64:67], v[72:75], v[52:67]
    buffer_load_dwordx4 a[120:123], v117, s[28:31], s65 offen offset:2048 sc1
    ds_read_b64_tr_b16 v[96:97], v17 offset:6144
    ds_read_b64_tr_b16 v[98:99], v17 offset:7168
    v_lshlrev_b32 v139, 16, v139
    s_waitcnt vmcnt(17) lgkmcnt(8)
    v_mfma_f32_32x32x16_bf16 v[36:51], a[68:71], v[76:79], v[36:51]
    buffer_load_dwordx4 a[124:127], v117, s[28:31], s65 offen offset:3072 sc1
    s_barrier
    ds_read_b64_tr_b16 v[68:69], v16 offset:16384
    ds_read_b64_tr_b16 v[70:71], v16 offset:17408
    v_lshlrev_b32 v164, 16, v134
    v_mfma_f32_32x32x16_bf16 v[52:67], a[68:71], v[80:83], v[52:67]
    s_add_u32 m0, s58, 81920
    s_add_u32 s64, s64, 524288
    s_cmp_eq_u32 s64, 7340032
    s_cselect_b32 s64, 0, s64
    buffer_load_dwordx4 v109, s[24:27], s64 offen lds
    ds_read_b64_tr_b16 v[72:73], v17 offset:16384
    ds_read_b64_tr_b16 v[74:75], v17 offset:17408
    v_and_b32 v165, 0xffff0000, v134
    s_waitcnt vmcnt(18) lgkmcnt(8)
    v_mfma_f32_32x32x16_bf16 v[36:51], a[72:75], v[84:87], v[36:51]
    buffer_load_dwordx4 v110, s[24:27], s64 offen offset:1024 lds
    ds_read_b64_tr_b16 v[76:77], v16 offset:18432
    ds_read_b64_tr_b16 v[78:79], v16 offset:19456
    v_add_f32 v164, v164, v139
    v_mfma_f32_32x32x16_bf16 v[52:67], a[72:75], v[88:91], v[52:67]
    buffer_load_dwordx4 v111, s[24:27], s64 offen offset:2048 lds
    ds_read_b64_tr_b16 v[80:81], v17 offset:18432
    ds_read_b64_tr_b16 v[82:83], v17 offset:19456
    v_add_f32 v165, v165, v139
    s_waitcnt vmcnt(19) lgkmcnt(8)
    v_mfma_f32_32x32x16_bf16 v[36:51], a[76:79], v[92:95], v[36:51]
    buffer_load_dwordx4 v112, s[24:27], s64 offen offset:3072 lds
    ds_read_b64_tr_b16 v[84:85], v16 offset:20480
    ds_read_b64_tr_b16 v[86:87], v16 offset:21504
    v_lshlrev_b32 v166, 16, v135
    v_mfma_f32_32x32x16_bf16 v[52:67], a[76:79], v[96:99], v[52:67]
    s_add_u32 s65, s65, 8192
    s_cmp_eq_u32 s65, 114688
    s_cselect_b32 s65, 0, s65
    buffer_load_dwordx4 a[128:131], v117, s[28:31], s65 offen offset:0 sc1
    ds_read_b64_tr_b16 v[88:89], v17 offset:20480
    ds_read_b64_tr_b16 v[90:91], v17 offset:21504
    v_and_b32 v167, 0xffff0000, v135
    s_waitcnt vmcnt(20) lgkmcnt(8)
    v_mfma_f32_32x32x16_bf16 v[36:51], a[80:83], v[68:71], v[36:51]
    buffer_load_dwordx4 a[132:135], v117, s[28:31], s65 offen offset:1024 sc1
    ds_read_b64_tr_b16 v[92:93], v16 offset:22528
    ds_read_b64_tr_b16 v[94:95], v16 offset:23552
    v_add_f32 v166, v166, v139
    v_mfma_f32_32x32x16_bf16 v[52:67], a[80:83], v[72:75], v[52:67]
    buffer_load_dwordx4 a[136:139], v117, s[28:31], s65 offen offset:2048 sc1
    ds_read_b64_tr_b16 v[96:97], v17 offset:22528
    ds_read_b64_tr_b16 v[98:99], v17 offset:23552
    v_add_f32 v167, v167, v139
    s_waitcnt vmcnt(21) lgkmcnt(8)
    v_mfma_f32_32x32x16_bf16 v[36:51], a[84:87], v[76:79], v[36:51]
    buffer_load_dwordx4 a[140:143], v117, s[28:31], s65 offen offset:3072 sc1
    ds_read_b64_tr_b16 v[68:69], v12 offset:0
    ds_read_b64_tr_b16 v[70:71], v12 offset:1024
    v_lshlrev_b32 v168, 16, v136
    v_mfma_f32_32x32x16_bf16 v[52:67], a[84:87], v[80:83], v[52:67]
    s_add_u32 m0, s58, 98304
    s_add_u32 s64, s64, 524288
    s_cmp_eq_u32 s64, 7340032
    s_cselect_b32 s64, 0, s64
    buffer_load_dwordx4 v109, s[24:27], s64 offen lds
    ds_read_b64_tr_b16 v[72:73], v13 offset:0
    ds_read_b64_tr_b16 v[74:75], v13 offset:1024
    v_and_b32 v169, 0xffff0000, v136
    s_waitcnt vmcnt(22) lgkmcnt(8)
    v_mfma_f32_32x32x16_bf16 v[36:51], a[88:91], v[84:87], v[36:51]
    buffer_load_dwordx4 v110, s[24:27], s64 offen offset:1024 lds
    ds_read_b64_tr_b16 v[76:77], v12 offset:2048
    ds_read_b64_tr_b16 v[78:79], v12 offset:3072
    v_add_f32 v168, v168, v139
    v_mfma_f32_32x32x16_bf16 v[52:67], a[88:91], v[88:91], v[52:67]
    buffer_load_dwordx4 v111, s[24:27], s64 offen offset:2048 lds
    ds_read_b64_tr_b16 v[80:81], v13 offset:2048
    ds_read_b64_tr_b16 v[82:83], v13 offset:3072
    v_add_f32 v169, v169, v139
    s_waitcnt vmcnt(23) lgkmcnt(8)
    v_mfma_f32_32x32x16_bf16 v[36:51], a[92:95], v[92:95], v[36:51]
    buffer_load_dwordx4 v112, s[24:27], s64 offen offset:3072 lds
    ds_read_b64_tr_b16 v[84:85], v12 offset:4096
    ds_read_b64_tr_b16 v[86:87], v12 offset:5120
    v_lshlrev_b32 v170, 16, v137
    v_mfma_f32_32x32x16_bf16 v[52:67], a[92:95], v[96:99], v[52:67]
    s_add_u32 s65, s65, 8192
    s_cmp_eq_u32 s65, 114688
    s_cselect_b32 s65, 0, s65
    buffer_load_dwordx4 a[144:147], v117, s[28:31], s65 offen offset:0 sc1
    ds_read_b64_tr_b16 v[88:89], v13 offset:4096
    ds_read_b64_tr_b16 v[90:91], v13 offset:5120
    v_and_b32 v171, 0xffff0000, v137
    s_waitcnt vmcnt(24) lgkmcnt(8)
    v_mfma_f32_32x32x16_bf16 v[36:51], a[96:99], v[68:71], v[36:51]
    buffer_load_dwordx4 a[148:151], v117, s[28:31], s65 offen offset:1024 sc1
    ds_read_b64_tr_b16 v[92:93], v12 offset:6144
    ds_read_b64_tr_b16 v[94:95], v12 offset:7168
    v_add_f32 v170, v170, v139
    v_mfma_f32_32x32x16_bf16 v[52:67], a[96:99], v[72:75], v[52:67]
    buffer_load_dwordx4 a[152:155], v117, s[28:31], s65 offen offset:2048 sc1
    ds_read_b64_tr_b16 v[96:97], v13 offset:6144
    ds_read_b64_tr_b16 v[98:99], v13 offset:7168
    v_add_f32 v171, v171, v139
    s_waitcnt vmcnt(25) lgkmcnt(8)
    v_mfma_f32_32x32x16_bf16 v[36:51], a[100:103], v[76:79], v[36:51]
    buffer_load_dwordx4 a[156:159], v117, s[28:31], s65 offen offset:3072 sc1
    ds_read_b64_tr_b16 v[68:69], v12 offset:16384
    ds_read_b64_tr_b16 v[70:71], v12 offset:17408
    v_mfma_f32_32x32x16_bf16 v[52:67], a[100:103], v[80:83], v[52:67]
    s_add_u32 m0, s58, 114688
    s_add_u32 s64, s64, 524288
    s_cmp_eq_u32 s64, 7340032
    s_cselect_b32 s64, 0, s64
    buffer_load_dwordx4 v109, s[24:27], s64 offen lds
    ds_read_b64_tr_b16 v[72:73], v13 offset:16384
    ds_read_b64_tr_b16 v[74:75], v13 offset:17408
    s_waitcnt vmcnt(26) lgkmcnt(8)
    v_mfma_f32_32x32x16_bf16 v[36:51], a[104:107], v[84:87], v[36:51]
    buffer_load_dwordx4 v110, s[24:27], s64 offen offset:1024 lds
    ds_read_b64_tr_b16 v[76:77], v12 offset:18432
    ds_read_b64_tr_b16 v[78:79], v12 offset:19456
    v_mfma_f32_32x32x16_bf16 v[52:67], a[104:107], v[88:91], v[52:67]
    buffer_load_dwordx4 v111, s[24:27], s64 offen offset:2048 lds
    ds_read_b64_tr_b16 v[80:81], v13 offset:18432
    ds_read_b64_tr_b16 v[82:83], v13 offset:19456
    s_waitcnt vmcnt(27) lgkmcnt(8)
    v_mfma_f32_32x32x16_bf16 v[36:51], a[108:111], v[92:95], v[36:51]
    buffer_load_dwordx4 v112, s[24:27], s64 offen offset:3072 lds
    ds_read_b64_tr_b16 v[84:85], v12 offset:20480
    ds_read_b64_tr_b16 v[86:87], v12 offset:21504
    v_mfma_f32_32x32x16_bf16 v[52:67], a[108:111], v[96:99], v[52:67]
    s_add_u32 s65, s65, 8192
    s_cmp_eq_u32 s65, 114688
    s_cselect_b32 s65, 0, s65
    buffer_load_dwordx4 a[160:163], v117, s[28:31], s65 offen offset:0 sc1
    ds_read_b64_tr_b16 v[88:89], v13 offset:20480
    ds_read_b64_tr_b16 v[90:91], v13 offset:21504
    s_waitcnt vmcnt(24) lgkmcnt(8)
    v_mfma_f32_32x32x16_bf16 v[36:51], a[112:115], v[68:71], v[36:51]
    ds_read_b64_tr_b16 v[92:93], v12 offset:22528
    ds_read_b64_tr_b16 v[94:95], v12 offset:23552
    v_mfma_f32_32x32x16_bf16 v[52:67], a[112:115], v[72:75], v[52:67]
    buffer_load_dwordx4 a[164:167], v117, s[28:31], s65 offen offset:1024 sc1
    ds_read_b64_tr_b16 v[96:97], v13 offset:22528
    ds_read_b64_tr_b16 v[98:99], v13 offset:23552
    s_waitcnt vmcnt(24) lgkmcnt(8)
    v_mfma_f32_32x32x16_bf16 v[36:51], a[116:119], v[76:79], v[36:51]
    ds_read_b64_tr_b16 v[68:69], v12 offset:32768
    ds_read_b64_tr_b16 v[70:71], v12 offset:33792
    v_mfma_f32_32x32x16_bf16 v[52:67], a[116:119], v[80:83], v[52:67]
    buffer_load_dwordx4 a[168:171], v117, s[28:31], s65 offen offset:2048 sc1
    ds_read_b64_tr_b16 v[72:73], v13 offset:32768
    ds_read_b64_tr_b16 v[74:75], v13 offset:33792
    s_waitcnt vmcnt(24) lgkmcnt(8)
    v_mfma_f32_32x32x16_bf16 v[36:51], a[120:123], v[84:87], v[36:51]
    ds_read_b64_tr_b16 v[76:77], v12 offset:34816
    ds_read_b64_tr_b16 v[78:79], v12 offset:35840
    v_mfma_f32_32x32x16_bf16 v[52:67], a[120:123], v[88:91], v[52:67]
    buffer_load_dwordx4 a[172:175], v117, s[28:31], s65 offen offset:3072 sc1
    ds_read_b64_tr_b16 v[80:81], v13 offset:34816
    ds_read_b64_tr_b16 v[82:83], v13 offset:35840
    s_waitcnt vmcnt(24) lgkmcnt(8)
    v_mfma_f32_32x32x16_bf16 v[36:51], a[124:127], v[92:95], v[36:51]
    ds_read_b64_tr_b16 v[84:85], v12 offset:36864
    ds_read_b64_tr_b16 v[86:87], v12 offset:37888
    v_mfma_f32_32x32x16_bf16 v[52:67], a[124:127], v[96:99], v[52:67]
    s_add_u32 s65, s65, 8192
    s_cmp_eq_u32 s65, 114688
    s_cselect_b32 s65, 0, s65
    buffer_load_dwordx4 a[176:179], v117, s[28:31], s65 offen offset:0 sc1
    ds_read_b64_tr_b16 v[88:89], v13 offset:36864
    ds_read_b64_tr_b16 v[90:91], v13 offset:37888
    s_waitcnt vmcnt(20) lgkmcnt(8)
    v_mfma_f32_32x32x16_bf16 v[36:51], a[128:131], v[68:71], v[36:51]
    ds_read_b64_tr_b16 v[92:93], v12 offset:38912
    ds_read_b64_tr_b16 v[94:95], v12 offset:39936
    v_mfma_f32_32x32x16_bf16 v[52:67], a[128:131], v[72:75], v[52:67]
    buffer_load_dwordx4 a[180:183], v117, s[28:31], s65 offen offset:1024 sc1
    ds_read_b64_tr_b16 v[96:97], v13 offset:38912
    ds_read_b64_tr_b16 v[98:99], v13 offset:39936
    s_waitcnt vmcnt(20) lgkmcnt(8)
    v_mfma_f32_32x32x16_bf16 v[36:51], a[132:135], v[76:79], v[36:51]
    ds_read_b64_tr_b16 v[68:69], v12 offset:49152
    ds_read_b64_tr_b16 v[70:71], v12 offset:50176
    v_mfma_f32_32x32x16_bf16 v[52:67], a[132:135], v[80:83], v[52:67]
    buffer_load_dwordx4 a[184:187], v117, s[28:31], s65 offen offset:2048 sc1
    ds_read_b64_tr_b16 v[72:73], v13 offset:49152
    ds_read_b64_tr_b16 v[74:75], v13 offset:50176
    s_waitcnt vmcnt(20) lgkmcnt(8)
    v_mfma_f32_32x32x16_bf16 v[36:51], a[136:139], v[84:87], v[36:51]
    ds_read_b64_tr_b16 v[76:77], v12 offset:51200
    ds_read_b64_tr_b16 v[78:79], v12 offset:52224
    v_mfma_f32_32x32x16_bf16 v[52:67], a[136:139], v[88:91], v[52:67]
    buffer_load_dwordx4 a[188:191], v117, s[28:31], s65 offen offset:3072 sc1
    ds_read_b64_tr_b16 v[80:81], v13 offset:51200
    ds_read_b64_tr_b16 v[82:83], v13 offset:52224
    s_waitcnt vmcnt(20) lgkmcnt(8)
    v_mfma_f32_32x32x16_bf16 v[36:51], a[140:143], v[92:95], v[36:51]
    ds_read_b64_tr_b16 v[84:85], v12 offset:53248
    ds_read_b64_tr_b16 v[86:87], v12 offset:54272
    v_mfma_f32_32x32x16_bf16 v[52:67], a[140:143], v[96:99], v[52:67]
    s_add_u32 s65, s65, 8192
    s_cmp_eq_u32 s65, 114688
    s_cselect_b32 s65, 0, s65
    buffer_load_dwordx4 a[192:195], v117, s[28:31], s65 offen offset:0 sc1
    ds_read_b64_tr_b16 v[88:89], v13 offset:53248
    ds_read_b64_tr_b16 v[90:91], v13 offset:54272
    s_waitcnt vmcnt(16) lgkmcnt(8)
    v_mfma_f32_32x32x16_bf16 v[36:51], a[144:147], v[68:71], v[36:51]
    ds_read_b64_tr_b16 v[92:93], v12 offset:55296
    ds_read_b64_tr_b16 v[94:95], v12 offset:56320
    v_mfma_f32_32x32x16_bf16 v[52:67], a[144:147], v[72:75], v[52:67]
    buffer_load_dwordx4 a[196:199], v117, s[28:31], s65 offen offset:1024 sc1
    ds_read_b64_tr_b16 v[96:97], v13 offset:55296
    ds_read_b64_tr_b16 v[98:99], v13 offset:56320
    s_waitcnt vmcnt(16) lgkmcnt(8)
    v_mfma_f32_32x32x16_bf16 v[36:51], a[148:151], v[76:79], v[36:51]
    s_waitcnt vmcnt(10)
    s_barrier
    ds_read_b64_tr_b16 v[68:69], v14 offset:0
    ds_read_b64_tr_b16 v[70:71], v14 offset:1024
    v_mfma_f32_32x32x16_bf16 v[52:67], a[148:151], v[80:83], v[52:67]
    buffer_load_dwordx4 a[200:203], v117, s[28:31], s65 offen offset:2048 sc1
    ds_read_b64_tr_b16 v[72:73], v15 offset:0
    ds_read_b64_tr_b16 v[74:75], v15 offset:1024
    s_waitcnt lgkmcnt(8)
    v_mfma_f32_32x32x16_bf16 v[36:51], a[152:155], v[84:87], v[36:51]
    ds_read_b64_tr_b16 v[76:77], v14 offset:2048
    ds_read_b64_tr_b16 v[78:79], v14 offset:3072
    v_mfma_f32_32x32x16_bf16 v[52:67], a[152:155], v[88:91], v[52:67]
    buffer_load_dwordx4 a[204:207], v117, s[28:31], s65 offen offset:3072 sc1
    ds_read_b64_tr_b16 v[80:81], v15 offset:2048
    ds_read_b64_tr_b16 v[82:83], v15 offset:3072
    s_waitcnt lgkmcnt(8)
    v_mfma_f32_32x32x16_bf16 v[36:51], a[156:159], v[92:95], v[36:51]
    ds_read_b64_tr_b16 v[84:85], v14 offset:4096
    ds_read_b64_tr_b16 v[86:87], v14 offset:5120
    v_mfma_f32_32x32x16_bf16 v[52:67], a[156:159], v[96:99], v[52:67]
    s_add_u32 s65, s65, 8192
    s_cmp_eq_u32 s65, 114688
    s_cselect_b32 s65, 0, s65
    buffer_load_dwordx4 a[208:211], v117, s[28:31], s65 offen offset:0 sc1
    ds_read_b64_tr_b16 v[88:89], v15 offset:4096
    ds_read_b64_tr_b16 v[90:91], v15 offset:5120
    s_waitcnt vmcnt(12) lgkmcnt(8)
    v_mfma_f32_32x32x16_bf16 v[36:51], a[160:163], v[68:71], v[36:51]
    ds_read_b64_tr_b16 v[92:93], v14 offset:6144
    ds_read_b64_tr_b16 v[94:95], v14 offset:7168
    v_mfma_f32_32x32x16_bf16 v[52:67], a[160:163], v[72:75], v[52:67]
    buffer_load_dwordx4 a[212:215], v117, s[28:31], s65 offen offset:1024 sc1
    ds_read_b64_tr_b16 v[96:97], v15 offset:6144
    ds_read_b64_tr_b16 v[98:99], v15 offset:7168
    s_waitcnt vmcnt(12) lgkmcnt(8)
    v_mfma_f32_32x32x16_bf16 v[36:51], a[164:167], v[76:79], v[36:51]
    ds_read_b64_tr_b16 v[68:69], v14 offset:16384
    ds_read_b64_tr_b16 v[70:71], v14 offset:17408
    v_mfma_f32_32x32x16_bf16 v[52:67], a[164:167], v[80:83], v[52:67]
    buffer_load_dwordx4 a[216:219], v117, s[28:31], s65 offen offset:2048 sc1
    ds_read_b64_tr_b16 v[72:73], v15 offset:16384
    ds_read_b64_tr_b16 v[74:75], v15 offset:17408
    s_waitcnt vmcnt(12) lgkmcnt(8)
    v_mfma_f32_32x32x16_bf16 v[36:51], a[168:171], v[84:87], v[36:51]
    ds_read_b64_tr_b16 v[76:77], v14 offset:18432
    ds_read_b64_tr_b16 v[78:79], v14 offset:19456
    v_mfma_f32_32x32x16_bf16 v[52:67], a[168:171], v[88:91], v[52:67]
    buffer_load_dwordx4 a[220:223], v117, s[28:31], s65 offen offset:3072 sc1
    ds_read_b64_tr_b16 v[80:81], v15 offset:18432
    ds_read_b64_tr_b16 v[82:83], v15 offset:19456
    s_waitcnt vmcnt(12) lgkmcnt(8)
    v_mfma_f32_32x32x16_bf16 v[36:51], a[172:175], v[92:95], v[36:51]
    ds_read_b64_tr_b16 v[84:85], v14 offset:20480
    ds_read_b64_tr_b16 v[86:87], v14 offset:21504
    v_mfma_f32_32x32x16_bf16 v[52:67], a[172:175], v[96:99], v[52:67]
    ds_read_b64_tr_b16 v[88:89], v15 offset:20480
    ds_read_b64_tr_b16 v[90:91], v15 offset:21504
    s_waitcnt vmcnt(11) lgkmcnt(8)
    v_mfma_f32_32x32x16_bf16 v[36:51], a[176:179], v[68:71], v[36:51]
    ds_read_b64_tr_b16 v[92:93], v14 offset:22528
    ds_read_b64_tr_b16 v[94:95], v14 offset:23552
    v_mfma_f32_32x32x16_bf16 v[52:67], a[176:179], v[72:75], v[52:67]
    ds_read_b64_tr_b16 v[96:97], v15 offset:22528
    ds_read_b64_tr_b16 v[98:99], v15 offset:23552
    s_waitcnt vmcnt(10) lgkmcnt(8)
    v_mfma_f32_32x32x16_bf16 v[36:51], a[180:183], v[76:79], v[36:51]
    ds_read_b64_tr_b16 v[68:69], v14 offset:32768
    ds_read_b64_tr_b16 v[70:71], v14 offset:33792
    v_mfma_f32_32x32x16_bf16 v[52:67], a[180:183], v[80:83], v[52:67]
    ds_read_b64_tr_b16 v[72:73], v15 offset:32768
    ds_read_b64_tr_b16 v[74:75], v15 offset:33792
    s_waitcnt vmcnt(9) lgkmcnt(8)
    v_mfma_f32_32x32x16_bf16 v[36:51], a[184:187], v[84:87], v[36:51]
    ds_read_b64_tr_b16 v[76:77], v14 offset:34816
    ds_read_b64_tr_b16 v[78:79], v14 offset:35840
    v_mfma_f32_32x32x16_bf16 v[52:67], a[184:187], v[88:91], v[52:67]
    ds_read_b64_tr_b16 v[80:81], v15 offset:34816
    ds_read_b64_tr_b16 v[82:83], v15 offset:35840
    s_waitcnt vmcnt(8) lgkmcnt(8)
    v_mfma_f32_32x32x16_bf16 v[36:51], a[188:191], v[92:95], v[36:51]
    ds_read_b64_tr_b16 v[84:85], v14 offset:36864
    ds_read_b64_tr_b16 v[86:87], v14 offset:37888
    v_mfma_f32_32x32x16_bf16 v[52:67], a[188:191], v[96:99], v[52:67]
    ds_read_b64_tr_b16 v[88:89], v15 offset:36864
    ds_read_b64_tr_b16 v[90:91], v15 offset:37888
    s_waitcnt vmcnt(7) lgkmcnt(8)
    v_mfma_f32_32x32x16_bf16 v[36:51], a[192:195], v[68:71], v[36:51]
    ds_read_b64_tr_b16 v[92:93], v14 offset:38912
    ds_read_b64_tr_b16 v[94:95], v14 offset:39936
    v_mfma_f32_32x32x16_bf16 v[52:67], a[192:195], v[72:75], v[52:67]
    ds_read_b64_tr_b16 v[96:97], v15 offset:38912
    ds_read_b64_tr_b16 v[98:99], v15 offset:39936
    s_waitcnt vmcnt(6) lgkmcnt(8)
    v_mfma_f32_32x32x16_bf16 v[36:51], a[196:199], v[76:79], v[36:51]
    ds_read_b64_tr_b16 v[68:69], v14 offset:49152
    ds_read_b64_tr_b16 v[70:71], v14 offset:50176
    v_mfma_f32_32x32x16_bf16 v[52:67], a[196:199], v[80:83], v[52:67]
    ds_read_b64_tr_b16 v[72:73], v15 offset:49152
    ds_read_b64_tr_b16 v[74:75], v15 offset:50176
    s_waitcnt vmcnt(5) lgkmcnt(8)
    v_mfma_f32_32x32x16_bf16 v[36:51], a[200:203], v[84:87], v[36:51]
    ds_read_b64_tr_b16 v[76:77], v14 offset:51200
    ds_read_b64_tr_b16 v[78:79], v14 offset:52224
    v_mfma_f32_32x32x16_bf16 v[52:67], a[200:203], v[88:91], v[52:67]
    ds_read_b64_tr_b16 v[80:81], v15 offset:51200
    ds_read_b64_tr_b16 v[82:83], v15 offset:52224
    s_waitcnt vmcnt(4) lgkmcnt(8)
    v_mfma_f32_32x32x16_bf16 v[36:51], a[204:207], v[92:95], v[36:51]
    ds_read_b64_tr_b16 v[84:85], v14 offset:53248
    ds_read_b64_tr_b16 v[86:87], v14 offset:54272
    v_mfma_f32_32x32x16_bf16 v[52:67], a[204:207], v[96:99], v[52:67]
    ds_read_b64_tr_b16 v[88:89], v15 offset:53248
    ds_read_b64_tr_b16 v[90:91], v15 offset:54272
    s_waitcnt vmcnt(3) lgkmcnt(8)
    v_mfma_f32_32x32x16_bf16 v[36:51], a[208:211], v[68:71], v[36:51]
    ds_read_b64_tr_b16 v[92:93], v14 offset:55296
    ds_read_b64_tr_b16 v[94:95], v14 offset:56320
    v_mfma_f32_32x32x16_bf16 v[52:67], a[208:211], v[72:75], v[52:67]
    ds_read_b64_tr_b16 v[96:97], v15 offset:55296
    ds_read_b64_tr_b16 v[98:99], v15 offset:56320
    s_waitcnt vmcnt(2) lgkmcnt(8)
    v_mfma_f32_32x32x16_bf16 v[36:51], a[212:215], v[76:79], v[36:51]
    v_mfma_f32_32x32x16_bf16 v[52:67], a[212:215], v[80:83], v[52:67]
    s_waitcnt vmcnt(1) lgkmcnt(4)
    v_mfma_f32_32x32x16_bf16 v[36:51], a[216:219], v[84:87], v[36:51]
    v_mfma_f32_32x32x16_bf16 v[52:67], a[216:219], v[88:91], v[52:67]
    s_waitcnt vmcnt(0) lgkmcnt(0)
    v_mfma_f32_32x32x16_bf16 v[36:51], a[220:223], v[92:95], v[36:51]
    v_mfma_f32_32x32x16_bf16 v[52:67], a[220:223], v[96:99], v[52:67]
    s_nop 10
    ds_write_b128 v174, v[36:39] offset:0
    ds_write_b128 v175, v[40:43] offset:0
    ds_write_b128 v176, v[44:47] offset:0
    ds_write_b128 v177, v[48:51] offset:0
    ds_write_b128 v174, v[52:55] offset:8192
    ds_write_b128 v175, v[56:59] offset:8192
    ds_write_b128 v176, v[60:63] offset:8192
    ds_write_b128 v177, v[64:67] offset:8192
    s_waitcnt lgkmcnt(0)
    s_barrier
    ds_read_b128 v[68:71], v178 offset:0
    ds_read_b128 v[72:75], v179 offset:0
    ds_read_b128 v[76:79], v180 offset:0
    ds_read_b128 v[80:83], v181 offset:0
    ds_read_b128 v[84:87], v178 offset:2048
    ds_read_b128 v[88:91], v179 offset:2048
    ds_read_b128 v[92:95], v180 offset:2048
    ds_read_b128 v[96:99], v181 offset:2048
    s_waitcnt lgkmcnt(7)
    v_pk_add_f32 v[156:157], v[156:157], v[68:69]
    v_pk_add_f32 v[158:159], v[158:159], v[70:71]
    s_waitcnt lgkmcnt(6)
    v_pk_add_f32 v[160:161], v[160:161], v[72:73]
    v_pk_add_f32 v[162:163], v[162:163], v[74:75]
    s_waitcnt lgkmcnt(5)
    v_pk_add_f32 v[156:157], v[156:157], v[76:77]
    v_pk_add_f32 v[158:159], v[158:159], v[78:79]
    s_waitcnt lgkmcnt(4)
    v_pk_add_f32 v[160:161], v[160:161], v[80:81]
    v_pk_add_f32 v[162:163], v[162:163], v[82:83]
    v_cvt_pk_bf16_f32 v28, v156, v157
    v_cvt_pk_bf16_f32 v29, v158, v159
    v_cvt_pk_bf16_f32 v30, v160, v161
    v_cvt_pk_bf16_f32 v31, v162, v163
    buffer_store_dwordx4 v[28:31], v118, s[32:35], s83 offen
    s_waitcnt lgkmcnt(3)
    v_pk_add_f32 v[164:165], v[164:165], v[84:85]
    v_pk_add_f32 v[166:167], v[166:167], v[86:87]
    s_waitcnt lgkmcnt(2)
    v_pk_add_f32 v[168:169], v[168:169], v[88:89]
    v_pk_add_f32 v[170:171], v[170:171], v[90:91]
    s_waitcnt lgkmcnt(1)
    v_pk_add_f32 v[164:165], v[164:165], v[92:93]
    v_pk_add_f32 v[166:167], v[166:167], v[94:95]
    s_waitcnt lgkmcnt(0)
    v_pk_add_f32 v[168:169], v[168:169], v[96:97]
    v_pk_add_f32 v[170:171], v[170:171], v[98:99]
    v_cvt_pk_bf16_f32 v32, v164, v165
    v_cvt_pk_bf16_f32 v33, v166, v167
    v_cvt_pk_bf16_f32 v34, v168, v169
    v_cvt_pk_bf16_f32 v35, v170, v171
    buffer_store_dwordx4 v[32:35], v118, s[32:35], s78 offen
L_fin:
L_end:
    s_endpgm
.section .rodata,"a"
.p2align 6
.amdhsa_kernel parallel_sum__sliding_local_dilated__mixer_token_mlp__prompt_kernel
  .amdhsa_next_free_vgpr 512
  .amdhsa_next_free_sgpr 102
  .amdhsa_accum_offset 256
  .amdhsa_group_segment_fixed_size 0
  .amdhsa_kernarg_size 88
  .amdhsa_user_sgpr_count 2
  .amdhsa_user_sgpr_kernarg_segment_ptr 1
  .amdhsa_system_sgpr_workgroup_id_x 1
.end_amdhsa_kernel
```

```asm
; @launch grid=(256,1,1) block=(256,1,1) lds=163840
.amdgcn_target "amdgcn-amd-amdhsa--gfx950"
.text
.globl parallel_sum__sliding_local_dilated__mixer_token_mlp__prompt_kernel
.p2align 8
.type parallel_sum__sliding_local_dilated__mixer_token_mlp__prompt_kernel,@function
parallel_sum__sliding_local_dilated__mixer_token_mlp__prompt_kernel:
    s_cmp_ge_u32 s2, 256
    s_cbranch_scc1 L_end
    s_load_dwordx2 s[8:9], s[0:1], 0
    s_load_dwordx2 s[20:21], s[0:1], 32
    s_load_dwordx2 s[28:29], s[0:1], 80
    s_load_dwordx2 s[44:45], s[0:1], 72
    s_load_dwordx2 s[12:13], s[0:1], 8
    s_load_dwordx2 s[16:17], s[0:1], 16
    s_load_dwordx2 s[24:25], s[0:1], 48
    s_load_dwordx2 s[32:33], s[0:1], 64
    s_load_dwordx2 s[36:37], s[0:1], 40
    s_load_dwordx2 s[40:41], s[0:1], 56
    s_memrealtime s[78:79]
    s_getpc_b64 s[6:7]
L_pc:
    s_and_b32 s3, s2, 0xf8
    v_lshrrev_b32 v14, 5, v0
    v_add_lshl_u32 v14, s3, v14, 7
    v_min_u32 v14, L_end-L_pc-4, v14
    global_load_dword v18, v14, s[6:7]
    v_lshrrev_b32 v14, 6, v0
    v_and_b32 v10, 31, v0
    v_readfirstlane_b32 s48, v14
    v_bfe_u32 v9, v0, 5, 1
    v_mul_u32_u24 v15, 896, v9
    v_lshl_add_u32 v15, v10, 4, v15
    v_cmp_gt_u32 vcc, 28, v10
    v_mov_b32 v16, 268435456
    s_mov_b32 s10, 1835008
    s_mov_b32 s11, 0x20000
    v_cndmask_b32 v15, v16, v15, vcc
    s_lshr_b32 s4, s48, 1
    s_and_b32 s5, s48, 1
    s_and_b32 s3, s2, 0xfe
    s_add_u32 s3, s3, s4
    s_lshl_b32 s3, s3, 1
    s_and_b32 s60, s2, 1
    s_add_u32 s3, s3, s60
    s_lshl_b32 s3, s3, 1
    s_add_u32 s3, s3, s5
    s_mul_i32 s3, s3, 1792
    s_waitcnt lgkmcnt(0)
    buffer_load_dwordx4 v[170:173], v15, s[8:11], s3 offen
    buffer_load_dwordx4 v[174:177], v15, s[8:11], s3 offen offset:448
    v_and_b32 v1, 63, v0
    s_mov_b32 s46, 256
    s_mov_b32 s47, 0x20000
    s_lshl_b32 s3, s48, 8
    s_add_u32 s3, s3, s2
    s_cmp_lt_u32 s3, 8
    s_cselect_b32 s3, 0, 268435456
    s_or_b32 s78, s78, 1
    v_mov_b32 v222, s78
    v_mov_b32 v223, 0
    v_lshlrev_b32 v11, 24, v1
    v_min_u32 v13, 1, v0
    v_lshlrev_b32 v13, 24, v13
    buffer_atomic_cmpswap v[222:223], v11, s[44:47], s3 offen sc1
    s_bfe_u32 s6, s2, 0x20001
    s_and_b32 s7, s2, 1
    s_and_b32 s61, s2, 7
    s_lshr_b32 s101, s2, 3
    s_mul_i32 s52, s7, 25
    s_add_u32 s52, s52, s101
    s_mul_i32 s51, s52, 37
    s_lshr_b32 s51, s51, 8
    s_mul_i32 s3, s51, 7
    s_sub_u32 s52, s52, s3
    s_mul_i32 s3, s6, 7
    s_add_u32 s51, s51, s3
    s_max_u32 s60, s101, 25
    s_sub_u32 s60, s60, 25
    s_add_u32 s3, s101, s7
    s_cmp_lt_u32 s3, 25
    s_cselect_b32 s55, 1, 0
    s_cselect_b32 s52, s52, s60
    s_mov_b32 s22, 7340032
    s_mov_b32 s23, 0x20000
    s_mul_i32 s3, s52, 2
    s_mul_i32 s60, s51, 0
    s_add_u32 s3, s3, s60
    s_mul_i32 s60, s3, 37
    s_lshr_b32 s60, s60, 8
    s_mul_i32 s60, s60, 7
    s_sub_u32 s3, s3, s60
    s_mul_i32 s3, s3, 37
    s_lshr_b32 s3, s3, 4
    s_mul_i32 s60, s6, 1
    s_add_u32 s3, s3, s60
    s_and_b32 s3, s3, 15
    s_mul_i32 s0, s3, 458752
    s_lshl_b32 s1, s3, 13
    s_lshl_b32 s58, s48, 12
    v_lshrrev_b32 v3, 4, v1
    v_lshrrev_b32 v5, 3, v1
    v_and_b32 v6, 7, v1
    v_and_b32 v14, 1, v3
    v_lshlrev_b32 v15, 2, v14
    v_xor_b32 v15, v15, v6
    v_lshlrev_b32 v69, 4, v15
    s_cmp_eq_u32 s55, 0
    s_cbranch_scc1 L_nog1
    v_mul_u32_u24 v15, 3584, v5
    s_mul_i32 s3, s48, 114688
    s_lshl_b32 s60, s51, 7
    s_add_u32 s3, s3, s60
    v_add3_u32 v41, v15, v69, s3
    v_add_u32 v42, 27648, v41
    v_add_u32 v43, 55296, v41
    v_add_u32 v44, 82944, v41
    s_mov_b32 s38, 3584
    s_mov_b32 s39, 0x20000
    v_lshlrev_b32 v14, 3, v9
    s_lshl_b32 s3, s51, 1
    s_add_u32 s3, s3, s4
    s_lshl_b32 s3, s3, 6
    buffer_load_dwordx2 v[234:235], v14, s[36:39], s3 offen offset:0
    buffer_load_dwordx2 v[236:237], v14, s[36:39], s3 offen offset:16
    buffer_load_dwordx2 v[238:239], v14, s[36:39], s3 offen offset:32
    buffer_load_dwordx2 v[240:241], v14, s[36:39], s3 offen offset:48
    s_add_u32 m0, s58, 0
    s_nop 0
    buffer_load_dwordx4 v41, s[20:23], s0 offen lds
    buffer_load_dwordx4 v42, s[20:23], s0 offen offset:1024 lds
    buffer_load_dwordx4 v43, s[20:23], s0 offen offset:2048 lds
    buffer_load_dwordx4 v44, s[20:23], s0 offen offset:3072 lds
    s_mul_i32 s53, s101, 37
    s_lshr_b32 s53, s53, 8
    s_mul_i32 s54, s53, 7
    s_sub_u32 s54, s101, s54
    s_cmp_lt_u32 s101, 28
    s_cselect_b32 s53, s53, s54
    s_lshl_b32 s3, s61, 2
    s_add_u32 s53, s53, s3
    s_cmp_lt_u32 s101, 28
    s_cselect_b32 s56, 1, 0
    s_lshl_b32 s50, s7, 3
    s_and_b32 s3, s101, 7
    s_add_u32 s50, s50, s3
    s_lshr_b32 s60, s101, 3
    s_lshl_b32 s49, s6, 2
    s_add_u32 s49, s49, s60
    s_lshl_b32 s49, s49, 2
    s_add_u32 s49, s49, s48
    s_mul_i32 s60, s60, 0
    s_add_u32 s3, s3, s60
    s_sub_u32 s60, s3, 7
    s_cmp_ge_u32 s3, 7
    s_cselect_b32 s3, s60, s3
    s_lshl_b32 s62, s3, 18
    s_mul_i32 s63, s3, 12288
    s_mov_b32 s30, 12582912
    s_mov_b32 s31, 0x20000
    s_mov_b32 s75, 0x3727c5ac
    s_mov_b32 s76, 0x3b124925
    s_mov_b32 s77, 0x3f803f80
    v_lshlrev_b32 v4, 4, v1
    v_bfe_u32 v7, v1, 2, 2
    v_and_b32 v8, 3, v1
    v_mul_u32_u24 v14, 960, v9
    v_lshl_add_u32 v14, v10, 4, v14
    s_mul_i32 s3, s48, 1920
    s_add_u32 s3, s3, 147456
    v_add_u32 v218, s3, v14
    v_mul_u32_u24 v14, 960, v7
    v_lshl_add_u32 v14, v3, 5, v14
    v_lshl_add_u32 v14, v8, 3, v14
    s_lshl_b32 s3, s48, 8
    s_add_u32 s3, s3, 147456
    v_add_u32 v219, s3, v14
    s_lshl_b32 s3, s48, 3
    s_add_u32 s3, s3, 155648
    v_lshl_add_u32 v220, v9, 2, s3
    v_lshlrev_b32 v225, 2, v6
    v_lshl_add_u32 v226, v5, 24, v225
    v_add_u32 v225, 155648, v225
    v_lshlrev_b32 v14, 17, v9
    v_lshl_add_u32 v221, v10, 4, v14
    s_cmp_eq_u32 s48, 3
    s_cselect_b32 s60, 268435456, 0
    s_lshl_b32 s70, s48, 10
    s_add_u32 s70, s70, s2
    s_lshl_b32 s70, s70, 9
    s_add_u32 s71, s70, 262144
    s_add_u32 s71, s71, s60
    s_xor_b32 s60, s60, 268435456
    s_lshl_b32 s72, s2, 7
    s_add_u32 s72, s72, s60
    s_add_u32 s72, s72, 6291456
    s_lshr_b32 s74, s2, 2
    s_lshl_b32 s74, s74, 5
    s_and_b32 s3, s2, 3
    s_add_u32 s74, s74, s3
    s_lshl_b32 s74, s74, 2
    s_add_u32 s74, s74, 10485760
    v_cmp_gt_u32 vcc, 8, v0
    v_lshlrev_b32 v224, 13, v0
    v_mov_b32 v14, 268435456
    s_and_b32 s83, s2, 7
    s_lshl_b32 s83, s83, 5
    s_add_u32 s83, s83, s4
    s_lshl_b32 s83, s83, 8
    s_add_u32 s83, s83, 10485760
    v_cndmask_b32 v224, v14, v224, vcc
    v_mov_b32 v17, 0
    s_waitcnt vmcnt(10)
    v_dot2_f32_bf16 v214, v170, s77, 0
    v_dot2_f32_bf16 v215, v170, v170, 0
    v_dot2_f32_bf16 v214, v171, s77, v214
    v_dot2_f32_bf16 v215, v171, v171, v215
    v_dot2_f32_bf16 v214, v172, s77, v214
    v_dot2_f32_bf16 v215, v172, v172, v215
    v_dot2_f32_bf16 v214, v173, s77, v214
    v_dot2_f32_bf16 v215, v173, v173, v215
    s_waitcnt vmcnt(9)
    v_dot2_f32_bf16 v214, v174, s77, v214
    v_dot2_f32_bf16 v215, v174, v174, v215
    v_dot2_f32_bf16 v214, v175, s77, v214
    v_dot2_f32_bf16 v215, v175, v175, v215
    v_dot2_f32_bf16 v214, v176, s77, v214
    v_dot2_f32_bf16 v215, v176, v176, v215
    v_dot2_f32_bf16 v214, v177, s77, v214
    v_dot2_f32_bf16 v215, v177, v177, v215
    buffer_load_dword v12, v17, s[44:47], 0 offen sc1
    v_lshlrev_b32 v178, 16, v170
    v_and_b32 v179, 0xffff0000, v170
    v_add_f32_dpp v214, v214, v214 quad_perm:[1,0,3,2] row_mask:0xf bank_mask:0xf
    v_add_f32_dpp v215, v215, v215 quad_perm:[1,0,3,2] row_mask:0xf bank_mask:0xf
    v_lshlrev_b32 v180, 16, v171
    v_add_f32_dpp v214, v214, v214 quad_perm:[2,3,0,1] row_mask:0xf bank_mask:0xf
    v_add_f32_dpp v215, v215, v215 quad_perm:[2,3,0,1] row_mask:0xf bank_mask:0xf
    v_and_b32 v181, 0xffff0000, v171
    v_add_f32_dpp v214, v214, v214 row_half_mirror row_mask:0xf bank_mask:0xf
    v_add_f32_dpp v215, v215, v215 row_half_mirror row_mask:0xf bank_mask:0xf
    v_lshlrev_b32 v182, 16, v172
    v_add_f32_dpp v214, v214, v214 row_mirror row_mask:0xf bank_mask:0xf
    v_add_f32_dpp v215, v215, v215 row_mirror row_mask:0xf bank_mask:0xf
    v_and_b32 v183, 0xffff0000, v172
    v_mov_b32 v216, v214
    v_mov_b32 v217, v215
    v_lshlrev_b32 v184, 16, v173
    v_permlane16_swap_b32 v214, v216
    v_permlane16_swap_b32 v215, v217
    v_add_f32 v214, v214, v216
    v_add_f32 v215, v215, v217
    v_mul_f32_e64 v214, -v214, s76
    v_mul_f32 v216, v214, v214
    v_fma_f32 v215, v215, s76, -v216
    v_max_f32 v215, 0, v215
    v_add_f32 v216, s75, v215
    v_rsq_f32 v210, v216
    v_and_b32 v185, 0xffff0000, v173
    v_mul_f32 v216, v210, v210
    v_fma_f32 v217, v216, v215, s75
    v_rsq_f32 v216, v217
    v_mul_f32 v211, v214, v210
    v_mul_f32 v212, v210, v216
    v_mul_f32 v213, v211, v216
    v_mul_f32 v217, v217, v216
    ds_write_b32 v220, v217
    v_lshlrev_b32 v186, 16, v174
    v_and_b32 v187, 0xffff0000, v174
    v_lshlrev_b32 v188, 16, v175
    v_and_b32 v189, 0xffff0000, v175
    v_lshlrev_b32 v190, 16, v176
    v_and_b32 v191, 0xffff0000, v176
    v_lshlrev_b32 v192, 16, v177
    v_and_b32 v193, 0xffff0000, v177
    v_pk_fma_f32 v[194:195], v[178:179], v[212:213], v[212:213] op_sel:[0,0,1] op_sel_hi:[1,0,1]
    v_pk_fma_f32 v[196:197], v[180:181], v[212:213], v[212:213] op_sel:[0,0,1] op_sel_hi:[1,0,1]
    v_pk_fma_f32 v[198:199], v[182:183], v[212:213], v[212:213] op_sel:[0,0,1] op_sel_hi:[1,0,1]
    v_pk_fma_f32 v[200:201], v[184:185], v[212:213], v[212:213] op_sel:[0,0,1] op_sel_hi:[1,0,1]
    v_cvt_pk_bf16_f32 v170, v194, v195
    v_cvt_pk_bf16_f32 v171, v196, v197
    v_cvt_pk_bf16_f32 v172, v198, v199
    v_cvt_pk_bf16_f32 v173, v200, v201
    ds_write_b128 v218, v[170:173] offset:0
    v_pk_fma_f32 v[202:203], v[186:187], v[212:213], v[212:213] op_sel:[0,0,1] op_sel_hi:[1,0,1]
    v_pk_fma_f32 v[204:205], v[188:189], v[212:213], v[212:213] op_sel:[0,0,1] op_sel_hi:[1,0,1]
    v_pk_fma_f32 v[206:207], v[190:191], v[212:213], v[212:213] op_sel:[0,0,1] op_sel_hi:[1,0,1]
    v_pk_fma_f32 v[208:209], v[192:193], v[212:213], v[212:213] op_sel:[0,0,1] op_sel_hi:[1,0,1]
    v_cvt_pk_bf16_f32 v174, v202, v203
    v_cvt_pk_bf16_f32 v175, v204, v205
    v_cvt_pk_bf16_f32 v176, v206, v207
    v_cvt_pk_bf16_f32 v177, v208, v209
    ds_write_b128 v218, v[174:177] offset:448
    s_waitcnt lgkmcnt(0)
    s_barrier
    ds_read_b64_tr_b16 v[98:99], v219 offset:0
    ds_read_b64_tr_b16 v[100:101], v219 offset:3840
    ds_read_b64_tr_b16 v[102:103], v219 offset:128
    ds_read_b64_tr_b16 v[104:105], v219 offset:3968
    ds_read_b32 v217, v225
    s_waitcnt lgkmcnt(3)
    buffer_store_dwordx4 v[98:101], v221, s[28:31], s70 offen sc1
    s_waitcnt lgkmcnt(1)
    buffer_store_dwordx4 v[102:105], v221, s[28:31], s71 offen sc1
    s_waitcnt lgkmcnt(0)
    buffer_store_dword v217, v226, s[28:31], s72 offen sc1
    s_mov_b32 s42, 4096
    s_mov_b32 s43, 0x20000
    s_lshl_b32 s3, s53, 2
    s_add_u32 s3, s3, s48
    s_lshl_b32 s7, s3, 5
    v_lshl_add_u32 v68, v5, 1, s7
    s_mul_i32 s3, s3, 14336
    s_lshl_b32 s6, s54, 7
    s_add_u32 s3, s3, s6
    v_mul_u32_u24 v15, 896, v5
    v_lshl_add_u32 v15, v6, 4, v15
    v_add_u32 v71, s3, v15
    v_add_u32 v72, 7168, v71
    s_add_u32 m0, s58, 16384
    s_add_u32 s0, s0, 458752
    s_cmp_eq_u32 s0, 7340032
    s_cselect_b32 s0, 0, s0
    buffer_load_dwordx4 v41, s[20:23], s0 offen lds
    buffer_load_dwordx4 v42, s[20:23], s0 offen offset:1024 lds
    buffer_load_dwordx4 v43, s[20:23], s0 offen offset:2048 lds
    buffer_load_dwordx4 v44, s[20:23], s0 offen offset:3072 lds
    s_mov_b32 s18, 401408
    s_mov_b32 s19, 0x20000
    s_mov_b32 s26, 7340032
    s_mov_b32 s27, 0x20000
    s_mov_b32 s34, 1835008
    s_mov_b32 s35, 0x20000
    v_and_b32 v2, 15, v1
    v_lshl_add_u32 v15, v9, 2, v7
    v_lshlrev_b32 v15, 7, v15
    v_lshl_add_u32 v15, v8, 3, v15
    v_and_b32 v16, 2, v7
    v_and_b32 v14, 1, v3
    v_add_u32 v16, v16, v14
    v_lshl_add_u32 v15, v16, 5, v15
    s_mul_i32 s3, s4, 8256
    v_xor_b32 v24, s3, v15
    v_xor_b32 v25, 64, v24
    v_add_u32 v26, 65536, v24
    v_add_u32 v27, 65536, v25
    v_add_u32 v28, 131072, v24
    v_add_u32 v29, 131072, v25
    s_lshl_b32 s6, s52, 1
    s_add_u32 s6, s6, s5
    s_lshl_b32 s3, s6, 5
    s_add_u32 s3, s3, s4
    s_lshl_b32 s3, s3, 12
    v_add_u32 v64, s3, v4
    v_lshrrev_b32 v15, 2, v1
    v_lshl_add_u32 v15, v15, 9, s83
    v_bfe_u32 v16, v1, 1, 1
    v_lshl_add_u32 v15, v16, 7, v15
    v_and_b32 v16, 1, v1
    v_lshl_add_u32 v20, v16, 3, v15
    s_mul_i32 s67, s6, 56
    s_lshl_b32 s3, s51, 1
    s_add_u32 s3, s3, s4
    s_add_u32 s67, s67, s3
    s_lshl_b32 s67, s67, 11
    s_add_u32 s67, s67, 2097152
    v_add_u32 v67, s58, v4
    s_lshl_b32 s68, s52, 5
    s_add_u32 s68, s68, s51
    s_lshl_b32 s68, s68, 7
    s_add_u32 s68, s68, 10551296
    s_waitcnt vmcnt(7)
    v_readfirstlane_b32 s57, v12
    s_mov_b32 s60, 0
    s_cmp_lg_u32 s57, 0
    s_cbranch_scc1 L_nonce_ok
L_nonce:
    buffer_load_dword v12, v17, s[44:47], 0 offen sc1
    s_add_u32 s60, s60, 1
    s_waitcnt vmcnt(0)
    v_readfirstlane_b32 s57, v12
    s_cmp_ge_u32 s60, 20000
    s_cbranch_scc1 L_nonce_ok
    s_cmp_eq_u32 s57, 0
    s_cbranch_scc1 L_nonce
L_nonce_ok:
    s_waitcnt vmcnt(4)
    s_barrier
    buffer_store_dword v12, v224, s[28:31], s74 offen sc1
    buffer_load_dwordx4 v[84:87], v71, s[8:11], 0 offen
    buffer_load_ushort v81, v68, s[40:43], 0 offen offset:0
    buffer_load_dwordx4 v[88:91], v72, s[8:11], 0 offen
    buffer_load_ushort v82, v68, s[40:43], 0 offen offset:16
    v_add_u32 v39, 65536, v4
    s_add_u32 m0, s58, 32768
    s_add_u32 s0, s0, 458752
    s_cmp_eq_u32 s0, 7340032
    s_cselect_b32 s0, 0, s0
    buffer_load_dwordx4 v41, s[20:23], s0 offen lds
    v_add_u32 v40, 131072, v4
    s_mul_i32 s59, s48, 3072
    s_mul_i32 s3, s50, 86016
    s_add_u32 s3, s3, s59
    s_add_u32 s3, s3, 8388608
    v_add_u32 v66, s3, v4
    v_lshlrev_b32 v15, 7, v9
    v_xor_b32 v15, v15, v4
    s_lshl_b32 s3, s49, 11
    v_add_u32 v53, s3, v15
    v_add_u32 v54, 129024, v53
    s_lshr_b32 s3, s49, 2
    s_lshl_b32 s3, s3, 3
    s_max_u32 s3, s3, 1
    s_sub_u32 s3, s3, 1
    s_lshl_b32 s3, s3, 10
    s_lshl_b32 s6, s5, 17
    s_add_u32 s3, s3, s6
    s_lshl_b32 s6, s4, 28
    s_add_u32 s3, s3, s6
    v_add_u32 v55, s3, v15
    buffer_load_dwordx4 v42, s[20:23], s0 offen offset:1024 lds
    s_lshl_b32 s100, s5, 1
    s_add_u32 s100, s100, s4
    s_lshl_b32 s100, s100, 10
    v_and_b32 v15, 1, v1
    v_mul_u32_u24 v15, 640, v15
    v_lshrrev_b32 v16, 2, v1
    v_lshlrev_b32 v16, 4, v16
    v_xor_b32 v15, v15, v16
    v_bfe_u32 v16, v1, 1, 1
    v_lshl_add_u32 v15, v16, 3, v15
    buffer_load_dwordx4 v43, s[20:23], s0 offen offset:2048 lds
    s_add_u32 s3, s58, 12288
    v_add_u32 v56, s3, v15
    s_sub_u32 s3, s3, 3072
    s_cmp_eq_u32 s48, 0
    s_cselect_b32 s3, 28672, s3
    v_add_u32 v57, s3, v15
    v_add_u32 v58, 65536, v56
    v_add_u32 v59, 65536, v57
    v_add_u32 v60, 131072, v56
    v_add_u32 v61, 131072, v57
    s_lshl_b32 s3, s49, 1
    v_min_u32 v15, 2, v3
    v_add_u32 v15, s3, v15
    v_max_u32 v15, 1, v15
    v_lshlrev_b32 v15, 1, v15
    v_and_b32 v16, 1, v7
    buffer_load_dwordx4 v44, s[20:23], s0 offen offset:3072 lds
    v_add_lshl_u32 v15, v15, v16, 7
    v_lshrrev_b32 v16, 1, v7
    v_lshl_add_u32 v16, v16, 2, v8
    v_lshl_add_u32 v15, v16, 2, v15
    v_add_u32 v63, 6291200, v15
    v_min_u32 v15, 2, v8
    v_lshlrev_b32 v15, 2, v15
    v_add_u32 v15, 10747904, v15
    v_lshrrev_b32 v16, 2, v1
    v_min_u32 v16, 13, v16
    v_lshl_add_u32 v21, v16, 7, v15
    s_lshl_b32 s82, s49, 5
    s_add_u32 s82, s82, s50
    s_lshl_b32 s82, s82, 10
    s_add_u32 s82, s82, 4194304
    s_lshr_b32 s69, s49, 2
    s_lshl_b32 s69, s69, 4
    s_add_u32 s69, s69, s50
    s_lshl_b32 s69, s69, 7
    s_add_u32 s69, s69, 10616832
    s_lshl_b32 s3, s48, 17
    s_lshl_b32 s6, s53, 7
    s_add_u32 s3, s3, s6
    v_lshlrev_b32 v15, 12, v5
    s_add_u32 m0, s58, 49152
    s_add_u32 s0, s0, 458752
    s_cmp_eq_u32 s0, 7340032
    s_cselect_b32 s0, 0, s0
    buffer_load_dwordx4 v41, s[20:23], s0 offen lds
    v_add3_u32 v45, v15, v69, s3
    v_add_u32 v46, 31744, v45
    v_add_u32 v47, 63488, v45
    v_add_u32 v48, 95232, v45
    v_mul_u32_u24 v15, 896, v5
    s_mul_i32 s3, s4, 25088
    s_mul_i32 s6, s5, 14336
    s_add_u32 s3, s3, s6
    s_lshl_b32 s6, s54, 7
    s_add_u32 s3, s3, s6
    v_add3_u32 v49, v15, v69, s3
    buffer_load_dwordx4 v42, s[20:23], s0 offen offset:1024 lds
    v_add_u32 v50, 6144, v49
    s_lshl_b32 s6, s53, 1
    s_add_u32 s6, s6, s5
    s_lshr_b32 s3, s53, 1
    s_lshl_b32 s3, s3, 4
    s_add_u32 s3, s3, s4
    s_lshl_b32 s3, s3, 7
    s_add_u32 s3, s3, 10616832
    v_lshl_add_u32 v23, v5, 8, s3
    s_lshl_b32 s3, s6, 5
    s_add_u32 s3, s3, s4
    s_lshl_b32 s3, s3, 10
    s_add_u32 s3, s3, 4192256
    v_add_u32 v51, s3, v4
    buffer_load_dwordx4 v43, s[20:23], s0 offen offset:2048 lds
    v_add_u32 v52, 15360, v51
    s_xor_b32 s3, s4, s5
    s_lshl_b32 s3, s3, 6
    v_xor_b32 v30, s3, v24
    v_add_u32 v31, 65536, v30
    v_add_u32 v32, 131072, v30
    v_lshlrev_b32 v14, 10, v14
    v_lshl_add_u32 v14, v9, 8, v14
    v_lshl_add_u32 v14, v2, 4, v14
    s_mul_i32 s3, s4, 12288
    s_add_u32 s3, s3, 2048
    v_add_u32 v33, s3, v14
    v_xor_b32 v34, 4096, v33
    v_add_u32 v35, 65536, v33
    v_add_u32 v36, 65536, v34
    v_add_u32 v37, 131072, v33
    buffer_load_dwordx4 v44, s[20:23], s0 offen offset:3072 lds
    v_add_u32 v38, 131072, v34
    s_lshl_b32 s6, s54, 1
    s_add_u32 s6, s6, s5
    s_mul_i32 s3, s6, 28
    s_add_u32 s3, s3, s4
    s_lshl_b32 s3, s3, 12
    s_add_u32 s3, s3, 2097152
    v_add_u32 v65, s3, v4
    s_lshl_b32 s3, s54, 5
    s_add_u32 s3, s3, s4
    s_lshl_b32 s3, s3, 7
    s_add_u32 s3, s3, 10551296
    v_lshrrev_b32 v15, 2, v1
    v_min_u32 v15, 13, v15
    v_lshl_add_u32 v22, v15, 8, s3
    s_and_b32 s3, s2, 7
    s_mul_i32 s3, s3, 7
    s_lshr_b32 s3, s3, 2
    s_mul_i32 s6, s54, 2
    s_add_u32 s3, s3, s6
    s_mul_i32 s6, s3, 37
    s_lshr_b32 s6, s6, 9
    s_mul_i32 s6, s6, 14
    s_sub_u32 s3, s3, s6
    s_lshl_b32 s64, s3, 19
    s_lshl_b32 s65, s3, 13
    s_lshl_b32 s3, s5, 3
    v_add_u32 v14, s3, v9
    v_xor_b32 v14, v14, v6
    v_lshlrev_b32 v14, 4, v14
    v_lshl_add_u32 v14, v10, 8, v14
    s_lshl_b32 s3, s4, 14
    s_add_u32 s3, s3, 32768
    v_add_u32 v73, s3, v14
    v_xor_b32 v74, 32, v73
    v_xor_b32 v75, 64, v73
    v_xor_b32 v76, 96, v73
    s_mul_i32 s3, s53, 2
    s_mul_i32 s6, s54, 1
    s_add_u32 s3, s3, s6
    s_add_u32 s66, s3, 7
    v_lshlrev_b32 v14, 1, v6
    v_xor_b32 v14, v14, v5
    v_lshlrev_b32 v14, 4, v14
    v_lshl_add_u32 v14, v5, 8, v14
    s_add_u32 s3, s58, 32768
    v_add_u32 v77, s3, v14
    v_xor_b32 v78, 16, v77
    v_xor_b32 v79, 24576, v77
    v_xor_b32 v80, 24592, v77
    v_lshlrev_b32 v138, 16, v234
    v_and_b32 v139, 0xffff0000, v234
    v_lshlrev_b32 v140, 16, v235
    v_and_b32 v141, 0xffff0000, v235
    v_lshlrev_b32 v142, 16, v236
    v_and_b32 v143, 0xffff0000, v236
    v_lshlrev_b32 v144, 16, v237
    v_and_b32 v145, 0xffff0000, v237
    v_lshlrev_b32 v146, 16, v238
    v_and_b32 v147, 0xffff0000, v238
    v_lshlrev_b32 v148, 16, v239
    v_and_b32 v149, 0xffff0000, v239
    v_lshlrev_b32 v150, 16, v240
    v_and_b32 v151, 0xffff0000, v240
    v_lshlrev_b32 v152, 16, v241
    v_and_b32 v153, 0xffff0000, v241
    s_mov_b32 s60, 0
    s_mov_b32 s70, s57
    s_mov_b32 s71, s57
    s_add_u32 s80, s28, 128
    s_addc_u32 s81, s29, 0
    s_lshr_b32 s3, s1, 4
    s_add_u32 s3, s3, 0
    s_and_b32 s3, s3, 0x1fff
    s_add_u32 s76, s3, s83
    s_lshr_b32 s3, s1, 4
    s_add_u32 s3, s3, 512
    s_and_b32 s3, s3, 0x1fff
    s_add_u32 s77, s3, s83
    s_lshr_b32 s3, s1, 4
    s_add_u32 s3, s3, 1024
    s_and_b32 s3, s3, 0x1fff
    s_add_u32 s78, s3, s83
    s_load_dwordx4 s[8:11], s[28:29], s76 glc
    s_load_dwordx4 s[36:39], s[80:81], s76 glc
    s_load_dwordx4 s[40:43], s[28:29], s77 glc
    s_load_dwordx4 s[44:47], s[80:81], s77 glc
    s_load_dwordx4 s[12:15], s[28:29], s78 glc
    s_load_dwordx4 s[72:75], s[80:81], s78 glc
    s_add_u32 m0, s58, 65536
    s_add_u32 s0, s0, 458752
    s_cmp_eq_u32 s0, 7340032
    s_cselect_b32 s0, 0, s0
    buffer_load_dwordx4 v41, s[20:23], s0 offen lds
    buffer_load_dwordx4 v42, s[20:23], s0 offen offset:1024 lds
    buffer_load_dwordx4 v43, s[20:23], s0 offen offset:2048 lds
    buffer_load_dwordx4 v44, s[20:23], s0 offen offset:3072 lds
    s_add_u32 m0, s58, 81920
    s_add_u32 s0, s0, 458752
    s_cmp_eq_u32 s0, 7340032
    s_cselect_b32 s0, 0, s0
    buffer_load_dwordx4 v41, s[20:23], s0 offen lds
    buffer_load_dwordx4 v42, s[20:23], s0 offen offset:1024 lds
    buffer_load_dwordx4 v43, s[20:23], s0 offen offset:2048 lds
    buffer_load_dwordx4 v44, s[20:23], s0 offen offset:3072 lds
    s_add_u32 m0, s58, 98304
    s_add_u32 s0, s0, 458752
    s_cmp_eq_u32 s0, 7340032
    s_cselect_b32 s0, 0, s0
    buffer_load_dwordx4 v41, s[20:23], s0 offen lds
    buffer_load_dwordx4 v42, s[20:23], s0 offen offset:1024 lds
    buffer_load_dwordx4 v43, s[20:23], s0 offen offset:2048 lds
    buffer_load_dwordx4 v44, s[20:23], s0 offen offset:3072 lds
    s_branch L_hchk
L_hretry:
    s_add_u32 s60, s60, 1
    s_cmp_ge_u32 s60, 20000
    s_cbranch_scc1 L_hok
    s_sleep 4
    s_load_dwordx4 s[8:11], s[28:29], s76 glc
    s_load_dwordx4 s[36:39], s[80:81], s76 glc
    s_load_dwordx4 s[40:43], s[28:29], s77 glc
    s_load_dwordx4 s[44:47], s[80:81], s77 glc
    s_load_dwordx4 s[12:15], s[28:29], s78 glc
    s_load_dwordx4 s[72:75], s[80:81], s78 glc
L_hchk:
    s_waitcnt lgkmcnt(0)
    s_cmp_lg_u64 s[8:9], s[70:71]
    s_cbranch_scc1 L_hretry
    s_cmp_lg_u64 s[10:11], s[70:71]
    s_cbranch_scc1 L_hretry
    s_cmp_lg_u64 s[36:37], s[70:71]
    s_cbranch_scc1 L_hretry
    s_cmp_lg_u64 s[38:39], s[70:71]
    s_cbranch_scc1 L_hretry
    s_cmp_lg_u64 s[40:41], s[70:71]
    s_cbranch_scc1 L_hretry
    s_cmp_lg_u64 s[42:43], s[70:71]
    s_cbranch_scc1 L_hretry
    s_cmp_lg_u64 s[44:45], s[70:71]
    s_cbranch_scc1 L_hretry
    s_cmp_lg_u64 s[46:47], s[70:71]
    s_cbranch_scc1 L_hretry
    s_cmp_lg_u64 s[12:13], s[70:71]
    s_cbranch_scc1 L_hretry
    s_cmp_lg_u64 s[14:15], s[70:71]
    s_cbranch_scc1 L_hretry
    s_cmp_lg_u64 s[72:73], s[70:71]
    s_cbranch_scc1 L_hretry
    s_cmp_lg_u64 s[74:75], s[70:71]
    s_cbranch_scc1 L_hretry
L_hok:
    buffer_load_dwordx4 a[0:3], v64, s[28:31], s1 offen offset:0 sc1
    buffer_load_dwordx4 a[4:7], v64, s[28:31], s1 offen offset:1024 sc1
    buffer_load_dwordx4 a[8:11], v64, s[28:31], s1 offen offset:2048 sc1
    buffer_load_dwordx4 a[12:15], v64, s[28:31], s1 offen offset:3072 sc1
    buffer_load_dwordx2 v[18:19], v20, s[28:31], 0 offen sc1
    s_add_u32 s1, s1, 8192
    s_and_b32 s1, s1, 0x1ffff
    buffer_load_dwordx4 a[16:19], v64, s[28:31], s1 offen offset:0 sc1
    buffer_load_dwordx4 a[20:23], v64, s[28:31], s1 offen offset:1024 sc1
    buffer_load_dwordx4 a[24:27], v64, s[28:31], s1 offen offset:2048 sc1
    buffer_load_dwordx4 a[28:31], v64, s[28:31], s1 offen offset:3072 sc1
    s_add_u32 s1, s1, 8192
    s_and_b32 s1, s1, 0x1ffff
    buffer_load_dwordx4 a[32:35], v64, s[28:31], s1 offen offset:0 sc1
    buffer_load_dwordx4 a[36:39], v64, s[28:31], s1 offen offset:1024 sc1
    buffer_load_dwordx4 a[40:43], v64, s[28:31], s1 offen offset:2048 sc1
    buffer_load_dwordx4 a[44:47], v64, s[28:31], s1 offen offset:3072 sc1
    s_waitcnt vmcnt(8)
    v_xor_b32 v18, s57, v18
    v_xor_b32 v19, s57, v19
    v_or_b32 v18, v18, v19
    v_cmp_ne_u32 vcc, 0, v18
    s_cbranch_vccz L_pollok0
    s_mov_b32 s60, 0
L_poll0:
    s_sleep 4
    buffer_load_dwordx2 v[18:19], v20, s[28:31], 0 offen sc1
    s_add_u32 s60, s60, 1
    s_waitcnt vmcnt(0)
    v_xor_b32 v18, s57, v18
    v_xor_b32 v19, s57, v19
    v_or_b32 v18, v18, v19
    v_cmp_ne_u32 vcc, 0, v18
    s_cbranch_vccz L_pollok0
    s_cmp_lt_u32 s60, 20000
    s_cbranch_scc1 L_poll0
L_pollok0:
    s_barrier
    ds_read_b64_tr_b16 v[106:107], v24 offset:0
    s_add_u32 s1, s1, 8192
    s_and_b32 s1, s1, 0x1ffff
    buffer_load_dwordx4 a[48:51], v64, s[28:31], s1 offen offset:0 sc1
    ds_read_b64_tr_b16 v[108:109], v24 offset:1024
    ds_read_b64_tr_b16 v[110:111], v25 offset:0
    ds_read_b64_tr_b16 v[112:113], v25 offset:1024
    ds_read_b64_tr_b16 v[114:115], v24 offset:2048
    ds_read_b64_tr_b16 v[116:117], v24 offset:3072
    ds_read_b64_tr_b16 v[118:119], v25 offset:2048
    ds_read_b64_tr_b16 v[120:121], v25 offset:3072
    ds_read_b64_tr_b16 v[122:123], v24 offset:4096
    ds_read_b64_tr_b16 v[124:125], v24 offset:5120
    ds_read_b64_tr_b16 v[126:127], v25 offset:4096
    ds_read_b64_tr_b16 v[128:129], v25 offset:5120
    s_waitcnt lgkmcnt(8)
    v_mfma_f32_32x32x16_bf16 v[138:153], v[106:109], a[0:3], v[138:153]
    buffer_load_dwordx4 a[52:55], v64, s[28:31], s1 offen offset:1024 sc1
    ds_read_b64_tr_b16 v[130:131], v24 offset:6144
    ds_read_b64_tr_b16 v[132:133], v24 offset:7168
    s_mov_b32 s70, 0xaaaaaaaa
    v_mfma_f32_32x32x16_bf16 v[154:169], v[110:113], a[0:3], 0
    buffer_load_dwordx4 a[56:59], v64, s[28:31], s1 offen offset:2048 sc1
    ds_read_b64_tr_b16 v[134:135], v25 offset:6144
    ds_read_b64_tr_b16 v[136:137], v25 offset:7168
    s_mov_b32 s71, 0xaaaaaaaa
    s_waitcnt lgkmcnt(8)
    v_mfma_f32_32x32x16_bf16 v[138:153], v[114:117], a[4:7], v[138:153]
    buffer_load_dwordx4 a[60:63], v64, s[28:31], s1 offen offset:3072 sc1
    ds_read_b64_tr_b16 v[106:107], v24 offset:16384
    ds_read_b64_tr_b16 v[108:109], v24 offset:17408
    s_mov_b32 s72, 0xfff0ffff
    v_mfma_f32_32x32x16_bf16 v[154:169], v[118:121], a[4:7], v[154:169]
    s_add_u32 m0, s58, 114688
    s_add_u32 s0, s0, 458752
    s_cmp_eq_u32 s0, 7340032
    s_cselect_b32 s0, 0, s0
    buffer_load_dwordx4 v41, s[20:23], s0 offen lds
    ds_read_b64_tr_b16 v[110:111], v25 offset:16384
    ds_read_b64_tr_b16 v[112:113], v25 offset:17408
    s_mov_b32 s73, 0xf000ff00
    s_waitcnt lgkmcnt(8)
    v_mfma_f32_32x32x16_bf16 v[138:153], v[122:125], a[8:11], v[138:153]
    buffer_load_dwordx4 v42, s[20:23], s0 offen offset:1024 lds
    ds_read_b64_tr_b16 v[114:115], v24 offset:18432
    ds_read_b64_tr_b16 v[116:117], v24 offset:19456
    s_mov_b32 s74, 0xffc0fffc
    v_mfma_f32_32x32x16_bf16 v[154:169], v[126:129], a[8:11], v[154:169]
    buffer_load_dwordx4 v43, s[20:23], s0 offen offset:2048 lds
    ds_read_b64_tr_b16 v[118:119], v25 offset:18432
    ds_read_b64_tr_b16 v[120:121], v25 offset:19456
    s_mov_b32 s75, 0xc000fc00
    s_waitcnt lgkmcnt(8)
    v_mfma_f32_32x32x16_bf16 v[138:153], v[130:133], a[12:15], v[138:153]
    buffer_load_dwordx4 v44, s[20:23], s0 offen offset:3072 lds
    ds_read_b64_tr_b16 v[122:123], v24 offset:20480
    ds_read_b64_tr_b16 v[124:125], v24 offset:21504
    s_cmp_eq_u32 s49, 0
    s_cselect_b64 s[76:77], 0, -1
    v_mfma_f32_32x32x16_bf16 v[154:169], v[134:137], a[12:15], v[154:169]
    s_add_u32 s1, s1, 8192
    s_and_b32 s1, s1, 0x1ffff
    buffer_load_dwordx4 a[64:67], v64, s[28:31], s1 offen offset:0 sc1
    ds_read_b64_tr_b16 v[126:127], v25 offset:20480
    ds_read_b64_tr_b16 v[128:129], v25 offset:21504
    v_mov_b32 v14, 0xffff
    buffer_load_dwordx4 a[68:71], v64, s[28:31], s1 offen offset:1024 sc1
    s_waitcnt vmcnt(17) lgkmcnt(8)
    v_mfma_f32_32x32x16_bf16 v[138:153], v[106:109], a[16:19], v[138:153]
    buffer_load_dwordx4 a[72:75], v64, s[28:31], s1 offen offset:2048 sc1
    ds_read_b64_tr_b16 v[130:131], v24 offset:22528
    ds_read_b64_tr_b16 v[132:133], v24 offset:23552
    v_mov_b32 v15, 0xffff0000
    v_mfma_f32_32x32x16_bf16 v[154:169], v[110:113], a[16:19], v[154:169]
    buffer_load_dwordx4 a[76:79], v64, s[28:31], s1 offen offset:3072 sc1
    ds_read_b64_tr_b16 v[134:135], v25 offset:22528
    ds_read_b64_tr_b16 v[136:137], v25 offset:23552
    v_cndmask_b32 v14, v14, v15, s[70:71]
    s_waitcnt vmcnt(18) lgkmcnt(8)
    v_mfma_f32_32x32x16_bf16 v[138:153], v[114:117], a[20:23], v[138:153]
    s_add_u32 m0, s58, 131072
    s_add_u32 s0, s0, 458752
    s_cmp_eq_u32 s0, 7340032
    s_cselect_b32 s0, 0, s0
    buffer_load_dwordx4 v41, s[20:23], s0 offen lds
    ds_read_b64_tr_b16 v[106:107], v24 offset:32768
    ds_read_b64_tr_b16 v[108:109], v24 offset:33792
    v_cndmask_b32 v92, v14, 0, s[72:73]
    v_mfma_f32_32x32x16_bf16 v[154:169], v[118:121], a[20:23], v[154:169]
    buffer_load_dwordx4 v42, s[20:23], s0 offen offset:1024 lds
    ds_read_b64_tr_b16 v[110:111], v25 offset:32768
    ds_read_b64_tr_b16 v[112:113], v25 offset:33792
    v_cndmask_b32 v94, 0, v14, s[72:73]
    s_waitcnt vmcnt(19) lgkmcnt(8)
    v_mfma_f32_32x32x16_bf16 v[138:153], v[122:125], a[24:27], v[138:153]
    buffer_load_dwordx4 v43, s[20:23], s0 offen offset:2048 lds
    ds_read_b64_tr_b16 v[114:115], v24 offset:34816
    ds_read_b64_tr_b16 v[116:117], v24 offset:35840
    v_cndmask_b32 v93, v14, 0, s[74:75]
    v_mfma_f32_32x32x16_bf16 v[154:169], v[126:129], a[24:27], v[154:169]
    buffer_load_dwordx4 v44, s[20:23], s0 offen offset:3072 lds
    ds_read_b64_tr_b16 v[118:119], v25 offset:34816
    ds_read_b64_tr_b16 v[120:121], v25 offset:35840
    v_cndmask_b32 v95, 0, v14, s[74:75]
    s_waitcnt vmcnt(20) lgkmcnt(8)
    v_mfma_f32_32x32x16_bf16 v[138:153], v[130:133], a[28:31], v[138:153]
    s_add_u32 s1, s1, 8192
    s_and_b32 s1, s1, 0x1ffff
    buffer_load_dwordx4 a[80:83], v64, s[28:31], s1 offen offset:0 sc1
    ds_read_b64_tr_b16 v[122:123], v24 offset:36864
    ds_read_b64_tr_b16 v[124:125], v24 offset:37888
    v_mov_b32 v70, 0xf149f2ca
    v_mfma_f32_32x32x16_bf16 v[154:169], v[134:137], a[28:31], v[154:169]
    buffer_load_dwordx4 a[84:87], v64, s[28:31], s1 offen offset:1024 sc1
    ds_read_b64_tr_b16 v[126:127], v25 offset:36864
    ds_read_b64_tr_b16 v[128:129], v25 offset:37888
    s_mov_b32 s83, 0x3e8b97f6
    s_waitcnt vmcnt(21) lgkmcnt(8)
    v_mfma_f32_32x32x16_bf16 v[138:153], v[106:109], a[32:35], v[138:153]
    buffer_load_dwordx4 a[88:91], v64, s[28:31], s1 offen offset:2048 sc1
    ds_read_b64_tr_b16 v[130:131], v24 offset:38912
    ds_read_b64_tr_b16 v[132:133], v24 offset:39936
    s_mov_b32 s78, 0xbdd2d3e8
    s_mov_b32 s79, 0xbdd2d3e8
    v_mfma_f32_32x32x16_bf16 v[154:169], v[110:113], a[32:35], v[154:169]
    buffer_load_dwordx4 a[92:95], v64, s[28:31], s1 offen offset:3072 sc1
    ds_read_b64_tr_b16 v[134:135], v25 offset:38912
    ds_read_b64_tr_b16 v[136:137], v25 offset:39936
    s_mov_b32 s80, 1.0
    s_mov_b32 s81, 1.0
    s_waitcnt vmcnt(22) lgkmcnt(8)
    v_mfma_f32_32x32x16_bf16 v[138:153], v[114:117], a[36:39], v[138:153]
    s_add_u32 m0, s58, 147456
    s_add_u32 s0, s0, 458752
    s_cmp_eq_u32 s0, 7340032
    s_cselect_b32 s0, 0, s0
    buffer_load_dwordx4 v41, s[20:23], s0 offen lds
    ds_read_b64_tr_b16 v[106:107], v24 offset:49152
    ds_read_b64_tr_b16 v[108:109], v24 offset:50176
    v_mov_b32 v96, 0xc0135761
    buffer_load_dwordx4 v42, s[20:23], s0 offen offset:1024 lds
    v_mfma_f32_32x32x16_bf16 v[154:169], v[118:121], a[36:39], v[154:169]
    buffer_load_dwordx4 v43, s[20:23], s0 offen offset:2048 lds
    ds_read_b64_tr_b16 v[110:111], v25 offset:49152
    ds_read_b64_tr_b16 v[112:113], v25 offset:50176
    v_mov_b32 v97, 0xc0135761
    s_waitcnt vmcnt(24) lgkmcnt(8)
    v_mfma_f32_32x32x16_bf16 v[138:153], v[122:125], a[40:43], v[138:153]
    buffer_load_dwordx4 v44, s[20:23], s0 offen offset:3072 lds
    ds_read_b64_tr_b16 v[114:115], v24 offset:51200
    ds_read_b64_tr_b16 v[116:117], v24 offset:52224
    v_mfma_f32_32x32x16_bf16 v[154:169], v[126:129], a[40:43], v[154:169]
    s_add_u32 s1, s1, 8192
    s_and_b32 s1, s1, 0x1ffff
    buffer_load_dwordx4 a[96:99], v64, s[28:31], s1 offen offset:0 sc1
    ds_read_b64_tr_b16 v[118:119], v25 offset:51200
    ds_read_b64_tr_b16 v[120:121], v25 offset:52224
    s_waitcnt vmcnt(25) lgkmcnt(8)
    v_mfma_f32_32x32x16_bf16 v[138:153], v[130:133], a[44:47], v[138:153]
    ds_read_b64_tr_b16 v[122:123], v24 offset:53248
    ds_read_b64_tr_b16 v[124:125], v24 offset:54272
    v_mfma_f32_32x32x16_bf16 v[154:169], v[134:137], a[44:47], v[154:169]
    buffer_load_dwordx4 a[100:103], v64, s[28:31], s1 offen offset:1024 sc1
    ds_read_b64_tr_b16 v[126:127], v25 offset:53248
    ds_read_b64_tr_b16 v[128:129], v25 offset:54272
    s_waitcnt vmcnt(25) lgkmcnt(8)
    v_mfma_f32_32x32x16_bf16 v[138:153], v[106:109], a[48:51], v[138:153]
    ds_read_b64_tr_b16 v[130:131], v24 offset:55296
    ds_read_b64_tr_b16 v[132:133], v24 offset:56320
    v_mfma_f32_32x32x16_bf16 v[154:169], v[110:113], a[48:51], v[154:169]
    buffer_load_dwordx4 a[104:107], v64, s[28:31], s1 offen offset:2048 sc1
    ds_read_b64_tr_b16 v[134:135], v25 offset:55296
    ds_read_b64_tr_b16 v[136:137], v25 offset:56320
    s_waitcnt vmcnt(25) lgkmcnt(8)
    v_mfma_f32_32x32x16_bf16 v[138:153], v[114:117], a[52:55], v[138:153]
    s_barrier
    ds_read_b64_tr_b16 v[106:107], v26 offset:0
    ds_read_b64_tr_b16 v[108:109], v26 offset:1024
    v_mfma_f32_32x32x16_bf16 v[154:169], v[118:121], a[52:55], v[154:169]
    buffer_load_dwordx4 a[108:111], v64, s[28:31], s1 offen offset:3072 sc1
    ds_read_b64_tr_b16 v[110:111], v27 offset:0
    ds_read_b64_tr_b16 v[112:113], v27 offset:1024
    s_waitcnt vmcnt(25) lgkmcnt(8)
    v_mfma_f32_32x32x16_bf16 v[138:153], v[122:125], a[56:59], v[138:153]
    ds_read_b64_tr_b16 v[114:115], v26 offset:2048
    ds_read_b64_tr_b16 v[116:117], v26 offset:3072
    v_mfma_f32_32x32x16_bf16 v[154:169], v[126:129], a[56:59], v[154:169]
    s_add_u32 s1, s1, 8192
    s_and_b32 s1, s1, 0x1ffff
    buffer_load_dwordx4 a[112:115], v64, s[28:31], s1 offen offset:0 sc1
    ds_read_b64_tr_b16 v[118:119], v27 offset:2048
    ds_read_b64_tr_b16 v[120:121], v27 offset:3072
    s_waitcnt vmcnt(25) lgkmcnt(8)
    v_mfma_f32_32x32x16_bf16 v[138:153], v[130:133], a[60:63], v[138:153]
    buffer_load_dwordx4 a[116:119], v64, s[28:31], s1 offen offset:1024 sc1
    ds_read_b64_tr_b16 v[122:123], v26 offset:4096
    ds_read_b64_tr_b16 v[124:125], v26 offset:5120
    v_mfma_f32_32x32x16_bf16 v[154:169], v[134:137], a[60:63], v[154:169]
    buffer_load_dwordx4 a[120:123], v64, s[28:31], s1 offen offset:2048 sc1
    ds_read_b64_tr_b16 v[126:127], v27 offset:4096
    ds_read_b64_tr_b16 v[128:129], v27 offset:5120
    s_waitcnt vmcnt(22) lgkmcnt(8)
    v_mfma_f32_32x32x16_bf16 v[138:153], v[106:109], a[64:67], v[138:153]
    buffer_load_dwordx4 a[124:127], v64, s[28:31], s1 offen offset:3072 sc1
    ds_read_b64_tr_b16 v[130:131], v26 offset:6144
    ds_read_b64_tr_b16 v[132:133], v26 offset:7168
    v_mfma_f32_32x32x16_bf16 v[154:169], v[110:113], a[64:67], v[154:169]
    s_add_u32 m0, s58, 0
    s_add_u32 s0, s0, 458752
    s_cmp_eq_u32 s0, 7340032
    s_cselect_b32 s0, 0, s0
    buffer_load_dwordx4 v41, s[20:23], s0 offen lds
    ds_read_b64_tr_b16 v[134:135], v27 offset:6144
    ds_read_b64_tr_b16 v[136:137], v27 offset:7168
    s_waitcnt vmcnt(23) lgkmcnt(8)
    v_mfma_f32_32x32x16_bf16 v[138:153], v[114:117], a[68:71], v[138:153]
    buffer_load_dwordx4 v42, s[20:23], s0 offen offset:1024 lds
    ds_read_b64_tr_b16 v[106:107], v26 offset:16384
    ds_read_b64_tr_b16 v[108:109], v26 offset:17408
    v_mfma_f32_32x32x16_bf16 v[154:169], v[118:121], a[68:71], v[154:169]
    buffer_load_dwordx4 v43, s[20:23], s0 offen offset:2048 lds
    ds_read_b64_tr_b16 v[110:111], v27 offset:16384
    ds_read_b64_tr_b16 v[112:113], v27 offset:17408
    s_waitcnt vmcnt(24) lgkmcnt(8)
    v_mfma_f32_32x32x16_bf16 v[138:153], v[122:125], a[72:75], v[138:153]
    buffer_load_dwordx4 v44, s[20:23], s0 offen offset:3072 lds
    ds_read_b64_tr_b16 v[114:115], v26 offset:18432
    ds_read_b64_tr_b16 v[116:117], v26 offset:19456
    v_mfma_f32_32x32x16_bf16 v[154:169], v[126:129], a[72:75], v[154:169]
    s_add_u32 s1, s1, 8192
    s_and_b32 s1, s1, 0x1ffff
    buffer_load_dwordx4 a[128:131], v64, s[28:31], s1 offen offset:0 sc1
    ds_read_b64_tr_b16 v[118:119], v27 offset:18432
    ds_read_b64_tr_b16 v[120:121], v27 offset:19456
    s_waitcnt vmcnt(25) lgkmcnt(8)
    v_mfma_f32_32x32x16_bf16 v[138:153], v[130:133], a[76:79], v[138:153]
    buffer_load_dwordx4 a[132:135], v64, s[28:31], s1 offen offset:1024 sc1
    ds_read_b64_tr_b16 v[122:123], v26 offset:20480
    ds_read_b64_tr_b16 v[124:125], v26 offset:21504
    v_mfma_f32_32x32x16_bf16 v[154:169], v[134:137], a[76:79], v[154:169]
    buffer_load_dwordx4 a[136:139], v64, s[28:31], s1 offen offset:2048 sc1
    ds_read_b64_tr_b16 v[126:127], v27 offset:20480
    ds_read_b64_tr_b16 v[128:129], v27 offset:21504
    s_waitcnt vmcnt(22) lgkmcnt(8)
    v_mfma_f32_32x32x16_bf16 v[138:153], v[106:109], a[80:83], v[138:153]
    buffer_load_dwordx4 a[140:143], v64, s[28:31], s1 offen offset:3072 sc1
    ds_read_b64_tr_b16 v[130:131], v26 offset:22528
    ds_read_b64_tr_b16 v[132:133], v26 offset:23552
    v_mfma_f32_32x32x16_bf16 v[154:169], v[110:113], a[80:83], v[154:169]
    s_add_u32 m0, s58, 16384
    s_add_u32 s0, s0, 458752
    s_cmp_eq_u32 s0, 7340032
    s_cselect_b32 s0, 0, s0
    buffer_load_dwordx4 v41, s[20:23], s0 offen lds
    ds_read_b64_tr_b16 v[134:135], v27 offset:22528
    ds_read_b64_tr_b16 v[136:137], v27 offset:23552
    s_waitcnt vmcnt(23) lgkmcnt(8)
    v_mfma_f32_32x32x16_bf16 v[138:153], v[114:117], a[84:87], v[138:153]
    buffer_load_dwordx4 v42, s[20:23], s0 offen offset:1024 lds
    ds_read_b64_tr_b16 v[106:107], v26 offset:32768
    ds_read_b64_tr_b16 v[108:109], v26 offset:33792
    v_mfma_f32_32x32x16_bf16 v[154:169], v[118:121], a[84:87], v[154:169]
    buffer_load_dwordx4 v43, s[20:23], s0 offen offset:2048 lds
    ds_read_b64_tr_b16 v[110:111], v27 offset:32768
    ds_read_b64_tr_b16 v[112:113], v27 offset:33792
    s_waitcnt vmcnt(24) lgkmcnt(8)
    v_mfma_f32_32x32x16_bf16 v[138:153], v[122:125], a[88:91], v[138:153]
    buffer_load_dwordx4 v44, s[20:23], s0 offen offset:3072 lds
    ds_read_b64_tr_b16 v[114:115], v26 offset:34816
    ds_read_b64_tr_b16 v[116:117], v26 offset:35840
    v_mfma_f32_32x32x16_bf16 v[154:169], v[126:129], a[88:91], v[154:169]
    s_add_u32 s1, s1, 8192
    s_and_b32 s1, s1, 0x1ffff
    buffer_load_dwordx4 a[144:147], v64, s[28:31], s1 offen offset:0 sc1
    ds_read_b64_tr_b16 v[118:119], v27 offset:34816
    ds_read_b64_tr_b16 v[120:121], v27 offset:35840
    s_waitcnt vmcnt(25) lgkmcnt(8)
    v_mfma_f32_32x32x16_bf16 v[138:153], v[130:133], a[92:95], v[138:153]
    buffer_load_dwordx4 a[148:151], v64, s[28:31], s1 offen offset:1024 sc1
    ds_read_b64_tr_b16 v[122:123], v26 offset:36864
    ds_read_b64_tr_b16 v[124:125], v26 offset:37888
    v_mfma_f32_32x32x16_bf16 v[154:169], v[134:137], a[92:95], v[154:169]
    buffer_load_dwordx4 a[152:155], v64, s[28:31], s1 offen offset:2048 sc1
    ds_read_b64_tr_b16 v[126:127], v27 offset:36864
    ds_read_b64_tr_b16 v[128:129], v27 offset:37888
    s_waitcnt vmcnt(22) lgkmcnt(8)
    v_mfma_f32_32x32x16_bf16 v[138:153], v[106:109], a[96:99], v[138:153]
    buffer_load_dwordx4 a[156:159], v64, s[28:31], s1 offen offset:3072 sc1
    ds_read_b64_tr_b16 v[130:131], v26 offset:38912
    ds_read_b64_tr_b16 v[132:133], v26 offset:39936
    v_mfma_f32_32x32x16_bf16 v[154:169], v[110:113], a[96:99], v[154:169]
    s_add_u32 m0, s58, 32768
    s_add_u32 s0, s0, 458752
    s_cmp_eq_u32 s0, 7340032
    s_cselect_b32 s0, 0, s0
    buffer_load_dwordx4 v41, s[20:23], s0 offen lds
    ds_read_b64_tr_b16 v[134:135], v27 offset:38912
    ds_read_b64_tr_b16 v[136:137], v27 offset:39936
    s_waitcnt vmcnt(23) lgkmcnt(8)
    v_mfma_f32_32x32x16_bf16 v[138:153], v[114:117], a[100:103], v[138:153]
    buffer_load_dwordx4 v42, s[20:23], s0 offen offset:1024 lds
    s_barrier
    ds_read_b64_tr_b16 v[106:107], v26 offset:49152
    ds_read_b64_tr_b16 v[108:109], v26 offset:50176
    v_mfma_f32_32x32x16_bf16 v[154:169], v[118:121], a[100:103], v[154:169]
    buffer_load_dwordx4 v43, s[20:23], s0 offen offset:2048 lds
    ds_read_b64_tr_b16 v[110:111], v27 offset:49152
    ds_read_b64_tr_b16 v[112:113], v27 offset:50176
    s_waitcnt vmcnt(24) lgkmcnt(8)
    v_mfma_f32_32x32x16_bf16 v[138:153], v[122:125], a[104:107], v[138:153]
    buffer_load_dwordx4 v44, s[20:23], s0 offen offset:3072 lds
    ds_read_b64_tr_b16 v[114:115], v26 offset:51200
    ds_read_b64_tr_b16 v[116:117], v26 offset:52224
    v_mfma_f32_32x32x16_bf16 v[154:169], v[126:129], a[104:107], v[154:169]
    s_add_u32 s1, s1, 8192
    s_and_b32 s1, s1, 0x1ffff
    buffer_load_dwordx4 a[160:163], v64, s[28:31], s1 offen offset:0 sc1
    ds_read_b64_tr_b16 v[118:119], v27 offset:51200
    ds_read_b64_tr_b16 v[120:121], v27 offset:52224
    s_waitcnt vmcnt(25) lgkmcnt(8)
    v_mfma_f32_32x32x16_bf16 v[138:153], v[130:133], a[108:111], v[138:153]
    buffer_load_dwordx4 a[164:167], v64, s[28:31], s1 offen offset:1024 sc1
    ds_read_b64_tr_b16 v[122:123], v26 offset:53248
    ds_read_b64_tr_b16 v[124:125], v26 offset:54272
    v_mfma_f32_32x32x16_bf16 v[154:169], v[134:137], a[108:111], v[154:169]
    buffer_load_dwordx4 a[168:171], v64, s[28:31], s1 offen offset:2048 sc1
    ds_read_b64_tr_b16 v[126:127], v27 offset:53248
    ds_read_b64_tr_b16 v[128:129], v27 offset:54272
    s_waitcnt vmcnt(26) lgkmcnt(8)
    v_mfma_f32_32x32x16_bf16 v[138:153], v[106:109], a[112:115], v[138:153]
    buffer_load_dwordx4 a[172:175], v64, s[28:31], s1 offen offset:3072 sc1
    ds_read_b64_tr_b16 v[130:131], v26 offset:55296
    ds_read_b64_tr_b16 v[132:133], v26 offset:56320
    v_mfma_f32_32x32x16_bf16 v[154:169], v[110:113], a[112:115], v[154:169]
    s_add_u32 m0, s58, 49152
    s_add_u32 s0, s0, 458752
    s_cmp_eq_u32 s0, 7340032
    s_cselect_b32 s0, 0, s0
    buffer_load_dwordx4 v41, s[20:23], s0 offen lds
    ds_read_b64_tr_b16 v[134:135], v27 offset:55296
    ds_read_b64_tr_b16 v[136:137], v27 offset:56320
    s_waitcnt vmcnt(27) lgkmcnt(8)
    v_mfma_f32_32x32x16_bf16 v[138:153], v[114:117], a[116:119], v[138:153]
    buffer_load_dwordx4 v42, s[20:23], s0 offen offset:1024 lds
    ds_read_b64_tr_b16 v[106:107], v28 offset:0
    ds_read_b64_tr_b16 v[108:109], v28 offset:1024
    v_mfma_f32_32x32x16_bf16 v[154:169], v[118:121], a[116:119], v[154:169]
    buffer_load_dwordx4 v43, s[20:23], s0 offen offset:2048 lds
    ds_read_b64_tr_b16 v[110:111], v29 offset:0
    ds_read_b64_tr_b16 v[112:113], v29 offset:1024
    s_waitcnt vmcnt(28) lgkmcnt(8)
    v_mfma_f32_32x32x16_bf16 v[138:153], v[122:125], a[120:123], v[138:153]
    buffer_load_dwordx4 v44, s[20:23], s0 offen offset:3072 lds
    ds_read_b64_tr_b16 v[114:115], v28 offset:2048
    ds_read_b64_tr_b16 v[116:117], v28 offset:3072
    v_mfma_f32_32x32x16_bf16 v[154:169], v[126:129], a[120:123], v[154:169]
    s_add_u32 s1, s1, 8192
    s_and_b32 s1, s1, 0x1ffff
    buffer_load_dwordx4 a[176:179], v64, s[28:31], s1 offen offset:0 sc1
    ds_read_b64_tr_b16 v[118:119], v29 offset:2048
    ds_read_b64_tr_b16 v[120:121], v29 offset:3072
    s_waitcnt vmcnt(29) lgkmcnt(8)
    v_mfma_f32_32x32x16_bf16 v[138:153], v[130:133], a[124:127], v[138:153]
    buffer_load_dwordx4 a[180:183], v64, s[28:31], s1 offen offset:1024 sc1
    ds_read_b64_tr_b16 v[122:123], v28 offset:4096
    ds_read_b64_tr_b16 v[124:125], v28 offset:5120
    v_mfma_f32_32x32x16_bf16 v[154:169], v[134:137], a[124:127], v[154:169]
    buffer_load_dwordx4 a[184:187], v64, s[28:31], s1 offen offset:2048 sc1
    ds_read_b64_tr_b16 v[126:127], v29 offset:4096
    ds_read_b64_tr_b16 v[128:129], v29 offset:5120
    s_waitcnt vmcnt(26) lgkmcnt(8)
    v_mfma_f32_32x32x16_bf16 v[138:153], v[106:109], a[128:131], v[138:153]
    buffer_load_dwordx4 a[188:191], v64, s[28:31], s1 offen offset:3072 sc1
    ds_read_b64_tr_b16 v[130:131], v28 offset:6144
    ds_read_b64_tr_b16 v[132:133], v28 offset:7168
    v_mfma_f32_32x32x16_bf16 v[154:169], v[110:113], a[128:131], v[154:169]
    s_add_u32 m0, s58, 65536
    s_add_u32 s0, s0, 458752
    s_cmp_eq_u32 s0, 7340032
    s_cselect_b32 s0, 0, s0
    buffer_load_dwordx4 v41, s[20:23], s0 offen lds
    ds_read_b64_tr_b16 v[134:135], v29 offset:6144
    ds_read_b64_tr_b16 v[136:137], v29 offset:7168
    s_waitcnt vmcnt(27) lgkmcnt(8)
    v_mfma_f32_32x32x16_bf16 v[138:153], v[114:117], a[132:135], v[138:153]
    buffer_load_dwordx4 v42, s[20:23], s0 offen offset:1024 lds
    ds_read_b64_tr_b16 v[106:107], v28 offset:16384
    ds_read_b64_tr_b16 v[108:109], v28 offset:17408
    v_mfma_f32_32x32x16_bf16 v[154:169], v[118:121], a[132:135], v[154:169]
    buffer_load_dwordx4 v43, s[20:23], s0 offen offset:2048 lds
    ds_read_b64_tr_b16 v[110:111], v29 offset:16384
    ds_read_b64_tr_b16 v[112:113], v29 offset:17408
    s_waitcnt vmcnt(28) lgkmcnt(8)
    v_mfma_f32_32x32x16_bf16 v[138:153], v[122:125], a[136:139], v[138:153]
    buffer_load_dwordx4 v44, s[20:23], s0 offen offset:3072 lds
    ds_read_b64_tr_b16 v[114:115], v28 offset:18432
    ds_read_b64_tr_b16 v[116:117], v28 offset:19456
    v_mfma_f32_32x32x16_bf16 v[154:169], v[126:129], a[136:139], v[154:169]
    s_add_u32 s1, s1, 8192
    s_and_b32 s1, s1, 0x1ffff
    buffer_load_dwordx4 a[192:195], v64, s[28:31], s1 offen offset:0 sc1
    ds_read_b64_tr_b16 v[118:119], v29 offset:18432
    ds_read_b64_tr_b16 v[120:121], v29 offset:19456
    s_waitcnt vmcnt(29) lgkmcnt(8)
    v_mfma_f32_32x32x16_bf16 v[138:153], v[130:133], a[140:143], v[138:153]
    buffer_load_dwordx4 a[196:199], v64, s[28:31], s1 offen offset:1024 sc1
    ds_read_b64_tr_b16 v[122:123], v28 offset:20480
    ds_read_b64_tr_b16 v[124:125], v28 offset:21504
    v_mfma_f32_32x32x16_bf16 v[154:169], v[134:137], a[140:143], v[154:169]
    buffer_load_dwordx4 a[200:203], v64, s[28:31], s1 offen offset:2048 sc1
    ds_read_b64_tr_b16 v[126:127], v29 offset:20480
    ds_read_b64_tr_b16 v[128:129], v29 offset:21504
    s_waitcnt vmcnt(26) lgkmcnt(8)
    v_mfma_f32_32x32x16_bf16 v[138:153], v[106:109], a[144:147], v[138:153]
    buffer_load_dwordx4 a[204:207], v64, s[28:31], s1 offen offset:3072 sc1
    ds_read_b64_tr_b16 v[130:131], v28 offset:22528
    ds_read_b64_tr_b16 v[132:133], v28 offset:23552
    v_mfma_f32_32x32x16_bf16 v[154:169], v[110:113], a[144:147], v[154:169]
    s_add_u32 m0, s58, 81920
    s_add_u32 s0, s0, 458752
    s_cmp_eq_u32 s0, 7340032
    s_cselect_b32 s0, 0, s0
    buffer_load_dwordx4 v41, s[20:23], s0 offen lds
    ds_read_b64_tr_b16 v[134:135], v29 offset:22528
    ds_read_b64_tr_b16 v[136:137], v29 offset:23552
    s_waitcnt vmcnt(27) lgkmcnt(8)
    v_mfma_f32_32x32x16_bf16 v[138:153], v[114:117], a[148:151], v[138:153]
    buffer_load_dwordx4 v42, s[20:23], s0 offen offset:1024 lds
    s_waitcnt vmcnt(22)
    s_barrier
    ds_read_b64_tr_b16 v[106:107], v24 offset:0
    ds_read_b64_tr_b16 v[108:109], v24 offset:1024
    v_mfma_f32_32x32x16_bf16 v[154:169], v[118:121], a[148:151], v[154:169]
    buffer_load_dwordx4 v43, s[20:23], s0 offen offset:2048 lds
    ds_read_b64_tr_b16 v[110:111], v25 offset:0
    ds_read_b64_tr_b16 v[112:113], v25 offset:1024
    s_waitcnt lgkmcnt(8)
    v_mfma_f32_32x32x16_bf16 v[138:153], v[122:125], a[152:155], v[138:153]
    buffer_load_dwordx4 v44, s[20:23], s0 offen offset:3072 lds
    ds_read_b64_tr_b16 v[114:115], v24 offset:2048
    ds_read_b64_tr_b16 v[116:117], v24 offset:3072
    v_mfma_f32_32x32x16_bf16 v[154:169], v[126:129], a[152:155], v[154:169]
    s_add_u32 s1, s1, 8192
    s_and_b32 s1, s1, 0x1ffff
    buffer_load_dwordx4 a[208:211], v64, s[28:31], s1 offen offset:0 sc1
    ds_read_b64_tr_b16 v[118:119], v25 offset:2048
    ds_read_b64_tr_b16 v[120:121], v25 offset:3072
    s_waitcnt lgkmcnt(8)
    v_mfma_f32_32x32x16_bf16 v[138:153], v[130:133], a[156:159], v[138:153]
    ds_read_b64_tr_b16 v[122:123], v24 offset:4096
    ds_read_b64_tr_b16 v[124:125], v24 offset:5120
    v_mfma_f32_32x32x16_bf16 v[154:169], v[134:137], a[156:159], v[154:169]
    buffer_load_dwordx4 a[212:215], v64, s[28:31], s1 offen offset:1024 sc1
    ds_read_b64_tr_b16 v[126:127], v25 offset:4096
    ds_read_b64_tr_b16 v[128:129], v25 offset:5120
    s_waitcnt vmcnt(25) lgkmcnt(8)
    v_mfma_f32_32x32x16_bf16 v[138:153], v[106:109], a[160:163], v[138:153]
    ds_read_b64_tr_b16 v[130:131], v24 offset:6144
    ds_read_b64_tr_b16 v[132:133], v24 offset:7168
    v_mfma_f32_32x32x16_bf16 v[154:169], v[110:113], a[160:163], v[154:169]
    buffer_load_dwordx4 a[216:219], v64, s[28:31], s1 offen offset:2048 sc1
    ds_read_b64_tr_b16 v[134:135], v25 offset:6144
    ds_read_b64_tr_b16 v[136:137], v25 offset:7168
    s_waitcnt vmcnt(25) lgkmcnt(8)
    v_mfma_f32_32x32x16_bf16 v[138:153], v[114:117], a[164:167], v[138:153]
    ds_read_b64_tr_b16 v[106:107], v24 offset:16384
    ds_read_b64_tr_b16 v[108:109], v24 offset:17408
    v_mfma_f32_32x32x16_bf16 v[154:169], v[118:121], a[164:167], v[154:169]
    buffer_load_dwordx4 a[220:223], v64, s[28:31], s1 offen offset:3072 sc1
    ds_read_b64_tr_b16 v[110:111], v25 offset:16384
    ds_read_b64_tr_b16 v[112:113], v25 offset:17408
    s_waitcnt vmcnt(25) lgkmcnt(8)
    v_mfma_f32_32x32x16_bf16 v[138:153], v[122:125], a[168:171], v[138:153]
    ds_read_b64_tr_b16 v[114:115], v24 offset:18432
    ds_read_b64_tr_b16 v[116:117], v24 offset:19456
    v_mfma_f32_32x32x16_bf16 v[154:169], v[126:129], a[168:171], v[154:169]
    buffer_load_dword v18, v21, s[28:31], 0 offen sc1
    ds_read_b64_tr_b16 v[118:119], v25 offset:18432
    buffer_load_dword v62, v63, s[28:31], 0 offen sc1
    ds_read_b64_tr_b16 v[120:121], v25 offset:19456
    s_waitcnt vmcnt(26) lgkmcnt(8)
    v_mfma_f32_32x32x16_bf16 v[138:153], v[130:133], a[172:175], v[138:153]
    s_add_u32 s1, s1, 8192
    s_and_b32 s1, s1, 0x1ffff
    buffer_load_dwordx4 a[224:227], v64, s[28:31], s1 offen offset:0 sc1
    ds_read_b64_tr_b16 v[122:123], v24 offset:20480
    ds_read_b64_tr_b16 v[124:125], v24 offset:21504
    v_mfma_f32_32x32x16_bf16 v[154:169], v[134:137], a[172:175], v[154:169]
    ds_read_b64_tr_b16 v[126:127], v25 offset:20480
    ds_read_b64_tr_b16 v[128:129], v25 offset:21504
    s_waitcnt vmcnt(22) lgkmcnt(8)
    v_mfma_f32_32x32x16_bf16 v[138:153], v[106:109], a[176:179], v[138:153]
    buffer_load_dwordx4 a[228:231], v64, s[28:31], s1 offen offset:1024 sc1
    ds_read_b64_tr_b16 v[130:131], v24 offset:22528
    ds_read_b64_tr_b16 v[132:133], v24 offset:23552
    v_mfma_f32_32x32x16_bf16 v[154:169], v[110:113], a[176:179], v[154:169]
    ds_read_b64_tr_b16 v[134:135], v25 offset:22528
    ds_read_b64_tr_b16 v[136:137], v25 offset:23552
    s_waitcnt vmcnt(22) lgkmcnt(8)
    v_mfma_f32_32x32x16_bf16 v[138:153], v[114:117], a[180:183], v[138:153]
    buffer_load_dwordx4 a[232:235], v64, s[28:31], s1 offen offset:2048 sc1
    s_waitcnt vmcnt(9)
    s_barrier
    s_waitcnt vmcnt(4)
    v_cmp_ne_u32 vcc, s57, v18
    s_cbranch_vccz L_pollok1
    s_mov_b32 s60, 0
L_poll1:
    s_sleep 8
    buffer_load_dword v18, v21, s[28:31], 0 offen sc1
    s_add_u32 s60, s60, 1
    s_waitcnt vmcnt(0)
    v_cmp_ne_u32 vcc, s57, v18
    s_cbranch_vccz L_pollok1
    s_cmp_lt_u32 s60, 20000
    s_cbranch_scc1 L_poll1
L_pollok1:
    ds_read_b64_tr_b16 v[106:107], v24 offset:32768
    ds_read_b64_tr_b16 v[108:109], v24 offset:33792
    v_mfma_f32_32x32x16_bf16 v[154:169], v[118:121], a[180:183], v[154:169]
    ds_read_b64_tr_b16 v[110:111], v25 offset:32768
    ds_read_b64_tr_b16 v[112:113], v25 offset:33792
    s_waitcnt lgkmcnt(8)
    v_mfma_f32_32x32x16_bf16 v[138:153], v[122:125], a[184:187], v[138:153]
    buffer_load_dwordx4 a[236:239], v64, s[28:31], s1 offen offset:3072 sc1
    ds_read_b64_tr_b16 v[114:115], v24 offset:34816
    ds_read_b64_tr_b16 v[116:117], v24 offset:35840
    v_mfma_f32_32x32x16_bf16 v[154:169], v[126:129], a[184:187], v[154:169]
    ds_read_b64_tr_b16 v[118:119], v25 offset:34816
    ds_read_b64_tr_b16 v[120:121], v25 offset:35840
    s_waitcnt lgkmcnt(8)
    v_mfma_f32_32x32x16_bf16 v[138:153], v[130:133], a[188:191], v[138:153]
    s_add_u32 s1, s1, 8192
    s_and_b32 s1, s1, 0x1ffff
    buffer_load_dwordx4 a[240:243], v64, s[28:31], s1 offen offset:0 sc1
    ds_read_b64_tr_b16 v[122:123], v24 offset:36864
    ds_read_b64_tr_b16 v[124:125], v24 offset:37888
    v_mfma_f32_32x32x16_bf16 v[154:169], v[134:137], a[188:191], v[154:169]
    buffer_load_dwordx4 a[244:247], v64, s[28:31], s1 offen offset:1024 sc1
    ds_read_b64_tr_b16 v[126:127], v25 offset:36864
    ds_read_b64_tr_b16 v[128:129], v25 offset:37888
    s_waitcnt lgkmcnt(8)
    v_mfma_f32_32x32x16_bf16 v[138:153], v[106:109], a[192:195], v[138:153]
    ds_read_b64_tr_b16 v[130:131], v24 offset:38912
    ds_read_b64_tr_b16 v[132:133], v24 offset:39936
    v_mfma_f32_32x32x16_bf16 v[154:169], v[110:113], a[192:195], v[154:169]
    buffer_load_dwordx4 a[248:251], v64, s[28:31], s1 offen offset:2048 sc1
    ds_read_b64_tr_b16 v[134:135], v25 offset:38912
    ds_read_b64_tr_b16 v[136:137], v25 offset:39936
    s_waitcnt lgkmcnt(8)
    v_mfma_f32_32x32x16_bf16 v[138:153], v[114:117], a[196:199], v[138:153]
    buffer_load_dwordx4 a[252:255], v64, s[28:31], s1 offen offset:3072 sc1
    ds_read_b64_tr_b16 v[106:107], v24 offset:49152
    ds_read_b64_tr_b16 v[108:109], v24 offset:50176
    v_mfma_f32_32x32x16_bf16 v[154:169], v[118:121], a[196:199], v[154:169]
    ds_read_b64_tr_b16 v[110:111], v25 offset:49152
    ds_read_b64_tr_b16 v[112:113], v25 offset:50176
    s_waitcnt lgkmcnt(8)
    v_mfma_f32_32x32x16_bf16 v[138:153], v[122:125], a[200:203], v[138:153]
    s_add_u32 m0, s59, 98304
    s_nop 0
    buffer_load_dwordx4 v66, s[28:31], s63 offen sc1 lds
    ds_read_b64_tr_b16 v[114:115], v24 offset:51200
    ds_read_b64_tr_b16 v[116:117], v24 offset:52224
    v_mfma_f32_32x32x16_bf16 v[154:169], v[126:129], a[200:203], v[154:169]
    buffer_load_dwordx4 v66, s[28:31], s63 offen offset:1024 sc1 lds
    ds_read_b64_tr_b16 v[118:119], v25 offset:51200
    ds_read_b64_tr_b16 v[120:121], v25 offset:52224
    s_waitcnt lgkmcnt(8)
    v_mfma_f32_32x32x16_bf16 v[138:153], v[130:133], a[204:207], v[138:153]
    ds_read_b64_tr_b16 v[122:123], v24 offset:53248
    ds_read_b64_tr_b16 v[124:125], v24 offset:54272
    v_mfma_f32_32x32x16_bf16 v[154:169], v[134:137], a[204:207], v[154:169]
    buffer_load_dwordx4 v66, s[28:31], s63 offen offset:2048 sc1 lds
    ds_read_b64_tr_b16 v[126:127], v25 offset:53248
    ds_read_b64_tr_b16 v[128:129], v25 offset:54272
    s_waitcnt lgkmcnt(8)
    v_mfma_f32_32x32x16_bf16 v[138:153], v[106:109], a[208:211], v[138:153]
    s_add_u32 m0, s100, 126976
    s_nop 0
    buffer_load_dwordx4 v55, s[28:31], s62 offen sc1 lds
    ds_read_b64_tr_b16 v[130:131], v24 offset:55296
    ds_read_b64_tr_b16 v[132:133], v24 offset:56320
    v_mfma_f32_32x32x16_bf16 v[154:169], v[110:113], a[208:211], v[154:169]
    ds_read_b64_tr_b16 v[134:135], v25 offset:55296
    ds_read_b64_tr_b16 v[136:137], v25 offset:56320
    s_waitcnt lgkmcnt(8)
    v_mfma_f32_32x32x16_bf16 v[138:153], v[114:117], a[212:215], v[138:153]
    s_add_u32 m0, s58, 110592
    s_nop 0
    buffer_load_dwordx4 v53, s[28:31], s62 offen sc1 lds
    s_barrier
    ds_read_b64_tr_b16 v[106:107], v26 offset:0
    ds_read_b64_tr_b16 v[108:109], v26 offset:1024
    v_mfma_f32_32x32x16_bf16 v[154:169], v[118:121], a[212:215], v[154:169]
    buffer_load_dwordx4 v53, s[28:31], s62 offen offset:1024 sc1 lds
    ds_read_b64_tr_b16 v[110:111], v27 offset:0
    ds_read_b64_tr_b16 v[112:113], v27 offset:1024
    s_waitcnt lgkmcnt(8)
    v_mfma_f32_32x32x16_bf16 v[138:153], v[122:125], a[216:219], v[138:153]
    buffer_load_dwordx4 v54, s[28:31], s62 offen offset:2048 sc1 lds
    ds_read_b64_tr_b16 v[114:115], v26 offset:2048
    ds_read_b64_tr_b16 v[116:117], v26 offset:3072
    v_mfma_f32_32x32x16_bf16 v[154:169], v[126:129], a[216:219], v[154:169]
    ds_read_b64_tr_b16 v[118:119], v27 offset:2048
    ds_read_b64_tr_b16 v[120:121], v27 offset:3072
    s_waitcnt lgkmcnt(8)
    v_mfma_f32_32x32x16_bf16 v[138:153], v[130:133], a[220:223], v[138:153]
    buffer_load_dwordx4 v54, s[28:31], s62 offen offset:3072 sc1 lds
    ds_read_b64_tr_b16 v[122:123], v26 offset:4096
    ds_read_b64_tr_b16 v[124:125], v26 offset:5120
    v_mfma_f32_32x32x16_bf16 v[154:169], v[134:137], a[220:223], v[154:169]
    s_add_u32 m0, s59, 131072
    s_add_u32 s63, s63, 12288
    s_cmp_eq_u32 s63, 86016
    s_cselect_b32 s63, 0, s63
    buffer_load_dwordx4 v66, s[28:31], s63 offen sc1 lds
    ds_read_b64_tr_b16 v[126:127], v27 offset:4096
    ds_read_b64_tr_b16 v[128:129], v27 offset:5120
    s_waitcnt vmcnt(16) lgkmcnt(8)
    v_mfma_f32_32x32x16_bf16 v[138:153], v[106:109], a[224:227], v[138:153]
    ds_read_b64_tr_b16 v[130:131], v26 offset:6144
    ds_read_b64_tr_b16 v[132:133], v26 offset:7168
    v_mfma_f32_32x32x16_bf16 v[154:169], v[110:113], a[224:227], v[154:169]
    buffer_load_dwordx4 v66, s[28:31], s63 offen offset:1024 sc1 lds
    ds_read_b64_tr_b16 v[134:135], v27 offset:6144
    ds_read_b64_tr_b16 v[136:137], v27 offset:7168
    s_waitcnt vmcnt(16) lgkmcnt(8)
    v_mfma_f32_32x32x16_bf16 v[138:153], v[114:117], a[228:231], v[138:153]
    buffer_load_dwordx4 v66, s[28:31], s63 offen offset:2048 sc1 lds
    ds_read_b64_tr_b16 v[106:107], v26 offset:16384
    ds_read_b64_tr_b16 v[108:109], v26 offset:17408
    v_mfma_f32_32x32x16_bf16 v[154:169], v[118:121], a[228:231], v[154:169]
    ds_read_b64_tr_b16 v[110:111], v27 offset:16384
    ds_read_b64_tr_b16 v[112:113], v27 offset:17408
    s_waitcnt vmcnt(16) lgkmcnt(8)
    v_mfma_f32_32x32x16_bf16 v[138:153], v[122:125], a[232:235], v[138:153]
    s_add_u32 m0, s100, 159744
    s_add_u32 s62, s62, 262144
    s_cmp_eq_u32 s62, 1835008
    s_cselect_b32 s62, 0, s62
    buffer_load_dwordx4 v55, s[28:31], s62 offen sc1 lds
    ds_read_b64_tr_b16 v[114:115], v26 offset:18432
    ds_read_b64_tr_b16 v[116:117], v26 offset:19456
    v_mfma_f32_32x32x16_bf16 v[154:169], v[126:129], a[232:235], v[154:169]
    s_add_u32 m0, s58, 143360
    s_nop 0
    buffer_load_dwordx4 v53, s[28:31], s62 offen sc1 lds
    ds_read_b64_tr_b16 v[118:119], v27 offset:18432
    ds_read_b64_tr_b16 v[120:121], v27 offset:19456
    s_waitcnt vmcnt(17) lgkmcnt(8)
    v_mfma_f32_32x32x16_bf16 v[138:153], v[130:133], a[236:239], v[138:153]
    ds_read_b64_tr_b16 v[122:123], v26 offset:20480
    ds_read_b64_tr_b16 v[124:125], v26 offset:21504
    v_mfma_f32_32x32x16_bf16 v[154:169], v[134:137], a[236:239], v[154:169]
    buffer_load_dwordx4 v53, s[28:31], s62 offen offset:1024 sc1 lds
    ds_read_b64_tr_b16 v[126:127], v27 offset:20480
    ds_read_b64_tr_b16 v[128:129], v27 offset:21504
    s_waitcnt vmcnt(17) lgkmcnt(8)
    v_mfma_f32_32x32x16_bf16 v[138:153], v[106:109], a[240:243], v[138:153]
    buffer_load_dwordx4 v54, s[28:31], s62 offen offset:2048 sc1 lds
    ds_read_b64_tr_b16 v[130:131], v26 offset:22528
    ds_read_b64_tr_b16 v[132:133], v26 offset:23552
    v_mfma_f32_32x32x16_bf16 v[154:169], v[110:113], a[240:243], v[154:169]
    ds_read_b64_tr_b16 v[134:135], v27 offset:22528
    ds_read_b64_tr_b16 v[136:137], v27 offset:23552
    s_waitcnt vmcnt(17) lgkmcnt(8)
    v_mfma_f32_32x32x16_bf16 v[138:153], v[114:117], a[244:247], v[138:153]
    buffer_load_dwordx4 v54, s[28:31], s62 offen offset:3072 sc1 lds
    v_mfma_f32_32x32x16_bf16 v[154:169], v[118:121], a[244:247], v[154:169]
    s_add_u32 m0, s59, 0
    s_add_u32 s63, s63, 12288
    s_cmp_eq_u32 s63, 86016
    s_cselect_b32 s63, 0, s63
    buffer_load_dwordx4 v66, s[28:31], s63 offen sc1 lds
    s_waitcnt vmcnt(18) lgkmcnt(4)
    v_mfma_f32_32x32x16_bf16 v[138:153], v[122:125], a[248:251], v[138:153]
    v_mfma_f32_32x32x16_bf16 v[154:169], v[126:129], a[248:251], v[154:169]
    buffer_load_dwordx4 v66, s[28:31], s63 offen offset:1024 sc1 lds
    s_waitcnt vmcnt(18) lgkmcnt(0)
    v_mfma_f32_32x32x16_bf16 v[138:153], v[130:133], a[252:255], v[138:153]
    buffer_load_dwordx4 v66, s[28:31], s63 offen offset:2048 sc1 lds
    v_mfma_f32_32x32x16_bf16 v[154:169], v[134:137], a[252:255], v[154:169]
    s_nop 11
    ds_write_b128 v67, v[154:157] offset:32768
    ds_write_b128 v67, v[158:161] offset:33792
    ds_write_b128 v67, v[162:165] offset:34816
    ds_write_b128 v67, v[166:169] offset:35840
    s_add_u32 m0, s100, 28672
    s_add_u32 s62, s62, 262144
    s_cmp_eq_u32 s62, 1835008
    s_cselect_b32 s62, 0, s62
    buffer_load_dwordx4 v55, s[28:31], s62 offen sc1 lds
    v_xor_b32 v67, 8192, v67
    s_waitcnt lgkmcnt(0)
    s_barrier
    ds_read_b128 v[170:173], v67 offset:32768
    ds_read_b128 v[174:177], v67 offset:33792
    ds_read_b128 v[178:181], v67 offset:34816
    ds_read_b128 v[182:185], v67 offset:35840
    s_waitcnt lgkmcnt(3)
    v_pk_add_f32 v[138:139], v[138:139], v[170:171]
    v_pk_add_f32 v[140:141], v[140:141], v[172:173]
    s_waitcnt lgkmcnt(2)
    v_pk_add_f32 v[142:143], v[142:143], v[174:175]
    v_pk_add_f32 v[144:145], v[144:145], v[176:177]
    v_pk_mul_f32 v[170:171], v[138:139], v[138:139]
    v_pk_mul_f32 v[172:173], v[140:141], v[140:141]
    s_add_u32 m0, s58, 12288
    s_nop 0
    buffer_load_dwordx4 v53, s[28:31], s62 offen sc1 lds
    v_pk_mul_f32 v[174:175], v[142:143], v[142:143]
    v_pk_mul_f32 v[176:177], v[144:145], v[144:145]
    v_pk_fma_f32 v[170:171], v[170:171], s[78:79], v[96:97]
    v_pk_fma_f32 v[172:173], v[172:173], s[78:79], v[96:97]
    v_pk_fma_f32 v[174:175], v[174:175], s[78:79], v[96:97]
    v_pk_fma_f32 v[176:177], v[176:177], s[78:79], v[96:97]
    v_pk_mul_f32 v[170:171], v[170:171], v[138:139]
    v_pk_mul_f32 v[172:173], v[172:173], v[140:141]
    v_pk_mul_f32 v[174:175], v[174:175], v[142:143]
    v_pk_mul_f32 v[176:177], v[176:177], v[144:145]
    v_exp_f32 v170, v170
    buffer_load_dwordx4 v53, s[28:31], s62 offen offset:1024 sc1 lds
    v_exp_f32 v171, v171
    v_exp_f32 v172, v172
    v_exp_f32 v173, v173
    v_exp_f32 v174, v174
    v_exp_f32 v175, v175
    v_exp_f32 v176, v176
    buffer_load_dwordx4 v54, s[28:31], s62 offen offset:2048 sc1 lds
    v_exp_f32 v177, v177
    v_pk_add_f32 v[170:171], v[170:171], s[80:81]
    v_pk_add_f32 v[172:173], v[172:173], s[80:81]
    v_pk_add_f32 v[174:175], v[174:175], s[80:81]
    v_pk_add_f32 v[176:177], v[176:177], s[80:81]
    v_rcp_f32 v170, v170
    v_rcp_f32 v171, v171
    v_rcp_f32 v172, v172
    buffer_load_dwordx4 v54, s[28:31], s62 offen offset:3072 sc1 lds
    v_rcp_f32 v173, v173
    v_rcp_f32 v174, v174
    v_rcp_f32 v175, v175
    v_rcp_f32 v176, v176
    v_rcp_f32 v177, v177
    v_pk_mul_f32 v[170:171], v[170:171], v[138:139]
    v_pk_mul_f32 v[172:173], v[172:173], v[140:141]
    v_pk_mul_f32 v[174:175], v[174:175], v[142:143]
    v_pk_mul_f32 v[176:177], v[176:177], v[144:145]
    v_cvt_pk_bf16_f32 v98, v170, v171
    v_cvt_pk_bf16_f32 v99, v172, v173
    v_cvt_pk_bf16_f32 v100, v174, v175
    v_cvt_pk_bf16_f32 v101, v176, v177
    s_waitcnt lgkmcnt(1)
    v_pk_add_f32 v[146:147], v[146:147], v[178:179]
    v_pk_add_f32 v[148:149], v[148:149], v[180:181]
    s_waitcnt lgkmcnt(0)
    v_pk_add_f32 v[150:151], v[150:151], v[182:183]
    v_pk_add_f32 v[152:153], v[152:153], v[184:185]
    v_pk_mul_f32 v[178:179], v[146:147], v[146:147]
    v_pk_mul_f32 v[180:181], v[148:149], v[148:149]
    v_pk_mul_f32 v[182:183], v[150:151], v[150:151]
    v_pk_mul_f32 v[184:185], v[152:153], v[152:153]
    v_pk_fma_f32 v[178:179], v[178:179], s[78:79], v[96:97]
    v_pk_fma_f32 v[180:181], v[180:181], s[78:79], v[96:97]
    v_pk_fma_f32 v[182:183], v[182:183], s[78:79], v[96:97]
    v_pk_fma_f32 v[184:185], v[184:185], s[78:79], v[96:97]
    v_pk_mul_f32 v[178:179], v[178:179], v[146:147]
    v_pk_mul_f32 v[180:181], v[180:181], v[148:149]
    v_pk_mul_f32 v[182:183], v[182:183], v[150:151]
    v_pk_mul_f32 v[184:185], v[184:185], v[152:153]
    v_exp_f32 v178, v178
    v_exp_f32 v179, v179
    v_exp_f32 v180, v180
    v_exp_f32 v181, v181
    v_exp_f32 v182, v182
    v_exp_f32 v183, v183
    v_exp_f32 v184, v184
    v_exp_f32 v185, v185
    v_pk_add_f32 v[178:179], v[178:179], s[80:81]
    v_pk_add_f32 v[180:181], v[180:181], s[80:81]
    v_pk_add_f32 v[182:183], v[182:183], s[80:81]
    v_pk_add_f32 v[184:185], v[184:185], s[80:81]
    v_rcp_f32 v178, v178
    v_rcp_f32 v179, v179
    v_rcp_f32 v180, v180
    v_rcp_f32 v181, v181
    v_rcp_f32 v182, v182
    v_rcp_f32 v183, v183
    v_rcp_f32 v184, v184
    v_rcp_f32 v185, v185
    v_pk_mul_f32 v[178:179], v[178:179], v[146:147]
    v_pk_mul_f32 v[180:181], v[180:181], v[148:149]
    v_pk_mul_f32 v[182:183], v[182:183], v[150:151]
    v_pk_mul_f32 v[184:185], v[184:185], v[152:153]
    v_cvt_pk_bf16_f32 v102, v178, v179
    v_cvt_pk_bf16_f32 v103, v180, v181
    v_cvt_pk_bf16_f32 v104, v182, v183
    v_cvt_pk_bf16_f32 v105, v184, v185
    buffer_store_dwordx4 v[98:101], v4, s[28:31], s67 offen offset:0 sc1
    buffer_store_dwordx4 v[102:105], v4, s[28:31], s67 offen offset:1024 sc1
    s_branch L_q
L_nog1:
    s_nop 1
    s_mov_b32 s14, 1204224
    s_mov_b32 s15, 0x20000
    s_sub_u32 s3, s2, 200
    s_cmp_lt_u32 s3, 42
    s_cselect_b32 s81, 0, 268435456
    s_cselect_b32 s3, s3, 0
    s_mul_i32 s79, s3, 43
    s_lshr_b32 s79, s79, 7
    s_mul_i32 s80, s79, 3
    s_sub_u32 s80, s3, s80
    v_min_u32 v14, 55, v1
    s_lshl_b32 s3, s79, 2
    s_add_u32 s3, s3, s48
    s_mul_i32 s3, s3, 21504
    s_mul_i32 s60, s80, 896
    s_add_u32 s3, s3, s60
    s_add_u32 s3, s3, s81
    v_lshl_add_u32 v230, v14, 4, s3
    s_mul_i32 s60, s48, 8448
    s_add_u32 m0, s60, 0
    s_mov_b32 s3, 0
    buffer_load_dwordx4 v230, s[12:15], s3 offen lds
    s_add_u32 m0, s60, 1056
    s_mov_b32 s3, 2688
    buffer_load_dwordx4 v230, s[12:15], s3 offen lds
    s_add_u32 m0, s60, 2112
    s_mov_b32 s3, 5376
    buffer_load_dwordx4 v230, s[12:15], s3 offen lds
    s_add_u32 m0, s60, 3168
    s_mov_b32 s3, 8064
    buffer_load_dwordx4 v230, s[12:15], s3 offen lds
    s_add_u32 m0, s60, 4224
    s_mov_b32 s3, 10752
    buffer_load_dwordx4 v230, s[12:15], s3 offen lds
    s_add_u32 m0, s60, 5280
    s_mov_b32 s3, 13440
    buffer_load_dwordx4 v230, s[12:15], s3 offen lds
    s_add_u32 m0, s60, 6336
    s_mov_b32 s3, 16128
    buffer_load_dwordx4 v230, s[12:15], s3 offen lds
    s_add_u32 m0, s60, 7392
    s_mov_b32 s3, 18816
    buffer_load_dwordx4 v230, s[12:15], s3 offen lds
    s_mul_i32 s53, s101, 37
    s_lshr_b32 s53, s53, 8
    s_mul_i32 s54, s53, 7
    s_sub_u32 s54, s101, s54
    s_cmp_lt_u32 s101, 28
    s_cselect_b32 s53, s53, s54
    s_lshl_b32 s3, s61, 2
    s_add_u32 s53, s53, s3
    s_cmp_lt_u32 s101, 28
    s_cselect_b32 s56, 1, 0
    s_lshl_b32 s50, s7, 3
    s_and_b32 s3, s101, 7
    s_add_u32 s50, s50, s3
    s_lshr_b32 s60, s101, 3
    s_lshl_b32 s49, s6, 2
    s_add_u32 s49, s49, s60
    s_lshl_b32 s49, s49, 2
    s_add_u32 s49, s49, s48
    s_mul_i32 s60, s60, 0
    s_add_u32 s3, s3, s60
    s_sub_u32 s60, s3, 7
    s_cmp_ge_u32 s3, 7
    s_cselect_b32 s3, s60, s3
    s_lshl_b32 s62, s3, 18
    s_mul_i32 s63, s3, 12288
    s_mov_b32 s30, 12582912
    s_mov_b32 s31, 0x20000
    s_mov_b32 s75, 0x3727c5ac
    s_mov_b32 s76, 0x3b124925
    s_mov_b32 s77, 0x3f803f80
    v_lshlrev_b32 v4, 4, v1
    v_bfe_u32 v7, v1, 2, 2
    v_and_b32 v8, 3, v1
    v_mul_u32_u24 v14, 960, v9
    v_lshl_add_u32 v14, v10, 4, v14
    s_mul_i32 s3, s48, 1920
    s_add_u32 s3, s3, 147456
    v_add_u32 v218, s3, v14
    v_mul_u32_u24 v14, 960, v7
    v_lshl_add_u32 v14, v3, 5, v14
    v_lshl_add_u32 v14, v8, 3, v14
    s_lshl_b32 s3, s48, 8
    s_add_u32 s3, s3, 147456
    v_add_u32 v219, s3, v14
    s_lshl_b32 s3, s48, 3
    s_add_u32 s3, s3, 155648
    v_lshl_add_u32 v220, v9, 2, s3
    v_lshlrev_b32 v225, 2, v6
    v_lshl_add_u32 v226, v5, 24, v225
    v_add_u32 v225, 155648, v225
    v_lshlrev_b32 v14, 17, v9
    v_lshl_add_u32 v221, v10, 4, v14
    s_cmp_eq_u32 s48, 3
    s_cselect_b32 s60, 268435456, 0
    s_lshl_b32 s70, s48, 10
    s_add_u32 s70, s70, s2
    s_lshl_b32 s70, s70, 9
    s_add_u32 s71, s70, 262144
    s_add_u32 s71, s71, s60
    s_xor_b32 s60, s60, 268435456
    s_lshl_b32 s72, s2, 7
    s_add_u32 s72, s72, s60
    s_add_u32 s72, s72, 6291456
    s_lshr_b32 s74, s2, 2
    s_lshl_b32 s74, s74, 5
    s_and_b32 s3, s2, 3
    s_add_u32 s74, s74, s3
    s_lshl_b32 s74, s74, 2
    s_add_u32 s74, s74, 10485760
    v_cmp_gt_u32 vcc, 8, v0
    v_lshlrev_b32 v224, 13, v0
    v_mov_b32 v14, 268435456
    s_and_b32 s83, s2, 7
    s_lshl_b32 s83, s83, 5
    s_add_u32 s83, s83, s4
    s_lshl_b32 s83, s83, 8
    s_add_u32 s83, s83, 10485760
    v_cndmask_b32 v224, v14, v224, vcc
    v_mov_b32 v17, 0
    s_waitcnt vmcnt(10)
    v_dot2_f32_bf16 v214, v170, s77, 0
    v_dot2_f32_bf16 v215, v170, v170, 0
    v_dot2_f32_bf16 v214, v171, s77, v214
    v_dot2_f32_bf16 v215, v171, v171, v215
    v_dot2_f32_bf16 v214, v172, s77, v214
    v_dot2_f32_bf16 v215, v172, v172, v215
    v_dot2_f32_bf16 v214, v173, s77, v214
    v_dot2_f32_bf16 v215, v173, v173, v215
    s_waitcnt vmcnt(9)
    v_dot2_f32_bf16 v214, v174, s77, v214
    v_dot2_f32_bf16 v215, v174, v174, v215
    v_dot2_f32_bf16 v214, v175, s77, v214
    v_dot2_f32_bf16 v215, v175, v175, v215
    v_dot2_f32_bf16 v214, v176, s77, v214
    v_dot2_f32_bf16 v215, v176, v176, v215
    v_dot2_f32_bf16 v214, v177, s77, v214
    v_dot2_f32_bf16 v215, v177, v177, v215
    buffer_load_dword v12, v17, s[44:47], 0 offen sc1
    v_lshlrev_b32 v178, 16, v170
    v_and_b32 v179, 0xffff0000, v170
    v_add_f32_dpp v214, v214, v214 quad_perm:[1,0,3,2] row_mask:0xf bank_mask:0xf
    v_add_f32_dpp v215, v215, v215 quad_perm:[1,0,3,2] row_mask:0xf bank_mask:0xf
    v_lshlrev_b32 v180, 16, v171
    v_add_f32_dpp v214, v214, v214 quad_perm:[2,3,0,1] row_mask:0xf bank_mask:0xf
    v_add_f32_dpp v215, v215, v215 quad_perm:[2,3,0,1] row_mask:0xf bank_mask:0xf
    v_and_b32 v181, 0xffff0000, v171
    v_add_f32_dpp v214, v214, v214 row_half_mirror row_mask:0xf bank_mask:0xf
    v_add_f32_dpp v215, v215, v215 row_half_mirror row_mask:0xf bank_mask:0xf
    v_lshlrev_b32 v182, 16, v172
    v_add_f32_dpp v214, v214, v214 row_mirror row_mask:0xf bank_mask:0xf
    v_add_f32_dpp v215, v215, v215 row_mirror row_mask:0xf bank_mask:0xf
    v_and_b32 v183, 0xffff0000, v172
    v_mov_b32 v216, v214
    v_mov_b32 v217, v215
    v_lshlrev_b32 v184, 16, v173
    v_permlane16_swap_b32 v214, v216
    v_permlane16_swap_b32 v215, v217
    v_add_f32 v214, v214, v216
    v_add_f32 v215, v215, v217
    v_mul_f32_e64 v214, -v214, s76
    v_mul_f32 v216, v214, v214
    v_fma_f32 v215, v215, s76, -v216
    v_max_f32 v215, 0, v215
    v_add_f32 v216, s75, v215
    v_rsq_f32 v210, v216
    v_and_b32 v185, 0xffff0000, v173
    v_mul_f32 v216, v210, v210
    v_fma_f32 v217, v216, v215, s75
    v_rsq_f32 v216, v217
    v_mul_f32 v211, v214, v210
    v_mul_f32 v212, v210, v216
    v_mul_f32 v213, v211, v216
    v_mul_f32 v217, v217, v216
    ds_write_b32 v220, v217
    v_lshlrev_b32 v186, 16, v174
    v_and_b32 v187, 0xffff0000, v174
    v_lshlrev_b32 v188, 16, v175
    v_and_b32 v189, 0xffff0000, v175
    v_lshlrev_b32 v190, 16, v176
    v_and_b32 v191, 0xffff0000, v176
    v_lshlrev_b32 v192, 16, v177
    v_and_b32 v193, 0xffff0000, v177
    v_pk_fma_f32 v[194:195], v[178:179], v[212:213], v[212:213] op_sel:[0,0,1] op_sel_hi:[1,0,1]
    v_pk_fma_f32 v[196:197], v[180:181], v[212:213], v[212:213] op_sel:[0,0,1] op_sel_hi:[1,0,1]
    v_pk_fma_f32 v[198:199], v[182:183], v[212:213], v[212:213] op_sel:[0,0,1] op_sel_hi:[1,0,1]
    v_pk_fma_f32 v[200:201], v[184:185], v[212:213], v[212:213] op_sel:[0,0,1] op_sel_hi:[1,0,1]
    v_cvt_pk_bf16_f32 v170, v194, v195
    v_cvt_pk_bf16_f32 v171, v196, v197
    v_cvt_pk_bf16_f32 v172, v198, v199
    v_cvt_pk_bf16_f32 v173, v200, v201
    ds_write_b128 v218, v[170:173] offset:0
    v_pk_fma_f32 v[202:203], v[186:187], v[212:213], v[212:213] op_sel:[0,0,1] op_sel_hi:[1,0,1]
    v_pk_fma_f32 v[204:205], v[188:189], v[212:213], v[212:213] op_sel:[0,0,1] op_sel_hi:[1,0,1]
    v_pk_fma_f32 v[206:207], v[190:191], v[212:213], v[212:213] op_sel:[0,0,1] op_sel_hi:[1,0,1]
    v_pk_fma_f32 v[208:209], v[192:193], v[212:213], v[212:213] op_sel:[0,0,1] op_sel_hi:[1,0,1]
    v_cvt_pk_bf16_f32 v174, v202, v203
    v_cvt_pk_bf16_f32 v175, v204, v205
    v_cvt_pk_bf16_f32 v176, v206, v207
    v_cvt_pk_bf16_f32 v177, v208, v209
    ds_write_b128 v218, v[174:177] offset:448
    s_waitcnt lgkmcnt(0)
    s_barrier
    ds_read_b64_tr_b16 v[98:99], v219 offset:0
    ds_read_b64_tr_b16 v[100:101], v219 offset:3840
    ds_read_b64_tr_b16 v[102:103], v219 offset:128
    ds_read_b64_tr_b16 v[104:105], v219 offset:3968
    ds_read_b32 v217, v225
    s_waitcnt lgkmcnt(3)
    buffer_store_dwordx4 v[98:101], v221, s[28:31], s70 offen sc1
    s_waitcnt lgkmcnt(1)
    buffer_store_dwordx4 v[102:105], v221, s[28:31], s71 offen sc1
    s_waitcnt lgkmcnt(0)
    buffer_store_dword v217, v226, s[28:31], s72 offen sc1
    s_mov_b32 s42, 4096
    s_mov_b32 s43, 0x20000
    s_lshl_b32 s3, s53, 2
    s_add_u32 s3, s3, s48
    s_lshl_b32 s7, s3, 5
    v_lshl_add_u32 v68, v5, 1, s7
    s_mul_i32 s3, s3, 14336
    s_lshl_b32 s6, s54, 7
    s_add_u32 s3, s3, s6
    v_mul_u32_u24 v15, 896, v5
    v_lshl_add_u32 v15, v6, 4, v15
    v_add_u32 v71, s3, v15
    v_add_u32 v72, 7168, v71
    v_lshrrev_b32 v14, 2, v1
    v_mul_u32_u24 v14, 1056, v14
    v_lshl_add_u32 v14, v8, 3, v14
    s_mul_i32 s3, s48, 224
    v_add_u32 v231, s3, v14
    s_mov_b32 s18, 401408
    s_mov_b32 s19, 0x20000
    s_mov_b32 s26, 7340032
    s_mov_b32 s27, 0x20000
    s_mov_b32 s34, 1835008
    s_mov_b32 s35, 0x20000
    v_and_b32 v2, 15, v1
    v_lshl_add_u32 v15, v9, 2, v7
    v_lshlrev_b32 v15, 7, v15
    v_lshl_add_u32 v15, v8, 3, v15
    v_and_b32 v16, 2, v7
    v_and_b32 v14, 1, v3
    v_add_u32 v16, v16, v14
    v_lshl_add_u32 v15, v16, 5, v15
    s_mul_i32 s3, s4, 8256
    v_xor_b32 v24, s3, v15
    v_xor_b32 v25, 64, v24
    v_add_u32 v26, 65536, v24
    v_add_u32 v27, 65536, v25
    v_add_u32 v28, 131072, v24
    v_add_u32 v29, 131072, v25
    s_lshl_b32 s6, s52, 1
    s_add_u32 s6, s6, s5
    s_lshl_b32 s3, s6, 5
    s_add_u32 s3, s3, s4
    s_lshl_b32 s3, s3, 12
    v_add_u32 v64, s3, v4
    v_lshrrev_b32 v15, 2, v1
    v_lshl_add_u32 v15, v15, 9, s83
    v_bfe_u32 v16, v1, 1, 1
    v_lshl_add_u32 v15, v16, 7, v15
    v_and_b32 v16, 1, v1
    v_lshl_add_u32 v20, v16, 3, v15
    s_mul_i32 s67, s6, 56
    s_lshl_b32 s3, s51, 1
    s_add_u32 s3, s3, s4
    s_add_u32 s67, s67, s3
    s_lshl_b32 s67, s67, 11
    s_add_u32 s67, s67, 2097152
    v_add_u32 v67, s58, v4
    s_lshl_b32 s68, s52, 5
    s_add_u32 s68, s68, s51
    s_lshl_b32 s68, s68, 7
    s_add_u32 s68, s68, 10551296
    s_waitcnt vmcnt(3)
    v_readfirstlane_b32 s57, v12
    s_mov_b32 s60, 0
    s_cmp_lg_u32 s57, 0
    s_cbranch_scc1 L_nonce_okh
L_nonceh:
    buffer_load_dword v12, v17, s[44:47], 0 offen sc1
    s_add_u32 s60, s60, 1
    s_waitcnt vmcnt(0)
    v_readfirstlane_b32 s57, v12
    s_cmp_ge_u32 s60, 20000
    s_cbranch_scc1 L_nonce_okh
    s_cmp_eq_u32 s57, 0
    s_cbranch_scc1 L_nonceh
L_nonce_okh:
    s_waitcnt vmcnt(0)
    s_barrier
    buffer_store_dword v12, v224, s[28:31], s74 offen sc1
    buffer_load_dwordx4 v[84:87], v71, s[8:11], 0 offen
    buffer_load_ushort v81, v68, s[40:43], 0 offen offset:0
    buffer_load_dwordx4 v[88:91], v72, s[8:11], 0 offen
    buffer_load_ushort v82, v68, s[40:43], 0 offen offset:16
    v_cmp_gt_u32 vcc, 12, v2
    s_mul_i32 s3, s48, 56
    s_add_u32 s3, s3, s79
    s_mul_i32 s3, s3, 3
    s_add_u32 s3, s3, s80
    s_lshl_b32 s3, s3, 11
    s_add_u32 s3, s3, 8388608
    s_add_u32 s3, s3, s81
    ds_read_b64_tr_b16 v[170:171], v231 offset:0
    ds_read_b64_tr_b16 v[172:173], v231 offset:16896
    ds_read_b64_tr_b16 v[174:175], v231 offset:32
    ds_read_b64_tr_b16 v[176:177], v231 offset:16928
    ds_read_b64_tr_b16 v[178:179], v231 offset:56
    ds_read_b64_tr_b16 v[180:181], v231 offset:16952
    ds_read_b64_tr_b16 v[182:183], v231 offset:88
    ds_read_b64_tr_b16 v[184:185], v231 offset:16984
    ds_read_b64_tr_b16 v[186:187], v231 offset:112
    ds_read_b64_tr_b16 v[188:189], v231 offset:17008
    ds_read_b64_tr_b16 v[190:191], v231 offset:144
    ds_read_b64_tr_b16 v[192:193], v231 offset:17040
    ds_read_b64_tr_b16 v[194:195], v231 offset:168
    ds_read_b64_tr_b16 v[196:197], v231 offset:17064
    ds_read_b64_tr_b16 v[198:199], v231 offset:200
    ds_read_b64_tr_b16 v[200:201], v231 offset:17096
    s_waitcnt lgkmcnt(13)
    v_cndmask_b32 v174, 0, v174, vcc
    v_cndmask_b32 v175, 0, v175, vcc
    s_waitcnt lgkmcnt(12)
    v_cndmask_b32 v176, 0, v176, vcc
    v_cndmask_b32 v177, 0, v177, vcc
    buffer_store_dwordx4 v[170:173], v4, s[28:31], s3 offen offset:0 sc1
    buffer_store_dwordx4 v[174:177], v4, s[28:31], s3 offen offset:1024 sc1
    s_add_u32 s3, s3, 86016
    s_waitcnt lgkmcnt(9)
    v_cndmask_b32 v182, 0, v182, vcc
    v_cndmask_b32 v183, 0, v183, vcc
    s_waitcnt lgkmcnt(8)
    v_cndmask_b32 v184, 0, v184, vcc
    v_cndmask_b32 v185, 0, v185, vcc
    buffer_store_dwordx4 v[178:181], v4, s[28:31], s3 offen offset:0 sc1
    buffer_store_dwordx4 v[182:185], v4, s[28:31], s3 offen offset:1024 sc1
    s_add_u32 s3, s3, 86016
    s_waitcnt lgkmcnt(5)
    v_cndmask_b32 v190, 0, v190, vcc
    v_cndmask_b32 v191, 0, v191, vcc
    s_waitcnt lgkmcnt(4)
    v_cndmask_b32 v192, 0, v192, vcc
    v_cndmask_b32 v193, 0, v193, vcc
    buffer_store_dwordx4 v[186:189], v4, s[28:31], s3 offen offset:0 sc1
    buffer_store_dwordx4 v[190:193], v4, s[28:31], s3 offen offset:1024 sc1
    s_add_u32 s3, s3, 86016
    s_waitcnt lgkmcnt(1)
    v_cndmask_b32 v198, 0, v198, vcc
    v_cndmask_b32 v199, 0, v199, vcc
    s_waitcnt lgkmcnt(0)
    v_cndmask_b32 v200, 0, v200, vcc
    v_cndmask_b32 v201, 0, v201, vcc
    buffer_store_dwordx4 v[194:197], v4, s[28:31], s3 offen offset:0 sc1
    buffer_store_dwordx4 v[198:201], v4, s[28:31], s3 offen offset:1024 sc1
    s_add_u32 s3, s3, 86016
    s_lshl_b32 s67, s79, 5
    s_add_u32 s67, s67, s80
    s_lshl_b32 s67, s67, 2
    s_add_u32 s67, s67, 10747904
    s_add_u32 s67, s67, s81
    s_mov_b32 s68, 268435456
    v_add_u32 v39, 65536, v4
    v_add_u32 v40, 131072, v4
    s_mul_i32 s59, s48, 3072
    s_mul_i32 s3, s50, 86016
    s_add_u32 s3, s3, s59
    s_add_u32 s3, s3, 8388608
    v_add_u32 v66, s3, v4
    v_lshlrev_b32 v15, 7, v9
    v_xor_b32 v15, v15, v4
    s_lshl_b32 s3, s49, 11
    v_add_u32 v53, s3, v15
    v_add_u32 v54, 129024, v53
    s_lshr_b32 s3, s49, 2
    s_lshl_b32 s3, s3, 3
    s_max_u32 s3, s3, 1
    s_sub_u32 s3, s3, 1
    s_lshl_b32 s3, s3, 10
    s_lshl_b32 s6, s5, 17
    s_add_u32 s3, s3, s6
    s_lshl_b32 s6, s4, 28
    s_add_u32 s3, s3, s6
    v_add_u32 v55, s3, v15
    s_lshl_b32 s100, s5, 1
    s_add_u32 s100, s100, s4
    s_lshl_b32 s100, s100, 10
    v_and_b32 v15, 1, v1
    v_mul_u32_u24 v15, 640, v15
    v_lshrrev_b32 v16, 2, v1
    v_lshlrev_b32 v16, 4, v16
    v_xor_b32 v15, v15, v16
    v_bfe_u32 v16, v1, 1, 1
    v_lshl_add_u32 v15, v16, 3, v15
    s_add_u32 s3, s58, 12288
    v_add_u32 v56, s3, v15
    s_sub_u32 s3, s3, 3072
    s_cmp_eq_u32 s48, 0
    s_cselect_b32 s3, 28672, s3
    v_add_u32 v57, s3, v15
    v_add_u32 v58, 65536, v56
    v_add_u32 v59, 65536, v57
    v_add_u32 v60, 131072, v56
    v_add_u32 v61, 131072, v57
    s_lshl_b32 s3, s49, 1
    v_min_u32 v15, 2, v3
    v_add_u32 v15, s3, v15
    v_max_u32 v15, 1, v15
    v_lshlrev_b32 v15, 1, v15
    v_and_b32 v16, 1, v7
    v_add_lshl_u32 v15, v15, v16, 7
    v_lshrrev_b32 v16, 1, v7
    v_lshl_add_u32 v16, v16, 2, v8
    v_lshl_add_u32 v15, v16, 2, v15
    v_add_u32 v63, 6291200, v15
    v_min_u32 v15, 2, v8
    v_lshlrev_b32 v15, 2, v15
    v_add_u32 v15, 10747904, v15
    v_lshrrev_b32 v16, 2, v1
    v_min_u32 v16, 13, v16
    v_lshl_add_u32 v21, v16, 7, v15
    s_lshl_b32 s82, s49, 5
    s_add_u32 s82, s82, s50
    s_lshl_b32 s82, s82, 10
    s_add_u32 s82, s82, 4194304
    s_lshr_b32 s69, s49, 2
    s_lshl_b32 s69, s69, 4
    s_add_u32 s69, s69, s50
    s_lshl_b32 s69, s69, 7
    s_add_u32 s69, s69, 10616832
    s_lshl_b32 s3, s48, 17
    s_lshl_b32 s6, s53, 7
    s_add_u32 s3, s3, s6
    v_lshlrev_b32 v15, 12, v5
    v_add3_u32 v45, v15, v69, s3
    v_add_u32 v46, 31744, v45
    v_add_u32 v47, 63488, v45
    v_add_u32 v48, 95232, v45
    v_mul_u32_u24 v15, 896, v5
    s_mul_i32 s3, s4, 25088
    s_mul_i32 s6, s5, 14336
    s_add_u32 s3, s3, s6
    s_lshl_b32 s6, s54, 7
    s_add_u32 s3, s3, s6
    v_add3_u32 v49, v15, v69, s3
    v_add_u32 v50, 6144, v49
    s_lshl_b32 s6, s53, 1
    s_add_u32 s6, s6, s5
    s_lshr_b32 s3, s53, 1
    s_lshl_b32 s3, s3, 4
    s_add_u32 s3, s3, s4
    s_lshl_b32 s3, s3, 7
    s_add_u32 s3, s3, 10616832
    v_lshl_add_u32 v23, v5, 8, s3
    s_lshl_b32 s3, s6, 5
    s_add_u32 s3, s3, s4
    s_lshl_b32 s3, s3, 10
    s_add_u32 s3, s3, 4192256
    v_add_u32 v51, s3, v4
    v_add_u32 v52, 15360, v51
    s_xor_b32 s3, s4, s5
    s_lshl_b32 s3, s3, 6
    v_xor_b32 v30, s3, v24
    v_add_u32 v31, 65536, v30
    v_add_u32 v32, 131072, v30
    v_lshlrev_b32 v14, 10, v14
    v_lshl_add_u32 v14, v9, 8, v14
    v_lshl_add_u32 v14, v2, 4, v14
    s_mul_i32 s3, s4, 12288
    s_add_u32 s3, s3, 2048
    v_add_u32 v33, s3, v14
    v_xor_b32 v34, 4096, v33
    v_add_u32 v35, 65536, v33
    v_add_u32 v36, 65536, v34
    v_add_u32 v37, 131072, v33
    v_add_u32 v38, 131072, v34
    s_lshl_b32 s6, s54, 1
    s_add_u32 s6, s6, s5
    s_mul_i32 s3, s6, 28
    s_add_u32 s3, s3, s4
    s_lshl_b32 s3, s3, 12
    s_add_u32 s3, s3, 2097152
    v_add_u32 v65, s3, v4
    s_lshl_b32 s3, s54, 5
    s_add_u32 s3, s3, s4
    s_lshl_b32 s3, s3, 7
    s_add_u32 s3, s3, 10551296
    v_lshrrev_b32 v15, 2, v1
    v_min_u32 v15, 13, v15
    v_lshl_add_u32 v22, v15, 8, s3
    s_and_b32 s3, s2, 7
    s_mul_i32 s3, s3, 7
    s_lshr_b32 s3, s3, 2
    s_mul_i32 s6, s54, 2
    s_add_u32 s3, s3, s6
    s_mul_i32 s6, s3, 37
    s_lshr_b32 s6, s6, 9
    s_mul_i32 s6, s6, 14
    s_sub_u32 s3, s3, s6
    s_lshl_b32 s64, s3, 19
    s_lshl_b32 s65, s3, 13
    s_lshl_b32 s3, s5, 3
    v_add_u32 v14, s3, v9
    v_xor_b32 v14, v14, v6
    v_lshlrev_b32 v14, 4, v14
    v_lshl_add_u32 v14, v10, 8, v14
    s_lshl_b32 s3, s4, 14
    s_add_u32 s3, s3, 32768
    v_add_u32 v73, s3, v14
    v_xor_b32 v74, 32, v73
    v_xor_b32 v75, 64, v73
    v_xor_b32 v76, 96, v73
    s_mul_i32 s3, s53, 2
    s_mul_i32 s6, s54, 1
    s_add_u32 s3, s3, s6
    s_add_u32 s66, s3, 7
    v_lshlrev_b32 v14, 1, v6
    v_xor_b32 v14, v14, v5
    v_lshlrev_b32 v14, 4, v14
    v_lshl_add_u32 v14, v5, 8, v14
    s_add_u32 s3, s58, 32768
    v_add_u32 v77, s3, v14
    v_xor_b32 v78, 16, v77
    v_xor_b32 v79, 24576, v77
    v_xor_b32 v80, 24592, v77
    s_mov_b32 s70, 0xaaaaaaaa
    s_mov_b32 s71, 0xaaaaaaaa
    s_mov_b32 s72, 0xfff0ffff
    s_mov_b32 s73, 0xf000ff00
    s_mov_b32 s74, 0xffc0fffc
    s_mov_b32 s75, 0xc000fc00
    s_cmp_eq_u32 s49, 0
    s_cselect_b64 s[76:77], 0, -1
    v_mov_b32 v14, 0xffff
    v_mov_b32 v15, 0xffff0000
    v_cndmask_b32 v14, v14, v15, s[70:71]
    v_cndmask_b32 v92, v14, 0, s[72:73]
    v_cndmask_b32 v94, 0, v14, s[72:73]
    v_cndmask_b32 v93, v14, 0, s[74:75]
    v_cndmask_b32 v95, 0, v14, s[74:75]
    v_mov_b32 v70, 0xf149f2ca
    s_mov_b32 s83, 0x3e8b97f6
    s_mov_b32 s78, 0xbdd2d3e8
    s_mov_b32 s79, 0xbdd2d3e8
    s_mov_b32 s80, 1.0
    s_mov_b32 s81, 1.0
    v_mov_b32 v96, 0xc0135761
    v_mov_b32 v97, 0xc0135761
    s_waitcnt vmcnt(0)
    s_barrier
    buffer_store_dword v12, v13, s[28:31], s67 offen sc1
    buffer_load_dwordx2 v[18:19], v20, s[28:31], 0 offen sc1
    s_cmp_eq_u32 s56, 0
    s_cselect_b32 s26, 0, s26
    v_sub_u32 v14, v64, v4
    v_lshl_add_u32 v14, v10, 7, v14
    s_add_u32 s3, s1, 8192
    v_lshl_add_u32 v15, v9, 13, s3
    s_waitcnt vmcnt(0)
    v_xor_b32 v18, s57, v18
    v_xor_b32 v19, s57, v19
    v_or_b32 v18, v18, v19
    v_cmp_ne_u32 vcc, 0, v18
    s_cbranch_vccz L_pollok2
    s_mov_b32 s60, 0
L_poll2:
    s_sleep 8
    buffer_load_dwordx2 v[18:19], v20, s[28:31], 0 offen sc1
    s_add_u32 s60, s60, 1
    s_waitcnt vmcnt(0)
    v_xor_b32 v18, s57, v18
    v_xor_b32 v19, s57, v19
    v_or_b32 v18, v18, v19
    v_cmp_ne_u32 vcc, 0, v18
    s_cbranch_vccz L_pollok2
    s_cmp_lt_u32 s60, 20000
    s_cbranch_scc1 L_poll2
L_pollok2:
    v_and_b32 v15, 0x1ffff, v15
    v_add_u32 v16, v14, v15
    v_add_u32 v15, 16384, v15
    buffer_load_dword v210, v16, s[28:31], 0 offen sc1
    v_and_b32 v15, 0x1ffff, v15
    v_add_u32 v16, v14, v15
    v_add_u32 v15, 16384, v15
    buffer_load_dword v211, v16, s[28:31], 0 offen sc1
    v_and_b32 v15, 0x1ffff, v15
    v_add_u32 v16, v14, v15
    v_add_u32 v15, 16384, v15
    buffer_load_dword v212, v16, s[28:31], 0 offen sc1
    v_and_b32 v15, 0x1ffff, v15
    v_add_u32 v16, v14, v15
    v_add_u32 v15, 16384, v15
    buffer_load_dword v213, v16, s[28:31], 0 offen sc1
    v_and_b32 v15, 0x1ffff, v15
    v_add_u32 v16, v14, v15
    v_add_u32 v15, 16384, v15
    buffer_load_dword v214, v16, s[28:31], 0 offen sc1
    v_and_b32 v15, 0x1ffff, v15
    v_add_u32 v16, v14, v15
    v_add_u32 v15, 16384, v15
    buffer_load_dword v215, v16, s[28:31], 0 offen sc1
    v_and_b32 v15, 0x1ffff, v15
    v_add_u32 v16, v14, v15
    v_add_u32 v15, 16384, v15
    buffer_load_dword v216, v16, s[28:31], 0 offen sc1
    v_and_b32 v15, 0x1ffff, v15
    v_add_u32 v16, v14, v15
    v_add_u32 v15, 16384, v15
    buffer_load_dword v217, v16, s[28:31], 0 offen sc1
    buffer_load_dword v18, v21, s[28:31], 0 offen sc1
    s_waitcnt vmcnt(0)
    v_cmp_ne_u32 vcc, s57, v18
    s_cbranch_vccz L_pollok3
    s_mov_b32 s60, 0
L_poll3:
    s_sleep 32
    buffer_load_dword v18, v21, s[28:31], 0 offen sc1
    s_add_u32 s60, s60, 1
    s_waitcnt vmcnt(0)
    v_cmp_ne_u32 vcc, s57, v18
    s_cbranch_vccz L_pollok3
    s_cmp_lt_u32 s60, 20000
    s_cbranch_scc1 L_poll3
L_pollok3:
    s_barrier
    s_max_u32 s3, s101, 25
    s_sub_u32 s3, s3, 25
    s_lshl_b32 s3, s3, 2
    s_add_u32 s7, s3, s48
    v_lshlrev_b32 v14, 7, v1
    s_and_b32 s3, s50, 8
    s_mul_i32 s3, s3, 86016
    s_mul_i32 s7, s7, 3072
    s_add_u32 s3, s3, s7
    s_add_u32 s3, s3, 8388608
    v_min_u32 v14, 2944, v14
    buffer_load_dword v172, v14, s[28:31], s3 offen sc1
    buffer_load_dword v62, v63, s[28:31], 0 offen sc1
    s_add_u32 m0, s59, 98304
    s_nop 0
    buffer_load_dwordx4 v66, s[28:31], s63 offen sc1 lds
    buffer_load_dwordx4 v66, s[28:31], s63 offen offset:1024 sc1 lds
    buffer_load_dwordx4 v66, s[28:31], s63 offen offset:2048 sc1 lds
    s_add_u32 m0, s100, 126976
    s_nop 0
    buffer_load_dwordx4 v55, s[28:31], s62 offen sc1 lds
    s_add_u32 m0, s58, 110592
    s_nop 0
    buffer_load_dwordx4 v53, s[28:31], s62 offen sc1 lds
    buffer_load_dwordx4 v53, s[28:31], s62 offen offset:1024 sc1 lds
    buffer_load_dwordx4 v54, s[28:31], s62 offen offset:2048 sc1 lds
    buffer_load_dwordx4 v54, s[28:31], s62 offen offset:3072 sc1 lds
    s_add_u32 m0, s59, 131072
    s_add_u32 s63, s63, 12288
    s_cmp_eq_u32 s63, 86016
    s_cselect_b32 s63, 0, s63
    buffer_load_dwordx4 v66, s[28:31], s63 offen sc1 lds
    buffer_load_dwordx4 v66, s[28:31], s63 offen offset:1024 sc1 lds
    buffer_load_dwordx4 v66, s[28:31], s63 offen offset:2048 sc1 lds
    s_add_u32 m0, s100, 159744
    s_add_u32 s62, s62, 262144
    s_cmp_eq_u32 s62, 1835008
    s_cselect_b32 s62, 0, s62
    buffer_load_dwordx4 v55, s[28:31], s62 offen sc1 lds
    s_add_u32 m0, s58, 143360
    s_nop 0
    buffer_load_dwordx4 v53, s[28:31], s62 offen sc1 lds
    buffer_load_dwordx4 v53, s[28:31], s62 offen offset:1024 sc1 lds
    buffer_load_dwordx4 v54, s[28:31], s62 offen offset:2048 sc1 lds
    buffer_load_dwordx4 v54, s[28:31], s62 offen offset:3072 sc1 lds
    s_add_u32 m0, s59, 0
    s_add_u32 s63, s63, 12288
    s_cmp_eq_u32 s63, 86016
    s_cselect_b32 s63, 0, s63
    buffer_load_dwordx4 v66, s[28:31], s63 offen sc1 lds
    buffer_load_dwordx4 v66, s[28:31], s63 offen offset:1024 sc1 lds
    buffer_load_dwordx4 v66, s[28:31], s63 offen offset:2048 sc1 lds
    s_add_u32 m0, s100, 28672
    s_add_u32 s62, s62, 262144
    s_cmp_eq_u32 s62, 1835008
    s_cselect_b32 s62, 0, s62
    buffer_load_dwordx4 v55, s[28:31], s62 offen sc1 lds
    s_add_u32 m0, s58, 12288
    s_nop 0
    buffer_load_dwordx4 v53, s[28:31], s62 offen sc1 lds
    buffer_load_dwordx4 v53, s[28:31], s62 offen offset:1024 sc1 lds
    buffer_load_dwordx4 v54, s[28:31], s62 offen offset:2048 sc1 lds
    buffer_load_dwordx4 v54, s[28:31], s62 offen offset:3072 sc1 lds
    s_waitcnt vmcnt(0) lgkmcnt(0)
    s_nop 3
L_q:
    s_waitcnt vmcnt(18)
    s_barrier
    ds_read_b64_tr_b16 a[236:237], v58 offset:32768
    s_add_u32 m0, s59, 32768
    s_add_u32 s63, s63, 12288
    s_cmp_eq_u32 s63, 86016
    s_cselect_b32 s63, 0, s63
    buffer_load_dwordx4 v66, s[28:31], s63 offen sc1 lds
    ds_read_b64_tr_b16 a[238:239], v58 offset:33024
    ds_read_b64_tr_b16 a[240:241], v58 offset:33792
    ds_read_b64_tr_b16 a[242:243], v58 offset:34048
    ds_read_b128 v[106:109], v39 offset:32768
    ds_read_b128 v[110:113], v39 offset:33792
    ds_read_b64_tr_b16 a[232:233], v59 offset:32768
    ds_read_b64_tr_b16 a[234:235], v59 offset:33024
    ds_read_b128 v[114:117], v39 offset:34816
    ds_read_b128 v[118:121], v39 offset:35840
    s_waitcnt lgkmcnt(4)
    v_mfma_f32_16x16x32_bf16 v[170:173], v[106:109], a[236:239], 0
    ds_read_b128 v[122:125], v39 offset:36864
    v_mfma_f32_16x16x32_bf16 v[178:181], v[106:109], a[240:243], 0
    buffer_load_dwordx4 v66, s[28:31], s63 offen offset:1024 sc1 lds
    v_mfma_f32_16x16x32_bf16 v[174:177], v[110:113], a[236:239], 0
    ds_read_b128 v[126:129], v39 offset:37888
    v_mfma_f32_16x16x32_bf16 v[182:185], v[110:113], a[240:243], 0
    s_waitcnt lgkmcnt(2)
    v_mfma_f32_16x16x32_bf16 v[194:197], v[114:117], a[236:239], 0
    ds_read_b64_tr_b16 a[248:249], v58 offset:34816
    ds_read_b64_tr_b16 a[250:251], v58 offset:35072
    ds_read_b64_tr_b16 a[252:253], v58 offset:35840
    ds_read_b64_tr_b16 a[254:255], v58 offset:36096
    ds_read_b128 v[130:133], v39 offset:38912
    v_mfma_f32_16x16x32_bf16 v[202:205], v[114:117], a[240:243], 0
    buffer_load_dwordx4 v66, s[28:31], s63 offen offset:2048 sc1 lds
    v_mfma_f32_16x16x32_bf16 v[186:189], v[114:117], a[232:235], 0
    v_mfma_f32_16x16x32_bf16 v[198:201], v[118:121], a[236:239], 0
    ds_read_b128 v[134:137], v39 offset:39936
    v_mfma_f32_16x16x32_bf16 v[206:209], v[118:121], a[240:243], 0
    v_mfma_f32_16x16x32_bf16 v[190:193], v[118:121], a[232:235], 0
    s_add_u32 m0, s100, 61440
    s_add_u32 s62, s62, 262144
    s_cmp_eq_u32 s62, 1835008
    s_cselect_b32 s62, 0, s62
    buffer_load_dwordx4 v55, s[28:31], s62 offen sc1 lds
    s_waitcnt lgkmcnt(6)
    v_mfma_f32_16x16x32_bf16 v[218:221], a[236:239], v[122:125], 0
    ds_read_b64_tr_b16 a[244:245], v59 offset:34816
    ds_read_b64_tr_b16 a[246:247], v59 offset:35072
    ds_read_b128 v[106:109], v39 offset:40960
    v_mfma_f32_16x16x32_bf16 v[226:229], a[240:243], v[122:125], 0
    v_mfma_f32_16x16x32_bf16 v[210:213], a[232:235], v[122:125], 0
    v_mfma_f32_16x16x32_bf16 v[222:225], a[236:239], v[126:129], 0
    s_add_u32 m0, s58, 45056
    s_nop 0
    buffer_load_dwordx4 v53, s[28:31], s62 offen sc1 lds
    ds_read_b128 v[110:113], v39 offset:41984
    v_mfma_f32_16x16x32_bf16 v[230:233], a[240:243], v[126:129], 0
    v_mfma_f32_16x16x32_bf16 v[214:217], a[232:235], v[126:129], 0
    s_waitcnt lgkmcnt(4)
    v_mfma_f32_16x16x32_bf16 v[170:173], v[130:133], a[248:251], v[170:173]
    buffer_load_dwordx4 v53, s[28:31], s62 offen offset:1024 sc1 lds
    ds_read_b128 v[114:117], v39 offset:43008
    v_mfma_f32_16x16x32_bf16 v[178:181], v[130:133], a[252:255], v[178:181]
    v_mfma_f32_16x16x32_bf16 v[174:177], v[134:137], a[248:251], v[174:177]
    ds_read_b128 v[118:121], v39 offset:44032
    v_mfma_f32_16x16x32_bf16 v[182:185], v[134:137], a[252:255], v[182:185]
    s_waitcnt lgkmcnt(2)
    v_mfma_f32_16x16x32_bf16 v[194:197], v[106:109], a[248:251], v[194:197]
    buffer_load_dwordx4 v54, s[28:31], s62 offen offset:2048 sc1 lds
    s_waitcnt vmcnt(17)
    s_barrier
    ds_read_b64_tr_b16 a[236:237], v60 offset:0
    ds_read_b64_tr_b16 a[238:239], v60 offset:256
    ds_read_b64_tr_b16 a[240:241], v60 offset:1024
    ds_read_b64_tr_b16 a[242:243], v60 offset:1280
    ds_read_b128 v[122:125], v40 offset:0
    v_mfma_f32_16x16x32_bf16 v[202:205], v[106:109], a[252:255], v[202:205]
    v_mfma_f32_16x16x32_bf16 v[186:189], v[106:109], a[244:247], v[186:189]
    v_mfma_f32_16x16x32_bf16 v[198:201], v[110:113], a[248:251], v[198:201]
    ds_read_b128 v[126:129], v40 offset:1024
    v_mfma_f32_16x16x32_bf16 v[206:209], v[110:113], a[252:255], v[206:209]
    buffer_load_dwordx4 v54, s[28:31], s62 offen offset:3072 sc1 lds
    v_mfma_f32_16x16x32_bf16 v[190:193], v[110:113], a[244:247], v[190:193]
    s_waitcnt lgkmcnt(6)
    v_mfma_f32_16x16x32_bf16 v[218:221], a[248:251], v[114:117], v[218:221]
    ds_read_b64_tr_b16 a[232:233], v61 offset:0
    ds_read_b64_tr_b16 a[234:235], v61 offset:256
    ds_read_b128 v[130:133], v40 offset:2048
    v_mfma_f32_16x16x32_bf16 v[226:229], a[252:255], v[114:117], v[226:229]
    s_add_u32 m0, s59, 65536
    s_add_u32 s63, s63, 12288
    s_cmp_eq_u32 s63, 86016
    s_cselect_b32 s63, 0, s63
    buffer_load_dwordx4 v66, s[28:31], s63 offen sc1 lds
    v_mfma_f32_16x16x32_bf16 v[210:213], a[244:247], v[114:117], v[210:213]
    v_mfma_f32_16x16x32_bf16 v[222:225], a[248:251], v[118:121], v[222:225]
    ds_read_b128 v[134:137], v40 offset:3072
    v_mfma_f32_16x16x32_bf16 v[230:233], a[252:255], v[118:121], v[230:233]
    v_mfma_f32_16x16x32_bf16 v[214:217], a[244:247], v[118:121], v[214:217]
    buffer_load_dwordx4 v66, s[28:31], s63 offen offset:1024 sc1 lds
    s_waitcnt lgkmcnt(4)
    v_mfma_f32_16x16x32_bf16 v[170:173], v[122:125], a[236:239], v[170:173]
    ds_read_b128 v[106:109], v40 offset:4096
    v_mfma_f32_16x16x32_bf16 v[178:181], v[122:125], a[240:243], v[178:181]
    v_lshlrev_b32 v14, 2, v2
    v_mfma_f32_16x16x32_bf16 v[174:177], v[126:129], a[236:239], v[174:177]
    ds_read_b128 v[110:113], v40 offset:5120
    v_mfma_f32_16x16x32_bf16 v[182:185], v[126:129], a[240:243], v[182:185]
    buffer_load_dwordx4 v66, s[28:31], s63 offen offset:2048 sc1 lds
    v_and_b32 v15, 1, v1
    s_waitcnt lgkmcnt(2)
    v_mfma_f32_16x16x32_bf16 v[194:197], v[130:133], a[236:239], v[194:197]
    ds_read_b64_tr_b16 a[248:249], v60 offset:2048
    ds_read_b64_tr_b16 a[250:251], v60 offset:2304
    ds_read_b64_tr_b16 a[252:253], v60 offset:3072
    ds_read_b64_tr_b16 a[254:255], v60 offset:3328
    ds_read_b128 v[114:117], v40 offset:6144
    v_mfma_f32_16x16x32_bf16 v[202:205], v[130:133], a[240:243], v[202:205]
    v_mfma_f32_16x16x32_bf16 v[186:189], v[130:133], a[232:235], v[186:189]
    s_add_u32 m0, s100, 94208
    s_add_u32 s62, s62, 262144
    s_cmp_eq_u32 s62, 1835008
    s_cselect_b32 s62, 0, s62
    buffer_load_dwordx4 v55, s[28:31], s62 offen sc1 lds
    v_lshl_add_u32 v15, v3, 2, v15
    v_mfma_f32_16x16x32_bf16 v[198:201], v[134:137], a[236:239], v[198:201]
    ds_read_b128 v[118:121], v40 offset:7168
    v_mfma_f32_16x16x32_bf16 v[206:209], v[134:137], a[240:243], v[206:209]
    v_mfma_f32_16x16x32_bf16 v[190:193], v[134:137], a[232:235], v[190:193]
    v_lshlrev_b32 v15, 2, v15
    s_add_u32 m0, s58, 77824
    s_nop 0
    buffer_load_dwordx4 v53, s[28:31], s62 offen sc1 lds
    s_waitcnt lgkmcnt(6)
    v_mfma_f32_16x16x32_bf16 v[218:221], a[236:239], v[106:109], v[218:221]
    ds_read_b64_tr_b16 a[244:245], v61 offset:2048
    ds_read_b64_tr_b16 a[246:247], v61 offset:2304
    ds_read_b128 v[122:125], v40 offset:8192
    v_mfma_f32_16x16x32_bf16 v[226:229], a[240:243], v[106:109], v[226:229]
    v_mfma_f32_16x16x32_bf16 v[210:213], a[232:235], v[106:109], v[210:213]
    v_add_u32 v16, 64, v15
    v_mfma_f32_16x16x32_bf16 v[222:225], a[236:239], v[110:113], v[222:225]
    buffer_load_dwordx4 v53, s[28:31], s62 offen offset:1024 sc1 lds
    ds_read_b128 v[126:129], v40 offset:9216
    v_mfma_f32_16x16x32_bf16 v[230:233], a[240:243], v[110:113], v[230:233]
    v_mfma_f32_16x16x32_bf16 v[214:217], a[232:235], v[110:113], v[214:217]
    v_cndmask_b32 v17, v15, v16, s[72:73]
    s_waitcnt lgkmcnt(4)
    v_mfma_f32_16x16x32_bf16 v[170:173], v[114:117], a[248:251], v[170:173]
    buffer_load_dwordx4 v54, s[28:31], s62 offen offset:2048 sc1 lds
    ds_read_b128 v[130:133], v40 offset:10240
    v_mfma_f32_16x16x32_bf16 v[178:181], v[114:117], a[252:255], v[178:181]
    v_cndmask_b32 v15, v15, v16, s[74:75]
    v_mfma_f32_16x16x32_bf16 v[174:177], v[118:121], a[248:251], v[174:177]
    ds_read_b128 v[134:137], v40 offset:11264
    v_mfma_f32_16x16x32_bf16 v[182:185], v[118:121], a[252:255], v[182:185]
    ds_bpermute_b32 v242, v14, v62 offset:64
    s_waitcnt lgkmcnt(3)
    v_mfma_f32_16x16x32_bf16 v[194:197], v[122:125], a[248:251], v[194:197]
    buffer_load_dwordx4 v54, s[28:31], s62 offen offset:3072 sc1 lds
    s_waitcnt vmcnt(16)
    s_barrier
    buffer_store_dword v12, v13, s[28:31], s68 offen sc1
    ds_read_b64_tr_b16 a[236:237], v56 offset:0
    ds_read_b64_tr_b16 a[238:239], v56 offset:256
    ds_read_b64_tr_b16 a[240:241], v56 offset:1024
    ds_read_b64_tr_b16 a[242:243], v56 offset:1280
    ds_read_b128 v[106:109], v4 offset:0
    v_mfma_f32_16x16x32_bf16 v[202:205], v[122:125], a[252:255], v[202:205]
    v_mfma_f32_16x16x32_bf16 v[186:189], v[122:125], a[244:247], v[186:189]
    ds_bpermute_b32 v166, v17, v62 offset:0
    v_mfma_f32_16x16x32_bf16 v[198:201], v[126:129], a[248:251], v[198:201]
    s_add_u32 m0, s59, 98304
    s_add_u32 s63, s63, 12288
    s_cmp_eq_u32 s63, 86016
    s_cselect_b32 s63, 0, s63
    buffer_load_dwordx4 v66, s[28:31], s63 offen sc1 lds
    ds_read_b128 v[110:113], v4 offset:1024
    v_mfma_f32_16x16x32_bf16 v[206:209], v[126:129], a[252:255], v[206:209]
    v_mfma_f32_16x16x32_bf16 v[190:193], v[126:129], a[244:247], v[190:193]
    ds_bpermute_b32 v167, v15, v62 offset:8
    s_waitcnt lgkmcnt(9)
    v_mfma_f32_16x16x32_bf16 v[218:221], a[248:251], v[130:133], v[218:221]
    ds_read_b64_tr_b16 a[232:233], v57 offset:0
    ds_read_b64_tr_b16 a[234:235], v57 offset:256
    ds_read_b128 v[114:117], v4 offset:2048
    v_mfma_f32_16x16x32_bf16 v[226:229], a[252:255], v[130:133], v[226:229]
    buffer_load_dwordx4 v66, s[28:31], s63 offen offset:1024 sc1 lds
    v_mfma_f32_16x16x32_bf16 v[210:213], a[244:247], v[130:133], v[210:213]
    ds_bpermute_b32 v243, v14, v62 offset:128
    v_mfma_f32_16x16x32_bf16 v[222:225], a[248:251], v[134:137], v[222:225]
    ds_read_b128 v[118:121], v4 offset:3072
    v_mfma_f32_16x16x32_bf16 v[230:233], a[252:255], v[134:137], v[230:233]
    v_mfma_f32_16x16x32_bf16 v[214:217], a[244:247], v[134:137], v[214:217]
    buffer_load_dwordx4 v66, s[28:31], s63 offen offset:2048 sc1 lds
    ds_bpermute_b32 v168, v17, v62 offset:64
    s_waitcnt lgkmcnt(7)
    v_mfma_f32_16x16x32_bf16 v[170:173], v[106:109], a[236:239], v[170:173]
    ds_read_b128 v[122:125], v4 offset:4096
    v_mfma_f32_16x16x32_bf16 v[178:181], v[106:109], a[240:243], v[178:181]
    ds_bpermute_b32 v169, v15, v62 offset:72
    v_mfma_f32_16x16x32_bf16 v[174:177], v[110:113], a[236:239], v[174:177]
    s_add_u32 m0, s100, 126976
    s_add_u32 s62, s62, 262144
    s_cmp_eq_u32 s62, 1835008
    s_cselect_b32 s62, 0, s62
    buffer_load_dwordx4 v55, s[28:31], s62 offen sc1 lds
    ds_read_b128 v[126:129], v4 offset:5120
    v_mfma_f32_16x16x32_bf16 v[182:185], v[110:113], a[240:243], v[182:185]
    s_waitcnt lgkmcnt(4)
    v_mfma_f32_16x16x32_bf16 v[194:197], v[114:117], a[236:239], v[194:197]
    ds_read_b64_tr_b16 a[248:249], v56 offset:2048
    ds_read_b64_tr_b16 a[250:251], v56 offset:2304
    ds_read_b64_tr_b16 a[252:253], v56 offset:3072
    ds_read_b64_tr_b16 a[254:255], v56 offset:3328
    ds_read_b128 v[130:133], v4 offset:6144
    v_mfma_f32_16x16x32_bf16 v[202:205], v[114:117], a[240:243], v[202:205]
    v_mfma_f32_16x16x32_bf16 v[186:189], v[114:117], a[232:235], v[186:189]
    s_add_u32 m0, s58, 110592
    s_nop 0
    buffer_load_dwordx4 v53, s[28:31], s62 offen sc1 lds
    v_mfma_f32_16x16x32_bf16 v[198:201], v[118:121], a[236:239], v[198:201]
    ds_read_b128 v[134:137], v4 offset:7168
    v_mfma_f32_16x16x32_bf16 v[206:209], v[118:121], a[240:243], v[206:209]
    v_mfma_f32_16x16x32_bf16 v[190:193], v[118:121], a[232:235], v[190:193]
    s_waitcnt lgkmcnt(6)
    v_mfma_f32_16x16x32_bf16 v[218:221], a[236:239], v[122:125], v[218:221]
    buffer_load_dwordx4 v53, s[28:31], s62 offen offset:1024 sc1 lds
    ds_read_b64_tr_b16 a[244:245], v57 offset:2048
    ds_read_b64_tr_b16 a[246:247], v57 offset:2304
    ds_read_b128 v[106:109], v4 offset:8192
    v_mfma_f32_16x16x32_bf16 v[226:229], a[240:243], v[122:125], v[226:229]
    v_mfma_f32_16x16x32_bf16 v[210:213], a[232:235], v[122:125], v[210:213]
    v_mfma_f32_16x16x32_bf16 v[222:225], a[236:239], v[126:129], v[222:225]
    ds_read_b128 v[110:113], v4 offset:9216
    v_mfma_f32_16x16x32_bf16 v[230:233], a[240:243], v[126:129], v[230:233]
    buffer_load_dwordx4 v54, s[28:31], s62 offen offset:2048 sc1 lds
    v_mfma_f32_16x16x32_bf16 v[214:217], a[232:235], v[126:129], v[214:217]
    s_waitcnt lgkmcnt(4)
    v_mfma_f32_16x16x32_bf16 v[170:173], v[130:133], a[248:251], v[170:173]
    ds_read_b128 v[114:117], v4 offset:10240
    v_mfma_f32_16x16x32_bf16 v[178:181], v[130:133], a[252:255], v[178:181]
    buffer_load_dwordx4 v54, s[28:31], s62 offen offset:3072 sc1 lds
    v_mfma_f32_16x16x32_bf16 v[174:177], v[134:137], a[248:251], v[174:177]
    ds_read_b128 v[118:121], v4 offset:11264
    v_mfma_f32_16x16x32_bf16 v[182:185], v[134:137], a[252:255], v[182:185]
    v_mul_f32 v242, s83, v242
    s_waitcnt lgkmcnt(2)
    v_mfma_f32_16x16x32_bf16 v[194:197], v[106:109], a[248:251], v[194:197]
    s_waitcnt vmcnt(17)
    s_barrier
    ds_read_b64_tr_b16 a[236:237], v56 offset:32768
    ds_read_b64_tr_b16 a[238:239], v56 offset:33024
    ds_read_b64_tr_b16 a[240:241], v56 offset:33792
    ds_read_b64_tr_b16 a[242:243], v56 offset:34048
    ds_read_b128 v[122:125], v4 offset:32768
    v_mfma_f32_16x16x32_bf16 v[202:205], v[106:109], a[252:255], v[202:205]
    s_add_u32 m0, s59, 131072
    s_add_u32 s63, s63, 12288
    s_cmp_eq_u32 s63, 86016
    s_cselect_b32 s63, 0, s63
    buffer_load_dwordx4 v66, s[28:31], s63 offen sc1 lds
    v_mfma_f32_16x16x32_bf16 v[186:189], v[106:109], a[244:247], v[186:189]
    v_mul_f32 v243, s83, v243
    v_mfma_f32_16x16x32_bf16 v[198:201], v[110:113], a[248:251], v[198:201]
    ds_read_b128 v[126:129], v4 offset:33792
    v_mfma_f32_16x16x32_bf16 v[206:209], v[110:113], a[252:255], v[206:209]
    buffer_load_dwordx4 v66, s[28:31], s63 offen offset:1024 sc1 lds
    v_mfma_f32_16x16x32_bf16 v[190:193], v[110:113], a[244:247], v[190:193]
    s_waitcnt lgkmcnt(6)
    v_mfma_f32_16x16x32_bf16 v[218:221], a[248:251], v[114:117], v[218:221]
    ds_read_b64_tr_b16 a[232:233], v57 offset:32768
    ds_read_b64_tr_b16 a[234:235], v57 offset:33024
    ds_read_b128 v[130:133], v4 offset:34816
    v_mfma_f32_16x16x32_bf16 v[226:229], a[252:255], v[114:117], v[226:229]
    v_mfma_f32_16x16x32_bf16 v[210:213], a[244:247], v[114:117], v[210:213]
    buffer_load_dwordx4 v66, s[28:31], s63 offen offset:2048 sc1 lds
    v_mfma_f32_16x16x32_bf16 v[222:225], a[248:251], v[118:121], v[222:225]
    ds_read_b128 v[134:137], v4 offset:35840
    v_mfma_f32_16x16x32_bf16 v[230:233], a[252:255], v[118:121], v[230:233]
    v_mfma_f32_16x16x32_bf16 v[214:217], a[244:247], v[118:121], v[214:217]
    s_waitcnt lgkmcnt(4)
    v_mfma_f32_16x16x32_bf16 v[170:173], v[122:125], a[236:239], v[170:173]
    s_add_u32 m0, s100, 159744
    s_add_u32 s62, s62, 262144
    s_cmp_eq_u32 s62, 1835008
    s_cselect_b32 s62, 0, s62
    buffer_load_dwordx4 v55, s[28:31], s62 offen sc1 lds
    ds_read_b128 v[106:109], v4 offset:36864
    v_mfma_f32_16x16x32_bf16 v[178:181], v[122:125], a[240:243], v[178:181]
    v_mfma_f32_16x16x32_bf16 v[174:177], v[126:129], a[236:239], v[174:177]
    ds_read_b128 v[110:113], v4 offset:37888
    v_mfma_f32_16x16x32_bf16 v[182:185], v[126:129], a[240:243], v[182:185]
    s_add_u32 m0, s58, 143360
    s_nop 0
    buffer_load_dwordx4 v53, s[28:31], s62 offen sc1 lds
    s_waitcnt lgkmcnt(2)
    v_mfma_f32_16x16x32_bf16 v[194:197], v[130:133], a[236:239], v[194:197]
    ds_read_b64_tr_b16 a[248:249], v56 offset:34816
    ds_read_b64_tr_b16 a[250:251], v56 offset:35072
    ds_read_b64_tr_b16 a[252:253], v56 offset:35840
    ds_read_b64_tr_b16 a[254:255], v56 offset:36096
    ds_read_b128 v[114:117], v4 offset:38912
    v_mfma_f32_16x16x32_bf16 v[202:205], v[130:133], a[240:243], v[202:205]
    v_mfma_f32_16x16x32_bf16 v[186:189], v[130:133], a[232:235], v[186:189]
    v_mfma_f32_16x16x32_bf16 v[198:201], v[134:137], a[236:239], v[198:201]
    buffer_load_dwordx4 v53, s[28:31], s62 offen offset:1024 sc1 lds
    ds_read_b128 v[118:121], v4 offset:39936
    v_mfma_f32_16x16x32_bf16 v[206:209], v[134:137], a[240:243], v[206:209]
    v_mfma_f32_16x16x32_bf16 v[190:193], v[134:137], a[232:235], v[190:193]
    s_waitcnt lgkmcnt(6)
    v_mfma_f32_16x16x32_bf16 v[218:221], a[236:239], v[106:109], v[218:221]
    ds_read_b64_tr_b16 a[244:245], v57 offset:34816
    ds_read_b64_tr_b16 a[246:247], v57 offset:35072
    ds_read_b128 v[122:125], v4 offset:40960
    v_mfma_f32_16x16x32_bf16 v[226:229], a[240:243], v[106:109], v[226:229]
    buffer_load_dwordx4 v54, s[28:31], s62 offen offset:2048 sc1 lds
    v_mfma_f32_16x16x32_bf16 v[210:213], a[232:235], v[106:109], v[210:213]
    v_mfma_f32_16x16x32_bf16 v[222:225], a[236:239], v[110:113], v[222:225]
    ds_read_b128 v[126:129], v4 offset:41984
    v_mfma_f32_16x16x32_bf16 v[230:233], a[240:243], v[110:113], v[230:233]
    v_mfma_f32_16x16x32_bf16 v[214:217], a[232:235], v[110:113], v[214:217]
    buffer_load_dwordx4 v54, s[28:31], s62 offen offset:3072 sc1 lds
    s_waitcnt lgkmcnt(4)
    v_mfma_f32_16x16x32_bf16 v[170:173], v[114:117], a[248:251], v[170:173]
    ds_read_b128 v[130:133], v4 offset:43008
    v_mfma_f32_16x16x32_bf16 v[178:181], v[114:117], a[252:255], v[178:181]
    v_mfma_f32_16x16x32_bf16 v[174:177], v[118:121], a[248:251], v[174:177]
    ds_read_b128 v[134:137], v4 offset:44032
    v_mfma_f32_16x16x32_bf16 v[182:185], v[118:121], a[252:255], v[182:185]
    s_waitcnt lgkmcnt(2)
    v_mfma_f32_16x16x32_bf16 v[194:197], v[122:125], a[248:251], v[194:197]
    s_waitcnt vmcnt(17)
    s_barrier
    ds_read_b64_tr_b16 a[236:237], v58 offset:0
    s_add_u32 m0, s58, 0
    s_nop 0
    buffer_load_dwordx4 v45, s[24:27], s64 offen lds
    ds_read_b64_tr_b16 a[238:239], v58 offset:256
    ds_read_b64_tr_b16 a[240:241], v58 offset:1024
    ds_read_b64_tr_b16 a[242:243], v58 offset:1280
    ds_read_b128 v[106:109], v39 offset:0
    v_mfma_f32_16x16x32_bf16 v[202:205], v[122:125], a[252:255], v[202:205]
    v_mfma_f32_16x16x32_bf16 v[186:189], v[122:125], a[244:247], v[186:189]
    buffer_load_dwordx4 v46, s[24:27], s64 offen offset:1024 lds
    v_mfma_f32_16x16x32_bf16 v[198:201], v[126:129], a[248:251], v[198:201]
    ds_read_b128 v[110:113], v39 offset:1024
    v_mfma_f32_16x16x32_bf16 v[206:209], v[126:129], a[252:255], v[206:209]
    v_mfma_f32_16x16x32_bf16 v[190:193], v[126:129], a[244:247], v[190:193]
    s_waitcnt lgkmcnt(6)
    v_mfma_f32_16x16x32_bf16 v[218:221], a[248:251], v[130:133], v[218:221]
    buffer_load_dwordx4 v47, s[24:27], s64 offen offset:2048 lds
    ds_read_b64_tr_b16 a[232:233], v59 offset:0
    ds_read_b64_tr_b16 a[234:235], v59 offset:256
    ds_read_b128 v[114:117], v39 offset:2048
    v_mfma_f32_16x16x32_bf16 v[226:229], a[252:255], v[130:133], v[226:229]
    v_mfma_f32_16x16x32_bf16 v[210:213], a[244:247], v[130:133], v[210:213]
    v_mfma_f32_16x16x32_bf16 v[222:225], a[248:251], v[134:137], v[222:225]
    ds_read_b128 v[118:121], v39 offset:3072
    v_mfma_f32_16x16x32_bf16 v[230:233], a[252:255], v[134:137], v[230:233]
    buffer_load_dwordx4 v48, s[24:27], s64 offen offset:3072 lds
    v_mfma_f32_16x16x32_bf16 v[214:217], a[244:247], v[134:137], v[214:217]
    s_waitcnt lgkmcnt(4)
    v_mfma_f32_16x16x32_bf16 v[170:173], v[106:109], a[236:239], v[170:173]
    ds_read_b128 v[122:125], v39 offset:4096
    v_mfma_f32_16x16x32_bf16 v[178:181], v[106:109], a[240:243], v[178:181]
    v_mfma_f32_16x16x32_bf16 v[174:177], v[110:113], a[236:239], v[174:177]
    s_add_u32 m0, s58, 16384
    s_add_u32 s64, s64, 524288
    s_cmp_eq_u32 s64, 7340032
    s_cselect_b32 s64, 0, s64
    buffer_load_dwordx4 v45, s[24:27], s64 offen lds
    ds_read_b128 v[126:129], v39 offset:5120
    v_mfma_f32_16x16x32_bf16 v[182:185], v[110:113], a[240:243], v[182:185]
    s_waitcnt lgkmcnt(2)
    v_mfma_f32_16x16x32_bf16 v[194:197], v[114:117], a[236:239], v[194:197]
    ds_read_b64_tr_b16 a[248:249], v58 offset:2048
    ds_read_b64_tr_b16 a[250:251], v58 offset:2304
    ds_read_b64_tr_b16 a[252:253], v58 offset:3072
    ds_read_b64_tr_b16 a[254:255], v58 offset:3328
    ds_read_b128 v[130:133], v39 offset:6144
    v_mfma_f32_16x16x32_bf16 v[202:205], v[114:117], a[240:243], v[202:205]
    buffer_load_dwordx4 v46, s[24:27], s64 offen offset:1024 lds
    v_mfma_f32_16x16x32_bf16 v[186:189], v[114:117], a[232:235], v[186:189]
    v_mfma_f32_16x16x32_bf16 v[198:201], v[118:121], a[236:239], v[198:201]
    ds_read_b128 v[134:137], v39 offset:7168
    v_mfma_f32_16x16x32_bf16 v[206:209], v[118:121], a[240:243], v[206:209]
    v_mfma_f32_16x16x32_bf16 v[190:193], v[118:121], a[232:235], v[190:193]
    buffer_load_dwordx4 v47, s[24:27], s64 offen offset:2048 lds
    s_waitcnt lgkmcnt(6)
    v_mfma_f32_16x16x32_bf16 v[218:221], a[236:239], v[122:125], v[218:221]
    ds_read_b64_tr_b16 a[244:245], v59 offset:2048
    ds_read_b64_tr_b16 a[246:247], v59 offset:2304
    ds_read_b128 v[106:109], v39 offset:8192
    v_mfma_f32_16x16x32_bf16 v[226:229], a[240:243], v[122:125], v[226:229]
    v_mfma_f32_16x16x32_bf16 v[210:213], a[232:235], v[122:125], v[210:213]
    v_mfma_f32_16x16x32_bf16 v[222:225], a[236:239], v[126:129], v[222:225]
    buffer_load_dwordx4 v48, s[24:27], s64 offen offset:3072 lds
    ds_read_b128 v[110:113], v39 offset:9216
    v_mfma_f32_16x16x32_bf16 v[230:233], a[240:243], v[126:129], v[230:233]
    v_mfma_f32_16x16x32_bf16 v[214:217], a[232:235], v[126:129], v[214:217]
    s_waitcnt lgkmcnt(4)
    v_mfma_f32_16x16x32_bf16 v[170:173], v[130:133], a[248:251], v[170:173]
    ds_read_b128 v[114:117], v39 offset:10240
    v_mfma_f32_16x16x32_bf16 v[178:181], v[130:133], a[252:255], v[178:181]
    v_mfma_f32_16x16x32_bf16 v[174:177], v[134:137], a[248:251], v[174:177]
    ds_read_b128 v[118:121], v39 offset:11264
    v_mfma_f32_16x16x32_bf16 v[182:185], v[134:137], a[252:255], v[182:185]
    s_waitcnt lgkmcnt(2)
    v_mfma_f32_16x16x32_bf16 v[194:197], v[106:109], a[248:251], v[194:197]
    s_waitcnt vmcnt(16)
    s_barrier
    ds_read_b64_tr_b16 a[236:237], v58 offset:32768
    s_add_u32 m0, s58, 32768
    s_add_u32 s64, s64, 524288
    s_cmp_eq_u32 s64, 7340032
    s_cselect_b32 s64, 0, s64
    buffer_load_dwordx4 v45, s[24:27], s64 offen lds
    ds_read_b64_tr_b16 a[238:239], v58 offset:33024
    ds_read_b64_tr_b16 a[240:241], v58 offset:33792
    ds_read_b64_tr_b16 a[242:243], v58 offset:34048
    ds_read_b128 v[122:125], v39 offset:32768
    v_mfma_f32_16x16x32_bf16 v[202:205], v[106:109], a[252:255], v[202:205]
    v_mfma_f32_16x16x32_bf16 v[186:189], v[106:109], a[244:247], v[186:189]
    buffer_load_dwordx4 v46, s[24:27], s64 offen offset:1024 lds
    v_mfma_f32_16x16x32_bf16 v[198:201], v[110:113], a[248:251], v[198:201]
    ds_read_b128 v[126:129], v39 offset:33792
    v_mfma_f32_16x16x32_bf16 v[206:209], v[110:113], a[252:255], v[206:209]
    v_mfma_f32_16x16x32_bf16 v[190:193], v[110:113], a[244:247], v[190:193]
    s_waitcnt lgkmcnt(6)
    v_mfma_f32_16x16x32_bf16 v[218:221], a[248:251], v[114:117], v[218:221]
    buffer_load_dwordx4 v47, s[24:27], s64 offen offset:2048 lds
    ds_read_b64_tr_b16 a[232:233], v59 offset:32768
    ds_read_b64_tr_b16 a[234:235], v59 offset:33024
    ds_read_b128 v[130:133], v39 offset:34816
    v_mfma_f32_16x16x32_bf16 v[226:229], a[252:255], v[114:117], v[226:229]
    v_mfma_f32_16x16x32_bf16 v[210:213], a[244:247], v[114:117], v[210:213]
    v_mfma_f32_16x16x32_bf16 v[222:225], a[248:251], v[118:121], v[222:225]
    ds_read_b128 v[134:137], v39 offset:35840
    v_mfma_f32_16x16x32_bf16 v[230:233], a[252:255], v[118:121], v[230:233]
    buffer_load_dwordx4 v48, s[24:27], s64 offen offset:3072 lds
    v_mfma_f32_16x16x32_bf16 v[214:217], a[244:247], v[118:121], v[214:217]
    s_waitcnt lgkmcnt(4)
    v_mfma_f32_16x16x32_bf16 v[170:173], v[122:125], a[236:239], v[170:173]
    ds_read_b128 v[106:109], v39 offset:36864
    v_mfma_f32_16x16x32_bf16 v[178:181], v[122:125], a[240:243], v[178:181]
    v_mfma_f32_16x16x32_bf16 v[174:177], v[126:129], a[236:239], v[174:177]
    s_add_u32 m0, s58, 49152
    s_add_u32 s64, s64, 524288
    s_cmp_eq_u32 s64, 7340032
    s_cselect_b32 s64, 0, s64
    buffer_load_dwordx4 v45, s[24:27], s64 offen lds
    ds_read_b128 v[110:113], v39 offset:37888
    v_mfma_f32_16x16x32_bf16 v[182:185], v[126:129], a[240:243], v[182:185]
    s_waitcnt lgkmcnt(2)
    v_mfma_f32_16x16x32_bf16 v[194:197], v[130:133], a[236:239], v[194:197]
    ds_read_b64_tr_b16 a[248:249], v58 offset:34816
    ds_read_b64_tr_b16 a[250:251], v58 offset:35072
    ds_read_b64_tr_b16 a[252:253], v58 offset:35840
    ds_read_b64_tr_b16 a[254:255], v58 offset:36096
    ds_read_b128 v[114:117], v39 offset:38912
    v_mfma_f32_16x16x32_bf16 v[202:205], v[130:133], a[240:243], v[202:205]
    buffer_load_dwordx4 v46, s[24:27], s64 offen offset:1024 lds
    v_mfma_f32_16x16x32_bf16 v[186:189], v[130:133], a[232:235], v[186:189]
    v_mfma_f32_16x16x32_bf16 v[198:201], v[134:137], a[236:239], v[198:201]
    ds_read_b128 v[118:121], v39 offset:39936
    v_mfma_f32_16x16x32_bf16 v[206:209], v[134:137], a[240:243], v[206:209]
    v_mfma_f32_16x16x32_bf16 v[190:193], v[134:137], a[232:235], v[190:193]
    buffer_load_dwordx4 v47, s[24:27], s64 offen offset:2048 lds
    s_waitcnt lgkmcnt(6)
    v_mfma_f32_16x16x32_bf16 v[218:221], a[236:239], v[106:109], v[218:221]
    ds_read_b64_tr_b16 a[244:245], v59 offset:34816
    ds_read_b64_tr_b16 a[246:247], v59 offset:35072
    ds_read_b128 v[122:125], v39 offset:40960
    v_mfma_f32_16x16x32_bf16 v[226:229], a[240:243], v[106:109], v[226:229]
    v_mfma_f32_16x16x32_bf16 v[210:213], a[232:235], v[106:109], v[210:213]
    v_mfma_f32_16x16x32_bf16 v[222:225], a[236:239], v[110:113], v[222:225]
    buffer_load_dwordx4 v48, s[24:27], s64 offen offset:3072 lds
    ds_read_b128 v[126:129], v39 offset:41984
    v_mfma_f32_16x16x32_bf16 v[230:233], a[240:243], v[110:113], v[230:233]
    v_mfma_f32_16x16x32_bf16 v[214:217], a[232:235], v[110:113], v[214:217]
    s_waitcnt lgkmcnt(4)
    v_mfma_f32_16x16x32_bf16 v[170:173], v[114:117], a[248:251], v[170:173]
    ds_read_b128 v[130:133], v39 offset:43008
    v_mfma_f32_16x16x32_bf16 v[178:181], v[114:117], a[252:255], v[178:181]
    v_mfma_f32_16x16x32_bf16 v[174:177], v[118:121], a[248:251], v[174:177]
    ds_read_b128 v[134:137], v39 offset:44032
    v_mfma_f32_16x16x32_bf16 v[182:185], v[118:121], a[252:255], v[182:185]
    s_waitcnt lgkmcnt(2)
    v_mfma_f32_16x16x32_bf16 v[194:197], v[122:125], a[248:251], v[194:197]
    s_waitcnt vmcnt(16)
    s_barrier
    ds_read_b64_tr_b16 a[236:237], v60 offset:0
    s_add_u32 m0, s58, 65536
    s_add_u32 s64, s64, 524288
    s_cmp_eq_u32 s64, 7340032
    s_cselect_b32 s64, 0, s64
    buffer_load_dwordx4 v45, s[24:27], s64 offen lds
    ds_read_b64_tr_b16 a[238:239], v60 offset:256
    ds_read_b64_tr_b16 a[240:241], v60 offset:1024
    ds_read_b64_tr_b16 a[242:243], v60 offset:1280
    ds_read_b128 v[106:109], v40 offset:0
    v_mfma_f32_16x16x32_bf16 v[202:205], v[122:125], a[252:255], v[202:205]
    v_mfma_f32_16x16x32_bf16 v[186:189], v[122:125], a[244:247], v[186:189]
    buffer_load_dwordx4 v46, s[24:27], s64 offen offset:1024 lds
    v_mfma_f32_16x16x32_bf16 v[198:201], v[126:129], a[248:251], v[198:201]
    ds_read_b128 v[110:113], v40 offset:1024
    v_mfma_f32_16x16x32_bf16 v[206:209], v[126:129], a[252:255], v[206:209]
    v_mfma_f32_16x16x32_bf16 v[190:193], v[126:129], a[244:247], v[190:193]
    s_waitcnt lgkmcnt(6)
    v_mfma_f32_16x16x32_bf16 v[218:221], a[248:251], v[130:133], v[218:221]
    buffer_load_dwordx4 v47, s[24:27], s64 offen offset:2048 lds
    ds_read_b64_tr_b16 a[232:233], v61 offset:0
    ds_read_b64_tr_b16 a[234:235], v61 offset:256
    ds_read_b128 v[114:117], v40 offset:2048
    v_mfma_f32_16x16x32_bf16 v[226:229], a[252:255], v[130:133], v[226:229]
    v_mfma_f32_16x16x32_bf16 v[210:213], a[244:247], v[130:133], v[210:213]
    v_mfma_f32_16x16x32_bf16 v[222:225], a[248:251], v[134:137], v[222:225]
    ds_read_b128 v[118:121], v40 offset:3072
    v_mfma_f32_16x16x32_bf16 v[230:233], a[252:255], v[134:137], v[230:233]
    buffer_load_dwordx4 v48, s[24:27], s64 offen offset:3072 lds
    v_mfma_f32_16x16x32_bf16 v[214:217], a[244:247], v[134:137], v[214:217]
    s_waitcnt lgkmcnt(4)
    v_mfma_f32_16x16x32_bf16 v[170:173], v[106:109], a[236:239], v[170:173]
    ds_read_b128 v[122:125], v40 offset:4096
    v_mfma_f32_16x16x32_bf16 v[178:181], v[106:109], a[240:243], v[178:181]
    v_mfma_f32_16x16x32_bf16 v[174:177], v[110:113], a[236:239], v[174:177]
    s_add_u32 m0, s58, 81920
    s_add_u32 s64, s64, 524288
    s_cmp_eq_u32 s64, 7340032
    s_cselect_b32 s64, 0, s64
    buffer_load_dwordx4 v45, s[24:27], s64 offen lds
    ds_read_b128 v[126:129], v40 offset:5120
    v_mfma_f32_16x16x32_bf16 v[182:185], v[110:113], a[240:243], v[182:185]
    s_waitcnt lgkmcnt(2)
    v_mfma_f32_16x16x32_bf16 v[194:197], v[114:117], a[236:239], v[194:197]
    ds_read_b64_tr_b16 a[248:249], v60 offset:2048
    ds_read_b64_tr_b16 a[250:251], v60 offset:2304
    ds_read_b64_tr_b16 a[252:253], v60 offset:3072
    ds_read_b64_tr_b16 a[254:255], v60 offset:3328
    ds_read_b128 v[130:133], v40 offset:6144
    v_mfma_f32_16x16x32_bf16 v[202:205], v[114:117], a[240:243], v[202:205]
    buffer_load_dwordx4 v46, s[24:27], s64 offen offset:1024 lds
    v_mfma_f32_16x16x32_bf16 v[186:189], v[114:117], a[232:235], v[186:189]
    v_mfma_f32_16x16x32_bf16 v[198:201], v[118:121], a[236:239], v[198:201]
    ds_read_b128 v[134:137], v40 offset:7168
    v_mfma_f32_16x16x32_bf16 v[206:209], v[118:121], a[240:243], v[206:209]
    v_mfma_f32_16x16x32_bf16 v[190:193], v[118:121], a[232:235], v[190:193]
    buffer_load_dwordx4 v47, s[24:27], s64 offen offset:2048 lds
    s_waitcnt lgkmcnt(6)
    v_mfma_f32_16x16x32_bf16 v[218:221], a[236:239], v[122:125], v[218:221]
    ds_read_b64_tr_b16 a[244:245], v61 offset:2048
    ds_read_b64_tr_b16 a[246:247], v61 offset:2304
    ds_read_b128 v[106:109], v40 offset:8192
    v_mfma_f32_16x16x32_bf16 v[226:229], a[240:243], v[122:125], v[226:229]
    v_mfma_f32_16x16x32_bf16 v[210:213], a[232:235], v[122:125], v[210:213]
    v_mfma_f32_16x16x32_bf16 v[222:225], a[236:239], v[126:129], v[222:225]
    buffer_load_dwordx4 v48, s[24:27], s64 offen offset:3072 lds
    ds_read_b128 v[110:113], v40 offset:9216
    v_mfma_f32_16x16x32_bf16 v[230:233], a[240:243], v[126:129], v[230:233]
    v_mfma_f32_16x16x32_bf16 v[214:217], a[232:235], v[126:129], v[214:217]
    s_waitcnt lgkmcnt(4)
    v_mfma_f32_16x16x32_bf16 v[170:173], v[130:133], a[248:251], v[170:173]
    ds_read_b128 v[114:117], v40 offset:10240
    v_mfma_f32_16x16x32_bf16 v[178:181], v[130:133], a[252:255], v[178:181]
    v_mfma_f32_16x16x32_bf16 v[174:177], v[134:137], a[248:251], v[174:177]
    ds_read_b128 v[118:121], v40 offset:11264
    v_mfma_f32_16x16x32_bf16 v[182:185], v[134:137], a[252:255], v[182:185]
    s_waitcnt lgkmcnt(2)
    v_mfma_f32_16x16x32_bf16 v[194:197], v[106:109], a[248:251], v[194:197]
    v_mfma_f32_16x16x32_bf16 v[202:205], v[106:109], a[252:255], v[202:205]
    v_mfma_f32_16x16x32_bf16 v[186:189], v[106:109], a[244:247], v[186:189]
    v_mfma_f32_16x16x32_bf16 v[198:201], v[110:113], a[248:251], v[198:201]
    v_mfma_f32_16x16x32_bf16 v[206:209], v[110:113], a[252:255], v[206:209]
    v_mfma_f32_16x16x32_bf16 v[190:193], v[110:113], a[244:247], v[190:193]
    s_waitcnt lgkmcnt(0)
    v_mfma_f32_16x16x32_bf16 v[218:221], a[248:251], v[114:117], v[218:221]
    v_mfma_f32_16x16x32_bf16 v[226:229], a[252:255], v[114:117], v[226:229]
    v_mfma_f32_16x16x32_bf16 v[210:213], a[244:247], v[114:117], v[210:213]
    v_mfma_f32_16x16x32_bf16 v[222:225], a[248:251], v[118:121], v[222:225]
    v_mfma_f32_16x16x32_bf16 v[230:233], a[252:255], v[118:121], v[230:233]
    v_mfma_f32_16x16x32_bf16 v[214:217], a[244:247], v[118:121], v[214:217]
    s_barrier
    v_cvt_pk_bf16_f32 v106, v170, v171
    buffer_load_dword v18, v22, s[28:31], 0 offen sc1
    v_cvt_pk_bf16_f32 v107, v172, v173
    s_add_u32 m0, s58, 98304
    s_add_u32 s64, s64, 524288
    s_cmp_eq_u32 s64, 7340032
    s_cselect_b32 s64, 0, s64
    buffer_load_dwordx4 v45, s[24:27], s64 offen lds
    v_cvt_pk_bf16_f32 v108, v174, v175
    v_cvt_pk_bf16_f32 v109, v176, v177
    v_cvt_pk_bf16_f32 v110, v178, v179
    v_cvt_pk_bf16_f32 v111, v180, v181
    v_cvt_pk_bf16_f32 v112, v182, v183
    v_cvt_pk_bf16_f32 v113, v184, v185
    v_cvt_pk_bf16_f32 v118, v194, v195
    v_cvt_pk_bf16_f32 v119, v196, v197
    v_cvt_pk_bf16_f32 v120, v198, v199
    v_cvt_pk_bf16_f32 v121, v200, v201
    v_cvt_pk_bf16_f32 v122, v202, v203
    v_cvt_pk_bf16_f32 v123, v204, v205
    buffer_load_dwordx4 v46, s[24:27], s64 offen offset:1024 lds
    v_cvt_pk_bf16_f32 v124, v206, v207
    v_cvt_pk_bf16_f32 v125, v208, v209
    v_cvt_pk_bf16_f32 v114, v186, v187
    v_cvt_pk_bf16_f32 v115, v188, v189
    v_cvt_pk_bf16_f32 v116, v190, v191
    v_cvt_pk_bf16_f32 v117, v192, v193
    v_mfma_f32_16x16x32_bf16 v[142:145], v[118:121], v[106:109], 0
    v_mfma_f32_16x16x32_bf16 v[146:149], v[118:121], v[110:113], 0
    v_mfma_f32_16x16x32_bf16 v[150:153], v[122:125], v[110:113], 0
    buffer_load_dwordx4 v47, s[24:27], s64 offen offset:2048 lds
    v_mfma_f32_16x16x32_bf16 v[138:141], v[114:117], v[106:109], 0
    v_cvt_pk_bf16_f32 v154, v210, v211
    v_cvt_pk_bf16_f32 v155, v212, v213
    v_cvt_pk_bf16_f32 v156, v218, v219
    v_cvt_pk_bf16_f32 v157, v220, v221
    v_cvt_pk_bf16_f32 v158, v226, v227
    v_cvt_pk_bf16_f32 v159, v228, v229
    v_cndmask_b32 v238, v146, v147, s[70:71]
    v_cndmask_b32 v241, v150, v151, s[70:71]
    v_cndmask_b32 v238, v238, v241, s[72:73]
    v_mul_f32 v238, v238, v168
    buffer_load_dwordx4 v48, s[24:27], s64 offen offset:3072 lds
    v_cndmask_b32 v239, v148, v149, s[70:71]
    v_cndmask_b32 v241, v152, v153, s[70:71]
    v_cndmask_b32 v239, v239, v241, s[74:75]
    v_mul_f32 v239, v239, v169
    v_cndmask_b32 v234, v138, v139, s[70:71]
    v_cndmask_b32 v234, v70, v234, s[76:77]
    v_cndmask_b32 v237, v142, v143, s[70:71]
    v_cndmask_b32 v234, v234, v237, s[72:73]
    v_mul_f32 v234, v234, v166
    v_cndmask_b32 v235, v140, v141, s[70:71]
    v_cndmask_b32 v235, v70, v235, s[76:77]
    v_cndmask_b32 v237, v144, v145, s[70:71]
    v_cndmask_b32 v235, v235, v237, s[74:75]
    v_mul_f32 v235, v235, v167
    v_max_f32 v236, v234, v235
    v_max_f32 v240, v238, v239
    s_add_u32 m0, s58, 114688
    s_add_u32 s64, s64, 524288
    s_cmp_eq_u32 s64, 7340032
    s_cselect_b32 s64, 0, s64
    buffer_load_dwordx4 v45, s[24:27], s64 offen lds
    v_mov_b32 v237, v236
    v_mov_b32 v241, v240
    v_cvt_pk_bf16_f32 v160, v214, v215
    v_permlane16_swap_b32 v236, v237
    v_permlane16_swap_b32 v240, v241
    v_max_f32 v236, v236, v237
    v_max_f32 v240, v240, v241
    v_mov_b32 v237, v236
    v_mov_b32 v241, v240
    v_cvt_pk_bf16_f32 v161, v216, v217
    v_permlane32_swap_b32 v236, v237
    v_permlane32_swap_b32 v240, v241
    v_max_f32 v236, v236, v237
    v_max_f32 v240, v240, v241
    v_mul_f32 v236, v242, v236
    v_mul_f32 v240, v243, v240
    buffer_load_dwordx4 v46, s[24:27], s64 offen offset:1024 lds
    v_fma_f32 v234, v234, v242, -v236
    v_fma_f32 v235, v235, v242, -v236
    v_fma_f32 v238, v238, v243, -v240
    v_fma_f32 v239, v239, v243, -v240
    v_exp_f32 v234, v234
    v_exp_f32 v235, v235
    v_exp_f32 v238, v238
    v_exp_f32 v239, v239
    v_add_f32 v236, v234, v235
    v_add_f32 v240, v238, v239
    v_mov_b32 v237, v236
    v_mov_b32 v241, v240
    buffer_load_dwordx4 v47, s[24:27], s64 offen offset:2048 lds
    v_cvt_pk_bf16_f32 v162, v222, v223
    v_permlane16_swap_b32 v236, v237
    v_permlane16_swap_b32 v240, v241
    v_add_f32 v236, v236, v237
    v_add_f32 v240, v240, v241
    v_mov_b32 v237, v236
    v_mov_b32 v241, v240
    v_cvt_pk_bf16_f32 v163, v224, v225
    v_permlane32_swap_b32 v236, v237
    v_permlane32_swap_b32 v240, v241
    v_add_f32 v236, v236, v237
    v_add_f32 v240, v240, v241
    v_rcp_f32 v236, v236
    v_rcp_f32 v240, v240
    buffer_load_dwordx4 v48, s[24:27], s64 offen offset:3072 lds
    v_cvt_pk_bf16_f32 v164, v230, v231
    v_cvt_pk_bf16_f32 v165, v232, v233
    v_mul_f32 v234, v234, v166
    v_mul_f32 v235, v235, v167
    v_mul_f32 v238, v238, v168
    v_mul_f32 v239, v239, v169
    v_mul_f32 v234, v234, v236
    v_mul_f32 v235, v235, v236
    v_mul_f32 v238, v238, v240
    v_mul_f32 v239, v239, v240
    v_cvt_pk_bf16_f32 v234, v234, v234
    v_cvt_pk_bf16_f32 v235, v235, v235
    v_cvt_pk_bf16_f32 v238, v238, v238
    v_cvt_pk_bf16_f32 v239, v239, v239
    v_and_b32 v126, v234, v92
    v_and_b32 v127, v235, v93
    s_add_u32 m0, s58, 131072
    s_add_u32 s64, s64, 524288
    s_cmp_eq_u32 s64, 7340032
    s_cselect_b32 s64, 0, s64
    buffer_load_dwordx4 v45, s[24:27], s64 offen lds
    v_and_b32 v128, v234, v94
    v_and_b32 v129, v235, v95
    v_and_b32 v130, v238, v92
    v_and_b32 v131, v239, v93
    v_and_b32 v132, v238, v94
    v_and_b32 v133, v239, v95
    v_mfma_f32_16x16x32_bf16 v[170:173], v[154:157], v[126:129], 0
    v_mfma_f32_16x16x32_bf16 v[174:177], v[160:163], v[126:129], 0
    v_mfma_f32_16x16x32_bf16 v[178:181], v[156:159], v[130:133], 0
    buffer_load_dwordx4 v46, s[24:27], s64 offen offset:1024 lds
    v_mfma_f32_16x16x32_bf16 v[182:185], v[162:165], v[130:133], 0
    s_add_u32 s83, s82, 16384
    s_nop 2
    v_cvt_pk_bf16_f32 v98, v170, v171
    v_cvt_pk_bf16_f32 v99, v172, v173
    v_cvt_pk_bf16_f32 v100, v174, v175
    v_cvt_pk_bf16_f32 v101, v176, v177
    v_cvt_pk_bf16_f32 v102, v178, v179
    v_cvt_pk_bf16_f32 v103, v180, v181
    v_cvt_pk_bf16_f32 v104, v182, v183
    v_cvt_pk_bf16_f32 v105, v184, v185
    s_cmp_lg_u32 s56, 0
    s_cbranch_scc1 L_f
    buffer_store_dwordx4 v[98:101], v4, s[28:31], s82 offen sc1
    buffer_store_dwordx4 v[102:105], v4, s[28:31], s83 offen sc1
    s_waitcnt vmcnt(0)
    s_barrier
    buffer_store_dword v12, v13, s[28:31], s69 offen sc1
    v_lshlrev_b32 v15, 7, v1
    buffer_load_dword v18, v22, s[28:31], 0 offen sc1
    v_sub_u32 v14, v65, v4
    v_lshl_add_u32 v14, v10, 7, v14
    v_lshl_add_u32 v16, v9, 13, s65
    s_mov_b32 s3, 0
    s_waitcnt vmcnt(0)
    v_cmp_ne_u32 vcc, s57, v18
    s_cbranch_vccz L_pollok4
    s_mov_b32 s60, 0
L_poll4:
    s_sleep 8
    buffer_load_dword v18, v22, s[28:31], 0 offen sc1
    s_add_u32 s60, s60, 1
    s_waitcnt vmcnt(0)
    v_cmp_ne_u32 vcc, s57, v18
    s_cbranch_vccz L_pollok4
    s_cmp_lt_u32 s60, 20000
    s_cbranch_scc1 L_poll4
L_pollok4:
    v_subrev_u32 v17, 114688, v16
    v_min_u32 v16, v16, v17
    v_add_u32 v17, v14, v16
    v_add_u32 v16, 16384, v16
    buffer_load_dword v170, v17, s[28:31], s3 offen sc1
    v_subrev_u32 v17, 114688, v16
    v_min_u32 v16, v16, v17
    v_add_u32 v17, v14, v16
    v_add_u32 v16, 16384, v16
    buffer_load_dword v171, v17, s[28:31], s3 offen sc1
    v_subrev_u32 v17, 114688, v16
    v_min_u32 v16, v16, v17
    v_add_u32 v17, v14, v16
    v_add_u32 v16, 16384, v16
    buffer_load_dword v172, v17, s[28:31], s3 offen sc1
    v_subrev_u32 v17, 114688, v16
    v_min_u32 v16, v16, v17
    v_add_u32 v17, v14, v16
    v_add_u32 v16, 16384, v16
    buffer_load_dword v173, v17, s[28:31], s3 offen sc1
    v_subrev_u32 v17, 114688, v16
    v_min_u32 v16, v16, v17
    v_add_u32 v17, v14, v16
    v_add_u32 v16, 16384, v16
    buffer_load_dword v174, v17, s[28:31], s3 offen sc1
    v_subrev_u32 v17, 114688, v16
    v_min_u32 v16, v16, v17
    v_add_u32 v17, v14, v16
    v_add_u32 v16, 16384, v16
    buffer_load_dword v175, v17, s[28:31], s3 offen sc1
    v_subrev_u32 v17, 114688, v16
    v_min_u32 v16, v16, v17
    v_add_u32 v17, v14, v16
    v_add_u32 v16, 16384, v16
    buffer_load_dword v176, v17, s[28:31], s3 offen sc1
    s_lshl_b32 s3, s54, 2
    s_add_u32 s3, s3, s48
    s_mul_i32 s3, s3, 25088
    buffer_load_dword v177, v15, s[16:19], s3 offen
    s_add_u32 s3, s3, 5632
    buffer_load_dword v178, v15, s[16:19], s3 offen
    s_add_u32 s3, s3, 5632
    buffer_load_dword v179, v15, s[16:19], s3 offen
    s_add_u32 s3, s3, 5632
    buffer_load_dword v180, v15, s[16:19], s3 offen
    s_add_u32 s3, s3, 5632
    buffer_load_dword v18, v23, s[28:31], 0 offen sc1
    s_waitcnt vmcnt(0)
    v_cmp_ne_u32 vcc, s57, v18
    s_cbranch_vccz L_pollok5
    s_mov_b32 s60, 0
L_poll5:
    s_sleep 16
    buffer_load_dword v18, v23, s[28:31], 0 offen sc1
    s_add_u32 s60, s60, 1
    s_waitcnt vmcnt(0)
    v_cmp_ne_u32 vcc, s57, v18
    s_cbranch_vccz L_pollok5
    s_cmp_lt_u32 s60, 20000
    s_cbranch_scc1 L_poll5
L_pollok5:
    s_lshl_b32 s3, s53, 2
    s_add_u32 s3, s3, s48
    s_lshl_b32 s3, s3, 14
    s_add_u32 s3, s3, 4194304
    buffer_load_dword v181, v15, s[28:31], s3 offen sc1
    s_add_u32 s3, s3, 8192
    buffer_load_dword v182, v15, s[28:31], s3 offen sc1
    s_add_u32 s3, s3, 8192
    s_branch L_fin
L_f:
    buffer_store_dwordx4 v[98:101], v4, s[28:31], s82 offen sc1
    buffer_store_dwordx4 v[102:105], v4, s[28:31], s83 offen sc1
    s_waitcnt vmcnt(12)
    v_cmp_ne_u32 vcc, s57, v18
    s_cbranch_vccz L_pollok6
    s_mov_b32 s60, 0
L_poll6:
    s_sleep 8
    buffer_load_dword v18, v22, s[28:31], 0 offen sc1
    s_add_u32 s60, s60, 1
    s_waitcnt vmcnt(0)
    v_cmp_ne_u32 vcc, s57, v18
    s_cbranch_vccz L_pollok6
    s_cmp_lt_u32 s60, 20000
    s_cbranch_scc1 L_poll6
L_pollok6:
    buffer_load_dwordx4 v47, s[24:27], s64 offen offset:2048 lds
    buffer_load_dwordx4 v48, s[24:27], s64 offen offset:3072 lds
    buffer_load_dwordx4 a[0:3], v65, s[28:31], s65 offen offset:0 sc1
    buffer_load_dwordx4 a[4:7], v65, s[28:31], s65 offen offset:1024 sc1
    buffer_load_dwordx4 a[8:11], v65, s[28:31], s65 offen offset:2048 sc1
    buffer_load_dwordx4 a[12:15], v65, s[28:31], s65 offen offset:3072 sc1
    s_add_u32 s65, s65, 8192
    s_cmp_eq_u32 s65, 114688
    s_cselect_b32 s65, 0, s65
    buffer_load_dwordx4 a[16:19], v65, s[28:31], s65 offen offset:0 sc1
    buffer_load_dwordx4 a[20:23], v65, s[28:31], s65 offen offset:1024 sc1
    buffer_load_dwordx4 a[24:27], v65, s[28:31], s65 offen offset:2048 sc1
    buffer_load_dwordx4 a[28:31], v65, s[28:31], s65 offen offset:3072 sc1
    s_add_u32 m0, s58, 147456
    s_add_u32 s64, s64, 524288
    s_cmp_eq_u32 s64, 7340032
    s_cselect_b32 s64, 0, s64
    buffer_load_dwordx4 v45, s[24:27], s64 offen lds
    buffer_load_dwordx4 v46, s[24:27], s64 offen offset:1024 lds
    buffer_load_dwordx4 v47, s[24:27], s64 offen offset:2048 lds
    buffer_load_dwordx4 v48, s[24:27], s64 offen offset:3072 lds
    s_add_u32 s65, s65, 8192
    s_cmp_eq_u32 s65, 114688
    s_cselect_b32 s65, 0, s65
    buffer_load_dwordx4 a[32:35], v65, s[28:31], s65 offen offset:0 sc1
    buffer_load_dwordx4 a[36:39], v65, s[28:31], s65 offen offset:1024 sc1
    buffer_load_dwordx4 a[40:43], v65, s[28:31], s65 offen offset:2048 sc1
    buffer_load_dwordx4 a[44:47], v65, s[28:31], s65 offen offset:3072 sc1
    s_barrier
    ds_read_b64_tr_b16 v[106:107], v24 offset:0
    s_add_u32 s65, s65, 8192
    s_cmp_eq_u32 s65, 114688
    s_cselect_b32 s65, 0, s65
    buffer_load_dwordx4 a[48:51], v65, s[28:31], s65 offen offset:0 sc1
    ds_read_b64_tr_b16 v[108:109], v24 offset:1024
    ds_read_b64_tr_b16 v[110:111], v25 offset:0
    ds_read_b64_tr_b16 v[112:113], v25 offset:1024
    ds_read_b64_tr_b16 v[114:115], v24 offset:2048
    ds_read_b64_tr_b16 v[116:117], v24 offset:3072
    ds_read_b64_tr_b16 v[118:119], v25 offset:2048
    ds_read_b64_tr_b16 v[120:121], v25 offset:3072
    ds_read_b64_tr_b16 v[122:123], v24 offset:4096
    ds_read_b64_tr_b16 v[124:125], v24 offset:5120
    ds_read_b64_tr_b16 v[126:127], v25 offset:4096
    ds_read_b64_tr_b16 v[128:129], v25 offset:5120
    s_waitcnt vmcnt(16) lgkmcnt(8)
    v_mfma_f32_32x32x16_bf16 v[138:153], a[0:3], v[106:109], 0
    ds_read_b64_tr_b16 v[130:131], v24 offset:6144
    ds_read_b64_tr_b16 v[132:133], v24 offset:7168
    v_lshlrev_b32 v81, 16, v81
    buffer_load_dwordx4 a[52:55], v65, s[28:31], s65 offen offset:1024 sc1
    v_mfma_f32_32x32x16_bf16 v[154:169], a[0:3], v[110:113], 0
    ds_read_b64_tr_b16 v[134:135], v25 offset:6144
    ds_read_b64_tr_b16 v[136:137], v25 offset:7168
    v_lshlrev_b32 v210, 16, v84
    s_waitcnt vmcnt(16) lgkmcnt(8)
    v_mfma_f32_32x32x16_bf16 v[138:153], a[4:7], v[114:117], v[138:153]
    buffer_load_dwordx4 a[56:59], v65, s[28:31], s65 offen offset:2048 sc1
    ds_read_b64_tr_b16 v[106:107], v24 offset:16384
    ds_read_b64_tr_b16 v[108:109], v24 offset:17408
    v_and_b32 v211, 0xffff0000, v84
    v_mfma_f32_32x32x16_bf16 v[154:169], a[4:7], v[118:121], v[154:169]
    buffer_load_dwordx4 a[60:63], v65, s[28:31], s65 offen offset:3072 sc1
    ds_read_b64_tr_b16 v[110:111], v25 offset:16384
    ds_read_b64_tr_b16 v[112:113], v25 offset:17408
    v_add_f32 v210, v210, v81
    s_waitcnt vmcnt(17) lgkmcnt(8)
    v_mfma_f32_32x32x16_bf16 v[138:153], a[8:11], v[122:125], v[138:153]
    s_add_u32 s65, s65, 8192
    s_cmp_eq_u32 s65, 114688
    s_cselect_b32 s65, 0, s65
    buffer_load_dwordx4 a[64:67], v65, s[28:31], s65 offen offset:0 sc1
    ds_read_b64_tr_b16 v[114:115], v24 offset:18432
    ds_read_b64_tr_b16 v[116:117], v24 offset:19456
    v_add_f32 v211, v211, v81
    v_mfma_f32_32x32x16_bf16 v[154:169], a[8:11], v[126:129], v[154:169]
    buffer_load_dwordx4 a[68:71], v65, s[28:31], s65 offen offset:1024 sc1
    ds_read_b64_tr_b16 v[118:119], v25 offset:18432
    ds_read_b64_tr_b16 v[120:121], v25 offset:19456
    v_lshlrev_b32 v212, 16, v85
    s_waitcnt vmcnt(18) lgkmcnt(8)
    v_mfma_f32_32x32x16_bf16 v[138:153], a[12:15], v[130:133], v[138:153]
    buffer_load_dwordx4 a[72:75], v65, s[28:31], s65 offen offset:2048 sc1
    ds_read_b64_tr_b16 v[122:123], v24 offset:20480
    ds_read_b64_tr_b16 v[124:125], v24 offset:21504
    v_and_b32 v213, 0xffff0000, v85
    v_mfma_f32_32x32x16_bf16 v[154:169], a[12:15], v[134:137], v[154:169]
    buffer_load_dwordx4 a[76:79], v65, s[28:31], s65 offen offset:3072 sc1
    ds_read_b64_tr_b16 v[126:127], v25 offset:20480
    ds_read_b64_tr_b16 v[128:129], v25 offset:21504
    v_add_f32 v212, v212, v81
    s_waitcnt vmcnt(19) lgkmcnt(8)
    v_mfma_f32_32x32x16_bf16 v[138:153], a[16:19], v[106:109], v[138:153]
    ds_read_b64_tr_b16 v[130:131], v24 offset:22528
    ds_read_b64_tr_b16 v[132:133], v24 offset:23552
    v_add_f32 v213, v213, v81
    v_mfma_f32_32x32x16_bf16 v[154:169], a[16:19], v[110:113], v[154:169]
    ds_read_b64_tr_b16 v[134:135], v25 offset:22528
    ds_read_b64_tr_b16 v[136:137], v25 offset:23552
    v_lshlrev_b32 v214, 16, v86
    s_waitcnt vmcnt(18) lgkmcnt(8)
    v_mfma_f32_32x32x16_bf16 v[138:153], a[20:23], v[114:117], v[138:153]
    ds_read_b64_tr_b16 v[106:107], v24 offset:32768
    s_add_u32 s65, s65, 8192
    s_cmp_eq_u32 s65, 114688
    s_cselect_b32 s65, 0, s65
    buffer_load_dwordx4 a[80:83], v65, s[28:31], s65 offen offset:0 sc1
    ds_read_b64_tr_b16 v[108:109], v24 offset:33792
    v_and_b32 v215, 0xffff0000, v86
    v_mfma_f32_32x32x16_bf16 v[154:169], a[20:23], v[118:121], v[154:169]
    buffer_load_dwordx4 a[84:87], v65, s[28:31], s65 offen offset:1024 sc1
    ds_read_b64_tr_b16 v[110:111], v25 offset:32768
    ds_read_b64_tr_b16 v[112:113], v25 offset:33792
    v_add_f32 v214, v214, v81
    s_waitcnt vmcnt(19) lgkmcnt(8)
    v_mfma_f32_32x32x16_bf16 v[138:153], a[24:27], v[122:125], v[138:153]
    buffer_load_dwordx4 a[88:91], v65, s[28:31], s65 offen offset:2048 sc1
    ds_read_b64_tr_b16 v[114:115], v24 offset:34816
    ds_read_b64_tr_b16 v[116:117], v24 offset:35840
    v_add_f32 v215, v215, v81
    v_mfma_f32_32x32x16_bf16 v[154:169], a[24:27], v[126:129], v[154:169]
    buffer_load_dwordx4 a[92:95], v65, s[28:31], s65 offen offset:3072 sc1
    ds_read_b64_tr_b16 v[118:119], v25 offset:34816
    ds_read_b64_tr_b16 v[120:121], v25 offset:35840
    v_lshlrev_b32 v216, 16, v87
    s_waitcnt vmcnt(20) lgkmcnt(8)
    v_mfma_f32_32x32x16_bf16 v[138:153], a[28:31], v[130:133], v[138:153]
    ds_read_b64_tr_b16 v[122:123], v24 offset:36864
    ds_read_b64_tr_b16 v[124:125], v24 offset:37888
    v_and_b32 v217, 0xffff0000, v87
    v_mfma_f32_32x32x16_bf16 v[154:169], a[28:31], v[134:137], v[154:169]
    ds_read_b64_tr_b16 v[126:127], v25 offset:36864
    ds_read_b64_tr_b16 v[128:129], v25 offset:37888
    v_add_f32 v216, v216, v81
    s_waitcnt vmcnt(15) lgkmcnt(8)
    v_mfma_f32_32x32x16_bf16 v[138:153], a[32:35], v[106:109], v[138:153]
    ds_read_b64_tr_b16 v[130:131], v24 offset:38912
    ds_read_b64_tr_b16 v[132:133], v24 offset:39936
    v_add_f32 v217, v217, v81
    v_mfma_f32_32x32x16_bf16 v[154:169], a[32:35], v[110:113], v[154:169]
    ds_read_b64_tr_b16 v[134:135], v25 offset:38912
    ds_read_b64_tr_b16 v[136:137], v25 offset:39936
    v_lshlrev_b32 v82, 16, v82
    s_waitcnt vmcnt(14) lgkmcnt(8)
    v_mfma_f32_32x32x16_bf16 v[138:153], a[36:39], v[114:117], v[138:153]
    s_barrier
    buffer_store_dword v12, v13, s[28:31], s69 offen sc1
    ds_read_b64_tr_b16 v[106:107], v24 offset:49152
    s_add_u32 s65, s65, 8192
    s_cmp_eq_u32 s65, 114688
    s_cselect_b32 s65, 0, s65
    buffer_load_dwordx4 a[96:99], v65, s[28:31], s65 offen offset:0 sc1
    ds_read_b64_tr_b16 v[108:109], v24 offset:50176
    v_lshlrev_b32 v218, 16, v88
    v_mfma_f32_32x32x16_bf16 v[154:169], a[36:39], v[118:121], v[154:169]
    buffer_load_dwordx4 a[100:103], v65, s[28:31], s65 offen offset:1024 sc1
    ds_read_b64_tr_b16 v[110:111], v25 offset:49152
    ds_read_b64_tr_b16 v[112:113], v25 offset:50176
    v_and_b32 v219, 0xffff0000, v88
    s_waitcnt vmcnt(16) lgkmcnt(8)
    v_mfma_f32_32x32x16_bf16 v[138:153], a[40:43], v[122:125], v[138:153]
    buffer_load_dwordx4 a[104:107], v65, s[28:31], s65 offen offset:2048 sc1
    ds_read_b64_tr_b16 v[114:115], v24 offset:51200
    ds_read_b64_tr_b16 v[116:117], v24 offset:52224
    v_add_f32 v218, v218, v82
    v_mfma_f32_32x32x16_bf16 v[154:169], a[40:43], v[126:129], v[154:169]
    buffer_load_dwordx4 a[108:111], v65, s[28:31], s65 offen offset:3072 sc1
    ds_read_b64_tr_b16 v[118:119], v25 offset:51200
    ds_read_b64_tr_b16 v[120:121], v25 offset:52224
    v_add_f32 v219, v219, v82
    s_waitcnt vmcnt(17) lgkmcnt(8)
    v_mfma_f32_32x32x16_bf16 v[138:153], a[44:47], v[130:133], v[138:153]
    s_add_u32 m0, s58, 0
    s_add_u32 s64, s64, 524288
    s_cmp_eq_u32 s64, 7340032
    s_cselect_b32 s64, 0, s64
    buffer_load_dwordx4 v45, s[24:27], s64 offen lds
    ds_read_b64_tr_b16 v[122:123], v24 offset:53248
    ds_read_b64_tr_b16 v[124:125], v24 offset:54272
    v_lshlrev_b32 v220, 16, v89
    v_mfma_f32_32x32x16_bf16 v[154:169], a[44:47], v[134:137], v[154:169]
    buffer_load_dwordx4 v46, s[24:27], s64 offen offset:1024 lds
    ds_read_b64_tr_b16 v[126:127], v25 offset:53248
    ds_read_b64_tr_b16 v[128:129], v25 offset:54272
    v_and_b32 v221, 0xffff0000, v89
    s_waitcnt vmcnt(18) lgkmcnt(8)
    v_mfma_f32_32x32x16_bf16 v[138:153], a[48:51], v[106:109], v[138:153]
    buffer_load_dwordx4 v47, s[24:27], s64 offen offset:2048 lds
    ds_read_b64_tr_b16 v[130:131], v24 offset:55296
    ds_read_b64_tr_b16 v[132:133], v24 offset:56320
    v_add_f32 v220, v220, v82
    v_mfma_f32_32x32x16_bf16 v[154:169], a[48:51], v[110:113], v[154:169]
    buffer_load_dwordx4 v48, s[24:27], s64 offen offset:3072 lds
    ds_read_b64_tr_b16 v[134:135], v25 offset:55296
    ds_read_b64_tr_b16 v[136:137], v25 offset:56320
    v_add_f32 v221, v221, v82
    s_waitcnt vmcnt(19) lgkmcnt(8)
    v_mfma_f32_32x32x16_bf16 v[138:153], a[52:55], v[114:117], v[138:153]
    ds_read_b64_tr_b16 v[106:107], v26 offset:0
    ds_read_b64_tr_b16 v[108:109], v26 offset:1024
    v_lshlrev_b32 v222, 16, v90
    s_add_u32 s65, s65, 8192
    s_cmp_eq_u32 s65, 114688
    s_cselect_b32 s65, 0, s65
    buffer_load_dwordx4 a[112:115], v65, s[28:31], s65 offen offset:0 sc1
    v_mfma_f32_32x32x16_bf16 v[154:169], a[52:55], v[118:121], v[154:169]
    ds_read_b64_tr_b16 v[110:111], v27 offset:0
    ds_read_b64_tr_b16 v[112:113], v27 offset:1024
    v_and_b32 v223, 0xffff0000, v90
    s_waitcnt vmcnt(19) lgkmcnt(8)
    v_mfma_f32_32x32x16_bf16 v[138:153], a[56:59], v[122:125], v[138:153]
    buffer_load_dwordx4 a[116:119], v65, s[28:31], s65 offen offset:1024 sc1
    ds_read_b64_tr_b16 v[114:115], v26 offset:2048
    ds_read_b64_tr_b16 v[116:117], v26 offset:3072
    v_add_f32 v222, v222, v82
    v_mfma_f32_32x32x16_bf16 v[154:169], a[56:59], v[126:129], v[154:169]
    buffer_load_dwordx4 a[120:123], v65, s[28:31], s65 offen offset:2048 sc1
    ds_read_b64_tr_b16 v[118:119], v27 offset:2048
    ds_read_b64_tr_b16 v[120:121], v27 offset:3072
    v_add_f32 v223, v223, v82
    s_waitcnt vmcnt(20) lgkmcnt(8)
    v_mfma_f32_32x32x16_bf16 v[138:153], a[60:63], v[130:133], v[138:153]
    buffer_load_dwordx4 a[124:127], v65, s[28:31], s65 offen offset:3072 sc1
    ds_read_b64_tr_b16 v[122:123], v26 offset:4096
    ds_read_b64_tr_b16 v[124:125], v26 offset:5120
    v_lshlrev_b32 v224, 16, v91
    v_mfma_f32_32x32x16_bf16 v[154:169], a[60:63], v[134:137], v[154:169]
    s_add_u32 m0, s58, 16384
    s_add_u32 s64, s64, 524288
    s_cmp_eq_u32 s64, 7340032
    s_cselect_b32 s64, 0, s64
    buffer_load_dwordx4 v45, s[24:27], s64 offen lds
    ds_read_b64_tr_b16 v[126:127], v27 offset:4096
    ds_read_b64_tr_b16 v[128:129], v27 offset:5120
    v_and_b32 v225, 0xffff0000, v91
    s_waitcnt vmcnt(21) lgkmcnt(8)
    v_mfma_f32_32x32x16_bf16 v[138:153], a[64:67], v[106:109], v[138:153]
    buffer_load_dwordx4 v46, s[24:27], s64 offen offset:1024 lds
    ds_read_b64_tr_b16 v[130:131], v26 offset:6144
    ds_read_b64_tr_b16 v[132:133], v26 offset:7168
    v_add_f32 v224, v224, v82
    v_mfma_f32_32x32x16_bf16 v[154:169], a[64:67], v[110:113], v[154:169]
    buffer_load_dwordx4 v47, s[24:27], s64 offen offset:2048 lds
    ds_read_b64_tr_b16 v[134:135], v27 offset:6144
    ds_read_b64_tr_b16 v[136:137], v27 offset:7168
    v_add_f32 v225, v225, v82
    s_waitcnt vmcnt(22) lgkmcnt(8)
    v_mfma_f32_32x32x16_bf16 v[138:153], a[68:71], v[114:117], v[138:153]
    buffer_load_dwordx4 v48, s[24:27], s64 offen offset:3072 lds
    ds_read_b64_tr_b16 v[106:107], v26 offset:16384
    ds_read_b64_tr_b16 v[108:109], v26 offset:17408
    v_mfma_f32_32x32x16_bf16 v[154:169], a[68:71], v[118:121], v[154:169]
    ds_read_b64_tr_b16 v[110:111], v27 offset:16384
    ds_read_b64_tr_b16 v[112:113], v27 offset:17408
    s_waitcnt vmcnt(22) lgkmcnt(8)
    v_mfma_f32_32x32x16_bf16 v[138:153], a[72:75], v[122:125], v[138:153]
    s_add_u32 s65, s65, 8192
    s_cmp_eq_u32 s65, 114688
    s_cselect_b32 s65, 0, s65
    buffer_load_dwordx4 a[128:131], v65, s[28:31], s65 offen offset:0 sc1
    ds_read_b64_tr_b16 v[114:115], v26 offset:18432
    ds_read_b64_tr_b16 v[116:117], v26 offset:19456
    v_mfma_f32_32x32x16_bf16 v[154:169], a[72:75], v[126:129], v[154:169]
    buffer_load_dwordx4 a[132:135], v65, s[28:31], s65 offen offset:1024 sc1
    ds_read_b64_tr_b16 v[118:119], v27 offset:18432
    ds_read_b64_tr_b16 v[120:121], v27 offset:19456
    s_waitcnt vmcnt(23) lgkmcnt(8)
    v_mfma_f32_32x32x16_bf16 v[138:153], a[76:79], v[130:133], v[138:153]
    buffer_load_dwordx4 a[136:139], v65, s[28:31], s65 offen offset:2048 sc1
    ds_read_b64_tr_b16 v[122:123], v26 offset:20480
    ds_read_b64_tr_b16 v[124:125], v26 offset:21504
    v_mfma_f32_32x32x16_bf16 v[154:169], a[76:79], v[134:137], v[154:169]
    buffer_load_dwordx4 a[140:143], v65, s[28:31], s65 offen offset:3072 sc1
    ds_read_b64_tr_b16 v[126:127], v27 offset:20480
    ds_read_b64_tr_b16 v[128:129], v27 offset:21504
    s_waitcnt vmcnt(24) lgkmcnt(8)
    v_mfma_f32_32x32x16_bf16 v[138:153], a[80:83], v[106:109], v[138:153]
    ds_read_b64_tr_b16 v[130:131], v26 offset:22528
    ds_read_b64_tr_b16 v[132:133], v26 offset:23552
    v_mfma_f32_32x32x16_bf16 v[154:169], a[80:83], v[110:113], v[154:169]
    ds_read_b64_tr_b16 v[134:135], v27 offset:22528
    ds_read_b64_tr_b16 v[136:137], v27 offset:23552
    s_waitcnt vmcnt(23) lgkmcnt(8)
    v_mfma_f32_32x32x16_bf16 v[138:153], a[84:87], v[114:117], v[138:153]
    s_barrier
    ds_read_b64_tr_b16 v[106:107], v26 offset:32768
    s_add_u32 s65, s65, 8192
    s_cmp_eq_u32 s65, 114688
    s_cselect_b32 s65, 0, s65
    buffer_load_dwordx4 a[144:147], v65, s[28:31], s65 offen offset:0 sc1
    ds_read_b64_tr_b16 v[108:109], v26 offset:33792
    v_mfma_f32_32x32x16_bf16 v[154:169], a[84:87], v[118:121], v[154:169]
    buffer_load_dwordx4 a[148:151], v65, s[28:31], s65 offen offset:1024 sc1
    ds_read_b64_tr_b16 v[110:111], v27 offset:32768
    ds_read_b64_tr_b16 v[112:113], v27 offset:33792
    s_waitcnt vmcnt(24) lgkmcnt(8)
    v_mfma_f32_32x32x16_bf16 v[138:153], a[88:91], v[122:125], v[138:153]
    buffer_load_dwordx4 a[152:155], v65, s[28:31], s65 offen offset:2048 sc1
    ds_read_b64_tr_b16 v[114:115], v26 offset:34816
    ds_read_b64_tr_b16 v[116:117], v26 offset:35840
    v_mfma_f32_32x32x16_bf16 v[154:169], a[88:91], v[126:129], v[154:169]
    buffer_load_dwordx4 a[156:159], v65, s[28:31], s65 offen offset:3072 sc1
    ds_read_b64_tr_b16 v[118:119], v27 offset:34816
    ds_read_b64_tr_b16 v[120:121], v27 offset:35840
    s_waitcnt vmcnt(25) lgkmcnt(8)
    v_mfma_f32_32x32x16_bf16 v[138:153], a[92:95], v[130:133], v[138:153]
    ds_read_b64_tr_b16 v[122:123], v26 offset:36864
    ds_read_b64_tr_b16 v[124:125], v26 offset:37888
    v_mfma_f32_32x32x16_bf16 v[154:169], a[92:95], v[134:137], v[154:169]
    s_add_u32 m0, s58, 32768
    s_add_u32 s64, s64, 524288
    s_cmp_eq_u32 s64, 7340032
    s_cselect_b32 s64, 0, s64
    buffer_load_dwordx4 v45, s[24:27], s64 offen lds
    ds_read_b64_tr_b16 v[126:127], v27 offset:36864
    ds_read_b64_tr_b16 v[128:129], v27 offset:37888
    s_waitcnt vmcnt(24) lgkmcnt(8)
    v_mfma_f32_32x32x16_bf16 v[138:153], a[96:99], v[106:109], v[138:153]
    buffer_load_dwordx4 v46, s[24:27], s64 offen offset:1024 lds
    ds_read_b64_tr_b16 v[130:131], v26 offset:38912
    ds_read_b64_tr_b16 v[132:133], v26 offset:39936
    v_mfma_f32_32x32x16_bf16 v[154:169], a[96:99], v[110:113], v[154:169]
    buffer_load_dwordx4 v47, s[24:27], s64 offen offset:2048 lds
    ds_read_b64_tr_b16 v[134:135], v27 offset:38912
    ds_read_b64_tr_b16 v[136:137], v27 offset:39936
    s_waitcnt vmcnt(25) lgkmcnt(8)
    v_mfma_f32_32x32x16_bf16 v[138:153], a[100:103], v[114:117], v[138:153]
    buffer_load_dwordx4 v48, s[24:27], s64 offen offset:3072 lds
    ds_read_b64_tr_b16 v[106:107], v26 offset:49152
    ds_read_b64_tr_b16 v[108:109], v26 offset:50176
    v_mfma_f32_32x32x16_bf16 v[154:169], a[100:103], v[118:121], v[154:169]
    ds_read_b64_tr_b16 v[110:111], v27 offset:49152
    ds_read_b64_tr_b16 v[112:113], v27 offset:50176
    s_waitcnt vmcnt(25) lgkmcnt(8)
    v_mfma_f32_32x32x16_bf16 v[138:153], a[104:107], v[122:125], v[138:153]
    s_add_u32 s65, s65, 8192
    s_cmp_eq_u32 s65, 114688
    s_cselect_b32 s65, 0, s65
    buffer_load_dwordx4 a[160:163], v65, s[28:31], s65 offen offset:0 sc1
    ds_read_b64_tr_b16 v[114:115], v26 offset:51200
    ds_read_b64_tr_b16 v[116:117], v26 offset:52224
    v_mfma_f32_32x32x16_bf16 v[154:169], a[104:107], v[126:129], v[154:169]
    buffer_load_dwordx4 a[164:167], v65, s[28:31], s65 offen offset:1024 sc1
    ds_read_b64_tr_b16 v[118:119], v27 offset:51200
    ds_read_b64_tr_b16 v[120:121], v27 offset:52224
    s_waitcnt vmcnt(26) lgkmcnt(8)
    v_mfma_f32_32x32x16_bf16 v[138:153], a[108:111], v[130:133], v[138:153]
    buffer_load_dwordx4 a[168:171], v65, s[28:31], s65 offen offset:2048 sc1
    ds_read_b64_tr_b16 v[122:123], v26 offset:53248
    ds_read_b64_tr_b16 v[124:125], v26 offset:54272
    v_mfma_f32_32x32x16_bf16 v[154:169], a[108:111], v[134:137], v[154:169]
    buffer_load_dwordx4 a[172:175], v65, s[28:31], s65 offen offset:3072 sc1
    ds_read_b64_tr_b16 v[126:127], v27 offset:53248
    ds_read_b64_tr_b16 v[128:129], v27 offset:54272
    s_waitcnt vmcnt(23) lgkmcnt(8)
    v_mfma_f32_32x32x16_bf16 v[138:153], a[112:115], v[106:109], v[138:153]
    ds_read_b64_tr_b16 v[130:131], v26 offset:55296
    ds_read_b64_tr_b16 v[132:133], v26 offset:56320
    v_mfma_f32_32x32x16_bf16 v[154:169], a[112:115], v[110:113], v[154:169]
    s_add_u32 m0, s58, 49152
    s_add_u32 s64, s64, 524288
    s_cmp_eq_u32 s64, 7340032
    s_cselect_b32 s64, 0, s64
    buffer_load_dwordx4 v45, s[24:27], s64 offen lds
    ds_read_b64_tr_b16 v[134:135], v27 offset:55296
    ds_read_b64_tr_b16 v[136:137], v27 offset:56320
    s_waitcnt vmcnt(23) lgkmcnt(8)
    v_mfma_f32_32x32x16_bf16 v[138:153], a[116:119], v[114:117], v[138:153]
    buffer_load_dwordx4 v46, s[24:27], s64 offen offset:1024 lds
    ds_read_b64_tr_b16 v[106:107], v28 offset:0
    ds_read_b64_tr_b16 v[108:109], v28 offset:1024
    v_mfma_f32_32x32x16_bf16 v[154:169], a[116:119], v[118:121], v[154:169]
    buffer_load_dwordx4 v47, s[24:27], s64 offen offset:2048 lds
    ds_read_b64_tr_b16 v[110:111], v29 offset:0
    ds_read_b64_tr_b16 v[112:113], v29 offset:1024
    s_waitcnt vmcnt(24) lgkmcnt(8)
    v_mfma_f32_32x32x16_bf16 v[138:153], a[120:123], v[122:125], v[138:153]
    buffer_load_dwordx4 v48, s[24:27], s64 offen offset:3072 lds
    ds_read_b64_tr_b16 v[114:115], v28 offset:2048
    ds_read_b64_tr_b16 v[116:117], v28 offset:3072
    v_mfma_f32_32x32x16_bf16 v[154:169], a[120:123], v[126:129], v[154:169]
    ds_read_b64_tr_b16 v[118:119], v29 offset:2048
    ds_read_b64_tr_b16 v[120:121], v29 offset:3072
    s_waitcnt vmcnt(24) lgkmcnt(8)
    v_mfma_f32_32x32x16_bf16 v[138:153], a[124:127], v[130:133], v[138:153]
    s_add_u32 s65, s65, 8192
    s_cmp_eq_u32 s65, 114688
    s_cselect_b32 s65, 0, s65
    buffer_load_dwordx4 a[176:179], v65, s[28:31], s65 offen offset:0 sc1
    ds_read_b64_tr_b16 v[122:123], v28 offset:4096
    ds_read_b64_tr_b16 v[124:125], v28 offset:5120
    v_mfma_f32_32x32x16_bf16 v[154:169], a[124:127], v[134:137], v[154:169]
    buffer_load_dwordx4 a[180:183], v65, s[28:31], s65 offen offset:1024 sc1
    ds_read_b64_tr_b16 v[126:127], v29 offset:4096
    ds_read_b64_tr_b16 v[128:129], v29 offset:5120
    s_waitcnt vmcnt(21) lgkmcnt(8)
    v_mfma_f32_32x32x16_bf16 v[138:153], a[128:131], v[106:109], v[138:153]
    buffer_load_dwordx4 a[184:187], v65, s[28:31], s65 offen offset:2048 sc1
    ds_read_b64_tr_b16 v[130:131], v28 offset:6144
    ds_read_b64_tr_b16 v[132:133], v28 offset:7168
    v_mfma_f32_32x32x16_bf16 v[154:169], a[128:131], v[110:113], v[154:169]
    buffer_load_dwordx4 a[188:191], v65, s[28:31], s65 offen offset:3072 sc1
    ds_read_b64_tr_b16 v[134:135], v29 offset:6144
    ds_read_b64_tr_b16 v[136:137], v29 offset:7168
    s_waitcnt vmcnt(22) lgkmcnt(8)
    v_mfma_f32_32x32x16_bf16 v[138:153], a[132:135], v[114:117], v[138:153]
    ds_read_b64_tr_b16 v[106:107], v28 offset:16384
    ds_read_b64_tr_b16 v[108:109], v28 offset:17408
    v_mfma_f32_32x32x16_bf16 v[154:169], a[132:135], v[118:121], v[154:169]
    s_add_u32 s65, s65, 8192
    s_cmp_eq_u32 s65, 114688
    s_cselect_b32 s65, 0, s65
    buffer_load_dwordx4 a[192:195], v65, s[28:31], s65 offen offset:0 sc1
    ds_read_b64_tr_b16 v[110:111], v29 offset:16384
    ds_read_b64_tr_b16 v[112:113], v29 offset:17408
    s_waitcnt vmcnt(22) lgkmcnt(8)
    v_mfma_f32_32x32x16_bf16 v[138:153], a[136:139], v[122:125], v[138:153]
    buffer_load_dwordx4 a[196:199], v65, s[28:31], s65 offen offset:1024 sc1
    ds_read_b64_tr_b16 v[114:115], v28 offset:18432
    ds_read_b64_tr_b16 v[116:117], v28 offset:19456
    v_mfma_f32_32x32x16_bf16 v[154:169], a[136:139], v[126:129], v[154:169]
    buffer_load_dwordx4 a[200:203], v65, s[28:31], s65 offen offset:2048 sc1
    ds_read_b64_tr_b16 v[118:119], v29 offset:18432
    ds_read_b64_tr_b16 v[120:121], v29 offset:19456
    s_waitcnt vmcnt(23) lgkmcnt(8)
    v_mfma_f32_32x32x16_bf16 v[138:153], a[140:143], v[130:133], v[138:153]
    buffer_load_dwordx4 a[204:207], v65, s[28:31], s65 offen offset:3072 sc1
    ds_read_b64_tr_b16 v[122:123], v28 offset:20480
    ds_read_b64_tr_b16 v[124:125], v28 offset:21504
    v_mfma_f32_32x32x16_bf16 v[154:169], a[140:143], v[134:137], v[154:169]
    ds_read_b64_tr_b16 v[126:127], v29 offset:20480
    ds_read_b64_tr_b16 v[128:129], v29 offset:21504
    s_waitcnt vmcnt(23) lgkmcnt(8)
    v_mfma_f32_32x32x16_bf16 v[138:153], a[144:147], v[106:109], v[138:153]
    buffer_load_dword v18, v23, s[28:31], 0 offen sc1
    ds_read_b64_tr_b16 v[130:131], v28 offset:22528
    ds_read_b64_tr_b16 v[132:133], v28 offset:23552
    v_mfma_f32_32x32x16_bf16 v[154:169], a[144:147], v[110:113], v[154:169]
    ds_read_b64_tr_b16 v[134:135], v29 offset:22528
    ds_read_b64_tr_b16 v[136:137], v29 offset:23552
    s_waitcnt vmcnt(23) lgkmcnt(8)
    v_mfma_f32_32x32x16_bf16 v[138:153], a[148:151], v[114:117], v[138:153]
    s_waitcnt vmcnt(9)
    s_barrier
    ds_read_b64_tr_b16 v[106:107], v24 offset:0
    s_add_u32 s65, s65, 8192
    s_cmp_eq_u32 s65, 114688
    s_cselect_b32 s65, 0, s65
    buffer_load_dwordx4 a[208:211], v65, s[28:31], s65 offen offset:0 sc1
    ds_read_b64_tr_b16 v[108:109], v24 offset:1024
    v_mfma_f32_32x32x16_bf16 v[154:169], a[148:151], v[118:121], v[154:169]
    buffer_load_dwordx4 a[212:215], v65, s[28:31], s65 offen offset:1024 sc1
    ds_read_b64_tr_b16 v[110:111], v25 offset:0
    ds_read_b64_tr_b16 v[112:113], v25 offset:1024
    s_waitcnt lgkmcnt(8)
    v_mfma_f32_32x32x16_bf16 v[138:153], a[152:155], v[122:125], v[138:153]
    buffer_load_dwordx4 a[216:219], v65, s[28:31], s65 offen offset:2048 sc1
    ds_read_b64_tr_b16 v[114:115], v24 offset:2048
    ds_read_b64_tr_b16 v[116:117], v24 offset:3072
    v_mfma_f32_32x32x16_bf16 v[154:169], a[152:155], v[126:129], v[154:169]
    buffer_load_dwordx4 a[220:223], v65, s[28:31], s65 offen offset:3072 sc1
    ds_read_b64_tr_b16 v[118:119], v25 offset:2048
    ds_read_b64_tr_b16 v[120:121], v25 offset:3072
    s_waitcnt lgkmcnt(8)
    v_mfma_f32_32x32x16_bf16 v[138:153], a[156:159], v[130:133], v[138:153]
    ds_read_b64_tr_b16 v[122:123], v24 offset:4096
    ds_read_b64_tr_b16 v[124:125], v24 offset:5120
    v_mfma_f32_32x32x16_bf16 v[154:169], a[156:159], v[134:137], v[154:169]
    ds_read_b64_tr_b16 v[126:127], v25 offset:4096
    ds_read_b64_tr_b16 v[128:129], v25 offset:5120
    s_waitcnt lgkmcnt(8)
    v_mfma_f32_32x32x16_bf16 v[138:153], a[160:163], v[106:109], v[138:153]
    ds_read_b64_tr_b16 v[130:131], v24 offset:6144
    ds_read_b64_tr_b16 v[132:133], v24 offset:7168
    v_mfma_f32_32x32x16_bf16 v[154:169], a[160:163], v[110:113], v[154:169]
    ds_read_b64_tr_b16 v[134:135], v25 offset:6144
    ds_read_b64_tr_b16 v[136:137], v25 offset:7168
    s_waitcnt lgkmcnt(8)
    v_mfma_f32_32x32x16_bf16 v[138:153], a[164:167], v[114:117], v[138:153]
    s_waitcnt vmcnt(4)
    v_cmp_ne_u32 vcc, s57, v18
    s_cbranch_vccz L_pollok7
    s_mov_b32 s60, 0
L_poll7:
    s_sleep 8
    buffer_load_dword v18, v23, s[28:31], 0 offen sc1
    s_add_u32 s60, s60, 1
    s_waitcnt vmcnt(0)
    v_cmp_ne_u32 vcc, s57, v18
    s_cbranch_vccz L_pollok7
    s_cmp_lt_u32 s60, 20000
    s_cbranch_scc1 L_poll7
L_pollok7:
    ds_read_b64_tr_b16 v[106:107], v24 offset:16384
    s_add_u32 m0, s58, 65536
    s_add_u32 s66, s66, 1
    s_and_b32 s66, s66, 7
    s_mul_i32 s61, s66, 50176
    buffer_load_dwordx4 v49, s[16:19], s61 offen lds
    ds_read_b64_tr_b16 v[108:109], v24 offset:17408
    v_mfma_f32_32x32x16_bf16 v[154:169], a[164:167], v[118:121], v[154:169]
    buffer_load_dwordx4 v50, s[16:19], s61 offen offset:1024 lds
    ds_read_b64_tr_b16 v[110:111], v25 offset:16384
    ds_read_b64_tr_b16 v[112:113], v25 offset:17408
    s_waitcnt lgkmcnt(8)
    v_mfma_f32_32x32x16_bf16 v[138:153], a[168:171], v[122:125], v[138:153]
    ds_read_b64_tr_b16 v[114:115], v24 offset:18432
    ds_read_b64_tr_b16 v[116:117], v24 offset:19456
    v_mfma_f32_32x32x16_bf16 v[154:169], a[168:171], v[126:129], v[154:169]
    s_lshl_b32 s61, s66, 11
    buffer_load_dwordx4 v51, s[28:31], s61 offen offset:2048 sc1 lds
    ds_read_b64_tr_b16 v[118:119], v25 offset:18432
    ds_read_b64_tr_b16 v[120:121], v25 offset:19456
    s_waitcnt lgkmcnt(8)
    v_mfma_f32_32x32x16_bf16 v[138:153], a[172:175], v[130:133], v[138:153]
    buffer_load_dwordx4 v52, s[28:31], s61 offen offset:3072 sc1 lds
    ds_read_b64_tr_b16 v[122:123], v24 offset:20480
    ds_read_b64_tr_b16 v[124:125], v24 offset:21504
    v_mfma_f32_32x32x16_bf16 v[154:169], a[172:175], v[134:137], v[154:169]
    ds_read_b64_tr_b16 v[126:127], v25 offset:20480
    ds_read_b64_tr_b16 v[128:129], v25 offset:21504
    s_waitcnt lgkmcnt(8)
    v_mfma_f32_32x32x16_bf16 v[138:153], a[176:179], v[106:109], v[138:153]
    s_add_u32 m0, s58, 81920
    s_add_u32 s66, s66, 1
    s_and_b32 s66, s66, 7
    s_mul_i32 s61, s66, 50176
    buffer_load_dwordx4 v49, s[16:19], s61 offen lds
    ds_read_b64_tr_b16 v[130:131], v24 offset:22528
    ds_read_b64_tr_b16 v[132:133], v24 offset:23552
    v_mfma_f32_32x32x16_bf16 v[154:169], a[176:179], v[110:113], v[154:169]
    buffer_load_dwordx4 v50, s[16:19], s61 offen offset:1024 lds
    ds_read_b64_tr_b16 v[134:135], v25 offset:22528
    ds_read_b64_tr_b16 v[136:137], v25 offset:23552
    s_waitcnt lgkmcnt(8)
    v_mfma_f32_32x32x16_bf16 v[138:153], a[180:183], v[114:117], v[138:153]
    ds_read_b64_tr_b16 v[106:107], v24 offset:32768
    ds_read_b64_tr_b16 v[108:109], v24 offset:33792
    v_mfma_f32_32x32x16_bf16 v[154:169], a[180:183], v[118:121], v[154:169]
    s_lshl_b32 s61, s66, 11
    buffer_load_dwordx4 v51, s[28:31], s61 offen offset:2048 sc1 lds
    ds_read_b64_tr_b16 v[110:111], v25 offset:32768
    ds_read_b64_tr_b16 v[112:113], v25 offset:33792
    s_waitcnt lgkmcnt(8)
    v_mfma_f32_32x32x16_bf16 v[138:153], a[184:187], v[122:125], v[138:153]
    buffer_load_dwordx4 v52, s[28:31], s61 offen offset:3072 sc1 lds
    ds_read_b64_tr_b16 v[114:115], v24 offset:34816
    ds_read_b64_tr_b16 v[116:117], v24 offset:35840
    v_mfma_f32_32x32x16_bf16 v[154:169], a[184:187], v[126:129], v[154:169]
    ds_read_b64_tr_b16 v[118:119], v25 offset:34816
    ds_read_b64_tr_b16 v[120:121], v25 offset:35840
    s_waitcnt lgkmcnt(8)
    v_mfma_f32_32x32x16_bf16 v[138:153], a[188:191], v[130:133], v[138:153]
    s_add_u32 m0, s58, 98304
    s_add_u32 s66, s66, 1
    s_and_b32 s66, s66, 7
    s_mul_i32 s61, s66, 50176
    buffer_load_dwordx4 v49, s[16:19], s61 offen lds
    ds_read_b64_tr_b16 v[122:123], v24 offset:36864
    ds_read_b64_tr_b16 v[124:125], v24 offset:37888
    v_mfma_f32_32x32x16_bf16 v[154:169], a[188:191], v[134:137], v[154:169]
    buffer_load_dwordx4 v50, s[16:19], s61 offen offset:1024 lds
    ds_read_b64_tr_b16 v[126:127], v25 offset:36864
    ds_read_b64_tr_b16 v[128:129], v25 offset:37888
    s_waitcnt lgkmcnt(8)
    v_mfma_f32_32x32x16_bf16 v[138:153], a[192:195], v[106:109], v[138:153]
    ds_read_b64_tr_b16 v[130:131], v24 offset:38912
    ds_read_b64_tr_b16 v[132:133], v24 offset:39936
    v_mfma_f32_32x32x16_bf16 v[154:169], a[192:195], v[110:113], v[154:169]
    s_lshl_b32 s61, s66, 11
    buffer_load_dwordx4 v51, s[28:31], s61 offen offset:2048 sc1 lds
    ds_read_b64_tr_b16 v[134:135], v25 offset:38912
    ds_read_b64_tr_b16 v[136:137], v25 offset:39936
    s_waitcnt lgkmcnt(8)
    v_mfma_f32_32x32x16_bf16 v[138:153], a[196:199], v[114:117], v[138:153]
    buffer_load_dwordx4 v52, s[28:31], s61 offen offset:3072 sc1 lds
    s_barrier
    ds_read_b64_tr_b16 v[106:107], v24 offset:49152
    ds_read_b64_tr_b16 v[108:109], v24 offset:50176
    v_mfma_f32_32x32x16_bf16 v[154:169], a[196:199], v[118:121], v[154:169]
    s_add_u32 m0, s58, 114688
    s_add_u32 s66, s66, 1
    s_and_b32 s66, s66, 7
    s_mul_i32 s61, s66, 50176
    buffer_load_dwordx4 v49, s[16:19], s61 offen lds
    ds_read_b64_tr_b16 v[110:111], v25 offset:49152
    ds_read_b64_tr_b16 v[112:113], v25 offset:50176
    s_waitcnt lgkmcnt(8)
    v_mfma_f32_32x32x16_bf16 v[138:153], a[200:203], v[122:125], v[138:153]
    ds_read_b64_tr_b16 v[114:115], v24 offset:51200
    ds_read_b64_tr_b16 v[116:117], v24 offset:52224
    v_mfma_f32_32x32x16_bf16 v[154:169], a[200:203], v[126:129], v[154:169]
    buffer_load_dwordx4 v50, s[16:19], s61 offen offset:1024 lds
    ds_read_b64_tr_b16 v[118:119], v25 offset:51200
    ds_read_b64_tr_b16 v[120:121], v25 offset:52224
    s_waitcnt lgkmcnt(8)
    v_mfma_f32_32x32x16_bf16 v[138:153], a[204:207], v[130:133], v[138:153]
    s_lshl_b32 s61, s66, 11
    buffer_load_dwordx4 v51, s[28:31], s61 offen offset:2048 sc1 lds
    ds_read_b64_tr_b16 v[122:123], v24 offset:53248
    ds_read_b64_tr_b16 v[124:125], v24 offset:54272
    v_mfma_f32_32x32x16_bf16 v[154:169], a[204:207], v[134:137], v[154:169]
    ds_read_b64_tr_b16 v[126:127], v25 offset:53248
    ds_read_b64_tr_b16 v[128:129], v25 offset:54272
    s_waitcnt vmcnt(18) lgkmcnt(8)
    v_mfma_f32_32x32x16_bf16 v[138:153], a[208:211], v[106:109], v[138:153]
    buffer_load_dwordx4 v52, s[28:31], s61 offen offset:3072 sc1 lds
    ds_read_b64_tr_b16 v[130:131], v24 offset:55296
    ds_read_b64_tr_b16 v[132:133], v24 offset:56320
    v_mfma_f32_32x32x16_bf16 v[154:169], a[208:211], v[110:113], v[154:169]
    s_add_u32 m0, s58, 131072
    s_add_u32 s66, s66, 1
    s_and_b32 s66, s66, 7
    s_mul_i32 s61, s66, 50176
    buffer_load_dwordx4 v49, s[16:19], s61 offen lds
    ds_read_b64_tr_b16 v[134:135], v25 offset:55296
    ds_read_b64_tr_b16 v[136:137], v25 offset:56320
    s_waitcnt vmcnt(19) lgkmcnt(8)
    v_mfma_f32_32x32x16_bf16 v[138:153], a[212:215], v[114:117], v[138:153]
    s_waitcnt vmcnt(9)
    s_barrier
    ds_read_b64_tr_b16 v[186:187], v31 offset:0
    ds_read_b64_tr_b16 v[188:189], v31 offset:4096
    ds_read_b128 v[106:109], v35 offset:0
    v_mfma_f32_32x32x16_bf16 v[154:169], a[212:215], v[118:121], v[154:169]
    buffer_load_dwordx4 v50, s[16:19], s61 offen offset:1024 lds
    ds_read_b128 v[110:113], v36 offset:0
    s_waitcnt lgkmcnt(8)
    v_mfma_f32_32x32x16_bf16 v[138:153], a[216:219], v[122:125], v[138:153]
    s_lshl_b32 s61, s66, 11
    buffer_load_dwordx4 v51, s[28:31], s61 offen offset:2048 sc1 lds
    ds_read_b64_tr_b16 v[190:191], v31 offset:1024
    ds_read_b64_tr_b16 v[192:193], v31 offset:5120
    ds_read_b128 v[114:117], v35 offset:512
    v_mfma_f32_32x32x16_bf16 v[154:169], a[216:219], v[126:129], v[154:169]
    buffer_load_dwordx4 v52, s[28:31], s61 offen offset:3072 sc1 lds
    ds_read_b128 v[118:121], v36 offset:512
    s_waitcnt lgkmcnt(8)
    v_mfma_f32_32x32x16_bf16 v[138:153], a[220:223], v[130:133], v[138:153]
    s_add_u32 m0, s58, 147456
    s_add_u32 s66, s66, 1
    s_and_b32 s66, s66, 7
    s_mul_i32 s61, s66, 50176
    buffer_load_dwordx4 v49, s[16:19], s61 offen lds
    ds_read_b64_tr_b16 v[194:195], v31 offset:16384
    ds_read_b64_tr_b16 v[196:197], v31 offset:20480
    ds_read_b128 v[122:125], v35 offset:16384
    v_mfma_f32_32x32x16_bf16 v[154:169], a[220:223], v[134:137], v[154:169]
    buffer_load_dwordx4 v50, s[16:19], s61 offen offset:1024 lds
    ds_read_b128 v[126:129], v36 offset:16384
    s_waitcnt lgkmcnt(8)
    v_mfma_f32_32x32x16_bf16 v[138:153], v[186:189], v[106:109], v[138:153]
    s_lshl_b32 s61, s66, 11
    buffer_load_dwordx4 v51, s[28:31], s61 offen offset:2048 sc1 lds
    ds_read_b64_tr_b16 v[198:199], v31 offset:17408
    ds_read_b64_tr_b16 v[200:201], v31 offset:21504
    ds_read_b128 v[130:133], v35 offset:16896
    v_mfma_f32_32x32x16_bf16 v[154:169], v[186:189], v[110:113], v[154:169]
    buffer_load_dwordx4 v52, s[28:31], s61 offen offset:3072 sc1 lds
    ds_read_b128 v[134:137], v36 offset:16896
    s_waitcnt lgkmcnt(8)
    v_mfma_f32_32x32x16_bf16 v[138:153], v[190:193], v[114:117], v[138:153]
    s_add_u32 m0, s58, 0
    s_add_u32 s66, s66, 1
    s_and_b32 s66, s66, 7
    s_mul_i32 s61, s66, 50176
    buffer_load_dwordx4 v49, s[16:19], s61 offen lds
    s_waitcnt vmcnt(9)
    s_barrier
    ds_read_b64_tr_b16 v[186:187], v31 offset:32768
    ds_read_b64_tr_b16 v[188:189], v31 offset:36864
    ds_read_b128 v[106:109], v35 offset:32768
    v_mfma_f32_32x32x16_bf16 v[154:169], v[190:193], v[118:121], v[154:169]
    buffer_load_dwordx4 v50, s[16:19], s61 offen offset:1024 lds
    ds_read_b128 v[110:113], v36 offset:32768
    s_waitcnt lgkmcnt(8)
    v_mfma_f32_32x32x16_bf16 v[138:153], v[194:197], v[122:125], v[138:153]
    s_lshl_b32 s61, s66, 11
    buffer_load_dwordx4 v51, s[28:31], s61 offen offset:2048 sc1 lds
    ds_read_b64_tr_b16 v[190:191], v31 offset:33792
    ds_read_b64_tr_b16 v[192:193], v31 offset:37888
    ds_read_b128 v[114:117], v35 offset:33280
    v_mfma_f32_32x32x16_bf16 v[154:169], v[194:197], v[126:129], v[154:169]
    buffer_load_dwordx4 v52, s[28:31], s61 offen offset:3072 sc1 lds
    ds_read_b128 v[118:121], v36 offset:33280
    s_waitcnt lgkmcnt(8)
    v_mfma_f32_32x32x16_bf16 v[138:153], v[198:201], v[130:133], v[138:153]
    s_add_u32 m0, s58, 16384
    s_add_u32 s66, s66, 1
    s_and_b32 s66, s66, 7
    s_mul_i32 s61, s66, 50176
    buffer_load_dwordx4 v49, s[16:19], s61 offen lds
    ds_read_b64_tr_b16 v[194:195], v31 offset:49152
    ds_read_b64_tr_b16 v[196:197], v31 offset:53248
    ds_read_b128 v[122:125], v35 offset:49152
    v_mfma_f32_32x32x16_bf16 v[154:169], v[198:201], v[134:137], v[154:169]
    buffer_load_dwordx4 v50, s[16:19], s61 offen offset:1024 lds
    ds_read_b128 v[126:129], v36 offset:49152
    s_waitcnt lgkmcnt(8)
    v_mfma_f32_32x32x16_bf16 v[138:153], v[186:189], v[106:109], v[138:153]
    s_lshl_b32 s61, s66, 11
    buffer_load_dwordx4 v51, s[28:31], s61 offen offset:2048 sc1 lds
    ds_read_b64_tr_b16 v[198:199], v31 offset:50176
    ds_read_b64_tr_b16 v[200:201], v31 offset:54272
    ds_read_b128 v[130:133], v35 offset:49664
    v_mfma_f32_32x32x16_bf16 v[154:169], v[186:189], v[110:113], v[154:169]
    buffer_load_dwordx4 v52, s[28:31], s61 offen offset:3072 sc1 lds
    ds_read_b128 v[134:137], v36 offset:49664
    s_waitcnt lgkmcnt(8)
    v_mfma_f32_32x32x16_bf16 v[138:153], v[190:193], v[114:117], v[138:153]
    s_waitcnt vmcnt(8)
    s_barrier
    ds_read_b64_tr_b16 v[186:187], v32 offset:0
    ds_read_b64_tr_b16 v[188:189], v32 offset:4096
    ds_read_b128 v[106:109], v37 offset:0
    v_mfma_f32_32x32x16_bf16 v[154:169], v[190:193], v[118:121], v[154:169]
    ds_read_b128 v[110:113], v38 offset:0
    s_waitcnt lgkmcnt(8)
    v_mfma_f32_32x32x16_bf16 v[138:153], v[194:197], v[122:125], v[138:153]
    ds_read_b64_tr_b16 v[190:191], v32 offset:1024
    ds_read_b64_tr_b16 v[192:193], v32 offset:5120
    ds_read_b128 v[114:117], v37 offset:512
    v_mfma_f32_32x32x16_bf16 v[154:169], v[194:197], v[126:129], v[154:169]
    ds_read_b128 v[118:121], v38 offset:512
    s_waitcnt lgkmcnt(8)
    v_mfma_f32_32x32x16_bf16 v[138:153], v[198:201], v[130:133], v[138:153]
    ds_read_b64_tr_b16 v[194:195], v32 offset:16384
    ds_read_b64_tr_b16 v[196:197], v32 offset:20480
    ds_read_b128 v[122:125], v37 offset:16384
    v_mfma_f32_32x32x16_bf16 v[154:169], v[198:201], v[134:137], v[154:169]
    ds_read_b128 v[126:129], v38 offset:16384
    s_waitcnt lgkmcnt(8)
    v_mfma_f32_32x32x16_bf16 v[138:153], v[186:189], v[106:109], v[138:153]
    ds_read_b64_tr_b16 v[198:199], v32 offset:17408
    ds_read_b64_tr_b16 v[200:201], v32 offset:21504
    ds_read_b128 v[130:133], v37 offset:16896
    v_mfma_f32_32x32x16_bf16 v[154:169], v[186:189], v[110:113], v[154:169]
    ds_read_b128 v[134:137], v38 offset:16896
    s_waitcnt lgkmcnt(8)
    v_mfma_f32_32x32x16_bf16 v[138:153], v[190:193], v[114:117], v[138:153]
    s_waitcnt vmcnt(4)
    s_barrier
    ds_read_b64_tr_b16 v[186:187], v30 offset:0
    ds_read_b64_tr_b16 v[188:189], v30 offset:4096
    ds_read_b128 v[106:109], v33 offset:0
    v_mfma_f32_32x32x16_bf16 v[154:169], v[190:193], v[118:121], v[154:169]
    ds_read_b128 v[110:113], v34 offset:0
    s_waitcnt lgkmcnt(8)
    v_mfma_f32_32x32x16_bf16 v[138:153], v[194:197], v[122:125], v[138:153]
    ds_read_b64_tr_b16 v[190:191], v30 offset:1024
    ds_read_b64_tr_b16 v[192:193], v30 offset:5120
    ds_read_b128 v[114:117], v33 offset:512
    v_mfma_f32_32x32x16_bf16 v[154:169], v[194:197], v[126:129], v[154:169]
    ds_read_b128 v[118:121], v34 offset:512
    s_waitcnt lgkmcnt(8)
    v_mfma_f32_32x32x16_bf16 v[138:153], v[198:201], v[130:133], v[138:153]
    s_waitcnt vmcnt(0)
    s_barrier
    ds_read_b64_tr_b16 v[194:195], v30 offset:16384
    ds_read_b64_tr_b16 v[196:197], v30 offset:20480
    ds_read_b128 v[122:125], v33 offset:16384
    v_mfma_f32_32x32x16_bf16 v[154:169], v[198:201], v[134:137], v[154:169]
    ds_read_b128 v[126:129], v34 offset:16384
    s_waitcnt lgkmcnt(8)
    v_mfma_f32_32x32x16_bf16 v[138:153], v[186:189], v[106:109], v[138:153]
    ds_read_b64_tr_b16 v[198:199], v30 offset:17408
    ds_read_b64_tr_b16 v[200:201], v30 offset:21504
    ds_read_b128 v[130:133], v33 offset:16896
    v_mfma_f32_32x32x16_bf16 v[154:169], v[186:189], v[110:113], v[154:169]
    ds_read_b128 v[134:137], v34 offset:16896
    s_waitcnt lgkmcnt(8)
    v_mfma_f32_32x32x16_bf16 v[138:153], v[190:193], v[114:117], v[138:153]
    v_mfma_f32_32x32x16_bf16 v[154:169], v[190:193], v[118:121], v[154:169]
    s_waitcnt lgkmcnt(4)
    v_mfma_f32_32x32x16_bf16 v[138:153], v[194:197], v[122:125], v[138:153]
    v_mfma_f32_32x32x16_bf16 v[154:169], v[194:197], v[126:129], v[154:169]
    s_waitcnt lgkmcnt(0)
    v_mfma_f32_32x32x16_bf16 v[138:153], v[198:201], v[130:133], v[138:153]
    v_mfma_f32_32x32x16_bf16 v[154:169], v[198:201], v[134:137], v[154:169]
    s_nop 10
    ds_write_b128 v73, v[138:141] offset:0
    ds_write_b128 v74, v[142:145] offset:0
    ds_write_b128 v75, v[146:149] offset:0
    ds_write_b128 v76, v[150:153] offset:0
    ds_write_b128 v73, v[154:157] offset:8192
    ds_write_b128 v74, v[158:161] offset:8192
    ds_write_b128 v75, v[162:165] offset:8192
    ds_write_b128 v76, v[166:169] offset:8192
    s_waitcnt lgkmcnt(0)
    s_barrier
    ds_read_b128 v[106:109], v77 offset:0
    ds_read_b128 v[110:113], v78 offset:0
    ds_read_b128 v[114:117], v79 offset:0
    ds_read_b128 v[118:121], v80 offset:0
    ds_read_b128 v[122:125], v77 offset:2048
    ds_read_b128 v[126:129], v78 offset:2048
    ds_read_b128 v[130:133], v79 offset:2048
    ds_read_b128 v[134:137], v80 offset:2048
    s_waitcnt lgkmcnt(7)
    v_pk_add_f32 v[210:211], v[210:211], v[106:107]
    v_pk_add_f32 v[212:213], v[212:213], v[108:109]
    s_waitcnt lgkmcnt(6)
    v_pk_add_f32 v[214:215], v[214:215], v[110:111]
    v_pk_add_f32 v[216:217], v[216:217], v[112:113]
    s_waitcnt lgkmcnt(5)
    v_pk_add_f32 v[210:211], v[210:211], v[114:115]
    v_pk_add_f32 v[212:213], v[212:213], v[116:117]
    s_waitcnt lgkmcnt(4)
    v_pk_add_f32 v[214:215], v[214:215], v[118:119]
    v_pk_add_f32 v[216:217], v[216:217], v[120:121]
    v_cvt_pk_bf16_f32 v98, v210, v211
    v_cvt_pk_bf16_f32 v99, v212, v213
    v_cvt_pk_bf16_f32 v100, v214, v215
    v_cvt_pk_bf16_f32 v101, v216, v217
    buffer_store_dwordx4 v[98:101], v71, s[32:35], 0 offen
    s_waitcnt lgkmcnt(3)
    v_pk_add_f32 v[218:219], v[218:219], v[122:123]
    v_pk_add_f32 v[220:221], v[220:221], v[124:125]
    s_waitcnt lgkmcnt(2)
    v_pk_add_f32 v[222:223], v[222:223], v[126:127]
    v_pk_add_f32 v[224:225], v[224:225], v[128:129]
    s_waitcnt lgkmcnt(1)
    v_pk_add_f32 v[218:219], v[218:219], v[130:131]
    v_pk_add_f32 v[220:221], v[220:221], v[132:133]
    s_waitcnt lgkmcnt(0)
    v_pk_add_f32 v[222:223], v[222:223], v[134:135]
    v_pk_add_f32 v[224:225], v[224:225], v[136:137]
    v_cvt_pk_bf16_f32 v102, v218, v219
    v_cvt_pk_bf16_f32 v103, v220, v221
    v_cvt_pk_bf16_f32 v104, v222, v223
    v_cvt_pk_bf16_f32 v105, v224, v225
    buffer_store_dwordx4 v[102:105], v72, s[32:35], 0 offen
L_fin:
L_end:
    s_endpgm
.section .rodata,"a"
.p2align 6
.amdhsa_kernel parallel_sum__sliding_local_dilated__mixer_token_mlp__prompt_kernel
  .amdhsa_next_free_vgpr 512
  .amdhsa_next_free_sgpr 102
  .amdhsa_accum_offset 256
  .amdhsa_group_segment_fixed_size 0
  .amdhsa_kernarg_size 88
  .amdhsa_user_sgpr_count 2
  .amdhsa_user_sgpr_kernarg_segment_ptr 1
  .amdhsa_system_sgpr_workgroup_id_x 1
.end_amdhsa_kernel
```

```asm
; @launch grid=(256,1,1) block=(256,1,1) lds=163840
.amdgcn_target "amdgcn-amd-amdhsa--gfx950"
.text
.globl parallel_sum__sliding_local_dilated__mixer_token_mlp__prompt_kernel
.p2align 8
.type parallel_sum__sliding_local_dilated__mixer_token_mlp__prompt_kernel,@function
parallel_sum__sliding_local_dilated__mixer_token_mlp__prompt_kernel:
    s_cmp_ge_u32 s2, 256
    s_cbranch_scc1 L_end
    s_load_dwordx2 s[8:9], s[0:1], 0
    s_load_dwordx2 s[20:21], s[0:1], 32
    s_load_dwordx2 s[28:29], s[0:1], 80
    s_load_dwordx2 s[44:45], s[0:1], 72
    s_load_dwordx2 s[12:13], s[0:1], 8
    s_load_dwordx2 s[16:17], s[0:1], 16
    s_load_dwordx2 s[24:25], s[0:1], 48
    s_load_dwordx2 s[32:33], s[0:1], 64
    s_load_dwordx2 s[36:37], s[0:1], 40
    s_load_dwordx2 s[40:41], s[0:1], 56
    s_memrealtime s[78:79]
    s_getpc_b64 s[6:7]
L_pc:
    s_and_b32 s3, s2, 0xf8
    v_lshrrev_b32 v14, 5, v0
    v_add_lshl_u32 v14, s3, v14, 7
    v_min_u32 v14, L_end-L_pc-4, v14
    global_load_dword v18, v14, s[6:7]
    v_lshrrev_b32 v14, 6, v0
    v_and_b32 v10, 31, v0
    v_readfirstlane_b32 s48, v14
    v_bfe_u32 v9, v0, 5, 1
    v_mul_u32_u24 v15, 896, v9
    v_lshl_add_u32 v15, v10, 4, v15
    v_cmp_gt_u32 vcc, 28, v10
    v_mov_b32 v16, 268435456
    s_mov_b32 s10, 1835008
    s_mov_b32 s11, 0x20000
    v_cndmask_b32 v15, v16, v15, vcc
    s_lshr_b32 s4, s48, 1
    s_and_b32 s5, s48, 1
    s_and_b32 s3, s2, 0xfe
    s_add_u32 s3, s3, s4
    s_lshl_b32 s3, s3, 1
    s_and_b32 s60, s2, 1
    s_add_u32 s3, s3, s60
    s_lshl_b32 s3, s3, 1
    s_add_u32 s3, s3, s5
    s_mul_i32 s3, s3, 1792
    s_waitcnt lgkmcnt(0)
    buffer_load_dwordx4 v[172:175], v15, s[8:11], s3 offen
    buffer_load_dwordx4 v[176:179], v15, s[8:11], s3 offen offset:448
    v_and_b32 v1, 63, v0
    s_mov_b32 s46, 256
    s_mov_b32 s47, 0x20000
    s_lshl_b32 s3, s48, 8
    s_add_u32 s3, s3, s2
    s_cmp_lt_u32 s3, 8
    s_cselect_b32 s3, 0, 268435456
    s_or_b32 s78, s78, 1
    v_mov_b32 v224, s78
    v_mov_b32 v225, 0
    v_lshlrev_b32 v11, 25, v1
    v_lshrrev_b32 v13, 4, v0
    v_lshlrev_b32 v13, 23, v13
    v_add_lshl_u32 v13, v13, v10, 2
    buffer_atomic_cmpswap v[224:225], v11, s[44:47], s3 offen sc1
    s_bfe_u32 s6, s2, 0x20001
    s_and_b32 s7, s2, 1
    s_and_b32 s61, s2, 7
    s_lshr_b32 s101, s2, 3
    s_mul_i32 s52, s7, 25
    s_add_u32 s52, s52, s101
    s_mul_i32 s51, s52, 37
    s_lshr_b32 s51, s51, 8
    s_mul_i32 s3, s51, 7
    s_sub_u32 s52, s52, s3
    s_and_b32 s3, s6, 1
    s_mul_i32 s3, s3, 6
    s_add_u32 s51, s51, s3
    s_add_u32 s51, s51, 1
    s_add_u32 s3, s3, s51
    s_cmp_eq_u32 s3, 7
    s_cselect_b32 s51, 0, s51
    s_lshr_b32 s59, s6, 1
    s_lshl_b32 s51, s51, 1
    s_add_u32 s51, s51, s59
    s_max_u32 s60, s101, 25
    s_sub_u32 s60, s60, 25
    s_add_u32 s3, s101, s7
    s_cmp_lt_u32 s3, 25
    s_cselect_b32 s55, 1, 0
    s_cselect_b32 s52, s52, s60
    s_mov_b32 s22, 7340032
    s_mov_b32 s23, 0x20000
    s_lshl_b32 s3, s52, 1
    s_sub_u32 s60, s3, 7
    s_cmp_ge_u32 s3, 7
    s_cselect_b32 s3, s60, s3
    s_and_b32 s3, s3, 7
    s_mul_i32 s60, s61, 2
    s_add_u32 s3, s3, s60
    s_and_b32 s3, s3, 7
    s_mul_i32 s0, s3, 458752
    s_lshl_b32 s1, s3, 13
    s_lshl_b32 s58, s48, 12
    v_lshrrev_b32 v3, 4, v1
    v_lshrrev_b32 v5, 3, v1
    v_and_b32 v6, 7, v1
    v_and_b32 v14, 1, v3
    v_lshlrev_b32 v15, 2, v14
    v_xor_b32 v15, v15, v6
    v_lshlrev_b32 v71, 4, v15
    s_cmp_eq_u32 s55, 0
    s_cbranch_scc1 L_nog1
    v_mul_u32_u24 v15, 3584, v5
    s_lshl_b32 s3, s59, 5
    s_add_u32 s3, s3, s48
    s_mul_i32 s3, s3, 114688
    s_lshl_b32 s60, s51, 7
    s_add_u32 s3, s3, s60
    v_add3_u32 v43, v15, v71, s3
    v_add_u32 v44, 27648, v43
    v_add_u32 v45, 55296, v43
    v_add_u32 v46, 82944, v43
    s_mov_b32 s38, 3584
    s_mov_b32 s39, 0x20000
    v_lshlrev_b32 v14, 3, v9
    s_lshl_b32 s3, s51, 1
    s_add_u32 s3, s3, s4
    s_lshl_b32 s3, s3, 6
    buffer_load_dwordx2 v[236:237], v14, s[36:39], s3 offen offset:0
    buffer_load_dwordx2 v[238:239], v14, s[36:39], s3 offen offset:16
    buffer_load_dwordx2 v[240:241], v14, s[36:39], s3 offen offset:32
    buffer_load_dwordx2 v[242:243], v14, s[36:39], s3 offen offset:48
    s_add_u32 m0, s58, 131072
    s_nop 0
    buffer_load_dwordx4 v43, s[20:23], s0 offen lds
    buffer_load_dwordx4 v44, s[20:23], s0 offen offset:1024 lds
    buffer_load_dwordx4 v45, s[20:23], s0 offen offset:2048 lds
    buffer_load_dwordx4 v46, s[20:23], s0 offen offset:3072 lds
    s_mul_i32 s53, s101, 37
    s_lshr_b32 s53, s53, 8
    s_mul_i32 s54, s53, 7
    s_sub_u32 s54, s101, s54
    s_and_b32 s53, s53, 3
    s_lshl_b32 s3, s6, 2
    s_add_u32 s53, s53, s3
    s_lshl_b32 s53, s53, 1
    s_add_u32 s53, s53, s7
    s_cmp_lt_u32 s101, 28
    s_cselect_b32 s56, 1, 0
    s_lshl_b32 s50, s7, 3
    s_and_b32 s3, s101, 7
    s_add_u32 s50, s50, s3
    s_lshr_b32 s60, s101, 3
    s_lshl_b32 s49, s6, 2
    s_add_u32 s49, s49, s60
    s_lshl_b32 s49, s49, 2
    s_add_u32 s49, s49, s48
    s_mul_i32 s60, s60, 0
    s_add_u32 s3, s3, s60
    s_sub_u32 s60, s3, 7
    s_cmp_ge_u32 s3, 7
    s_cselect_b32 s3, s60, s3
    s_lshl_b32 s62, s3, 18
    s_mul_i32 s63, s3, 12288
    s_mov_b32 s30, 20971520
    s_mov_b32 s31, 0x20000
    s_mov_b32 s75, 0x3727c5ac
    s_mov_b32 s76, 0x3b124925
    s_mov_b32 s77, 0x3f803f80
    v_lshlrev_b32 v4, 4, v1
    v_bfe_u32 v7, v1, 2, 2
    v_and_b32 v8, 3, v1
    v_mul_u32_u24 v14, 960, v9
    v_lshl_add_u32 v14, v10, 4, v14
    s_mul_i32 s3, s48, 1920
    s_add_u32 s3, s3, 147456
    v_add_u32 v220, s3, v14
    v_mul_u32_u24 v14, 960, v7
    v_lshl_add_u32 v14, v3, 5, v14
    v_lshl_add_u32 v14, v8, 3, v14
    s_lshl_b32 s3, s48, 8
    s_add_u32 s3, s3, 147456
    v_add_u32 v221, s3, v14
    s_lshl_b32 s3, s48, 3
    s_add_u32 s3, s3, 155648
    v_lshl_add_u32 v222, v9, 2, s3
    v_lshlrev_b32 v227, 2, v6
    v_and_b32 v2, 15, v1
    v_lshlrev_b32 v228, 14, v3
    v_add_lshl_u32 v228, v228, v2, 2
    v_add_u32 v227, 155648, v227
    v_lshlrev_b32 v14, 17, v9
    v_lshl_add_u32 v223, v10, 4, v14
    s_cmp_eq_u32 s48, 3
    s_cselect_b32 s60, 268435456, 0
    s_lshl_b32 s70, s48, 10
    s_add_u32 s70, s70, s2
    s_lshl_b32 s70, s70, 9
    s_add_u32 s71, s70, 262144
    s_add_u32 s71, s71, s60
    s_xor_b32 s60, s60, 268435456
    s_lshl_b32 s72, s2, 7
    s_add_u32 s72, s72, s60
    s_add_u32 s72, s72, 6291456
    s_lshr_b32 s74, s2, 2
    s_lshl_b32 s74, s74, 5
    s_and_b32 s3, s2, 3
    s_add_u32 s74, s74, s3
    s_lshl_b32 s74, s74, 2
    s_add_u32 s74, s74, 10485760
    v_cmp_gt_u32 vcc, 8, v0
    v_lshlrev_b32 v226, 13, v0
    v_mov_b32 v14, 268435456
    s_and_b32 s3, s2, 7
    s_lshl_b32 s3, s3, 13
    s_add_u32 s3, s3, 10485760
    v_lshrrev_b32 v15, 2, v0
    v_lshl_add_u32 v15, v15, 7, s3
    v_lshl_add_u32 v20, v8, 2, v15
    v_cndmask_b32 v226, v14, v226, vcc
    v_mov_b32 v17, 0
    s_lshl_b32 s3, s48, 14
    s_add_u32 s74, s74, s3
    s_add_u32 s73, s74, 8192
    s_waitcnt vmcnt(10)
    v_dot2_f32_bf16 v216, v172, s77, 0
    v_dot2_f32_bf16 v217, v172, v172, 0
    v_dot2_f32_bf16 v216, v173, s77, v216
    v_dot2_f32_bf16 v217, v173, v173, v217
    v_dot2_f32_bf16 v216, v174, s77, v216
    v_dot2_f32_bf16 v217, v174, v174, v217
    v_dot2_f32_bf16 v216, v175, s77, v216
    v_dot2_f32_bf16 v217, v175, v175, v217
    s_waitcnt vmcnt(9)
    v_dot2_f32_bf16 v216, v176, s77, v216
    v_dot2_f32_bf16 v217, v176, v176, v217
    v_dot2_f32_bf16 v216, v177, s77, v216
    v_dot2_f32_bf16 v217, v177, v177, v217
    v_dot2_f32_bf16 v216, v178, s77, v216
    v_dot2_f32_bf16 v217, v178, v178, v217
    v_dot2_f32_bf16 v216, v179, s77, v216
    v_dot2_f32_bf16 v217, v179, v179, v217
    buffer_load_dword v12, v17, s[44:47], 0 offen sc1
    v_lshlrev_b32 v180, 16, v172
    v_and_b32 v181, 0xffff0000, v172
    v_add_f32_dpp v216, v216, v216 quad_perm:[1,0,3,2] row_mask:0xf bank_mask:0xf
    v_add_f32_dpp v217, v217, v217 quad_perm:[1,0,3,2] row_mask:0xf bank_mask:0xf
    v_lshlrev_b32 v182, 16, v173
    v_add_f32_dpp v216, v216, v216 quad_perm:[2,3,0,1] row_mask:0xf bank_mask:0xf
    v_add_f32_dpp v217, v217, v217 quad_perm:[2,3,0,1] row_mask:0xf bank_mask:0xf
    v_and_b32 v183, 0xffff0000, v173
    v_add_f32_dpp v216, v216, v216 row_half_mirror row_mask:0xf bank_mask:0xf
    v_add_f32_dpp v217, v217, v217 row_half_mirror row_mask:0xf bank_mask:0xf
    v_lshlrev_b32 v184, 16, v174
    v_add_f32_dpp v216, v216, v216 row_mirror row_mask:0xf bank_mask:0xf
    v_add_f32_dpp v217, v217, v217 row_mirror row_mask:0xf bank_mask:0xf
    v_and_b32 v185, 0xffff0000, v174
    v_mov_b32 v218, v216
    v_mov_b32 v219, v217
    v_lshlrev_b32 v186, 16, v175
    v_permlane16_swap_b32 v216, v218
    v_permlane16_swap_b32 v217, v219
    v_add_f32 v216, v216, v218
    v_add_f32 v217, v217, v219
    v_mul_f32_e64 v216, -v216, s76
    v_mul_f32 v218, v216, v216
    v_fma_f32 v217, v217, s76, -v218
    v_max_f32 v217, 0, v217
    v_add_f32 v218, s75, v217
    v_rsq_f32 v212, v218
    v_and_b32 v187, 0xffff0000, v175
    v_mul_f32 v218, v212, v212
    v_fma_f32 v219, v218, v217, s75
    v_rsq_f32 v218, v219
    v_mul_f32 v213, v216, v212
    v_mul_f32 v214, v212, v218
    v_mul_f32 v215, v213, v218
    v_mul_f32 v219, v219, v218
    ds_write_b32 v222, v219
    v_lshlrev_b32 v188, 16, v176
    v_and_b32 v189, 0xffff0000, v176
    v_lshlrev_b32 v190, 16, v177
    v_and_b32 v191, 0xffff0000, v177
    v_lshlrev_b32 v192, 16, v178
    v_and_b32 v193, 0xffff0000, v178
    v_lshlrev_b32 v194, 16, v179
    v_and_b32 v195, 0xffff0000, v179
    v_pk_fma_f32 v[196:197], v[180:181], v[214:215], v[214:215] op_sel:[0,0,1] op_sel_hi:[1,0,1]
    v_pk_fma_f32 v[198:199], v[182:183], v[214:215], v[214:215] op_sel:[0,0,1] op_sel_hi:[1,0,1]
    v_pk_fma_f32 v[200:201], v[184:185], v[214:215], v[214:215] op_sel:[0,0,1] op_sel_hi:[1,0,1]
    v_pk_fma_f32 v[202:203], v[186:187], v[214:215], v[214:215] op_sel:[0,0,1] op_sel_hi:[1,0,1]
    v_cvt_pk_bf16_f32 v172, v196, v197
    v_cvt_pk_bf16_f32 v173, v198, v199
    v_cvt_pk_bf16_f32 v174, v200, v201
    v_cvt_pk_bf16_f32 v175, v202, v203
    ds_write_b128 v220, v[172:175] offset:0
    v_pk_fma_f32 v[204:205], v[188:189], v[214:215], v[214:215] op_sel:[0,0,1] op_sel_hi:[1,0,1]
    v_pk_fma_f32 v[206:207], v[190:191], v[214:215], v[214:215] op_sel:[0,0,1] op_sel_hi:[1,0,1]
    v_pk_fma_f32 v[208:209], v[192:193], v[214:215], v[214:215] op_sel:[0,0,1] op_sel_hi:[1,0,1]
    v_pk_fma_f32 v[210:211], v[194:195], v[214:215], v[214:215] op_sel:[0,0,1] op_sel_hi:[1,0,1]
    v_cvt_pk_bf16_f32 v176, v204, v205
    v_cvt_pk_bf16_f32 v177, v206, v207
    v_cvt_pk_bf16_f32 v178, v208, v209
    v_cvt_pk_bf16_f32 v179, v210, v211
    ds_write_b128 v220, v[176:179] offset:448
    s_waitcnt lgkmcnt(0)
    s_barrier
    ds_read_b64_tr_b16 v[100:101], v221 offset:0
    ds_read_b64_tr_b16 v[102:103], v221 offset:3840
    ds_read_b64_tr_b16 v[104:105], v221 offset:128
    ds_read_b64_tr_b16 v[106:107], v221 offset:3968
    ds_read_b32 v219, v227
    s_waitcnt lgkmcnt(3)
    buffer_store_dwordx4 v[100:103], v223, s[28:31], s70 offen sc1
    s_waitcnt lgkmcnt(1)
    buffer_store_dwordx4 v[104:107], v223, s[28:31], s71 offen sc1
    v_cmp_gt_u32 vcc, 16, v1
    s_waitcnt lgkmcnt(0)
    s_nop 0
    v_cndmask_b32 v219, 0, v219, vcc
    buffer_store_dword v219, v228, s[28:31], s72 offen sc1
    s_mov_b32 s42, 4096
    s_mov_b32 s43, 0x20000
    s_lshl_b32 s3, s53, 2
    s_add_u32 s3, s3, s48
    s_lshl_b32 s7, s3, 5
    v_lshl_add_u32 v70, v5, 1, s7
    s_mul_i32 s3, s3, 14336
    s_lshl_b32 s6, s54, 7
    s_add_u32 s3, s3, s6
    v_mul_u32_u24 v15, 896, v5
    v_lshl_add_u32 v15, v6, 4, v15
    v_add_u32 v73, s3, v15
    v_add_u32 v74, 7168, v73
    s_add_u32 m0, s58, 0
    v_xor_b32 v43, 128, v43
    buffer_load_dwordx4 v43, s[20:23], s0 offen lds
    v_xor_b32 v44, 128, v44
    buffer_load_dwordx4 v44, s[20:23], s0 offen offset:1024 lds
    v_xor_b32 v45, 128, v45
    buffer_load_dwordx4 v45, s[20:23], s0 offen offset:2048 lds
    v_xor_b32 v46, 128, v46
    buffer_load_dwordx4 v46, s[20:23], s0 offen offset:3072 lds
    s_mov_b32 s18, 401408
    s_mov_b32 s19, 0x20000
    s_mov_b32 s26, 7340032
    s_mov_b32 s27, 0x20000
    s_mov_b32 s34, 1835008
    s_mov_b32 s35, 0x20000
    s_mov_b32 s36, 1
    v_lshl_add_u32 v15, v9, 2, v7
    v_lshlrev_b32 v15, 7, v15
    v_lshl_add_u32 v15, v8, 3, v15
    v_and_b32 v16, 2, v7
    v_and_b32 v14, 1, v3
    v_add_u32 v16, v16, v14
    v_lshl_add_u32 v15, v16, 5, v15
    s_mul_i32 s3, s4, 8256
    v_xor_b32 v26, s3, v15
    v_xor_b32 v27, 64, v26
    v_add_u32 v28, 65536, v26
    v_add_u32 v29, 65536, v27
    v_add_u32 v30, 131072, v26
    v_add_u32 v31, 131072, v27
    s_lshl_b32 s6, s52, 1
    s_add_u32 s6, s6, s5
    s_lshl_b32 s3, s6, 1
    s_add_u32 s3, s3, s59
    s_lshl_b32 s3, s3, 4
    s_add_u32 s3, s3, s4
    s_lshl_b32 s3, s3, 12
    v_add_u32 v66, s3, v4
    s_xor_b32 s37, s51, 1
    s_lshl_b32 s37, s37, 3
    s_add_u32 s37, s37, s52
    s_lshl_b32 s3, s37, 14
    s_add_u32 s3, s3, s58
    s_add_u32 s3, s3, 16777216
    v_add_u32 v24, s3, v4
    s_lshl_b32 s37, s37, 5
    s_add_u32 s37, s37, s5
    s_lshl_b32 s37, s37, 2
    s_add_u32 s37, s37, 6422528
    s_mul_i32 s67, s6, 56
    s_lshl_b32 s3, s51, 1
    s_add_u32 s3, s3, s4
    s_add_u32 s67, s67, s3
    s_lshl_b32 s67, s67, 11
    s_add_u32 s67, s67, 2097152
    v_add_u32 v69, s58, v4
    s_lshl_b32 s68, s52, 2
    s_and_b32 s3, s51, 1
    s_add_u32 s68, s68, s3
    s_cmp_ge_u32 s51, 14
    s_cselect_b32 s3, 2, 0
    s_add_u32 s68, s68, s3
    s_lshl_b32 s68, s68, 7
    s_add_u32 s68, s68, 6356992
    s_waitcnt vmcnt(7)
    v_readfirstlane_b32 s57, v12
    s_mov_b32 s60, 0
    s_cmp_lg_u32 s57, 0
    s_cbranch_scc1 L_nonce_ok
L_nonce:
    buffer_load_dword v12, v17, s[44:47], 0 offen sc1
    s_add_u32 s60, s60, 1
    s_waitcnt vmcnt(0)
    v_readfirstlane_b32 s57, v12
    s_cmp_ge_u32 s60, 20000
    s_cbranch_scc1 L_nonce_ok
    s_cmp_eq_u32 s57, 0
    s_cbranch_scc1 L_nonce
L_nonce_ok:
    s_waitcnt vmcnt(4)
    s_barrier
    s_atomic_swap s57, s[28:29], s74
    s_atomic_swap s57, s[28:29], s73
    buffer_load_dwordx4 v[86:89], v73, s[8:11], 0 offen
    buffer_load_ushort v83, v70, s[40:43], 0 offen offset:0
    buffer_load_dwordx4 v[90:93], v74, s[8:11], 0 offen
    buffer_load_ushort v84, v70, s[40:43], 0 offen offset:16
    v_add_u32 v41, 65536, v4
    s_add_u32 m0, s58, 16384
    s_add_u32 s0, s0, 458752
    s_cmp_eq_u32 s0, 3670016
    s_cselect_b32 s0, 0, s0
    buffer_load_dwordx4 v43, s[20:23], s0 offen lds
    v_add_u32 v42, 131072, v4
    s_mul_i32 s59, s48, 3072
    s_mul_i32 s3, s50, 86016
    s_add_u32 s3, s3, s59
    s_add_u32 s3, s3, 8388608
    v_add_u32 v68, s3, v4
    v_lshlrev_b32 v15, 7, v9
    v_xor_b32 v15, v15, v4
    s_lshl_b32 s3, s49, 11
    v_add_u32 v55, s3, v15
    v_add_u32 v56, 129024, v55
    s_lshr_b32 s3, s49, 2
    s_lshl_b32 s3, s3, 3
    s_max_u32 s3, s3, 1
    s_sub_u32 s3, s3, 1
    s_lshl_b32 s3, s3, 10
    s_lshl_b32 s6, s5, 17
    s_add_u32 s3, s3, s6
    s_lshl_b32 s6, s4, 28
    s_add_u32 s3, s3, s6
    v_add_u32 v57, s3, v15
    buffer_load_dwordx4 v44, s[20:23], s0 offen offset:1024 lds
    s_lshl_b32 s100, s5, 1
    s_add_u32 s100, s100, s4
    s_lshl_b32 s100, s100, 10
    v_and_b32 v15, 1, v1
    v_mul_u32_u24 v15, 640, v15
    v_lshrrev_b32 v16, 2, v1
    v_lshlrev_b32 v16, 4, v16
    v_xor_b32 v15, v15, v16
    v_bfe_u32 v16, v1, 1, 1
    v_lshl_add_u32 v15, v16, 3, v15
    buffer_load_dwordx4 v45, s[20:23], s0 offen offset:2048 lds
    s_add_u32 s3, s58, 12288
    v_add_u32 v58, s3, v15
    s_sub_u32 s3, s3, 3072
    s_cmp_eq_u32 s48, 0
    s_cselect_b32 s3, 28672, s3
    v_add_u32 v59, s3, v15
    v_add_u32 v60, 65536, v58
    v_add_u32 v61, 65536, v59
    v_add_u32 v62, 131072, v58
    v_add_u32 v63, 131072, v59
    s_lshl_b32 s3, s49, 1
    v_min_u32 v15, 2, v3
    v_add_u32 v15, s3, v15
    v_max_u32 v15, 1, v15
    v_lshlrev_b32 v15, 1, v15
    v_and_b32 v16, 1, v7
    buffer_load_dwordx4 v46, s[20:23], s0 offen offset:3072 lds
    v_add_lshl_u32 v15, v15, v16, 7
    v_lshrrev_b32 v16, 1, v7
    v_lshl_add_u32 v16, v16, 2, v8
    v_lshl_add_u32 v15, v16, 2, v15
    v_add_u32 v65, 6291200, v15
    v_min_u32 v15, 41, v1
    v_lshlrev_b32 v15, 6, v15
    v_add_u32 v21, 10747904, v15
    s_lshl_b32 s82, s49, 5
    s_add_u32 s82, s82, s50
    s_lshl_b32 s82, s82, 10
    s_add_u32 s82, s82, 4194304
    s_lshr_b32 s69, s49, 2
    s_lshl_b32 s69, s69, 1
    s_and_b32 s3, s50, 1
    s_add_u32 s69, s69, s3
    s_lshl_b32 s69, s69, 7
    s_add_u32 s69, s69, 6361088
    s_and_b32 s7, s53, 1
    s_mul_i32 s3, s7, 28
    s_add_u32 s3, s3, s48
    s_lshl_b32 s3, s3, 17
    s_xor_b32 s6, s53, 1
    s_lshl_b32 s55, s6, 3
    s_lshl_b32 s6, s53, 7
    s_add_u32 s3, s3, s6
    v_lshlrev_b32 v15, 12, v5
    s_add_u32 m0, s58, 32768
    s_add_u32 s0, s0, 458752
    s_cmp_eq_u32 s0, 3670016
    s_cselect_b32 s0, 0, s0
    buffer_load_dwordx4 v43, s[20:23], s0 offen lds
    v_add3_u32 v47, v15, v71, s3
    v_add_u32 v48, 31744, v47
    v_add_u32 v49, 63488, v47
    v_add_u32 v50, 95232, v47
    v_mul_u32_u24 v15, 896, v5
    s_mul_i32 s3, s4, 25088
    s_mul_i32 s6, s5, 14336
    s_add_u32 s3, s3, s6
    s_lshl_b32 s6, s54, 7
    s_add_u32 s3, s3, s6
    v_add3_u32 v51, v15, v71, s3
    buffer_load_dwordx4 v44, s[20:23], s0 offen offset:1024 lds
    v_add_u32 v52, 6144, v51
    s_lshl_b32 s6, s53, 1
    s_add_u32 s6, s6, s5
    s_and_b32 s3, s53, 30
    s_add_u32 s3, s3, s4
    s_lshl_b32 s3, s3, 7
    s_add_u32 s39, s3, 6361088
    s_lshl_b32 s3, s6, 5
    s_add_u32 s3, s3, s4
    s_lshl_b32 s3, s3, 10
    s_add_u32 s3, s3, 4194304
    v_add_u32 v53, s3, v4
    v_add_u32 v54, 15360, v53
    s_xor_b32 s3, s4, s5
    s_lshl_b32 s3, s3, 6
    v_xor_b32 v32, s3, v26
    buffer_load_dwordx4 v45, s[20:23], s0 offen offset:2048 lds
    v_add_u32 v33, 65536, v32
    v_add_u32 v34, 131072, v32
    v_lshlrev_b32 v14, 10, v14
    v_lshl_add_u32 v14, v9, 8, v14
    v_lshl_add_u32 v14, v2, 4, v14
    s_mul_i32 s3, s4, 12288
    v_add_u32 v35, s3, v14
    v_xor_b32 v36, 4096, v35
    v_add_u32 v37, 65536, v35
    v_add_u32 v38, 65536, v36
    v_add_u32 v39, 131072, v35
    v_add_u32 v40, 131072, v36
    s_lshl_b32 s6, s54, 1
    s_add_u32 s6, s6, s5
    s_lshl_b32 s3, s6, 1
    s_add_u32 s3, s3, s7
    s_mul_i32 s3, s3, 14
    s_add_u32 s3, s3, s4
    s_lshl_b32 s3, s3, 12
    s_add_u32 s3, s3, 2097152
    v_add_u32 v67, s3, v4
    buffer_load_dwordx4 v46, s[20:23], s0 offen offset:3072 lds
    s_lshl_b32 s3, s54, 1
    s_add_u32 s3, s3, s7
    s_lshl_b32 s3, s3, 1
    s_add_u32 s3, s3, s4
    s_lshl_b32 s3, s3, 7
    s_add_u32 s38, s3, 6356992
    s_and_b32 s3, s2, 6
    s_add_u32 s3, s3, s54
    s_sub_u32 s6, s3, 7
    s_cmp_ge_u32 s3, 7
    s_cselect_b32 s3, s6, s3
    s_lshl_b32 s64, s3, 19
    s_lshl_b32 s65, s3, 13
    s_add_u32 s55, s55, s54
    s_lshl_b32 s3, s55, 14
    s_add_u32 s3, s3, s58
    s_add_u32 s3, s3, 12582912
    v_add_u32 v22, s3, v4
    s_add_u32 m0, s58, 49152
    s_add_u32 s0, s0, 458752
    s_cmp_eq_u32 s0, 3670016
    s_cselect_b32 s0, 0, s0
    buffer_load_dwordx4 v43, s[20:23], s0 offen lds
    s_lshl_b32 s55, s55, 5
    s_add_u32 s55, s55, s48
    s_lshl_b32 s55, s55, 2
    s_add_u32 s55, s55, 6488064
    s_lshl_b32 s3, s5, 3
    v_add_u32 v14, s3, v9
    v_xor_b32 v14, v14, v6
    v_lshlrev_b32 v14, 4, v14
    v_lshl_add_u32 v14, v10, 8, v14
    buffer_load_dwordx4 v44, s[20:23], s0 offen offset:1024 lds
    s_lshl_b32 s3, s4, 14
    s_add_u32 s3, s3, 131072
    v_add_u32 v75, s3, v14
    v_xor_b32 v76, 32, v75
    v_xor_b32 v77, 64, v75
    v_xor_b32 v78, 96, v75
    s_lshr_b32 s3, s53, 1
    s_add_u32 s66, s3, s54
    v_lshlrev_b32 v14, 1, v6
    v_xor_b32 v14, v14, v5
    v_lshlrev_b32 v14, 4, v14
    v_lshl_add_u32 v14, v5, 8, v14
    s_add_u32 s3, s58, 131072
    v_add_u32 v79, s3, v14
    v_xor_b32 v80, 16, v79
    v_xor_b32 v81, 24576, v79
    buffer_load_dwordx4 v45, s[20:23], s0 offen offset:2048 lds
    v_xor_b32 v82, 24592, v79
    v_lshlrev_b32 v140, 16, v236
    v_and_b32 v141, 0xffff0000, v236
    v_lshlrev_b32 v142, 16, v237
    v_and_b32 v143, 0xffff0000, v237
    v_lshlrev_b32 v144, 16, v238
    v_and_b32 v145, 0xffff0000, v238
    v_lshlrev_b32 v146, 16, v239
    v_and_b32 v147, 0xffff0000, v239
    v_lshlrev_b32 v148, 16, v240
    v_and_b32 v149, 0xffff0000, v240
    v_lshlrev_b32 v150, 16, v241
    v_and_b32 v151, 0xffff0000, v241
    v_lshlrev_b32 v152, 16, v242
    v_and_b32 v153, 0xffff0000, v242
    v_lshlrev_b32 v154, 16, v243
    buffer_load_dwordx4 v46, s[20:23], s0 offen offset:3072 lds
    v_and_b32 v155, 0xffff0000, v243
    s_add_u32 m0, s58, 65536
    s_add_u32 s0, s0, 458752
    s_cmp_eq_u32 s0, 3670016
    s_cselect_b32 s0, 0, s0
    buffer_load_dwordx4 v43, s[20:23], s0 offen lds
    buffer_load_dwordx4 v44, s[20:23], s0 offen offset:1024 lds
    buffer_load_dwordx4 v45, s[20:23], s0 offen offset:2048 lds
    buffer_load_dwordx4 v46, s[20:23], s0 offen offset:3072 lds
    buffer_load_dword v18, v20, s[28:31], 0 offen sc1
    s_add_u32 m0, s58, 81920
    s_add_u32 s0, s0, 458752
    s_cmp_eq_u32 s0, 3670016
    s_cselect_b32 s0, 0, s0
    buffer_load_dwordx4 v43, s[20:23], s0 offen lds
    buffer_load_dwordx4 v44, s[20:23], s0 offen offset:1024 lds
    buffer_load_dwordx4 v45, s[20:23], s0 offen offset:2048 lds
    buffer_load_dwordx4 v46, s[20:23], s0 offen offset:3072 lds
    s_add_u32 m0, s58, 98304
    s_add_u32 s0, s0, 458752
    s_cmp_eq_u32 s0, 3670016
    s_cselect_b32 s0, 0, s0
    buffer_load_dwordx4 v43, s[20:23], s0 offen lds
    buffer_load_dwordx4 v44, s[20:23], s0 offen offset:1024 lds
    buffer_load_dwordx4 v45, s[20:23], s0 offen offset:2048 lds
    buffer_load_dwordx4 v46, s[20:23], s0 offen offset:3072 lds
    s_waitcnt vmcnt(8)
    v_cmp_ne_u32 vcc, s57, v18
    s_cbranch_vccz L_pollok0
    s_mov_b32 s60, 0
L_poll0:
    s_sleep 4
    buffer_load_dword v18, v20, s[28:31], 0 offen sc1
    s_add_u32 s60, s60, 1
    s_waitcnt vmcnt(0)
    v_cmp_ne_u32 vcc, s57, v18
    s_cbranch_vccz L_pollok0
    s_cmp_lt_u32 s60, 20000
    s_cbranch_scc1 L_poll0
L_pollok0:
    s_barrier
    buffer_load_dwordx4 a[0:3], v66, s[28:31], s1 offen offset:0 sc1
    buffer_load_dwordx4 a[4:7], v66, s[28:31], s1 offen offset:1024 sc1
    buffer_load_dwordx4 a[8:11], v66, s[28:31], s1 offen offset:2048 sc1
    buffer_load_dwordx4 a[12:15], v66, s[28:31], s1 offen offset:3072 sc1
    s_add_u32 s1, s1, 8192
    s_and_b32 s1, s1, 0xffff
    buffer_load_dwordx4 a[16:19], v66, s[28:31], s1 offen offset:0 sc1
    buffer_load_dwordx4 a[20:23], v66, s[28:31], s1 offen offset:1024 sc1
    buffer_load_dwordx4 a[24:27], v66, s[28:31], s1 offen offset:2048 sc1
    buffer_load_dwordx4 a[28:31], v66, s[28:31], s1 offen offset:3072 sc1
    s_add_u32 s1, s1, 8192
    s_and_b32 s1, s1, 0xffff
    buffer_load_dwordx4 a[32:35], v66, s[28:31], s1 offen offset:0 sc1
    buffer_load_dwordx4 a[36:39], v66, s[28:31], s1 offen offset:1024 sc1
    buffer_load_dwordx4 a[40:43], v66, s[28:31], s1 offen offset:2048 sc1
    buffer_load_dwordx4 a[44:47], v66, s[28:31], s1 offen offset:3072 sc1
    ds_read_b64_tr_b16 v[108:109], v26 offset:0
    s_add_u32 s1, s1, 8192
    s_and_b32 s1, s1, 0xffff
    buffer_load_dwordx4 a[48:51], v66, s[28:31], s1 offen offset:0 sc1
    ds_read_b64_tr_b16 v[110:111], v26 offset:1024
    ds_read_b64_tr_b16 v[112:113], v27 offset:0
    ds_read_b64_tr_b16 v[114:115], v27 offset:1024
    ds_read_b64_tr_b16 v[116:117], v26 offset:2048
    ds_read_b64_tr_b16 v[118:119], v26 offset:3072
    ds_read_b64_tr_b16 v[120:121], v27 offset:2048
    ds_read_b64_tr_b16 v[122:123], v27 offset:3072
    ds_read_b64_tr_b16 v[124:125], v26 offset:4096
    ds_read_b64_tr_b16 v[126:127], v26 offset:5120
    ds_read_b64_tr_b16 v[128:129], v27 offset:4096
    ds_read_b64_tr_b16 v[130:131], v27 offset:5120
    s_waitcnt vmcnt(12) lgkmcnt(8)
    v_mfma_f32_32x32x16_bf16 v[172:187], v[108:111], a[0:3], 0
    buffer_load_dwordx4 a[52:55], v66, s[28:31], s1 offen offset:1024 sc1
    ds_read_b64_tr_b16 v[132:133], v26 offset:6144
    ds_read_b64_tr_b16 v[134:135], v26 offset:7168
    s_mov_b32 s70, 0xaaaaaaaa
    v_mfma_f32_32x32x16_bf16 v[188:203], v[112:115], a[0:3], 0
    buffer_load_dwordx4 a[56:59], v66, s[28:31], s1 offen offset:2048 sc1
    ds_read_b64_tr_b16 v[136:137], v27 offset:6144
    ds_read_b64_tr_b16 v[138:139], v27 offset:7168
    s_mov_b32 s71, 0xaaaaaaaa
    s_waitcnt vmcnt(13) lgkmcnt(8)
    v_mfma_f32_32x32x16_bf16 v[172:187], v[116:119], a[4:7], v[172:187]
    buffer_load_dwordx4 a[60:63], v66, s[28:31], s1 offen offset:3072 sc1
    ds_read_b64_tr_b16 v[108:109], v26 offset:16384
    ds_read_b64_tr_b16 v[110:111], v26 offset:17408
    s_mov_b32 s72, 0xfff0ffff
    v_mfma_f32_32x32x16_bf16 v[188:203], v[120:123], a[4:7], v[188:203]
    s_add_u32 m0, s58, 114688
    s_add_u32 s0, s0, 458752
    s_cmp_eq_u32 s0, 3670016
    s_cselect_b32 s0, 0, s0
    buffer_load_dwordx4 v43, s[20:23], s0 offen lds
    ds_read_b64_tr_b16 v[112:113], v27 offset:16384
    ds_read_b64_tr_b16 v[114:115], v27 offset:17408
    s_mov_b32 s73, 0xf000ff00
    s_waitcnt vmcnt(14) lgkmcnt(8)
    v_mfma_f32_32x32x16_bf16 v[172:187], v[124:127], a[8:11], v[172:187]
    buffer_load_dwordx4 v44, s[20:23], s0 offen offset:1024 lds
    ds_read_b64_tr_b16 v[116:117], v26 offset:18432
    ds_read_b64_tr_b16 v[118:119], v26 offset:19456
    s_mov_b32 s74, 0xffc0fffc
    v_mfma_f32_32x32x16_bf16 v[188:203], v[128:131], a[8:11], v[188:203]
    buffer_load_dwordx4 v45, s[20:23], s0 offen offset:2048 lds
    ds_read_b64_tr_b16 v[120:121], v27 offset:18432
    ds_read_b64_tr_b16 v[122:123], v27 offset:19456
    s_mov_b32 s75, 0xc000fc00
    s_waitcnt vmcnt(15) lgkmcnt(8)
    v_mfma_f32_32x32x16_bf16 v[172:187], v[132:135], a[12:15], v[172:187]
    buffer_load_dwordx4 v46, s[20:23], s0 offen offset:3072 lds
    ds_read_b64_tr_b16 v[124:125], v26 offset:20480
    ds_read_b64_tr_b16 v[126:127], v26 offset:21504
    s_cmp_eq_u32 s49, 0
    s_cselect_b64 s[76:77], 0, -1
    v_mfma_f32_32x32x16_bf16 v[188:203], v[136:139], a[12:15], v[188:203]
    s_add_u32 s1, s1, 8192
    s_and_b32 s1, s1, 0xffff
    buffer_load_dwordx4 a[64:67], v66, s[28:31], s1 offen offset:0 sc1
    ds_read_b64_tr_b16 v[128:129], v27 offset:20480
    ds_read_b64_tr_b16 v[130:131], v27 offset:21504
    v_mov_b32 v14, 0xffff
    buffer_load_dwordx4 a[68:71], v66, s[28:31], s1 offen offset:1024 sc1
    s_waitcnt vmcnt(17) lgkmcnt(8)
    v_mfma_f32_32x32x16_bf16 v[172:187], v[108:111], a[16:19], v[172:187]
    buffer_load_dwordx4 a[72:75], v66, s[28:31], s1 offen offset:2048 sc1
    ds_read_b64_tr_b16 v[132:133], v26 offset:22528
    ds_read_b64_tr_b16 v[134:135], v26 offset:23552
    v_mov_b32 v15, 0xffff0000
    v_mfma_f32_32x32x16_bf16 v[188:203], v[112:115], a[16:19], v[188:203]
    buffer_load_dwordx4 a[76:79], v66, s[28:31], s1 offen offset:3072 sc1
    ds_read_b64_tr_b16 v[136:137], v27 offset:22528
    ds_read_b64_tr_b16 v[138:139], v27 offset:23552
    v_cndmask_b32 v14, v14, v15, s[70:71]
    s_waitcnt vmcnt(18) lgkmcnt(8)
    v_mfma_f32_32x32x16_bf16 v[172:187], v[116:119], a[20:23], v[172:187]
    s_add_u32 m0, s58, 147456
    s_add_u32 s0, s0, 458752
    s_cmp_eq_u32 s0, 3670016
    s_cselect_b32 s0, 0, s0
    s_add_u32 s0, s0, 458752
    s_cmp_eq_u32 s0, 3670016
    s_cselect_b32 s0, 0, s0
    v_xor_b32 v43, 128, v43
    buffer_load_dwordx4 v43, s[20:23], s0 offen lds
    ds_read_b64_tr_b16 v[108:109], v26 offset:32768
    ds_read_b64_tr_b16 v[110:111], v26 offset:33792
    v_cndmask_b32 v94, v14, 0, s[72:73]
    v_mfma_f32_32x32x16_bf16 v[188:203], v[120:123], a[20:23], v[188:203]
    v_xor_b32 v44, 128, v44
    buffer_load_dwordx4 v44, s[20:23], s0 offen offset:1024 lds
    ds_read_b64_tr_b16 v[112:113], v27 offset:32768
    ds_read_b64_tr_b16 v[114:115], v27 offset:33792
    v_cndmask_b32 v96, 0, v14, s[72:73]
    s_waitcnt vmcnt(19) lgkmcnt(8)
    v_mfma_f32_32x32x16_bf16 v[172:187], v[124:127], a[24:27], v[172:187]
    v_xor_b32 v45, 128, v45
    buffer_load_dwordx4 v45, s[20:23], s0 offen offset:2048 lds
    ds_read_b64_tr_b16 v[116:117], v26 offset:34816
    ds_read_b64_tr_b16 v[118:119], v26 offset:35840
    v_cndmask_b32 v95, v14, 0, s[74:75]
    v_mfma_f32_32x32x16_bf16 v[188:203], v[128:131], a[24:27], v[188:203]
    v_xor_b32 v46, 128, v46
    buffer_load_dwordx4 v46, s[20:23], s0 offen offset:3072 lds
    ds_read_b64_tr_b16 v[120:121], v27 offset:34816
    ds_read_b64_tr_b16 v[122:123], v27 offset:35840
    v_cndmask_b32 v97, 0, v14, s[74:75]
    s_waitcnt vmcnt(20) lgkmcnt(8)
    v_mfma_f32_32x32x16_bf16 v[172:187], v[132:135], a[28:31], v[172:187]
    s_add_u32 s1, s1, 8192
    s_and_b32 s1, s1, 0xffff
    buffer_load_dwordx4 a[80:83], v66, s[28:31], s1 offen offset:0 sc1
    ds_read_b64_tr_b16 v[124:125], v26 offset:36864
    ds_read_b64_tr_b16 v[126:127], v26 offset:37888
    v_mov_b32 v72, 0xf149f2ca
    v_mfma_f32_32x32x16_bf16 v[188:203], v[136:139], a[28:31], v[188:203]
    buffer_load_dwordx4 a[84:87], v66, s[28:31], s1 offen offset:1024 sc1
    ds_read_b64_tr_b16 v[128:129], v27 offset:36864
    ds_read_b64_tr_b16 v[130:131], v27 offset:37888
    s_mov_b32 s83, 0x3e8b97f6
    s_waitcnt vmcnt(21) lgkmcnt(8)
    v_mfma_f32_32x32x16_bf16 v[172:187], v[108:111], a[32:35], v[172:187]
    ds_read_b64_tr_b16 v[132:133], v26 offset:38912
    ds_read_b64_tr_b16 v[134:135], v26 offset:39936
    s_mov_b32 s78, 0xbdd2d3e8
    s_mov_b32 s79, 0xbdd2d3e8
    v_mfma_f32_32x32x16_bf16 v[188:203], v[112:115], a[32:35], v[188:203]
    buffer_load_dwordx4 a[88:91], v66, s[28:31], s1 offen offset:2048 sc1
    ds_read_b64_tr_b16 v[136:137], v27 offset:38912
    ds_read_b64_tr_b16 v[138:139], v27 offset:39936
    s_mov_b32 s80, 1.0
    s_mov_b32 s81, 1.0
    s_waitcnt vmcnt(21) lgkmcnt(8)
    v_mfma_f32_32x32x16_bf16 v[172:187], v[116:119], a[36:39], v[172:187]
    buffer_load_dwordx4 a[92:95], v66, s[28:31], s1 offen offset:3072 sc1
    s_barrier
    ds_read_b64_tr_b16 v[108:109], v26 offset:49152
    ds_read_b64_tr_b16 v[110:111], v26 offset:50176
    v_mov_b32 v98, 0xc0135761
    v_mfma_f32_32x32x16_bf16 v[188:203], v[120:123], a[36:39], v[188:203]
    ds_read_b64_tr_b16 v[112:113], v27 offset:49152
    ds_read_b64_tr_b16 v[114:115], v27 offset:50176
    v_mov_b32 v99, 0xc0135761
    s_waitcnt vmcnt(21) lgkmcnt(8)
    v_mfma_f32_32x32x16_bf16 v[172:187], v[124:127], a[40:43], v[172:187]
    s_add_u32 s1, s1, 8192
    s_and_b32 s1, s1, 0xffff
    buffer_load_dwordx4 a[96:99], v66, s[28:31], s1 offen offset:0 sc1
    ds_read_b64_tr_b16 v[116:117], v26 offset:51200
    ds_read_b64_tr_b16 v[118:119], v26 offset:52224
    v_mfma_f32_32x32x16_bf16 v[188:203], v[128:131], a[40:43], v[188:203]
    buffer_load_dwordx4 a[100:103], v66, s[28:31], s1 offen offset:1024 sc1
    ds_read_b64_tr_b16 v[120:121], v27 offset:51200
    ds_read_b64_tr_b16 v[122:123], v27 offset:52224
    s_waitcnt vmcnt(22) lgkmcnt(8)
    v_mfma_f32_32x32x16_bf16 v[172:187], v[132:135], a[44:47], v[172:187]
    ds_read_b64_tr_b16 v[124:125], v26 offset:53248
    ds_read_b64_tr_b16 v[126:127], v26 offset:54272
    v_mfma_f32_32x32x16_bf16 v[188:203], v[136:139], a[44:47], v[188:203]
    buffer_load_dwordx4 a[104:107], v66, s[28:31], s1 offen offset:2048 sc1
    ds_read_b64_tr_b16 v[128:129], v27 offset:53248
    ds_read_b64_tr_b16 v[130:131], v27 offset:54272
    s_waitcnt vmcnt(22) lgkmcnt(8)
    v_mfma_f32_32x32x16_bf16 v[172:187], v[108:111], a[48:51], v[172:187]
    ds_read_b64_tr_b16 v[132:133], v26 offset:55296
    ds_read_b64_tr_b16 v[134:135], v26 offset:56320
    v_mfma_f32_32x32x16_bf16 v[188:203], v[112:115], a[48:51], v[188:203]
    buffer_load_dwordx4 a[108:111], v66, s[28:31], s1 offen offset:3072 sc1
    ds_read_b64_tr_b16 v[136:137], v27 offset:55296
    ds_read_b64_tr_b16 v[138:139], v27 offset:56320
    s_waitcnt vmcnt(22) lgkmcnt(8)
    v_mfma_f32_32x32x16_bf16 v[172:187], v[116:119], a[52:55], v[172:187]
    ds_read_b64_tr_b16 v[108:109], v28 offset:0
    ds_read_b64_tr_b16 v[110:111], v28 offset:1024
    v_mfma_f32_32x32x16_bf16 v[188:203], v[120:123], a[52:55], v[188:203]
    s_add_u32 m0, s58, 0
    s_add_u32 s0, s0, 458752
    s_cmp_eq_u32 s0, 3670016
    s_cselect_b32 s0, 0, s0
    buffer_load_dwordx4 v43, s[20:23], s0 offen lds
    ds_read_b64_tr_b16 v[112:113], v29 offset:0
    ds_read_b64_tr_b16 v[114:115], v29 offset:1024
    s_waitcnt vmcnt(22) lgkmcnt(8)
    v_mfma_f32_32x32x16_bf16 v[172:187], v[124:127], a[56:59], v[172:187]
    buffer_load_dwordx4 v44, s[20:23], s0 offen offset:1024 lds
    ds_read_b64_tr_b16 v[116:117], v28 offset:2048
    ds_read_b64_tr_b16 v[118:119], v28 offset:3072
    v_mfma_f32_32x32x16_bf16 v[188:203], v[128:131], a[56:59], v[188:203]
    ds_read_b64_tr_b16 v[120:121], v29 offset:2048
    ds_read_b64_tr_b16 v[122:123], v29 offset:3072
    s_waitcnt vmcnt(22) lgkmcnt(8)
    v_mfma_f32_32x32x16_bf16 v[172:187], v[132:135], a[60:63], v[172:187]
    buffer_load_dwordx4 v45, s[20:23], s0 offen offset:2048 lds
    ds_read_b64_tr_b16 v[124:125], v28 offset:4096
    ds_read_b64_tr_b16 v[126:127], v28 offset:5120
    v_mfma_f32_32x32x16_bf16 v[188:203], v[136:139], a[60:63], v[188:203]
    ds_read_b64_tr_b16 v[128:129], v29 offset:4096
    ds_read_b64_tr_b16 v[130:131], v29 offset:5120
    s_waitcnt vmcnt(18) lgkmcnt(8)
    v_mfma_f32_32x32x16_bf16 v[172:187], v[108:111], a[64:67], v[172:187]
    buffer_load_dwordx4 v46, s[20:23], s0 offen offset:3072 lds
    ds_read_b64_tr_b16 v[132:133], v28 offset:6144
    ds_read_b64_tr_b16 v[134:135], v28 offset:7168
    v_mfma_f32_32x32x16_bf16 v[188:203], v[112:115], a[64:67], v[188:203]
    ds_read_b64_tr_b16 v[136:137], v29 offset:6144
    ds_read_b64_tr_b16 v[138:139], v29 offset:7168
    s_waitcnt vmcnt(18) lgkmcnt(8)
    v_mfma_f32_32x32x16_bf16 v[172:187], v[116:119], a[68:71], v[172:187]
    s_add_u32 m0, s58, 16384
    s_add_u32 s0, s0, 458752
    s_cmp_eq_u32 s0, 3670016
    s_cselect_b32 s0, 0, s0
    buffer_load_dwordx4 v43, s[20:23], s0 offen lds
    s_barrier
    ds_read_b64_tr_b16 v[108:109], v28 offset:16384
    ds_read_b64_tr_b16 v[110:111], v28 offset:17408
    v_mfma_f32_32x32x16_bf16 v[188:203], v[120:123], a[68:71], v[188:203]
    buffer_load_dwordx4 v44, s[20:23], s0 offen offset:1024 lds
    ds_read_b64_tr_b16 v[112:113], v29 offset:16384
    ds_read_b64_tr_b16 v[114:115], v29 offset:17408
    s_waitcnt vmcnt(19) lgkmcnt(8)
    v_mfma_f32_32x32x16_bf16 v[172:187], v[124:127], a[72:75], v[172:187]
    ds_read_b64_tr_b16 v[116:117], v28 offset:18432
    ds_read_b64_tr_b16 v[118:119], v28 offset:19456
    v_mfma_f32_32x32x16_bf16 v[188:203], v[128:131], a[72:75], v[188:203]
    buffer_load_dwordx4 v45, s[20:23], s0 offen offset:2048 lds
    ds_read_b64_tr_b16 v[120:121], v29 offset:18432
    ds_read_b64_tr_b16 v[122:123], v29 offset:19456
    s_waitcnt vmcnt(19) lgkmcnt(8)
    v_mfma_f32_32x32x16_bf16 v[172:187], v[132:135], a[76:79], v[172:187]
    ds_read_b64_tr_b16 v[124:125], v28 offset:20480
    ds_read_b64_tr_b16 v[126:127], v28 offset:21504
    v_mfma_f32_32x32x16_bf16 v[188:203], v[136:139], a[76:79], v[188:203]
    buffer_load_dwordx4 v46, s[20:23], s0 offen offset:3072 lds
    ds_read_b64_tr_b16 v[128:129], v29 offset:20480
    ds_read_b64_tr_b16 v[130:131], v29 offset:21504
    s_waitcnt vmcnt(15) lgkmcnt(8)
    v_mfma_f32_32x32x16_bf16 v[172:187], v[108:111], a[80:83], v[172:187]
    s_add_u32 s1, s1, 8192
    s_and_b32 s1, s1, 0xffff
    buffer_load_dwordx4 a[112:115], v66, s[28:31], s1 offen offset:0 sc1
    ds_read_b64_tr_b16 v[132:133], v28 offset:22528
    ds_read_b64_tr_b16 v[134:135], v28 offset:23552
    v_mfma_f32_32x32x16_bf16 v[188:203], v[112:115], a[80:83], v[188:203]
    ds_read_b64_tr_b16 v[136:137], v29 offset:22528
    ds_read_b64_tr_b16 v[138:139], v29 offset:23552
    s_waitcnt vmcnt(15) lgkmcnt(8)
    v_mfma_f32_32x32x16_bf16 v[172:187], v[116:119], a[84:87], v[172:187]
    buffer_load_dwordx4 a[116:119], v66, s[28:31], s1 offen offset:1024 sc1
    ds_read_b64_tr_b16 v[108:109], v28 offset:32768
    ds_read_b64_tr_b16 v[110:111], v28 offset:33792
    v_mfma_f32_32x32x16_bf16 v[188:203], v[120:123], a[84:87], v[188:203]
    ds_read_b64_tr_b16 v[112:113], v29 offset:32768
    ds_read_b64_tr_b16 v[114:115], v29 offset:33792
    s_waitcnt vmcnt(15) lgkmcnt(8)
    v_mfma_f32_32x32x16_bf16 v[172:187], v[124:127], a[88:91], v[172:187]
    buffer_load_dword v18, v21, s[28:31], 0 offen sc1
    ds_read_b64_tr_b16 v[116:117], v28 offset:34816
    buffer_load_dword v64, v65, s[28:31], 0 offen sc1
    ds_read_b64_tr_b16 v[118:119], v28 offset:35840
    v_mfma_f32_32x32x16_bf16 v[188:203], v[128:131], a[88:91], v[188:203]
    buffer_load_dwordx4 a[120:123], v66, s[28:31], s1 offen offset:2048 sc1
    ds_read_b64_tr_b16 v[120:121], v29 offset:34816
    ds_read_b64_tr_b16 v[122:123], v29 offset:35840
    s_waitcnt vmcnt(17) lgkmcnt(8)
    v_mfma_f32_32x32x16_bf16 v[172:187], v[132:135], a[92:95], v[172:187]
    ds_read_b64_tr_b16 v[124:125], v28 offset:36864
    ds_read_b64_tr_b16 v[126:127], v28 offset:37888
    v_mfma_f32_32x32x16_bf16 v[188:203], v[136:139], a[92:95], v[188:203]
    buffer_load_dwordx4 a[124:127], v66, s[28:31], s1 offen offset:3072 sc1
    ds_read_b64_tr_b16 v[128:129], v29 offset:36864
    ds_read_b64_tr_b16 v[130:131], v29 offset:37888
    s_waitcnt vmcnt(17) lgkmcnt(8)
    v_mfma_f32_32x32x16_bf16 v[172:187], v[108:111], a[96:99], v[172:187]
    s_add_u32 m0, s58, 32768
    s_add_u32 s0, s0, 458752
    s_cmp_eq_u32 s0, 3670016
    s_cselect_b32 s0, 0, s0
    buffer_load_dwordx4 v43, s[20:23], s0 offen lds
    ds_read_b64_tr_b16 v[132:133], v28 offset:38912
    ds_read_b64_tr_b16 v[134:135], v28 offset:39936
    v_mfma_f32_32x32x16_bf16 v[188:203], v[112:115], a[96:99], v[188:203]
    ds_read_b64_tr_b16 v[136:137], v29 offset:38912
    ds_read_b64_tr_b16 v[138:139], v29 offset:39936
    s_waitcnt vmcnt(17) lgkmcnt(8)
    v_mfma_f32_32x32x16_bf16 v[172:187], v[116:119], a[100:103], v[172:187]
    buffer_load_dwordx4 v44, s[20:23], s0 offen offset:1024 lds
    s_waitcnt vmcnt(8)
    s_barrier
    ds_read_b64_tr_b16 v[108:109], v28 offset:49152
    ds_read_b64_tr_b16 v[110:111], v28 offset:50176
    v_mfma_f32_32x32x16_bf16 v[188:203], v[120:123], a[100:103], v[188:203]
    ds_read_b64_tr_b16 v[112:113], v29 offset:49152
    ds_read_b64_tr_b16 v[114:115], v29 offset:50176
    s_waitcnt lgkmcnt(8)
    v_mfma_f32_32x32x16_bf16 v[172:187], v[124:127], a[104:107], v[172:187]
    buffer_load_dwordx4 v45, s[20:23], s0 offen offset:2048 lds
    ds_read_b64_tr_b16 v[116:117], v28 offset:51200
    ds_read_b64_tr_b16 v[118:119], v28 offset:52224
    v_mfma_f32_32x32x16_bf16 v[188:203], v[128:131], a[104:107], v[188:203]
    ds_read_b64_tr_b16 v[120:121], v29 offset:51200
    ds_read_b64_tr_b16 v[122:123], v29 offset:52224
    s_waitcnt lgkmcnt(8)
    v_mfma_f32_32x32x16_bf16 v[172:187], v[132:135], a[108:111], v[172:187]
    buffer_load_dwordx4 v46, s[20:23], s0 offen offset:3072 lds
    ds_read_b64_tr_b16 v[124:125], v28 offset:53248
    ds_read_b64_tr_b16 v[126:127], v28 offset:54272
    v_mfma_f32_32x32x16_bf16 v[188:203], v[136:139], a[108:111], v[188:203]
    s_add_u32 m0, s58, 49152
    s_add_u32 s0, s0, 458752
    s_cmp_eq_u32 s0, 3670016
    s_cselect_b32 s0, 0, s0
    buffer_load_dwordx4 v43, s[20:23], s0 offen lds
    ds_read_b64_tr_b16 v[128:129], v29 offset:53248
    ds_read_b64_tr_b16 v[130:131], v29 offset:54272
    s_waitcnt vmcnt(10) lgkmcnt(8)
    v_mfma_f32_32x32x16_bf16 v[172:187], v[108:111], a[112:115], v[172:187]
    ds_read_b64_tr_b16 v[132:133], v28 offset:55296
    ds_read_b64_tr_b16 v[134:135], v28 offset:56320
    v_mfma_f32_32x32x16_bf16 v[188:203], v[112:115], a[112:115], v[188:203]
    buffer_load_dwordx4 v44, s[20:23], s0 offen offset:1024 lds
    ds_read_b64_tr_b16 v[136:137], v29 offset:55296
    ds_read_b64_tr_b16 v[138:139], v29 offset:56320
    s_waitcnt vmcnt(10) lgkmcnt(8)
    v_mfma_f32_32x32x16_bf16 v[172:187], v[116:119], a[116:119], v[172:187]
    ds_read_b64_tr_b16 v[108:109], v30 offset:0
    ds_read_b64_tr_b16 v[110:111], v30 offset:1024
    v_mfma_f32_32x32x16_bf16 v[188:203], v[120:123], a[116:119], v[188:203]
    buffer_load_dwordx4 v45, s[20:23], s0 offen offset:2048 lds
    ds_read_b64_tr_b16 v[112:113], v31 offset:0
    ds_read_b64_tr_b16 v[114:115], v31 offset:1024
    s_waitcnt vmcnt(8) lgkmcnt(8)
    v_mfma_f32_32x32x16_bf16 v[172:187], v[124:127], a[120:123], v[172:187]
    ds_read_b64_tr_b16 v[116:117], v30 offset:2048
    ds_read_b64_tr_b16 v[118:119], v30 offset:3072
    v_mfma_f32_32x32x16_bf16 v[188:203], v[128:131], a[120:123], v[188:203]
    buffer_load_dwordx4 v46, s[20:23], s0 offen offset:3072 lds
    ds_read_b64_tr_b16 v[120:121], v31 offset:2048
    ds_read_b64_tr_b16 v[122:123], v31 offset:3072
    s_waitcnt vmcnt(8) lgkmcnt(8)
    v_mfma_f32_32x32x16_bf16 v[172:187], v[132:135], a[124:127], v[172:187]
    s_add_u32 m0, s58, 65536
    s_add_u32 s0, s0, 458752
    s_cmp_eq_u32 s0, 3670016
    s_cselect_b32 s0, 0, s0
    buffer_load_dwordx4 v43, s[20:23], s0 offen lds
    ds_read_b64_tr_b16 v[124:125], v30 offset:4096
    ds_read_b64_tr_b16 v[126:127], v30 offset:5120
    v_mfma_f32_32x32x16_bf16 v[188:203], v[136:139], a[124:127], v[188:203]
    ds_read_b64_tr_b16 v[128:129], v31 offset:4096
    ds_read_b64_tr_b16 v[130:131], v31 offset:5120
    s_waitcnt lgkmcnt(8)
    v_mfma_f32_32x32x16_bf16 v[140:155], v[108:111], a[0:3], v[140:155]
    buffer_load_dwordx4 v44, s[20:23], s0 offen offset:1024 lds
    ds_read_b64_tr_b16 v[132:133], v30 offset:6144
    ds_read_b64_tr_b16 v[134:135], v30 offset:7168
    v_mfma_f32_32x32x16_bf16 v[156:171], v[112:115], a[0:3], 0
    ds_read_b64_tr_b16 v[136:137], v31 offset:6144
    ds_read_b64_tr_b16 v[138:139], v31 offset:7168
    v_cvt_pk_bf16_f32 v172, v172, v173
    v_cvt_pk_bf16_f32 v173, v174, v175
    v_cvt_pk_bf16_f32 v174, v176, v177
    buffer_load_dwordx4 v45, s[20:23], s0 offen offset:2048 lds
    v_cvt_pk_bf16_f32 v175, v178, v179
    buffer_store_dwordx4 v[172:175], v24, s[28:31], 0 offen offset:0 sc1
    s_waitcnt lgkmcnt(8)
    v_mfma_f32_32x32x16_bf16 v[140:155], v[116:119], a[4:7], v[140:155]
    buffer_load_dwordx4 v46, s[20:23], s0 offen offset:3072 lds
    s_barrier
    v_cmp_ne_u32 vcc, s57, v18
    s_cbranch_vccz L_pollok1
    s_mov_b32 s60, 0
L_poll1:
    s_sleep 8
    buffer_load_dword v18, v21, s[28:31], 0 offen sc1
    s_add_u32 s60, s60, 1
    s_waitcnt vmcnt(0)
    v_cmp_ne_u32 vcc, s57, v18
    s_cbranch_vccz L_pollok1
    s_cmp_lt_u32 s60, 20000
    s_cbranch_scc1 L_poll1
L_pollok1:
    ds_read_b64_tr_b16 v[108:109], v30 offset:16384
    ds_read_b64_tr_b16 v[110:111], v30 offset:17408
    v_cvt_pk_bf16_f32 v180, v180, v181
    v_cvt_pk_bf16_f32 v181, v182, v183
    v_cvt_pk_bf16_f32 v182, v184, v185
    v_cvt_pk_bf16_f32 v183, v186, v187
    buffer_store_dwordx4 v[180:183], v24, s[28:31], 0 offen offset:1024 sc1
    v_mfma_f32_32x32x16_bf16 v[156:171], v[120:123], a[4:7], v[156:171]
    s_add_u32 m0, s58, 81920
    s_add_u32 s0, s0, 458752
    s_cmp_eq_u32 s0, 3670016
    s_cselect_b32 s0, 0, s0
    buffer_load_dwordx4 v43, s[20:23], s0 offen lds
    ds_read_b64_tr_b16 v[112:113], v31 offset:16384
    ds_read_b64_tr_b16 v[114:115], v31 offset:17408
    v_cvt_pk_bf16_f32 v188, v188, v189
    v_cvt_pk_bf16_f32 v189, v190, v191
    v_cvt_pk_bf16_f32 v190, v192, v193
    v_cvt_pk_bf16_f32 v191, v194, v195
    buffer_store_dwordx4 v[188:191], v24, s[28:31], 0 offen offset:2048 sc1
    s_waitcnt lgkmcnt(8)
    v_mfma_f32_32x32x16_bf16 v[140:155], v[124:127], a[8:11], v[140:155]
    buffer_load_dwordx4 v44, s[20:23], s0 offen offset:1024 lds
    ds_read_b64_tr_b16 v[116:117], v30 offset:18432
    ds_read_b64_tr_b16 v[118:119], v30 offset:19456
    v_cvt_pk_bf16_f32 v196, v196, v197
    v_cvt_pk_bf16_f32 v197, v198, v199
    v_cvt_pk_bf16_f32 v198, v200, v201
    v_cvt_pk_bf16_f32 v199, v202, v203
    buffer_store_dwordx4 v[196:199], v24, s[28:31], 0 offen offset:3072 sc1
    v_mfma_f32_32x32x16_bf16 v[156:171], v[128:131], a[8:11], v[156:171]
    buffer_load_dwordx4 v45, s[20:23], s0 offen offset:2048 lds
    ds_read_b64_tr_b16 v[120:121], v31 offset:18432
    ds_read_b64_tr_b16 v[122:123], v31 offset:19456
    s_waitcnt lgkmcnt(8)
    v_mfma_f32_32x32x16_bf16 v[140:155], v[132:135], a[12:15], v[140:155]
    buffer_load_dwordx4 v46, s[20:23], s0 offen offset:3072 lds
    ds_read_b64_tr_b16 v[124:125], v30 offset:20480
    ds_read_b64_tr_b16 v[126:127], v30 offset:21504
    v_mfma_f32_32x32x16_bf16 v[156:171], v[136:139], a[12:15], v[156:171]
    ds_read_b64_tr_b16 v[128:129], v31 offset:20480
    ds_read_b64_tr_b16 v[130:131], v31 offset:21504
    s_waitcnt lgkmcnt(8)
    v_mfma_f32_32x32x16_bf16 v[140:155], v[108:111], a[16:19], v[140:155]
    s_add_u32 m0, s59, 98304
    s_nop 0
    buffer_load_dwordx4 v68, s[28:31], s63 offen sc1 lds
    ds_read_b64_tr_b16 v[132:133], v30 offset:22528
    ds_read_b64_tr_b16 v[134:135], v30 offset:23552
    v_mfma_f32_32x32x16_bf16 v[156:171], v[112:115], a[16:19], v[156:171]
    ds_read_b64_tr_b16 v[136:137], v31 offset:22528
    ds_read_b64_tr_b16 v[138:139], v31 offset:23552
    s_waitcnt lgkmcnt(8)
    v_mfma_f32_32x32x16_bf16 v[140:155], v[116:119], a[20:23], v[140:155]
    buffer_load_dwordx4 v68, s[28:31], s63 offen offset:1024 sc1 lds
    ds_read_b64_tr_b16 v[108:109], v26 offset:0
    ds_read_b64_tr_b16 v[110:111], v26 offset:1024
    v_mfma_f32_32x32x16_bf16 v[156:171], v[120:123], a[20:23], v[156:171]
    ds_read_b64_tr_b16 v[112:113], v27 offset:0
    ds_read_b64_tr_b16 v[114:115], v27 offset:1024
    s_waitcnt lgkmcnt(8)
    v_mfma_f32_32x32x16_bf16 v[140:155], v[124:127], a[24:27], v[140:155]
    buffer_load_dwordx4 v68, s[28:31], s63 offen offset:2048 sc1 lds
    ds_read_b64_tr_b16 v[116:117], v26 offset:2048
    ds_read_b64_tr_b16 v[118:119], v26 offset:3072
    v_mfma_f32_32x32x16_bf16 v[156:171], v[128:131], a[24:27], v[156:171]
    s_add_u32 m0, s100, 126976
    s_nop 0
    buffer_load_dwordx4 v57, s[28:31], s62 offen sc1 lds
    ds_read_b64_tr_b16 v[120:121], v27 offset:2048
    ds_read_b64_tr_b16 v[122:123], v27 offset:3072
    s_waitcnt lgkmcnt(8)
    v_mfma_f32_32x32x16_bf16 v[140:155], v[132:135], a[28:31], v[140:155]
    ds_read_b64_tr_b16 v[124:125], v26 offset:4096
    ds_read_b64_tr_b16 v[126:127], v26 offset:5120
    v_mfma_f32_32x32x16_bf16 v[156:171], v[136:139], a[28:31], v[156:171]
    s_add_u32 m0, s58, 110592
    s_nop 0
    buffer_load_dwordx4 v55, s[28:31], s62 offen sc1 lds
    ds_read_b64_tr_b16 v[128:129], v27 offset:4096
    ds_read_b64_tr_b16 v[130:131], v27 offset:5120
    s_waitcnt lgkmcnt(8)
    v_mfma_f32_32x32x16_bf16 v[140:155], v[108:111], a[32:35], v[140:155]
    ds_read_b64_tr_b16 v[132:133], v26 offset:6144
    ds_read_b64_tr_b16 v[134:135], v26 offset:7168
    v_mfma_f32_32x32x16_bf16 v[156:171], v[112:115], a[32:35], v[156:171]
    buffer_load_dwordx4 v55, s[28:31], s62 offen offset:1024 sc1 lds
    ds_read_b64_tr_b16 v[136:137], v27 offset:6144
    ds_read_b64_tr_b16 v[138:139], v27 offset:7168
    s_waitcnt lgkmcnt(8)
    v_mfma_f32_32x32x16_bf16 v[140:155], v[116:119], a[36:39], v[140:155]
    s_waitcnt vmcnt(6)
    s_barrier
    s_atomic_add s36, s[28:29], s37
    ds_read_b64_tr_b16 v[108:109], v26 offset:16384
    buffer_load_dwordx4 v56, s[28:31], s62 offen offset:2048 sc1 lds
    ds_read_b64_tr_b16 v[110:111], v26 offset:17408
    v_mfma_f32_32x32x16_bf16 v[156:171], v[120:123], a[36:39], v[156:171]
    ds_read_b64_tr_b16 v[112:113], v27 offset:16384
    ds_read_b64_tr_b16 v[114:115], v27 offset:17408
    s_waitcnt lgkmcnt(8)
    v_mfma_f32_32x32x16_bf16 v[140:155], v[124:127], a[40:43], v[140:155]
    buffer_load_dwordx4 v56, s[28:31], s62 offen offset:3072 sc1 lds
    ds_read_b64_tr_b16 v[116:117], v26 offset:18432
    ds_read_b64_tr_b16 v[118:119], v26 offset:19456
    v_mfma_f32_32x32x16_bf16 v[156:171], v[128:131], a[40:43], v[156:171]
    ds_read_b64_tr_b16 v[120:121], v27 offset:18432
    ds_read_b64_tr_b16 v[122:123], v27 offset:19456
    s_waitcnt lgkmcnt(8)
    v_mfma_f32_32x32x16_bf16 v[140:155], v[132:135], a[44:47], v[140:155]
    s_add_u32 m0, s59, 131072
    s_add_u32 s63, s63, 12288
    s_cmp_eq_u32 s63, 86016
    s_cselect_b32 s63, 0, s63
    buffer_load_dwordx4 v68, s[28:31], s63 offen sc1 lds
    ds_read_b64_tr_b16 v[124:125], v26 offset:20480
    ds_read_b64_tr_b16 v[126:127], v26 offset:21504
    v_mfma_f32_32x32x16_bf16 v[156:171], v[136:139], a[44:47], v[156:171]
    ds_read_b64_tr_b16 v[128:129], v27 offset:20480
    ds_read_b64_tr_b16 v[130:131], v27 offset:21504
    s_waitcnt lgkmcnt(8)
    v_mfma_f32_32x32x16_bf16 v[140:155], v[108:111], a[48:51], v[140:155]
    buffer_load_dwordx4 v68, s[28:31], s63 offen offset:1024 sc1 lds
    ds_read_b64_tr_b16 v[132:133], v26 offset:22528
    ds_read_b64_tr_b16 v[134:135], v26 offset:23552
    v_mfma_f32_32x32x16_bf16 v[156:171], v[112:115], a[48:51], v[156:171]
    buffer_load_dwordx4 v68, s[28:31], s63 offen offset:2048 sc1 lds
    ds_read_b64_tr_b16 v[136:137], v27 offset:22528
    ds_read_b64_tr_b16 v[138:139], v27 offset:23552
    s_waitcnt lgkmcnt(8)
    v_mfma_f32_32x32x16_bf16 v[140:155], v[116:119], a[52:55], v[140:155]
    ds_read_b64_tr_b16 v[108:109], v26 offset:32768
    ds_read_b64_tr_b16 v[110:111], v26 offset:33792
    v_mfma_f32_32x32x16_bf16 v[156:171], v[120:123], a[52:55], v[156:171]
    s_add_u32 m0, s100, 159744
    s_add_u32 s62, s62, 262144
    s_cmp_eq_u32 s62, 1835008
    s_cselect_b32 s62, 0, s62
    buffer_load_dwordx4 v57, s[28:31], s62 offen sc1 lds
    ds_read_b64_tr_b16 v[112:113], v27 offset:32768
    ds_read_b64_tr_b16 v[114:115], v27 offset:33792
    s_waitcnt lgkmcnt(8)
    v_mfma_f32_32x32x16_bf16 v[140:155], v[124:127], a[56:59], v[140:155]
    ds_read_b64_tr_b16 v[116:117], v26 offset:34816
    ds_read_b64_tr_b16 v[118:119], v26 offset:35840
    v_mfma_f32_32x32x16_bf16 v[156:171], v[128:131], a[56:59], v[156:171]
    s_add_u32 m0, s58, 143360
    s_nop 0
    buffer_load_dwordx4 v55, s[28:31], s62 offen sc1 lds
    ds_read_b64_tr_b16 v[120:121], v27 offset:34816
    ds_read_b64_tr_b16 v[122:123], v27 offset:35840
    s_waitcnt lgkmcnt(8)
    v_mfma_f32_32x32x16_bf16 v[140:155], v[132:135], a[60:63], v[140:155]
    ds_read_b64_tr_b16 v[124:125], v26 offset:36864
    ds_read_b64_tr_b16 v[126:127], v26 offset:37888
    v_mfma_f32_32x32x16_bf16 v[156:171], v[136:139], a[60:63], v[156:171]
    buffer_load_dwordx4 v55, s[28:31], s62 offen offset:1024 sc1 lds
    ds_read_b64_tr_b16 v[128:129], v27 offset:36864
    ds_read_b64_tr_b16 v[130:131], v27 offset:37888
    s_waitcnt lgkmcnt(8)
    v_mfma_f32_32x32x16_bf16 v[140:155], v[108:111], a[64:67], v[140:155]
    buffer_load_dwordx4 v56, s[28:31], s62 offen offset:2048 sc1 lds
    ds_read_b64_tr_b16 v[132:133], v26 offset:38912
    ds_read_b64_tr_b16 v[134:135], v26 offset:39936
    v_mfma_f32_32x32x16_bf16 v[156:171], v[112:115], a[64:67], v[156:171]
    ds_read_b64_tr_b16 v[136:137], v27 offset:38912
    ds_read_b64_tr_b16 v[138:139], v27 offset:39936
    s_waitcnt lgkmcnt(8)
    v_mfma_f32_32x32x16_bf16 v[140:155], v[116:119], a[68:71], v[140:155]
    buffer_load_dwordx4 v56, s[28:31], s62 offen offset:3072 sc1 lds
    s_barrier
    s_xor_b32 s37, s37, 1024
    s_load_dword s46, s[28:29], s37 glc
    ds_read_b64_tr_b16 v[108:109], v26 offset:49152
    ds_read_b64_tr_b16 v[110:111], v26 offset:50176
    v_mfma_f32_32x32x16_bf16 v[156:171], v[120:123], a[68:71], v[156:171]
    s_add_u32 m0, s59, 0
    s_add_u32 s63, s63, 12288
    s_cmp_eq_u32 s63, 86016
    s_cselect_b32 s63, 0, s63
    buffer_load_dwordx4 v68, s[28:31], s63 offen sc1 lds
    ds_read_b64_tr_b16 v[112:113], v27 offset:49152
    ds_read_b64_tr_b16 v[114:115], v27 offset:50176
    s_waitcnt lgkmcnt(8)
    v_mfma_f32_32x32x16_bf16 v[140:155], v[124:127], a[72:75], v[140:155]
    ds_read_b64_tr_b16 v[116:117], v26 offset:51200
    ds_read_b64_tr_b16 v[118:119], v26 offset:52224
    v_mfma_f32_32x32x16_bf16 v[156:171], v[128:131], a[72:75], v[156:171]
    buffer_load_dwordx4 v68, s[28:31], s63 offen offset:1024 sc1 lds
    ds_read_b64_tr_b16 v[120:121], v27 offset:51200
    ds_read_b64_tr_b16 v[122:123], v27 offset:52224
    s_waitcnt lgkmcnt(8)
    v_mfma_f32_32x32x16_bf16 v[140:155], v[132:135], a[76:79], v[140:155]
    ds_read_b64_tr_b16 v[124:125], v26 offset:53248
    ds_read_b64_tr_b16 v[126:127], v26 offset:54272
    v_mfma_f32_32x32x16_bf16 v[156:171], v[136:139], a[76:79], v[156:171]
    buffer_load_dwordx4 v68, s[28:31], s63 offen offset:2048 sc1 lds
    ds_read_b64_tr_b16 v[128:129], v27 offset:53248
    ds_read_b64_tr_b16 v[130:131], v27 offset:54272
    s_waitcnt lgkmcnt(8)
    v_mfma_f32_32x32x16_bf16 v[140:155], v[108:111], a[80:83], v[140:155]
    ds_read_b64_tr_b16 v[132:133], v26 offset:55296
    ds_read_b64_tr_b16 v[134:135], v26 offset:56320
    v_mfma_f32_32x32x16_bf16 v[156:171], v[112:115], a[80:83], v[156:171]
    s_add_u32 m0, s100, 28672
    s_add_u32 s62, s62, 262144
    s_cmp_eq_u32 s62, 1835008
    s_cselect_b32 s62, 0, s62
    buffer_load_dwordx4 v57, s[28:31], s62 offen sc1 lds
    ds_read_b64_tr_b16 v[136:137], v27 offset:55296
    ds_read_b64_tr_b16 v[138:139], v27 offset:56320
    s_waitcnt lgkmcnt(8)
    v_mfma_f32_32x32x16_bf16 v[140:155], v[116:119], a[84:87], v[140:155]
    s_add_u32 m0, s58, 12288
    s_nop 0
    buffer_load_dwordx4 v55, s[28:31], s62 offen sc1 lds
    s_barrier
    ds_read_b64_tr_b16 v[108:109], v28 offset:0
    ds_read_b64_tr_b16 v[110:111], v28 offset:1024
    v_mfma_f32_32x32x16_bf16 v[156:171], v[120:123], a[84:87], v[156:171]
    ds_read_b64_tr_b16 v[112:113], v29 offset:0
    ds_read_b64_tr_b16 v[114:115], v29 offset:1024
    s_waitcnt lgkmcnt(8)
    v_mfma_f32_32x32x16_bf16 v[140:155], v[124:127], a[88:91], v[140:155]
    buffer_load_dwordx4 v55, s[28:31], s62 offen offset:1024 sc1 lds
    ds_read_b64_tr_b16 v[116:117], v28 offset:2048
    ds_read_b64_tr_b16 v[118:119], v28 offset:3072
    v_mfma_f32_32x32x16_bf16 v[156:171], v[128:131], a[88:91], v[156:171]
    ds_read_b64_tr_b16 v[120:121], v29 offset:2048
    ds_read_b64_tr_b16 v[122:123], v29 offset:3072
    s_waitcnt lgkmcnt(8)
    v_mfma_f32_32x32x16_bf16 v[140:155], v[132:135], a[92:95], v[140:155]
    buffer_load_dwordx4 v56, s[28:31], s62 offen offset:2048 sc1 lds
    ds_read_b64_tr_b16 v[124:125], v28 offset:4096
    ds_read_b64_tr_b16 v[126:127], v28 offset:5120
    v_mfma_f32_32x32x16_bf16 v[156:171], v[136:139], a[92:95], v[156:171]
    ds_read_b64_tr_b16 v[128:129], v29 offset:4096
    ds_read_b64_tr_b16 v[130:131], v29 offset:5120
    s_waitcnt lgkmcnt(8)
    v_mfma_f32_32x32x16_bf16 v[140:155], v[108:111], a[96:99], v[140:155]
    buffer_load_dwordx4 v56, s[28:31], s62 offen offset:3072 sc1 lds
    ds_read_b64_tr_b16 v[132:133], v28 offset:6144
    ds_read_b64_tr_b16 v[134:135], v28 offset:7168
    v_mfma_f32_32x32x16_bf16 v[156:171], v[112:115], a[96:99], v[156:171]
    ds_read_b64_tr_b16 v[136:137], v29 offset:6144
    ds_read_b64_tr_b16 v[138:139], v29 offset:7168
    s_waitcnt lgkmcnt(8)
    v_mfma_f32_32x32x16_bf16 v[140:155], v[116:119], a[100:103], v[140:155]
    s_waitcnt lgkmcnt(0)
    s_cmp_eq_u32 s46, 2
    s_cbranch_scc1 L_pollok2
    s_mov_b32 s60, 0
L_poll2:
    s_sleep 4
    s_load_dword s46, s[28:29], s37 glc
    s_add_u32 s60, s60, 1
    s_waitcnt lgkmcnt(0)
    s_cmp_eq_u32 s46, 2
    s_cbranch_scc1 L_pollok2
    s_cmp_lt_u32 s60, 20000
    s_cbranch_scc1 L_poll2
L_pollok2:
    v_xor_b32 v24, 131072, v24
    v_xor_b32 v23, 8192, v24
    ds_read_b64_tr_b16 v[108:109], v28 offset:16384
    buffer_load_dwordx4 v[204:207], v24, s[28:31], 0 offen offset:0 sc1
    ds_read_b64_tr_b16 v[110:111], v28 offset:17408
    v_mfma_f32_32x32x16_bf16 v[156:171], v[120:123], a[100:103], v[156:171]
    buffer_load_dwordx4 v[208:211], v24, s[28:31], 0 offen offset:1024 sc1
    ds_read_b64_tr_b16 v[112:113], v29 offset:16384
    ds_read_b64_tr_b16 v[114:115], v29 offset:17408
    v_mfma_f32_32x32x16_bf16 v[140:155], v[124:127], a[104:107], v[140:155]
    buffer_load_dwordx4 v[212:215], v23, s[28:31], 0 offen offset:2048 sc1
    ds_read_b64_tr_b16 v[116:117], v28 offset:18432
    ds_read_b64_tr_b16 v[118:119], v28 offset:19456
    v_mfma_f32_32x32x16_bf16 v[156:171], v[128:131], a[104:107], v[156:171]
    buffer_load_dwordx4 v[216:219], v23, s[28:31], 0 offen offset:3072 sc1
    ds_read_b64_tr_b16 v[120:121], v29 offset:18432
    ds_read_b64_tr_b16 v[122:123], v29 offset:19456
    v_mfma_f32_32x32x16_bf16 v[140:155], v[132:135], a[108:111], v[140:155]
    ds_read_b64_tr_b16 v[124:125], v28 offset:20480
    ds_read_b64_tr_b16 v[126:127], v28 offset:21504
    v_mfma_f32_32x32x16_bf16 v[156:171], v[136:139], a[108:111], v[156:171]
    ds_read_b64_tr_b16 v[128:129], v29 offset:20480
    ds_read_b64_tr_b16 v[130:131], v29 offset:21504
    s_waitcnt lgkmcnt(8)
    v_mfma_f32_32x32x16_bf16 v[140:155], v[108:111], a[112:115], v[140:155]
    ds_read_b64_tr_b16 v[132:133], v28 offset:22528
    ds_read_b64_tr_b16 v[134:135], v28 offset:23552
    v_mfma_f32_32x32x16_bf16 v[156:171], v[112:115], a[112:115], v[156:171]
    ds_read_b64_tr_b16 v[136:137], v29 offset:22528
    ds_read_b64_tr_b16 v[138:139], v29 offset:23552
    s_waitcnt lgkmcnt(8)
    v_mfma_f32_32x32x16_bf16 v[140:155], v[116:119], a[116:119], v[140:155]
    v_mfma_f32_32x32x16_bf16 v[156:171], v[120:123], a[116:119], v[156:171]
    s_waitcnt lgkmcnt(4)
    v_mfma_f32_32x32x16_bf16 v[140:155], v[124:127], a[120:123], v[140:155]
    v_mfma_f32_32x32x16_bf16 v[156:171], v[128:131], a[120:123], v[156:171]
    s_waitcnt lgkmcnt(0)
    v_mfma_f32_32x32x16_bf16 v[140:155], v[132:135], a[124:127], v[140:155]
    v_mfma_f32_32x32x16_bf16 v[156:171], v[136:139], a[124:127], v[156:171]
    s_nop 11
    ds_write_b128 v69, v[156:159] offset:32768
    ds_write_b128 v69, v[160:163] offset:33792
    ds_write_b128 v69, v[164:167] offset:34816
    ds_write_b128 v69, v[168:171] offset:35840
    s_waitcnt vmcnt(3)
    v_lshlrev_b32 v188, 16, v204
    v_and_b32 v189, 0xffff0000, v204
    v_pk_add_f32 v[140:141], v[140:141], v[188:189]
    v_lshlrev_b32 v190, 16, v205
    v_and_b32 v191, 0xffff0000, v205
    v_pk_add_f32 v[142:143], v[142:143], v[190:191]
    v_lshlrev_b32 v192, 16, v206
    v_and_b32 v193, 0xffff0000, v206
    v_pk_add_f32 v[144:145], v[144:145], v[192:193]
    v_lshlrev_b32 v194, 16, v207
    v_and_b32 v195, 0xffff0000, v207
    v_pk_add_f32 v[146:147], v[146:147], v[194:195]
    s_waitcnt vmcnt(2)
    v_lshlrev_b32 v188, 16, v208
    v_and_b32 v189, 0xffff0000, v208
    v_pk_add_f32 v[148:149], v[148:149], v[188:189]
    v_lshlrev_b32 v190, 16, v209
    v_and_b32 v191, 0xffff0000, v209
    v_pk_add_f32 v[150:151], v[150:151], v[190:191]
    v_lshlrev_b32 v192, 16, v210
    v_and_b32 v193, 0xffff0000, v210
    v_pk_add_f32 v[152:153], v[152:153], v[192:193]
    v_lshlrev_b32 v194, 16, v211
    v_and_b32 v195, 0xffff0000, v211
    v_pk_add_f32 v[154:155], v[154:155], v[194:195]
    s_waitcnt vmcnt(1)
    v_lshlrev_b32 v188, 16, v212
    v_and_b32 v189, 0xffff0000, v212
    v_pk_add_f32 v[140:141], v[140:141], v[188:189]
    v_lshlrev_b32 v190, 16, v213
    v_and_b32 v191, 0xffff0000, v213
    v_pk_add_f32 v[142:143], v[142:143], v[190:191]
    v_lshlrev_b32 v192, 16, v214
    v_and_b32 v193, 0xffff0000, v214
    v_pk_add_f32 v[144:145], v[144:145], v[192:193]
    v_lshlrev_b32 v194, 16, v215
    v_and_b32 v195, 0xffff0000, v215
    v_pk_add_f32 v[146:147], v[146:147], v[194:195]
    v_xor_b32 v69, 8192, v69
    s_waitcnt lgkmcnt(0)
    s_barrier
    ds_read_b128 v[172:175], v69 offset:32768
    s_add_u32 m0, s59, 65536
    s_add_u32 s63, s63, 12288
    s_cmp_eq_u32 s63, 86016
    s_cselect_b32 s63, 0, s63
    buffer_load_dwordx4 v68, s[28:31], s63 offen sc1 lds
    ds_read_b128 v[176:179], v69 offset:33792
    ds_read_b128 v[180:183], v69 offset:34816
    ds_read_b128 v[184:187], v69 offset:35840
    s_waitcnt vmcnt(1)
    v_lshlrev_b32 v188, 16, v216
    v_and_b32 v189, 0xffff0000, v216
    v_pk_add_f32 v[148:149], v[148:149], v[188:189]
    v_lshlrev_b32 v190, 16, v217
    buffer_load_dwordx4 v68, s[28:31], s63 offen offset:1024 sc1 lds
    v_and_b32 v191, 0xffff0000, v217
    v_pk_add_f32 v[150:151], v[150:151], v[190:191]
    v_lshlrev_b32 v192, 16, v218
    v_and_b32 v193, 0xffff0000, v218
    v_pk_add_f32 v[152:153], v[152:153], v[192:193]
    v_lshlrev_b32 v194, 16, v219
    v_and_b32 v195, 0xffff0000, v219
    v_pk_add_f32 v[154:155], v[154:155], v[194:195]
    s_waitcnt lgkmcnt(3)
    v_pk_add_f32 v[140:141], v[140:141], v[172:173]
    v_pk_add_f32 v[142:143], v[142:143], v[174:175]
    s_waitcnt lgkmcnt(2)
    v_pk_add_f32 v[144:145], v[144:145], v[176:177]
    v_pk_add_f32 v[146:147], v[146:147], v[178:179]
    v_pk_mul_f32 v[172:173], v[140:141], v[140:141]
    v_pk_mul_f32 v[174:175], v[142:143], v[142:143]
    buffer_load_dwordx4 v68, s[28:31], s63 offen offset:2048 sc1 lds
    v_pk_mul_f32 v[176:177], v[144:145], v[144:145]
    v_pk_mul_f32 v[178:179], v[146:147], v[146:147]
    v_pk_fma_f32 v[172:173], v[172:173], s[78:79], v[98:99]
    v_pk_fma_f32 v[174:175], v[174:175], s[78:79], v[98:99]
    v_pk_fma_f32 v[176:177], v[176:177], s[78:79], v[98:99]
    v_pk_fma_f32 v[178:179], v[178:179], s[78:79], v[98:99]
    v_pk_mul_f32 v[172:173], v[172:173], v[140:141]
    v_pk_mul_f32 v[174:175], v[174:175], v[142:143]
    v_pk_mul_f32 v[176:177], v[176:177], v[144:145]
    v_pk_mul_f32 v[178:179], v[178:179], v[146:147]
    v_exp_f32 v172, v172
    v_exp_f32 v173, v173
    s_add_u32 m0, s100, 94208
    s_add_u32 s62, s62, 262144
    s_cmp_eq_u32 s62, 1835008
    s_cselect_b32 s62, 0, s62
    buffer_load_dwordx4 v57, s[28:31], s62 offen sc1 lds
    v_exp_f32 v174, v174
    v_exp_f32 v175, v175
    v_exp_f32 v176, v176
    v_exp_f32 v177, v177
    v_exp_f32 v178, v178
    v_exp_f32 v179, v179
    v_pk_add_f32 v[172:173], v[172:173], s[80:81]
    v_pk_add_f32 v[174:175], v[174:175], s[80:81]
    s_add_u32 m0, s58, 77824
    s_nop 0
    buffer_load_dwordx4 v55, s[28:31], s62 offen sc1 lds
    v_pk_add_f32 v[176:177], v[176:177], s[80:81]
    v_pk_add_f32 v[178:179], v[178:179], s[80:81]
    v_rcp_f32 v172, v172
    v_rcp_f32 v173, v173
    v_rcp_f32 v174, v174
    v_rcp_f32 v175, v175
    v_rcp_f32 v176, v176
    v_rcp_f32 v177, v177
    buffer_load_dwordx4 v55, s[28:31], s62 offen offset:1024 sc1 lds
    v_rcp_f32 v178, v178
    v_rcp_f32 v179, v179
    v_pk_mul_f32 v[172:173], v[172:173], v[140:141]
    v_pk_mul_f32 v[174:175], v[174:175], v[142:143]
    v_pk_mul_f32 v[176:177], v[176:177], v[144:145]
    v_pk_mul_f32 v[178:179], v[178:179], v[146:147]
    v_cvt_pk_bf16_f32 v100, v172, v173
    v_cvt_pk_bf16_f32 v101, v174, v175
    v_cvt_pk_bf16_f32 v102, v176, v177
    v_cvt_pk_bf16_f32 v103, v178, v179
    s_waitcnt lgkmcnt(1)
    v_pk_add_f32 v[148:149], v[148:149], v[180:181]
    v_pk_add_f32 v[150:151], v[150:151], v[182:183]
    buffer_load_dwordx4 v56, s[28:31], s62 offen offset:2048 sc1 lds
    s_waitcnt lgkmcnt(0)
    v_pk_add_f32 v[152:153], v[152:153], v[184:185]
    v_pk_add_f32 v[154:155], v[154:155], v[186:187]
    v_pk_mul_f32 v[180:181], v[148:149], v[148:149]
    v_pk_mul_f32 v[182:183], v[150:151], v[150:151]
    v_pk_mul_f32 v[184:185], v[152:153], v[152:153]
    v_pk_mul_f32 v[186:187], v[154:155], v[154:155]
    v_pk_fma_f32 v[180:181], v[180:181], s[78:79], v[98:99]
    v_pk_fma_f32 v[182:183], v[182:183], s[78:79], v[98:99]
    v_pk_fma_f32 v[184:185], v[184:185], s[78:79], v[98:99]
    v_pk_fma_f32 v[186:187], v[186:187], s[78:79], v[98:99]
    v_pk_mul_f32 v[180:181], v[180:181], v[148:149]
    v_pk_mul_f32 v[182:183], v[182:183], v[150:151]
    v_pk_mul_f32 v[184:185], v[184:185], v[152:153]
    v_pk_mul_f32 v[186:187], v[186:187], v[154:155]
    buffer_load_dwordx4 v56, s[28:31], s62 offen offset:3072 sc1 lds
    v_exp_f32 v180, v180
    v_exp_f32 v181, v181
    v_exp_f32 v182, v182
    v_exp_f32 v183, v183
    v_exp_f32 v184, v184
    v_exp_f32 v185, v185
    v_exp_f32 v186, v186
    v_exp_f32 v187, v187
    v_pk_add_f32 v[180:181], v[180:181], s[80:81]
    v_pk_add_f32 v[182:183], v[182:183], s[80:81]
    v_pk_add_f32 v[184:185], v[184:185], s[80:81]
    v_pk_add_f32 v[186:187], v[186:187], s[80:81]
    v_rcp_f32 v180, v180
    v_rcp_f32 v181, v181
    v_rcp_f32 v182, v182
    v_rcp_f32 v183, v183
    v_rcp_f32 v184, v184
    v_rcp_f32 v185, v185
    v_rcp_f32 v186, v186
    v_rcp_f32 v187, v187
    v_pk_mul_f32 v[180:181], v[180:181], v[148:149]
    v_pk_mul_f32 v[182:183], v[182:183], v[150:151]
    v_pk_mul_f32 v[184:185], v[184:185], v[152:153]
    v_pk_mul_f32 v[186:187], v[186:187], v[154:155]
    v_cvt_pk_bf16_f32 v104, v180, v181
    v_cvt_pk_bf16_f32 v105, v182, v183
    v_cvt_pk_bf16_f32 v106, v184, v185
    v_cvt_pk_bf16_f32 v107, v186, v187
    buffer_store_dwordx4 v[100:103], v4, s[28:31], s67 offen offset:0 sc1
    buffer_store_dwordx4 v[104:107], v4, s[28:31], s67 offen offset:1024 sc1
    s_branch L_q
L_nog1:
    s_nop 1
    s_mov_b32 s14, 1204224
    s_mov_b32 s15, 0x20000
    s_sub_u32 s3, s2, 200
    s_cmp_lt_u32 s3, 42
    s_cselect_b32 s81, 0, 268435456
    s_cselect_b32 s3, s3, 0
    s_mul_i32 s79, s3, 43
    s_lshr_b32 s79, s79, 7
    s_mul_i32 s80, s79, 3
    s_sub_u32 s80, s3, s80
    v_min_u32 v14, 55, v1
    s_lshl_b32 s3, s79, 2
    s_add_u32 s3, s3, s48
    s_mul_i32 s3, s3, 21504
    s_mul_i32 s60, s80, 896
    s_add_u32 s3, s3, s60
    s_add_u32 s3, s3, s81
    v_lshl_add_u32 v232, v14, 4, s3
    s_mul_i32 s60, s48, 8448
    s_add_u32 m0, s60, 0
    s_mov_b32 s3, 0
    buffer_load_dwordx4 v232, s[12:15], s3 offen lds
    s_add_u32 m0, s60, 1056
    s_mov_b32 s3, 2688
    buffer_load_dwordx4 v232, s[12:15], s3 offen lds
    s_add_u32 m0, s60, 2112
    s_mov_b32 s3, 5376
    buffer_load_dwordx4 v232, s[12:15], s3 offen lds
    s_add_u32 m0, s60, 3168
    s_mov_b32 s3, 8064
    buffer_load_dwordx4 v232, s[12:15], s3 offen lds
    s_add_u32 m0, s60, 4224
    s_mov_b32 s3, 10752
    buffer_load_dwordx4 v232, s[12:15], s3 offen lds
    s_add_u32 m0, s60, 5280
    s_mov_b32 s3, 13440
    buffer_load_dwordx4 v232, s[12:15], s3 offen lds
    s_add_u32 m0, s60, 6336
    s_mov_b32 s3, 16128
    buffer_load_dwordx4 v232, s[12:15], s3 offen lds
    s_add_u32 m0, s60, 7392
    s_mov_b32 s3, 18816
    buffer_load_dwordx4 v232, s[12:15], s3 offen lds
    s_mul_i32 s53, s101, 37
    s_lshr_b32 s53, s53, 8
    s_mul_i32 s54, s53, 7
    s_sub_u32 s54, s101, s54
    s_and_b32 s53, s53, 3
    s_lshl_b32 s3, s6, 2
    s_add_u32 s53, s53, s3
    s_lshl_b32 s53, s53, 1
    s_add_u32 s53, s53, s7
    s_cmp_lt_u32 s101, 28
    s_cselect_b32 s56, 1, 0
    s_lshl_b32 s50, s7, 3
    s_and_b32 s3, s101, 7
    s_add_u32 s50, s50, s3
    s_lshr_b32 s60, s101, 3
    s_lshl_b32 s49, s6, 2
    s_add_u32 s49, s49, s60
    s_lshl_b32 s49, s49, 2
    s_add_u32 s49, s49, s48
    s_mul_i32 s60, s60, 0
    s_add_u32 s3, s3, s60
    s_sub_u32 s60, s3, 7
    s_cmp_ge_u32 s3, 7
    s_cselect_b32 s3, s60, s3
    s_lshl_b32 s62, s3, 18
    s_mul_i32 s63, s3, 12288
    s_mov_b32 s30, 20971520
    s_mov_b32 s31, 0x20000
    s_mov_b32 s75, 0x3727c5ac
    s_mov_b32 s76, 0x3b124925
    s_mov_b32 s77, 0x3f803f80
    v_lshlrev_b32 v4, 4, v1
    v_bfe_u32 v7, v1, 2, 2
    v_and_b32 v8, 3, v1
    v_mul_u32_u24 v14, 960, v9
    v_lshl_add_u32 v14, v10, 4, v14
    s_mul_i32 s3, s48, 1920
    s_add_u32 s3, s3, 147456
    v_add_u32 v220, s3, v14
    v_mul_u32_u24 v14, 960, v7
    v_lshl_add_u32 v14, v3, 5, v14
    v_lshl_add_u32 v14, v8, 3, v14
    s_lshl_b32 s3, s48, 8
    s_add_u32 s3, s3, 147456
    v_add_u32 v221, s3, v14
    s_lshl_b32 s3, s48, 3
    s_add_u32 s3, s3, 155648
    v_lshl_add_u32 v222, v9, 2, s3
    v_lshlrev_b32 v227, 2, v6
    v_and_b32 v2, 15, v1
    v_lshlrev_b32 v228, 14, v3
    v_add_lshl_u32 v228, v228, v2, 2
    v_add_u32 v227, 155648, v227
    v_lshlrev_b32 v14, 17, v9
    v_lshl_add_u32 v223, v10, 4, v14
    s_cmp_eq_u32 s48, 3
    s_cselect_b32 s60, 268435456, 0
    s_lshl_b32 s70, s48, 10
    s_add_u32 s70, s70, s2
    s_lshl_b32 s70, s70, 9
    s_add_u32 s71, s70, 262144
    s_add_u32 s71, s71, s60
    s_xor_b32 s60, s60, 268435456
    s_lshl_b32 s72, s2, 7
    s_add_u32 s72, s72, s60
    s_add_u32 s72, s72, 6291456
    s_lshr_b32 s74, s2, 2
    s_lshl_b32 s74, s74, 5
    s_and_b32 s3, s2, 3
    s_add_u32 s74, s74, s3
    s_lshl_b32 s74, s74, 2
    s_add_u32 s74, s74, 10485760
    v_cmp_gt_u32 vcc, 8, v0
    v_lshlrev_b32 v226, 13, v0
    v_mov_b32 v14, 268435456
    s_and_b32 s3, s2, 7
    s_lshl_b32 s3, s3, 13
    s_add_u32 s3, s3, 10485760
    v_lshrrev_b32 v15, 2, v0
    v_lshl_add_u32 v15, v15, 7, s3
    v_lshl_add_u32 v20, v8, 2, v15
    v_cndmask_b32 v226, v14, v226, vcc
    v_mov_b32 v17, 0
    s_lshl_b32 s3, s48, 14
    s_add_u32 s74, s74, s3
    s_add_u32 s73, s74, 8192
    s_waitcnt vmcnt(10)
    v_dot2_f32_bf16 v216, v172, s77, 0
    v_dot2_f32_bf16 v217, v172, v172, 0
    v_dot2_f32_bf16 v216, v173, s77, v216
    v_dot2_f32_bf16 v217, v173, v173, v217
    v_dot2_f32_bf16 v216, v174, s77, v216
    v_dot2_f32_bf16 v217, v174, v174, v217
    v_dot2_f32_bf16 v216, v175, s77, v216
    v_dot2_f32_bf16 v217, v175, v175, v217
    s_waitcnt vmcnt(9)
    v_dot2_f32_bf16 v216, v176, s77, v216
    v_dot2_f32_bf16 v217, v176, v176, v217
    v_dot2_f32_bf16 v216, v177, s77, v216
    v_dot2_f32_bf16 v217, v177, v177, v217
    v_dot2_f32_bf16 v216, v178, s77, v216
    v_dot2_f32_bf16 v217, v178, v178, v217
    v_dot2_f32_bf16 v216, v179, s77, v216
    v_dot2_f32_bf16 v217, v179, v179, v217
    buffer_load_dword v12, v17, s[44:47], 0 offen sc1
    v_lshlrev_b32 v180, 16, v172
    v_and_b32 v181, 0xffff0000, v172
    v_add_f32_dpp v216, v216, v216 quad_perm:[1,0,3,2] row_mask:0xf bank_mask:0xf
    v_add_f32_dpp v217, v217, v217 quad_perm:[1,0,3,2] row_mask:0xf bank_mask:0xf
    v_lshlrev_b32 v182, 16, v173
    v_add_f32_dpp v216, v216, v216 quad_perm:[2,3,0,1] row_mask:0xf bank_mask:0xf
    v_add_f32_dpp v217, v217, v217 quad_perm:[2,3,0,1] row_mask:0xf bank_mask:0xf
    v_and_b32 v183, 0xffff0000, v173
    v_add_f32_dpp v216, v216, v216 row_half_mirror row_mask:0xf bank_mask:0xf
    v_add_f32_dpp v217, v217, v217 row_half_mirror row_mask:0xf bank_mask:0xf
    v_lshlrev_b32 v184, 16, v174
    v_add_f32_dpp v216, v216, v216 row_mirror row_mask:0xf bank_mask:0xf
    v_add_f32_dpp v217, v217, v217 row_mirror row_mask:0xf bank_mask:0xf
    v_and_b32 v185, 0xffff0000, v174
    v_mov_b32 v218, v216
    v_mov_b32 v219, v217
    v_lshlrev_b32 v186, 16, v175
    v_permlane16_swap_b32 v216, v218
    v_permlane16_swap_b32 v217, v219
    v_add_f32 v216, v216, v218
    v_add_f32 v217, v217, v219
    v_mul_f32_e64 v216, -v216, s76
    v_mul_f32 v218, v216, v216
    v_fma_f32 v217, v217, s76, -v218
    v_max_f32 v217, 0, v217
    v_add_f32 v218, s75, v217
    v_rsq_f32 v212, v218
    v_and_b32 v187, 0xffff0000, v175
    v_mul_f32 v218, v212, v212
    v_fma_f32 v219, v218, v217, s75
    v_rsq_f32 v218, v219
    v_mul_f32 v213, v216, v212
    v_mul_f32 v214, v212, v218
    v_mul_f32 v215, v213, v218
    v_mul_f32 v219, v219, v218
    ds_write_b32 v222, v219
    v_lshlrev_b32 v188, 16, v176
    v_and_b32 v189, 0xffff0000, v176
    v_lshlrev_b32 v190, 16, v177
    v_and_b32 v191, 0xffff0000, v177
    v_lshlrev_b32 v192, 16, v178
    v_and_b32 v193, 0xffff0000, v178
    v_lshlrev_b32 v194, 16, v179
    v_and_b32 v195, 0xffff0000, v179
    v_pk_fma_f32 v[196:197], v[180:181], v[214:215], v[214:215] op_sel:[0,0,1] op_sel_hi:[1,0,1]
    v_pk_fma_f32 v[198:199], v[182:183], v[214:215], v[214:215] op_sel:[0,0,1] op_sel_hi:[1,0,1]
    v_pk_fma_f32 v[200:201], v[184:185], v[214:215], v[214:215] op_sel:[0,0,1] op_sel_hi:[1,0,1]
    v_pk_fma_f32 v[202:203], v[186:187], v[214:215], v[214:215] op_sel:[0,0,1] op_sel_hi:[1,0,1]
    v_cvt_pk_bf16_f32 v172, v196, v197
    v_cvt_pk_bf16_f32 v173, v198, v199
    v_cvt_pk_bf16_f32 v174, v200, v201
    v_cvt_pk_bf16_f32 v175, v202, v203
    ds_write_b128 v220, v[172:175] offset:0
    v_pk_fma_f32 v[204:205], v[188:189], v[214:215], v[214:215] op_sel:[0,0,1] op_sel_hi:[1,0,1]
    v_pk_fma_f32 v[206:207], v[190:191], v[214:215], v[214:215] op_sel:[0,0,1] op_sel_hi:[1,0,1]
    v_pk_fma_f32 v[208:209], v[192:193], v[214:215], v[214:215] op_sel:[0,0,1] op_sel_hi:[1,0,1]
    v_pk_fma_f32 v[210:211], v[194:195], v[214:215], v[214:215] op_sel:[0,0,1] op_sel_hi:[1,0,1]
    v_cvt_pk_bf16_f32 v176, v204, v205
    v_cvt_pk_bf16_f32 v177, v206, v207
    v_cvt_pk_bf16_f32 v178, v208, v209
    v_cvt_pk_bf16_f32 v179, v210, v211
    ds_write_b128 v220, v[176:179] offset:448
    s_waitcnt lgkmcnt(0)
    s_barrier
    ds_read_b64_tr_b16 v[100:101], v221 offset:0
    ds_read_b64_tr_b16 v[102:103], v221 offset:3840
    ds_read_b64_tr_b16 v[104:105], v221 offset:128
    ds_read_b64_tr_b16 v[106:107], v221 offset:3968
    ds_read_b32 v219, v227
    s_waitcnt lgkmcnt(3)
    buffer_store_dwordx4 v[100:103], v223, s[28:31], s70 offen sc1
    s_waitcnt lgkmcnt(1)
    buffer_store_dwordx4 v[104:107], v223, s[28:31], s71 offen sc1
    v_cmp_gt_u32 vcc, 16, v1
    s_waitcnt lgkmcnt(0)
    s_nop 0
    v_cndmask_b32 v219, 0, v219, vcc
    buffer_store_dword v219, v228, s[28:31], s72 offen sc1
    s_mov_b32 s42, 4096
    s_mov_b32 s43, 0x20000
    s_lshl_b32 s3, s53, 2
    s_add_u32 s3, s3, s48
    s_lshl_b32 s7, s3, 5
    v_lshl_add_u32 v70, v5, 1, s7
    s_mul_i32 s3, s3, 14336
    s_lshl_b32 s6, s54, 7
    s_add_u32 s3, s3, s6
    v_mul_u32_u24 v15, 896, v5
    v_lshl_add_u32 v15, v6, 4, v15
    v_add_u32 v73, s3, v15
    v_add_u32 v74, 7168, v73
    v_lshrrev_b32 v14, 2, v1
    v_mul_u32_u24 v14, 1056, v14
    v_lshl_add_u32 v14, v8, 3, v14
    s_mul_i32 s3, s48, 224
    v_add_u32 v233, s3, v14
    s_mov_b32 s18, 401408
    s_mov_b32 s19, 0x20000
    s_mov_b32 s26, 7340032
    s_mov_b32 s27, 0x20000
    s_mov_b32 s34, 1835008
    s_mov_b32 s35, 0x20000
    s_mov_b32 s36, 1
    v_lshl_add_u32 v15, v9, 2, v7
    v_lshlrev_b32 v15, 7, v15
    v_lshl_add_u32 v15, v8, 3, v15
    v_and_b32 v16, 2, v7
    v_and_b32 v14, 1, v3
    v_add_u32 v16, v16, v14
    v_lshl_add_u32 v15, v16, 5, v15
    s_mul_i32 s3, s4, 8256
    v_xor_b32 v26, s3, v15
    v_xor_b32 v27, 64, v26
    v_add_u32 v28, 65536, v26
    v_add_u32 v29, 65536, v27
    v_add_u32 v30, 131072, v26
    v_add_u32 v31, 131072, v27
    s_lshl_b32 s6, s52, 1
    s_add_u32 s6, s6, s5
    s_lshl_b32 s3, s6, 1
    s_add_u32 s3, s3, s59
    s_lshl_b32 s3, s3, 4
    s_add_u32 s3, s3, s4
    s_lshl_b32 s3, s3, 12
    v_add_u32 v66, s3, v4
    s_xor_b32 s37, s51, 1
    s_lshl_b32 s37, s37, 3
    s_add_u32 s37, s37, s52
    s_lshl_b32 s3, s37, 14
    s_add_u32 s3, s3, s58
    s_add_u32 s3, s3, 16777216
    v_add_u32 v24, s3, v4
    s_lshl_b32 s37, s37, 5
    s_add_u32 s37, s37, s5
    s_lshl_b32 s37, s37, 2
    s_add_u32 s37, s37, 6422528
    s_mul_i32 s67, s6, 56
    s_lshl_b32 s3, s51, 1
    s_add_u32 s3, s3, s4
    s_add_u32 s67, s67, s3
    s_lshl_b32 s67, s67, 11
    s_add_u32 s67, s67, 2097152
    v_add_u32 v69, s58, v4
    s_lshl_b32 s68, s52, 2
    s_and_b32 s3, s51, 1
    s_add_u32 s68, s68, s3
    s_cmp_ge_u32 s51, 14
    s_cselect_b32 s3, 2, 0
    s_add_u32 s68, s68, s3
    s_lshl_b32 s68, s68, 7
    s_add_u32 s68, s68, 6356992
    s_waitcnt vmcnt(3)
    v_readfirstlane_b32 s57, v12
    s_mov_b32 s60, 0
    s_cmp_lg_u32 s57, 0
    s_cbranch_scc1 L_nonce_okh
L_nonceh:
    buffer_load_dword v12, v17, s[44:47], 0 offen sc1
    s_add_u32 s60, s60, 1
    s_waitcnt vmcnt(0)
    v_readfirstlane_b32 s57, v12
    s_cmp_ge_u32 s60, 20000
    s_cbranch_scc1 L_nonce_okh
    s_cmp_eq_u32 s57, 0
    s_cbranch_scc1 L_nonceh
L_nonce_okh:
    s_waitcnt vmcnt(0)
    s_barrier
    s_atomic_swap s57, s[28:29], s74
    s_atomic_swap s57, s[28:29], s73
    buffer_load_dwordx4 v[86:89], v73, s[8:11], 0 offen
    buffer_load_ushort v83, v70, s[40:43], 0 offen offset:0
    buffer_load_dwordx4 v[90:93], v74, s[8:11], 0 offen
    buffer_load_ushort v84, v70, s[40:43], 0 offen offset:16
    v_cmp_gt_u32 vcc, 12, v2
    s_mul_i32 s3, s48, 56
    s_add_u32 s3, s3, s79
    s_mul_i32 s3, s3, 3
    s_add_u32 s3, s3, s80
    s_lshl_b32 s3, s3, 11
    s_add_u32 s3, s3, 8388608
    s_add_u32 s3, s3, s81
    ds_read_b64_tr_b16 v[172:173], v233 offset:0
    ds_read_b64_tr_b16 v[174:175], v233 offset:16896
    ds_read_b64_tr_b16 v[176:177], v233 offset:32
    ds_read_b64_tr_b16 v[178:179], v233 offset:16928
    ds_read_b64_tr_b16 v[180:181], v233 offset:56
    ds_read_b64_tr_b16 v[182:183], v233 offset:16952
    ds_read_b64_tr_b16 v[184:185], v233 offset:88
    ds_read_b64_tr_b16 v[186:187], v233 offset:16984
    ds_read_b64_tr_b16 v[188:189], v233 offset:112
    ds_read_b64_tr_b16 v[190:191], v233 offset:17008
    ds_read_b64_tr_b16 v[192:193], v233 offset:144
    ds_read_b64_tr_b16 v[194:195], v233 offset:17040
    ds_read_b64_tr_b16 v[196:197], v233 offset:168
    ds_read_b64_tr_b16 v[198:199], v233 offset:17064
    ds_read_b64_tr_b16 v[200:201], v233 offset:200
    ds_read_b64_tr_b16 v[202:203], v233 offset:17096
    s_waitcnt lgkmcnt(13)
    v_cndmask_b32 v176, 0, v176, vcc
    v_cndmask_b32 v177, 0, v177, vcc
    s_waitcnt lgkmcnt(12)
    v_cndmask_b32 v178, 0, v178, vcc
    v_cndmask_b32 v179, 0, v179, vcc
    buffer_store_dwordx4 v[172:175], v4, s[28:31], s3 offen offset:0 sc1
    buffer_store_dwordx4 v[176:179], v4, s[28:31], s3 offen offset:1024 sc1
    s_add_u32 s3, s3, 86016
    s_waitcnt lgkmcnt(9)
    v_cndmask_b32 v184, 0, v184, vcc
    v_cndmask_b32 v185, 0, v185, vcc
    s_waitcnt lgkmcnt(8)
    v_cndmask_b32 v186, 0, v186, vcc
    v_cndmask_b32 v187, 0, v187, vcc
    buffer_store_dwordx4 v[180:183], v4, s[28:31], s3 offen offset:0 sc1
    buffer_store_dwordx4 v[184:187], v4, s[28:31], s3 offen offset:1024 sc1
    s_add_u32 s3, s3, 86016
    s_waitcnt lgkmcnt(5)
    v_cndmask_b32 v192, 0, v192, vcc
    v_cndmask_b32 v193, 0, v193, vcc
    s_waitcnt lgkmcnt(4)
    v_cndmask_b32 v194, 0, v194, vcc
    v_cndmask_b32 v195, 0, v195, vcc
    buffer_store_dwordx4 v[188:191], v4, s[28:31], s3 offen offset:0 sc1
    buffer_store_dwordx4 v[192:195], v4, s[28:31], s3 offen offset:1024 sc1
    s_add_u32 s3, s3, 86016
    ds_read_b32 v25, v4
    s_waitcnt lgkmcnt(2)
    v_cndmask_b32 v200, 0, v200, vcc
    v_cndmask_b32 v201, 0, v201, vcc
    ds_read_b32 v25, v4
    s_waitcnt lgkmcnt(2)
    v_cndmask_b32 v202, 0, v202, vcc
    v_cndmask_b32 v203, 0, v203, vcc
    buffer_store_dwordx4 v[196:199], v4, s[28:31], s3 offen offset:0 sc1
    buffer_store_dwordx4 v[200:203], v4, s[28:31], s3 offen offset:1024 sc1
    s_add_u32 s3, s3, 86016
    s_mul_i32 s67, s79, 3
    s_add_u32 s67, s67, s80
    s_lshl_b32 s67, s67, 6
    s_add_u32 s67, s67, 10747904
    s_add_u32 s67, s67, s81
    s_mov_b32 s68, 6369792
    v_add_u32 v41, 65536, v4
    v_add_u32 v42, 131072, v4
    s_mul_i32 s59, s48, 3072
    s_mul_i32 s3, s50, 86016
    s_add_u32 s3, s3, s59
    s_add_u32 s3, s3, 8388608
    v_add_u32 v68, s3, v4
    v_lshlrev_b32 v15, 7, v9
    v_xor_b32 v15, v15, v4
    s_lshl_b32 s3, s49, 11
    v_add_u32 v55, s3, v15
    v_add_u32 v56, 129024, v55
    s_lshr_b32 s3, s49, 2
    s_lshl_b32 s3, s3, 3
    s_max_u32 s3, s3, 1
    s_sub_u32 s3, s3, 1
    s_lshl_b32 s3, s3, 10
    s_lshl_b32 s6, s5, 17
    s_add_u32 s3, s3, s6
    s_lshl_b32 s6, s4, 28
    s_add_u32 s3, s3, s6
    v_add_u32 v57, s3, v15
    s_lshl_b32 s100, s5, 1
    s_add_u32 s100, s100, s4
    s_lshl_b32 s100, s100, 10
    v_and_b32 v15, 1, v1
    v_mul_u32_u24 v15, 640, v15
    v_lshrrev_b32 v16, 2, v1
    v_lshlrev_b32 v16, 4, v16
    v_xor_b32 v15, v15, v16
    v_bfe_u32 v16, v1, 1, 1
    v_lshl_add_u32 v15, v16, 3, v15
    s_add_u32 s3, s58, 12288
    v_add_u32 v58, s3, v15
    s_sub_u32 s3, s3, 3072
    s_cmp_eq_u32 s48, 0
    s_cselect_b32 s3, 28672, s3
    v_add_u32 v59, s3, v15
    v_add_u32 v60, 65536, v58
    v_add_u32 v61, 65536, v59
    v_add_u32 v62, 131072, v58
    v_add_u32 v63, 131072, v59
    s_lshl_b32 s3, s49, 1
    v_min_u32 v15, 2, v3
    v_add_u32 v15, s3, v15
    v_max_u32 v15, 1, v15
    v_lshlrev_b32 v15, 1, v15
    v_and_b32 v16, 1, v7
    v_add_lshl_u32 v15, v15, v16, 7
    v_lshrrev_b32 v16, 1, v7
    v_lshl_add_u32 v16, v16, 2, v8
    v_lshl_add_u32 v15, v16, 2, v15
    v_add_u32 v65, 6291200, v15
    v_min_u32 v15, 41, v1
    v_lshlrev_b32 v15, 6, v15
    v_add_u32 v21, 10747904, v15
    s_lshl_b32 s82, s49, 5
    s_add_u32 s82, s82, s50
    s_lshl_b32 s82, s82, 10
    s_add_u32 s82, s82, 4194304
    s_lshr_b32 s69, s49, 2
    s_lshl_b32 s69, s69, 1
    s_and_b32 s3, s50, 1
    s_add_u32 s69, s69, s3
    s_lshl_b32 s69, s69, 7
    s_add_u32 s69, s69, 6361088
    s_and_b32 s7, s53, 1
    s_mul_i32 s3, s7, 28
    s_add_u32 s3, s3, s48
    s_lshl_b32 s3, s3, 17
    s_xor_b32 s6, s53, 1
    s_lshl_b32 s55, s6, 3
    s_lshl_b32 s6, s53, 7
    s_add_u32 s3, s3, s6
    v_lshlrev_b32 v15, 12, v5
    v_add3_u32 v47, v15, v71, s3
    v_add_u32 v48, 31744, v47
    v_add_u32 v49, 63488, v47
    v_add_u32 v50, 95232, v47
    v_mul_u32_u24 v15, 896, v5
    s_mul_i32 s3, s4, 25088
    s_mul_i32 s6, s5, 14336
    s_add_u32 s3, s3, s6
    s_lshl_b32 s6, s54, 7
    s_add_u32 s3, s3, s6
    v_add3_u32 v51, v15, v71, s3
    v_add_u32 v52, 6144, v51
    s_lshl_b32 s6, s53, 1
    s_add_u32 s6, s6, s5
    s_and_b32 s3, s53, 30
    s_add_u32 s3, s3, s4
    s_lshl_b32 s3, s3, 7
    s_add_u32 s39, s3, 6361088
    s_lshl_b32 s3, s6, 5
    s_add_u32 s3, s3, s4
    s_lshl_b32 s3, s3, 10
    s_add_u32 s3, s3, 4194304
    v_add_u32 v53, s3, v4
    v_add_u32 v54, 15360, v53
    s_xor_b32 s3, s4, s5
    s_lshl_b32 s3, s3, 6
    v_xor_b32 v32, s3, v26
    v_add_u32 v33, 65536, v32
    v_add_u32 v34, 131072, v32
    v_lshlrev_b32 v14, 10, v14
    v_lshl_add_u32 v14, v9, 8, v14
    v_lshl_add_u32 v14, v2, 4, v14
    s_mul_i32 s3, s4, 12288
    v_add_u32 v35, s3, v14
    v_xor_b32 v36, 4096, v35
    v_add_u32 v37, 65536, v35
    v_add_u32 v38, 65536, v36
    v_add_u32 v39, 131072, v35
    v_add_u32 v40, 131072, v36
    s_lshl_b32 s6, s54, 1
    s_add_u32 s6, s6, s5
    s_lshl_b32 s3, s6, 1
    s_add_u32 s3, s3, s7
    s_mul_i32 s3, s3, 14
    s_add_u32 s3, s3, s4
    s_lshl_b32 s3, s3, 12
    s_add_u32 s3, s3, 2097152
    v_add_u32 v67, s3, v4
    s_lshl_b32 s3, s54, 1
    s_add_u32 s3, s3, s7
    s_lshl_b32 s3, s3, 1
    s_add_u32 s3, s3, s4
    s_lshl_b32 s3, s3, 7
    s_add_u32 s38, s3, 6356992
    s_and_b32 s3, s2, 6
    s_add_u32 s3, s3, s54
    s_sub_u32 s6, s3, 7
    s_cmp_ge_u32 s3, 7
    s_cselect_b32 s3, s6, s3
    s_lshl_b32 s64, s3, 19
    s_lshl_b32 s65, s3, 13
    s_add_u32 s55, s55, s54
    s_lshl_b32 s3, s55, 14
    s_add_u32 s3, s3, s58
    s_add_u32 s3, s3, 12582912
    v_add_u32 v22, s3, v4
    s_lshl_b32 s55, s55, 5
    s_add_u32 s55, s55, s48
    s_lshl_b32 s55, s55, 2
    s_add_u32 s55, s55, 6488064
    s_lshl_b32 s3, s5, 3
    v_add_u32 v14, s3, v9
    v_xor_b32 v14, v14, v6
    v_lshlrev_b32 v14, 4, v14
    v_lshl_add_u32 v14, v10, 8, v14
    s_lshl_b32 s3, s4, 14
    s_add_u32 s3, s3, 131072
    v_add_u32 v75, s3, v14
    v_xor_b32 v76, 32, v75
    v_xor_b32 v77, 64, v75
    v_xor_b32 v78, 96, v75
    s_lshr_b32 s3, s53, 1
    s_add_u32 s66, s3, s54
    v_lshlrev_b32 v14, 1, v6
    v_xor_b32 v14, v14, v5
    v_lshlrev_b32 v14, 4, v14
    v_lshl_add_u32 v14, v5, 8, v14
    s_add_u32 s3, s58, 131072
    v_add_u32 v79, s3, v14
    v_xor_b32 v80, 16, v79
    v_xor_b32 v81, 24576, v79
    v_xor_b32 v82, 24592, v79
    s_mov_b32 s70, 0xaaaaaaaa
    s_mov_b32 s71, 0xaaaaaaaa
    s_mov_b32 s72, 0xfff0ffff
    s_mov_b32 s73, 0xf000ff00
    s_mov_b32 s74, 0xffc0fffc
    s_mov_b32 s75, 0xc000fc00
    s_cmp_eq_u32 s49, 0
    s_cselect_b64 s[76:77], 0, -1
    v_mov_b32 v14, 0xffff
    v_mov_b32 v15, 0xffff0000
    v_cndmask_b32 v14, v14, v15, s[70:71]
    v_cndmask_b32 v94, v14, 0, s[72:73]
    v_cndmask_b32 v96, 0, v14, s[72:73]
    v_cndmask_b32 v95, v14, 0, s[74:75]
    v_cndmask_b32 v97, 0, v14, s[74:75]
    v_mov_b32 v72, 0xf149f2ca
    s_mov_b32 s83, 0x3e8b97f6
    s_mov_b32 s78, 0xbdd2d3e8
    s_mov_b32 s79, 0xbdd2d3e8
    s_mov_b32 s80, 1.0
    s_mov_b32 s81, 1.0
    v_mov_b32 v98, 0xc0135761
    v_mov_b32 v99, 0xc0135761
    s_waitcnt vmcnt(0)
    s_barrier
    buffer_store_dword v12, v13, s[28:31], s67 offen sc1
    buffer_load_dword v18, v20, s[28:31], 0 offen sc1
    s_cmp_eq_u32 s56, 0
    s_cselect_b32 s26, 0, s26
    v_sub_u32 v14, v66, v4
    v_lshl_add_u32 v14, v10, 7, v14
    s_add_u32 s3, s1, 8192
    v_lshl_add_u32 v15, v9, 13, s3
    s_waitcnt vmcnt(0)
    v_cmp_ne_u32 vcc, s57, v18
    s_cbranch_vccz L_pollok3
    s_mov_b32 s60, 0
L_poll3:
    s_sleep 8
    buffer_load_dword v18, v20, s[28:31], 0 offen sc1
    s_add_u32 s60, s60, 1
    s_waitcnt vmcnt(0)
    v_cmp_ne_u32 vcc, s57, v18
    s_cbranch_vccz L_pollok3
    s_cmp_lt_u32 s60, 20000
    s_cbranch_scc1 L_poll3
L_pollok3:
    s_barrier
    v_and_b32 v15, 0xffff, v15
    v_add_u32 v16, v14, v15
    v_add_u32 v15, 16384, v15
    buffer_load_dword v212, v16, s[28:31], 0 offen sc1
    v_and_b32 v15, 0xffff, v15
    v_add_u32 v16, v14, v15
    v_add_u32 v15, 16384, v15
    buffer_load_dword v213, v16, s[28:31], 0 offen sc1
    v_and_b32 v15, 0xffff, v15
    v_add_u32 v16, v14, v15
    v_add_u32 v15, 16384, v15
    buffer_load_dword v214, v16, s[28:31], 0 offen sc1
    v_and_b32 v15, 0xffff, v15
    v_add_u32 v16, v14, v15
    v_add_u32 v15, 16384, v15
    buffer_load_dword v215, v16, s[28:31], 0 offen sc1
    buffer_load_dword v18, v21, s[28:31], 0 offen sc1
    s_mov_b32 s26, 7340032
    s_and_b32 s3, s2, 1
    s_mul_i32 s3, s3, 7
    s_add_u32 s3, s3, s52
    s_lshl_b32 s3, s3, 2
    s_add_u32 s3, s3, s48
    s_lshl_b32 s3, s3, 17
    s_and_b32 s6, s2, 6
    s_lshl_b32 s6, s6, 9
    s_add_u32 s3, s3, s6
    v_lshlrev_b32 v14, 12, v10
    v_lshl_add_u32 v14, v9, 9, v14
    buffer_load_dword v222, v14, s[24:27], s3 offen offset:384
    buffer_load_dword v223, v14, s[24:27], s3 offen offset:256
    s_cmp_eq_u32 s56, 0
    s_cselect_b32 s26, 0, s26
    s_waitcnt vmcnt(2)
    v_cmp_ne_u32 vcc, s57, v18
    s_cbranch_vccz L_pollok4
    s_mov_b32 s60, 0
L_poll4:
    s_sleep 32
    buffer_load_dword v18, v21, s[28:31], 0 offen sc1
    s_add_u32 s60, s60, 1
    s_waitcnt vmcnt(0)
    v_cmp_ne_u32 vcc, s57, v18
    s_cbranch_vccz L_pollok4
    s_cmp_lt_u32 s60, 20000
    s_cbranch_scc1 L_poll4
L_pollok4:
    s_cmp_eq_u32 s56, 0
    s_cselect_b32 s3, 268435456, 0
    v_add_u32 v67, s3, v67
    buffer_load_dword v64, v65, s[28:31], 0 offen sc1
    s_add_u32 m0, s59, 98304
    s_nop 0
    buffer_load_dwordx4 v68, s[28:31], s63 offen sc1 lds
    buffer_load_dwordx4 v68, s[28:31], s63 offen offset:1024 sc1 lds
    buffer_load_dwordx4 v68, s[28:31], s63 offen offset:2048 sc1 lds
    s_add_u32 m0, s100, 126976
    s_nop 0
    buffer_load_dwordx4 v57, s[28:31], s62 offen sc1 lds
    s_add_u32 m0, s58, 110592
    s_nop 0
    buffer_load_dwordx4 v55, s[28:31], s62 offen sc1 lds
    buffer_load_dwordx4 v55, s[28:31], s62 offen offset:1024 sc1 lds
    buffer_load_dwordx4 v56, s[28:31], s62 offen offset:2048 sc1 lds
    buffer_load_dwordx4 v56, s[28:31], s62 offen offset:3072 sc1 lds
    s_add_u32 m0, s59, 131072
    s_add_u32 s63, s63, 12288
    s_cmp_eq_u32 s63, 86016
    s_cselect_b32 s63, 0, s63
    buffer_load_dwordx4 v68, s[28:31], s63 offen sc1 lds
    buffer_load_dwordx4 v68, s[28:31], s63 offen offset:1024 sc1 lds
    buffer_load_dwordx4 v68, s[28:31], s63 offen offset:2048 sc1 lds
    s_add_u32 m0, s100, 159744
    s_add_u32 s62, s62, 262144
    s_cmp_eq_u32 s62, 1835008
    s_cselect_b32 s62, 0, s62
    buffer_load_dwordx4 v57, s[28:31], s62 offen sc1 lds
    s_add_u32 m0, s58, 143360
    s_nop 0
    buffer_load_dwordx4 v55, s[28:31], s62 offen sc1 lds
    buffer_load_dwordx4 v55, s[28:31], s62 offen offset:1024 sc1 lds
    buffer_load_dwordx4 v56, s[28:31], s62 offen offset:2048 sc1 lds
    buffer_load_dwordx4 v56, s[28:31], s62 offen offset:3072 sc1 lds
    s_add_u32 m0, s59, 0
    s_add_u32 s63, s63, 12288
    s_cmp_eq_u32 s63, 86016
    s_cselect_b32 s63, 0, s63
    buffer_load_dwordx4 v68, s[28:31], s63 offen sc1 lds
    buffer_load_dwordx4 v68, s[28:31], s63 offen offset:1024 sc1 lds
    buffer_load_dwordx4 v68, s[28:31], s63 offen offset:2048 sc1 lds
    s_add_u32 m0, s100, 28672
    s_add_u32 s62, s62, 262144
    s_cmp_eq_u32 s62, 1835008
    s_cselect_b32 s62, 0, s62
    buffer_load_dwordx4 v57, s[28:31], s62 offen sc1 lds
    s_add_u32 m0, s58, 12288
    s_nop 0
    buffer_load_dwordx4 v55, s[28:31], s62 offen sc1 lds
    buffer_load_dwordx4 v55, s[28:31], s62 offen offset:1024 sc1 lds
    buffer_load_dwordx4 v56, s[28:31], s62 offen offset:2048 sc1 lds
    buffer_load_dwordx4 v56, s[28:31], s62 offen offset:3072 sc1 lds
    s_add_u32 m0, s59, 65536
    s_add_u32 s63, s63, 12288
    s_cmp_eq_u32 s63, 86016
    s_cselect_b32 s63, 0, s63
    buffer_load_dwordx4 v68, s[28:31], s63 offen sc1 lds
    buffer_load_dwordx4 v68, s[28:31], s63 offen offset:1024 sc1 lds
    buffer_load_dwordx4 v68, s[28:31], s63 offen offset:2048 sc1 lds
    s_add_u32 m0, s100, 94208
    s_add_u32 s62, s62, 262144
    s_cmp_eq_u32 s62, 1835008
    s_cselect_b32 s62, 0, s62
    buffer_load_dwordx4 v57, s[28:31], s62 offen sc1 lds
    s_add_u32 m0, s58, 77824
    s_nop 0
    buffer_load_dwordx4 v55, s[28:31], s62 offen sc1 lds
    buffer_load_dwordx4 v55, s[28:31], s62 offen offset:1024 sc1 lds
    buffer_load_dwordx4 v56, s[28:31], s62 offen offset:2048 sc1 lds
    buffer_load_dwordx4 v56, s[28:31], s62 offen offset:3072 sc1 lds
    s_mov_b32 s3, 268435456
    buffer_store_dword v12, v11, s[28:31], s3 offen
    buffer_store_dword v12, v11, s[28:31], s3 offen
    ds_read_b32 v25, v4
    ds_read_b32 v25, v4
    s_waitcnt vmcnt(10) lgkmcnt(2)
    s_nop 3
L_q:
    s_barrier
    ds_read_b64_tr_b16 a[180:181], v60 offset:32768
    ds_read_b64_tr_b16 a[182:183], v60 offset:33024
    ds_read_b128 a[128:131], v41 offset:32768
    ds_read_b64_tr_b16 a[184:185], v60 offset:33792
    ds_read_b64_tr_b16 a[186:187], v60 offset:34048
    ds_read_b128 a[132:135], v41 offset:33792
    ds_read_b128 a[136:139], v41 offset:34816
    ds_read_b64_tr_b16 a[176:177], v61 offset:32768
    ds_read_b64_tr_b16 a[178:179], v61 offset:33024
    ds_read_b128 a[140:143], v41 offset:35840
    ds_read_b128 a[144:147], v41 offset:36864
    ds_read_b128 a[148:151], v41 offset:37888
    s_waitcnt lgkmcnt(6)
    v_mfma_f32_16x16x32_bf16 v[172:175], a[128:131], a[180:183], 0
    ds_read_b64_tr_b16 a[192:193], v60 offset:34816
    s_add_u32 m0, s59, 32768
    v_mfma_f32_16x16x32_bf16 v[180:183], a[128:131], a[184:187], 0
    ds_read_b64_tr_b16 a[194:195], v60 offset:35072
    s_add_u32 s63, s63, 12288
    v_mfma_f32_16x16x32_bf16 v[176:179], a[132:135], a[180:183], 0
    ds_read_b128 a[152:155], v41 offset:38912
    s_cmp_eq_u32 s63, 86016
    v_mfma_f32_16x16x32_bf16 v[184:187], a[132:135], a[184:187], 0
    ds_read_b64_tr_b16 a[196:197], v60 offset:35840
    s_waitcnt lgkmcnt(4)
    v_mfma_f32_16x16x32_bf16 v[196:199], a[136:139], a[180:183], 0
    ds_read_b64_tr_b16 a[198:199], v60 offset:36096
    s_cselect_b32 s63, 0, s63
    v_mfma_f32_16x16x32_bf16 v[204:207], a[136:139], a[184:187], 0
    ds_read_b128 a[156:159], v41 offset:39936
    buffer_load_dwordx4 v68, s[28:31], s63 offen sc1 lds
    v_mfma_f32_16x16x32_bf16 v[188:191], a[136:139], a[176:179], 0
    ds_read_b128 a[160:163], v41 offset:40960
    v_mfma_f32_16x16x32_bf16 v[200:203], a[140:143], a[180:183], 0
    ds_read_b64_tr_b16 a[188:189], v61 offset:34816
    buffer_load_dwordx4 v68, s[28:31], s63 offen offset:1024 sc1 lds
    v_mfma_f32_16x16x32_bf16 v[208:211], a[140:143], a[184:187], 0
    ds_read_b64_tr_b16 a[190:191], v61 offset:35072
    v_mfma_f32_16x16x32_bf16 v[192:195], a[140:143], a[176:179], 0
    ds_read_b128 a[164:167], v41 offset:41984
    v_mfma_f32_16x16x32_bf16 v[220:223], a[180:183], a[144:147], 0
    ds_read_b128 a[168:171], v41 offset:43008
    v_mfma_f32_16x16x32_bf16 v[228:231], a[184:187], a[144:147], 0
    ds_read_b128 a[172:175], v41 offset:44032
    buffer_load_dwordx4 v68, s[28:31], s63 offen offset:2048 sc1 lds
    v_mfma_f32_16x16x32_bf16 v[212:215], a[176:179], a[144:147], 0
    s_add_u32 m0, s100, 61440
    s_add_u32 s62, s62, 262144
    v_mfma_f32_16x16x32_bf16 v[224:227], a[180:183], a[148:151], 0
    s_cmp_eq_u32 s62, 1835008
    s_cselect_b32 s62, 0, s62
    v_mfma_f32_16x16x32_bf16 v[232:235], a[184:187], a[148:151], 0
    v_mfma_f32_16x16x32_bf16 v[216:219], a[176:179], a[148:151], 0
    buffer_load_dwordx4 v57, s[28:31], s62 offen sc1 lds
    s_waitcnt lgkmcnt(0)
    s_barrier
    v_mfma_f32_16x16x32_bf16 v[172:175], a[152:155], a[192:195], v[172:175]
    ds_read_b64_tr_b16 a[180:181], v62 offset:0
    s_add_u32 m0, s58, 45056
    v_mfma_f32_16x16x32_bf16 v[180:183], a[152:155], a[196:199], v[180:183]
    ds_read_b64_tr_b16 a[182:183], v62 offset:256
    v_mfma_f32_16x16x32_bf16 v[176:179], a[156:159], a[192:195], v[176:179]
    ds_read_b128 a[128:131], v42 offset:0
    buffer_load_dwordx4 v55, s[28:31], s62 offen sc1 lds
    v_mfma_f32_16x16x32_bf16 v[184:187], a[156:159], a[196:199], v[184:187]
    ds_read_b64_tr_b16 a[184:185], v62 offset:1024
    v_mfma_f32_16x16x32_bf16 v[196:199], a[160:163], a[192:195], v[196:199]
    ds_read_b64_tr_b16 a[186:187], v62 offset:1280
    v_mfma_f32_16x16x32_bf16 v[204:207], a[160:163], a[196:199], v[204:207]
    ds_read_b128 a[132:135], v42 offset:1024
    v_mfma_f32_16x16x32_bf16 v[188:191], a[160:163], a[188:191], v[188:191]
    ds_read_b128 a[136:139], v42 offset:2048
    buffer_load_dwordx4 v55, s[28:31], s62 offen offset:1024 sc1 lds
    v_mfma_f32_16x16x32_bf16 v[200:203], a[164:167], a[192:195], v[200:203]
    ds_read_b64_tr_b16 a[176:177], v63 offset:0
    v_mfma_f32_16x16x32_bf16 v[208:211], a[164:167], a[196:199], v[208:211]
    ds_read_b64_tr_b16 a[178:179], v63 offset:256
    v_mfma_f32_16x16x32_bf16 v[192:195], a[164:167], a[188:191], v[192:195]
    ds_read_b128 a[140:143], v42 offset:3072
    v_mfma_f32_16x16x32_bf16 v[220:223], a[192:195], a[168:171], v[220:223]
    ds_read_b128 a[144:147], v42 offset:4096
    buffer_load_dwordx4 v56, s[28:31], s62 offen offset:2048 sc1 lds
    v_mfma_f32_16x16x32_bf16 v[228:231], a[196:199], a[168:171], v[228:231]
    ds_read_b128 a[148:151], v42 offset:5120
    v_mfma_f32_16x16x32_bf16 v[212:215], a[188:191], a[168:171], v[212:215]
    v_mfma_f32_16x16x32_bf16 v[224:227], a[192:195], a[172:175], v[224:227]
    v_mfma_f32_16x16x32_bf16 v[232:235], a[196:199], a[172:175], v[232:235]
    buffer_load_dwordx4 v56, s[28:31], s62 offen offset:3072 sc1 lds
    s_add_u32 m0, s59, 98304
    v_mfma_f32_16x16x32_bf16 v[216:219], a[188:191], a[172:175], v[216:219]
    s_add_u32 s63, s63, 12288
    s_waitcnt lgkmcnt(6)
    v_mfma_f32_16x16x32_bf16 v[172:175], a[128:131], a[180:183], v[172:175]
    ds_read_b64_tr_b16 a[192:193], v62 offset:2048
    s_cmp_eq_u32 s63, 86016
    v_mfma_f32_16x16x32_bf16 v[180:183], a[128:131], a[184:187], v[180:183]
    ds_read_b64_tr_b16 a[194:195], v62 offset:2304
    s_cselect_b32 s63, 0, s63
    v_mfma_f32_16x16x32_bf16 v[176:179], a[132:135], a[180:183], v[176:179]
    ds_read_b128 a[152:155], v42 offset:6144
    buffer_load_dwordx4 v68, s[28:31], s63 offen sc1 lds
    v_mfma_f32_16x16x32_bf16 v[184:187], a[132:135], a[184:187], v[184:187]
    ds_read_b64_tr_b16 a[196:197], v62 offset:3072
    s_waitcnt lgkmcnt(4)
    v_mfma_f32_16x16x32_bf16 v[196:199], a[136:139], a[180:183], v[196:199]
    ds_read_b64_tr_b16 a[198:199], v62 offset:3328
    v_mfma_f32_16x16x32_bf16 v[204:207], a[136:139], a[184:187], v[204:207]
    ds_read_b128 a[156:159], v42 offset:7168
    buffer_load_dwordx4 v68, s[28:31], s63 offen offset:1024 sc1 lds
    v_mfma_f32_16x16x32_bf16 v[188:191], a[136:139], a[176:179], v[188:191]
    ds_read_b128 a[160:163], v42 offset:8192
    v_mfma_f32_16x16x32_bf16 v[200:203], a[140:143], a[180:183], v[200:203]
    ds_read_b64_tr_b16 a[188:189], v63 offset:2048
    v_mfma_f32_16x16x32_bf16 v[208:211], a[140:143], a[184:187], v[208:211]
    ds_read_b64_tr_b16 a[190:191], v63 offset:2304
    v_mfma_f32_16x16x32_bf16 v[192:195], a[140:143], a[176:179], v[192:195]
    ds_read_b128 a[164:167], v42 offset:9216
    buffer_load_dwordx4 v68, s[28:31], s63 offen offset:2048 sc1 lds
    v_mfma_f32_16x16x32_bf16 v[220:223], a[180:183], a[144:147], v[220:223]
    ds_read_b128 a[168:171], v42 offset:10240
    s_add_u32 m0, s100, 126976
    v_mfma_f32_16x16x32_bf16 v[228:231], a[184:187], a[144:147], v[228:231]
    ds_read_b128 a[172:175], v42 offset:11264
    s_add_u32 s62, s62, 262144
    v_mfma_f32_16x16x32_bf16 v[212:215], a[176:179], a[144:147], v[212:215]
    s_cmp_eq_u32 s62, 1835008
    s_cselect_b32 s62, 0, s62
    v_mfma_f32_16x16x32_bf16 v[224:227], a[180:183], a[148:151], v[224:227]
    buffer_load_dwordx4 v57, s[28:31], s62 offen sc1 lds
    s_add_u32 m0, s58, 110592
    v_mfma_f32_16x16x32_bf16 v[232:235], a[184:187], a[148:151], v[232:235]
    v_lshlrev_b32 v14, 2, v2
    v_mfma_f32_16x16x32_bf16 v[216:219], a[176:179], a[148:151], v[216:219]
    v_and_b32 v15, 1, v1
    s_waitcnt vmcnt(12) lgkmcnt(0)
    s_barrier
    s_cmp_lg_u32 s48, 0
    s_cbranch_scc1 L_sig1
    s_atomic_add s36, s[28:29], s68
L_sig1:
    v_mfma_f32_16x16x32_bf16 v[172:175], a[152:155], a[192:195], v[172:175]
    ds_read_b64_tr_b16 a[180:181], v58 offset:0
    buffer_load_dwordx4 v55, s[28:31], s62 offen sc1 lds
    v_mfma_f32_16x16x32_bf16 v[180:183], a[152:155], a[196:199], v[180:183]
    ds_read_b64_tr_b16 a[182:183], v58 offset:256
    v_mfma_f32_16x16x32_bf16 v[176:179], a[156:159], a[192:195], v[176:179]
    ds_read_b128 a[128:131], v4 offset:0
    v_mfma_f32_16x16x32_bf16 v[184:187], a[156:159], a[196:199], v[184:187]
    ds_read_b64_tr_b16 a[184:185], v58 offset:1024
    v_mfma_f32_16x16x32_bf16 v[196:199], a[160:163], a[192:195], v[196:199]
    ds_read_b64_tr_b16 a[186:187], v58 offset:1280
    buffer_load_dwordx4 v55, s[28:31], s62 offen offset:1024 sc1 lds
    v_mfma_f32_16x16x32_bf16 v[204:207], a[160:163], a[196:199], v[204:207]
    ds_read_b128 a[132:135], v4 offset:1024
    v_mfma_f32_16x16x32_bf16 v[188:191], a[160:163], a[188:191], v[188:191]
    ds_read_b128 a[136:139], v4 offset:2048
    buffer_load_dwordx4 v56, s[28:31], s62 offen offset:2048 sc1 lds
    v_mfma_f32_16x16x32_bf16 v[200:203], a[164:167], a[192:195], v[200:203]
    ds_read_b64_tr_b16 a[176:177], v59 offset:0
    v_mfma_f32_16x16x32_bf16 v[208:211], a[164:167], a[196:199], v[208:211]
    ds_read_b64_tr_b16 a[178:179], v59 offset:256
    v_mfma_f32_16x16x32_bf16 v[192:195], a[164:167], a[188:191], v[192:195]
    ds_read_b128 a[140:143], v4 offset:3072
    v_mfma_f32_16x16x32_bf16 v[220:223], a[192:195], a[168:171], v[220:223]
    ds_read_b128 a[144:147], v4 offset:4096
    buffer_load_dwordx4 v56, s[28:31], s62 offen offset:3072 sc1 lds
    v_mfma_f32_16x16x32_bf16 v[228:231], a[196:199], a[168:171], v[228:231]
    ds_read_b128 a[148:151], v4 offset:5120
    s_add_u32 m0, s59, 131072
    v_mfma_f32_16x16x32_bf16 v[212:215], a[188:191], a[168:171], v[212:215]
    s_add_u32 s63, s63, 12288
    s_cmp_eq_u32 s63, 86016
    v_mfma_f32_16x16x32_bf16 v[224:227], a[192:195], a[172:175], v[224:227]
    s_cselect_b32 s63, 0, s63
    v_lshl_add_u32 v15, v3, 2, v15
    v_mfma_f32_16x16x32_bf16 v[232:235], a[196:199], a[172:175], v[232:235]
    buffer_load_dwordx4 v68, s[28:31], s63 offen sc1 lds
    v_lshlrev_b32 v15, 2, v15
    v_mfma_f32_16x16x32_bf16 v[216:219], a[188:191], a[172:175], v[216:219]
    v_add_u32 v16, 64, v15
    s_waitcnt lgkmcnt(6)
    v_mfma_f32_16x16x32_bf16 v[172:175], a[128:131], a[180:183], v[172:175]
    ds_read_b64_tr_b16 a[192:193], v58 offset:2048
    v_mfma_f32_16x16x32_bf16 v[180:183], a[128:131], a[184:187], v[180:183]
    ds_read_b64_tr_b16 a[194:195], v58 offset:2304
    buffer_load_dwordx4 v68, s[28:31], s63 offen offset:1024 sc1 lds
    v_mfma_f32_16x16x32_bf16 v[176:179], a[132:135], a[180:183], v[176:179]
    ds_read_b128 a[152:155], v4 offset:6144
    v_mfma_f32_16x16x32_bf16 v[184:187], a[132:135], a[184:187], v[184:187]
    ds_read_b64_tr_b16 a[196:197], v58 offset:3072
    s_waitcnt lgkmcnt(4)
    v_mfma_f32_16x16x32_bf16 v[196:199], a[136:139], a[180:183], v[196:199]
    ds_read_b64_tr_b16 a[198:199], v58 offset:3328
    v_mfma_f32_16x16x32_bf16 v[204:207], a[136:139], a[184:187], v[204:207]
    ds_read_b128 a[156:159], v4 offset:7168
    buffer_load_dwordx4 v68, s[28:31], s63 offen offset:2048 sc1 lds
    v_mfma_f32_16x16x32_bf16 v[188:191], a[136:139], a[176:179], v[188:191]
    ds_read_b128 a[160:163], v4 offset:8192
    s_add_u32 m0, s100, 159744
    v_mfma_f32_16x16x32_bf16 v[200:203], a[140:143], a[180:183], v[200:203]
    ds_read_b64_tr_b16 a[188:189], v59 offset:2048
    s_add_u32 s62, s62, 262144
    v_mfma_f32_16x16x32_bf16 v[208:211], a[140:143], a[184:187], v[208:211]
    ds_read_b64_tr_b16 a[190:191], v59 offset:2304
    s_cmp_eq_u32 s62, 1835008
    v_mfma_f32_16x16x32_bf16 v[192:195], a[140:143], a[176:179], v[192:195]
    ds_read_b128 a[164:167], v4 offset:9216
    s_cselect_b32 s62, 0, s62
    v_mfma_f32_16x16x32_bf16 v[220:223], a[180:183], a[144:147], v[220:223]
    ds_read_b128 a[168:171], v4 offset:10240
    buffer_load_dwordx4 v57, s[28:31], s62 offen sc1 lds
    v_mfma_f32_16x16x32_bf16 v[228:231], a[184:187], a[144:147], v[228:231]
    ds_read_b128 a[172:175], v4 offset:11264
    s_add_u32 m0, s58, 143360
    v_mfma_f32_16x16x32_bf16 v[212:215], a[176:179], a[144:147], v[212:215]
    buffer_load_dwordx4 v55, s[28:31], s62 offen sc1 lds
    v_cndmask_b32 v17, v15, v16, s[72:73]
    v_mfma_f32_16x16x32_bf16 v[224:227], a[180:183], a[148:151], v[224:227]
    v_cndmask_b32 v15, v15, v16, s[74:75]
    v_mfma_f32_16x16x32_bf16 v[232:235], a[184:187], a[148:151], v[232:235]
    ds_bpermute_b32 v244, v14, v64 offset:64
    v_mfma_f32_16x16x32_bf16 v[216:219], a[176:179], a[148:151], v[216:219]
    ds_bpermute_b32 v168, v17, v64 offset:0
    ds_read_b32 v25, v4
    s_waitcnt lgkmcnt(1)
    s_barrier
    v_mfma_f32_16x16x32_bf16 v[172:175], a[152:155], a[192:195], v[172:175]
    ds_read_b64_tr_b16 a[180:181], v60 offset:0
    buffer_load_dwordx4 v55, s[28:31], s62 offen offset:1024 sc1 lds
    v_mfma_f32_16x16x32_bf16 v[180:183], a[152:155], a[196:199], v[180:183]
    ds_read_b64_tr_b16 a[182:183], v60 offset:256
    v_mfma_f32_16x16x32_bf16 v[176:179], a[156:159], a[192:195], v[176:179]
    ds_read_b128 a[128:131], v41 offset:0
    v_mfma_f32_16x16x32_bf16 v[184:187], a[156:159], a[196:199], v[184:187]
    ds_read_b64_tr_b16 a[184:185], v60 offset:1024
    v_mfma_f32_16x16x32_bf16 v[196:199], a[160:163], a[192:195], v[196:199]
    ds_read_b64_tr_b16 a[186:187], v60 offset:1280
    buffer_load_dwordx4 v56, s[28:31], s62 offen offset:2048 sc1 lds
    v_mfma_f32_16x16x32_bf16 v[204:207], a[160:163], a[196:199], v[204:207]
    ds_read_b128 a[132:135], v41 offset:1024
    v_mfma_f32_16x16x32_bf16 v[188:191], a[160:163], a[188:191], v[188:191]
    ds_read_b128 a[136:139], v41 offset:2048
    v_mfma_f32_16x16x32_bf16 v[200:203], a[164:167], a[192:195], v[200:203]
    ds_read_b64_tr_b16 a[176:177], v61 offset:0
    buffer_load_dwordx4 v56, s[28:31], s62 offen offset:3072 sc1 lds
    v_mfma_f32_16x16x32_bf16 v[208:211], a[164:167], a[196:199], v[208:211]
    ds_read_b64_tr_b16 a[178:179], v61 offset:256
    s_add_u32 m0, s58, 0
    v_mfma_f32_16x16x32_bf16 v[192:195], a[164:167], a[188:191], v[192:195]
    ds_read_b128 a[140:143], v41 offset:3072
    v_mfma_f32_16x16x32_bf16 v[220:223], a[192:195], a[168:171], v[220:223]
    ds_read_b128 a[144:147], v41 offset:4096
    v_mfma_f32_16x16x32_bf16 v[228:231], a[196:199], a[168:171], v[228:231]
    ds_read_b128 a[148:151], v41 offset:5120
    buffer_load_dwordx4 v47, s[24:27], s64 offen lds
    v_mfma_f32_16x16x32_bf16 v[212:215], a[188:191], a[168:171], v[212:215]
    ds_bpermute_b32 v169, v15, v64 offset:8
    v_mfma_f32_16x16x32_bf16 v[224:227], a[192:195], a[172:175], v[224:227]
    ds_bpermute_b32 v245, v14, v64 offset:128
    v_mfma_f32_16x16x32_bf16 v[232:235], a[196:199], a[172:175], v[232:235]
    buffer_load_dwordx4 v48, s[24:27], s64 offen offset:1024 lds
    ds_bpermute_b32 v170, v17, v64 offset:64
    v_mfma_f32_16x16x32_bf16 v[216:219], a[188:191], a[172:175], v[216:219]
    ds_bpermute_b32 v171, v15, v64 offset:72
    s_waitcnt lgkmcnt(6)
    v_mfma_f32_16x16x32_bf16 v[172:175], a[128:131], a[180:183], v[172:175]
    ds_read_b64_tr_b16 a[192:193], v60 offset:2048
    v_mfma_f32_16x16x32_bf16 v[180:183], a[128:131], a[184:187], v[180:183]
    ds_read_b64_tr_b16 a[194:195], v60 offset:2304
    v_mfma_f32_16x16x32_bf16 v[176:179], a[132:135], a[180:183], v[176:179]
    ds_read_b128 a[152:155], v41 offset:6144
    buffer_load_dwordx4 v49, s[24:27], s64 offen offset:2048 lds
    v_mfma_f32_16x16x32_bf16 v[184:187], a[132:135], a[184:187], v[184:187]
    ds_read_b64_tr_b16 a[196:197], v60 offset:3072
    s_waitcnt lgkmcnt(4)
    v_mfma_f32_16x16x32_bf16 v[196:199], a[136:139], a[180:183], v[196:199]
    ds_read_b64_tr_b16 a[198:199], v60 offset:3328
    v_mfma_f32_16x16x32_bf16 v[204:207], a[136:139], a[184:187], v[204:207]
    ds_read_b128 a[156:159], v41 offset:7168
    v_mfma_f32_16x16x32_bf16 v[188:191], a[136:139], a[176:179], v[188:191]
    ds_read_b128 a[160:163], v41 offset:8192
    buffer_load_dwordx4 v50, s[24:27], s64 offen offset:3072 lds
    v_mfma_f32_16x16x32_bf16 v[200:203], a[140:143], a[180:183], v[200:203]
    ds_read_b64_tr_b16 a[188:189], v61 offset:2048
    s_add_u32 m0, s58, 16384
    v_mfma_f32_16x16x32_bf16 v[208:211], a[140:143], a[184:187], v[208:211]
    ds_read_b64_tr_b16 a[190:191], v61 offset:2304
    v_xor_b32 v47, 128, v47
    v_mfma_f32_16x16x32_bf16 v[192:195], a[140:143], a[176:179], v[192:195]
    ds_read_b128 a[164:167], v41 offset:9216
    v_mfma_f32_16x16x32_bf16 v[220:223], a[180:183], a[144:147], v[220:223]
    ds_read_b128 a[168:171], v41 offset:10240
    buffer_load_dwordx4 v47, s[24:27], s64 offen lds
    v_mfma_f32_16x16x32_bf16 v[228:231], a[184:187], a[144:147], v[228:231]
    ds_read_b128 a[172:175], v41 offset:11264
    v_xor_b32 v48, 128, v48
    v_mfma_f32_16x16x32_bf16 v[212:215], a[176:179], a[144:147], v[212:215]
    v_mfma_f32_16x16x32_bf16 v[224:227], a[180:183], a[148:151], v[224:227]
    buffer_load_dwordx4 v48, s[24:27], s64 offen offset:1024 lds
    v_xor_b32 v49, 128, v49
    v_mfma_f32_16x16x32_bf16 v[232:235], a[184:187], a[148:151], v[232:235]
    v_mfma_f32_16x16x32_bf16 v[216:219], a[176:179], a[148:151], v[216:219]
    ds_read_b32 v25, v4
    s_waitcnt vmcnt(22) lgkmcnt(1)
    s_barrier
    v_mfma_f32_16x16x32_bf16 v[172:175], a[152:155], a[192:195], v[172:175]
    ds_read_b64_tr_b16 a[180:181], v58 offset:32768
    v_mfma_f32_16x16x32_bf16 v[180:183], a[152:155], a[196:199], v[180:183]
    ds_read_b64_tr_b16 a[182:183], v58 offset:33024
    buffer_load_dwordx4 v49, s[24:27], s64 offen offset:2048 lds
    v_mfma_f32_16x16x32_bf16 v[176:179], a[156:159], a[192:195], v[176:179]
    ds_read_b128 a[128:131], v4 offset:32768
    v_xor_b32 v50, 128, v50
    v_mfma_f32_16x16x32_bf16 v[184:187], a[156:159], a[196:199], v[184:187]
    ds_read_b64_tr_b16 a[184:185], v58 offset:33792
    v_mfma_f32_16x16x32_bf16 v[196:199], a[160:163], a[192:195], v[196:199]
    ds_read_b64_tr_b16 a[186:187], v58 offset:34048
    v_mfma_f32_16x16x32_bf16 v[204:207], a[160:163], a[196:199], v[204:207]
    ds_read_b128 a[132:135], v4 offset:33792
    buffer_load_dwordx4 v50, s[24:27], s64 offen offset:3072 lds
    v_mfma_f32_16x16x32_bf16 v[188:191], a[160:163], a[188:191], v[188:191]
    ds_read_b128 a[136:139], v4 offset:34816
    s_add_u32 m0, s58, 65536
    v_mfma_f32_16x16x32_bf16 v[200:203], a[164:167], a[192:195], v[200:203]
    ds_read_b64_tr_b16 a[176:177], v59 offset:32768
    s_add_u32 s64, s64, 524288
    v_mfma_f32_16x16x32_bf16 v[208:211], a[164:167], a[196:199], v[208:211]
    ds_read_b64_tr_b16 a[178:179], v59 offset:33024
    s_cmp_eq_u32 s64, 3670016
    v_mfma_f32_16x16x32_bf16 v[192:195], a[164:167], a[188:191], v[192:195]
    ds_read_b128 a[140:143], v4 offset:35840
    s_cselect_b32 s64, 0, s64
    v_mfma_f32_16x16x32_bf16 v[220:223], a[192:195], a[168:171], v[220:223]
    ds_read_b128 a[144:147], v4 offset:36864
    buffer_load_dwordx4 v47, s[24:27], s64 offen lds
    v_mfma_f32_16x16x32_bf16 v[228:231], a[196:199], a[168:171], v[228:231]
    ds_read_b128 a[148:151], v4 offset:37888
    v_mfma_f32_16x16x32_bf16 v[212:215], a[188:191], a[168:171], v[212:215]
    buffer_load_dwordx4 v48, s[24:27], s64 offen offset:1024 lds
    v_mfma_f32_16x16x32_bf16 v[224:227], a[192:195], a[172:175], v[224:227]
    v_mfma_f32_16x16x32_bf16 v[232:235], a[196:199], a[172:175], v[232:235]
    v_mul_f32 v244, s83, v244
    v_mfma_f32_16x16x32_bf16 v[216:219], a[188:191], a[172:175], v[216:219]
    v_mul_f32 v245, s83, v245
    s_waitcnt lgkmcnt(6)
    v_mfma_f32_16x16x32_bf16 v[172:175], a[128:131], a[180:183], v[172:175]
    ds_read_b64_tr_b16 a[192:193], v58 offset:34816
    buffer_load_dwordx4 v49, s[24:27], s64 offen offset:2048 lds
    v_mfma_f32_16x16x32_bf16 v[180:183], a[128:131], a[184:187], v[180:183]
    ds_read_b64_tr_b16 a[194:195], v58 offset:35072
    v_mfma_f32_16x16x32_bf16 v[176:179], a[132:135], a[180:183], v[176:179]
    ds_read_b128 a[152:155], v4 offset:38912
    v_mfma_f32_16x16x32_bf16 v[184:187], a[132:135], a[184:187], v[184:187]
    ds_read_b64_tr_b16 a[196:197], v58 offset:35840
    s_waitcnt lgkmcnt(4)
    v_mfma_f32_16x16x32_bf16 v[196:199], a[136:139], a[180:183], v[196:199]
    ds_read_b64_tr_b16 a[198:199], v58 offset:36096
    buffer_load_dwordx4 v50, s[24:27], s64 offen offset:3072 lds
    v_mfma_f32_16x16x32_bf16 v[204:207], a[136:139], a[184:187], v[204:207]
    ds_read_b128 a[156:159], v4 offset:39936
    s_add_u32 m0, s58, 81920
    v_mfma_f32_16x16x32_bf16 v[188:191], a[136:139], a[176:179], v[188:191]
    ds_read_b128 a[160:163], v4 offset:40960
    s_add_u32 s64, s64, 524288
    v_mfma_f32_16x16x32_bf16 v[200:203], a[140:143], a[180:183], v[200:203]
    ds_read_b64_tr_b16 a[188:189], v59 offset:34816
    s_cmp_eq_u32 s64, 3670016
    v_mfma_f32_16x16x32_bf16 v[208:211], a[140:143], a[184:187], v[208:211]
    ds_read_b64_tr_b16 a[190:191], v59 offset:35072
    s_cselect_b32 s64, 0, s64
    v_mfma_f32_16x16x32_bf16 v[192:195], a[140:143], a[176:179], v[192:195]
    ds_read_b128 a[164:167], v4 offset:41984
    buffer_load_dwordx4 v47, s[24:27], s64 offen lds
    v_mfma_f32_16x16x32_bf16 v[220:223], a[180:183], a[144:147], v[220:223]
    ds_read_b128 a[168:171], v4 offset:43008
    v_mfma_f32_16x16x32_bf16 v[228:231], a[184:187], a[144:147], v[228:231]
    ds_read_b128 a[172:175], v4 offset:44032
    buffer_load_dwordx4 v48, s[24:27], s64 offen offset:1024 lds
    v_mfma_f32_16x16x32_bf16 v[212:215], a[176:179], a[144:147], v[212:215]
    v_mfma_f32_16x16x32_bf16 v[224:227], a[180:183], a[148:151], v[224:227]
    v_mfma_f32_16x16x32_bf16 v[232:235], a[184:187], a[148:151], v[232:235]
    v_mfma_f32_16x16x32_bf16 v[216:219], a[176:179], a[148:151], v[216:219]
    buffer_load_dwordx4 v49, s[24:27], s64 offen offset:2048 lds
    ds_read_b32 v25, v4
    s_waitcnt vmcnt(23) lgkmcnt(1)
    s_barrier
    v_mfma_f32_16x16x32_bf16 v[172:175], a[152:155], a[192:195], v[172:175]
    ds_read_b64_tr_b16 a[180:181], v60 offset:32768
    v_mfma_f32_16x16x32_bf16 v[180:183], a[152:155], a[196:199], v[180:183]
    ds_read_b64_tr_b16 a[182:183], v60 offset:33024
    v_mfma_f32_16x16x32_bf16 v[176:179], a[156:159], a[192:195], v[176:179]
    ds_read_b128 a[128:131], v41 offset:32768
    v_mfma_f32_16x16x32_bf16 v[184:187], a[156:159], a[196:199], v[184:187]
    ds_read_b64_tr_b16 a[184:185], v60 offset:33792
    v_mfma_f32_16x16x32_bf16 v[196:199], a[160:163], a[192:195], v[196:199]
    ds_read_b64_tr_b16 a[186:187], v60 offset:34048
    buffer_load_dwordx4 v50, s[24:27], s64 offen offset:3072 lds
    v_mfma_f32_16x16x32_bf16 v[204:207], a[160:163], a[196:199], v[204:207]
    ds_read_b128 a[132:135], v41 offset:33792
    s_add_u32 m0, s58, 32768
    v_mfma_f32_16x16x32_bf16 v[188:191], a[160:163], a[188:191], v[188:191]
    ds_read_b128 a[136:139], v41 offset:34816
    s_add_u32 s64, s64, 524288
    v_mfma_f32_16x16x32_bf16 v[200:203], a[164:167], a[192:195], v[200:203]
    ds_read_b64_tr_b16 a[176:177], v61 offset:32768
    s_cmp_eq_u32 s64, 3670016
    v_mfma_f32_16x16x32_bf16 v[208:211], a[164:167], a[196:199], v[208:211]
    ds_read_b64_tr_b16 a[178:179], v61 offset:33024
    s_cselect_b32 s64, 0, s64
    v_mfma_f32_16x16x32_bf16 v[192:195], a[164:167], a[188:191], v[192:195]
    ds_read_b128 a[140:143], v41 offset:35840
    buffer_load_dwordx4 v47, s[24:27], s64 offen lds
    v_mfma_f32_16x16x32_bf16 v[220:223], a[192:195], a[168:171], v[220:223]
    ds_read_b128 a[144:147], v41 offset:36864
    v_mfma_f32_16x16x32_bf16 v[228:231], a[196:199], a[168:171], v[228:231]
    ds_read_b128 a[148:151], v41 offset:37888
    buffer_load_dwordx4 v48, s[24:27], s64 offen offset:1024 lds
    v_mfma_f32_16x16x32_bf16 v[212:215], a[188:191], a[168:171], v[212:215]
    v_mfma_f32_16x16x32_bf16 v[224:227], a[192:195], a[172:175], v[224:227]
    v_mfma_f32_16x16x32_bf16 v[232:235], a[196:199], a[172:175], v[232:235]
    v_mfma_f32_16x16x32_bf16 v[216:219], a[188:191], a[172:175], v[216:219]
    buffer_load_dwordx4 v49, s[24:27], s64 offen offset:2048 lds
    s_waitcnt lgkmcnt(6)
    v_mfma_f32_16x16x32_bf16 v[172:175], a[128:131], a[180:183], v[172:175]
    ds_read_b64_tr_b16 a[192:193], v60 offset:34816
    v_mfma_f32_16x16x32_bf16 v[180:183], a[128:131], a[184:187], v[180:183]
    ds_read_b64_tr_b16 a[194:195], v60 offset:35072
    v_mfma_f32_16x16x32_bf16 v[176:179], a[132:135], a[180:183], v[176:179]
    ds_read_b128 a[152:155], v41 offset:38912
    v_mfma_f32_16x16x32_bf16 v[184:187], a[132:135], a[184:187], v[184:187]
    ds_read_b64_tr_b16 a[196:197], v60 offset:35840
    s_waitcnt lgkmcnt(4)
    v_mfma_f32_16x16x32_bf16 v[196:199], a[136:139], a[180:183], v[196:199]
    ds_read_b64_tr_b16 a[198:199], v60 offset:36096
    buffer_load_dwordx4 v50, s[24:27], s64 offen offset:3072 lds
    v_mfma_f32_16x16x32_bf16 v[204:207], a[136:139], a[184:187], v[204:207]
    ds_read_b128 a[156:159], v41 offset:39936
    s_add_u32 m0, s58, 49152
    v_mfma_f32_16x16x32_bf16 v[188:191], a[136:139], a[176:179], v[188:191]
    ds_read_b128 a[160:163], v41 offset:40960
    s_add_u32 s64, s64, 524288
    v_mfma_f32_16x16x32_bf16 v[200:203], a[140:143], a[180:183], v[200:203]
    ds_read_b64_tr_b16 a[188:189], v61 offset:34816
    s_cmp_eq_u32 s64, 3670016
    v_mfma_f32_16x16x32_bf16 v[208:211], a[140:143], a[184:187], v[208:211]
    ds_read_b64_tr_b16 a[190:191], v61 offset:35072
    s_cselect_b32 s64, 0, s64
    v_mfma_f32_16x16x32_bf16 v[192:195], a[140:143], a[176:179], v[192:195]
    ds_read_b128 a[164:167], v41 offset:41984
    buffer_load_dwordx4 v47, s[24:27], s64 offen lds
    v_mfma_f32_16x16x32_bf16 v[220:223], a[180:183], a[144:147], v[220:223]
    ds_read_b128 a[168:171], v41 offset:43008
    v_mfma_f32_16x16x32_bf16 v[228:231], a[184:187], a[144:147], v[228:231]
    ds_read_b128 a[172:175], v41 offset:44032
    buffer_load_dwordx4 v48, s[24:27], s64 offen offset:1024 lds
    v_mfma_f32_16x16x32_bf16 v[212:215], a[176:179], a[144:147], v[212:215]
    v_mfma_f32_16x16x32_bf16 v[224:227], a[180:183], a[148:151], v[224:227]
    v_mfma_f32_16x16x32_bf16 v[232:235], a[184:187], a[148:151], v[232:235]
    v_mfma_f32_16x16x32_bf16 v[216:219], a[176:179], a[148:151], v[216:219]
    buffer_load_dwordx4 v49, s[24:27], s64 offen offset:2048 lds
    ds_read_b32 v25, v4
    s_waitcnt vmcnt(23) lgkmcnt(1)
    s_barrier
    s_load_dword s46, s[28:29], s38 glc
    v_mfma_f32_16x16x32_bf16 v[172:175], a[152:155], a[192:195], v[172:175]
    ds_read_b64_tr_b16 a[180:181], v62 offset:0
    v_mfma_f32_16x16x32_bf16 v[180:183], a[152:155], a[196:199], v[180:183]
    ds_read_b64_tr_b16 a[182:183], v62 offset:256
    v_mfma_f32_16x16x32_bf16 v[176:179], a[156:159], a[192:195], v[176:179]
    ds_read_b128 a[128:131], v42 offset:0
    buffer_load_dwordx4 v50, s[24:27], s64 offen offset:3072 lds
    v_mfma_f32_16x16x32_bf16 v[184:187], a[156:159], a[196:199], v[184:187]
    ds_read_b64_tr_b16 a[184:185], v62 offset:1024
    v_mfma_f32_16x16x32_bf16 v[196:199], a[160:163], a[192:195], v[196:199]
    ds_read_b64_tr_b16 a[186:187], v62 offset:1280
    s_add_u32 m0, s58, 98304
    v_mfma_f32_16x16x32_bf16 v[204:207], a[160:163], a[196:199], v[204:207]
    ds_read_b128 a[132:135], v42 offset:1024
    s_add_u32 s64, s64, 524288
    v_mfma_f32_16x16x32_bf16 v[188:191], a[160:163], a[188:191], v[188:191]
    ds_read_b128 a[136:139], v42 offset:2048
    s_cmp_eq_u32 s64, 3670016
    v_mfma_f32_16x16x32_bf16 v[200:203], a[164:167], a[192:195], v[200:203]
    ds_read_b64_tr_b16 a[176:177], v63 offset:0
    s_cselect_b32 s64, 0, s64
    v_mfma_f32_16x16x32_bf16 v[208:211], a[164:167], a[196:199], v[208:211]
    ds_read_b64_tr_b16 a[178:179], v63 offset:256
    buffer_load_dwordx4 v47, s[24:27], s64 offen lds
    v_mfma_f32_16x16x32_bf16 v[192:195], a[164:167], a[188:191], v[192:195]
    ds_read_b128 a[140:143], v42 offset:3072
    v_mfma_f32_16x16x32_bf16 v[220:223], a[192:195], a[168:171], v[220:223]
    ds_read_b128 a[144:147], v42 offset:4096
    buffer_load_dwordx4 v48, s[24:27], s64 offen offset:1024 lds
    v_mfma_f32_16x16x32_bf16 v[228:231], a[196:199], a[168:171], v[228:231]
    ds_read_b128 a[148:151], v42 offset:5120
    v_mfma_f32_16x16x32_bf16 v[212:215], a[188:191], a[168:171], v[212:215]
    v_mfma_f32_16x16x32_bf16 v[224:227], a[192:195], a[172:175], v[224:227]
    v_mfma_f32_16x16x32_bf16 v[232:235], a[196:199], a[172:175], v[232:235]
    buffer_load_dwordx4 v49, s[24:27], s64 offen offset:2048 lds
    v_mfma_f32_16x16x32_bf16 v[216:219], a[188:191], a[172:175], v[216:219]
    s_waitcnt lgkmcnt(6)
    v_mfma_f32_16x16x32_bf16 v[172:175], a[128:131], a[180:183], v[172:175]
    ds_read_b64_tr_b16 a[192:193], v62 offset:2048
    v_mfma_f32_16x16x32_bf16 v[180:183], a[128:131], a[184:187], v[180:183]
    ds_read_b64_tr_b16 a[194:195], v62 offset:2304
    v_mfma_f32_16x16x32_bf16 v[176:179], a[132:135], a[180:183], v[176:179]
    ds_read_b128 a[152:155], v42 offset:6144
    buffer_load_dwordx4 v50, s[24:27], s64 offen offset:3072 lds
    v_mfma_f32_16x16x32_bf16 v[184:187], a[132:135], a[184:187], v[184:187]
    ds_read_b64_tr_b16 a[196:197], v62 offset:3072
    s_waitcnt lgkmcnt(4)
    v_mfma_f32_16x16x32_bf16 v[196:199], a[136:139], a[180:183], v[196:199]
    ds_read_b64_tr_b16 a[198:199], v62 offset:3328
    s_add_u32 m0, s58, 114688
    v_mfma_f32_16x16x32_bf16 v[204:207], a[136:139], a[184:187], v[204:207]
    ds_read_b128 a[156:159], v42 offset:7168
    s_add_u32 s64, s64, 524288
    v_mfma_f32_16x16x32_bf16 v[188:191], a[136:139], a[176:179], v[188:191]
    ds_read_b128 a[160:163], v42 offset:8192
    s_cmp_eq_u32 s64, 3670016
    v_mfma_f32_16x16x32_bf16 v[200:203], a[140:143], a[180:183], v[200:203]
    ds_read_b64_tr_b16 a[188:189], v63 offset:2048
    s_cselect_b32 s64, 0, s64
    v_mfma_f32_16x16x32_bf16 v[208:211], a[140:143], a[184:187], v[208:211]
    ds_read_b64_tr_b16 a[190:191], v63 offset:2304
    buffer_load_dwordx4 v47, s[24:27], s64 offen lds
    v_mfma_f32_16x16x32_bf16 v[192:195], a[140:143], a[176:179], v[192:195]
    ds_read_b128 a[164:167], v42 offset:9216
    v_mfma_f32_16x16x32_bf16 v[220:223], a[180:183], a[144:147], v[220:223]
    ds_read_b128 a[168:171], v42 offset:10240
    buffer_load_dwordx4 v48, s[24:27], s64 offen offset:1024 lds
    v_mfma_f32_16x16x32_bf16 v[228:231], a[184:187], a[144:147], v[228:231]
    ds_read_b128 a[172:175], v42 offset:11264
    v_mfma_f32_16x16x32_bf16 v[212:215], a[176:179], a[144:147], v[212:215]
    v_mfma_f32_16x16x32_bf16 v[224:227], a[180:183], a[148:151], v[224:227]
    v_mfma_f32_16x16x32_bf16 v[232:235], a[184:187], a[148:151], v[232:235]
    buffer_load_dwordx4 v49, s[24:27], s64 offen offset:2048 lds
    v_mfma_f32_16x16x32_bf16 v[216:219], a[176:179], a[148:151], v[216:219]
    ds_read_b32 v25, v4
    s_waitcnt lgkmcnt(1)
    s_barrier
    v_mfma_f32_16x16x32_bf16 v[172:175], a[152:155], a[192:195], v[172:175]
    v_mfma_f32_16x16x32_bf16 v[180:183], a[152:155], a[196:199], v[180:183]
    v_mfma_f32_16x16x32_bf16 v[176:179], a[156:159], a[192:195], v[176:179]
    buffer_load_dwordx4 v50, s[24:27], s64 offen offset:3072 lds
    s_add_u32 m0, s58, 131072
    v_mfma_f32_16x16x32_bf16 v[184:187], a[156:159], a[196:199], v[184:187]
    s_add_u32 s64, s64, 524288
    v_mfma_f32_16x16x32_bf16 v[196:199], a[160:163], a[192:195], v[196:199]
    s_cmp_eq_u32 s64, 3670016
    s_cselect_b32 s64, 0, s64
    v_mfma_f32_16x16x32_bf16 v[204:207], a[160:163], a[196:199], v[204:207]
    s_add_u32 s64, s64, 524288
    s_cmp_eq_u32 s64, 3670016
    v_mfma_f32_16x16x32_bf16 v[188:191], a[160:163], a[188:191], v[188:191]
    s_cselect_b32 s64, 0, s64
    v_xor_b32 v47, 128, v47
    v_mfma_f32_16x16x32_bf16 v[200:203], a[164:167], a[192:195], v[200:203]
    buffer_load_dwordx4 v47, s[24:27], s64 offen lds
    v_xor_b32 v48, 128, v48
    v_mfma_f32_16x16x32_bf16 v[208:211], a[164:167], a[196:199], v[208:211]
    v_mfma_f32_16x16x32_bf16 v[192:195], a[164:167], a[188:191], v[192:195]
    buffer_load_dwordx4 v48, s[24:27], s64 offen offset:1024 lds
    v_xor_b32 v49, 128, v49
    v_mfma_f32_16x16x32_bf16 v[220:223], a[192:195], a[168:171], v[220:223]
    v_mfma_f32_16x16x32_bf16 v[228:231], a[196:199], a[168:171], v[228:231]
    v_mfma_f32_16x16x32_bf16 v[212:215], a[188:191], a[168:171], v[212:215]
    v_mfma_f32_16x16x32_bf16 v[224:227], a[192:195], a[172:175], v[224:227]
    buffer_load_dwordx4 v49, s[24:27], s64 offen offset:2048 lds
    v_xor_b32 v50, 128, v50
    v_mfma_f32_16x16x32_bf16 v[232:235], a[196:199], a[172:175], v[232:235]
    v_mfma_f32_16x16x32_bf16 v[216:219], a[188:191], a[172:175], v[216:219]
    s_cmp_eq_u32 s56, 0
    s_cbranch_scc1 L_pollok5
    s_waitcnt lgkmcnt(0)
    s_cmp_eq_u32 s46, 7
    s_cbranch_scc1 L_pollok5
    s_mov_b32 s60, 0
L_poll5:
    s_sleep 8
    s_load_dword s46, s[28:29], s38 glc
    s_add_u32 s60, s60, 1
    s_waitcnt lgkmcnt(0)
    s_cmp_eq_u32 s46, 7
    s_cbranch_scc1 L_pollok5
    s_cmp_lt_u32 s60, 20000
    s_cbranch_scc1 L_poll5
L_pollok5:
    v_cvt_pk_bf16_f32 v108, v172, v173
    v_cvt_pk_bf16_f32 v109, v174, v175
    buffer_load_dwordx4 v50, s[24:27], s64 offen offset:3072 lds
    v_cvt_pk_bf16_f32 v110, v176, v177
    v_cvt_pk_bf16_f32 v111, v178, v179
    v_cvt_pk_bf16_f32 v112, v180, v181
    v_cvt_pk_bf16_f32 v113, v182, v183
    v_cvt_pk_bf16_f32 v114, v184, v185
    v_cvt_pk_bf16_f32 v115, v186, v187
    v_cvt_pk_bf16_f32 v120, v196, v197
    v_cvt_pk_bf16_f32 v121, v198, v199
    v_cvt_pk_bf16_f32 v122, v200, v201
    v_cvt_pk_bf16_f32 v123, v202, v203
    v_cvt_pk_bf16_f32 v124, v204, v205
    v_cvt_pk_bf16_f32 v125, v206, v207
    v_cvt_pk_bf16_f32 v126, v208, v209
    v_cvt_pk_bf16_f32 v127, v210, v211
    v_cvt_pk_bf16_f32 v116, v188, v189
    s_add_u32 m0, s58, 147456
    s_add_u32 s64, s64, 524288
    s_cmp_eq_u32 s64, 3670016
    s_cselect_b32 s64, 0, s64
    buffer_load_dwordx4 v47, s[24:27], s64 offen lds
    v_cvt_pk_bf16_f32 v117, v190, v191
    v_cvt_pk_bf16_f32 v118, v192, v193
    v_cvt_pk_bf16_f32 v119, v194, v195
    v_mfma_f32_16x16x32_bf16 v[144:147], v[120:123], v[108:111], 0
    v_mfma_f32_16x16x32_bf16 v[148:151], v[120:123], v[112:115], 0
    v_mfma_f32_16x16x32_bf16 v[152:155], v[124:127], v[112:115], 0
    buffer_load_dwordx4 v48, s[24:27], s64 offen offset:1024 lds
    v_mfma_f32_16x16x32_bf16 v[140:143], v[116:119], v[108:111], 0
    v_cvt_pk_bf16_f32 v156, v212, v213
    v_cvt_pk_bf16_f32 v157, v214, v215
    v_cvt_pk_bf16_f32 v158, v220, v221
    v_cvt_pk_bf16_f32 v159, v222, v223
    v_cvt_pk_bf16_f32 v160, v228, v229
    v_cvt_pk_bf16_f32 v161, v230, v231
    v_cndmask_b32 v240, v148, v149, s[70:71]
    v_cndmask_b32 v243, v152, v153, s[70:71]
    v_cndmask_b32 v240, v240, v243, s[72:73]
    v_mul_f32 v240, v240, v170
    v_cndmask_b32 v241, v150, v151, s[70:71]
    buffer_load_dwordx4 v49, s[24:27], s64 offen offset:2048 lds
    v_cndmask_b32 v243, v154, v155, s[70:71]
    v_cndmask_b32 v241, v241, v243, s[74:75]
    v_mul_f32 v241, v241, v171
    v_cndmask_b32 v236, v140, v141, s[70:71]
    v_cndmask_b32 v236, v72, v236, s[76:77]
    v_cndmask_b32 v239, v144, v145, s[70:71]
    v_cndmask_b32 v236, v236, v239, s[72:73]
    v_mul_f32 v236, v236, v168
    v_cndmask_b32 v237, v142, v143, s[70:71]
    v_cndmask_b32 v237, v72, v237, s[76:77]
    v_cndmask_b32 v239, v146, v147, s[70:71]
    v_cndmask_b32 v237, v237, v239, s[74:75]
    v_mul_f32 v237, v237, v169
    v_max_f32 v238, v236, v237
    v_max_f32 v242, v240, v241
    buffer_load_dwordx4 v50, s[24:27], s64 offen offset:3072 lds
    v_mov_b32 v239, v238
    v_mov_b32 v243, v242
    v_cvt_pk_bf16_f32 v162, v216, v217
    v_permlane16_swap_b32 v238, v239
    v_permlane16_swap_b32 v242, v243
    v_max_f32 v238, v238, v239
    v_max_f32 v242, v242, v243
    v_mov_b32 v239, v238
    v_mov_b32 v243, v242
    v_cvt_pk_bf16_f32 v163, v218, v219
    v_permlane32_swap_b32 v238, v239
    v_permlane32_swap_b32 v242, v243
    v_max_f32 v238, v238, v239
    v_max_f32 v242, v242, v243
    v_mul_f32 v238, v244, v238
    buffer_load_dwordx4 a[0:3], v67, s[28:31], s65 offen offset:0 sc1
    v_mul_f32 v242, v245, v242
    v_fma_f32 v236, v236, v244, -v238
    v_fma_f32 v237, v237, v244, -v238
    v_fma_f32 v240, v240, v245, -v242
    v_fma_f32 v241, v241, v245, -v242
    v_exp_f32 v236, v236
    v_exp_f32 v237, v237
    v_exp_f32 v240, v240
    v_exp_f32 v241, v241
    v_add_f32 v238, v236, v237
    buffer_load_dwordx4 a[4:7], v67, s[28:31], s65 offen offset:1024 sc1
    v_add_f32 v242, v240, v241
    v_mov_b32 v239, v238
    v_mov_b32 v243, v242
    v_cvt_pk_bf16_f32 v164, v224, v225
    v_permlane16_swap_b32 v238, v239
    v_permlane16_swap_b32 v242, v243
    v_add_f32 v238, v238, v239
    v_add_f32 v242, v242, v243
    v_mov_b32 v239, v238
    v_mov_b32 v243, v242
    v_cvt_pk_bf16_f32 v165, v226, v227
    v_permlane32_swap_b32 v238, v239
    v_permlane32_swap_b32 v242, v243
    v_add_f32 v238, v238, v239
    buffer_load_dwordx4 a[8:11], v67, s[28:31], s65 offen offset:2048 sc1
    v_add_f32 v242, v242, v243
    v_rcp_f32 v238, v238
    v_rcp_f32 v242, v242
    v_cvt_pk_bf16_f32 v166, v232, v233
    v_cvt_pk_bf16_f32 v167, v234, v235
    v_mul_f32 v236, v236, v168
    v_mul_f32 v237, v237, v169
    v_mul_f32 v240, v240, v170
    v_mul_f32 v241, v241, v171
    v_mul_f32 v236, v236, v238
    v_mul_f32 v237, v237, v238
    v_mul_f32 v240, v240, v242
    buffer_load_dwordx4 a[12:15], v67, s[28:31], s65 offen offset:3072 sc1
    v_mul_f32 v241, v241, v242
    v_cvt_pk_bf16_f32 v236, v236, v236
    v_cvt_pk_bf16_f32 v237, v237, v237
    v_cvt_pk_bf16_f32 v240, v240, v240
    v_cvt_pk_bf16_f32 v241, v241, v241
    v_and_b32 v128, v236, v94
    v_and_b32 v129, v237, v95
    v_and_b32 v130, v236, v96
    v_and_b32 v131, v237, v97
    v_and_b32 v132, v240, v94
    v_and_b32 v133, v241, v95
    v_and_b32 v134, v240, v96
    v_and_b32 v135, v241, v97
    v_mfma_f32_16x16x32_bf16 v[172:175], v[156:159], v[128:131], 0
    s_add_u32 s65, s65, 8192
    s_cmp_eq_u32 s65, 57344
    s_cselect_b32 s65, 0, s65
    buffer_load_dwordx4 a[16:19], v67, s[28:31], s65 offen offset:0 sc1
    v_mfma_f32_16x16x32_bf16 v[176:179], v[162:165], v[128:131], 0
    v_mfma_f32_16x16x32_bf16 v[180:183], v[158:161], v[132:135], 0
    v_mfma_f32_16x16x32_bf16 v[184:187], v[164:167], v[132:135], 0
    buffer_load_dwordx4 a[20:23], v67, s[28:31], s65 offen offset:1024 sc1
    s_add_u32 s83, s82, 16384
    v_cvt_pk_bf16_f32 v100, v172, v173
    v_cvt_pk_bf16_f32 v101, v174, v175
    s_nop 1
    v_cvt_pk_bf16_f32 v102, v176, v177
    v_cvt_pk_bf16_f32 v103, v178, v179
    v_cvt_pk_bf16_f32 v104, v180, v181
    v_cvt_pk_bf16_f32 v105, v182, v183
    v_cvt_pk_bf16_f32 v106, v184, v185
    v_cvt_pk_bf16_f32 v107, v186, v187
    s_cmp_lg_u32 s56, 0
    s_cbranch_scc1 L_f
    buffer_store_dwordx4 v[100:103], v4, s[28:31], s82 offen sc1
    buffer_store_dwordx4 v[104:107], v4, s[28:31], s83 offen sc1
    s_waitcnt vmcnt(0)
    s_barrier
    s_cmp_lg_u32 s48, 0
    s_cbranch_scc1 L_sig2
    s_atomic_add s36, s[28:29], s69
L_sig2:
    v_lshlrev_b32 v15, 7, v1
    s_lshl_b32 s3, s54, 2
    s_add_u32 s3, s3, s48
    s_mul_i32 s3, s3, 25088
    buffer_load_dword v172, v15, s[16:19], s3 offen
    s_add_u32 s3, s3, 5632
    buffer_load_dword v173, v15, s[16:19], s3 offen
    s_add_u32 s3, s3, 5632
    buffer_load_dword v174, v15, s[16:19], s3 offen
    s_add_u32 s3, s3, 5632
    buffer_load_dword v175, v15, s[16:19], s3 offen
    s_add_u32 s3, s3, 5632
    s_branch L_fin
L_f:
    buffer_store_dwordx4 v[100:103], v4, s[28:31], s82 offen sc1
    buffer_store_dwordx4 v[104:107], v4, s[28:31], s83 offen sc1
    buffer_load_dwordx4 a[24:27], v67, s[28:31], s65 offen offset:2048 sc1
    buffer_load_dwordx4 a[28:31], v67, s[28:31], s65 offen offset:3072 sc1
    s_add_u32 s65, s65, 8192
    s_cmp_eq_u32 s65, 57344
    s_cselect_b32 s65, 0, s65
    buffer_load_dwordx4 a[32:35], v67, s[28:31], s65 offen offset:0 sc1
    buffer_load_dwordx4 a[36:39], v67, s[28:31], s65 offen offset:1024 sc1
    buffer_load_dwordx4 a[40:43], v67, s[28:31], s65 offen offset:2048 sc1
    buffer_load_dwordx4 a[44:47], v67, s[28:31], s65 offen offset:3072 sc1
    s_waitcnt vmcnt(14)
    s_barrier
    ds_read_b64_tr_b16 v[108:109], v26 offset:16384
    ds_read_b64_tr_b16 v[110:111], v26 offset:17408
    ds_read_b64_tr_b16 v[112:113], v27 offset:16384
    ds_read_b64_tr_b16 v[114:115], v27 offset:17408
    ds_read_b64_tr_b16 v[116:117], v26 offset:18432
    ds_read_b64_tr_b16 v[118:119], v26 offset:19456
    ds_read_b64_tr_b16 v[120:121], v27 offset:18432
    ds_read_b64_tr_b16 v[122:123], v27 offset:19456
    ds_read_b64_tr_b16 v[124:125], v26 offset:20480
    ds_read_b64_tr_b16 v[126:127], v26 offset:21504
    ds_read_b64_tr_b16 v[128:129], v27 offset:20480
    ds_read_b64_tr_b16 v[130:131], v27 offset:21504
    s_waitcnt vmcnt(13) lgkmcnt(8)
    v_mfma_f32_32x32x16_bf16 v[172:187], a[0:3], v[108:111], 0
    ds_read_b64_tr_b16 v[132:133], v26 offset:22528
    ds_read_b64_tr_b16 v[134:135], v26 offset:23552
    v_lshlrev_b32 v83, 16, v83
    v_mfma_f32_32x32x16_bf16 v[228:243], a[0:3], v[112:115], 0
    s_add_u32 s65, s65, 8192
    s_cmp_eq_u32 s65, 57344
    s_cselect_b32 s65, 0, s65
    buffer_load_dwordx4 a[48:51], v67, s[28:31], s65 offen offset:0 sc1
    ds_read_b64_tr_b16 v[136:137], v27 offset:22528
    ds_read_b64_tr_b16 v[138:139], v27 offset:23552
    v_lshlrev_b32 v212, 16, v86
    s_waitcnt vmcnt(13) lgkmcnt(8)
    v_mfma_f32_32x32x16_bf16 v[172:187], a[4:7], v[116:119], v[172:187]
    ds_read_b64_tr_b16 v[108:109], v28 offset:0
    ds_read_b64_tr_b16 v[110:111], v28 offset:1024
    v_and_b32 v213, 0xffff0000, v86
    buffer_load_dwordx4 a[52:55], v67, s[28:31], s65 offen offset:1024 sc1
    v_mfma_f32_32x32x16_bf16 v[228:243], a[4:7], v[120:123], v[228:243]
    ds_read_b64_tr_b16 v[112:113], v29 offset:0
    ds_read_b64_tr_b16 v[114:115], v29 offset:1024
    v_add_f32 v212, v212, v83
    s_waitcnt vmcnt(13) lgkmcnt(8)
    v_mfma_f32_32x32x16_bf16 v[172:187], a[8:11], v[124:127], v[172:187]
    buffer_load_dwordx4 a[56:59], v67, s[28:31], s65 offen offset:2048 sc1
    ds_read_b64_tr_b16 v[116:117], v28 offset:2048
    ds_read_b64_tr_b16 v[118:119], v28 offset:3072
    v_add_f32 v213, v213, v83
    v_mfma_f32_32x32x16_bf16 v[228:243], a[8:11], v[128:131], v[228:243]
    ds_read_b64_tr_b16 v[120:121], v29 offset:2048
    ds_read_b64_tr_b16 v[122:123], v29 offset:3072
    v_lshlrev_b32 v214, 16, v87
    s_waitcnt vmcnt(13) lgkmcnt(8)
    v_mfma_f32_32x32x16_bf16 v[172:187], a[12:15], v[132:135], v[172:187]
    buffer_load_dwordx4 a[60:63], v67, s[28:31], s65 offen offset:3072 sc1
    ds_read_b64_tr_b16 v[124:125], v28 offset:4096
    ds_read_b64_tr_b16 v[126:127], v28 offset:5120
    v_and_b32 v215, 0xffff0000, v87
    v_mfma_f32_32x32x16_bf16 v[228:243], a[12:15], v[136:139], v[228:243]
    s_add_u32 s65, s65, 8192
    s_cmp_eq_u32 s65, 57344
    s_cselect_b32 s65, 0, s65
    buffer_load_dwordx4 a[64:67], v67, s[28:31], s65 offen offset:0 sc1
    ds_read_b64_tr_b16 v[128:129], v29 offset:4096
    ds_read_b64_tr_b16 v[130:131], v29 offset:5120
    v_add_f32 v214, v214, v83
    s_waitcnt vmcnt(14) lgkmcnt(8)
    v_mfma_f32_32x32x16_bf16 v[172:187], a[16:19], v[108:111], v[172:187]
    ds_read_b64_tr_b16 v[132:133], v28 offset:6144
    ds_read_b64_tr_b16 v[134:135], v28 offset:7168
    v_add_f32 v215, v215, v83
    v_mfma_f32_32x32x16_bf16 v[228:243], a[16:19], v[112:115], v[228:243]
    buffer_load_dwordx4 a[68:71], v67, s[28:31], s65 offen offset:1024 sc1
    ds_read_b64_tr_b16 v[136:137], v29 offset:6144
    ds_read_b64_tr_b16 v[138:139], v29 offset:7168
    v_lshlrev_b32 v216, 16, v88
    s_waitcnt vmcnt(14) lgkmcnt(8)
    v_mfma_f32_32x32x16_bf16 v[172:187], a[20:23], v[116:119], v[172:187]
    buffer_load_dwordx4 a[72:75], v67, s[28:31], s65 offen offset:2048 sc1
    ds_read_b64_tr_b16 v[108:109], v28 offset:16384
    ds_read_b64_tr_b16 v[110:111], v28 offset:17408
    v_and_b32 v217, 0xffff0000, v88
    v_mfma_f32_32x32x16_bf16 v[228:243], a[20:23], v[120:123], v[228:243]
    ds_read_b64_tr_b16 v[112:113], v29 offset:16384
    ds_read_b64_tr_b16 v[114:115], v29 offset:17408
    v_add_f32 v216, v216, v83
    s_waitcnt vmcnt(12) lgkmcnt(8)
    v_mfma_f32_32x32x16_bf16 v[172:187], a[24:27], v[124:127], v[172:187]
    buffer_load_dwordx4 a[76:79], v67, s[28:31], s65 offen offset:3072 sc1
    ds_read_b64_tr_b16 v[116:117], v28 offset:18432
    ds_read_b64_tr_b16 v[118:119], v28 offset:19456
    v_add_f32 v217, v217, v83
    v_mfma_f32_32x32x16_bf16 v[228:243], a[24:27], v[128:131], v[228:243]
    s_add_u32 s65, s65, 8192
    s_cmp_eq_u32 s65, 57344
    s_cselect_b32 s65, 0, s65
    buffer_load_dwordx4 a[80:83], v67, s[28:31], s65 offen offset:0 sc1
    ds_read_b64_tr_b16 v[120:121], v29 offset:18432
    ds_read_b64_tr_b16 v[122:123], v29 offset:19456
    v_lshlrev_b32 v218, 16, v89
    s_waitcnt vmcnt(13) lgkmcnt(8)
    v_mfma_f32_32x32x16_bf16 v[172:187], a[28:31], v[132:135], v[172:187]
    ds_read_b64_tr_b16 v[124:125], v28 offset:20480
    ds_read_b64_tr_b16 v[126:127], v28 offset:21504
    v_and_b32 v219, 0xffff0000, v89
    v_mfma_f32_32x32x16_bf16 v[228:243], a[28:31], v[136:139], v[228:243]
    buffer_load_dwordx4 a[84:87], v67, s[28:31], s65 offen offset:1024 sc1
    ds_read_b64_tr_b16 v[128:129], v29 offset:20480
    ds_read_b64_tr_b16 v[130:131], v29 offset:21504
    v_add_f32 v218, v218, v83
    s_waitcnt vmcnt(13) lgkmcnt(8)
    v_mfma_f32_32x32x16_bf16 v[172:187], a[32:35], v[108:111], v[172:187]
    ds_read_b64_tr_b16 v[132:133], v28 offset:22528
    ds_read_b64_tr_b16 v[134:135], v28 offset:23552
    v_add_f32 v219, v219, v83
    buffer_load_dwordx4 a[88:91], v67, s[28:31], s65 offen offset:2048 sc1
    v_mfma_f32_32x32x16_bf16 v[228:243], a[32:35], v[112:115], v[228:243]
    ds_read_b64_tr_b16 v[136:137], v29 offset:22528
    ds_read_b64_tr_b16 v[138:139], v29 offset:23552
    v_lshlrev_b32 v84, 16, v84
    s_waitcnt vmcnt(13) lgkmcnt(8)
    v_mfma_f32_32x32x16_bf16 v[172:187], a[36:39], v[116:119], v[172:187]
    buffer_load_dwordx4 a[92:95], v67, s[28:31], s65 offen offset:3072 sc1
    s_barrier
    s_cmp_lg_u32 s48, 0
    s_cbranch_scc1 L_sig3
    s_atomic_add s36, s[28:29], s69
L_sig3:
    ds_read_b64_tr_b16 v[108:109], v26 offset:32768
    ds_read_b64_tr_b16 v[110:111], v26 offset:33792
    v_lshlrev_b32 v220, 16, v90
    v_mfma_f32_32x32x16_bf16 v[228:243], a[36:39], v[120:123], v[228:243]
    s_add_u32 s65, s65, 8192
    s_cmp_eq_u32 s65, 57344
    s_cselect_b32 s65, 0, s65
    buffer_load_dwordx4 a[96:99], v67, s[28:31], s65 offen offset:0 sc1
    ds_read_b64_tr_b16 v[112:113], v27 offset:32768
    ds_read_b64_tr_b16 v[114:115], v27 offset:33792
    v_and_b32 v221, 0xffff0000, v90
    s_waitcnt vmcnt(14) lgkmcnt(8)
    v_mfma_f32_32x32x16_bf16 v[172:187], a[40:43], v[124:127], v[172:187]
    ds_read_b64_tr_b16 v[116:117], v26 offset:34816
    ds_read_b64_tr_b16 v[118:119], v26 offset:35840
    v_add_f32 v220, v220, v84
    v_mfma_f32_32x32x16_bf16 v[228:243], a[40:43], v[128:131], v[228:243]
    buffer_load_dwordx4 a[100:103], v67, s[28:31], s65 offen offset:1024 sc1
    ds_read_b64_tr_b16 v[120:121], v27 offset:34816
    ds_read_b64_tr_b16 v[122:123], v27 offset:35840
    v_add_f32 v221, v221, v84
    s_waitcnt vmcnt(14) lgkmcnt(8)
    v_mfma_f32_32x32x16_bf16 v[172:187], a[44:47], v[132:135], v[172:187]
    buffer_load_dwordx4 a[104:107], v67, s[28:31], s65 offen offset:2048 sc1
    ds_read_b64_tr_b16 v[124:125], v26 offset:36864
    ds_read_b64_tr_b16 v[126:127], v26 offset:37888
    v_lshlrev_b32 v222, 16, v91
    v_mfma_f32_32x32x16_bf16 v[228:243], a[44:47], v[136:139], v[228:243]
    ds_read_b64_tr_b16 v[128:129], v27 offset:36864
    ds_read_b64_tr_b16 v[130:131], v27 offset:37888
    v_and_b32 v223, 0xffff0000, v91
    s_waitcnt vmcnt(14) lgkmcnt(8)
    v_mfma_f32_32x32x16_bf16 v[172:187], a[48:51], v[108:111], v[172:187]
    buffer_load_dwordx4 a[108:111], v67, s[28:31], s65 offen offset:3072 sc1
    ds_read_b64_tr_b16 v[132:133], v26 offset:38912
    ds_read_b64_tr_b16 v[134:135], v26 offset:39936
    v_add_f32 v222, v222, v84
    v_mfma_f32_32x32x16_bf16 v[228:243], a[48:51], v[112:115], v[228:243]
    s_add_u32 m0, s58, 16384
    s_add_u32 s64, s64, 524288
    s_cmp_eq_u32 s64, 3670016
    s_cselect_b32 s64, 0, s64
    buffer_load_dwordx4 v47, s[24:27], s64 offen lds
    ds_read_b64_tr_b16 v[136:137], v27 offset:38912
    ds_read_b64_tr_b16 v[138:139], v27 offset:39936
    v_add_f32 v223, v223, v84
    s_waitcnt vmcnt(15) lgkmcnt(8)
    v_mfma_f32_32x32x16_bf16 v[172:187], a[52:55], v[116:119], v[172:187]
    ds_read_b64_tr_b16 v[108:109], v26 offset:49152
    ds_read_b64_tr_b16 v[110:111], v26 offset:50176
    v_lshlrev_b32 v224, 16, v92
    v_mfma_f32_32x32x16_bf16 v[228:243], a[52:55], v[120:123], v[228:243]
    buffer_load_dwordx4 v48, s[24:27], s64 offen offset:1024 lds
    ds_read_b64_tr_b16 v[112:113], v27 offset:49152
    ds_read_b64_tr_b16 v[114:115], v27 offset:50176
    v_and_b32 v225, 0xffff0000, v92
    s_waitcnt vmcnt(15) lgkmcnt(8)
    v_mfma_f32_32x32x16_bf16 v[172:187], a[56:59], v[124:127], v[172:187]
    ds_read_b64_tr_b16 v[116:117], v26 offset:51200
    ds_read_b64_tr_b16 v[118:119], v26 offset:52224
    v_add_f32 v224, v224, v84
    buffer_load_dwordx4 v49, s[24:27], s64 offen offset:2048 lds
    v_mfma_f32_32x32x16_bf16 v[228:243], a[56:59], v[128:131], v[228:243]
    ds_read_b64_tr_b16 v[120:121], v27 offset:51200
    ds_read_b64_tr_b16 v[122:123], v27 offset:52224
    v_add_f32 v225, v225, v84
    s_waitcnt vmcnt(15) lgkmcnt(8)
    v_mfma_f32_32x32x16_bf16 v[172:187], a[60:63], v[132:135], v[172:187]
    buffer_load_dwordx4 v50, s[24:27], s64 offen offset:3072 lds
    ds_read_b64_tr_b16 v[124:125], v26 offset:53248
    ds_read_b64_tr_b16 v[126:127], v26 offset:54272
    v_lshlrev_b32 v226, 16, v93
    v_mfma_f32_32x32x16_bf16 v[228:243], a[60:63], v[136:139], v[228:243]
    ds_read_b64_tr_b16 v[128:129], v27 offset:53248
    ds_read_b64_tr_b16 v[130:131], v27 offset:54272
    v_and_b32 v227, 0xffff0000, v93
    s_waitcnt vmcnt(15) lgkmcnt(8)
    v_mfma_f32_32x32x16_bf16 v[172:187], a[64:67], v[108:111], v[172:187]
    s_add_u32 m0, s58, 65536
    s_add_u32 s64, s64, 524288
    s_cmp_eq_u32 s64, 3670016
    s_cselect_b32 s64, 0, s64
    buffer_load_dwordx4 v47, s[24:27], s64 offen lds
    ds_read_b64_tr_b16 v[132:133], v26 offset:55296
    ds_read_b64_tr_b16 v[134:135], v26 offset:56320
    v_add_f32 v226, v226, v84
    v_mfma_f32_32x32x16_bf16 v[228:243], a[64:67], v[112:115], v[228:243]
    buffer_load_dwordx4 v48, s[24:27], s64 offen offset:1024 lds
    ds_read_b64_tr_b16 v[136:137], v27 offset:55296
    ds_read_b64_tr_b16 v[138:139], v27 offset:56320
    v_add_f32 v227, v227, v84
    s_waitcnt vmcnt(16) lgkmcnt(8)
    v_mfma_f32_32x32x16_bf16 v[172:187], a[68:71], v[116:119], v[172:187]
    s_barrier
    ds_read_b64_tr_b16 v[108:109], v28 offset:32768
    ds_read_b64_tr_b16 v[110:111], v28 offset:33792
    v_mfma_f32_32x32x16_bf16 v[228:243], a[68:71], v[120:123], v[228:243]
    buffer_load_dwordx4 v49, s[24:27], s64 offen offset:2048 lds
    ds_read_b64_tr_b16 v[112:113], v29 offset:32768
    ds_read_b64_tr_b16 v[114:115], v29 offset:33792
    s_waitcnt vmcnt(16) lgkmcnt(8)
    v_mfma_f32_32x32x16_bf16 v[172:187], a[72:75], v[124:127], v[172:187]
    buffer_load_dwordx4 v50, s[24:27], s64 offen offset:3072 lds
    ds_read_b64_tr_b16 v[116:117], v28 offset:34816
    ds_read_b64_tr_b16 v[118:119], v28 offset:35840
    v_mfma_f32_32x32x16_bf16 v[228:243], a[72:75], v[128:131], v[228:243]
    ds_read_b64_tr_b16 v[120:121], v29 offset:34816
    ds_read_b64_tr_b16 v[122:123], v29 offset:35840
    s_waitcnt vmcnt(16) lgkmcnt(8)
    v_mfma_f32_32x32x16_bf16 v[172:187], a[76:79], v[132:135], v[172:187]
    s_add_u32 m0, s58, 81920
    s_add_u32 s64, s64, 524288
    s_cmp_eq_u32 s64, 3670016
    s_cselect_b32 s64, 0, s64
    buffer_load_dwordx4 v47, s[24:27], s64 offen lds
    ds_read_b64_tr_b16 v[124:125], v28 offset:36864
    ds_read_b64_tr_b16 v[126:127], v28 offset:37888
    v_mfma_f32_32x32x16_bf16 v[228:243], a[76:79], v[136:139], v[228:243]
    ds_read_b64_tr_b16 v[128:129], v29 offset:36864
    ds_read_b64_tr_b16 v[130:131], v29 offset:37888
    s_waitcnt vmcnt(16) lgkmcnt(8)
    v_mfma_f32_32x32x16_bf16 v[172:187], a[80:83], v[108:111], v[172:187]
    buffer_load_dwordx4 v48, s[24:27], s64 offen offset:1024 lds
    ds_read_b64_tr_b16 v[132:133], v28 offset:38912
    ds_read_b64_tr_b16 v[134:135], v28 offset:39936
    v_mfma_f32_32x32x16_bf16 v[228:243], a[80:83], v[112:115], v[228:243]
    ds_read_b64_tr_b16 v[136:137], v29 offset:38912
    ds_read_b64_tr_b16 v[138:139], v29 offset:39936
    s_waitcnt vmcnt(16) lgkmcnt(8)
    v_mfma_f32_32x32x16_bf16 v[172:187], a[84:87], v[116:119], v[172:187]
    buffer_load_dwordx4 v49, s[24:27], s64 offen offset:2048 lds
    ds_read_b64_tr_b16 v[108:109], v28 offset:49152
    ds_read_b64_tr_b16 v[110:111], v28 offset:50176
    v_mfma_f32_32x32x16_bf16 v[228:243], a[84:87], v[120:123], v[228:243]
    buffer_load_dwordx4 v50, s[24:27], s64 offen offset:3072 lds
    ds_read_b64_tr_b16 v[112:113], v29 offset:49152
    ds_read_b64_tr_b16 v[114:115], v29 offset:50176
    s_waitcnt vmcnt(17) lgkmcnt(8)
    v_mfma_f32_32x32x16_bf16 v[172:187], a[88:91], v[124:127], v[172:187]
    ds_read_b64_tr_b16 v[116:117], v28 offset:51200
    ds_read_b64_tr_b16 v[118:119], v28 offset:52224
    v_mfma_f32_32x32x16_bf16 v[228:243], a[88:91], v[128:131], v[228:243]
    s_add_u32 m0, s58, 32768
    s_add_u32 s64, s64, 524288
    s_cmp_eq_u32 s64, 3670016
    s_cselect_b32 s64, 0, s64
    buffer_load_dwordx4 v47, s[24:27], s64 offen lds
    ds_read_b64_tr_b16 v[120:121], v29 offset:51200
    ds_read_b64_tr_b16 v[122:123], v29 offset:52224
    s_waitcnt vmcnt(17) lgkmcnt(8)
    v_mfma_f32_32x32x16_bf16 v[172:187], a[92:95], v[132:135], v[172:187]
    ds_read_b64_tr_b16 v[124:125], v28 offset:53248
    ds_read_b64_tr_b16 v[126:127], v28 offset:54272
    v_mfma_f32_32x32x16_bf16 v[228:243], a[92:95], v[136:139], v[228:243]
    buffer_load_dwordx4 v48, s[24:27], s64 offen offset:1024 lds
    ds_read_b64_tr_b16 v[128:129], v29 offset:53248
    ds_read_b64_tr_b16 v[130:131], v29 offset:54272
    s_waitcnt vmcnt(17) lgkmcnt(8)
    v_mfma_f32_32x32x16_bf16 v[172:187], a[96:99], v[108:111], v[172:187]
    ds_read_b64_tr_b16 v[132:133], v28 offset:55296
    ds_read_b64_tr_b16 v[134:135], v28 offset:56320
    v_mfma_f32_32x32x16_bf16 v[228:243], a[96:99], v[112:115], v[228:243]
    buffer_load_dwordx4 v49, s[24:27], s64 offen offset:2048 lds
    ds_read_b64_tr_b16 v[136:137], v29 offset:55296
    ds_read_b64_tr_b16 v[138:139], v29 offset:56320
    s_waitcnt vmcnt(17) lgkmcnt(8)
    v_mfma_f32_32x32x16_bf16 v[172:187], a[100:103], v[116:119], v[172:187]
    buffer_load_dwordx4 v50, s[24:27], s64 offen offset:3072 lds
    s_barrier
    ds_read_b64_tr_b16 v[108:109], v26 offset:0
    ds_read_b64_tr_b16 v[110:111], v26 offset:1024
    v_mfma_f32_32x32x16_bf16 v[228:243], a[100:103], v[120:123], v[228:243]
    ds_read_b64_tr_b16 v[112:113], v27 offset:0
    ds_read_b64_tr_b16 v[114:115], v27 offset:1024
    s_waitcnt vmcnt(17) lgkmcnt(8)
    v_mfma_f32_32x32x16_bf16 v[172:187], a[104:107], v[124:127], v[172:187]
    s_add_u32 m0, s58, 49152
    s_add_u32 s66, s66, 1
    s_and_b32 s66, s66, 3
    s_mul_i32 s61, s66, 100352
    buffer_load_dwordx4 v51, s[16:19], s61 offen lds
    ds_read_b64_tr_b16 v[116:117], v26 offset:2048
    ds_read_b64_tr_b16 v[118:119], v26 offset:3072
    v_mfma_f32_32x32x16_bf16 v[228:243], a[104:107], v[128:131], v[228:243]
    ds_read_b64_tr_b16 v[120:121], v27 offset:2048
    ds_read_b64_tr_b16 v[122:123], v27 offset:3072
    s_waitcnt vmcnt(17) lgkmcnt(8)
    v_mfma_f32_32x32x16_bf16 v[172:187], a[108:111], v[132:135], v[172:187]
    buffer_load_dwordx4 v52, s[16:19], s61 offen offset:1024 lds
    ds_read_b64_tr_b16 v[124:125], v26 offset:4096
    ds_read_b64_tr_b16 v[126:127], v26 offset:5120
    v_mfma_f32_32x32x16_bf16 v[228:243], a[108:111], v[136:139], v[228:243]
    ds_read_b64_tr_b16 v[128:129], v27 offset:4096
    ds_read_b64_tr_b16 v[130:131], v27 offset:5120
    s_waitcnt lgkmcnt(8)
    v_mfma_f32_32x32x16_bf16 v[140:155], a[0:3], v[108:111], 0
    s_add_u32 s61, s61, 48128
    buffer_load_dwordx4 v51, s[16:19], s61 offen offset:2048 lds
    ds_read_b64_tr_b16 v[132:133], v26 offset:6144
    ds_read_b64_tr_b16 v[134:135], v26 offset:7168
    v_mfma_f32_32x32x16_bf16 v[156:171], a[0:3], v[112:115], 0
    buffer_load_dwordx4 v52, s[16:19], s61 offen offset:3072 lds
    ds_read_b64_tr_b16 v[136:137], v27 offset:6144
    ds_read_b64_tr_b16 v[138:139], v27 offset:7168
    v_cvt_pk_bf16_f32 v172, v172, v173
    v_cvt_pk_bf16_f32 v173, v174, v175
    v_cvt_pk_bf16_f32 v174, v176, v177
    v_cvt_pk_bf16_f32 v175, v178, v179
    buffer_store_dwordx4 v[172:175], v22, s[28:31], 0 offen offset:0 sc1
    s_waitcnt lgkmcnt(8)
    v_mfma_f32_32x32x16_bf16 v[140:155], a[4:7], v[116:119], v[140:155]
    s_add_u32 m0, s58, 98304
    s_add_u32 s66, s66, 1
    s_and_b32 s66, s66, 3
    s_mul_i32 s61, s66, 100352
    buffer_load_dwordx4 v51, s[16:19], s61 offen lds
    s_load_dword s46, s[28:29], s39 glc
    ds_read_b64_tr_b16 v[108:109], v30 offset:0
    ds_read_b64_tr_b16 v[110:111], v30 offset:1024
    v_cvt_pk_bf16_f32 v180, v180, v181
    v_cvt_pk_bf16_f32 v181, v182, v183
    v_cvt_pk_bf16_f32 v182, v184, v185
    v_cvt_pk_bf16_f32 v183, v186, v187
    buffer_store_dwordx4 v[180:183], v22, s[28:31], 0 offen offset:1024 sc1
    v_mfma_f32_32x32x16_bf16 v[156:171], a[4:7], v[120:123], v[156:171]
    buffer_load_dwordx4 v52, s[16:19], s61 offen offset:1024 lds
    ds_read_b64_tr_b16 v[112:113], v31 offset:0
    ds_read_b64_tr_b16 v[114:115], v31 offset:1024
    v_cvt_pk_bf16_f32 v228, v228, v229
    v_cvt_pk_bf16_f32 v229, v230, v231
    v_cvt_pk_bf16_f32 v230, v232, v233
    v_cvt_pk_bf16_f32 v231, v234, v235
    buffer_store_dwordx4 v[228:231], v22, s[28:31], 0 offen offset:2048 sc1
    s_waitcnt lgkmcnt(8)
    v_mfma_f32_32x32x16_bf16 v[140:155], a[8:11], v[124:127], v[140:155]
    s_add_u32 s61, s61, 48128
    buffer_load_dwordx4 v51, s[16:19], s61 offen offset:2048 lds
    ds_read_b64_tr_b16 v[116:117], v30 offset:2048
    ds_read_b64_tr_b16 v[118:119], v30 offset:3072
    v_cvt_pk_bf16_f32 v236, v236, v237
    v_cvt_pk_bf16_f32 v237, v238, v239
    v_cvt_pk_bf16_f32 v238, v240, v241
    v_cvt_pk_bf16_f32 v239, v242, v243
    buffer_store_dwordx4 v[236:239], v22, s[28:31], 0 offen offset:3072 sc1
    v_mfma_f32_32x32x16_bf16 v[156:171], a[8:11], v[128:131], v[156:171]
    buffer_load_dwordx4 v52, s[16:19], s61 offen offset:3072 lds
    ds_read_b64_tr_b16 v[120:121], v31 offset:2048
    ds_read_b64_tr_b16 v[122:123], v31 offset:3072
    s_waitcnt lgkmcnt(8)
    v_mfma_f32_32x32x16_bf16 v[140:155], a[12:15], v[132:135], v[140:155]
    ds_read_b64_tr_b16 v[124:125], v30 offset:4096
    ds_read_b64_tr_b16 v[126:127], v30 offset:5120
    v_mfma_f32_32x32x16_bf16 v[156:171], a[12:15], v[136:139], v[156:171]
    ds_read_b64_tr_b16 v[128:129], v31 offset:4096
    ds_read_b64_tr_b16 v[130:131], v31 offset:5120
    s_waitcnt lgkmcnt(8)
    v_mfma_f32_32x32x16_bf16 v[140:155], a[16:19], v[108:111], v[140:155]
    ds_read_b64_tr_b16 v[132:133], v30 offset:6144
    ds_read_b64_tr_b16 v[134:135], v30 offset:7168
    v_mfma_f32_32x32x16_bf16 v[156:171], a[16:19], v[112:115], v[156:171]
    ds_read_b64_tr_b16 v[136:137], v31 offset:6144
    ds_read_b64_tr_b16 v[138:139], v31 offset:7168
    s_waitcnt lgkmcnt(8)
    v_mfma_f32_32x32x16_bf16 v[140:155], a[20:23], v[116:119], v[140:155]
    s_waitcnt vmcnt(12)
    s_barrier
    ds_read_b64_tr_b16 v[108:109], v30 offset:16384
    s_add_u32 m0, s58, 114688
    s_add_u32 s66, s66, 1
    s_and_b32 s66, s66, 3
    s_mul_i32 s61, s66, 100352
    buffer_load_dwordx4 v51, s[16:19], s61 offen lds
    ds_read_b64_tr_b16 v[110:111], v30 offset:17408
    v_mfma_f32_32x32x16_bf16 v[156:171], a[20:23], v[120:123], v[156:171]
    buffer_load_dwordx4 v52, s[16:19], s61 offen offset:1024 lds
    ds_read_b64_tr_b16 v[112:113], v31 offset:16384
    ds_read_b64_tr_b16 v[114:115], v31 offset:17408
    s_waitcnt lgkmcnt(8)
    v_mfma_f32_32x32x16_bf16 v[140:155], a[24:27], v[124:127], v[140:155]
    ds_read_b64_tr_b16 v[116:117], v30 offset:18432
    ds_read_b64_tr_b16 v[118:119], v30 offset:19456
    v_mfma_f32_32x32x16_bf16 v[156:171], a[24:27], v[128:131], v[156:171]
    s_add_u32 s61, s61, 48128
    buffer_load_dwordx4 v51, s[16:19], s61 offen offset:2048 lds
    ds_read_b64_tr_b16 v[120:121], v31 offset:18432
    ds_read_b64_tr_b16 v[122:123], v31 offset:19456
    s_waitcnt lgkmcnt(8)
    v_mfma_f32_32x32x16_bf16 v[140:155], a[28:31], v[132:135], v[140:155]
    ds_read_b64_tr_b16 v[124:125], v30 offset:20480
    ds_read_b64_tr_b16 v[126:127], v30 offset:21504
    v_mfma_f32_32x32x16_bf16 v[156:171], a[28:31], v[136:139], v[156:171]
    buffer_load_dwordx4 v52, s[16:19], s61 offen offset:3072 lds
    ds_read_b64_tr_b16 v[128:129], v31 offset:20480
    ds_read_b64_tr_b16 v[130:131], v31 offset:21504
    s_waitcnt lgkmcnt(8)
    v_mfma_f32_32x32x16_bf16 v[140:155], a[32:35], v[108:111], v[140:155]
    ds_read_b64_tr_b16 v[132:133], v30 offset:22528
    ds_read_b64_tr_b16 v[134:135], v30 offset:23552
    v_mfma_f32_32x32x16_bf16 v[156:171], a[32:35], v[112:115], v[156:171]
    s_add_u32 m0, s58, 0
    s_add_u32 s66, s66, 1
    s_and_b32 s66, s66, 3
    s_mul_i32 s61, s66, 100352
    buffer_load_dwordx4 v51, s[16:19], s61 offen lds
    ds_read_b64_tr_b16 v[136:137], v31 offset:22528
    ds_read_b64_tr_b16 v[138:139], v31 offset:23552
    s_waitcnt lgkmcnt(8)
    v_mfma_f32_32x32x16_bf16 v[140:155], a[36:39], v[116:119], v[140:155]
    buffer_load_dwordx4 v52, s[16:19], s61 offen offset:1024 lds
    ds_read_b64_tr_b16 v[108:109], v26 offset:16384
    ds_read_b64_tr_b16 v[110:111], v26 offset:17408
    v_mfma_f32_32x32x16_bf16 v[156:171], a[36:39], v[120:123], v[156:171]
    ds_read_b64_tr_b16 v[112:113], v27 offset:16384
    ds_read_b64_tr_b16 v[114:115], v27 offset:17408
    s_waitcnt lgkmcnt(8)
    v_mfma_f32_32x32x16_bf16 v[140:155], a[40:43], v[124:127], v[140:155]
    s_add_u32 s61, s61, 48128
    buffer_load_dwordx4 v51, s[16:19], s61 offen offset:2048 lds
    ds_read_b64_tr_b16 v[116:117], v26 offset:18432
    ds_read_b64_tr_b16 v[118:119], v26 offset:19456
    v_mfma_f32_32x32x16_bf16 v[156:171], a[40:43], v[128:131], v[156:171]
    ds_read_b64_tr_b16 v[120:121], v27 offset:18432
    ds_read_b64_tr_b16 v[122:123], v27 offset:19456
    s_waitcnt lgkmcnt(8)
    v_mfma_f32_32x32x16_bf16 v[140:155], a[44:47], v[132:135], v[140:155]
    buffer_load_dwordx4 v52, s[16:19], s61 offen offset:3072 lds
    ds_read_b64_tr_b16 v[124:125], v26 offset:20480
    ds_read_b64_tr_b16 v[126:127], v26 offset:21504
    v_mfma_f32_32x32x16_bf16 v[156:171], a[44:47], v[136:139], v[156:171]
    ds_read_b64_tr_b16 v[128:129], v27 offset:20480
    ds_read_b64_tr_b16 v[130:131], v27 offset:21504
    s_waitcnt lgkmcnt(8)
    v_mfma_f32_32x32x16_bf16 v[140:155], a[48:51], v[108:111], v[140:155]
    ds_read_b64_tr_b16 v[132:133], v26 offset:22528
    ds_read_b64_tr_b16 v[134:135], v26 offset:23552
    v_mfma_f32_32x32x16_bf16 v[156:171], a[48:51], v[112:115], v[156:171]
    ds_read_b64_tr_b16 v[136:137], v27 offset:22528
    ds_read_b64_tr_b16 v[138:139], v27 offset:23552
    s_waitcnt lgkmcnt(8)
    v_mfma_f32_32x32x16_bf16 v[140:155], a[52:55], v[116:119], v[140:155]
    s_barrier
    s_waitcnt lgkmcnt(0)
    s_cmp_eq_u32 s46, 8
    s_cbranch_scc1 L_pollok6
    s_mov_b32 s60, 0
L_poll6:
    s_sleep 8
    s_load_dword s46, s[28:29], s39 glc
    s_add_u32 s60, s60, 1
    s_waitcnt lgkmcnt(0)
    s_cmp_eq_u32 s46, 8
    s_cbranch_scc1 L_pollok6
    s_cmp_lt_u32 s60, 20000
    s_cbranch_scc1 L_poll6
L_pollok6:
    s_waitcnt vmcnt(9)
    s_atomic_add s36, s[28:29], s55
    ds_read_b64_tr_b16 v[108:109], v28 offset:0
    s_add_u32 m0, s58, 131072
    s_add_u32 s66, s66, 1
    s_and_b32 s66, s66, 3
    s_lshl_b32 s61, s66, 12
    buffer_load_dwordx4 v53, s[28:31], s61 offen sc1 lds
    ds_read_b64_tr_b16 v[110:111], v28 offset:1024
    v_mfma_f32_32x32x16_bf16 v[156:171], a[52:55], v[120:123], v[156:171]
    buffer_load_dwordx4 v54, s[28:31], s61 offen offset:1024 sc1 lds
    ds_read_b64_tr_b16 v[112:113], v29 offset:0
    ds_read_b64_tr_b16 v[114:115], v29 offset:1024
    v_mfma_f32_32x32x16_bf16 v[140:155], a[56:59], v[124:127], v[140:155]
    ds_read_b64_tr_b16 v[116:117], v28 offset:2048
    ds_read_b64_tr_b16 v[118:119], v28 offset:3072
    v_mfma_f32_32x32x16_bf16 v[156:171], a[56:59], v[128:131], v[156:171]
    buffer_load_dwordx4 v53, s[28:31], s61 offen offset:2048 sc1 lds
    ds_read_b64_tr_b16 v[120:121], v29 offset:2048
    ds_read_b64_tr_b16 v[122:123], v29 offset:3072
    v_mfma_f32_32x32x16_bf16 v[140:155], a[60:63], v[132:135], v[140:155]
    buffer_load_dwordx4 v54, s[28:31], s61 offen offset:3072 sc1 lds
    ds_read_b64_tr_b16 v[124:125], v28 offset:4096
    ds_read_b64_tr_b16 v[126:127], v28 offset:5120
    v_mfma_f32_32x32x16_bf16 v[156:171], a[60:63], v[136:139], v[156:171]
    ds_read_b64_tr_b16 v[128:129], v29 offset:4096
    ds_read_b64_tr_b16 v[130:131], v29 offset:5120
    s_waitcnt lgkmcnt(8)
    v_mfma_f32_32x32x16_bf16 v[140:155], a[64:67], v[108:111], v[140:155]
    s_add_u32 m0, s58, 147456
    s_add_u32 s66, s66, 1
    s_and_b32 s66, s66, 3
    s_lshl_b32 s61, s66, 12
    buffer_load_dwordx4 v53, s[28:31], s61 offen sc1 lds
    ds_read_b64_tr_b16 v[132:133], v28 offset:6144
    ds_read_b64_tr_b16 v[134:135], v28 offset:7168
    v_mfma_f32_32x32x16_bf16 v[156:171], a[64:67], v[112:115], v[156:171]
    buffer_load_dwordx4 v54, s[28:31], s61 offen offset:1024 sc1 lds
    ds_read_b64_tr_b16 v[136:137], v29 offset:6144
    ds_read_b64_tr_b16 v[138:139], v29 offset:7168
    s_waitcnt lgkmcnt(8)
    v_mfma_f32_32x32x16_bf16 v[140:155], a[68:71], v[116:119], v[140:155]
    ds_read_b64_tr_b16 v[108:109], v28 offset:16384
    ds_read_b64_tr_b16 v[110:111], v28 offset:17408
    v_mfma_f32_32x32x16_bf16 v[156:171], a[68:71], v[120:123], v[156:171]
    buffer_load_dwordx4 v53, s[28:31], s61 offen offset:2048 sc1 lds
    ds_read_b64_tr_b16 v[112:113], v29 offset:16384
    ds_read_b64_tr_b16 v[114:115], v29 offset:17408
    s_waitcnt lgkmcnt(8)
    v_mfma_f32_32x32x16_bf16 v[140:155], a[72:75], v[124:127], v[140:155]
    buffer_load_dwordx4 v54, s[28:31], s61 offen offset:3072 sc1 lds
    ds_read_b64_tr_b16 v[116:117], v28 offset:18432
    ds_read_b64_tr_b16 v[118:119], v28 offset:19456
    v_mfma_f32_32x32x16_bf16 v[156:171], a[72:75], v[128:131], v[156:171]
    ds_read_b64_tr_b16 v[120:121], v29 offset:18432
    ds_read_b64_tr_b16 v[122:123], v29 offset:19456
    s_waitcnt lgkmcnt(8)
    v_mfma_f32_32x32x16_bf16 v[140:155], a[76:79], v[132:135], v[140:155]
    ds_read_b64_tr_b16 v[124:125], v28 offset:20480
    ds_read_b64_tr_b16 v[126:127], v28 offset:21504
    v_mfma_f32_32x32x16_bf16 v[156:171], a[76:79], v[136:139], v[156:171]
    ds_read_b64_tr_b16 v[128:129], v29 offset:20480
    ds_read_b64_tr_b16 v[130:131], v29 offset:21504
    s_waitcnt lgkmcnt(8)
    v_mfma_f32_32x32x16_bf16 v[140:155], a[80:83], v[108:111], v[140:155]
    ds_read_b64_tr_b16 v[132:133], v28 offset:22528
    ds_read_b64_tr_b16 v[134:135], v28 offset:23552
    v_mfma_f32_32x32x16_bf16 v[156:171], a[80:83], v[112:115], v[156:171]
    ds_read_b64_tr_b16 v[136:137], v29 offset:22528
    ds_read_b64_tr_b16 v[138:139], v29 offset:23552
    s_waitcnt lgkmcnt(8)
    v_mfma_f32_32x32x16_bf16 v[140:155], a[84:87], v[116:119], v[140:155]
    s_barrier
    ds_read_b64_tr_b16 v[108:109], v26 offset:32768
    s_add_u32 m0, s58, 16384
    s_add_u32 s66, s66, 1
    s_and_b32 s66, s66, 3
    s_lshl_b32 s61, s66, 12
    buffer_load_dwordx4 v53, s[28:31], s61 offen sc1 lds
    ds_read_b64_tr_b16 v[110:111], v26 offset:33792
    v_mfma_f32_32x32x16_bf16 v[156:171], a[84:87], v[120:123], v[156:171]
    buffer_load_dwordx4 v54, s[28:31], s61 offen offset:1024 sc1 lds
    ds_read_b64_tr_b16 v[112:113], v27 offset:32768
    ds_read_b64_tr_b16 v[114:115], v27 offset:33792
    s_waitcnt lgkmcnt(8)
    v_mfma_f32_32x32x16_bf16 v[140:155], a[88:91], v[124:127], v[140:155]
    ds_read_b64_tr_b16 v[116:117], v26 offset:34816
    ds_read_b64_tr_b16 v[118:119], v26 offset:35840
    v_mfma_f32_32x32x16_bf16 v[156:171], a[88:91], v[128:131], v[156:171]
    buffer_load_dwordx4 v53, s[28:31], s61 offen offset:2048 sc1 lds
    ds_read_b64_tr_b16 v[120:121], v27 offset:34816
    ds_read_b64_tr_b16 v[122:123], v27 offset:35840
    s_waitcnt lgkmcnt(8)
    v_mfma_f32_32x32x16_bf16 v[140:155], a[92:95], v[132:135], v[140:155]
    buffer_load_dwordx4 v54, s[28:31], s61 offen offset:3072 sc1 lds
    ds_read_b64_tr_b16 v[124:125], v26 offset:36864
    ds_read_b64_tr_b16 v[126:127], v26 offset:37888
    v_mfma_f32_32x32x16_bf16 v[156:171], a[92:95], v[136:139], v[156:171]
    ds_read_b64_tr_b16 v[128:129], v27 offset:36864
    ds_read_b64_tr_b16 v[130:131], v27 offset:37888
    s_waitcnt lgkmcnt(8)
    v_mfma_f32_32x32x16_bf16 v[140:155], a[96:99], v[108:111], v[140:155]
    s_add_u32 m0, s58, 65536
    s_add_u32 s66, s66, 1
    s_and_b32 s66, s66, 3
    s_lshl_b32 s61, s66, 12
    buffer_load_dwordx4 v53, s[28:31], s61 offen sc1 lds
    ds_read_b64_tr_b16 v[132:133], v26 offset:38912
    ds_read_b64_tr_b16 v[134:135], v26 offset:39936
    v_mfma_f32_32x32x16_bf16 v[156:171], a[96:99], v[112:115], v[156:171]
    buffer_load_dwordx4 v54, s[28:31], s61 offen offset:1024 sc1 lds
    ds_read_b64_tr_b16 v[136:137], v27 offset:38912
    ds_read_b64_tr_b16 v[138:139], v27 offset:39936
    s_waitcnt lgkmcnt(8)
    v_mfma_f32_32x32x16_bf16 v[140:155], a[100:103], v[116:119], v[140:155]
    s_waitcnt vmcnt(10)
    s_barrier
    s_xor_b32 s55, s55, 1024
    s_load_dword s46, s[28:29], s55 glc
    ds_read_b64_tr_b16 v[188:189], v32 offset:49152
    buffer_load_dwordx4 v53, s[28:31], s61 offen offset:2048 sc1 lds
    ds_read_b64_tr_b16 v[190:191], v32 offset:53248
    ds_read_b128 v[108:111], v39 offset:0
    v_mfma_f32_32x32x16_bf16 v[156:171], a[100:103], v[120:123], v[156:171]
    ds_read_b128 v[112:115], v40 offset:0
    s_waitcnt lgkmcnt(8)
    v_mfma_f32_32x32x16_bf16 v[140:155], a[104:107], v[124:127], v[140:155]
    buffer_load_dwordx4 v54, s[28:31], s61 offen offset:3072 sc1 lds
    ds_read_b64_tr_b16 v[192:193], v32 offset:50176
    ds_read_b64_tr_b16 v[194:195], v32 offset:54272
    ds_read_b128 v[116:119], v39 offset:512
    v_mfma_f32_32x32x16_bf16 v[156:171], a[104:107], v[128:131], v[156:171]
    ds_read_b128 v[120:123], v40 offset:512
    s_waitcnt lgkmcnt(8)
    v_mfma_f32_32x32x16_bf16 v[140:155], a[108:111], v[132:135], v[140:155]
    ds_read_b64_tr_b16 v[196:197], v32 offset:51200
    ds_read_b64_tr_b16 v[198:199], v32 offset:55296
    ds_read_b128 v[124:127], v39 offset:2048
    v_mfma_f32_32x32x16_bf16 v[156:171], a[108:111], v[136:139], v[156:171]
    ds_read_b128 v[128:131], v40 offset:2048
    s_waitcnt lgkmcnt(8)
    v_mfma_f32_32x32x16_bf16 v[140:155], v[188:191], v[108:111], v[140:155]
    ds_read_b64_tr_b16 v[200:201], v32 offset:52224
    ds_read_b64_tr_b16 v[202:203], v32 offset:56320
    ds_read_b128 v[132:135], v39 offset:2560
    v_mfma_f32_32x32x16_bf16 v[156:171], v[188:191], v[112:115], v[156:171]
    ds_read_b128 v[136:139], v40 offset:2560
    s_waitcnt lgkmcnt(8)
    v_mfma_f32_32x32x16_bf16 v[140:155], v[192:195], v[116:119], v[140:155]
    s_waitcnt vmcnt(8)
    s_barrier
    ds_read_b64_tr_b16 v[188:189], v33 offset:32768
    ds_read_b64_tr_b16 v[190:191], v33 offset:36864
    ds_read_b128 v[108:111], v39 offset:16384
    v_mfma_f32_32x32x16_bf16 v[156:171], v[192:195], v[120:123], v[156:171]
    ds_read_b128 v[112:115], v40 offset:16384
    s_waitcnt lgkmcnt(8)
    v_mfma_f32_32x32x16_bf16 v[140:155], v[196:199], v[124:127], v[140:155]
    ds_read_b64_tr_b16 v[192:193], v33 offset:33792
    ds_read_b64_tr_b16 v[194:195], v33 offset:37888
    ds_read_b128 v[116:119], v39 offset:16896
    v_mfma_f32_32x32x16_bf16 v[156:171], v[196:199], v[128:131], v[156:171]
    ds_read_b128 v[120:123], v40 offset:16896
    s_waitcnt lgkmcnt(8)
    v_mfma_f32_32x32x16_bf16 v[140:155], v[200:203], v[132:135], v[140:155]
    ds_read_b64_tr_b16 v[196:197], v33 offset:34816
    ds_read_b64_tr_b16 v[198:199], v33 offset:38912
    ds_read_b128 v[124:127], v39 offset:18432
    v_mfma_f32_32x32x16_bf16 v[156:171], v[200:203], v[136:139], v[156:171]
    ds_read_b128 v[128:131], v40 offset:18432
    s_waitcnt lgkmcnt(8)
    v_mfma_f32_32x32x16_bf16 v[140:155], v[188:191], v[108:111], v[140:155]
    ds_read_b64_tr_b16 v[200:201], v33 offset:35840
    ds_read_b64_tr_b16 v[202:203], v33 offset:39936
    ds_read_b128 v[132:135], v39 offset:18944
    v_mfma_f32_32x32x16_bf16 v[156:171], v[188:191], v[112:115], v[156:171]
    ds_read_b128 v[136:139], v40 offset:18944
    s_waitcnt lgkmcnt(8)
    v_mfma_f32_32x32x16_bf16 v[140:155], v[192:195], v[116:119], v[140:155]
    s_waitcnt vmcnt(4)
    s_barrier
    s_waitcnt lgkmcnt(0)
    s_cmp_eq_u32 s46, 1
    s_cbranch_scc1 L_pollok7
    s_mov_b32 s60, 0
L_poll7:
    s_sleep 4
    s_load_dword s46, s[28:29], s55 glc
    s_add_u32 s60, s60, 1
    s_waitcnt lgkmcnt(0)
    s_cmp_eq_u32 s46, 1
    s_cbranch_scc1 L_pollok7
    s_cmp_lt_u32 s60, 20000
    s_cbranch_scc1 L_poll7
L_pollok7:
    v_xor_b32 v22, 131072, v22
    ds_read_b64_tr_b16 v[188:189], v33 offset:49152
    buffer_load_dwordx4 v[228:231], v22, s[28:31], 0 offen offset:0 sc1
    ds_read_b64_tr_b16 v[190:191], v33 offset:53248
    ds_read_b128 v[108:111], v35 offset:16384
    v_mfma_f32_32x32x16_bf16 v[156:171], v[192:195], v[120:123], v[156:171]
    buffer_load_dwordx4 v[232:235], v22, s[28:31], 0 offen offset:1024 sc1
    ds_read_b128 v[112:115], v36 offset:16384
    v_mfma_f32_32x32x16_bf16 v[140:155], v[196:199], v[124:127], v[140:155]
    buffer_load_dwordx4 v[236:239], v22, s[28:31], 0 offen offset:2048 sc1
    ds_read_b64_tr_b16 v[192:193], v33 offset:50176
    ds_read_b64_tr_b16 v[194:195], v33 offset:54272
    ds_read_b128 v[116:119], v35 offset:16896
    v_mfma_f32_32x32x16_bf16 v[156:171], v[196:199], v[128:131], v[156:171]
    buffer_load_dwordx4 v[240:243], v22, s[28:31], 0 offen offset:3072 sc1
    ds_read_b128 v[120:123], v36 offset:16896
    v_mfma_f32_32x32x16_bf16 v[140:155], v[200:203], v[132:135], v[140:155]
    ds_read_b64_tr_b16 v[196:197], v33 offset:51200
    ds_read_b64_tr_b16 v[198:199], v33 offset:55296
    ds_read_b128 v[124:127], v35 offset:18432
    v_mfma_f32_32x32x16_bf16 v[156:171], v[200:203], v[136:139], v[156:171]
    ds_read_b128 v[128:131], v36 offset:18432
    s_waitcnt lgkmcnt(8)
    v_mfma_f32_32x32x16_bf16 v[140:155], v[188:191], v[108:111], v[140:155]
    ds_read_b64_tr_b16 v[200:201], v33 offset:52224
    ds_read_b64_tr_b16 v[202:203], v33 offset:56320
    ds_read_b128 v[132:135], v35 offset:18944
    v_mfma_f32_32x32x16_bf16 v[156:171], v[188:191], v[112:115], v[156:171]
    ds_read_b128 v[136:139], v36 offset:18944
    s_waitcnt lgkmcnt(8)
    v_mfma_f32_32x32x16_bf16 v[140:155], v[192:195], v[116:119], v[140:155]
    s_waitcnt vmcnt(4)
    s_barrier
    ds_read_b64_tr_b16 v[188:189], v32 offset:0
    ds_read_b64_tr_b16 v[190:191], v32 offset:4096
    ds_read_b128 v[108:111], v37 offset:0
    v_mfma_f32_32x32x16_bf16 v[156:171], v[192:195], v[120:123], v[156:171]
    ds_read_b128 v[112:115], v38 offset:0
    s_waitcnt lgkmcnt(8)
    v_mfma_f32_32x32x16_bf16 v[140:155], v[196:199], v[124:127], v[140:155]
    ds_read_b64_tr_b16 v[192:193], v32 offset:1024
    ds_read_b64_tr_b16 v[194:195], v32 offset:5120
    ds_read_b128 v[116:119], v37 offset:512
    v_mfma_f32_32x32x16_bf16 v[156:171], v[196:199], v[128:131], v[156:171]
    ds_read_b128 v[120:123], v38 offset:512
    s_waitcnt lgkmcnt(8)
    v_mfma_f32_32x32x16_bf16 v[140:155], v[200:203], v[132:135], v[140:155]
    ds_read_b64_tr_b16 v[196:197], v32 offset:2048
    ds_read_b64_tr_b16 v[198:199], v32 offset:6144
    ds_read_b128 v[124:127], v37 offset:2048
    v_mfma_f32_32x32x16_bf16 v[156:171], v[200:203], v[136:139], v[156:171]
    ds_read_b128 v[128:131], v38 offset:2048
    s_waitcnt lgkmcnt(8)
    v_mfma_f32_32x32x16_bf16 v[140:155], v[188:191], v[108:111], v[140:155]
    ds_read_b64_tr_b16 v[200:201], v32 offset:3072
    ds_read_b64_tr_b16 v[202:203], v32 offset:7168
    ds_read_b128 v[132:135], v37 offset:2560
    v_mfma_f32_32x32x16_bf16 v[156:171], v[188:191], v[112:115], v[156:171]
    ds_read_b128 v[136:139], v38 offset:2560
    s_waitcnt lgkmcnt(8)
    v_mfma_f32_32x32x16_bf16 v[140:155], v[192:195], v[116:119], v[140:155]
    v_mfma_f32_32x32x16_bf16 v[156:171], v[192:195], v[120:123], v[156:171]
    s_waitcnt lgkmcnt(4)
    v_mfma_f32_32x32x16_bf16 v[140:155], v[196:199], v[124:127], v[140:155]
    v_mfma_f32_32x32x16_bf16 v[156:171], v[196:199], v[128:131], v[156:171]
    s_waitcnt lgkmcnt(0)
    v_mfma_f32_32x32x16_bf16 v[140:155], v[200:203], v[132:135], v[140:155]
    v_mfma_f32_32x32x16_bf16 v[156:171], v[200:203], v[136:139], v[156:171]
    s_waitcnt vmcnt(3)
    v_lshlrev_b32 v172, 16, v228
    v_and_b32 v173, 0xffff0000, v228
    s_nop 7
    v_pk_add_f32 v[140:141], v[140:141], v[172:173]
    v_lshlrev_b32 v174, 16, v229
    v_and_b32 v175, 0xffff0000, v229
    v_pk_add_f32 v[142:143], v[142:143], v[174:175]
    ds_write_b128 v75, v[140:143] offset:0
    v_lshlrev_b32 v172, 16, v230
    v_and_b32 v173, 0xffff0000, v230
    v_pk_add_f32 v[144:145], v[144:145], v[172:173]
    v_lshlrev_b32 v174, 16, v231
    v_and_b32 v175, 0xffff0000, v231
    v_pk_add_f32 v[146:147], v[146:147], v[174:175]
    ds_write_b128 v76, v[144:147] offset:0
    s_waitcnt vmcnt(2)
    v_lshlrev_b32 v172, 16, v232
    v_and_b32 v173, 0xffff0000, v232
    v_pk_add_f32 v[148:149], v[148:149], v[172:173]
    v_lshlrev_b32 v174, 16, v233
    v_and_b32 v175, 0xffff0000, v233
    v_pk_add_f32 v[150:151], v[150:151], v[174:175]
    ds_write_b128 v77, v[148:151] offset:0
    v_lshlrev_b32 v172, 16, v234
    v_and_b32 v173, 0xffff0000, v234
    v_pk_add_f32 v[152:153], v[152:153], v[172:173]
    v_lshlrev_b32 v174, 16, v235
    v_and_b32 v175, 0xffff0000, v235
    v_pk_add_f32 v[154:155], v[154:155], v[174:175]
    ds_write_b128 v78, v[152:155] offset:0
    s_waitcnt vmcnt(1)
    v_lshlrev_b32 v172, 16, v236
    v_and_b32 v173, 0xffff0000, v236
    v_pk_add_f32 v[156:157], v[156:157], v[172:173]
    v_lshlrev_b32 v174, 16, v237
    v_and_b32 v175, 0xffff0000, v237
    v_pk_add_f32 v[158:159], v[158:159], v[174:175]
    ds_write_b128 v75, v[156:159] offset:8192
    v_lshlrev_b32 v172, 16, v238
    v_and_b32 v173, 0xffff0000, v238
    v_pk_add_f32 v[160:161], v[160:161], v[172:173]
    v_lshlrev_b32 v174, 16, v239
    v_and_b32 v175, 0xffff0000, v239
    v_pk_add_f32 v[162:163], v[162:163], v[174:175]
    ds_write_b128 v76, v[160:163] offset:8192
    s_waitcnt vmcnt(0)
    v_lshlrev_b32 v172, 16, v240
    v_and_b32 v173, 0xffff0000, v240
    v_pk_add_f32 v[164:165], v[164:165], v[172:173]
    v_lshlrev_b32 v174, 16, v241
    v_and_b32 v175, 0xffff0000, v241
    v_pk_add_f32 v[166:167], v[166:167], v[174:175]
    ds_write_b128 v77, v[164:167] offset:8192
    v_lshlrev_b32 v172, 16, v242
    v_and_b32 v173, 0xffff0000, v242
    v_pk_add_f32 v[168:169], v[168:169], v[172:173]
    v_lshlrev_b32 v174, 16, v243
    v_and_b32 v175, 0xffff0000, v243
    v_pk_add_f32 v[170:171], v[170:171], v[174:175]
    ds_write_b128 v78, v[168:171] offset:8192
    s_waitcnt lgkmcnt(0)
    s_barrier
    ds_read_b128 v[108:111], v79 offset:0
    ds_read_b128 v[112:115], v80 offset:0
    ds_read_b128 v[116:119], v81 offset:0
    ds_read_b128 v[120:123], v82 offset:0
    ds_read_b128 v[124:127], v79 offset:2048
    ds_read_b128 v[128:131], v80 offset:2048
    ds_read_b128 v[132:135], v81 offset:2048
    ds_read_b128 v[136:139], v82 offset:2048
    s_waitcnt lgkmcnt(7)
    v_pk_add_f32 v[212:213], v[212:213], v[108:109]
    v_pk_add_f32 v[214:215], v[214:215], v[110:111]
    s_waitcnt lgkmcnt(6)
    v_pk_add_f32 v[216:217], v[216:217], v[112:113]
    v_pk_add_f32 v[218:219], v[218:219], v[114:115]
    s_waitcnt lgkmcnt(5)
    v_pk_add_f32 v[212:213], v[212:213], v[116:117]
    v_pk_add_f32 v[214:215], v[214:215], v[118:119]
    s_waitcnt lgkmcnt(4)
    v_pk_add_f32 v[216:217], v[216:217], v[120:121]
    v_pk_add_f32 v[218:219], v[218:219], v[122:123]
    v_cvt_pk_bf16_f32 v100, v212, v213
    v_cvt_pk_bf16_f32 v101, v214, v215
    v_cvt_pk_bf16_f32 v102, v216, v217
    v_cvt_pk_bf16_f32 v103, v218, v219
    buffer_store_dwordx4 v[100:103], v73, s[32:35], 0 offen
    s_waitcnt lgkmcnt(3)
    v_pk_add_f32 v[220:221], v[220:221], v[124:125]
    v_pk_add_f32 v[222:223], v[222:223], v[126:127]
    s_waitcnt lgkmcnt(2)
    v_pk_add_f32 v[224:225], v[224:225], v[128:129]
    v_pk_add_f32 v[226:227], v[226:227], v[130:131]
    s_waitcnt lgkmcnt(1)
    v_pk_add_f32 v[220:221], v[220:221], v[132:133]
    v_pk_add_f32 v[222:223], v[222:223], v[134:135]
    s_waitcnt lgkmcnt(0)
    v_pk_add_f32 v[224:225], v[224:225], v[136:137]
    v_pk_add_f32 v[226:227], v[226:227], v[138:139]
    v_cvt_pk_bf16_f32 v104, v220, v221
    v_cvt_pk_bf16_f32 v105, v222, v223
    v_cvt_pk_bf16_f32 v106, v224, v225
    v_cvt_pk_bf16_f32 v107, v226, v227
    buffer_store_dwordx4 v[104:107], v74, s[32:35], 0 offen
L_fin:
L_end:
    s_endpgm
.section .rodata,"a"
.p2align 6
.amdhsa_kernel parallel_sum__sliding_local_dilated__mixer_token_mlp__prompt_kernel
  .amdhsa_next_free_vgpr 512
  .amdhsa_next_free_sgpr 102
  .amdhsa_accum_offset 256
  .amdhsa_group_segment_fixed_size 0
  .amdhsa_kernarg_size 88
  .amdhsa_user_sgpr_count 2
  .amdhsa_user_sgpr_kernarg_segment_ptr 1
  .amdhsa_system_sgpr_workgroup_id_x 1
.end_amdhsa_kernel
```

```asm
; @launch grid=(256,1,1) block=(256,1,1) lds=163840
.amdgcn_target "amdgcn-amd-amdhsa--gfx950"
.text
.globl parallel_sum__sliding_local_dilated__mixer_token_mlp__prompt_kernel
.p2align 8
.type parallel_sum__sliding_local_dilated__mixer_token_mlp__prompt_kernel,@function
parallel_sum__sliding_local_dilated__mixer_token_mlp__prompt_kernel:
    s_cmp_ge_u32 s2, 256
    s_cbranch_scc1 L_end
    s_load_dwordx2 s[8:9], s[0:1], 0
    s_load_dwordx2 s[20:21], s[0:1], 32
    s_load_dwordx2 s[28:29], s[0:1], 80
    s_load_dwordx2 s[44:45], s[0:1], 72
    s_load_dwordx2 s[12:13], s[0:1], 8
    s_load_dwordx2 s[16:17], s[0:1], 16
    s_load_dwordx2 s[24:25], s[0:1], 48
    s_load_dwordx2 s[32:33], s[0:1], 64
    s_load_dwordx2 s[36:37], s[0:1], 40
    s_load_dwordx2 s[40:41], s[0:1], 56
    s_memrealtime s[78:79]
    s_getpc_b64 s[6:7]
L_pc:
    s_and_b32 s3, s2, 0xf8
    v_lshrrev_b32 v14, 5, v0
    v_add_lshl_u32 v14, s3, v14, 7
    v_min_u32 v14, L_end-L_pc-4, v14
    global_load_dword v18, v14, s[6:7]
    v_lshrrev_b32 v14, 6, v0
    v_and_b32 v10, 31, v0
    v_readfirstlane_b32 s48, v14
    v_bfe_u32 v9, v0, 5, 1
    v_mul_u32_u24 v15, 896, v9
    v_lshl_add_u32 v15, v10, 4, v15
    v_cmp_gt_u32 vcc, 28, v10
    v_mov_b32 v16, 268435456
    s_mov_b32 s10, 1835008
    s_mov_b32 s11, 0x20000
    v_cndmask_b32 v15, v16, v15, vcc
    s_lshr_b32 s4, s48, 1
    s_and_b32 s5, s48, 1
    s_and_b32 s3, s2, 0xfe
    s_add_u32 s3, s3, s4
    s_lshl_b32 s3, s3, 1
    s_and_b32 s60, s2, 1
    s_add_u32 s3, s3, s60
    s_lshl_b32 s3, s3, 1
    s_add_u32 s3, s3, s5
    s_mul_i32 s3, s3, 1792
    s_waitcnt lgkmcnt(0)
    buffer_load_dwordx4 v[176:179], v15, s[8:11], s3 offen
    buffer_load_dwordx4 v[180:183], v15, s[8:11], s3 offen offset:448
    v_and_b32 v1, 63, v0
    s_mov_b32 s46, 256
    s_mov_b32 s47, 0x20000
    s_lshl_b32 s3, s48, 8
    s_add_u32 s3, s3, s2
    s_cmp_lt_u32 s3, 8
    s_cselect_b32 s3, 0, 268435456
    s_or_b32 s78, s78, 1
    v_mov_b32 v228, s78
    v_mov_b32 v229, 0
    v_lshlrev_b32 v11, 25, v1
    v_lshrrev_b32 v13, 4, v0
    v_lshlrev_b32 v13, 23, v13
    v_add_lshl_u32 v13, v13, v10, 2
    buffer_atomic_cmpswap v[228:229], v11, s[44:47], s3 offen sc1
    s_bfe_u32 s6, s2, 0x20001
    s_and_b32 s7, s2, 1
    s_and_b32 s61, s2, 7
    s_lshr_b32 s101, s2, 3
    s_mul_i32 s52, s7, 25
    s_add_u32 s52, s52, s101
    s_mul_i32 s51, s52, 37
    s_lshr_b32 s51, s51, 8
    s_mul_i32 s3, s51, 7
    s_sub_u32 s52, s52, s3
    s_and_b32 s3, s6, 1
    s_mul_i32 s3, s3, 6
    s_add_u32 s51, s51, s3
    s_add_u32 s51, s51, 1
    s_add_u32 s3, s3, s51
    s_cmp_eq_u32 s3, 7
    s_cselect_b32 s51, 0, s51
    s_lshr_b32 s59, s6, 1
    s_lshl_b32 s51, s51, 1
    s_add_u32 s51, s51, s59
    s_max_u32 s60, s101, 25
    s_sub_u32 s60, s60, 25
    s_add_u32 s3, s101, s7
    s_cmp_lt_u32 s3, 25
    s_cselect_b32 s55, 1, 0
    s_cselect_b32 s52, s52, s60
    s_mov_b32 s22, 7340032
    s_mov_b32 s23, 0x20000
    s_lshl_b32 s3, s52, 1
    s_sub_u32 s60, s3, 7
    s_cmp_ge_u32 s3, 7
    s_cselect_b32 s3, s60, s3
    s_and_b32 s3, s3, 7
    s_mul_i32 s60, s61, 2
    s_add_u32 s3, s3, s60
    s_and_b32 s3, s3, 7
    s_mul_i32 s0, s3, 458752
    s_lshl_b32 s1, s3, 13
    s_lshl_b32 s58, s48, 12
    v_lshrrev_b32 v3, 4, v1
    v_lshrrev_b32 v5, 3, v1
    v_and_b32 v6, 7, v1
    v_and_b32 v14, 1, v3
    v_lshlrev_b32 v15, 2, v14
    v_xor_b32 v15, v15, v6
    v_lshlrev_b32 v76, 4, v15
    s_cmp_eq_u32 s55, 0
    s_cbranch_scc1 L_nog1
    v_mul_u32_u24 v15, 3584, v5
    s_lshl_b32 s3, s59, 5
    s_add_u32 s3, s3, s48
    s_mul_i32 s3, s3, 114688
    s_lshl_b32 s60, s51, 7
    s_add_u32 s3, s3, s60
    v_add3_u32 v48, v15, v76, s3
    v_add_u32 v49, 27648, v48
    v_add_u32 v50, 55296, v48
    v_add_u32 v51, 82944, v48
    s_mov_b32 s38, 3584
    s_mov_b32 s39, 0x20000
    v_lshlrev_b32 v14, 3, v9
    s_lshl_b32 s3, s51, 1
    s_add_u32 s3, s3, s4
    s_lshl_b32 s3, s3, 6
    buffer_load_dwordx2 v[240:241], v14, s[36:39], s3 offen offset:0
    buffer_load_dwordx2 v[242:243], v14, s[36:39], s3 offen offset:16
    buffer_load_dwordx2 v[244:245], v14, s[36:39], s3 offen offset:32
    buffer_load_dwordx2 v[246:247], v14, s[36:39], s3 offen offset:48
    s_add_u32 m0, s58, 0
    v_xor_b32 v48, 128, v48
    buffer_load_dwordx4 v48, s[20:23], s0 offen lds
    v_xor_b32 v49, 128, v49
    buffer_load_dwordx4 v49, s[20:23], s0 offen offset:1024 lds
    v_xor_b32 v50, 128, v50
    buffer_load_dwordx4 v50, s[20:23], s0 offen offset:2048 lds
    v_xor_b32 v51, 128, v51
    buffer_load_dwordx4 v51, s[20:23], s0 offen offset:3072 lds
    s_mul_i32 s53, s101, 37
    s_lshr_b32 s53, s53, 8
    s_mul_i32 s54, s53, 7
    s_sub_u32 s54, s101, s54
    s_and_b32 s53, s53, 3
    s_lshl_b32 s3, s6, 2
    s_add_u32 s53, s53, s3
    s_lshl_b32 s53, s53, 1
    s_add_u32 s53, s53, s7
    s_mov_b32 s42, 4096
    s_mov_b32 s43, 0x20000
    s_lshl_b32 s3, s53, 2
    s_add_u32 s3, s3, s48
    s_lshl_b32 s60, s3, 5
    v_lshl_add_u32 v75, v5, 1, s60
    s_mul_i32 s3, s3, 14336
    s_lshl_b32 s60, s54, 7
    s_add_u32 s3, s3, s60
    v_mul_u32_u24 v15, 896, v5
    v_lshl_add_u32 v15, v6, 4, v15
    v_add_u32 v78, s3, v15
    v_add_u32 v79, 7168, v78
    s_cmp_lt_u32 s101, 28
    s_cselect_b32 s56, 1, 0
    s_lshl_b32 s50, s7, 3
    s_and_b32 s3, s101, 7
    s_add_u32 s50, s50, s3
    s_lshr_b32 s60, s101, 3
    s_lshl_b32 s49, s6, 2
    s_add_u32 s49, s49, s60
    s_lshl_b32 s49, s49, 2
    s_add_u32 s49, s49, s48
    s_mul_i32 s60, s60, 0
    s_add_u32 s3, s3, s60
    s_sub_u32 s60, s3, 7
    s_cmp_ge_u32 s3, 7
    s_cselect_b32 s3, s60, s3
    s_lshl_b32 s62, s3, 18
    s_mul_i32 s63, s3, 12288
    s_mov_b32 s30, 20971520
    s_mov_b32 s31, 0x20000
    s_mov_b32 s75, 0x3727c5ac
    s_mov_b32 s76, 0x3b124925
    s_mov_b32 s77, 0x3f803f80
    v_lshlrev_b32 v4, 4, v1
    v_bfe_u32 v7, v1, 2, 2
    v_and_b32 v8, 3, v1
    v_mul_u32_u24 v14, 960, v9
    v_lshl_add_u32 v14, v10, 4, v14
    s_mul_i32 s3, s48, 1920
    s_add_u32 s3, s3, 147456
    v_add_u32 v224, s3, v14
    v_mul_u32_u24 v14, 960, v7
    v_lshl_add_u32 v14, v3, 5, v14
    v_lshl_add_u32 v14, v8, 3, v14
    s_lshl_b32 s3, s48, 8
    s_add_u32 s3, s3, 147456
    v_add_u32 v225, s3, v14
    s_lshl_b32 s3, s48, 3
    s_add_u32 s3, s3, 155648
    v_lshl_add_u32 v226, v9, 2, s3
    v_lshlrev_b32 v231, 2, v6
    v_and_b32 v2, 15, v1
    v_lshlrev_b32 v232, 14, v3
    v_add_lshl_u32 v232, v232, v2, 2
    v_add_u32 v231, 155648, v231
    v_lshlrev_b32 v14, 17, v9
    v_lshl_add_u32 v227, v10, 4, v14
    s_cmp_eq_u32 s48, 3
    s_cselect_b32 s60, 268435456, 0
    s_lshl_b32 s70, s48, 10
    s_add_u32 s70, s70, s2
    s_lshl_b32 s70, s70, 9
    s_add_u32 s71, s70, 262144
    s_add_u32 s71, s71, s60
    s_xor_b32 s60, s60, 268435456
    s_lshl_b32 s72, s2, 7
    s_add_u32 s72, s72, s60
    s_add_u32 s72, s72, 6291456
    s_lshr_b32 s74, s2, 2
    s_lshl_b32 s74, s74, 5
    s_and_b32 s3, s2, 3
    s_add_u32 s74, s74, s3
    s_lshl_b32 s74, s74, 2
    s_add_u32 s74, s74, 10485760
    v_cmp_gt_u32 vcc, 8, v0
    v_lshlrev_b32 v230, 13, v0
    v_mov_b32 v14, 268435456
    s_and_b32 s3, s2, 7
    s_lshl_b32 s3, s3, 13
    s_add_u32 s3, s3, 10485760
    v_lshrrev_b32 v15, 2, v0
    v_lshl_add_u32 v15, v15, 7, s3
    v_lshl_add_u32 v20, v8, 2, v15
    v_cndmask_b32 v230, v14, v230, vcc
    v_mov_b32 v17, 0
    s_lshl_b32 s3, s48, 14
    s_add_u32 s74, s74, s3
    s_add_u32 s73, s74, 8192
    s_waitcnt vmcnt(10)
    v_dot2_f32_bf16 v220, v176, s77, 0
    v_dot2_f32_bf16 v221, v176, v176, 0
    v_dot2_f32_bf16 v220, v177, s77, v220
    v_dot2_f32_bf16 v221, v177, v177, v221
    v_dot2_f32_bf16 v220, v178, s77, v220
    v_dot2_f32_bf16 v221, v178, v178, v221
    v_dot2_f32_bf16 v220, v179, s77, v220
    v_dot2_f32_bf16 v221, v179, v179, v221
    s_waitcnt vmcnt(9)
    v_dot2_f32_bf16 v220, v180, s77, v220
    v_dot2_f32_bf16 v221, v180, v180, v221
    v_dot2_f32_bf16 v220, v181, s77, v220
    v_dot2_f32_bf16 v221, v181, v181, v221
    v_dot2_f32_bf16 v220, v182, s77, v220
    v_dot2_f32_bf16 v221, v182, v182, v221
    v_dot2_f32_bf16 v220, v183, s77, v220
    v_dot2_f32_bf16 v221, v183, v183, v221
    buffer_load_dword v12, v17, s[44:47], 0 offen sc1
    v_lshlrev_b32 v184, 16, v176
    v_and_b32 v185, 0xffff0000, v176
    v_add_f32_dpp v220, v220, v220 quad_perm:[1,0,3,2] row_mask:0xf bank_mask:0xf
    v_add_f32_dpp v221, v221, v221 quad_perm:[1,0,3,2] row_mask:0xf bank_mask:0xf
    v_lshlrev_b32 v186, 16, v177
    v_add_f32_dpp v220, v220, v220 quad_perm:[2,3,0,1] row_mask:0xf bank_mask:0xf
    v_add_f32_dpp v221, v221, v221 quad_perm:[2,3,0,1] row_mask:0xf bank_mask:0xf
    v_and_b32 v187, 0xffff0000, v177
    v_add_f32_dpp v220, v220, v220 row_half_mirror row_mask:0xf bank_mask:0xf
    v_add_f32_dpp v221, v221, v221 row_half_mirror row_mask:0xf bank_mask:0xf
    v_lshlrev_b32 v188, 16, v178
    v_add_f32_dpp v220, v220, v220 row_mirror row_mask:0xf bank_mask:0xf
    v_add_f32_dpp v221, v221, v221 row_mirror row_mask:0xf bank_mask:0xf
    v_and_b32 v189, 0xffff0000, v178
    v_mov_b32 v222, v220
    v_mov_b32 v223, v221
    v_lshlrev_b32 v190, 16, v179
    v_permlane16_swap_b32 v220, v222
    v_permlane16_swap_b32 v221, v223
    v_add_f32 v220, v220, v222
    v_add_f32 v221, v221, v223
    v_mul_f32_e64 v220, -v220, s76
    v_mul_f32 v222, v220, v220
    v_fma_f32 v221, v221, s76, -v222
    v_max_f32 v221, 0, v221
    v_add_f32 v222, s75, v221
    v_rsq_f32 v216, v222
    v_and_b32 v191, 0xffff0000, v179
    v_mul_f32 v222, v216, v216
    v_fma_f32 v223, v222, v221, s75
    v_rsq_f32 v222, v223
    v_mul_f32 v217, v220, v216
    v_mul_f32 v218, v216, v222
    v_mul_f32 v219, v217, v222
    v_mul_f32 v223, v223, v222
    ds_write_b32 v226, v223
    v_lshlrev_b32 v192, 16, v180
    v_and_b32 v193, 0xffff0000, v180
    v_lshlrev_b32 v194, 16, v181
    v_and_b32 v195, 0xffff0000, v181
    v_lshlrev_b32 v196, 16, v182
    v_and_b32 v197, 0xffff0000, v182
    v_lshlrev_b32 v198, 16, v183
    v_and_b32 v199, 0xffff0000, v183
    v_pk_fma_f32 v[200:201], v[184:185], v[218:219], v[218:219] op_sel:[0,0,1] op_sel_hi:[1,0,1]
    v_pk_fma_f32 v[202:203], v[186:187], v[218:219], v[218:219] op_sel:[0,0,1] op_sel_hi:[1,0,1]
    v_pk_fma_f32 v[204:205], v[188:189], v[218:219], v[218:219] op_sel:[0,0,1] op_sel_hi:[1,0,1]
    v_pk_fma_f32 v[206:207], v[190:191], v[218:219], v[218:219] op_sel:[0,0,1] op_sel_hi:[1,0,1]
    v_cvt_pk_bf16_f32 v176, v200, v201
    v_cvt_pk_bf16_f32 v177, v202, v203
    v_cvt_pk_bf16_f32 v178, v204, v205
    v_cvt_pk_bf16_f32 v179, v206, v207
    ds_write_b128 v224, v[176:179] offset:0
    v_pk_fma_f32 v[208:209], v[192:193], v[218:219], v[218:219] op_sel:[0,0,1] op_sel_hi:[1,0,1]
    v_pk_fma_f32 v[210:211], v[194:195], v[218:219], v[218:219] op_sel:[0,0,1] op_sel_hi:[1,0,1]
    v_pk_fma_f32 v[212:213], v[196:197], v[218:219], v[218:219] op_sel:[0,0,1] op_sel_hi:[1,0,1]
    v_pk_fma_f32 v[214:215], v[198:199], v[218:219], v[218:219] op_sel:[0,0,1] op_sel_hi:[1,0,1]
    v_cvt_pk_bf16_f32 v180, v208, v209
    v_cvt_pk_bf16_f32 v181, v210, v211
    v_cvt_pk_bf16_f32 v182, v212, v213
    v_cvt_pk_bf16_f32 v183, v214, v215
    ds_write_b128 v224, v[180:183] offset:448
    s_waitcnt lgkmcnt(0)
    s_barrier
    ds_read_b64_tr_b16 v[104:105], v225 offset:0
    ds_read_b64_tr_b16 v[106:107], v225 offset:3840
    ds_read_b64_tr_b16 v[108:109], v225 offset:128
    ds_read_b64_tr_b16 v[110:111], v225 offset:3968
    ds_read_b32 v223, v231
    s_waitcnt lgkmcnt(3)
    buffer_store_dwordx4 v[104:107], v227, s[28:31], s70 offen sc1
    s_waitcnt lgkmcnt(1)
    buffer_store_dwordx4 v[108:111], v227, s[28:31], s71 offen sc1
    v_cmp_gt_u32 vcc, 16, v1
    s_waitcnt lgkmcnt(0)
    s_nop 0
    v_cndmask_b32 v223, 0, v223, vcc
    buffer_store_dword v223, v232, s[28:31], s72 offen sc1
    s_add_u32 m0, s58, 16384
    s_add_u32 s0, s0, 458752
    s_cmp_eq_u32 s0, 3670016
    s_cselect_b32 s0, 0, s0
    buffer_load_dwordx4 v48, s[20:23], s0 offen lds
    buffer_load_dwordx4 v49, s[20:23], s0 offen offset:1024 lds
    buffer_load_dwordx4 v50, s[20:23], s0 offen offset:2048 lds
    buffer_load_dwordx4 v51, s[20:23], s0 offen offset:3072 lds
    s_mov_b32 s18, 401408
    s_mov_b32 s19, 0x20000
    s_mov_b32 s26, 7340032
    s_mov_b32 s27, 0x20000
    s_mov_b32 s34, 1835008
    s_mov_b32 s35, 0x20000
    s_mov_b32 s36, 1
    v_lshl_add_u32 v15, v9, 2, v7
    v_lshlrev_b32 v15, 7, v15
    v_lshl_add_u32 v15, v8, 3, v15
    v_and_b32 v16, 2, v7
    v_and_b32 v14, 1, v3
    v_add_u32 v16, v16, v14
    v_lshl_add_u32 v15, v16, 5, v15
    s_mul_i32 s3, s4, 8256
    v_xor_b32 v31, s3, v15
    v_xor_b32 v32, 64, v31
    v_add_u32 v33, 65536, v31
    v_add_u32 v34, 65536, v32
    v_add_u32 v35, 131072, v31
    v_add_u32 v36, 131072, v32
    s_lshl_b32 s6, s52, 1
    s_add_u32 s6, s6, s5
    s_lshl_b32 s3, s6, 1
    s_add_u32 s3, s3, s59
    s_lshl_b32 s3, s3, 4
    s_add_u32 s3, s3, s4
    s_lshl_b32 s3, s3, 12
    v_add_u32 v71, s3, v4
    s_xor_b32 s37, s51, 1
    s_lshl_b32 s37, s37, 3
    s_add_u32 s37, s37, s52
    s_lshl_b32 s3, s37, 14
    s_add_u32 s3, s3, s58
    s_add_u32 s3, s3, 16777216
    v_add_u32 v23, s3, v4
    s_lshl_b32 s37, s37, 5
    s_add_u32 s37, s37, s5
    s_lshl_b32 s37, s37, 2
    s_add_u32 s37, s37, 6422528
    s_mul_i32 s67, s6, 56
    s_lshl_b32 s3, s51, 1
    s_add_u32 s3, s3, s4
    s_add_u32 s67, s67, s3
    s_lshl_b32 s67, s67, 11
    s_add_u32 s67, s67, 2097152
    v_add_u32 v74, s58, v4
    s_lshl_b32 s68, s52, 2
    s_and_b32 s3, s51, 1
    s_add_u32 s68, s68, s3
    s_cmp_ge_u32 s51, 14
    s_cselect_b32 s3, 2, 0
    s_add_u32 s68, s68, s3
    s_lshl_b32 s68, s68, 7
    s_add_u32 s68, s68, 6356992
    s_waitcnt vmcnt(7)
    v_readfirstlane_b32 s57, v12
    s_mov_b32 s60, 0
    s_cmp_lg_u32 s57, 0
    s_cbranch_scc1 L_nonce_ok
L_nonce:
    buffer_load_dword v12, v17, s[44:47], 0 offen sc1
    s_add_u32 s60, s60, 1
    s_waitcnt vmcnt(0)
    v_readfirstlane_b32 s57, v12
    s_cmp_ge_u32 s60, 20000
    s_cbranch_scc1 L_nonce_ok
    s_cmp_eq_u32 s57, 0
    s_cbranch_scc1 L_nonce
L_nonce_ok:
    s_waitcnt vmcnt(4)
    s_barrier
    s_atomic_swap s57, s[28:29], s74
    s_atomic_swap s57, s[28:29], s73
    buffer_load_dwordx4 v[90:93], v78, s[8:11], 0 offen
    buffer_load_ushort v88, v75, s[40:43], 0 offen offset:0
    buffer_load_dwordx4 v[94:97], v79, s[8:11], 0 offen
    buffer_load_ushort v89, v75, s[40:43], 0 offen offset:16
    v_add_u32 v46, 65536, v4
    s_add_u32 m0, s58, 32768
    s_add_u32 s0, s0, 458752
    s_cmp_eq_u32 s0, 3670016
    s_cselect_b32 s0, 0, s0
    buffer_load_dwordx4 v48, s[20:23], s0 offen lds
    v_add_u32 v47, 131072, v4
    s_mul_i32 s59, s48, 3072
    s_mul_i32 s3, s50, 86016
    s_add_u32 s3, s3, s59
    s_add_u32 s3, s3, 8388608
    v_add_u32 v73, s3, v4
    v_lshlrev_b32 v15, 7, v9
    v_xor_b32 v15, v15, v4
    s_lshl_b32 s3, s49, 11
    v_add_u32 v60, s3, v15
    v_add_u32 v61, 129024, v60
    s_lshr_b32 s3, s49, 2
    s_lshl_b32 s3, s3, 3
    s_max_u32 s3, s3, 1
    s_sub_u32 s3, s3, 1
    s_lshl_b32 s3, s3, 10
    s_lshl_b32 s6, s5, 17
    s_add_u32 s3, s3, s6
    s_lshl_b32 s6, s4, 28
    s_add_u32 s3, s3, s6
    v_add_u32 v62, s3, v15
    buffer_load_dwordx4 v49, s[20:23], s0 offen offset:1024 lds
    s_lshl_b32 s100, s5, 1
    s_add_u32 s100, s100, s4
    s_lshl_b32 s100, s100, 10
    v_and_b32 v15, 1, v1
    v_mul_u32_u24 v15, 640, v15
    v_lshrrev_b32 v16, 2, v1
    v_lshlrev_b32 v16, 4, v16
    v_xor_b32 v15, v15, v16
    v_bfe_u32 v16, v1, 1, 1
    v_lshl_add_u32 v15, v16, 3, v15
    buffer_load_dwordx4 v50, s[20:23], s0 offen offset:2048 lds
    s_add_u32 s3, s58, 12288
    v_add_u32 v63, s3, v15
    s_sub_u32 s3, s3, 3072
    s_cmp_eq_u32 s48, 0
    s_cselect_b32 s3, 28672, s3
    v_add_u32 v64, s3, v15
    v_add_u32 v65, 65536, v63
    v_add_u32 v66, 65536, v64
    v_add_u32 v67, 131072, v63
    v_add_u32 v68, 131072, v64
    s_lshl_b32 s3, s49, 1
    v_min_u32 v15, 2, v3
    v_add_u32 v15, s3, v15
    v_max_u32 v15, 1, v15
    v_lshlrev_b32 v15, 1, v15
    v_and_b32 v16, 1, v7
    buffer_load_dwordx4 v51, s[20:23], s0 offen offset:3072 lds
    v_add_lshl_u32 v15, v15, v16, 7
    v_lshrrev_b32 v16, 1, v7
    v_lshl_add_u32 v16, v16, 2, v8
    v_lshl_add_u32 v15, v16, 2, v15
    v_add_u32 v70, 6291200, v15
    s_min_u32 s15, s48, 2
    s_lshl_b32 s15, s15, 6
    s_add_u32 s15, s15, 64
    s_lshl_b32 s82, s49, 5
    s_add_u32 s82, s82, s50
    s_lshl_b32 s82, s82, 10
    s_add_u32 s82, s82, 4194304
    s_lshr_b32 s69, s49, 2
    s_lshl_b32 s69, s69, 1
    s_and_b32 s3, s50, 1
    s_add_u32 s69, s69, s3
    s_lshl_b32 s69, s69, 7
    s_add_u32 s69, s69, 6361088
    s_and_b32 s7, s53, 1
    s_mul_i32 s3, s7, 28
    s_add_u32 s3, s3, s48
    s_lshl_b32 s3, s3, 17
    s_xor_b32 s6, s53, 1
    s_lshl_b32 s55, s6, 3
    s_lshl_b32 s6, s53, 7
    s_add_u32 s3, s3, s6
    v_lshlrev_b32 v15, 12, v5
    s_add_u32 m0, s58, 49152
    s_add_u32 s0, s0, 458752
    s_cmp_eq_u32 s0, 3670016
    s_cselect_b32 s0, 0, s0
    buffer_load_dwordx4 v48, s[20:23], s0 offen lds
    v_add3_u32 v52, v15, v76, s3
    v_add_u32 v53, 31744, v52
    v_add_u32 v54, 63488, v52
    v_add_u32 v55, 95232, v52
    v_mul_u32_u24 v15, 896, v5
    s_mul_i32 s3, s4, 25088
    s_mul_i32 s6, s5, 14336
    s_add_u32 s3, s3, s6
    s_lshl_b32 s6, s54, 7
    s_add_u32 s3, s3, s6
    v_add3_u32 v56, v15, v76, s3
    buffer_load_dwordx4 v49, s[20:23], s0 offen offset:1024 lds
    v_add_u32 v57, 6144, v56
    s_lshl_b32 s6, s53, 1
    s_add_u32 s6, s6, s5
    s_and_b32 s3, s53, 30
    s_add_u32 s3, s3, s4
    s_lshl_b32 s3, s3, 7
    s_add_u32 s39, s3, 6361088
    s_lshl_b32 s3, s6, 5
    s_add_u32 s3, s3, s4
    s_lshl_b32 s3, s3, 10
    s_add_u32 s3, s3, 4194304
    v_add_u32 v58, s3, v4
    v_add_u32 v59, 15360, v58
    s_xor_b32 s3, s4, s5
    s_lshl_b32 s3, s3, 6
    v_xor_b32 v37, s3, v31
    buffer_load_dwordx4 v50, s[20:23], s0 offen offset:2048 lds
    v_add_u32 v38, 65536, v37
    v_add_u32 v39, 131072, v37
    v_lshlrev_b32 v14, 10, v14
    v_lshl_add_u32 v14, v9, 8, v14
    v_lshl_add_u32 v14, v2, 4, v14
    s_mul_i32 s3, s4, 12288
    v_add_u32 v40, s3, v14
    v_xor_b32 v41, 4096, v40
    v_add_u32 v42, 65536, v40
    v_add_u32 v43, 65536, v41
    v_add_u32 v44, 131072, v40
    v_add_u32 v45, 131072, v41
    s_lshl_b32 s6, s54, 1
    s_add_u32 s6, s6, s5
    s_lshl_b32 s3, s6, 1
    s_add_u32 s3, s3, s7
    s_mul_i32 s3, s3, 14
    s_add_u32 s3, s3, s4
    s_lshl_b32 s3, s3, 12
    s_add_u32 s3, s3, 2097152
    v_add_u32 v72, s3, v4
    buffer_load_dwordx4 v51, s[20:23], s0 offen offset:3072 lds
    s_lshl_b32 s3, s54, 1
    s_add_u32 s3, s3, s7
    s_lshl_b32 s3, s3, 1
    s_add_u32 s3, s3, s4
    s_lshl_b32 s3, s3, 7
    s_add_u32 s38, s3, 6356992
    s_and_b32 s3, s2, 6
    s_add_u32 s3, s3, s54
    s_sub_u32 s6, s3, 7
    s_cmp_ge_u32 s3, 7
    s_cselect_b32 s3, s6, s3
    s_lshl_b32 s64, s3, 19
    s_lshl_b32 s65, s3, 13
    s_add_u32 s55, s55, s54
    s_lshl_b32 s3, s55, 14
    s_add_u32 s3, s3, s58
    s_add_u32 s3, s3, 12582912
    v_add_u32 v21, s3, v4
    s_add_u32 m0, s58, 65536
    s_add_u32 s0, s0, 458752
    s_cmp_eq_u32 s0, 3670016
    s_cselect_b32 s0, 0, s0
    buffer_load_dwordx4 v48, s[20:23], s0 offen lds
    s_lshl_b32 s55, s55, 5
    s_add_u32 s55, s55, s48
    s_lshl_b32 s55, s55, 2
    s_add_u32 s55, s55, 6488064
    s_lshl_b32 s3, s5, 3
    v_add_u32 v14, s3, v9
    v_xor_b32 v14, v14, v6
    v_lshlrev_b32 v14, 4, v14
    v_lshl_add_u32 v14, v10, 8, v14
    buffer_load_dwordx4 v49, s[20:23], s0 offen offset:1024 lds
    s_lshl_b32 s3, s4, 14
    s_add_u32 s3, s3, 131072
    v_add_u32 v80, s3, v14
    v_xor_b32 v81, 32, v80
    v_xor_b32 v82, 64, v80
    v_xor_b32 v83, 96, v80
    s_lshr_b32 s3, s53, 1
    s_add_u32 s66, s3, s54
    v_lshlrev_b32 v14, 1, v6
    v_xor_b32 v14, v14, v5
    v_lshlrev_b32 v14, 4, v14
    v_lshl_add_u32 v14, v5, 8, v14
    s_add_u32 s3, s58, 131072
    v_add_u32 v84, s3, v14
    v_xor_b32 v85, 16, v84
    v_xor_b32 v86, 24576, v84
    buffer_load_dwordx4 v50, s[20:23], s0 offen offset:2048 lds
    v_xor_b32 v87, 24592, v84
    v_lshlrev_b32 v144, 16, v240
    v_and_b32 v145, 0xffff0000, v240
    v_lshlrev_b32 v146, 16, v241
    v_and_b32 v147, 0xffff0000, v241
    v_lshlrev_b32 v148, 16, v242
    v_and_b32 v149, 0xffff0000, v242
    v_lshlrev_b32 v150, 16, v243
    v_and_b32 v151, 0xffff0000, v243
    v_lshlrev_b32 v152, 16, v244
    v_and_b32 v153, 0xffff0000, v244
    v_lshlrev_b32 v154, 16, v245
    v_and_b32 v155, 0xffff0000, v245
    v_lshlrev_b32 v156, 16, v246
    v_and_b32 v157, 0xffff0000, v246
    v_lshlrev_b32 v158, 16, v247
    buffer_load_dwordx4 v51, s[20:23], s0 offen offset:3072 lds
    v_and_b32 v159, 0xffff0000, v247
    s_add_u32 m0, s58, 81920
    s_add_u32 s0, s0, 458752
    s_cmp_eq_u32 s0, 3670016
    s_cselect_b32 s0, 0, s0
    buffer_load_dwordx4 v48, s[20:23], s0 offen lds
    buffer_load_dwordx4 v49, s[20:23], s0 offen offset:1024 lds
    buffer_load_dwordx4 v50, s[20:23], s0 offen offset:2048 lds
    buffer_load_dwordx4 v51, s[20:23], s0 offen offset:3072 lds
    buffer_load_dword v18, v20, s[28:31], 0 offen sc1
    s_add_u32 m0, s58, 98304
    s_add_u32 s0, s0, 458752
    s_cmp_eq_u32 s0, 3670016
    s_cselect_b32 s0, 0, s0
    buffer_load_dwordx4 v48, s[20:23], s0 offen lds
    buffer_load_dwordx4 v49, s[20:23], s0 offen offset:1024 lds
    buffer_load_dwordx4 v50, s[20:23], s0 offen offset:2048 lds
    buffer_load_dwordx4 v51, s[20:23], s0 offen offset:3072 lds
    s_add_u32 m0, s58, 114688
    s_add_u32 s0, s0, 458752
    s_cmp_eq_u32 s0, 3670016
    s_cselect_b32 s0, 0, s0
    buffer_load_dwordx4 v48, s[20:23], s0 offen lds
    buffer_load_dwordx4 v49, s[20:23], s0 offen offset:1024 lds
    buffer_load_dwordx4 v50, s[20:23], s0 offen offset:2048 lds
    buffer_load_dwordx4 v51, s[20:23], s0 offen offset:3072 lds
    s_waitcnt vmcnt(8)
    v_cmp_ne_u32 vcc, s57, v18
    s_cbranch_vccz L_pollok0
    s_mov_b32 s60, 0
L_poll0:
    s_sleep 4
    buffer_load_dword v18, v20, s[28:31], 0 offen sc1
    s_add_u32 s60, s60, 1
    s_waitcnt vmcnt(0)
    v_cmp_ne_u32 vcc, s57, v18
    s_cbranch_vccz L_pollok0
    s_cmp_lt_u32 s60, 20000
    s_cbranch_scc1 L_poll0
L_pollok0:
    s_barrier
    buffer_load_dwordx4 a[0:3], v71, s[28:31], s1 offen offset:0 sc1
    buffer_load_dwordx4 a[4:7], v71, s[28:31], s1 offen offset:1024 sc1
    buffer_load_dwordx4 a[8:11], v71, s[28:31], s1 offen offset:2048 sc1
    buffer_load_dwordx4 a[12:15], v71, s[28:31], s1 offen offset:3072 sc1
    buffer_load_dword v69, v70, s[28:31], 0 offen sc1
    s_add_u32 s1, s1, 8192
    s_and_b32 s1, s1, 0xffff
    buffer_load_dwordx4 a[16:19], v71, s[28:31], s1 offen offset:0 sc1
    buffer_load_dwordx4 a[20:23], v71, s[28:31], s1 offen offset:1024 sc1
    buffer_load_dwordx4 a[24:27], v71, s[28:31], s1 offen offset:2048 sc1
    buffer_load_dwordx4 a[28:31], v71, s[28:31], s1 offen offset:3072 sc1
    s_add_u32 s1, s1, 8192
    s_and_b32 s1, s1, 0xffff
    buffer_load_dwordx4 a[32:35], v71, s[28:31], s1 offen offset:0 sc1
    buffer_load_dwordx4 a[36:39], v71, s[28:31], s1 offen offset:1024 sc1
    buffer_load_dwordx4 a[40:43], v71, s[28:31], s1 offen offset:2048 sc1
    buffer_load_dwordx4 a[44:47], v71, s[28:31], s1 offen offset:3072 sc1
    ds_read_b64_tr_b16 v[112:113], v31 offset:0
    s_add_u32 s1, s1, 8192
    s_and_b32 s1, s1, 0xffff
    buffer_load_dwordx4 a[48:51], v71, s[28:31], s1 offen offset:0 sc1
    ds_read_b64_tr_b16 v[114:115], v31 offset:1024
    ds_read_b64_tr_b16 v[116:117], v32 offset:0
    ds_read_b64_tr_b16 v[118:119], v32 offset:1024
    ds_read_b64_tr_b16 v[120:121], v31 offset:2048
    ds_read_b64_tr_b16 v[122:123], v31 offset:3072
    ds_read_b64_tr_b16 v[124:125], v32 offset:2048
    ds_read_b64_tr_b16 v[126:127], v32 offset:3072
    ds_read_b64_tr_b16 v[128:129], v31 offset:4096
    ds_read_b64_tr_b16 v[130:131], v31 offset:5120
    ds_read_b64_tr_b16 v[132:133], v32 offset:4096
    ds_read_b64_tr_b16 v[134:135], v32 offset:5120
    s_waitcnt vmcnt(13) lgkmcnt(8)
    v_mfma_f32_32x32x16_bf16 v[176:191], v[112:115], a[0:3], 0
    buffer_load_dwordx4 a[52:55], v71, s[28:31], s1 offen offset:1024 sc1
    ds_read_b64_tr_b16 v[136:137], v31 offset:6144
    ds_read_b64_tr_b16 v[138:139], v31 offset:7168
    s_mov_b32 s70, 0xaaaaaaaa
    v_mfma_f32_32x32x16_bf16 v[192:207], v[116:119], a[0:3], 0
    buffer_load_dwordx4 a[56:59], v71, s[28:31], s1 offen offset:2048 sc1
    ds_read_b64_tr_b16 v[140:141], v32 offset:6144
    ds_read_b64_tr_b16 v[142:143], v32 offset:7168
    s_mov_b32 s71, 0xaaaaaaaa
    s_waitcnt vmcnt(14) lgkmcnt(8)
    v_mfma_f32_32x32x16_bf16 v[176:191], v[120:123], a[4:7], v[176:191]
    buffer_load_dwordx4 a[60:63], v71, s[28:31], s1 offen offset:3072 sc1
    ds_read_b64_tr_b16 v[112:113], v31 offset:16384
    ds_read_b64_tr_b16 v[114:115], v31 offset:17408
    s_mov_b32 s72, 0xfff0ffff
    v_mfma_f32_32x32x16_bf16 v[192:207], v[124:127], a[4:7], v[192:207]
    s_add_u32 m0, s58, 131072
    s_add_u32 s0, s0, 458752
    s_cmp_eq_u32 s0, 3670016
    s_cselect_b32 s0, 0, s0
    v_xor_b32 v48, 128, v48
    buffer_load_dwordx4 v48, s[20:23], s0 offen lds
    ds_read_b64_tr_b16 v[116:117], v32 offset:16384
    ds_read_b64_tr_b16 v[118:119], v32 offset:17408
    s_mov_b32 s73, 0xf000ff00
    s_waitcnt vmcnt(15) lgkmcnt(8)
    v_mfma_f32_32x32x16_bf16 v[176:191], v[128:131], a[8:11], v[176:191]
    v_xor_b32 v49, 128, v49
    buffer_load_dwordx4 v49, s[20:23], s0 offen offset:1024 lds
    ds_read_b64_tr_b16 v[120:121], v31 offset:18432
    ds_read_b64_tr_b16 v[122:123], v31 offset:19456
    s_mov_b32 s74, 0xffc0fffc
    v_mfma_f32_32x32x16_bf16 v[192:207], v[132:135], a[8:11], v[192:207]
    v_xor_b32 v50, 128, v50
    buffer_load_dwordx4 v50, s[20:23], s0 offen offset:2048 lds
    ds_read_b64_tr_b16 v[124:125], v32 offset:18432
    ds_read_b64_tr_b16 v[126:127], v32 offset:19456
    s_mov_b32 s75, 0xc000fc00
    s_waitcnt vmcnt(16) lgkmcnt(8)
    v_mfma_f32_32x32x16_bf16 v[176:191], v[136:139], a[12:15], v[176:191]
    v_xor_b32 v51, 128, v51
    buffer_load_dwordx4 v51, s[20:23], s0 offen offset:3072 lds
    ds_read_b64_tr_b16 v[128:129], v31 offset:20480
    ds_read_b64_tr_b16 v[130:131], v31 offset:21504
    s_cmp_eq_u32 s49, 0
    s_cselect_b64 s[76:77], 0, -1
    v_mfma_f32_32x32x16_bf16 v[192:207], v[140:143], a[12:15], v[192:207]
    s_add_u32 s1, s1, 8192
    s_and_b32 s1, s1, 0xffff
    buffer_load_dwordx4 a[64:67], v71, s[28:31], s1 offen offset:0 sc1
    ds_read_b64_tr_b16 v[132:133], v32 offset:20480
    ds_read_b64_tr_b16 v[134:135], v32 offset:21504
    v_mov_b32 v14, 0xffff
    buffer_load_dwordx4 a[68:71], v71, s[28:31], s1 offen offset:1024 sc1
    s_waitcnt vmcnt(17) lgkmcnt(8)
    v_mfma_f32_32x32x16_bf16 v[176:191], v[112:115], a[16:19], v[176:191]
    buffer_load_dwordx4 a[72:75], v71, s[28:31], s1 offen offset:2048 sc1
    ds_read_b64_tr_b16 v[136:137], v31 offset:22528
    ds_read_b64_tr_b16 v[138:139], v31 offset:23552
    v_mov_b32 v15, 0xffff0000
    v_mfma_f32_32x32x16_bf16 v[192:207], v[116:119], a[16:19], v[192:207]
    buffer_load_dwordx4 a[76:79], v71, s[28:31], s1 offen offset:3072 sc1
    ds_read_b64_tr_b16 v[140:141], v32 offset:22528
    ds_read_b64_tr_b16 v[142:143], v32 offset:23552
    v_cndmask_b32 v14, v14, v15, s[70:71]
    s_waitcnt vmcnt(18) lgkmcnt(8)
    v_mfma_f32_32x32x16_bf16 v[176:191], v[120:123], a[20:23], v[176:191]
    s_add_u32 m0, s58, 147456
    s_add_u32 s0, s0, 458752
    s_cmp_eq_u32 s0, 3670016
    s_cselect_b32 s0, 0, s0
    buffer_load_dwordx4 v48, s[20:23], s0 offen lds
    ds_read_b64_tr_b16 v[112:113], v31 offset:32768
    ds_read_b64_tr_b16 v[114:115], v31 offset:33792
    v_cndmask_b32 v98, v14, 0, s[72:73]
    v_mfma_f32_32x32x16_bf16 v[192:207], v[124:127], a[20:23], v[192:207]
    buffer_load_dwordx4 v49, s[20:23], s0 offen offset:1024 lds
    ds_read_b64_tr_b16 v[116:117], v32 offset:32768
    ds_read_b64_tr_b16 v[118:119], v32 offset:33792
    v_cndmask_b32 v100, 0, v14, s[72:73]
    s_waitcnt vmcnt(19) lgkmcnt(8)
    v_mfma_f32_32x32x16_bf16 v[176:191], v[128:131], a[24:27], v[176:191]
    buffer_load_dwordx4 v50, s[20:23], s0 offen offset:2048 lds
    ds_read_b64_tr_b16 v[120:121], v31 offset:34816
    ds_read_b64_tr_b16 v[122:123], v31 offset:35840
    v_cndmask_b32 v99, v14, 0, s[74:75]
    v_mfma_f32_32x32x16_bf16 v[192:207], v[132:135], a[24:27], v[192:207]
    buffer_load_dwordx4 v51, s[20:23], s0 offen offset:3072 lds
    ds_read_b64_tr_b16 v[124:125], v32 offset:34816
    ds_read_b64_tr_b16 v[126:127], v32 offset:35840
    v_cndmask_b32 v101, 0, v14, s[74:75]
    s_waitcnt vmcnt(20) lgkmcnt(8)
    v_mfma_f32_32x32x16_bf16 v[176:191], v[136:139], a[28:31], v[176:191]
    s_add_u32 s1, s1, 8192
    s_and_b32 s1, s1, 0xffff
    buffer_load_dwordx4 a[80:83], v71, s[28:31], s1 offen offset:0 sc1
    ds_read_b64_tr_b16 v[128:129], v31 offset:36864
    ds_read_b64_tr_b16 v[130:131], v31 offset:37888
    v_mov_b32 v77, 0xf149f2ca
    v_mfma_f32_32x32x16_bf16 v[192:207], v[140:143], a[28:31], v[192:207]
    buffer_load_dwordx4 a[84:87], v71, s[28:31], s1 offen offset:1024 sc1
    ds_read_b64_tr_b16 v[132:133], v32 offset:36864
    ds_read_b64_tr_b16 v[134:135], v32 offset:37888
    s_mov_b32 s83, 0x3e8b97f6
    s_waitcnt vmcnt(21) lgkmcnt(8)
    v_mfma_f32_32x32x16_bf16 v[176:191], v[112:115], a[32:35], v[176:191]
    ds_read_b64_tr_b16 v[136:137], v31 offset:38912
    ds_read_b64_tr_b16 v[138:139], v31 offset:39936
    s_mov_b32 s78, 0xbdd2d3e8
    s_mov_b32 s79, 0xbdd2d3e8
    v_mfma_f32_32x32x16_bf16 v[192:207], v[116:119], a[32:35], v[192:207]
    buffer_load_dwordx4 a[88:91], v71, s[28:31], s1 offen offset:2048 sc1
    ds_read_b64_tr_b16 v[140:141], v32 offset:38912
    ds_read_b64_tr_b16 v[142:143], v32 offset:39936
    s_mov_b32 s80, 1.0
    s_mov_b32 s81, 1.0
    s_waitcnt vmcnt(21) lgkmcnt(8)
    v_mfma_f32_32x32x16_bf16 v[176:191], v[120:123], a[36:39], v[176:191]
    buffer_load_dwordx4 a[92:95], v71, s[28:31], s1 offen offset:3072 sc1
    s_barrier
    ds_read_b64_tr_b16 v[112:113], v31 offset:49152
    ds_read_b64_tr_b16 v[114:115], v31 offset:50176
    v_mov_b32 v102, 0xc0135761
    v_mfma_f32_32x32x16_bf16 v[192:207], v[124:127], a[36:39], v[192:207]
    ds_read_b64_tr_b16 v[116:117], v32 offset:49152
    ds_read_b64_tr_b16 v[118:119], v32 offset:50176
    v_mov_b32 v103, 0xc0135761
    s_waitcnt vmcnt(21) lgkmcnt(8)
    v_mfma_f32_32x32x16_bf16 v[176:191], v[128:131], a[40:43], v[176:191]
    s_add_u32 s1, s1, 8192
    s_and_b32 s1, s1, 0xffff
    buffer_load_dwordx4 a[96:99], v71, s[28:31], s1 offen offset:0 sc1
    ds_read_b64_tr_b16 v[120:121], v31 offset:51200
    ds_read_b64_tr_b16 v[122:123], v31 offset:52224
    v_lshlrev_b32 v14, 2, v2
    v_mfma_f32_32x32x16_bf16 v[192:207], v[132:135], a[40:43], v[192:207]
    buffer_load_dwordx4 a[100:103], v71, s[28:31], s1 offen offset:1024 sc1
    ds_read_b64_tr_b16 v[124:125], v32 offset:51200
    ds_read_b64_tr_b16 v[126:127], v32 offset:52224
    v_and_b32 v15, 1, v1
    s_waitcnt vmcnt(22) lgkmcnt(8)
    v_mfma_f32_32x32x16_bf16 v[176:191], v[136:139], a[44:47], v[176:191]
    ds_read_b64_tr_b16 v[128:129], v31 offset:53248
    ds_read_b64_tr_b16 v[130:131], v31 offset:54272
    v_lshl_add_u32 v15, v3, 2, v15
    v_mfma_f32_32x32x16_bf16 v[192:207], v[140:143], a[44:47], v[192:207]
    buffer_load_dwordx4 a[104:107], v71, s[28:31], s1 offen offset:2048 sc1
    ds_read_b64_tr_b16 v[132:133], v32 offset:53248
    ds_read_b64_tr_b16 v[134:135], v32 offset:54272
    v_lshlrev_b32 v15, 2, v15
    s_waitcnt vmcnt(22) lgkmcnt(8)
    v_mfma_f32_32x32x16_bf16 v[176:191], v[112:115], a[48:51], v[176:191]
    buffer_load_dwordx4 a[108:111], v71, s[28:31], s1 offen offset:3072 sc1
    ds_read_b64_tr_b16 v[136:137], v31 offset:55296
    ds_read_b64_tr_b16 v[138:139], v31 offset:56320
    v_add_u32 v16, 64, v15
    v_mfma_f32_32x32x16_bf16 v[192:207], v[116:119], a[48:51], v[192:207]
    ds_read_b64_tr_b16 v[140:141], v32 offset:55296
    ds_read_b64_tr_b16 v[142:143], v32 offset:56320
    v_cndmask_b32 v17, v15, v16, s[72:73]
    s_waitcnt vmcnt(22) lgkmcnt(8)
    v_mfma_f32_32x32x16_bf16 v[176:191], v[120:123], a[52:55], v[176:191]
    s_add_u32 m0, s58, 0
    s_add_u32 s0, s0, 458752
    s_cmp_eq_u32 s0, 3670016
    s_cselect_b32 s0, 0, s0
    buffer_load_dwordx4 v48, s[20:23], s0 offen lds
    ds_read_b64_tr_b16 v[112:113], v33 offset:0
    ds_read_b64_tr_b16 v[114:115], v33 offset:1024
    v_cndmask_b32 v15, v15, v16, s[74:75]
    v_mfma_f32_32x32x16_bf16 v[192:207], v[124:127], a[52:55], v[192:207]
    buffer_load_dwordx4 v49, s[20:23], s0 offen offset:1024 lds
    ds_read_b64_tr_b16 v[116:117], v34 offset:0
    ds_read_b64_tr_b16 v[118:119], v34 offset:1024
    ds_bpermute_b32 v25, v14, v69 offset:64
    s_waitcnt vmcnt(23) lgkmcnt(9)
    v_mfma_f32_32x32x16_bf16 v[176:191], v[128:131], a[56:59], v[176:191]
    ds_read_b64_tr_b16 v[120:121], v33 offset:2048
    ds_read_b64_tr_b16 v[122:123], v33 offset:3072
    ds_bpermute_b32 v27, v17, v69 offset:0
    v_mfma_f32_32x32x16_bf16 v[192:207], v[132:135], a[56:59], v[192:207]
    buffer_load_dwordx4 v50, s[20:23], s0 offen offset:2048 lds
    ds_read_b64_tr_b16 v[124:125], v34 offset:2048
    ds_read_b64_tr_b16 v[126:127], v34 offset:3072
    ds_bpermute_b32 v28, v15, v69 offset:8
    s_waitcnt vmcnt(23) lgkmcnt(11)
    v_mfma_f32_32x32x16_bf16 v[176:191], v[136:139], a[60:63], v[176:191]
    ds_read_b64_tr_b16 v[128:129], v33 offset:4096
    ds_read_b64_tr_b16 v[130:131], v33 offset:5120
    ds_bpermute_b32 v26, v14, v69 offset:128
    v_mfma_f32_32x32x16_bf16 v[192:207], v[140:143], a[60:63], v[192:207]
    buffer_load_dwordx4 v51, s[20:23], s0 offen offset:3072 lds
    ds_read_b64_tr_b16 v[132:133], v34 offset:4096
    ds_read_b64_tr_b16 v[134:135], v34 offset:5120
    ds_bpermute_b32 v29, v17, v69 offset:64
    s_waitcnt vmcnt(19) lgkmcnt(13)
    v_mfma_f32_32x32x16_bf16 v[176:191], v[112:115], a[64:67], v[176:191]
    ds_read_b64_tr_b16 v[136:137], v33 offset:6144
    ds_read_b64_tr_b16 v[138:139], v33 offset:7168
    ds_bpermute_b32 v30, v15, v69 offset:72
    v_mfma_f32_32x32x16_bf16 v[192:207], v[116:119], a[64:67], v[192:207]
    s_add_u32 m0, s58, 16384
    s_add_u32 s0, s0, 458752
    s_cmp_eq_u32 s0, 3670016
    s_cselect_b32 s0, 0, s0
    buffer_load_dwordx4 v48, s[20:23], s0 offen lds
    ds_read_b64_tr_b16 v[140:141], v34 offset:6144
    ds_read_b64_tr_b16 v[142:143], v34 offset:7168
    s_waitcnt vmcnt(19) lgkmcnt(12)
    v_mfma_f32_32x32x16_bf16 v[176:191], v[120:123], a[68:71], v[176:191]
    buffer_load_dwordx4 v49, s[20:23], s0 offen offset:1024 lds
    s_barrier
    ds_read_b64_tr_b16 v[112:113], v33 offset:16384
    ds_read_b64_tr_b16 v[114:115], v33 offset:17408
    v_mfma_f32_32x32x16_bf16 v[192:207], v[124:127], a[68:71], v[192:207]
    ds_read_b64_tr_b16 v[116:117], v34 offset:16384
    ds_read_b64_tr_b16 v[118:119], v34 offset:17408
    s_waitcnt vmcnt(19) lgkmcnt(10)
    v_mfma_f32_32x32x16_bf16 v[176:191], v[128:131], a[72:75], v[176:191]
    buffer_load_dwordx4 v50, s[20:23], s0 offen offset:2048 lds
    ds_read_b64_tr_b16 v[120:121], v33 offset:18432
    ds_read_b64_tr_b16 v[122:123], v33 offset:19456
    v_mfma_f32_32x32x16_bf16 v[192:207], v[132:135], a[72:75], v[192:207]
    ds_read_b64_tr_b16 v[124:125], v34 offset:18432
    ds_read_b64_tr_b16 v[126:127], v34 offset:19456
    s_waitcnt vmcnt(19) lgkmcnt(8)
    v_mfma_f32_32x32x16_bf16 v[176:191], v[136:139], a[76:79], v[176:191]
    buffer_load_dwordx4 v51, s[20:23], s0 offen offset:3072 lds
    ds_read_b64_tr_b16 v[128:129], v33 offset:20480
    ds_read_b64_tr_b16 v[130:131], v33 offset:21504
    v_mfma_f32_32x32x16_bf16 v[192:207], v[140:143], a[76:79], v[192:207]
    ds_read_b64_tr_b16 v[132:133], v34 offset:20480
    ds_read_b64_tr_b16 v[134:135], v34 offset:21504
    v_mul_f32 v25, s83, v25
    s_add_u32 s1, s1, 8192
    s_and_b32 s1, s1, 0xffff
    buffer_load_dwordx4 a[112:115], v71, s[28:31], s1 offen offset:0 sc1
    s_waitcnt vmcnt(16) lgkmcnt(8)
    v_mfma_f32_32x32x16_bf16 v[176:191], v[112:115], a[80:83], v[176:191]
    ds_read_b64_tr_b16 v[136:137], v33 offset:22528
    ds_read_b64_tr_b16 v[138:139], v33 offset:23552
    v_mul_f32 v26, s83, v26
    v_mfma_f32_32x32x16_bf16 v[192:207], v[116:119], a[80:83], v[192:207]
    buffer_load_dwordx4 a[116:119], v71, s[28:31], s1 offen offset:1024 sc1
    ds_read_b64_tr_b16 v[140:141], v34 offset:22528
    ds_read_b64_tr_b16 v[142:143], v34 offset:23552
    s_waitcnt vmcnt(16) lgkmcnt(8)
    v_mfma_f32_32x32x16_bf16 v[176:191], v[120:123], a[84:87], v[176:191]
    s_load_dword s14, s[44:45], s15
    ds_read_b64_tr_b16 v[112:113], v33 offset:32768
    ds_read_b64_tr_b16 v[114:115], v33 offset:33792
    v_mfma_f32_32x32x16_bf16 v[192:207], v[124:127], a[84:87], v[192:207]
    buffer_load_dwordx4 a[120:123], v71, s[28:31], s1 offen offset:2048 sc1
    ds_read_b64_tr_b16 v[116:117], v34 offset:32768
    ds_read_b64_tr_b16 v[118:119], v34 offset:33792
    s_waitcnt vmcnt(16) lgkmcnt(8)
    v_mfma_f32_32x32x16_bf16 v[176:191], v[128:131], a[88:91], v[176:191]
    buffer_load_dwordx4 a[124:127], v71, s[28:31], s1 offen offset:3072 sc1
    ds_read_b64_tr_b16 v[120:121], v33 offset:34816
    ds_read_b64_tr_b16 v[122:123], v33 offset:35840
    v_mfma_f32_32x32x16_bf16 v[192:207], v[132:135], a[88:91], v[192:207]
    ds_read_b64_tr_b16 v[124:125], v34 offset:34816
    ds_read_b64_tr_b16 v[126:127], v34 offset:35840
    s_waitcnt vmcnt(16) lgkmcnt(8)
    v_mfma_f32_32x32x16_bf16 v[176:191], v[136:139], a[92:95], v[176:191]
    s_add_u32 m0, s58, 32768
    s_add_u32 s0, s0, 458752
    s_cmp_eq_u32 s0, 3670016
    s_cselect_b32 s0, 0, s0
    buffer_load_dwordx4 v48, s[20:23], s0 offen lds
    ds_read_b64_tr_b16 v[128:129], v33 offset:36864
    ds_read_b64_tr_b16 v[130:131], v33 offset:37888
    v_mfma_f32_32x32x16_bf16 v[192:207], v[140:143], a[92:95], v[192:207]
    ds_read_b64_tr_b16 v[132:133], v34 offset:36864
    ds_read_b64_tr_b16 v[134:135], v34 offset:37888
    s_waitcnt vmcnt(16) lgkmcnt(8)
    v_mfma_f32_32x32x16_bf16 v[176:191], v[112:115], a[96:99], v[176:191]
    buffer_load_dwordx4 v49, s[20:23], s0 offen offset:1024 lds
    ds_read_b64_tr_b16 v[136:137], v33 offset:38912
    ds_read_b64_tr_b16 v[138:139], v33 offset:39936
    v_mfma_f32_32x32x16_bf16 v[192:207], v[116:119], a[96:99], v[192:207]
    ds_read_b64_tr_b16 v[140:141], v34 offset:38912
    ds_read_b64_tr_b16 v[142:143], v34 offset:39936
    s_waitcnt vmcnt(16) lgkmcnt(8)
    v_mfma_f32_32x32x16_bf16 v[176:191], v[120:123], a[100:103], v[176:191]
    buffer_load_dwordx4 v50, s[20:23], s0 offen offset:2048 lds
    s_waitcnt vmcnt(7)
    s_barrier
    ds_read_b64_tr_b16 v[112:113], v33 offset:49152
    ds_read_b64_tr_b16 v[114:115], v33 offset:50176
    v_mfma_f32_32x32x16_bf16 v[192:207], v[124:127], a[100:103], v[192:207]
    buffer_load_dwordx4 v51, s[20:23], s0 offen offset:3072 lds
    ds_read_b64_tr_b16 v[116:117], v34 offset:49152
    ds_read_b64_tr_b16 v[118:119], v34 offset:50176
    s_waitcnt lgkmcnt(8)
    v_mfma_f32_32x32x16_bf16 v[176:191], v[128:131], a[104:107], v[176:191]
    ds_read_b64_tr_b16 v[120:121], v33 offset:51200
    ds_read_b64_tr_b16 v[122:123], v33 offset:52224
    v_mfma_f32_32x32x16_bf16 v[192:207], v[132:135], a[104:107], v[192:207]
    s_add_u32 m0, s58, 49152
    s_add_u32 s0, s0, 458752
    s_cmp_eq_u32 s0, 3670016
    s_cselect_b32 s0, 0, s0
    buffer_load_dwordx4 v48, s[20:23], s0 offen lds
    ds_read_b64_tr_b16 v[124:125], v34 offset:51200
    ds_read_b64_tr_b16 v[126:127], v34 offset:52224
    s_waitcnt lgkmcnt(8)
    v_mfma_f32_32x32x16_bf16 v[176:191], v[136:139], a[108:111], v[176:191]
    ds_read_b64_tr_b16 v[128:129], v33 offset:53248
    ds_read_b64_tr_b16 v[130:131], v33 offset:54272
    v_mfma_f32_32x32x16_bf16 v[192:207], v[140:143], a[108:111], v[192:207]
    buffer_load_dwordx4 v49, s[20:23], s0 offen offset:1024 lds
    ds_read_b64_tr_b16 v[132:133], v34 offset:53248
    ds_read_b64_tr_b16 v[134:135], v34 offset:54272
    s_waitcnt vmcnt(9) lgkmcnt(8)
    v_mfma_f32_32x32x16_bf16 v[176:191], v[112:115], a[112:115], v[176:191]
    ds_read_b64_tr_b16 v[136:137], v33 offset:55296
    ds_read_b64_tr_b16 v[138:139], v33 offset:56320
    v_mfma_f32_32x32x16_bf16 v[192:207], v[116:119], a[112:115], v[192:207]
    buffer_load_dwordx4 v50, s[20:23], s0 offen offset:2048 lds
    ds_read_b64_tr_b16 v[140:141], v34 offset:55296
    ds_read_b64_tr_b16 v[142:143], v34 offset:56320
    s_waitcnt vmcnt(9) lgkmcnt(8)
    v_mfma_f32_32x32x16_bf16 v[176:191], v[120:123], a[116:119], v[176:191]
    buffer_load_dwordx4 v51, s[20:23], s0 offen offset:3072 lds
    ds_read_b64_tr_b16 v[112:113], v35 offset:0
    ds_read_b64_tr_b16 v[114:115], v35 offset:1024
    v_mfma_f32_32x32x16_bf16 v[192:207], v[124:127], a[116:119], v[192:207]
    ds_read_b64_tr_b16 v[116:117], v36 offset:0
    ds_read_b64_tr_b16 v[118:119], v36 offset:1024
    s_waitcnt vmcnt(9) lgkmcnt(8)
    v_mfma_f32_32x32x16_bf16 v[176:191], v[128:131], a[120:123], v[176:191]
    s_add_u32 m0, s58, 65536
    s_add_u32 s0, s0, 458752
    s_cmp_eq_u32 s0, 3670016
    s_cselect_b32 s0, 0, s0
    buffer_load_dwordx4 v48, s[20:23], s0 offen lds
    ds_read_b64_tr_b16 v[120:121], v35 offset:2048
    ds_read_b64_tr_b16 v[122:123], v35 offset:3072
    v_mfma_f32_32x32x16_bf16 v[192:207], v[132:135], a[120:123], v[192:207]
    ds_read_b64_tr_b16 v[124:125], v36 offset:2048
    ds_read_b64_tr_b16 v[126:127], v36 offset:3072
    s_waitcnt vmcnt(9) lgkmcnt(8)
    v_mfma_f32_32x32x16_bf16 v[176:191], v[136:139], a[124:127], v[176:191]
    buffer_load_dwordx4 v49, s[20:23], s0 offen offset:1024 lds
    ds_read_b64_tr_b16 v[128:129], v35 offset:4096
    ds_read_b64_tr_b16 v[130:131], v35 offset:5120
    v_mfma_f32_32x32x16_bf16 v[192:207], v[140:143], a[124:127], v[192:207]
    ds_read_b64_tr_b16 v[132:133], v36 offset:4096
    ds_read_b64_tr_b16 v[134:135], v36 offset:5120
    s_waitcnt lgkmcnt(8)
    v_mfma_f32_32x32x16_bf16 v[144:159], v[112:115], a[0:3], v[144:159]
    buffer_load_dwordx4 v50, s[20:23], s0 offen offset:2048 lds
    ds_read_b64_tr_b16 v[136:137], v35 offset:6144
    ds_read_b64_tr_b16 v[138:139], v35 offset:7168
    v_mfma_f32_32x32x16_bf16 v[160:175], v[116:119], a[0:3], 0
    buffer_load_dwordx4 v51, s[20:23], s0 offen offset:3072 lds
    ds_read_b64_tr_b16 v[140:141], v36 offset:6144
    ds_read_b64_tr_b16 v[142:143], v36 offset:7168
    v_cvt_pk_bf16_f32 v176, v176, v177
    v_cvt_pk_bf16_f32 v177, v178, v179
    v_cvt_pk_bf16_f32 v178, v180, v181
    v_cvt_pk_bf16_f32 v179, v182, v183
    buffer_store_dwordx4 v[176:179], v23, s[28:31], 0 offen offset:0 sc1
    s_waitcnt lgkmcnt(8)
    v_mfma_f32_32x32x16_bf16 v[144:159], v[120:123], a[4:7], v[144:159]
    s_add_u32 m0, s58, 81920
    s_add_u32 s0, s0, 458752
    s_cmp_eq_u32 s0, 3670016
    s_cselect_b32 s0, 0, s0
    buffer_load_dwordx4 v48, s[20:23], s0 offen lds
    s_waitcnt lgkmcnt(0)
    s_cmp_eq_u32 s14, 14
    s_cbranch_scc1 L_pollok1
    s_mov_b32 s60, 0
L_poll1:
    s_sleep 8
    buffer_load_dword v18, off, s[44:47], s15 sc1
    s_add_u32 s60, s60, 1
    s_waitcnt vmcnt(0)
    v_readfirstlane_b32 s14, v18
    s_nop 0
    s_cmp_eq_u32 s14, 14
    s_cbranch_scc1 L_pollok1
    s_cmp_lt_u32 s60, 20000
    s_cbranch_scc1 L_poll1
L_pollok1:
    s_barrier
    ds_read_b64_tr_b16 v[112:113], v35 offset:16384
    ds_read_b64_tr_b16 v[114:115], v35 offset:17408
    v_cvt_pk_bf16_f32 v184, v184, v185
    v_cvt_pk_bf16_f32 v185, v186, v187
    v_cvt_pk_bf16_f32 v186, v188, v189
    v_cvt_pk_bf16_f32 v187, v190, v191
    buffer_store_dwordx4 v[184:187], v23, s[28:31], 0 offen offset:1024 sc1
    v_mfma_f32_32x32x16_bf16 v[160:175], v[124:127], a[4:7], v[160:175]
    buffer_load_dwordx4 v49, s[20:23], s0 offen offset:1024 lds
    ds_read_b64_tr_b16 v[116:117], v36 offset:16384
    ds_read_b64_tr_b16 v[118:119], v36 offset:17408
    v_cvt_pk_bf16_f32 v192, v192, v193
    v_cvt_pk_bf16_f32 v193, v194, v195
    v_cvt_pk_bf16_f32 v194, v196, v197
    v_cvt_pk_bf16_f32 v195, v198, v199
    buffer_store_dwordx4 v[192:195], v23, s[28:31], 0 offen offset:2048 sc1
    v_mfma_f32_32x32x16_bf16 v[144:159], v[128:131], a[8:11], v[144:159]
    buffer_load_dwordx4 v50, s[20:23], s0 offen offset:2048 lds
    ds_read_b64_tr_b16 v[120:121], v35 offset:18432
    ds_read_b64_tr_b16 v[122:123], v35 offset:19456
    v_cvt_pk_bf16_f32 v200, v200, v201
    v_cvt_pk_bf16_f32 v201, v202, v203
    v_cvt_pk_bf16_f32 v202, v204, v205
    v_cvt_pk_bf16_f32 v203, v206, v207
    buffer_store_dwordx4 v[200:203], v23, s[28:31], 0 offen offset:3072 sc1
    v_mfma_f32_32x32x16_bf16 v[160:175], v[132:135], a[8:11], v[160:175]
    buffer_load_dwordx4 v51, s[20:23], s0 offen offset:3072 lds
    ds_read_b64_tr_b16 v[124:125], v36 offset:18432
    ds_read_b64_tr_b16 v[126:127], v36 offset:19456
    v_mfma_f32_32x32x16_bf16 v[144:159], v[136:139], a[12:15], v[144:159]
    s_add_u32 m0, s59, 98304
    s_nop 0
    buffer_load_dwordx4 v73, s[28:31], s63 offen sc1 lds
    ds_read_b64_tr_b16 v[128:129], v35 offset:20480
    ds_read_b64_tr_b16 v[130:131], v35 offset:21504
    v_mfma_f32_32x32x16_bf16 v[160:175], v[140:143], a[12:15], v[160:175]
    ds_read_b64_tr_b16 v[132:133], v36 offset:20480
    ds_read_b64_tr_b16 v[134:135], v36 offset:21504
    s_waitcnt lgkmcnt(8)
    v_mfma_f32_32x32x16_bf16 v[144:159], v[112:115], a[16:19], v[144:159]
    buffer_load_dwordx4 v73, s[28:31], s63 offen offset:1024 sc1 lds
    ds_read_b64_tr_b16 v[136:137], v35 offset:22528
    ds_read_b64_tr_b16 v[138:139], v35 offset:23552
    v_mfma_f32_32x32x16_bf16 v[160:175], v[116:119], a[16:19], v[160:175]
    ds_read_b64_tr_b16 v[140:141], v36 offset:22528
    ds_read_b64_tr_b16 v[142:143], v36 offset:23552
    s_waitcnt lgkmcnt(8)
    v_mfma_f32_32x32x16_bf16 v[144:159], v[120:123], a[20:23], v[144:159]
    buffer_load_dwordx4 v73, s[28:31], s63 offen offset:2048 sc1 lds
    ds_read_b64_tr_b16 v[112:113], v31 offset:0
    ds_read_b64_tr_b16 v[114:115], v31 offset:1024
    v_mfma_f32_32x32x16_bf16 v[160:175], v[124:127], a[20:23], v[160:175]
    ds_read_b64_tr_b16 v[116:117], v32 offset:0
    ds_read_b64_tr_b16 v[118:119], v32 offset:1024
    s_waitcnt lgkmcnt(8)
    v_mfma_f32_32x32x16_bf16 v[144:159], v[128:131], a[24:27], v[144:159]
    s_add_u32 m0, s100, 126976
    s_nop 0
    buffer_load_dwordx4 v62, s[28:31], s62 offen sc1 lds
    ds_read_b64_tr_b16 v[120:121], v31 offset:2048
    ds_read_b64_tr_b16 v[122:123], v31 offset:3072
    v_mfma_f32_32x32x16_bf16 v[160:175], v[132:135], a[24:27], v[160:175]
    s_add_u32 m0, s58, 110592
    s_nop 0
    buffer_load_dwordx4 v60, s[28:31], s62 offen sc1 lds
    ds_read_b64_tr_b16 v[124:125], v32 offset:2048
    ds_read_b64_tr_b16 v[126:127], v32 offset:3072
    s_waitcnt lgkmcnt(8)
    v_mfma_f32_32x32x16_bf16 v[144:159], v[136:139], a[28:31], v[144:159]
    ds_read_b64_tr_b16 v[128:129], v31 offset:4096
    ds_read_b64_tr_b16 v[130:131], v31 offset:5120
    v_mfma_f32_32x32x16_bf16 v[160:175], v[140:143], a[28:31], v[160:175]
    buffer_load_dwordx4 v60, s[28:31], s62 offen offset:1024 sc1 lds
    ds_read_b64_tr_b16 v[132:133], v32 offset:4096
    ds_read_b64_tr_b16 v[134:135], v32 offset:5120
    s_waitcnt lgkmcnt(8)
    v_mfma_f32_32x32x16_bf16 v[144:159], v[112:115], a[32:35], v[144:159]
    ds_read_b64_tr_b16 v[136:137], v31 offset:6144
    ds_read_b64_tr_b16 v[138:139], v31 offset:7168
    v_mfma_f32_32x32x16_bf16 v[160:175], v[116:119], a[32:35], v[160:175]
    buffer_load_dwordx4 v61, s[28:31], s62 offen offset:2048 sc1 lds
    ds_read_b64_tr_b16 v[140:141], v32 offset:6144
    ds_read_b64_tr_b16 v[142:143], v32 offset:7168
    s_waitcnt lgkmcnt(8)
    v_mfma_f32_32x32x16_bf16 v[144:159], v[120:123], a[36:39], v[144:159]
    s_waitcnt vmcnt(7)
    s_barrier
    s_atomic_add s36, s[28:29], s37
    ds_read_b64_tr_b16 v[112:113], v31 offset:16384
    buffer_load_dwordx4 v61, s[28:31], s62 offen offset:3072 sc1 lds
    ds_read_b64_tr_b16 v[114:115], v31 offset:17408
    v_mfma_f32_32x32x16_bf16 v[160:175], v[124:127], a[36:39], v[160:175]
    ds_read_b64_tr_b16 v[116:117], v32 offset:16384
    ds_read_b64_tr_b16 v[118:119], v32 offset:17408
    s_waitcnt lgkmcnt(8)
    v_mfma_f32_32x32x16_bf16 v[144:159], v[128:131], a[40:43], v[144:159]
    s_add_u32 m0, s59, 131072
    s_add_u32 s63, s63, 12288
    s_cmp_eq_u32 s63, 86016
    s_cselect_b32 s63, 0, s63
    buffer_load_dwordx4 v73, s[28:31], s63 offen sc1 lds
    ds_read_b64_tr_b16 v[120:121], v31 offset:18432
    ds_read_b64_tr_b16 v[122:123], v31 offset:19456
    v_mfma_f32_32x32x16_bf16 v[160:175], v[132:135], a[40:43], v[160:175]
    ds_read_b64_tr_b16 v[124:125], v32 offset:18432
    ds_read_b64_tr_b16 v[126:127], v32 offset:19456
    s_waitcnt lgkmcnt(8)
    v_mfma_f32_32x32x16_bf16 v[144:159], v[136:139], a[44:47], v[144:159]
    buffer_load_dwordx4 v73, s[28:31], s63 offen offset:1024 sc1 lds
    ds_read_b64_tr_b16 v[128:129], v31 offset:20480
    ds_read_b64_tr_b16 v[130:131], v31 offset:21504
    v_mfma_f32_32x32x16_bf16 v[160:175], v[140:143], a[44:47], v[160:175]
    ds_read_b64_tr_b16 v[132:133], v32 offset:20480
    ds_read_b64_tr_b16 v[134:135], v32 offset:21504
    s_waitcnt lgkmcnt(8)
    v_mfma_f32_32x32x16_bf16 v[144:159], v[112:115], a[48:51], v[144:159]
    buffer_load_dwordx4 v73, s[28:31], s63 offen offset:2048 sc1 lds
    ds_read_b64_tr_b16 v[136:137], v31 offset:22528
    ds_read_b64_tr_b16 v[138:139], v31 offset:23552
    v_mfma_f32_32x32x16_bf16 v[160:175], v[116:119], a[48:51], v[160:175]
    s_add_u32 m0, s100, 159744
    s_add_u32 s62, s62, 262144
    s_cmp_eq_u32 s62, 1835008
    s_cselect_b32 s62, 0, s62
    buffer_load_dwordx4 v62, s[28:31], s62 offen sc1 lds
    ds_read_b64_tr_b16 v[140:141], v32 offset:22528
    ds_read_b64_tr_b16 v[142:143], v32 offset:23552
    s_waitcnt lgkmcnt(8)
    v_mfma_f32_32x32x16_bf16 v[144:159], v[120:123], a[52:55], v[144:159]
    ds_read_b64_tr_b16 v[112:113], v31 offset:32768
    ds_read_b64_tr_b16 v[114:115], v31 offset:33792
    v_mfma_f32_32x32x16_bf16 v[160:175], v[124:127], a[52:55], v[160:175]
    s_add_u32 m0, s58, 143360
    s_nop 0
    buffer_load_dwordx4 v60, s[28:31], s62 offen sc1 lds
    ds_read_b64_tr_b16 v[116:117], v32 offset:32768
    ds_read_b64_tr_b16 v[118:119], v32 offset:33792
    s_waitcnt lgkmcnt(8)
    v_mfma_f32_32x32x16_bf16 v[144:159], v[128:131], a[56:59], v[144:159]
    ds_read_b64_tr_b16 v[120:121], v31 offset:34816
    ds_read_b64_tr_b16 v[122:123], v31 offset:35840
    v_mfma_f32_32x32x16_bf16 v[160:175], v[132:135], a[56:59], v[160:175]
    buffer_load_dwordx4 v60, s[28:31], s62 offen offset:1024 sc1 lds
    ds_read_b64_tr_b16 v[124:125], v32 offset:34816
    ds_read_b64_tr_b16 v[126:127], v32 offset:35840
    s_waitcnt lgkmcnt(8)
    v_mfma_f32_32x32x16_bf16 v[144:159], v[136:139], a[60:63], v[144:159]
    ds_read_b64_tr_b16 v[128:129], v31 offset:36864
    ds_read_b64_tr_b16 v[130:131], v31 offset:37888
    v_mfma_f32_32x32x16_bf16 v[160:175], v[140:143], a[60:63], v[160:175]
    buffer_load_dwordx4 v61, s[28:31], s62 offen offset:2048 sc1 lds
    ds_read_b64_tr_b16 v[132:133], v32 offset:36864
    ds_read_b64_tr_b16 v[134:135], v32 offset:37888
    s_waitcnt lgkmcnt(8)
    v_mfma_f32_32x32x16_bf16 v[144:159], v[112:115], a[64:67], v[144:159]
    buffer_load_dwordx4 v61, s[28:31], s62 offen offset:3072 sc1 lds
    ds_read_b64_tr_b16 v[136:137], v31 offset:38912
    ds_read_b64_tr_b16 v[138:139], v31 offset:39936
    v_mfma_f32_32x32x16_bf16 v[160:175], v[116:119], a[64:67], v[160:175]
    ds_read_b64_tr_b16 v[140:141], v32 offset:38912
    ds_read_b64_tr_b16 v[142:143], v32 offset:39936
    s_waitcnt lgkmcnt(8)
    v_mfma_f32_32x32x16_bf16 v[144:159], v[120:123], a[68:71], v[144:159]
    s_barrier
    s_xor_b32 s37, s37, 1024
    s_load_dword s14, s[28:29], s37
    ds_read_b64_tr_b16 v[112:113], v31 offset:49152
    s_add_u32 m0, s59, 0
    s_add_u32 s63, s63, 12288
    s_cmp_eq_u32 s63, 86016
    s_cselect_b32 s63, 0, s63
    buffer_load_dwordx4 v73, s[28:31], s63 offen sc1 lds
    ds_read_b64_tr_b16 v[114:115], v31 offset:50176
    v_mfma_f32_32x32x16_bf16 v[160:175], v[124:127], a[68:71], v[160:175]
    buffer_load_dwordx4 v73, s[28:31], s63 offen offset:1024 sc1 lds
    ds_read_b64_tr_b16 v[116:117], v32 offset:49152
    ds_read_b64_tr_b16 v[118:119], v32 offset:50176
    s_waitcnt lgkmcnt(8)
    v_mfma_f32_32x32x16_bf16 v[144:159], v[128:131], a[72:75], v[144:159]
    ds_read_b64_tr_b16 v[120:121], v31 offset:51200
    ds_read_b64_tr_b16 v[122:123], v31 offset:52224
    v_mfma_f32_32x32x16_bf16 v[160:175], v[132:135], a[72:75], v[160:175]
    buffer_load_dwordx4 v73, s[28:31], s63 offen offset:2048 sc1 lds
    ds_read_b64_tr_b16 v[124:125], v32 offset:51200
    ds_read_b64_tr_b16 v[126:127], v32 offset:52224
    s_waitcnt lgkmcnt(8)
    v_mfma_f32_32x32x16_bf16 v[144:159], v[136:139], a[76:79], v[144:159]
    ds_read_b64_tr_b16 v[128:129], v31 offset:53248
    ds_read_b64_tr_b16 v[130:131], v31 offset:54272
    v_mfma_f32_32x32x16_bf16 v[160:175], v[140:143], a[76:79], v[160:175]
    s_add_u32 m0, s100, 28672
    s_add_u32 s62, s62, 262144
    s_cmp_eq_u32 s62, 1835008
    s_cselect_b32 s62, 0, s62
    buffer_load_dwordx4 v62, s[28:31], s62 offen sc1 lds
    ds_read_b64_tr_b16 v[132:133], v32 offset:53248
    ds_read_b64_tr_b16 v[134:135], v32 offset:54272
    s_waitcnt lgkmcnt(8)
    v_mfma_f32_32x32x16_bf16 v[144:159], v[112:115], a[80:83], v[144:159]
    ds_read_b64_tr_b16 v[136:137], v31 offset:55296
    ds_read_b64_tr_b16 v[138:139], v31 offset:56320
    v_mfma_f32_32x32x16_bf16 v[160:175], v[116:119], a[80:83], v[160:175]
    s_add_u32 m0, s58, 12288
    s_nop 0
    buffer_load_dwordx4 v60, s[28:31], s62 offen sc1 lds
    ds_read_b64_tr_b16 v[140:141], v32 offset:55296
    ds_read_b64_tr_b16 v[142:143], v32 offset:56320
    s_waitcnt lgkmcnt(8)
    v_mfma_f32_32x32x16_bf16 v[144:159], v[120:123], a[84:87], v[144:159]
    buffer_load_dwordx4 v60, s[28:31], s62 offen offset:1024 sc1 lds
    s_barrier
    ds_read_b64_tr_b16 v[112:113], v33 offset:0
    ds_read_b64_tr_b16 v[114:115], v33 offset:1024
    v_mfma_f32_32x32x16_bf16 v[160:175], v[124:127], a[84:87], v[160:175]
    ds_read_b64_tr_b16 v[116:117], v34 offset:0
    ds_read_b64_tr_b16 v[118:119], v34 offset:1024
    s_waitcnt lgkmcnt(8)
    v_mfma_f32_32x32x16_bf16 v[144:159], v[128:131], a[88:91], v[144:159]
    buffer_load_dwordx4 v61, s[28:31], s62 offen offset:2048 sc1 lds
    ds_read_b64_tr_b16 v[120:121], v33 offset:2048
    ds_read_b64_tr_b16 v[122:123], v33 offset:3072
    v_mfma_f32_32x32x16_bf16 v[160:175], v[132:135], a[88:91], v[160:175]
    ds_read_b64_tr_b16 v[124:125], v34 offset:2048
    ds_read_b64_tr_b16 v[126:127], v34 offset:3072
    s_waitcnt lgkmcnt(8)
    v_mfma_f32_32x32x16_bf16 v[144:159], v[136:139], a[92:95], v[144:159]
    buffer_load_dwordx4 v61, s[28:31], s62 offen offset:3072 sc1 lds
    ds_read_b64_tr_b16 v[128:129], v33 offset:4096
    ds_read_b64_tr_b16 v[130:131], v33 offset:5120
    v_mfma_f32_32x32x16_bf16 v[160:175], v[140:143], a[92:95], v[160:175]
    ds_read_b64_tr_b16 v[132:133], v34 offset:4096
    ds_read_b64_tr_b16 v[134:135], v34 offset:5120
    s_waitcnt lgkmcnt(8)
    v_mfma_f32_32x32x16_bf16 v[144:159], v[112:115], a[96:99], v[144:159]
    ds_read_b64_tr_b16 v[136:137], v33 offset:6144
    ds_read_b64_tr_b16 v[138:139], v33 offset:7168
    v_mfma_f32_32x32x16_bf16 v[160:175], v[116:119], a[96:99], v[160:175]
    ds_read_b64_tr_b16 v[140:141], v34 offset:6144
    ds_read_b64_tr_b16 v[142:143], v34 offset:7168
    s_waitcnt lgkmcnt(8)
    v_mfma_f32_32x32x16_bf16 v[144:159], v[120:123], a[100:103], v[144:159]
    s_waitcnt lgkmcnt(0)
    s_cmp_eq_u32 s14, 2
    s_cbranch_scc1 L_pollok2
    s_mov_b32 s60, 0
L_poll2:
    s_sleep 4
    buffer_load_dword v18, off, s[28:31], s37 sc1
    s_add_u32 s60, s60, 1
    s_waitcnt vmcnt(0)
    v_readfirstlane_b32 s14, v18
    s_nop 0
    s_cmp_eq_u32 s14, 2
    s_cbranch_scc1 L_pollok2
    s_cmp_lt_u32 s60, 20000
    s_cbranch_scc1 L_poll2
L_pollok2:
    v_xor_b32 v23, 131072, v23
    v_xor_b32 v22, 8192, v23
    ds_read_b64_tr_b16 v[112:113], v33 offset:16384
    buffer_load_dwordx4 v[208:211], v23, s[28:31], 0 offen offset:0 sc1
    ds_read_b64_tr_b16 v[114:115], v33 offset:17408
    v_mfma_f32_32x32x16_bf16 v[160:175], v[124:127], a[100:103], v[160:175]
    buffer_load_dwordx4 v[212:215], v23, s[28:31], 0 offen offset:1024 sc1
    ds_read_b64_tr_b16 v[116:117], v34 offset:16384
    ds_read_b64_tr_b16 v[118:119], v34 offset:17408
    v_mfma_f32_32x32x16_bf16 v[144:159], v[128:131], a[104:107], v[144:159]
    buffer_load_dwordx4 v[216:219], v22, s[28:31], 0 offen offset:2048 sc1
    ds_read_b64_tr_b16 v[120:121], v33 offset:18432
    ds_read_b64_tr_b16 v[122:123], v33 offset:19456
    v_mfma_f32_32x32x16_bf16 v[160:175], v[132:135], a[104:107], v[160:175]
    buffer_load_dwordx4 v[220:223], v22, s[28:31], 0 offen offset:3072 sc1
    ds_read_b64_tr_b16 v[124:125], v34 offset:18432
    ds_read_b64_tr_b16 v[126:127], v34 offset:19456
    v_mfma_f32_32x32x16_bf16 v[144:159], v[136:139], a[108:111], v[144:159]
    ds_read_b64_tr_b16 v[128:129], v33 offset:20480
    ds_read_b64_tr_b16 v[130:131], v33 offset:21504
    v_mfma_f32_32x32x16_bf16 v[160:175], v[140:143], a[108:111], v[160:175]
    ds_read_b64_tr_b16 v[132:133], v34 offset:20480
    ds_read_b64_tr_b16 v[134:135], v34 offset:21504
    s_waitcnt lgkmcnt(8)
    v_mfma_f32_32x32x16_bf16 v[144:159], v[112:115], a[112:115], v[144:159]
    ds_read_b64_tr_b16 v[136:137], v33 offset:22528
    ds_read_b64_tr_b16 v[138:139], v33 offset:23552
    v_mfma_f32_32x32x16_bf16 v[160:175], v[116:119], a[112:115], v[160:175]
    ds_read_b64_tr_b16 v[140:141], v34 offset:22528
    ds_read_b64_tr_b16 v[142:143], v34 offset:23552
    s_waitcnt lgkmcnt(8)
    v_mfma_f32_32x32x16_bf16 v[144:159], v[120:123], a[116:119], v[144:159]
    v_mfma_f32_32x32x16_bf16 v[160:175], v[124:127], a[116:119], v[160:175]
    s_waitcnt lgkmcnt(4)
    v_mfma_f32_32x32x16_bf16 v[144:159], v[128:131], a[120:123], v[144:159]
    v_mfma_f32_32x32x16_bf16 v[160:175], v[132:135], a[120:123], v[160:175]
    s_waitcnt lgkmcnt(0)
    v_mfma_f32_32x32x16_bf16 v[144:159], v[136:139], a[124:127], v[144:159]
    v_mfma_f32_32x32x16_bf16 v[160:175], v[140:143], a[124:127], v[160:175]
    s_nop 11
    ds_write_b128 v74, v[160:163] offset:32768
    ds_write_b128 v74, v[164:167] offset:33792
    ds_write_b128 v74, v[168:171] offset:34816
    ds_write_b128 v74, v[172:175] offset:35840
    s_waitcnt vmcnt(3)
    v_lshlrev_b32 v192, 16, v208
    v_and_b32 v193, 0xffff0000, v208
    v_pk_add_f32 v[144:145], v[144:145], v[192:193]
    v_lshlrev_b32 v194, 16, v209
    v_and_b32 v195, 0xffff0000, v209
    v_pk_add_f32 v[146:147], v[146:147], v[194:195]
    v_lshlrev_b32 v196, 16, v210
    v_and_b32 v197, 0xffff0000, v210
    v_pk_add_f32 v[148:149], v[148:149], v[196:197]
    v_lshlrev_b32 v198, 16, v211
    v_and_b32 v199, 0xffff0000, v211
    v_pk_add_f32 v[150:151], v[150:151], v[198:199]
    s_waitcnt vmcnt(2)
    v_lshlrev_b32 v192, 16, v212
    v_and_b32 v193, 0xffff0000, v212
    v_pk_add_f32 v[152:153], v[152:153], v[192:193]
    v_lshlrev_b32 v194, 16, v213
    v_and_b32 v195, 0xffff0000, v213
    v_pk_add_f32 v[154:155], v[154:155], v[194:195]
    v_lshlrev_b32 v196, 16, v214
    v_and_b32 v197, 0xffff0000, v214
    v_pk_add_f32 v[156:157], v[156:157], v[196:197]
    v_lshlrev_b32 v198, 16, v215
    v_and_b32 v199, 0xffff0000, v215
    v_pk_add_f32 v[158:159], v[158:159], v[198:199]
    s_waitcnt vmcnt(1)
    v_lshlrev_b32 v192, 16, v216
    v_and_b32 v193, 0xffff0000, v216
    v_pk_add_f32 v[144:145], v[144:145], v[192:193]
    v_lshlrev_b32 v194, 16, v217
    v_and_b32 v195, 0xffff0000, v217
    v_pk_add_f32 v[146:147], v[146:147], v[194:195]
    v_lshlrev_b32 v196, 16, v218
    v_and_b32 v197, 0xffff0000, v218
    v_pk_add_f32 v[148:149], v[148:149], v[196:197]
    v_lshlrev_b32 v198, 16, v219
    v_and_b32 v199, 0xffff0000, v219
    v_pk_add_f32 v[150:151], v[150:151], v[198:199]
    v_xor_b32 v74, 8192, v74
    s_waitcnt lgkmcnt(0)
    s_barrier
    ds_read_b128 v[176:179], v74 offset:32768
    s_add_u32 m0, s59, 65536
    s_add_u32 s63, s63, 12288
    s_cmp_eq_u32 s63, 86016
    s_cselect_b32 s63, 0, s63
    buffer_load_dwordx4 v73, s[28:31], s63 offen sc1 lds
    ds_read_b128 v[180:183], v74 offset:33792
    ds_read_b128 v[184:187], v74 offset:34816
    ds_read_b128 v[188:191], v74 offset:35840
    s_waitcnt vmcnt(1)
    v_lshlrev_b32 v192, 16, v220
    v_and_b32 v193, 0xffff0000, v220
    v_pk_add_f32 v[152:153], v[152:153], v[192:193]
    v_lshlrev_b32 v194, 16, v221
    buffer_load_dwordx4 v73, s[28:31], s63 offen offset:1024 sc1 lds
    v_and_b32 v195, 0xffff0000, v221
    v_pk_add_f32 v[154:155], v[154:155], v[194:195]
    v_lshlrev_b32 v196, 16, v222
    v_and_b32 v197, 0xffff0000, v222
    v_pk_add_f32 v[156:157], v[156:157], v[196:197]
    v_lshlrev_b32 v198, 16, v223
    v_and_b32 v199, 0xffff0000, v223
    v_pk_add_f32 v[158:159], v[158:159], v[198:199]
    s_waitcnt lgkmcnt(3)
    v_pk_add_f32 v[144:145], v[144:145], v[176:177]
    v_pk_add_f32 v[146:147], v[146:147], v[178:179]
    s_waitcnt lgkmcnt(2)
    v_pk_add_f32 v[148:149], v[148:149], v[180:181]
    v_pk_add_f32 v[150:151], v[150:151], v[182:183]
    v_pk_mul_f32 v[176:177], v[144:145], v[144:145]
    v_pk_mul_f32 v[178:179], v[146:147], v[146:147]
    buffer_load_dwordx4 v73, s[28:31], s63 offen offset:2048 sc1 lds
    v_pk_mul_f32 v[180:181], v[148:149], v[148:149]
    v_pk_mul_f32 v[182:183], v[150:151], v[150:151]
    v_pk_fma_f32 v[176:177], v[176:177], s[78:79], v[102:103]
    v_pk_fma_f32 v[178:179], v[178:179], s[78:79], v[102:103]
    v_pk_fma_f32 v[180:181], v[180:181], s[78:79], v[102:103]
    v_pk_fma_f32 v[182:183], v[182:183], s[78:79], v[102:103]
    v_pk_mul_f32 v[176:177], v[176:177], v[144:145]
    v_pk_mul_f32 v[178:179], v[178:179], v[146:147]
    v_pk_mul_f32 v[180:181], v[180:181], v[148:149]
    v_pk_mul_f32 v[182:183], v[182:183], v[150:151]
    v_exp_f32 v176, v176
    v_exp_f32 v177, v177
    s_add_u32 m0, s100, 94208
    s_add_u32 s62, s62, 262144
    s_cmp_eq_u32 s62, 1835008
    s_cselect_b32 s62, 0, s62
    buffer_load_dwordx4 v62, s[28:31], s62 offen sc1 lds
    v_exp_f32 v178, v178
    v_exp_f32 v179, v179
    v_exp_f32 v180, v180
    v_exp_f32 v181, v181
    v_exp_f32 v182, v182
    v_exp_f32 v183, v183
    v_pk_add_f32 v[176:177], v[176:177], s[80:81]
    v_pk_add_f32 v[178:179], v[178:179], s[80:81]
    s_add_u32 m0, s58, 77824
    s_nop 0
    buffer_load_dwordx4 v60, s[28:31], s62 offen sc1 lds
    v_pk_add_f32 v[180:181], v[180:181], s[80:81]
    v_pk_add_f32 v[182:183], v[182:183], s[80:81]
    v_rcp_f32 v176, v176
    v_rcp_f32 v177, v177
    v_rcp_f32 v178, v178
    v_rcp_f32 v179, v179
    v_rcp_f32 v180, v180
    v_rcp_f32 v181, v181
    buffer_load_dwordx4 v60, s[28:31], s62 offen offset:1024 sc1 lds
    v_rcp_f32 v182, v182
    v_rcp_f32 v183, v183
    v_pk_mul_f32 v[176:177], v[176:177], v[144:145]
    v_pk_mul_f32 v[178:179], v[178:179], v[146:147]
    v_pk_mul_f32 v[180:181], v[180:181], v[148:149]
    v_pk_mul_f32 v[182:183], v[182:183], v[150:151]
    v_cvt_pk_bf16_f32 v104, v176, v177
    v_cvt_pk_bf16_f32 v105, v178, v179
    v_cvt_pk_bf16_f32 v106, v180, v181
    v_cvt_pk_bf16_f32 v107, v182, v183
    s_waitcnt lgkmcnt(1)
    v_pk_add_f32 v[152:153], v[152:153], v[184:185]
    v_pk_add_f32 v[154:155], v[154:155], v[186:187]
    buffer_load_dwordx4 v61, s[28:31], s62 offen offset:2048 sc1 lds
    s_waitcnt lgkmcnt(0)
    v_pk_add_f32 v[156:157], v[156:157], v[188:189]
    v_pk_add_f32 v[158:159], v[158:159], v[190:191]
    v_pk_mul_f32 v[184:185], v[152:153], v[152:153]
    v_pk_mul_f32 v[186:187], v[154:155], v[154:155]
    v_pk_mul_f32 v[188:189], v[156:157], v[156:157]
    v_pk_mul_f32 v[190:191], v[158:159], v[158:159]
    v_pk_fma_f32 v[184:185], v[184:185], s[78:79], v[102:103]
    v_pk_fma_f32 v[186:187], v[186:187], s[78:79], v[102:103]
    v_pk_fma_f32 v[188:189], v[188:189], s[78:79], v[102:103]
    v_pk_fma_f32 v[190:191], v[190:191], s[78:79], v[102:103]
    v_pk_mul_f32 v[184:185], v[184:185], v[152:153]
    v_pk_mul_f32 v[186:187], v[186:187], v[154:155]
    v_pk_mul_f32 v[188:189], v[188:189], v[156:157]
    v_pk_mul_f32 v[190:191], v[190:191], v[158:159]
    buffer_load_dwordx4 v61, s[28:31], s62 offen offset:3072 sc1 lds
    v_exp_f32 v184, v184
    v_exp_f32 v185, v185
    v_exp_f32 v186, v186
    v_exp_f32 v187, v187
    v_exp_f32 v188, v188
    v_exp_f32 v189, v189
    v_exp_f32 v190, v190
    v_exp_f32 v191, v191
    v_pk_add_f32 v[184:185], v[184:185], s[80:81]
    v_pk_add_f32 v[186:187], v[186:187], s[80:81]
    v_pk_add_f32 v[188:189], v[188:189], s[80:81]
    v_pk_add_f32 v[190:191], v[190:191], s[80:81]
    v_rcp_f32 v184, v184
    v_rcp_f32 v185, v185
    v_rcp_f32 v186, v186
    v_rcp_f32 v187, v187
    v_rcp_f32 v188, v188
    v_rcp_f32 v189, v189
    v_rcp_f32 v190, v190
    v_rcp_f32 v191, v191
    v_pk_mul_f32 v[184:185], v[184:185], v[152:153]
    v_pk_mul_f32 v[186:187], v[186:187], v[154:155]
    v_pk_mul_f32 v[188:189], v[188:189], v[156:157]
    v_pk_mul_f32 v[190:191], v[190:191], v[158:159]
    v_cvt_pk_bf16_f32 v108, v184, v185
    v_cvt_pk_bf16_f32 v109, v186, v187
    v_cvt_pk_bf16_f32 v110, v188, v189
    v_cvt_pk_bf16_f32 v111, v190, v191
    buffer_store_dwordx4 v[104:107], v4, s[28:31], s67 offen offset:0 sc1
    buffer_store_dwordx4 v[108:111], v4, s[28:31], s67 offen offset:1024 sc1
    s_branch L_q
L_nog1:
    s_nop 1
    s_mov_b32 s14, 1204224
    s_mov_b32 s15, 0x20000
    s_sub_u32 s3, s2, 200
    s_cmp_lt_u32 s3, 42
    s_cselect_b32 s81, 0, 268435456
    s_cselect_b32 s3, s3, 0
    s_mul_i32 s79, s3, 43
    s_lshr_b32 s79, s79, 7
    s_mul_i32 s80, s79, 3
    s_sub_u32 s80, s3, s80
    v_min_u32 v14, 55, v1
    s_lshl_b32 s3, s79, 2
    s_add_u32 s3, s3, s48
    s_mul_i32 s3, s3, 21504
    s_mul_i32 s60, s80, 896
    s_add_u32 s3, s3, s60
    s_add_u32 s3, s3, s81
    v_lshl_add_u32 v236, v14, 4, s3
    s_mul_i32 s60, s48, 8448
    s_add_u32 m0, s60, 0
    s_mov_b32 s3, 0
    buffer_load_dwordx4 v236, s[12:15], s3 offen lds
    s_add_u32 m0, s60, 1056
    s_mov_b32 s3, 2688
    buffer_load_dwordx4 v236, s[12:15], s3 offen lds
    s_add_u32 m0, s60, 2112
    s_mov_b32 s3, 5376
    buffer_load_dwordx4 v236, s[12:15], s3 offen lds
    s_add_u32 m0, s60, 3168
    s_mov_b32 s3, 8064
    buffer_load_dwordx4 v236, s[12:15], s3 offen lds
    s_add_u32 m0, s60, 4224
    s_mov_b32 s3, 10752
    buffer_load_dwordx4 v236, s[12:15], s3 offen lds
    s_add_u32 m0, s60, 5280
    s_mov_b32 s3, 13440
    buffer_load_dwordx4 v236, s[12:15], s3 offen lds
    s_add_u32 m0, s60, 6336
    s_mov_b32 s3, 16128
    buffer_load_dwordx4 v236, s[12:15], s3 offen lds
    s_add_u32 m0, s60, 7392
    s_mov_b32 s3, 18816
    buffer_load_dwordx4 v236, s[12:15], s3 offen lds
    s_mul_i32 s53, s101, 37
    s_lshr_b32 s53, s53, 8
    s_mul_i32 s54, s53, 7
    s_sub_u32 s54, s101, s54
    s_and_b32 s53, s53, 3
    s_lshl_b32 s3, s6, 2
    s_add_u32 s53, s53, s3
    s_lshl_b32 s53, s53, 1
    s_add_u32 s53, s53, s7
    s_mov_b32 s42, 4096
    s_mov_b32 s43, 0x20000
    s_lshl_b32 s3, s53, 2
    s_add_u32 s3, s3, s48
    s_lshl_b32 s60, s3, 5
    v_lshl_add_u32 v75, v5, 1, s60
    s_mul_i32 s3, s3, 14336
    s_lshl_b32 s60, s54, 7
    s_add_u32 s3, s3, s60
    v_mul_u32_u24 v15, 896, v5
    v_lshl_add_u32 v15, v6, 4, v15
    v_add_u32 v78, s3, v15
    v_add_u32 v79, 7168, v78
    s_cmp_lt_u32 s101, 28
    s_cselect_b32 s56, 1, 0
    s_lshl_b32 s50, s7, 3
    s_and_b32 s3, s101, 7
    s_add_u32 s50, s50, s3
    s_lshr_b32 s60, s101, 3
    s_lshl_b32 s49, s6, 2
    s_add_u32 s49, s49, s60
    s_lshl_b32 s49, s49, 2
    s_add_u32 s49, s49, s48
    s_mul_i32 s60, s60, 0
    s_add_u32 s3, s3, s60
    s_sub_u32 s60, s3, 7
    s_cmp_ge_u32 s3, 7
    s_cselect_b32 s3, s60, s3
    s_lshl_b32 s62, s3, 18
    s_mul_i32 s63, s3, 12288
    s_mov_b32 s30, 20971520
    s_mov_b32 s31, 0x20000
    s_mov_b32 s75, 0x3727c5ac
    s_mov_b32 s76, 0x3b124925
    s_mov_b32 s77, 0x3f803f80
    v_lshlrev_b32 v4, 4, v1
    v_bfe_u32 v7, v1, 2, 2
    v_and_b32 v8, 3, v1
    v_mul_u32_u24 v14, 960, v9
    v_lshl_add_u32 v14, v10, 4, v14
    s_mul_i32 s3, s48, 1920
    s_add_u32 s3, s3, 147456
    v_add_u32 v224, s3, v14
    v_mul_u32_u24 v14, 960, v7
    v_lshl_add_u32 v14, v3, 5, v14
    v_lshl_add_u32 v14, v8, 3, v14
    s_lshl_b32 s3, s48, 8
    s_add_u32 s3, s3, 147456
    v_add_u32 v225, s3, v14
    s_lshl_b32 s3, s48, 3
    s_add_u32 s3, s3, 155648
    v_lshl_add_u32 v226, v9, 2, s3
    v_lshlrev_b32 v231, 2, v6
    v_and_b32 v2, 15, v1
    v_lshlrev_b32 v232, 14, v3
    v_add_lshl_u32 v232, v232, v2, 2
    v_add_u32 v231, 155648, v231
    v_lshlrev_b32 v14, 17, v9
    v_lshl_add_u32 v227, v10, 4, v14
    s_cmp_eq_u32 s48, 3
    s_cselect_b32 s60, 268435456, 0
    s_lshl_b32 s70, s48, 10
    s_add_u32 s70, s70, s2
    s_lshl_b32 s70, s70, 9
    s_add_u32 s71, s70, 262144
    s_add_u32 s71, s71, s60
    s_xor_b32 s60, s60, 268435456
    s_lshl_b32 s72, s2, 7
    s_add_u32 s72, s72, s60
    s_add_u32 s72, s72, 6291456
    s_lshr_b32 s74, s2, 2
    s_lshl_b32 s74, s74, 5
    s_and_b32 s3, s2, 3
    s_add_u32 s74, s74, s3
    s_lshl_b32 s74, s74, 2
    s_add_u32 s74, s74, 10485760
    v_cmp_gt_u32 vcc, 8, v0
    v_lshlrev_b32 v230, 13, v0
    v_mov_b32 v14, 268435456
    s_and_b32 s3, s2, 7
    s_lshl_b32 s3, s3, 13
    s_add_u32 s3, s3, 10485760
    v_lshrrev_b32 v15, 2, v0
    v_lshl_add_u32 v15, v15, 7, s3
    v_lshl_add_u32 v20, v8, 2, v15
    v_cndmask_b32 v230, v14, v230, vcc
    v_mov_b32 v17, 0
    s_lshl_b32 s3, s48, 14
    s_add_u32 s74, s74, s3
    s_add_u32 s73, s74, 8192
    s_waitcnt vmcnt(10)
    v_dot2_f32_bf16 v220, v176, s77, 0
    v_dot2_f32_bf16 v221, v176, v176, 0
    v_dot2_f32_bf16 v220, v177, s77, v220
    v_dot2_f32_bf16 v221, v177, v177, v221
    v_dot2_f32_bf16 v220, v178, s77, v220
    v_dot2_f32_bf16 v221, v178, v178, v221
    v_dot2_f32_bf16 v220, v179, s77, v220
    v_dot2_f32_bf16 v221, v179, v179, v221
    s_waitcnt vmcnt(9)
    v_dot2_f32_bf16 v220, v180, s77, v220
    v_dot2_f32_bf16 v221, v180, v180, v221
    v_dot2_f32_bf16 v220, v181, s77, v220
    v_dot2_f32_bf16 v221, v181, v181, v221
    v_dot2_f32_bf16 v220, v182, s77, v220
    v_dot2_f32_bf16 v221, v182, v182, v221
    v_dot2_f32_bf16 v220, v183, s77, v220
    v_dot2_f32_bf16 v221, v183, v183, v221
    buffer_load_dword v12, v17, s[44:47], 0 offen sc1
    v_lshlrev_b32 v184, 16, v176
    v_and_b32 v185, 0xffff0000, v176
    v_add_f32_dpp v220, v220, v220 quad_perm:[1,0,3,2] row_mask:0xf bank_mask:0xf
    v_add_f32_dpp v221, v221, v221 quad_perm:[1,0,3,2] row_mask:0xf bank_mask:0xf
    v_lshlrev_b32 v186, 16, v177
    v_add_f32_dpp v220, v220, v220 quad_perm:[2,3,0,1] row_mask:0xf bank_mask:0xf
    v_add_f32_dpp v221, v221, v221 quad_perm:[2,3,0,1] row_mask:0xf bank_mask:0xf
    v_and_b32 v187, 0xffff0000, v177
    v_add_f32_dpp v220, v220, v220 row_half_mirror row_mask:0xf bank_mask:0xf
    v_add_f32_dpp v221, v221, v221 row_half_mirror row_mask:0xf bank_mask:0xf
    v_lshlrev_b32 v188, 16, v178
    v_add_f32_dpp v220, v220, v220 row_mirror row_mask:0xf bank_mask:0xf
    v_add_f32_dpp v221, v221, v221 row_mirror row_mask:0xf bank_mask:0xf
    v_and_b32 v189, 0xffff0000, v178
    v_mov_b32 v222, v220
    v_mov_b32 v223, v221
    v_lshlrev_b32 v190, 16, v179
    v_permlane16_swap_b32 v220, v222
    v_permlane16_swap_b32 v221, v223
    v_add_f32 v220, v220, v222
    v_add_f32 v221, v221, v223
    v_mul_f32_e64 v220, -v220, s76
    v_mul_f32 v222, v220, v220
    v_fma_f32 v221, v221, s76, -v222
    v_max_f32 v221, 0, v221
    v_add_f32 v222, s75, v221
    v_rsq_f32 v216, v222
    v_and_b32 v191, 0xffff0000, v179
    v_mul_f32 v222, v216, v216
    v_fma_f32 v223, v222, v221, s75
    v_rsq_f32 v222, v223
    v_mul_f32 v217, v220, v216
    v_mul_f32 v218, v216, v222
    v_mul_f32 v219, v217, v222
    v_mul_f32 v223, v223, v222
    ds_write_b32 v226, v223
    v_lshlrev_b32 v192, 16, v180
    v_and_b32 v193, 0xffff0000, v180
    v_lshlrev_b32 v194, 16, v181
    v_and_b32 v195, 0xffff0000, v181
    v_lshlrev_b32 v196, 16, v182
    v_and_b32 v197, 0xffff0000, v182
    v_lshlrev_b32 v198, 16, v183
    v_and_b32 v199, 0xffff0000, v183
    v_pk_fma_f32 v[200:201], v[184:185], v[218:219], v[218:219] op_sel:[0,0,1] op_sel_hi:[1,0,1]
    v_pk_fma_f32 v[202:203], v[186:187], v[218:219], v[218:219] op_sel:[0,0,1] op_sel_hi:[1,0,1]
    v_pk_fma_f32 v[204:205], v[188:189], v[218:219], v[218:219] op_sel:[0,0,1] op_sel_hi:[1,0,1]
    v_pk_fma_f32 v[206:207], v[190:191], v[218:219], v[218:219] op_sel:[0,0,1] op_sel_hi:[1,0,1]
    v_cvt_pk_bf16_f32 v176, v200, v201
    v_cvt_pk_bf16_f32 v177, v202, v203
    v_cvt_pk_bf16_f32 v178, v204, v205
    v_cvt_pk_bf16_f32 v179, v206, v207
    ds_write_b128 v224, v[176:179] offset:0
    v_pk_fma_f32 v[208:209], v[192:193], v[218:219], v[218:219] op_sel:[0,0,1] op_sel_hi:[1,0,1]
    v_pk_fma_f32 v[210:211], v[194:195], v[218:219], v[218:219] op_sel:[0,0,1] op_sel_hi:[1,0,1]
    v_pk_fma_f32 v[212:213], v[196:197], v[218:219], v[218:219] op_sel:[0,0,1] op_sel_hi:[1,0,1]
    v_pk_fma_f32 v[214:215], v[198:199], v[218:219], v[218:219] op_sel:[0,0,1] op_sel_hi:[1,0,1]
    v_cvt_pk_bf16_f32 v180, v208, v209
    v_cvt_pk_bf16_f32 v181, v210, v211
    v_cvt_pk_bf16_f32 v182, v212, v213
    v_cvt_pk_bf16_f32 v183, v214, v215
    ds_write_b128 v224, v[180:183] offset:448
    s_waitcnt lgkmcnt(0)
    s_barrier
    ds_read_b64_tr_b16 v[104:105], v225 offset:0
    ds_read_b64_tr_b16 v[106:107], v225 offset:3840
    ds_read_b64_tr_b16 v[108:109], v225 offset:128
    ds_read_b64_tr_b16 v[110:111], v225 offset:3968
    ds_read_b32 v223, v231
    s_waitcnt lgkmcnt(3)
    buffer_store_dwordx4 v[104:107], v227, s[28:31], s70 offen sc1
    s_waitcnt lgkmcnt(1)
    buffer_store_dwordx4 v[108:111], v227, s[28:31], s71 offen sc1
    v_cmp_gt_u32 vcc, 16, v1
    s_waitcnt lgkmcnt(0)
    s_nop 0
    v_cndmask_b32 v223, 0, v223, vcc
    buffer_store_dword v223, v232, s[28:31], s72 offen sc1
    v_lshrrev_b32 v14, 2, v1
    v_mul_u32_u24 v14, 1056, v14
    v_lshl_add_u32 v14, v8, 3, v14
    s_mul_i32 s3, s48, 224
    v_add_u32 v237, s3, v14
    s_mov_b32 s18, 401408
    s_mov_b32 s19, 0x20000
    s_mov_b32 s26, 7340032
    s_mov_b32 s27, 0x20000
    s_mov_b32 s34, 1835008
    s_mov_b32 s35, 0x20000
    s_mov_b32 s36, 1
    v_lshl_add_u32 v15, v9, 2, v7
    v_lshlrev_b32 v15, 7, v15
    v_lshl_add_u32 v15, v8, 3, v15
    v_and_b32 v16, 2, v7
    v_and_b32 v14, 1, v3
    v_add_u32 v16, v16, v14
    v_lshl_add_u32 v15, v16, 5, v15
    s_mul_i32 s3, s4, 8256
    v_xor_b32 v31, s3, v15
    v_xor_b32 v32, 64, v31
    v_add_u32 v33, 65536, v31
    v_add_u32 v34, 65536, v32
    v_add_u32 v35, 131072, v31
    v_add_u32 v36, 131072, v32
    s_lshl_b32 s6, s52, 1
    s_add_u32 s6, s6, s5
    s_lshl_b32 s3, s6, 1
    s_add_u32 s3, s3, s59
    s_lshl_b32 s3, s3, 4
    s_add_u32 s3, s3, s4
    s_lshl_b32 s3, s3, 12
    v_add_u32 v71, s3, v4
    s_xor_b32 s37, s51, 1
    s_lshl_b32 s37, s37, 3
    s_add_u32 s37, s37, s52
    s_lshl_b32 s3, s37, 14
    s_add_u32 s3, s3, s58
    s_add_u32 s3, s3, 16777216
    v_add_u32 v23, s3, v4
    s_lshl_b32 s37, s37, 5
    s_add_u32 s37, s37, s5
    s_lshl_b32 s37, s37, 2
    s_add_u32 s37, s37, 6422528
    s_mul_i32 s67, s6, 56
    s_lshl_b32 s3, s51, 1
    s_add_u32 s3, s3, s4
    s_add_u32 s67, s67, s3
    s_lshl_b32 s67, s67, 11
    s_add_u32 s67, s67, 2097152
    v_add_u32 v74, s58, v4
    s_lshl_b32 s68, s52, 2
    s_and_b32 s3, s51, 1
    s_add_u32 s68, s68, s3
    s_cmp_ge_u32 s51, 14
    s_cselect_b32 s3, 2, 0
    s_add_u32 s68, s68, s3
    s_lshl_b32 s68, s68, 7
    s_add_u32 s68, s68, 6356992
    s_waitcnt vmcnt(3)
    v_readfirstlane_b32 s57, v12
    s_mov_b32 s60, 0
    s_cmp_lg_u32 s57, 0
    s_cbranch_scc1 L_nonce_okh
L_nonceh:
    buffer_load_dword v12, v17, s[44:47], 0 offen sc1
    s_add_u32 s60, s60, 1
    s_waitcnt vmcnt(0)
    v_readfirstlane_b32 s57, v12
    s_cmp_ge_u32 s60, 20000
    s_cbranch_scc1 L_nonce_okh
    s_cmp_eq_u32 s57, 0
    s_cbranch_scc1 L_nonceh
L_nonce_okh:
    s_waitcnt vmcnt(0)
    s_barrier
    s_atomic_swap s57, s[28:29], s74
    s_atomic_swap s57, s[28:29], s73
    buffer_load_dwordx4 v[90:93], v78, s[8:11], 0 offen
    buffer_load_ushort v88, v75, s[40:43], 0 offen offset:0
    buffer_load_dwordx4 v[94:97], v79, s[8:11], 0 offen
    buffer_load_ushort v89, v75, s[40:43], 0 offen offset:16
    v_cmp_gt_u32 vcc, 12, v2
    s_mul_i32 s3, s48, 56
    s_add_u32 s3, s3, s79
    s_mul_i32 s3, s3, 3
    s_add_u32 s3, s3, s80
    s_lshl_b32 s3, s3, 11
    s_add_u32 s3, s3, 8388608
    s_add_u32 s3, s3, s81
    ds_read_b64_tr_b16 v[176:177], v237 offset:0
    ds_read_b64_tr_b16 v[178:179], v237 offset:16896
    ds_read_b64_tr_b16 v[180:181], v237 offset:32
    ds_read_b64_tr_b16 v[182:183], v237 offset:16928
    ds_read_b64_tr_b16 v[184:185], v237 offset:56
    ds_read_b64_tr_b16 v[186:187], v237 offset:16952
    ds_read_b64_tr_b16 v[188:189], v237 offset:88
    ds_read_b64_tr_b16 v[190:191], v237 offset:16984
    ds_read_b64_tr_b16 v[192:193], v237 offset:112
    ds_read_b64_tr_b16 v[194:195], v237 offset:17008
    ds_read_b64_tr_b16 v[196:197], v237 offset:144
    ds_read_b64_tr_b16 v[198:199], v237 offset:17040
    ds_read_b64_tr_b16 v[200:201], v237 offset:168
    ds_read_b64_tr_b16 v[202:203], v237 offset:17064
    ds_read_b64_tr_b16 v[204:205], v237 offset:200
    ds_read_b64_tr_b16 v[206:207], v237 offset:17096
    s_waitcnt lgkmcnt(13)
    v_cndmask_b32 v180, 0, v180, vcc
    v_cndmask_b32 v181, 0, v181, vcc
    s_waitcnt lgkmcnt(12)
    v_cndmask_b32 v182, 0, v182, vcc
    v_cndmask_b32 v183, 0, v183, vcc
    buffer_store_dwordx4 v[176:179], v4, s[28:31], s3 offen offset:0 sc1
    buffer_store_dwordx4 v[180:183], v4, s[28:31], s3 offen offset:1024 sc1
    s_add_u32 s3, s3, 86016
    s_waitcnt lgkmcnt(9)
    v_cndmask_b32 v188, 0, v188, vcc
    v_cndmask_b32 v189, 0, v189, vcc
    s_waitcnt lgkmcnt(8)
    v_cndmask_b32 v190, 0, v190, vcc
    v_cndmask_b32 v191, 0, v191, vcc
    buffer_store_dwordx4 v[184:187], v4, s[28:31], s3 offen offset:0 sc1
    buffer_store_dwordx4 v[188:191], v4, s[28:31], s3 offen offset:1024 sc1
    s_add_u32 s3, s3, 86016
    s_waitcnt lgkmcnt(5)
    v_cndmask_b32 v196, 0, v196, vcc
    v_cndmask_b32 v197, 0, v197, vcc
    s_waitcnt lgkmcnt(4)
    v_cndmask_b32 v198, 0, v198, vcc
    v_cndmask_b32 v199, 0, v199, vcc
    buffer_store_dwordx4 v[192:195], v4, s[28:31], s3 offen offset:0 sc1
    buffer_store_dwordx4 v[196:199], v4, s[28:31], s3 offen offset:1024 sc1
    s_add_u32 s3, s3, 86016
    ds_read_b32 v24, v4
    s_waitcnt lgkmcnt(2)
    v_cndmask_b32 v204, 0, v204, vcc
    v_cndmask_b32 v205, 0, v205, vcc
    ds_read_b32 v24, v4
    s_waitcnt lgkmcnt(2)
    v_cndmask_b32 v206, 0, v206, vcc
    v_cndmask_b32 v207, 0, v207, vcc
    buffer_store_dwordx4 v[200:203], v4, s[28:31], s3 offen offset:0 sc1
    buffer_store_dwordx4 v[204:207], v4, s[28:31], s3 offen offset:1024 sc1
    s_add_u32 s3, s3, 86016
    s_lshl_b32 s67, s80, 6
    s_add_u32 s67, s67, 64
    s_cmp_eq_u32 s81, 0
    s_cselect_b32 s37, s48, 1
    s_mov_b32 s68, 6369792
    s_and_b32 s3, s2, 1
    s_mul_i32 s3, s3, 3
    s_bfe_u32 s6, s2, 0x10001
    s_mul_i32 s7, s6, 6
    s_add_u32 s3, s3, s7
    s_add_u32 s3, s3, 1
    v_add_u32 v15, s3, v8
    s_mul_i32 s6, s6, 64
    s_add_u32 s6, s6, 7
    v_cmp_ne_u32 vcc, s6, v15
    v_lshrrev_b32 v16, 2, v1
    v_mul_u32_u24 v16, 3584, v16
    v_cndmask_b32 v15, 0, v15, vcc
    v_lshl_add_u32 v15, v15, 8, v16
    s_lshl_b32 s3, s52, 2
    s_add_u32 s3, s3, s48
    s_mul_i32 s3, s3, 37
    s_min_u32 s3, s3, 976
    s_mul_i32 s3, s3, 3584
    s_mul_i32 s6, s59, 3670144
    s_add_u32 s3, s3, s6
    buffer_load_dword v220, v15, s[20:23], s3 offen
    s_add_u32 s3, s3, 57344
    buffer_load_dword v221, v15, s[20:23], s3 offen
    s_add_u32 s3, s3, 57344
    buffer_load_dword v222, v15, s[20:23], s3 offen
    s_add_u32 s3, s3, 57344
    v_add_u32 v46, 65536, v4
    v_add_u32 v47, 131072, v4
    s_mul_i32 s59, s48, 3072
    s_mul_i32 s3, s50, 86016
    s_add_u32 s3, s3, s59
    s_add_u32 s3, s3, 8388608
    v_add_u32 v73, s3, v4
    v_lshlrev_b32 v15, 7, v9
    v_xor_b32 v15, v15, v4
    s_lshl_b32 s3, s49, 11
    v_add_u32 v60, s3, v15
    v_add_u32 v61, 129024, v60
    s_lshr_b32 s3, s49, 2
    s_lshl_b32 s3, s3, 3
    s_max_u32 s3, s3, 1
    s_sub_u32 s3, s3, 1
    s_lshl_b32 s3, s3, 10
    s_lshl_b32 s6, s5, 17
    s_add_u32 s3, s3, s6
    s_lshl_b32 s6, s4, 28
    s_add_u32 s3, s3, s6
    v_add_u32 v62, s3, v15
    s_lshl_b32 s100, s5, 1
    s_add_u32 s100, s100, s4
    s_lshl_b32 s100, s100, 10
    v_and_b32 v15, 1, v1
    v_mul_u32_u24 v15, 640, v15
    v_lshrrev_b32 v16, 2, v1
    v_lshlrev_b32 v16, 4, v16
    v_xor_b32 v15, v15, v16
    v_bfe_u32 v16, v1, 1, 1
    v_lshl_add_u32 v15, v16, 3, v15
    s_add_u32 s3, s58, 12288
    v_add_u32 v63, s3, v15
    s_sub_u32 s3, s3, 3072
    s_cmp_eq_u32 s48, 0
    s_cselect_b32 s3, 28672, s3
    v_add_u32 v64, s3, v15
    v_add_u32 v65, 65536, v63
    v_add_u32 v66, 65536, v64
    v_add_u32 v67, 131072, v63
    v_add_u32 v68, 131072, v64
    s_lshl_b32 s3, s49, 1
    v_min_u32 v15, 2, v3
    v_add_u32 v15, s3, v15
    v_max_u32 v15, 1, v15
    v_lshlrev_b32 v15, 1, v15
    v_and_b32 v16, 1, v7
    v_add_lshl_u32 v15, v15, v16, 7
    v_lshrrev_b32 v16, 1, v7
    v_lshl_add_u32 v16, v16, 2, v8
    v_lshl_add_u32 v15, v16, 2, v15
    v_add_u32 v70, 6291200, v15
    s_min_u32 s15, s48, 2
    s_lshl_b32 s15, s15, 6
    s_add_u32 s15, s15, 64
    s_lshl_b32 s82, s49, 5
    s_add_u32 s82, s82, s50
    s_lshl_b32 s82, s82, 10
    s_add_u32 s82, s82, 4194304
    s_lshr_b32 s69, s49, 2
    s_lshl_b32 s69, s69, 1
    s_and_b32 s3, s50, 1
    s_add_u32 s69, s69, s3
    s_lshl_b32 s69, s69, 7
    s_add_u32 s69, s69, 6361088
    s_and_b32 s7, s53, 1
    s_mul_i32 s3, s7, 28
    s_add_u32 s3, s3, s48
    s_lshl_b32 s3, s3, 17
    s_xor_b32 s6, s53, 1
    s_lshl_b32 s55, s6, 3
    s_lshl_b32 s6, s53, 7
    s_add_u32 s3, s3, s6
    v_lshlrev_b32 v15, 12, v5
    v_add3_u32 v52, v15, v76, s3
    v_add_u32 v53, 31744, v52
    v_add_u32 v54, 63488, v52
    v_add_u32 v55, 95232, v52
    v_mul_u32_u24 v15, 896, v5
    s_mul_i32 s3, s4, 25088
    s_mul_i32 s6, s5, 14336
    s_add_u32 s3, s3, s6
    s_lshl_b32 s6, s54, 7
    s_add_u32 s3, s3, s6
    v_add3_u32 v56, v15, v76, s3
    v_add_u32 v57, 6144, v56
    s_lshl_b32 s6, s53, 1
    s_add_u32 s6, s6, s5
    s_and_b32 s3, s53, 30
    s_add_u32 s3, s3, s4
    s_lshl_b32 s3, s3, 7
    s_add_u32 s39, s3, 6361088
    s_lshl_b32 s3, s6, 5
    s_add_u32 s3, s3, s4
    s_lshl_b32 s3, s3, 10
    s_add_u32 s3, s3, 4194304
    v_add_u32 v58, s3, v4
    v_add_u32 v59, 15360, v58
    s_xor_b32 s3, s4, s5
    s_lshl_b32 s3, s3, 6
    v_xor_b32 v37, s3, v31
    v_add_u32 v38, 65536, v37
    v_add_u32 v39, 131072, v37
    v_lshlrev_b32 v14, 10, v14
    v_lshl_add_u32 v14, v9, 8, v14
    v_lshl_add_u32 v14, v2, 4, v14
    s_mul_i32 s3, s4, 12288
    v_add_u32 v40, s3, v14
    v_xor_b32 v41, 4096, v40
    v_add_u32 v42, 65536, v40
    v_add_u32 v43, 65536, v41
    v_add_u32 v44, 131072, v40
    v_add_u32 v45, 131072, v41
    s_lshl_b32 s6, s54, 1
    s_add_u32 s6, s6, s5
    s_lshl_b32 s3, s6, 1
    s_add_u32 s3, s3, s7
    s_mul_i32 s3, s3, 14
    s_add_u32 s3, s3, s4
    s_lshl_b32 s3, s3, 12
    s_add_u32 s3, s3, 2097152
    v_add_u32 v72, s3, v4
    s_lshl_b32 s3, s54, 1
    s_add_u32 s3, s3, s7
    s_lshl_b32 s3, s3, 1
    s_add_u32 s3, s3, s4
    s_lshl_b32 s3, s3, 7
    s_add_u32 s38, s3, 6356992
    s_and_b32 s3, s2, 6
    s_add_u32 s3, s3, s54
    s_sub_u32 s6, s3, 7
    s_cmp_ge_u32 s3, 7
    s_cselect_b32 s3, s6, s3
    s_lshl_b32 s64, s3, 19
    s_lshl_b32 s65, s3, 13
    s_add_u32 s55, s55, s54
    s_lshl_b32 s3, s55, 14
    s_add_u32 s3, s3, s58
    s_add_u32 s3, s3, 12582912
    v_add_u32 v21, s3, v4
    s_lshl_b32 s55, s55, 5
    s_add_u32 s55, s55, s48
    s_lshl_b32 s55, s55, 2
    s_add_u32 s55, s55, 6488064
    s_lshl_b32 s3, s5, 3
    v_add_u32 v14, s3, v9
    v_xor_b32 v14, v14, v6
    v_lshlrev_b32 v14, 4, v14
    v_lshl_add_u32 v14, v10, 8, v14
    s_lshl_b32 s3, s4, 14
    s_add_u32 s3, s3, 131072
    v_add_u32 v80, s3, v14
    v_xor_b32 v81, 32, v80
    v_xor_b32 v82, 64, v80
    v_xor_b32 v83, 96, v80
    s_lshr_b32 s3, s53, 1
    s_add_u32 s66, s3, s54
    v_lshlrev_b32 v14, 1, v6
    v_xor_b32 v14, v14, v5
    v_lshlrev_b32 v14, 4, v14
    v_lshl_add_u32 v14, v5, 8, v14
    s_add_u32 s3, s58, 131072
    v_add_u32 v84, s3, v14
    v_xor_b32 v85, 16, v84
    v_xor_b32 v86, 24576, v84
    v_xor_b32 v87, 24592, v84
    s_mov_b32 s70, 0xaaaaaaaa
    s_mov_b32 s71, 0xaaaaaaaa
    s_mov_b32 s72, 0xfff0ffff
    s_mov_b32 s73, 0xf000ff00
    s_mov_b32 s74, 0xffc0fffc
    s_mov_b32 s75, 0xc000fc00
    s_cmp_eq_u32 s49, 0
    s_cselect_b64 s[76:77], 0, -1
    v_mov_b32 v14, 0xffff
    v_mov_b32 v15, 0xffff0000
    v_cndmask_b32 v14, v14, v15, s[70:71]
    v_cndmask_b32 v98, v14, 0, s[72:73]
    v_cndmask_b32 v100, 0, v14, s[72:73]
    v_cndmask_b32 v99, v14, 0, s[74:75]
    v_cndmask_b32 v101, 0, v14, s[74:75]
    v_mov_b32 v77, 0xf149f2ca
    s_mov_b32 s83, 0x3e8b97f6
    s_mov_b32 s78, 0xbdd2d3e8
    s_mov_b32 s79, 0xbdd2d3e8
    s_mov_b32 s80, 1.0
    s_mov_b32 s81, 1.0
    v_mov_b32 v102, 0xc0135761
    v_mov_b32 v103, 0xc0135761
    s_waitcnt vmcnt(3)
    s_barrier
    s_cmp_lg_u32 s37, 0
    s_cbranch_scc1 L_nowsig
    s_atomic_add s36, s[44:45], s67
L_nowsig:
    buffer_load_dword v18, v20, s[28:31], 0 offen sc1
    s_cmp_eq_u32 s56, 0
    s_cselect_b32 s26, 0, s26
    v_sub_u32 v14, v71, v4
    v_lshl_add_u32 v14, v10, 7, v14
    s_add_u32 s3, s1, 8192
    v_lshl_add_u32 v15, v9, 13, s3
    s_waitcnt vmcnt(0)
    v_cmp_ne_u32 vcc, s57, v18
    s_cbranch_vccz L_pollok3
    s_mov_b32 s60, 0
L_poll3:
    s_sleep 8
    buffer_load_dword v18, v20, s[28:31], 0 offen sc1
    s_add_u32 s60, s60, 1
    s_waitcnt vmcnt(0)
    v_cmp_ne_u32 vcc, s57, v18
    s_cbranch_vccz L_pollok3
    s_cmp_lt_u32 s60, 20000
    s_cbranch_scc1 L_poll3
L_pollok3:
    s_barrier
    buffer_load_dword v69, v70, s[28:31], 0 offen sc1
    s_mov_b32 s26, 7340032
    s_and_b32 s3, s2, 1
    s_mul_i32 s3, s3, 7
    s_add_u32 s3, s3, s52
    s_lshl_b32 s3, s3, 2
    s_add_u32 s3, s3, s48
    s_lshl_b32 s3, s3, 17
    s_and_b32 s6, s2, 6
    s_lshl_b32 s6, s6, 9
    s_add_u32 s3, s3, s6
    v_lshlrev_b32 v14, 12, v10
    v_lshl_add_u32 v14, v9, 9, v14
    buffer_load_dword v226, v14, s[24:27], s3 offen offset:384
    buffer_load_dword v227, v14, s[24:27], s3 offen offset:256
    s_cmp_eq_u32 s56, 0
    s_cselect_b32 s26, 0, s26
    v_lshlrev_b32 v14, 2, v2
    v_and_b32 v15, 1, v1
    v_lshl_add_u32 v15, v3, 2, v15
    v_lshlrev_b32 v15, 2, v15
    v_add_u32 v16, 64, v15
    v_cndmask_b32 v17, v15, v16, s[72:73]
    v_cndmask_b32 v15, v15, v16, s[74:75]
    s_waitcnt vmcnt(2)
    ds_bpermute_b32 v25, v14, v69 offset:64
    ds_bpermute_b32 v27, v17, v69 offset:0
    ds_bpermute_b32 v28, v15, v69 offset:8
    ds_bpermute_b32 v26, v14, v69 offset:128
    ds_bpermute_b32 v29, v17, v69 offset:64
    ds_bpermute_b32 v30, v15, v69 offset:72
    s_waitcnt lgkmcnt(5)
    v_mul_f32 v25, s83, v25
    ds_read_b32 v24, v4
    s_waitcnt lgkmcnt(3)
    v_mul_f32 v26, s83, v26
    s_load_dword s14, s[44:45], s15
    s_waitcnt lgkmcnt(0)
    s_cmp_eq_u32 s14, 14
    s_cbranch_scc1 L_pollok4
    s_mov_b32 s60, 0
L_poll4:
    s_sleep 16
    buffer_load_dword v18, off, s[44:47], s15 sc1
    s_add_u32 s60, s60, 1
    s_waitcnt vmcnt(0)
    v_readfirstlane_b32 s14, v18
    s_nop 0
    s_cmp_eq_u32 s14, 14
    s_cbranch_scc1 L_pollok4
    s_cmp_lt_u32 s60, 20000
    s_cbranch_scc1 L_poll4
L_pollok4:
    s_barrier
    s_cmp_eq_u32 s56, 0
    s_cselect_b32 s3, 268435456, 0
    v_add_u32 v72, s3, v72
    s_add_u32 m0, s59, 98304
    s_nop 0
    buffer_load_dwordx4 v73, s[28:31], s63 offen sc1 lds
    buffer_load_dwordx4 v73, s[28:31], s63 offen offset:1024 sc1 lds
    buffer_load_dwordx4 v73, s[28:31], s63 offen offset:2048 sc1 lds
    s_add_u32 m0, s100, 126976
    s_nop 0
    buffer_load_dwordx4 v62, s[28:31], s62 offen sc1 lds
    s_add_u32 m0, s58, 110592
    s_nop 0
    buffer_load_dwordx4 v60, s[28:31], s62 offen sc1 lds
    buffer_load_dwordx4 v60, s[28:31], s62 offen offset:1024 sc1 lds
    buffer_load_dwordx4 v61, s[28:31], s62 offen offset:2048 sc1 lds
    buffer_load_dwordx4 v61, s[28:31], s62 offen offset:3072 sc1 lds
    s_add_u32 m0, s59, 131072
    s_add_u32 s63, s63, 12288
    s_cmp_eq_u32 s63, 86016
    s_cselect_b32 s63, 0, s63
    buffer_load_dwordx4 v73, s[28:31], s63 offen sc1 lds
    buffer_load_dwordx4 v73, s[28:31], s63 offen offset:1024 sc1 lds
    buffer_load_dwordx4 v73, s[28:31], s63 offen offset:2048 sc1 lds
    s_add_u32 m0, s100, 159744
    s_add_u32 s62, s62, 262144
    s_cmp_eq_u32 s62, 1835008
    s_cselect_b32 s62, 0, s62
    buffer_load_dwordx4 v62, s[28:31], s62 offen sc1 lds
    s_add_u32 m0, s58, 143360
    s_nop 0
    buffer_load_dwordx4 v60, s[28:31], s62 offen sc1 lds
    buffer_load_dwordx4 v60, s[28:31], s62 offen offset:1024 sc1 lds
    buffer_load_dwordx4 v61, s[28:31], s62 offen offset:2048 sc1 lds
    buffer_load_dwordx4 v61, s[28:31], s62 offen offset:3072 sc1 lds
    s_add_u32 m0, s59, 0
    s_add_u32 s63, s63, 12288
    s_cmp_eq_u32 s63, 86016
    s_cselect_b32 s63, 0, s63
    buffer_load_dwordx4 v73, s[28:31], s63 offen sc1 lds
    buffer_load_dwordx4 v73, s[28:31], s63 offen offset:1024 sc1 lds
    buffer_load_dwordx4 v73, s[28:31], s63 offen offset:2048 sc1 lds
    s_add_u32 m0, s100, 28672
    s_add_u32 s62, s62, 262144
    s_cmp_eq_u32 s62, 1835008
    s_cselect_b32 s62, 0, s62
    buffer_load_dwordx4 v62, s[28:31], s62 offen sc1 lds
    s_add_u32 m0, s58, 12288
    s_nop 0
    buffer_load_dwordx4 v60, s[28:31], s62 offen sc1 lds
    buffer_load_dwordx4 v60, s[28:31], s62 offen offset:1024 sc1 lds
    buffer_load_dwordx4 v61, s[28:31], s62 offen offset:2048 sc1 lds
    buffer_load_dwordx4 v61, s[28:31], s62 offen offset:3072 sc1 lds
    s_add_u32 m0, s59, 65536
    s_add_u32 s63, s63, 12288
    s_cmp_eq_u32 s63, 86016
    s_cselect_b32 s63, 0, s63
    buffer_load_dwordx4 v73, s[28:31], s63 offen sc1 lds
    buffer_load_dwordx4 v73, s[28:31], s63 offen offset:1024 sc1 lds
    buffer_load_dwordx4 v73, s[28:31], s63 offen offset:2048 sc1 lds
    s_add_u32 m0, s100, 94208
    s_add_u32 s62, s62, 262144
    s_cmp_eq_u32 s62, 1835008
    s_cselect_b32 s62, 0, s62
    buffer_load_dwordx4 v62, s[28:31], s62 offen sc1 lds
    s_add_u32 m0, s58, 77824
    s_nop 0
    buffer_load_dwordx4 v60, s[28:31], s62 offen sc1 lds
    buffer_load_dwordx4 v60, s[28:31], s62 offen offset:1024 sc1 lds
    buffer_load_dwordx4 v61, s[28:31], s62 offen offset:2048 sc1 lds
    buffer_load_dwordx4 v61, s[28:31], s62 offen offset:3072 sc1 lds
    s_mov_b32 s3, 268435456
    buffer_store_dword v12, v11, s[28:31], s3 offen
    buffer_store_dword v12, v11, s[28:31], s3 offen
    s_waitcnt vmcnt(10)
    s_nop 3
L_q:
    s_barrier
    ds_read_b64_tr_b16 a[180:181], v65 offset:32768
    ds_read_b64_tr_b16 a[182:183], v65 offset:33024
    ds_read_b128 a[128:131], v46 offset:32768
    ds_read_b64_tr_b16 a[184:185], v65 offset:33792
    ds_read_b64_tr_b16 a[186:187], v65 offset:34048
    ds_read_b128 a[132:135], v46 offset:33792
    ds_read_b128 a[136:139], v46 offset:34816
    ds_read_b64_tr_b16 a[176:177], v66 offset:32768
    ds_read_b64_tr_b16 a[178:179], v66 offset:33024
    ds_read_b128 a[140:143], v46 offset:35840
    ds_read_b128 a[144:147], v46 offset:36864
    ds_read_b128 a[148:151], v46 offset:37888
    s_waitcnt lgkmcnt(6)
    v_mfma_f32_16x16x32_bf16 v[176:179], a[128:131], a[180:183], 0
    ds_read_b64_tr_b16 a[192:193], v65 offset:34816
    s_add_u32 m0, s59, 32768
    v_mfma_f32_16x16x32_bf16 v[184:187], a[128:131], a[184:187], 0
    ds_read_b64_tr_b16 a[194:195], v65 offset:35072
    s_add_u32 s63, s63, 12288
    v_mfma_f32_16x16x32_bf16 v[180:183], a[132:135], a[180:183], 0
    ds_read_b128 a[152:155], v46 offset:38912
    s_cmp_eq_u32 s63, 86016
    v_mfma_f32_16x16x32_bf16 v[188:191], a[132:135], a[184:187], 0
    ds_read_b64_tr_b16 a[196:197], v65 offset:35840
    s_waitcnt lgkmcnt(4)
    v_mfma_f32_16x16x32_bf16 v[200:203], a[136:139], a[180:183], 0
    ds_read_b64_tr_b16 a[198:199], v65 offset:36096
    s_cselect_b32 s63, 0, s63
    v_mfma_f32_16x16x32_bf16 v[208:211], a[136:139], a[184:187], 0
    ds_read_b128 a[156:159], v46 offset:39936
    buffer_load_dwordx4 v73, s[28:31], s63 offen sc1 lds
    v_mfma_f32_16x16x32_bf16 v[192:195], a[136:139], a[176:179], 0
    ds_read_b128 a[160:163], v46 offset:40960
    v_mfma_f32_16x16x32_bf16 v[204:207], a[140:143], a[180:183], 0
    ds_read_b64_tr_b16 a[188:189], v66 offset:34816
    buffer_load_dwordx4 v73, s[28:31], s63 offen offset:1024 sc1 lds
    v_mfma_f32_16x16x32_bf16 v[212:215], a[140:143], a[184:187], 0
    ds_read_b64_tr_b16 a[190:191], v66 offset:35072
    v_mfma_f32_16x16x32_bf16 v[196:199], a[140:143], a[176:179], 0
    ds_read_b128 a[164:167], v46 offset:41984
    v_mfma_f32_16x16x32_bf16 v[224:227], a[180:183], a[144:147], 0
    ds_read_b128 a[168:171], v46 offset:43008
    v_mfma_f32_16x16x32_bf16 v[232:235], a[184:187], a[144:147], 0
    ds_read_b128 a[172:175], v46 offset:44032
    buffer_load_dwordx4 v73, s[28:31], s63 offen offset:2048 sc1 lds
    v_mfma_f32_16x16x32_bf16 v[216:219], a[176:179], a[144:147], 0
    s_add_u32 m0, s100, 61440
    s_add_u32 s62, s62, 262144
    v_mfma_f32_16x16x32_bf16 v[228:231], a[180:183], a[148:151], 0
    s_cmp_eq_u32 s62, 1835008
    s_cselect_b32 s62, 0, s62
    v_mfma_f32_16x16x32_bf16 v[236:239], a[184:187], a[148:151], 0
    v_mfma_f32_16x16x32_bf16 v[220:223], a[176:179], a[148:151], 0
    buffer_load_dwordx4 v62, s[28:31], s62 offen sc1 lds
    s_waitcnt lgkmcnt(0)
    s_barrier
    v_mfma_f32_16x16x32_bf16 v[176:179], a[152:155], a[192:195], v[176:179]
    ds_read_b64_tr_b16 a[180:181], v67 offset:0
    s_add_u32 m0, s58, 45056
    v_mfma_f32_16x16x32_bf16 v[184:187], a[152:155], a[196:199], v[184:187]
    ds_read_b64_tr_b16 a[182:183], v67 offset:256
    v_mfma_f32_16x16x32_bf16 v[180:183], a[156:159], a[192:195], v[180:183]
    ds_read_b128 a[128:131], v47 offset:0
    buffer_load_dwordx4 v60, s[28:31], s62 offen sc1 lds
    v_mfma_f32_16x16x32_bf16 v[188:191], a[156:159], a[196:199], v[188:191]
    ds_read_b64_tr_b16 a[184:185], v67 offset:1024
    v_mfma_f32_16x16x32_bf16 v[200:203], a[160:163], a[192:195], v[200:203]
    ds_read_b64_tr_b16 a[186:187], v67 offset:1280
    v_mfma_f32_16x16x32_bf16 v[208:211], a[160:163], a[196:199], v[208:211]
    ds_read_b128 a[132:135], v47 offset:1024
    v_mfma_f32_16x16x32_bf16 v[192:195], a[160:163], a[188:191], v[192:195]
    ds_read_b128 a[136:139], v47 offset:2048
    buffer_load_dwordx4 v60, s[28:31], s62 offen offset:1024 sc1 lds
    v_mfma_f32_16x16x32_bf16 v[204:207], a[164:167], a[192:195], v[204:207]
    ds_read_b64_tr_b16 a[176:177], v68 offset:0
    v_mfma_f32_16x16x32_bf16 v[212:215], a[164:167], a[196:199], v[212:215]
    ds_read_b64_tr_b16 a[178:179], v68 offset:256
    v_mfma_f32_16x16x32_bf16 v[196:199], a[164:167], a[188:191], v[196:199]
    ds_read_b128 a[140:143], v47 offset:3072
    v_mfma_f32_16x16x32_bf16 v[224:227], a[192:195], a[168:171], v[224:227]
    ds_read_b128 a[144:147], v47 offset:4096
    buffer_load_dwordx4 v61, s[28:31], s62 offen offset:2048 sc1 lds
    v_mfma_f32_16x16x32_bf16 v[232:235], a[196:199], a[168:171], v[232:235]
    ds_read_b128 a[148:151], v47 offset:5120
    v_mfma_f32_16x16x32_bf16 v[216:219], a[188:191], a[168:171], v[216:219]
    v_mfma_f32_16x16x32_bf16 v[228:231], a[192:195], a[172:175], v[228:231]
    v_mfma_f32_16x16x32_bf16 v[236:239], a[196:199], a[172:175], v[236:239]
    buffer_load_dwordx4 v61, s[28:31], s62 offen offset:3072 sc1 lds
    s_add_u32 m0, s59, 98304
    v_mfma_f32_16x16x32_bf16 v[220:223], a[188:191], a[172:175], v[220:223]
    s_add_u32 s63, s63, 12288
    s_waitcnt lgkmcnt(6)
    v_mfma_f32_16x16x32_bf16 v[176:179], a[128:131], a[180:183], v[176:179]
    ds_read_b64_tr_b16 a[192:193], v67 offset:2048
    s_cmp_eq_u32 s63, 86016
    v_mfma_f32_16x16x32_bf16 v[184:187], a[128:131], a[184:187], v[184:187]
    ds_read_b64_tr_b16 a[194:195], v67 offset:2304
    s_cselect_b32 s63, 0, s63
    v_mfma_f32_16x16x32_bf16 v[180:183], a[132:135], a[180:183], v[180:183]
    ds_read_b128 a[152:155], v47 offset:6144
    buffer_load_dwordx4 v73, s[28:31], s63 offen sc1 lds
    v_mfma_f32_16x16x32_bf16 v[188:191], a[132:135], a[184:187], v[188:191]
    ds_read_b64_tr_b16 a[196:197], v67 offset:3072
    s_waitcnt lgkmcnt(4)
    v_mfma_f32_16x16x32_bf16 v[200:203], a[136:139], a[180:183], v[200:203]
    ds_read_b64_tr_b16 a[198:199], v67 offset:3328
    v_mfma_f32_16x16x32_bf16 v[208:211], a[136:139], a[184:187], v[208:211]
    ds_read_b128 a[156:159], v47 offset:7168
    buffer_load_dwordx4 v73, s[28:31], s63 offen offset:1024 sc1 lds
    v_mfma_f32_16x16x32_bf16 v[192:195], a[136:139], a[176:179], v[192:195]
    ds_read_b128 a[160:163], v47 offset:8192
    v_mfma_f32_16x16x32_bf16 v[204:207], a[140:143], a[180:183], v[204:207]
    ds_read_b64_tr_b16 a[188:189], v68 offset:2048
    v_mfma_f32_16x16x32_bf16 v[212:215], a[140:143], a[184:187], v[212:215]
    ds_read_b64_tr_b16 a[190:191], v68 offset:2304
    v_mfma_f32_16x16x32_bf16 v[196:199], a[140:143], a[176:179], v[196:199]
    ds_read_b128 a[164:167], v47 offset:9216
    buffer_load_dwordx4 v73, s[28:31], s63 offen offset:2048 sc1 lds
    v_mfma_f32_16x16x32_bf16 v[224:227], a[180:183], a[144:147], v[224:227]
    ds_read_b128 a[168:171], v47 offset:10240
    s_add_u32 m0, s100, 126976
    v_mfma_f32_16x16x32_bf16 v[232:235], a[184:187], a[144:147], v[232:235]
    ds_read_b128 a[172:175], v47 offset:11264
    s_add_u32 s62, s62, 262144
    v_mfma_f32_16x16x32_bf16 v[216:219], a[176:179], a[144:147], v[216:219]
    s_cmp_eq_u32 s62, 1835008
    s_cselect_b32 s62, 0, s62
    v_mfma_f32_16x16x32_bf16 v[228:231], a[180:183], a[148:151], v[228:231]
    buffer_load_dwordx4 v62, s[28:31], s62 offen sc1 lds
    s_add_u32 m0, s58, 110592
    v_mfma_f32_16x16x32_bf16 v[236:239], a[184:187], a[148:151], v[236:239]
    v_mfma_f32_16x16x32_bf16 v[220:223], a[176:179], a[148:151], v[220:223]
    s_waitcnt vmcnt(12) lgkmcnt(0)
    s_barrier
    s_cmp_lg_u32 s48, 0
    s_cbranch_scc1 L_sig2
    s_atomic_add s36, s[28:29], s68
L_sig2:
    v_mfma_f32_16x16x32_bf16 v[176:179], a[152:155], a[192:195], v[176:179]
    ds_read_b64_tr_b16 a[180:181], v63 offset:0
    buffer_load_dwordx4 v60, s[28:31], s62 offen sc1 lds
    v_mfma_f32_16x16x32_bf16 v[184:187], a[152:155], a[196:199], v[184:187]
    ds_read_b64_tr_b16 a[182:183], v63 offset:256
    v_mfma_f32_16x16x32_bf16 v[180:183], a[156:159], a[192:195], v[180:183]
    ds_read_b128 a[128:131], v4 offset:0
    v_mfma_f32_16x16x32_bf16 v[188:191], a[156:159], a[196:199], v[188:191]
    ds_read_b64_tr_b16 a[184:185], v63 offset:1024
    v_mfma_f32_16x16x32_bf16 v[200:203], a[160:163], a[192:195], v[200:203]
    ds_read_b64_tr_b16 a[186:187], v63 offset:1280
    buffer_load_dwordx4 v60, s[28:31], s62 offen offset:1024 sc1 lds
    v_mfma_f32_16x16x32_bf16 v[208:211], a[160:163], a[196:199], v[208:211]
    ds_read_b128 a[132:135], v4 offset:1024
    v_mfma_f32_16x16x32_bf16 v[192:195], a[160:163], a[188:191], v[192:195]
    ds_read_b128 a[136:139], v4 offset:2048
    v_mfma_f32_16x16x32_bf16 v[204:207], a[164:167], a[192:195], v[204:207]
    ds_read_b64_tr_b16 a[176:177], v64 offset:0
    buffer_load_dwordx4 v61, s[28:31], s62 offen offset:2048 sc1 lds
    v_mfma_f32_16x16x32_bf16 v[212:215], a[164:167], a[196:199], v[212:215]
    ds_read_b64_tr_b16 a[178:179], v64 offset:256
    v_mfma_f32_16x16x32_bf16 v[196:199], a[164:167], a[188:191], v[196:199]
    ds_read_b128 a[140:143], v4 offset:3072
    v_mfma_f32_16x16x32_bf16 v[224:227], a[192:195], a[168:171], v[224:227]
    ds_read_b128 a[144:147], v4 offset:4096
    v_mfma_f32_16x16x32_bf16 v[232:235], a[196:199], a[168:171], v[232:235]
    ds_read_b128 a[148:151], v4 offset:5120
    buffer_load_dwordx4 v61, s[28:31], s62 offen offset:3072 sc1 lds
    v_mfma_f32_16x16x32_bf16 v[216:219], a[188:191], a[168:171], v[216:219]
    s_add_u32 m0, s59, 131072
    s_add_u32 s63, s63, 12288
    v_mfma_f32_16x16x32_bf16 v[228:231], a[192:195], a[172:175], v[228:231]
    s_cmp_eq_u32 s63, 86016
    s_cselect_b32 s63, 0, s63
    v_mfma_f32_16x16x32_bf16 v[236:239], a[196:199], a[172:175], v[236:239]
    buffer_load_dwordx4 v73, s[28:31], s63 offen sc1 lds
    v_mfma_f32_16x16x32_bf16 v[220:223], a[188:191], a[172:175], v[220:223]
    s_waitcnt lgkmcnt(6)
    v_mfma_f32_16x16x32_bf16 v[176:179], a[128:131], a[180:183], v[176:179]
    ds_read_b64_tr_b16 a[192:193], v63 offset:2048
    v_mfma_f32_16x16x32_bf16 v[184:187], a[128:131], a[184:187], v[184:187]
    ds_read_b64_tr_b16 a[194:195], v63 offset:2304
    v_mfma_f32_16x16x32_bf16 v[180:183], a[132:135], a[180:183], v[180:183]
    ds_read_b128 a[152:155], v4 offset:6144
    buffer_load_dwordx4 v73, s[28:31], s63 offen offset:1024 sc1 lds
    v_mfma_f32_16x16x32_bf16 v[188:191], a[132:135], a[184:187], v[188:191]
    ds_read_b64_tr_b16 a[196:197], v63 offset:3072
    s_waitcnt lgkmcnt(4)
    v_mfma_f32_16x16x32_bf16 v[200:203], a[136:139], a[180:183], v[200:203]
    ds_read_b64_tr_b16 a[198:199], v63 offset:3328
    v_mfma_f32_16x16x32_bf16 v[208:211], a[136:139], a[184:187], v[208:211]
    ds_read_b128 a[156:159], v4 offset:7168
    v_mfma_f32_16x16x32_bf16 v[192:195], a[136:139], a[176:179], v[192:195]
    ds_read_b128 a[160:163], v4 offset:8192
    buffer_load_dwordx4 v73, s[28:31], s63 offen offset:2048 sc1 lds
    v_mfma_f32_16x16x32_bf16 v[204:207], a[140:143], a[180:183], v[204:207]
    ds_read_b64_tr_b16 a[188:189], v64 offset:2048
    s_add_u32 m0, s100, 159744
    v_mfma_f32_16x16x32_bf16 v[212:215], a[140:143], a[184:187], v[212:215]
    ds_read_b64_tr_b16 a[190:191], v64 offset:2304
    s_add_u32 s62, s62, 262144
    v_mfma_f32_16x16x32_bf16 v[196:199], a[140:143], a[176:179], v[196:199]
    ds_read_b128 a[164:167], v4 offset:9216
    s_cmp_eq_u32 s62, 1835008
    v_mfma_f32_16x16x32_bf16 v[224:227], a[180:183], a[144:147], v[224:227]
    ds_read_b128 a[168:171], v4 offset:10240
    s_cselect_b32 s62, 0, s62
    v_mfma_f32_16x16x32_bf16 v[232:235], a[184:187], a[144:147], v[232:235]
    ds_read_b128 a[172:175], v4 offset:11264
    buffer_load_dwordx4 v62, s[28:31], s62 offen sc1 lds
    v_mfma_f32_16x16x32_bf16 v[216:219], a[176:179], a[144:147], v[216:219]
    s_add_u32 m0, s58, 143360
    v_mfma_f32_16x16x32_bf16 v[228:231], a[180:183], a[148:151], v[228:231]
    buffer_load_dwordx4 v60, s[28:31], s62 offen sc1 lds
    v_mfma_f32_16x16x32_bf16 v[236:239], a[184:187], a[148:151], v[236:239]
    v_mfma_f32_16x16x32_bf16 v[220:223], a[176:179], a[148:151], v[220:223]
    ds_read_b32 v24, v4
    s_waitcnt lgkmcnt(1)
    s_barrier
    v_mfma_f32_16x16x32_bf16 v[176:179], a[152:155], a[192:195], v[176:179]
    ds_read_b64_tr_b16 a[180:181], v65 offset:0
    v_mfma_f32_16x16x32_bf16 v[184:187], a[152:155], a[196:199], v[184:187]
    ds_read_b64_tr_b16 a[182:183], v65 offset:256
    buffer_load_dwordx4 v60, s[28:31], s62 offen offset:1024 sc1 lds
    v_mfma_f32_16x16x32_bf16 v[180:183], a[156:159], a[192:195], v[180:183]
    ds_read_b128 a[128:131], v46 offset:0
    v_mfma_f32_16x16x32_bf16 v[188:191], a[156:159], a[196:199], v[188:191]
    ds_read_b64_tr_b16 a[184:185], v65 offset:1024
    v_mfma_f32_16x16x32_bf16 v[200:203], a[160:163], a[192:195], v[200:203]
    ds_read_b64_tr_b16 a[186:187], v65 offset:1280
    v_mfma_f32_16x16x32_bf16 v[208:211], a[160:163], a[196:199], v[208:211]
    ds_read_b128 a[132:135], v46 offset:1024
    buffer_load_dwordx4 v61, s[28:31], s62 offen offset:2048 sc1 lds
    v_mfma_f32_16x16x32_bf16 v[192:195], a[160:163], a[188:191], v[192:195]
    ds_read_b128 a[136:139], v46 offset:2048
    v_mfma_f32_16x16x32_bf16 v[204:207], a[164:167], a[192:195], v[204:207]
    ds_read_b64_tr_b16 a[176:177], v66 offset:0
    v_mfma_f32_16x16x32_bf16 v[212:215], a[164:167], a[196:199], v[212:215]
    ds_read_b64_tr_b16 a[178:179], v66 offset:256
    buffer_load_dwordx4 v61, s[28:31], s62 offen offset:3072 sc1 lds
    v_mfma_f32_16x16x32_bf16 v[196:199], a[164:167], a[188:191], v[196:199]
    ds_read_b128 a[140:143], v46 offset:3072
    s_add_u32 m0, s58, 0
    v_mfma_f32_16x16x32_bf16 v[224:227], a[192:195], a[168:171], v[224:227]
    ds_read_b128 a[144:147], v46 offset:4096
    v_mfma_f32_16x16x32_bf16 v[232:235], a[196:199], a[168:171], v[232:235]
    ds_read_b128 a[148:151], v46 offset:5120
    v_mfma_f32_16x16x32_bf16 v[216:219], a[188:191], a[168:171], v[216:219]
    buffer_load_dwordx4 v52, s[24:27], s64 offen lds
    v_mfma_f32_16x16x32_bf16 v[228:231], a[192:195], a[172:175], v[228:231]
    v_mfma_f32_16x16x32_bf16 v[236:239], a[196:199], a[172:175], v[236:239]
    v_mfma_f32_16x16x32_bf16 v[220:223], a[188:191], a[172:175], v[220:223]
    s_waitcnt lgkmcnt(6)
    v_mfma_f32_16x16x32_bf16 v[176:179], a[128:131], a[180:183], v[176:179]
    ds_read_b64_tr_b16 a[192:193], v65 offset:2048
    buffer_load_dwordx4 v53, s[24:27], s64 offen offset:1024 lds
    v_mfma_f32_16x16x32_bf16 v[184:187], a[128:131], a[184:187], v[184:187]
    ds_read_b64_tr_b16 a[194:195], v65 offset:2304
    v_mfma_f32_16x16x32_bf16 v[180:183], a[132:135], a[180:183], v[180:183]
    ds_read_b128 a[152:155], v46 offset:6144
    v_mfma_f32_16x16x32_bf16 v[188:191], a[132:135], a[184:187], v[188:191]
    ds_read_b64_tr_b16 a[196:197], v65 offset:3072
    s_waitcnt lgkmcnt(4)
    v_mfma_f32_16x16x32_bf16 v[200:203], a[136:139], a[180:183], v[200:203]
    ds_read_b64_tr_b16 a[198:199], v65 offset:3328
    buffer_load_dwordx4 v54, s[24:27], s64 offen offset:2048 lds
    v_mfma_f32_16x16x32_bf16 v[208:211], a[136:139], a[184:187], v[208:211]
    ds_read_b128 a[156:159], v46 offset:7168
    v_mfma_f32_16x16x32_bf16 v[192:195], a[136:139], a[176:179], v[192:195]
    ds_read_b128 a[160:163], v46 offset:8192
    v_mfma_f32_16x16x32_bf16 v[204:207], a[140:143], a[180:183], v[204:207]
    ds_read_b64_tr_b16 a[188:189], v66 offset:2048
    buffer_load_dwordx4 v55, s[24:27], s64 offen offset:3072 lds
    v_mfma_f32_16x16x32_bf16 v[212:215], a[140:143], a[184:187], v[212:215]
    ds_read_b64_tr_b16 a[190:191], v66 offset:2304
    s_add_u32 m0, s58, 16384
    v_mfma_f32_16x16x32_bf16 v[196:199], a[140:143], a[176:179], v[196:199]
    ds_read_b128 a[164:167], v46 offset:9216
    v_xor_b32 v52, 128, v52
    v_mfma_f32_16x16x32_bf16 v[224:227], a[180:183], a[144:147], v[224:227]
    ds_read_b128 a[168:171], v46 offset:10240
    v_mfma_f32_16x16x32_bf16 v[232:235], a[184:187], a[144:147], v[232:235]
    ds_read_b128 a[172:175], v46 offset:11264
    buffer_load_dwordx4 v52, s[24:27], s64 offen lds
    v_mfma_f32_16x16x32_bf16 v[216:219], a[176:179], a[144:147], v[216:219]
    v_xor_b32 v53, 128, v53
    v_mfma_f32_16x16x32_bf16 v[228:231], a[180:183], a[148:151], v[228:231]
    v_mfma_f32_16x16x32_bf16 v[236:239], a[184:187], a[148:151], v[236:239]
    v_mfma_f32_16x16x32_bf16 v[220:223], a[176:179], a[148:151], v[220:223]
    buffer_load_dwordx4 v53, s[24:27], s64 offen offset:1024 lds
    ds_read_b32 v24, v4
    s_waitcnt vmcnt(22) lgkmcnt(1)
    s_barrier
    v_mfma_f32_16x16x32_bf16 v[176:179], a[152:155], a[192:195], v[176:179]
    ds_read_b64_tr_b16 a[180:181], v63 offset:32768
    v_xor_b32 v54, 128, v54
    v_mfma_f32_16x16x32_bf16 v[184:187], a[152:155], a[196:199], v[184:187]
    ds_read_b64_tr_b16 a[182:183], v63 offset:33024
    v_mfma_f32_16x16x32_bf16 v[180:183], a[156:159], a[192:195], v[180:183]
    ds_read_b128 a[128:131], v4 offset:32768
    buffer_load_dwordx4 v54, s[24:27], s64 offen offset:2048 lds
    v_mfma_f32_16x16x32_bf16 v[188:191], a[156:159], a[196:199], v[188:191]
    ds_read_b64_tr_b16 a[184:185], v63 offset:33792
    v_mfma_f32_16x16x32_bf16 v[200:203], a[160:163], a[192:195], v[200:203]
    ds_read_b64_tr_b16 a[186:187], v63 offset:34048
    v_xor_b32 v55, 128, v55
    v_mfma_f32_16x16x32_bf16 v[208:211], a[160:163], a[196:199], v[208:211]
    ds_read_b128 a[132:135], v4 offset:33792
    v_mfma_f32_16x16x32_bf16 v[192:195], a[160:163], a[188:191], v[192:195]
    ds_read_b128 a[136:139], v4 offset:34816
    buffer_load_dwordx4 v55, s[24:27], s64 offen offset:3072 lds
    v_mfma_f32_16x16x32_bf16 v[204:207], a[164:167], a[192:195], v[204:207]
    ds_read_b64_tr_b16 a[176:177], v64 offset:32768
    s_add_u32 m0, s58, 65536
    v_mfma_f32_16x16x32_bf16 v[212:215], a[164:167], a[196:199], v[212:215]
    ds_read_b64_tr_b16 a[178:179], v64 offset:33024
    s_add_u32 s64, s64, 524288
    v_mfma_f32_16x16x32_bf16 v[196:199], a[164:167], a[188:191], v[196:199]
    ds_read_b128 a[140:143], v4 offset:35840
    s_cmp_eq_u32 s64, 3670016
    v_mfma_f32_16x16x32_bf16 v[224:227], a[192:195], a[168:171], v[224:227]
    ds_read_b128 a[144:147], v4 offset:36864
    s_cselect_b32 s64, 0, s64
    v_mfma_f32_16x16x32_bf16 v[232:235], a[196:199], a[168:171], v[232:235]
    ds_read_b128 a[148:151], v4 offset:37888
    buffer_load_dwordx4 v52, s[24:27], s64 offen lds
    v_mfma_f32_16x16x32_bf16 v[216:219], a[188:191], a[168:171], v[216:219]
    v_mfma_f32_16x16x32_bf16 v[228:231], a[192:195], a[172:175], v[228:231]
    v_mfma_f32_16x16x32_bf16 v[236:239], a[196:199], a[172:175], v[236:239]
    buffer_load_dwordx4 v53, s[24:27], s64 offen offset:1024 lds
    v_mfma_f32_16x16x32_bf16 v[220:223], a[188:191], a[172:175], v[220:223]
    s_waitcnt lgkmcnt(6)
    v_mfma_f32_16x16x32_bf16 v[176:179], a[128:131], a[180:183], v[176:179]
    ds_read_b64_tr_b16 a[192:193], v63 offset:34816
    v_mfma_f32_16x16x32_bf16 v[184:187], a[128:131], a[184:187], v[184:187]
    ds_read_b64_tr_b16 a[194:195], v63 offset:35072
    buffer_load_dwordx4 v54, s[24:27], s64 offen offset:2048 lds
    v_mfma_f32_16x16x32_bf16 v[180:183], a[132:135], a[180:183], v[180:183]
    ds_read_b128 a[152:155], v4 offset:38912
    v_mfma_f32_16x16x32_bf16 v[188:191], a[132:135], a[184:187], v[188:191]
    ds_read_b64_tr_b16 a[196:197], v63 offset:35840
    s_waitcnt lgkmcnt(4)
    v_mfma_f32_16x16x32_bf16 v[200:203], a[136:139], a[180:183], v[200:203]
    ds_read_b64_tr_b16 a[198:199], v63 offset:36096
    v_mfma_f32_16x16x32_bf16 v[208:211], a[136:139], a[184:187], v[208:211]
    ds_read_b128 a[156:159], v4 offset:39936
    buffer_load_dwordx4 v55, s[24:27], s64 offen offset:3072 lds
    v_mfma_f32_16x16x32_bf16 v[192:195], a[136:139], a[176:179], v[192:195]
    ds_read_b128 a[160:163], v4 offset:40960
    s_add_u32 m0, s58, 81920
    v_mfma_f32_16x16x32_bf16 v[204:207], a[140:143], a[180:183], v[204:207]
    ds_read_b64_tr_b16 a[188:189], v64 offset:34816
    s_add_u32 s64, s64, 524288
    v_mfma_f32_16x16x32_bf16 v[212:215], a[140:143], a[184:187], v[212:215]
    ds_read_b64_tr_b16 a[190:191], v64 offset:35072
    s_cmp_eq_u32 s64, 3670016
    v_mfma_f32_16x16x32_bf16 v[196:199], a[140:143], a[176:179], v[196:199]
    ds_read_b128 a[164:167], v4 offset:41984
    s_cselect_b32 s64, 0, s64
    v_mfma_f32_16x16x32_bf16 v[224:227], a[180:183], a[144:147], v[224:227]
    ds_read_b128 a[168:171], v4 offset:43008
    buffer_load_dwordx4 v52, s[24:27], s64 offen lds
    v_mfma_f32_16x16x32_bf16 v[232:235], a[184:187], a[144:147], v[232:235]
    ds_read_b128 a[172:175], v4 offset:44032
    v_mfma_f32_16x16x32_bf16 v[216:219], a[176:179], a[144:147], v[216:219]
    v_mfma_f32_16x16x32_bf16 v[228:231], a[180:183], a[148:151], v[228:231]
    buffer_load_dwordx4 v53, s[24:27], s64 offen offset:1024 lds
    v_mfma_f32_16x16x32_bf16 v[236:239], a[184:187], a[148:151], v[236:239]
    v_mfma_f32_16x16x32_bf16 v[220:223], a[176:179], a[148:151], v[220:223]
    ds_read_b32 v24, v4
    s_waitcnt vmcnt(22) lgkmcnt(1)
    s_barrier
    v_mfma_f32_16x16x32_bf16 v[176:179], a[152:155], a[192:195], v[176:179]
    ds_read_b64_tr_b16 a[180:181], v65 offset:32768
    buffer_load_dwordx4 v54, s[24:27], s64 offen offset:2048 lds
    v_mfma_f32_16x16x32_bf16 v[184:187], a[152:155], a[196:199], v[184:187]
    ds_read_b64_tr_b16 a[182:183], v65 offset:33024
    v_mfma_f32_16x16x32_bf16 v[180:183], a[156:159], a[192:195], v[180:183]
    ds_read_b128 a[128:131], v46 offset:32768
    v_mfma_f32_16x16x32_bf16 v[188:191], a[156:159], a[196:199], v[188:191]
    ds_read_b64_tr_b16 a[184:185], v65 offset:33792
    v_mfma_f32_16x16x32_bf16 v[200:203], a[160:163], a[192:195], v[200:203]
    ds_read_b64_tr_b16 a[186:187], v65 offset:34048
    buffer_load_dwordx4 v55, s[24:27], s64 offen offset:3072 lds
    v_mfma_f32_16x16x32_bf16 v[208:211], a[160:163], a[196:199], v[208:211]
    ds_read_b128 a[132:135], v46 offset:33792
    s_add_u32 m0, s58, 32768
    v_mfma_f32_16x16x32_bf16 v[192:195], a[160:163], a[188:191], v[192:195]
    ds_read_b128 a[136:139], v46 offset:34816
    s_add_u32 s64, s64, 524288
    v_mfma_f32_16x16x32_bf16 v[204:207], a[164:167], a[192:195], v[204:207]
    ds_read_b64_tr_b16 a[176:177], v66 offset:32768
    s_cmp_eq_u32 s64, 3670016
    v_mfma_f32_16x16x32_bf16 v[212:215], a[164:167], a[196:199], v[212:215]
    ds_read_b64_tr_b16 a[178:179], v66 offset:33024
    s_cselect_b32 s64, 0, s64
    v_mfma_f32_16x16x32_bf16 v[196:199], a[164:167], a[188:191], v[196:199]
    ds_read_b128 a[140:143], v46 offset:35840
    buffer_load_dwordx4 v52, s[24:27], s64 offen lds
    v_mfma_f32_16x16x32_bf16 v[224:227], a[192:195], a[168:171], v[224:227]
    ds_read_b128 a[144:147], v46 offset:36864
    v_mfma_f32_16x16x32_bf16 v[232:235], a[196:199], a[168:171], v[232:235]
    ds_read_b128 a[148:151], v46 offset:37888
    buffer_load_dwordx4 v53, s[24:27], s64 offen offset:1024 lds
    v_mfma_f32_16x16x32_bf16 v[216:219], a[188:191], a[168:171], v[216:219]
    v_mfma_f32_16x16x32_bf16 v[228:231], a[192:195], a[172:175], v[228:231]
    v_mfma_f32_16x16x32_bf16 v[236:239], a[196:199], a[172:175], v[236:239]
    v_mfma_f32_16x16x32_bf16 v[220:223], a[188:191], a[172:175], v[220:223]
    buffer_load_dwordx4 v54, s[24:27], s64 offen offset:2048 lds
    s_waitcnt lgkmcnt(6)
    v_mfma_f32_16x16x32_bf16 v[176:179], a[128:131], a[180:183], v[176:179]
    ds_read_b64_tr_b16 a[192:193], v65 offset:34816
    v_mfma_f32_16x16x32_bf16 v[184:187], a[128:131], a[184:187], v[184:187]
    ds_read_b64_tr_b16 a[194:195], v65 offset:35072
    v_mfma_f32_16x16x32_bf16 v[180:183], a[132:135], a[180:183], v[180:183]
    ds_read_b128 a[152:155], v46 offset:38912
    v_mfma_f32_16x16x32_bf16 v[188:191], a[132:135], a[184:187], v[188:191]
    ds_read_b64_tr_b16 a[196:197], v65 offset:35840
    s_waitcnt lgkmcnt(4)
    v_mfma_f32_16x16x32_bf16 v[200:203], a[136:139], a[180:183], v[200:203]
    ds_read_b64_tr_b16 a[198:199], v65 offset:36096
    buffer_load_dwordx4 v55, s[24:27], s64 offen offset:3072 lds
    v_mfma_f32_16x16x32_bf16 v[208:211], a[136:139], a[184:187], v[208:211]
    ds_read_b128 a[156:159], v46 offset:39936
    s_add_u32 m0, s58, 49152
    v_mfma_f32_16x16x32_bf16 v[192:195], a[136:139], a[176:179], v[192:195]
    ds_read_b128 a[160:163], v46 offset:40960
    s_add_u32 s64, s64, 524288
    v_mfma_f32_16x16x32_bf16 v[204:207], a[140:143], a[180:183], v[204:207]
    ds_read_b64_tr_b16 a[188:189], v66 offset:34816
    s_cmp_eq_u32 s64, 3670016
    v_mfma_f32_16x16x32_bf16 v[212:215], a[140:143], a[184:187], v[212:215]
    ds_read_b64_tr_b16 a[190:191], v66 offset:35072
    s_cselect_b32 s64, 0, s64
    v_mfma_f32_16x16x32_bf16 v[196:199], a[140:143], a[176:179], v[196:199]
    ds_read_b128 a[164:167], v46 offset:41984
    buffer_load_dwordx4 v52, s[24:27], s64 offen lds
    v_mfma_f32_16x16x32_bf16 v[224:227], a[180:183], a[144:147], v[224:227]
    ds_read_b128 a[168:171], v46 offset:43008
    v_mfma_f32_16x16x32_bf16 v[232:235], a[184:187], a[144:147], v[232:235]
    ds_read_b128 a[172:175], v46 offset:44032
    buffer_load_dwordx4 v53, s[24:27], s64 offen offset:1024 lds
    v_mfma_f32_16x16x32_bf16 v[216:219], a[176:179], a[144:147], v[216:219]
    v_mfma_f32_16x16x32_bf16 v[228:231], a[180:183], a[148:151], v[228:231]
    v_mfma_f32_16x16x32_bf16 v[236:239], a[184:187], a[148:151], v[236:239]
    v_mfma_f32_16x16x32_bf16 v[220:223], a[176:179], a[148:151], v[220:223]
    buffer_load_dwordx4 v54, s[24:27], s64 offen offset:2048 lds
    ds_read_b32 v24, v4
    s_waitcnt vmcnt(23) lgkmcnt(1)
    s_barrier
    s_load_dword s14, s[28:29], s38
    v_mfma_f32_16x16x32_bf16 v[176:179], a[152:155], a[192:195], v[176:179]
    ds_read_b64_tr_b16 a[180:181], v67 offset:0
    v_mfma_f32_16x16x32_bf16 v[184:187], a[152:155], a[196:199], v[184:187]
    ds_read_b64_tr_b16 a[182:183], v67 offset:256
    v_mfma_f32_16x16x32_bf16 v[180:183], a[156:159], a[192:195], v[180:183]
    ds_read_b128 a[128:131], v47 offset:0
    buffer_load_dwordx4 v55, s[24:27], s64 offen offset:3072 lds
    v_mfma_f32_16x16x32_bf16 v[188:191], a[156:159], a[196:199], v[188:191]
    ds_read_b64_tr_b16 a[184:185], v67 offset:1024
    v_mfma_f32_16x16x32_bf16 v[200:203], a[160:163], a[192:195], v[200:203]
    ds_read_b64_tr_b16 a[186:187], v67 offset:1280
    s_add_u32 m0, s58, 98304
    v_mfma_f32_16x16x32_bf16 v[208:211], a[160:163], a[196:199], v[208:211]
    ds_read_b128 a[132:135], v47 offset:1024
    s_add_u32 s64, s64, 524288
    v_mfma_f32_16x16x32_bf16 v[192:195], a[160:163], a[188:191], v[192:195]
    ds_read_b128 a[136:139], v47 offset:2048
    s_cmp_eq_u32 s64, 3670016
    v_mfma_f32_16x16x32_bf16 v[204:207], a[164:167], a[192:195], v[204:207]
    ds_read_b64_tr_b16 a[176:177], v68 offset:0
    s_cselect_b32 s64, 0, s64
    v_mfma_f32_16x16x32_bf16 v[212:215], a[164:167], a[196:199], v[212:215]
    ds_read_b64_tr_b16 a[178:179], v68 offset:256
    buffer_load_dwordx4 v52, s[24:27], s64 offen lds
    v_mfma_f32_16x16x32_bf16 v[196:199], a[164:167], a[188:191], v[196:199]
    ds_read_b128 a[140:143], v47 offset:3072
    v_mfma_f32_16x16x32_bf16 v[224:227], a[192:195], a[168:171], v[224:227]
    ds_read_b128 a[144:147], v47 offset:4096
    buffer_load_dwordx4 v53, s[24:27], s64 offen offset:1024 lds
    v_mfma_f32_16x16x32_bf16 v[232:235], a[196:199], a[168:171], v[232:235]
    ds_read_b128 a[148:151], v47 offset:5120
    v_mfma_f32_16x16x32_bf16 v[216:219], a[188:191], a[168:171], v[216:219]
    v_mfma_f32_16x16x32_bf16 v[228:231], a[192:195], a[172:175], v[228:231]
    v_mfma_f32_16x16x32_bf16 v[236:239], a[196:199], a[172:175], v[236:239]
    buffer_load_dwordx4 v54, s[24:27], s64 offen offset:2048 lds
    v_mfma_f32_16x16x32_bf16 v[220:223], a[188:191], a[172:175], v[220:223]
    s_waitcnt lgkmcnt(6)
    v_mfma_f32_16x16x32_bf16 v[176:179], a[128:131], a[180:183], v[176:179]
    ds_read_b64_tr_b16 a[192:193], v67 offset:2048
    v_mfma_f32_16x16x32_bf16 v[184:187], a[128:131], a[184:187], v[184:187]
    ds_read_b64_tr_b16 a[194:195], v67 offset:2304
    v_mfma_f32_16x16x32_bf16 v[180:183], a[132:135], a[180:183], v[180:183]
    ds_read_b128 a[152:155], v47 offset:6144
    buffer_load_dwordx4 v55, s[24:27], s64 offen offset:3072 lds
    v_mfma_f32_16x16x32_bf16 v[188:191], a[132:135], a[184:187], v[188:191]
    ds_read_b64_tr_b16 a[196:197], v67 offset:3072
    s_waitcnt lgkmcnt(4)
    v_mfma_f32_16x16x32_bf16 v[200:203], a[136:139], a[180:183], v[200:203]
    ds_read_b64_tr_b16 a[198:199], v67 offset:3328
    s_add_u32 m0, s58, 114688
    v_mfma_f32_16x16x32_bf16 v[208:211], a[136:139], a[184:187], v[208:211]
    ds_read_b128 a[156:159], v47 offset:7168
    s_add_u32 s64, s64, 524288
    v_mfma_f32_16x16x32_bf16 v[192:195], a[136:139], a[176:179], v[192:195]
    ds_read_b128 a[160:163], v47 offset:8192
    s_cmp_eq_u32 s64, 3670016
    v_mfma_f32_16x16x32_bf16 v[204:207], a[140:143], a[180:183], v[204:207]
    ds_read_b64_tr_b16 a[188:189], v68 offset:2048
    s_cselect_b32 s64, 0, s64
    v_mfma_f32_16x16x32_bf16 v[212:215], a[140:143], a[184:187], v[212:215]
    ds_read_b64_tr_b16 a[190:191], v68 offset:2304
    buffer_load_dwordx4 v52, s[24:27], s64 offen lds
    v_mfma_f32_16x16x32_bf16 v[196:199], a[140:143], a[176:179], v[196:199]
    ds_read_b128 a[164:167], v47 offset:9216
    v_mfma_f32_16x16x32_bf16 v[224:227], a[180:183], a[144:147], v[224:227]
    ds_read_b128 a[168:171], v47 offset:10240
    buffer_load_dwordx4 v53, s[24:27], s64 offen offset:1024 lds
    v_mfma_f32_16x16x32_bf16 v[232:235], a[184:187], a[144:147], v[232:235]
    ds_read_b128 a[172:175], v47 offset:11264
    v_mfma_f32_16x16x32_bf16 v[216:219], a[176:179], a[144:147], v[216:219]
    v_mfma_f32_16x16x32_bf16 v[228:231], a[180:183], a[148:151], v[228:231]
    v_mfma_f32_16x16x32_bf16 v[236:239], a[184:187], a[148:151], v[236:239]
    buffer_load_dwordx4 v54, s[24:27], s64 offen offset:2048 lds
    v_mfma_f32_16x16x32_bf16 v[220:223], a[176:179], a[148:151], v[220:223]
    ds_read_b32 v24, v4
    s_waitcnt lgkmcnt(1)
    s_barrier
    v_mfma_f32_16x16x32_bf16 v[176:179], a[152:155], a[192:195], v[176:179]
    v_mfma_f32_16x16x32_bf16 v[184:187], a[152:155], a[196:199], v[184:187]
    v_mfma_f32_16x16x32_bf16 v[180:183], a[156:159], a[192:195], v[180:183]
    buffer_load_dwordx4 v55, s[24:27], s64 offen offset:3072 lds
    s_add_u32 m0, s58, 131072
    v_mfma_f32_16x16x32_bf16 v[188:191], a[156:159], a[196:199], v[188:191]
    s_add_u32 s64, s64, 524288
    v_mfma_f32_16x16x32_bf16 v[200:203], a[160:163], a[192:195], v[200:203]
    s_cmp_eq_u32 s64, 3670016
    s_cselect_b32 s64, 0, s64
    v_mfma_f32_16x16x32_bf16 v[208:211], a[160:163], a[196:199], v[208:211]
    s_add_u32 s64, s64, 524288
    s_cmp_eq_u32 s64, 3670016
    v_mfma_f32_16x16x32_bf16 v[192:195], a[160:163], a[188:191], v[192:195]
    s_cselect_b32 s64, 0, s64
    v_xor_b32 v52, 128, v52
    v_mfma_f32_16x16x32_bf16 v[204:207], a[164:167], a[192:195], v[204:207]
    buffer_load_dwordx4 v52, s[24:27], s64 offen lds
    v_xor_b32 v53, 128, v53
    v_mfma_f32_16x16x32_bf16 v[212:215], a[164:167], a[196:199], v[212:215]
    v_mfma_f32_16x16x32_bf16 v[196:199], a[164:167], a[188:191], v[196:199]
    buffer_load_dwordx4 v53, s[24:27], s64 offen offset:1024 lds
    v_xor_b32 v54, 128, v54
    v_mfma_f32_16x16x32_bf16 v[224:227], a[192:195], a[168:171], v[224:227]
    v_mfma_f32_16x16x32_bf16 v[232:235], a[196:199], a[168:171], v[232:235]
    v_mfma_f32_16x16x32_bf16 v[216:219], a[188:191], a[168:171], v[216:219]
    v_mfma_f32_16x16x32_bf16 v[228:231], a[192:195], a[172:175], v[228:231]
    buffer_load_dwordx4 v54, s[24:27], s64 offen offset:2048 lds
    v_xor_b32 v55, 128, v55
    v_mfma_f32_16x16x32_bf16 v[236:239], a[196:199], a[172:175], v[236:239]
    v_mfma_f32_16x16x32_bf16 v[220:223], a[188:191], a[172:175], v[220:223]
    s_cmp_eq_u32 s56, 0
    s_cbranch_scc1 L_pollok5
    s_waitcnt lgkmcnt(0)
    s_cmp_eq_u32 s14, 7
    s_cbranch_scc1 L_pollok5
    s_mov_b32 s60, 0
L_poll5:
    s_sleep 8
    buffer_load_dword v18, off, s[28:31], s38 sc1
    s_add_u32 s60, s60, 1
    s_waitcnt vmcnt(0)
    v_readfirstlane_b32 s14, v18
    s_nop 0
    s_cmp_eq_u32 s14, 7
    s_cbranch_scc1 L_pollok5
    s_cmp_lt_u32 s60, 20000
    s_cbranch_scc1 L_poll5
L_pollok5:
    v_cvt_pk_bf16_f32 v112, v176, v177
    v_cvt_pk_bf16_f32 v113, v178, v179
    buffer_load_dwordx4 v55, s[24:27], s64 offen offset:3072 lds
    v_cvt_pk_bf16_f32 v114, v180, v181
    v_cvt_pk_bf16_f32 v115, v182, v183
    v_cvt_pk_bf16_f32 v116, v184, v185
    v_cvt_pk_bf16_f32 v117, v186, v187
    v_cvt_pk_bf16_f32 v118, v188, v189
    v_cvt_pk_bf16_f32 v119, v190, v191
    v_cvt_pk_bf16_f32 v124, v200, v201
    v_cvt_pk_bf16_f32 v125, v202, v203
    v_cvt_pk_bf16_f32 v126, v204, v205
    v_cvt_pk_bf16_f32 v127, v206, v207
    v_cvt_pk_bf16_f32 v128, v208, v209
    v_cvt_pk_bf16_f32 v129, v210, v211
    v_cvt_pk_bf16_f32 v130, v212, v213
    v_cvt_pk_bf16_f32 v131, v214, v215
    v_cvt_pk_bf16_f32 v120, v192, v193
    s_add_u32 m0, s58, 147456
    s_add_u32 s64, s64, 524288
    s_cmp_eq_u32 s64, 3670016
    s_cselect_b32 s64, 0, s64
    buffer_load_dwordx4 v52, s[24:27], s64 offen lds
    v_cvt_pk_bf16_f32 v121, v194, v195
    v_cvt_pk_bf16_f32 v122, v196, v197
    v_cvt_pk_bf16_f32 v123, v198, v199
    v_mfma_f32_16x16x32_bf16 v[148:151], v[124:127], v[112:115], 0
    v_mfma_f32_16x16x32_bf16 v[152:155], v[124:127], v[116:119], 0
    v_mfma_f32_16x16x32_bf16 v[156:159], v[128:131], v[116:119], 0
    buffer_load_dwordx4 v53, s[24:27], s64 offen offset:1024 lds
    v_mfma_f32_16x16x32_bf16 v[144:147], v[120:123], v[112:115], 0
    v_cvt_pk_bf16_f32 v160, v216, v217
    v_cvt_pk_bf16_f32 v161, v218, v219
    v_cvt_pk_bf16_f32 v162, v224, v225
    v_cvt_pk_bf16_f32 v163, v226, v227
    v_cvt_pk_bf16_f32 v164, v232, v233
    v_cvt_pk_bf16_f32 v165, v234, v235
    v_cndmask_b32 v244, v152, v153, s[70:71]
    v_cndmask_b32 v247, v156, v157, s[70:71]
    v_cndmask_b32 v244, v244, v247, s[72:73]
    v_mul_f32 v244, v244, v29
    v_cndmask_b32 v245, v154, v155, s[70:71]
    buffer_load_dwordx4 v54, s[24:27], s64 offen offset:2048 lds
    v_cndmask_b32 v247, v158, v159, s[70:71]
    v_cndmask_b32 v245, v245, v247, s[74:75]
    v_mul_f32 v245, v245, v30
    v_cndmask_b32 v240, v144, v145, s[70:71]
    v_cndmask_b32 v240, v77, v240, s[76:77]
    v_cndmask_b32 v243, v148, v149, s[70:71]
    v_cndmask_b32 v240, v240, v243, s[72:73]
    v_mul_f32 v240, v240, v27
    v_cndmask_b32 v241, v146, v147, s[70:71]
    v_cndmask_b32 v241, v77, v241, s[76:77]
    v_cndmask_b32 v243, v150, v151, s[70:71]
    v_cndmask_b32 v241, v241, v243, s[74:75]
    v_mul_f32 v241, v241, v28
    v_max_f32 v242, v240, v241
    v_max_f32 v246, v244, v245
    buffer_load_dwordx4 v55, s[24:27], s64 offen offset:3072 lds
    v_mov_b32 v243, v242
    v_mov_b32 v247, v246
    v_cvt_pk_bf16_f32 v166, v220, v221
    v_permlane16_swap_b32 v242, v243
    v_permlane16_swap_b32 v246, v247
    v_max_f32 v242, v242, v243
    v_max_f32 v246, v246, v247
    v_mov_b32 v243, v242
    v_mov_b32 v247, v246
    v_cvt_pk_bf16_f32 v167, v222, v223
    v_permlane32_swap_b32 v242, v243
    v_permlane32_swap_b32 v246, v247
    v_max_f32 v242, v242, v243
    v_max_f32 v246, v246, v247
    v_mul_f32 v242, v25, v242
    buffer_load_dwordx4 a[0:3], v72, s[28:31], s65 offen offset:0 sc1
    v_mul_f32 v246, v26, v246
    v_fma_f32 v240, v240, v25, -v242
    v_fma_f32 v241, v241, v25, -v242
    v_fma_f32 v244, v244, v26, -v246
    v_fma_f32 v245, v245, v26, -v246
    v_exp_f32 v240, v240
    v_exp_f32 v241, v241
    v_exp_f32 v244, v244
    v_exp_f32 v245, v245
    v_add_f32 v242, v240, v241
    buffer_load_dwordx4 a[4:7], v72, s[28:31], s65 offen offset:1024 sc1
    v_add_f32 v246, v244, v245
    v_mov_b32 v243, v242
    v_mov_b32 v247, v246
    v_cvt_pk_bf16_f32 v168, v228, v229
    v_permlane16_swap_b32 v242, v243
    v_permlane16_swap_b32 v246, v247
    v_add_f32 v242, v242, v243
    v_add_f32 v246, v246, v247
    v_mov_b32 v243, v242
    v_mov_b32 v247, v246
    v_cvt_pk_bf16_f32 v169, v230, v231
    v_permlane32_swap_b32 v242, v243
    v_permlane32_swap_b32 v246, v247
    v_add_f32 v242, v242, v243
    buffer_load_dwordx4 a[8:11], v72, s[28:31], s65 offen offset:2048 sc1
    v_add_f32 v246, v246, v247
    v_rcp_f32 v242, v242
    v_rcp_f32 v246, v246
    v_cvt_pk_bf16_f32 v170, v236, v237
    v_cvt_pk_bf16_f32 v171, v238, v239
    v_mul_f32 v240, v240, v27
    v_mul_f32 v241, v241, v28
    v_mul_f32 v244, v244, v29
    v_mul_f32 v245, v245, v30
    v_mul_f32 v240, v240, v242
    v_mul_f32 v241, v241, v242
    v_mul_f32 v244, v244, v246
    buffer_load_dwordx4 a[12:15], v72, s[28:31], s65 offen offset:3072 sc1
    v_mul_f32 v245, v245, v246
    v_cvt_pk_bf16_f32 v240, v240, v240
    v_cvt_pk_bf16_f32 v241, v241, v241
    v_cvt_pk_bf16_f32 v244, v244, v244
    v_cvt_pk_bf16_f32 v245, v245, v245
    v_and_b32 v132, v240, v98
    v_and_b32 v133, v241, v99
    v_and_b32 v134, v240, v100
    v_and_b32 v135, v241, v101
    v_and_b32 v136, v244, v98
    v_and_b32 v137, v245, v99
    v_and_b32 v138, v244, v100
    v_and_b32 v139, v245, v101
    v_mfma_f32_16x16x32_bf16 v[176:179], v[160:163], v[132:135], 0
    s_add_u32 s65, s65, 8192
    s_cmp_eq_u32 s65, 57344
    s_cselect_b32 s65, 0, s65
    buffer_load_dwordx4 a[16:19], v72, s[28:31], s65 offen offset:0 sc1
    v_mfma_f32_16x16x32_bf16 v[180:183], v[166:169], v[132:135], 0
    v_mfma_f32_16x16x32_bf16 v[184:187], v[162:165], v[136:139], 0
    v_mfma_f32_16x16x32_bf16 v[188:191], v[168:171], v[136:139], 0
    buffer_load_dwordx4 a[20:23], v72, s[28:31], s65 offen offset:1024 sc1
    s_add_u32 s83, s82, 16384
    v_cvt_pk_bf16_f32 v104, v176, v177
    v_cvt_pk_bf16_f32 v105, v178, v179
    s_nop 1
    v_cvt_pk_bf16_f32 v106, v180, v181
    v_cvt_pk_bf16_f32 v107, v182, v183
    v_cvt_pk_bf16_f32 v108, v184, v185
    v_cvt_pk_bf16_f32 v109, v186, v187
    v_cvt_pk_bf16_f32 v110, v188, v189
    v_cvt_pk_bf16_f32 v111, v190, v191
    s_cmp_lg_u32 s56, 0
    s_cbranch_scc1 L_f
    buffer_store_dwordx4 v[104:107], v4, s[28:31], s82 offen sc1
    buffer_store_dwordx4 v[108:111], v4, s[28:31], s83 offen sc1
    s_waitcnt vmcnt(0)
    s_barrier
    s_cmp_lg_u32 s48, 0
    s_cbranch_scc1 L_sig3
    s_atomic_add s36, s[28:29], s69
L_sig3:
    v_lshlrev_b32 v15, 7, v1
    s_lshl_b32 s3, s54, 2
    s_add_u32 s3, s3, s48
    s_mul_i32 s3, s3, 25088
    buffer_load_dword v176, v15, s[16:19], s3 offen
    s_add_u32 s3, s3, 5632
    buffer_load_dword v177, v15, s[16:19], s3 offen
    s_add_u32 s3, s3, 5632
    buffer_load_dword v178, v15, s[16:19], s3 offen
    s_add_u32 s3, s3, 5632
    buffer_load_dword v179, v15, s[16:19], s3 offen
    s_add_u32 s3, s3, 5632
    s_branch L_fin
L_f:
    buffer_store_dwordx4 v[104:107], v4, s[28:31], s82 offen sc1
    buffer_store_dwordx4 v[108:111], v4, s[28:31], s83 offen sc1
    buffer_load_dwordx4 a[24:27], v72, s[28:31], s65 offen offset:2048 sc1
    buffer_load_dwordx4 a[28:31], v72, s[28:31], s65 offen offset:3072 sc1
    s_add_u32 s65, s65, 8192
    s_cmp_eq_u32 s65, 57344
    s_cselect_b32 s65, 0, s65
    buffer_load_dwordx4 a[32:35], v72, s[28:31], s65 offen offset:0 sc1
    buffer_load_dwordx4 a[36:39], v72, s[28:31], s65 offen offset:1024 sc1
    buffer_load_dwordx4 a[40:43], v72, s[28:31], s65 offen offset:2048 sc1
    buffer_load_dwordx4 a[44:47], v72, s[28:31], s65 offen offset:3072 sc1
    s_waitcnt vmcnt(14)
    s_barrier
    ds_read_b64_tr_b16 v[112:113], v31 offset:16384
    ds_read_b64_tr_b16 v[114:115], v31 offset:17408
    ds_read_b64_tr_b16 v[116:117], v32 offset:16384
    ds_read_b64_tr_b16 v[118:119], v32 offset:17408
    ds_read_b64_tr_b16 v[120:121], v31 offset:18432
    ds_read_b64_tr_b16 v[122:123], v31 offset:19456
    ds_read_b64_tr_b16 v[124:125], v32 offset:18432
    ds_read_b64_tr_b16 v[126:127], v32 offset:19456
    ds_read_b64_tr_b16 v[128:129], v31 offset:20480
    ds_read_b64_tr_b16 v[130:131], v31 offset:21504
    ds_read_b64_tr_b16 v[132:133], v32 offset:20480
    ds_read_b64_tr_b16 v[134:135], v32 offset:21504
    s_waitcnt vmcnt(13) lgkmcnt(8)
    v_mfma_f32_32x32x16_bf16 v[176:191], a[0:3], v[112:115], 0
    ds_read_b64_tr_b16 v[136:137], v31 offset:22528
    ds_read_b64_tr_b16 v[138:139], v31 offset:23552
    v_lshlrev_b32 v88, 16, v88
    v_mfma_f32_32x32x16_bf16 v[232:247], a[0:3], v[116:119], 0
    s_add_u32 s65, s65, 8192
    s_cmp_eq_u32 s65, 57344
    s_cselect_b32 s65, 0, s65
    buffer_load_dwordx4 a[48:51], v72, s[28:31], s65 offen offset:0 sc1
    ds_read_b64_tr_b16 v[140:141], v32 offset:22528
    ds_read_b64_tr_b16 v[142:143], v32 offset:23552
    v_lshlrev_b32 v216, 16, v90
    s_waitcnt vmcnt(13) lgkmcnt(8)
    v_mfma_f32_32x32x16_bf16 v[176:191], a[4:7], v[120:123], v[176:191]
    ds_read_b64_tr_b16 v[112:113], v33 offset:0
    ds_read_b64_tr_b16 v[114:115], v33 offset:1024
    v_and_b32 v217, 0xffff0000, v90
    buffer_load_dwordx4 a[52:55], v72, s[28:31], s65 offen offset:1024 sc1
    v_mfma_f32_32x32x16_bf16 v[232:247], a[4:7], v[124:127], v[232:247]
    ds_read_b64_tr_b16 v[116:117], v34 offset:0
    ds_read_b64_tr_b16 v[118:119], v34 offset:1024
    v_add_f32 v216, v216, v88
    s_waitcnt vmcnt(13) lgkmcnt(8)
    v_mfma_f32_32x32x16_bf16 v[176:191], a[8:11], v[128:131], v[176:191]
    buffer_load_dwordx4 a[56:59], v72, s[28:31], s65 offen offset:2048 sc1
    ds_read_b64_tr_b16 v[120:121], v33 offset:2048
    ds_read_b64_tr_b16 v[122:123], v33 offset:3072
    v_add_f32 v217, v217, v88
    v_mfma_f32_32x32x16_bf16 v[232:247], a[8:11], v[132:135], v[232:247]
    ds_read_b64_tr_b16 v[124:125], v34 offset:2048
    ds_read_b64_tr_b16 v[126:127], v34 offset:3072
    v_lshlrev_b32 v218, 16, v91
    s_waitcnt vmcnt(13) lgkmcnt(8)
    v_mfma_f32_32x32x16_bf16 v[176:191], a[12:15], v[136:139], v[176:191]
    buffer_load_dwordx4 a[60:63], v72, s[28:31], s65 offen offset:3072 sc1
    ds_read_b64_tr_b16 v[128:129], v33 offset:4096
    ds_read_b64_tr_b16 v[130:131], v33 offset:5120
    v_and_b32 v219, 0xffff0000, v91
    v_mfma_f32_32x32x16_bf16 v[232:247], a[12:15], v[140:143], v[232:247]
    s_add_u32 s65, s65, 8192
    s_cmp_eq_u32 s65, 57344
    s_cselect_b32 s65, 0, s65
    buffer_load_dwordx4 a[64:67], v72, s[28:31], s65 offen offset:0 sc1
    ds_read_b64_tr_b16 v[132:133], v34 offset:4096
    ds_read_b64_tr_b16 v[134:135], v34 offset:5120
    v_add_f32 v218, v218, v88
    s_waitcnt vmcnt(14) lgkmcnt(8)
    v_mfma_f32_32x32x16_bf16 v[176:191], a[16:19], v[112:115], v[176:191]
    ds_read_b64_tr_b16 v[136:137], v33 offset:6144
    ds_read_b64_tr_b16 v[138:139], v33 offset:7168
    v_add_f32 v219, v219, v88
    v_mfma_f32_32x32x16_bf16 v[232:247], a[16:19], v[116:119], v[232:247]
    buffer_load_dwordx4 a[68:71], v72, s[28:31], s65 offen offset:1024 sc1
    ds_read_b64_tr_b16 v[140:141], v34 offset:6144
    ds_read_b64_tr_b16 v[142:143], v34 offset:7168
    v_lshlrev_b32 v220, 16, v92
    s_waitcnt vmcnt(14) lgkmcnt(8)
    v_mfma_f32_32x32x16_bf16 v[176:191], a[20:23], v[120:123], v[176:191]
    buffer_load_dwordx4 a[72:75], v72, s[28:31], s65 offen offset:2048 sc1
    ds_read_b64_tr_b16 v[112:113], v33 offset:16384
    ds_read_b64_tr_b16 v[114:115], v33 offset:17408
    v_and_b32 v221, 0xffff0000, v92
    v_mfma_f32_32x32x16_bf16 v[232:247], a[20:23], v[124:127], v[232:247]
    ds_read_b64_tr_b16 v[116:117], v34 offset:16384
    ds_read_b64_tr_b16 v[118:119], v34 offset:17408
    v_add_f32 v220, v220, v88
    s_waitcnt vmcnt(12) lgkmcnt(8)
    v_mfma_f32_32x32x16_bf16 v[176:191], a[24:27], v[128:131], v[176:191]
    buffer_load_dwordx4 a[76:79], v72, s[28:31], s65 offen offset:3072 sc1
    ds_read_b64_tr_b16 v[120:121], v33 offset:18432
    ds_read_b64_tr_b16 v[122:123], v33 offset:19456
    v_add_f32 v221, v221, v88
    v_mfma_f32_32x32x16_bf16 v[232:247], a[24:27], v[132:135], v[232:247]
    s_add_u32 s65, s65, 8192
    s_cmp_eq_u32 s65, 57344
    s_cselect_b32 s65, 0, s65
    buffer_load_dwordx4 a[80:83], v72, s[28:31], s65 offen offset:0 sc1
    ds_read_b64_tr_b16 v[124:125], v34 offset:18432
    ds_read_b64_tr_b16 v[126:127], v34 offset:19456
    v_lshlrev_b32 v222, 16, v93
    s_waitcnt vmcnt(13) lgkmcnt(8)
    v_mfma_f32_32x32x16_bf16 v[176:191], a[28:31], v[136:139], v[176:191]
    ds_read_b64_tr_b16 v[128:129], v33 offset:20480
    ds_read_b64_tr_b16 v[130:131], v33 offset:21504
    v_and_b32 v223, 0xffff0000, v93
    v_mfma_f32_32x32x16_bf16 v[232:247], a[28:31], v[140:143], v[232:247]
    buffer_load_dwordx4 a[84:87], v72, s[28:31], s65 offen offset:1024 sc1
    ds_read_b64_tr_b16 v[132:133], v34 offset:20480
    ds_read_b64_tr_b16 v[134:135], v34 offset:21504
    v_add_f32 v222, v222, v88
    s_waitcnt vmcnt(13) lgkmcnt(8)
    v_mfma_f32_32x32x16_bf16 v[176:191], a[32:35], v[112:115], v[176:191]
    ds_read_b64_tr_b16 v[136:137], v33 offset:22528
    ds_read_b64_tr_b16 v[138:139], v33 offset:23552
    v_add_f32 v223, v223, v88
    buffer_load_dwordx4 a[88:91], v72, s[28:31], s65 offen offset:2048 sc1
    v_mfma_f32_32x32x16_bf16 v[232:247], a[32:35], v[116:119], v[232:247]
    ds_read_b64_tr_b16 v[140:141], v34 offset:22528
    ds_read_b64_tr_b16 v[142:143], v34 offset:23552
    v_lshlrev_b32 v89, 16, v89
    s_waitcnt vmcnt(13) lgkmcnt(8)
    v_mfma_f32_32x32x16_bf16 v[176:191], a[36:39], v[120:123], v[176:191]
    buffer_load_dwordx4 a[92:95], v72, s[28:31], s65 offen offset:3072 sc1
    s_barrier
    s_cmp_lg_u32 s48, 0
    s_cbranch_scc1 L_sig4
    s_atomic_add s36, s[28:29], s69
L_sig4:
    ds_read_b64_tr_b16 v[112:113], v31 offset:32768
    ds_read_b64_tr_b16 v[114:115], v31 offset:33792
    v_lshlrev_b32 v224, 16, v94
    v_mfma_f32_32x32x16_bf16 v[232:247], a[36:39], v[124:127], v[232:247]
    s_add_u32 s65, s65, 8192
    s_cmp_eq_u32 s65, 57344
    s_cselect_b32 s65, 0, s65
    buffer_load_dwordx4 a[96:99], v72, s[28:31], s65 offen offset:0 sc1
    ds_read_b64_tr_b16 v[116:117], v32 offset:32768
    ds_read_b64_tr_b16 v[118:119], v32 offset:33792
    v_and_b32 v225, 0xffff0000, v94
    s_waitcnt vmcnt(14) lgkmcnt(8)
    v_mfma_f32_32x32x16_bf16 v[176:191], a[40:43], v[128:131], v[176:191]
    ds_read_b64_tr_b16 v[120:121], v31 offset:34816
    ds_read_b64_tr_b16 v[122:123], v31 offset:35840
    v_add_f32 v224, v224, v89
    v_mfma_f32_32x32x16_bf16 v[232:247], a[40:43], v[132:135], v[232:247]
    buffer_load_dwordx4 a[100:103], v72, s[28:31], s65 offen offset:1024 sc1
    ds_read_b64_tr_b16 v[124:125], v32 offset:34816
    ds_read_b64_tr_b16 v[126:127], v32 offset:35840
    v_add_f32 v225, v225, v89
    s_waitcnt vmcnt(14) lgkmcnt(8)
    v_mfma_f32_32x32x16_bf16 v[176:191], a[44:47], v[136:139], v[176:191]
    buffer_load_dwordx4 a[104:107], v72, s[28:31], s65 offen offset:2048 sc1
    ds_read_b64_tr_b16 v[128:129], v31 offset:36864
    ds_read_b64_tr_b16 v[130:131], v31 offset:37888
    v_lshlrev_b32 v226, 16, v95
    v_mfma_f32_32x32x16_bf16 v[232:247], a[44:47], v[140:143], v[232:247]
    ds_read_b64_tr_b16 v[132:133], v32 offset:36864
    ds_read_b64_tr_b16 v[134:135], v32 offset:37888
    v_and_b32 v227, 0xffff0000, v95
    s_waitcnt vmcnt(14) lgkmcnt(8)
    v_mfma_f32_32x32x16_bf16 v[176:191], a[48:51], v[112:115], v[176:191]
    buffer_load_dwordx4 a[108:111], v72, s[28:31], s65 offen offset:3072 sc1
    ds_read_b64_tr_b16 v[136:137], v31 offset:38912
    ds_read_b64_tr_b16 v[138:139], v31 offset:39936
    v_add_f32 v226, v226, v89
    v_mfma_f32_32x32x16_bf16 v[232:247], a[48:51], v[116:119], v[232:247]
    s_add_u32 m0, s58, 16384
    s_add_u32 s64, s64, 524288
    s_cmp_eq_u32 s64, 3670016
    s_cselect_b32 s64, 0, s64
    buffer_load_dwordx4 v52, s[24:27], s64 offen lds
    ds_read_b64_tr_b16 v[140:141], v32 offset:38912
    ds_read_b64_tr_b16 v[142:143], v32 offset:39936
    v_add_f32 v227, v227, v89
    s_waitcnt vmcnt(15) lgkmcnt(8)
    v_mfma_f32_32x32x16_bf16 v[176:191], a[52:55], v[120:123], v[176:191]
    ds_read_b64_tr_b16 v[112:113], v31 offset:49152
    ds_read_b64_tr_b16 v[114:115], v31 offset:50176
    v_lshlrev_b32 v228, 16, v96
    v_mfma_f32_32x32x16_bf16 v[232:247], a[52:55], v[124:127], v[232:247]
    buffer_load_dwordx4 v53, s[24:27], s64 offen offset:1024 lds
    ds_read_b64_tr_b16 v[116:117], v32 offset:49152
    ds_read_b64_tr_b16 v[118:119], v32 offset:50176
    v_and_b32 v229, 0xffff0000, v96
    s_waitcnt vmcnt(15) lgkmcnt(8)
    v_mfma_f32_32x32x16_bf16 v[176:191], a[56:59], v[128:131], v[176:191]
    ds_read_b64_tr_b16 v[120:121], v31 offset:51200
    ds_read_b64_tr_b16 v[122:123], v31 offset:52224
    v_add_f32 v228, v228, v89
    buffer_load_dwordx4 v54, s[24:27], s64 offen offset:2048 lds
    v_mfma_f32_32x32x16_bf16 v[232:247], a[56:59], v[132:135], v[232:247]
    ds_read_b64_tr_b16 v[124:125], v32 offset:51200
    ds_read_b64_tr_b16 v[126:127], v32 offset:52224
    v_add_f32 v229, v229, v89
    s_waitcnt vmcnt(15) lgkmcnt(8)
    v_mfma_f32_32x32x16_bf16 v[176:191], a[60:63], v[136:139], v[176:191]
    buffer_load_dwordx4 v55, s[24:27], s64 offen offset:3072 lds
    ds_read_b64_tr_b16 v[128:129], v31 offset:53248
    ds_read_b64_tr_b16 v[130:131], v31 offset:54272
    v_lshlrev_b32 v230, 16, v97
    v_mfma_f32_32x32x16_bf16 v[232:247], a[60:63], v[140:143], v[232:247]
    ds_read_b64_tr_b16 v[132:133], v32 offset:53248
    ds_read_b64_tr_b16 v[134:135], v32 offset:54272
    v_and_b32 v231, 0xffff0000, v97
    s_waitcnt vmcnt(15) lgkmcnt(8)
    v_mfma_f32_32x32x16_bf16 v[176:191], a[64:67], v[112:115], v[176:191]
    s_add_u32 m0, s58, 65536
    s_add_u32 s64, s64, 524288
    s_cmp_eq_u32 s64, 3670016
    s_cselect_b32 s64, 0, s64
    buffer_load_dwordx4 v52, s[24:27], s64 offen lds
    ds_read_b64_tr_b16 v[136:137], v31 offset:55296
    ds_read_b64_tr_b16 v[138:139], v31 offset:56320
    v_add_f32 v230, v230, v89
    v_mfma_f32_32x32x16_bf16 v[232:247], a[64:67], v[116:119], v[232:247]
    buffer_load_dwordx4 v53, s[24:27], s64 offen offset:1024 lds
    ds_read_b64_tr_b16 v[140:141], v32 offset:55296
    ds_read_b64_tr_b16 v[142:143], v32 offset:56320
    v_add_f32 v231, v231, v89
    s_waitcnt vmcnt(16) lgkmcnt(8)
    v_mfma_f32_32x32x16_bf16 v[176:191], a[68:71], v[120:123], v[176:191]
    s_barrier
    ds_read_b64_tr_b16 v[112:113], v33 offset:32768
    ds_read_b64_tr_b16 v[114:115], v33 offset:33792
    v_mfma_f32_32x32x16_bf16 v[232:247], a[68:71], v[124:127], v[232:247]
    buffer_load_dwordx4 v54, s[24:27], s64 offen offset:2048 lds
    ds_read_b64_tr_b16 v[116:117], v34 offset:32768
    ds_read_b64_tr_b16 v[118:119], v34 offset:33792
    s_waitcnt vmcnt(16) lgkmcnt(8)
    v_mfma_f32_32x32x16_bf16 v[176:191], a[72:75], v[128:131], v[176:191]
    buffer_load_dwordx4 v55, s[24:27], s64 offen offset:3072 lds
    ds_read_b64_tr_b16 v[120:121], v33 offset:34816
    ds_read_b64_tr_b16 v[122:123], v33 offset:35840
    v_mfma_f32_32x32x16_bf16 v[232:247], a[72:75], v[132:135], v[232:247]
    ds_read_b64_tr_b16 v[124:125], v34 offset:34816
    ds_read_b64_tr_b16 v[126:127], v34 offset:35840
    s_waitcnt vmcnt(16) lgkmcnt(8)
    v_mfma_f32_32x32x16_bf16 v[176:191], a[76:79], v[136:139], v[176:191]
    s_add_u32 m0, s58, 81920
    s_add_u32 s64, s64, 524288
    s_cmp_eq_u32 s64, 3670016
    s_cselect_b32 s64, 0, s64
    buffer_load_dwordx4 v52, s[24:27], s64 offen lds
    ds_read_b64_tr_b16 v[128:129], v33 offset:36864
    ds_read_b64_tr_b16 v[130:131], v33 offset:37888
    v_mfma_f32_32x32x16_bf16 v[232:247], a[76:79], v[140:143], v[232:247]
    ds_read_b64_tr_b16 v[132:133], v34 offset:36864
    ds_read_b64_tr_b16 v[134:135], v34 offset:37888
    s_waitcnt vmcnt(16) lgkmcnt(8)
    v_mfma_f32_32x32x16_bf16 v[176:191], a[80:83], v[112:115], v[176:191]
    buffer_load_dwordx4 v53, s[24:27], s64 offen offset:1024 lds
    ds_read_b64_tr_b16 v[136:137], v33 offset:38912
    ds_read_b64_tr_b16 v[138:139], v33 offset:39936
    v_mfma_f32_32x32x16_bf16 v[232:247], a[80:83], v[116:119], v[232:247]
    ds_read_b64_tr_b16 v[140:141], v34 offset:38912
    ds_read_b64_tr_b16 v[142:143], v34 offset:39936
    s_waitcnt vmcnt(16) lgkmcnt(8)
    v_mfma_f32_32x32x16_bf16 v[176:191], a[84:87], v[120:123], v[176:191]
    buffer_load_dwordx4 v54, s[24:27], s64 offen offset:2048 lds
    ds_read_b64_tr_b16 v[112:113], v33 offset:49152
    ds_read_b64_tr_b16 v[114:115], v33 offset:50176
    v_mfma_f32_32x32x16_bf16 v[232:247], a[84:87], v[124:127], v[232:247]
    buffer_load_dwordx4 v55, s[24:27], s64 offen offset:3072 lds
    ds_read_b64_tr_b16 v[116:117], v34 offset:49152
    ds_read_b64_tr_b16 v[118:119], v34 offset:50176
    s_waitcnt vmcnt(17) lgkmcnt(8)
    v_mfma_f32_32x32x16_bf16 v[176:191], a[88:91], v[128:131], v[176:191]
    ds_read_b64_tr_b16 v[120:121], v33 offset:51200
    ds_read_b64_tr_b16 v[122:123], v33 offset:52224
    v_mfma_f32_32x32x16_bf16 v[232:247], a[88:91], v[132:135], v[232:247]
    s_add_u32 m0, s58, 32768
    s_add_u32 s64, s64, 524288
    s_cmp_eq_u32 s64, 3670016
    s_cselect_b32 s64, 0, s64
    buffer_load_dwordx4 v52, s[24:27], s64 offen lds
    ds_read_b64_tr_b16 v[124:125], v34 offset:51200
    ds_read_b64_tr_b16 v[126:127], v34 offset:52224
    s_waitcnt vmcnt(17) lgkmcnt(8)
    v_mfma_f32_32x32x16_bf16 v[176:191], a[92:95], v[136:139], v[176:191]
    ds_read_b64_tr_b16 v[128:129], v33 offset:53248
    ds_read_b64_tr_b16 v[130:131], v33 offset:54272
    v_mfma_f32_32x32x16_bf16 v[232:247], a[92:95], v[140:143], v[232:247]
    buffer_load_dwordx4 v53, s[24:27], s64 offen offset:1024 lds
    ds_read_b64_tr_b16 v[132:133], v34 offset:53248
    ds_read_b64_tr_b16 v[134:135], v34 offset:54272
    s_waitcnt vmcnt(17) lgkmcnt(8)
    v_mfma_f32_32x32x16_bf16 v[176:191], a[96:99], v[112:115], v[176:191]
    ds_read_b64_tr_b16 v[136:137], v33 offset:55296
    ds_read_b64_tr_b16 v[138:139], v33 offset:56320
    v_mfma_f32_32x32x16_bf16 v[232:247], a[96:99], v[116:119], v[232:247]
    buffer_load_dwordx4 v54, s[24:27], s64 offen offset:2048 lds
    ds_read_b64_tr_b16 v[140:141], v34 offset:55296
    ds_read_b64_tr_b16 v[142:143], v34 offset:56320
    s_waitcnt vmcnt(17) lgkmcnt(8)
    v_mfma_f32_32x32x16_bf16 v[176:191], a[100:103], v[120:123], v[176:191]
    buffer_load_dwordx4 v55, s[24:27], s64 offen offset:3072 lds
    s_barrier
    ds_read_b64_tr_b16 v[112:113], v31 offset:0
    ds_read_b64_tr_b16 v[114:115], v31 offset:1024
    v_mfma_f32_32x32x16_bf16 v[232:247], a[100:103], v[124:127], v[232:247]
    ds_read_b64_tr_b16 v[116:117], v32 offset:0
    ds_read_b64_tr_b16 v[118:119], v32 offset:1024
    s_waitcnt vmcnt(17) lgkmcnt(8)
    v_mfma_f32_32x32x16_bf16 v[176:191], a[104:107], v[128:131], v[176:191]
    s_add_u32 m0, s58, 49152
    s_add_u32 s66, s66, 1
    s_and_b32 s66, s66, 3
    s_mul_i32 s61, s66, 100352
    buffer_load_dwordx4 v56, s[16:19], s61 offen lds
    ds_read_b64_tr_b16 v[120:121], v31 offset:2048
    ds_read_b64_tr_b16 v[122:123], v31 offset:3072
    v_mfma_f32_32x32x16_bf16 v[232:247], a[104:107], v[132:135], v[232:247]
    ds_read_b64_tr_b16 v[124:125], v32 offset:2048
    ds_read_b64_tr_b16 v[126:127], v32 offset:3072
    s_waitcnt vmcnt(17) lgkmcnt(8)
    v_mfma_f32_32x32x16_bf16 v[176:191], a[108:111], v[136:139], v[176:191]
    buffer_load_dwordx4 v57, s[16:19], s61 offen offset:1024 lds
    ds_read_b64_tr_b16 v[128:129], v31 offset:4096
    ds_read_b64_tr_b16 v[130:131], v31 offset:5120
    v_mfma_f32_32x32x16_bf16 v[232:247], a[108:111], v[140:143], v[232:247]
    ds_read_b64_tr_b16 v[132:133], v32 offset:4096
    ds_read_b64_tr_b16 v[134:135], v32 offset:5120
    s_waitcnt lgkmcnt(8)
    v_mfma_f32_32x32x16_bf16 v[144:159], a[0:3], v[112:115], 0
    s_add_u32 s61, s61, 48128
    buffer_load_dwordx4 v56, s[16:19], s61 offen offset:2048 lds
    ds_read_b64_tr_b16 v[136:137], v31 offset:6144
    ds_read_b64_tr_b16 v[138:139], v31 offset:7168
    v_mfma_f32_32x32x16_bf16 v[160:175], a[0:3], v[116:119], 0
    buffer_load_dwordx4 v57, s[16:19], s61 offen offset:3072 lds
    ds_read_b64_tr_b16 v[140:141], v32 offset:6144
    ds_read_b64_tr_b16 v[142:143], v32 offset:7168
    v_cvt_pk_bf16_f32 v176, v176, v177
    v_cvt_pk_bf16_f32 v177, v178, v179
    v_cvt_pk_bf16_f32 v178, v180, v181
    v_cvt_pk_bf16_f32 v179, v182, v183
    buffer_store_dwordx4 v[176:179], v21, s[28:31], 0 offen offset:0 sc1
    s_waitcnt lgkmcnt(8)
    v_mfma_f32_32x32x16_bf16 v[144:159], a[4:7], v[120:123], v[144:159]
    s_add_u32 m0, s58, 98304
    s_add_u32 s66, s66, 1
    s_and_b32 s66, s66, 3
    s_mul_i32 s61, s66, 100352
    buffer_load_dwordx4 v56, s[16:19], s61 offen lds
    s_load_dword s14, s[28:29], s39
    ds_read_b64_tr_b16 v[112:113], v35 offset:0
    ds_read_b64_tr_b16 v[114:115], v35 offset:1024
    v_cvt_pk_bf16_f32 v184, v184, v185
    v_cvt_pk_bf16_f32 v185, v186, v187
    v_cvt_pk_bf16_f32 v186, v188, v189
    v_cvt_pk_bf16_f32 v187, v190, v191
    buffer_store_dwordx4 v[184:187], v21, s[28:31], 0 offen offset:1024 sc1
    v_mfma_f32_32x32x16_bf16 v[160:175], a[4:7], v[124:127], v[160:175]
    buffer_load_dwordx4 v57, s[16:19], s61 offen offset:1024 lds
    ds_read_b64_tr_b16 v[116:117], v36 offset:0
    ds_read_b64_tr_b16 v[118:119], v36 offset:1024
    v_cvt_pk_bf16_f32 v232, v232, v233
    v_cvt_pk_bf16_f32 v233, v234, v235
    v_cvt_pk_bf16_f32 v234, v236, v237
    v_cvt_pk_bf16_f32 v235, v238, v239
    buffer_store_dwordx4 v[232:235], v21, s[28:31], 0 offen offset:2048 sc1
    s_waitcnt lgkmcnt(8)
    v_mfma_f32_32x32x16_bf16 v[144:159], a[8:11], v[128:131], v[144:159]
    s_add_u32 s61, s61, 48128
    buffer_load_dwordx4 v56, s[16:19], s61 offen offset:2048 lds
    ds_read_b64_tr_b16 v[120:121], v35 offset:2048
    ds_read_b64_tr_b16 v[122:123], v35 offset:3072
    v_cvt_pk_bf16_f32 v240, v240, v241
    v_cvt_pk_bf16_f32 v241, v242, v243
    v_cvt_pk_bf16_f32 v242, v244, v245
    v_cvt_pk_bf16_f32 v243, v246, v247
    buffer_store_dwordx4 v[240:243], v21, s[28:31], 0 offen offset:3072 sc1
    v_mfma_f32_32x32x16_bf16 v[160:175], a[8:11], v[132:135], v[160:175]
    buffer_load_dwordx4 v57, s[16:19], s61 offen offset:3072 lds
    ds_read_b64_tr_b16 v[124:125], v36 offset:2048
    ds_read_b64_tr_b16 v[126:127], v36 offset:3072
    s_waitcnt lgkmcnt(8)
    v_mfma_f32_32x32x16_bf16 v[144:159], a[12:15], v[136:139], v[144:159]
    ds_read_b64_tr_b16 v[128:129], v35 offset:4096
    ds_read_b64_tr_b16 v[130:131], v35 offset:5120
    v_mfma_f32_32x32x16_bf16 v[160:175], a[12:15], v[140:143], v[160:175]
    ds_read_b64_tr_b16 v[132:133], v36 offset:4096
    ds_read_b64_tr_b16 v[134:135], v36 offset:5120
    s_waitcnt lgkmcnt(8)
    v_mfma_f32_32x32x16_bf16 v[144:159], a[16:19], v[112:115], v[144:159]
    ds_read_b64_tr_b16 v[136:137], v35 offset:6144
    ds_read_b64_tr_b16 v[138:139], v35 offset:7168
    v_mfma_f32_32x32x16_bf16 v[160:175], a[16:19], v[116:119], v[160:175]
    ds_read_b64_tr_b16 v[140:141], v36 offset:6144
    ds_read_b64_tr_b16 v[142:143], v36 offset:7168
    s_waitcnt lgkmcnt(8)
    v_mfma_f32_32x32x16_bf16 v[144:159], a[20:23], v[120:123], v[144:159]
    s_waitcnt vmcnt(12)
    s_barrier
    ds_read_b64_tr_b16 v[112:113], v35 offset:16384
    s_add_u32 m0, s58, 114688
    s_add_u32 s66, s66, 1
    s_and_b32 s66, s66, 3
    s_mul_i32 s61, s66, 100352
    buffer_load_dwordx4 v56, s[16:19], s61 offen lds
    ds_read_b64_tr_b16 v[114:115], v35 offset:17408
    v_mfma_f32_32x32x16_bf16 v[160:175], a[20:23], v[124:127], v[160:175]
    buffer_load_dwordx4 v57, s[16:19], s61 offen offset:1024 lds
    ds_read_b64_tr_b16 v[116:117], v36 offset:16384
    ds_read_b64_tr_b16 v[118:119], v36 offset:17408
    s_waitcnt lgkmcnt(8)
    v_mfma_f32_32x32x16_bf16 v[144:159], a[24:27], v[128:131], v[144:159]
    ds_read_b64_tr_b16 v[120:121], v35 offset:18432
    ds_read_b64_tr_b16 v[122:123], v35 offset:19456
    v_mfma_f32_32x32x16_bf16 v[160:175], a[24:27], v[132:135], v[160:175]
    s_add_u32 s61, s61, 48128
    buffer_load_dwordx4 v56, s[16:19], s61 offen offset:2048 lds
    ds_read_b64_tr_b16 v[124:125], v36 offset:18432
    ds_read_b64_tr_b16 v[126:127], v36 offset:19456
    s_waitcnt lgkmcnt(8)
    v_mfma_f32_32x32x16_bf16 v[144:159], a[28:31], v[136:139], v[144:159]
    ds_read_b64_tr_b16 v[128:129], v35 offset:20480
    ds_read_b64_tr_b16 v[130:131], v35 offset:21504
    v_mfma_f32_32x32x16_bf16 v[160:175], a[28:31], v[140:143], v[160:175]
    buffer_load_dwordx4 v57, s[16:19], s61 offen offset:3072 lds
    ds_read_b64_tr_b16 v[132:133], v36 offset:20480
    ds_read_b64_tr_b16 v[134:135], v36 offset:21504
    s_waitcnt lgkmcnt(8)
    v_mfma_f32_32x32x16_bf16 v[144:159], a[32:35], v[112:115], v[144:159]
    ds_read_b64_tr_b16 v[136:137], v35 offset:22528
    ds_read_b64_tr_b16 v[138:139], v35 offset:23552
    v_mfma_f32_32x32x16_bf16 v[160:175], a[32:35], v[116:119], v[160:175]
    s_add_u32 m0, s58, 0
    s_add_u32 s66, s66, 1
    s_and_b32 s66, s66, 3
    s_mul_i32 s61, s66, 100352
    buffer_load_dwordx4 v56, s[16:19], s61 offen lds
    ds_read_b64_tr_b16 v[140:141], v36 offset:22528
    ds_read_b64_tr_b16 v[142:143], v36 offset:23552
    s_waitcnt lgkmcnt(8)
    v_mfma_f32_32x32x16_bf16 v[144:159], a[36:39], v[120:123], v[144:159]
    buffer_load_dwordx4 v57, s[16:19], s61 offen offset:1024 lds
    ds_read_b64_tr_b16 v[112:113], v31 offset:16384
    ds_read_b64_tr_b16 v[114:115], v31 offset:17408
    v_mfma_f32_32x32x16_bf16 v[160:175], a[36:39], v[124:127], v[160:175]
    ds_read_b64_tr_b16 v[116:117], v32 offset:16384
    ds_read_b64_tr_b16 v[118:119], v32 offset:17408
    s_waitcnt lgkmcnt(8)
    v_mfma_f32_32x32x16_bf16 v[144:159], a[40:43], v[128:131], v[144:159]
    s_add_u32 s61, s61, 48128
    buffer_load_dwordx4 v56, s[16:19], s61 offen offset:2048 lds
    ds_read_b64_tr_b16 v[120:121], v31 offset:18432
    ds_read_b64_tr_b16 v[122:123], v31 offset:19456
    v_mfma_f32_32x32x16_bf16 v[160:175], a[40:43], v[132:135], v[160:175]
    ds_read_b64_tr_b16 v[124:125], v32 offset:18432
    ds_read_b64_tr_b16 v[126:127], v32 offset:19456
    s_waitcnt lgkmcnt(8)
    v_mfma_f32_32x32x16_bf16 v[144:159], a[44:47], v[136:139], v[144:159]
    buffer_load_dwordx4 v57, s[16:19], s61 offen offset:3072 lds
    ds_read_b64_tr_b16 v[128:129], v31 offset:20480
    ds_read_b64_tr_b16 v[130:131], v31 offset:21504
    v_mfma_f32_32x32x16_bf16 v[160:175], a[44:47], v[140:143], v[160:175]
    ds_read_b64_tr_b16 v[132:133], v32 offset:20480
    ds_read_b64_tr_b16 v[134:135], v32 offset:21504
    s_waitcnt lgkmcnt(8)
    v_mfma_f32_32x32x16_bf16 v[144:159], a[48:51], v[112:115], v[144:159]
    ds_read_b64_tr_b16 v[136:137], v31 offset:22528
    ds_read_b64_tr_b16 v[138:139], v31 offset:23552
    v_mfma_f32_32x32x16_bf16 v[160:175], a[48:51], v[116:119], v[160:175]
    ds_read_b64_tr_b16 v[140:141], v32 offset:22528
    ds_read_b64_tr_b16 v[142:143], v32 offset:23552
    s_waitcnt lgkmcnt(8)
    v_mfma_f32_32x32x16_bf16 v[144:159], a[52:55], v[120:123], v[144:159]
    s_barrier
    s_waitcnt lgkmcnt(0)
    s_cmp_eq_u32 s14, 8
    s_cbranch_scc1 L_pollok6
    s_mov_b32 s60, 0
L_poll6:
    s_sleep 8
    buffer_load_dword v18, off, s[28:31], s39 sc1
    s_add_u32 s60, s60, 1
    s_waitcnt vmcnt(0)
    v_readfirstlane_b32 s14, v18
    s_nop 0
    s_cmp_eq_u32 s14, 8
    s_cbranch_scc1 L_pollok6
    s_cmp_lt_u32 s60, 20000
    s_cbranch_scc1 L_poll6
L_pollok6:
    s_waitcnt vmcnt(9)
    s_atomic_add s36, s[28:29], s55
    ds_read_b64_tr_b16 v[112:113], v33 offset:0
    s_add_u32 m0, s58, 131072
    s_add_u32 s66, s66, 1
    s_and_b32 s66, s66, 3
    s_lshl_b32 s61, s66, 12
    buffer_load_dwordx4 v58, s[28:31], s61 offen sc1 lds
    ds_read_b64_tr_b16 v[114:115], v33 offset:1024
    v_mfma_f32_32x32x16_bf16 v[160:175], a[52:55], v[124:127], v[160:175]
    buffer_load_dwordx4 v59, s[28:31], s61 offen offset:1024 sc1 lds
    ds_read_b64_tr_b16 v[116:117], v34 offset:0
    ds_read_b64_tr_b16 v[118:119], v34 offset:1024
    v_mfma_f32_32x32x16_bf16 v[144:159], a[56:59], v[128:131], v[144:159]
    ds_read_b64_tr_b16 v[120:121], v33 offset:2048
    ds_read_b64_tr_b16 v[122:123], v33 offset:3072
    v_mfma_f32_32x32x16_bf16 v[160:175], a[56:59], v[132:135], v[160:175]
    buffer_load_dwordx4 v58, s[28:31], s61 offen offset:2048 sc1 lds
    ds_read_b64_tr_b16 v[124:125], v34 offset:2048
    ds_read_b64_tr_b16 v[126:127], v34 offset:3072
    v_mfma_f32_32x32x16_bf16 v[144:159], a[60:63], v[136:139], v[144:159]
    buffer_load_dwordx4 v59, s[28:31], s61 offen offset:3072 sc1 lds
    ds_read_b64_tr_b16 v[128:129], v33 offset:4096
    ds_read_b64_tr_b16 v[130:131], v33 offset:5120
    v_mfma_f32_32x32x16_bf16 v[160:175], a[60:63], v[140:143], v[160:175]
    ds_read_b64_tr_b16 v[132:133], v34 offset:4096
    ds_read_b64_tr_b16 v[134:135], v34 offset:5120
    s_waitcnt lgkmcnt(8)
    v_mfma_f32_32x32x16_bf16 v[144:159], a[64:67], v[112:115], v[144:159]
    s_add_u32 m0, s58, 147456
    s_add_u32 s66, s66, 1
    s_and_b32 s66, s66, 3
    s_lshl_b32 s61, s66, 12
    buffer_load_dwordx4 v58, s[28:31], s61 offen sc1 lds
    ds_read_b64_tr_b16 v[136:137], v33 offset:6144
    ds_read_b64_tr_b16 v[138:139], v33 offset:7168
    v_mfma_f32_32x32x16_bf16 v[160:175], a[64:67], v[116:119], v[160:175]
    buffer_load_dwordx4 v59, s[28:31], s61 offen offset:1024 sc1 lds
    ds_read_b64_tr_b16 v[140:141], v34 offset:6144
    ds_read_b64_tr_b16 v[142:143], v34 offset:7168
    s_waitcnt lgkmcnt(8)
    v_mfma_f32_32x32x16_bf16 v[144:159], a[68:71], v[120:123], v[144:159]
    ds_read_b64_tr_b16 v[112:113], v33 offset:16384
    ds_read_b64_tr_b16 v[114:115], v33 offset:17408
    v_mfma_f32_32x32x16_bf16 v[160:175], a[68:71], v[124:127], v[160:175]
    buffer_load_dwordx4 v58, s[28:31], s61 offen offset:2048 sc1 lds
    ds_read_b64_tr_b16 v[116:117], v34 offset:16384
    ds_read_b64_tr_b16 v[118:119], v34 offset:17408
    s_waitcnt lgkmcnt(8)
    v_mfma_f32_32x32x16_bf16 v[144:159], a[72:75], v[128:131], v[144:159]
    buffer_load_dwordx4 v59, s[28:31], s61 offen offset:3072 sc1 lds
    ds_read_b64_tr_b16 v[120:121], v33 offset:18432
    ds_read_b64_tr_b16 v[122:123], v33 offset:19456
    v_mfma_f32_32x32x16_bf16 v[160:175], a[72:75], v[132:135], v[160:175]
    ds_read_b64_tr_b16 v[124:125], v34 offset:18432
    ds_read_b64_tr_b16 v[126:127], v34 offset:19456
    s_waitcnt lgkmcnt(8)
    v_mfma_f32_32x32x16_bf16 v[144:159], a[76:79], v[136:139], v[144:159]
    ds_read_b64_tr_b16 v[128:129], v33 offset:20480
    ds_read_b64_tr_b16 v[130:131], v33 offset:21504
    v_mfma_f32_32x32x16_bf16 v[160:175], a[76:79], v[140:143], v[160:175]
    ds_read_b64_tr_b16 v[132:133], v34 offset:20480
    ds_read_b64_tr_b16 v[134:135], v34 offset:21504
    s_waitcnt lgkmcnt(8)
    v_mfma_f32_32x32x16_bf16 v[144:159], a[80:83], v[112:115], v[144:159]
    ds_read_b64_tr_b16 v[136:137], v33 offset:22528
    ds_read_b64_tr_b16 v[138:139], v33 offset:23552
    v_mfma_f32_32x32x16_bf16 v[160:175], a[80:83], v[116:119], v[160:175]
    ds_read_b64_tr_b16 v[140:141], v34 offset:22528
    ds_read_b64_tr_b16 v[142:143], v34 offset:23552
    s_waitcnt lgkmcnt(8)
    v_mfma_f32_32x32x16_bf16 v[144:159], a[84:87], v[120:123], v[144:159]
    s_barrier
    ds_read_b64_tr_b16 v[112:113], v31 offset:32768
    s_add_u32 m0, s58, 16384
    s_add_u32 s66, s66, 1
    s_and_b32 s66, s66, 3
    s_lshl_b32 s61, s66, 12
    buffer_load_dwordx4 v58, s[28:31], s61 offen sc1 lds
    ds_read_b64_tr_b16 v[114:115], v31 offset:33792
    v_mfma_f32_32x32x16_bf16 v[160:175], a[84:87], v[124:127], v[160:175]
    buffer_load_dwordx4 v59, s[28:31], s61 offen offset:1024 sc1 lds
    ds_read_b64_tr_b16 v[116:117], v32 offset:32768
    ds_read_b64_tr_b16 v[118:119], v32 offset:33792
    s_waitcnt lgkmcnt(8)
    v_mfma_f32_32x32x16_bf16 v[144:159], a[88:91], v[128:131], v[144:159]
    ds_read_b64_tr_b16 v[120:121], v31 offset:34816
    ds_read_b64_tr_b16 v[122:123], v31 offset:35840
    v_mfma_f32_32x32x16_bf16 v[160:175], a[88:91], v[132:135], v[160:175]
    buffer_load_dwordx4 v58, s[28:31], s61 offen offset:2048 sc1 lds
    ds_read_b64_tr_b16 v[124:125], v32 offset:34816
    ds_read_b64_tr_b16 v[126:127], v32 offset:35840
    s_waitcnt lgkmcnt(8)
    v_mfma_f32_32x32x16_bf16 v[144:159], a[92:95], v[136:139], v[144:159]
    buffer_load_dwordx4 v59, s[28:31], s61 offen offset:3072 sc1 lds
    ds_read_b64_tr_b16 v[128:129], v31 offset:36864
    ds_read_b64_tr_b16 v[130:131], v31 offset:37888
    v_mfma_f32_32x32x16_bf16 v[160:175], a[92:95], v[140:143], v[160:175]
    ds_read_b64_tr_b16 v[132:133], v32 offset:36864
    ds_read_b64_tr_b16 v[134:135], v32 offset:37888
    s_waitcnt lgkmcnt(8)
    v_mfma_f32_32x32x16_bf16 v[144:159], a[96:99], v[112:115], v[144:159]
    s_add_u32 m0, s58, 65536
    s_add_u32 s66, s66, 1
    s_and_b32 s66, s66, 3
    s_lshl_b32 s61, s66, 12
    buffer_load_dwordx4 v58, s[28:31], s61 offen sc1 lds
    ds_read_b64_tr_b16 v[136:137], v31 offset:38912
    ds_read_b64_tr_b16 v[138:139], v31 offset:39936
    v_mfma_f32_32x32x16_bf16 v[160:175], a[96:99], v[116:119], v[160:175]
    buffer_load_dwordx4 v59, s[28:31], s61 offen offset:1024 sc1 lds
    ds_read_b64_tr_b16 v[140:141], v32 offset:38912
    ds_read_b64_tr_b16 v[142:143], v32 offset:39936
    s_waitcnt lgkmcnt(8)
    v_mfma_f32_32x32x16_bf16 v[144:159], a[100:103], v[120:123], v[144:159]
    s_waitcnt vmcnt(10)
    s_barrier
    s_xor_b32 s55, s55, 1024
    s_load_dword s14, s[28:29], s55
    ds_read_b64_tr_b16 v[192:193], v37 offset:49152
    buffer_load_dwordx4 v58, s[28:31], s61 offen offset:2048 sc1 lds
    ds_read_b64_tr_b16 v[194:195], v37 offset:53248
    ds_read_b128 v[112:115], v44 offset:0
    v_mfma_f32_32x32x16_bf16 v[160:175], a[100:103], v[124:127], v[160:175]
    ds_read_b128 v[116:119], v45 offset:0
    s_waitcnt lgkmcnt(8)
    v_mfma_f32_32x32x16_bf16 v[144:159], a[104:107], v[128:131], v[144:159]
    buffer_load_dwordx4 v59, s[28:31], s61 offen offset:3072 sc1 lds
    ds_read_b64_tr_b16 v[196:197], v37 offset:50176
    ds_read_b64_tr_b16 v[198:199], v37 offset:54272
    ds_read_b128 v[120:123], v44 offset:512
    v_mfma_f32_32x32x16_bf16 v[160:175], a[104:107], v[132:135], v[160:175]
    ds_read_b128 v[124:127], v45 offset:512
    s_waitcnt lgkmcnt(8)
    v_mfma_f32_32x32x16_bf16 v[144:159], a[108:111], v[136:139], v[144:159]
    ds_read_b64_tr_b16 v[200:201], v37 offset:51200
    ds_read_b64_tr_b16 v[202:203], v37 offset:55296
    ds_read_b128 v[128:131], v44 offset:2048
    v_mfma_f32_32x32x16_bf16 v[160:175], a[108:111], v[140:143], v[160:175]
    ds_read_b128 v[132:135], v45 offset:2048
    s_waitcnt lgkmcnt(8)
    v_mfma_f32_32x32x16_bf16 v[144:159], v[192:195], v[112:115], v[144:159]
    ds_read_b64_tr_b16 v[204:205], v37 offset:52224
    ds_read_b64_tr_b16 v[206:207], v37 offset:56320
    ds_read_b128 v[136:139], v44 offset:2560
    v_mfma_f32_32x32x16_bf16 v[160:175], v[192:195], v[116:119], v[160:175]
    ds_read_b128 v[140:143], v45 offset:2560
    s_waitcnt lgkmcnt(8)
    v_mfma_f32_32x32x16_bf16 v[144:159], v[196:199], v[120:123], v[144:159]
    s_waitcnt vmcnt(8)
    s_barrier
    ds_read_b64_tr_b16 v[192:193], v38 offset:32768
    ds_read_b64_tr_b16 v[194:195], v38 offset:36864
    ds_read_b128 v[112:115], v44 offset:16384
    v_mfma_f32_32x32x16_bf16 v[160:175], v[196:199], v[124:127], v[160:175]
    ds_read_b128 v[116:119], v45 offset:16384
    s_waitcnt lgkmcnt(8)
    v_mfma_f32_32x32x16_bf16 v[144:159], v[200:203], v[128:131], v[144:159]
    ds_read_b64_tr_b16 v[196:197], v38 offset:33792
    ds_read_b64_tr_b16 v[198:199], v38 offset:37888
    ds_read_b128 v[120:123], v44 offset:16896
    v_mfma_f32_32x32x16_bf16 v[160:175], v[200:203], v[132:135], v[160:175]
    ds_read_b128 v[124:127], v45 offset:16896
    s_waitcnt lgkmcnt(8)
    v_mfma_f32_32x32x16_bf16 v[144:159], v[204:207], v[136:139], v[144:159]
    ds_read_b64_tr_b16 v[200:201], v38 offset:34816
    ds_read_b64_tr_b16 v[202:203], v38 offset:38912
    ds_read_b128 v[128:131], v44 offset:18432
    v_mfma_f32_32x32x16_bf16 v[160:175], v[204:207], v[140:143], v[160:175]
    ds_read_b128 v[132:135], v45 offset:18432
    s_waitcnt lgkmcnt(8)
    v_mfma_f32_32x32x16_bf16 v[144:159], v[192:195], v[112:115], v[144:159]
    ds_read_b64_tr_b16 v[204:205], v38 offset:35840
    ds_read_b64_tr_b16 v[206:207], v38 offset:39936
    ds_read_b128 v[136:139], v44 offset:18944
    v_mfma_f32_32x32x16_bf16 v[160:175], v[192:195], v[116:119], v[160:175]
    ds_read_b128 v[140:143], v45 offset:18944
    s_waitcnt lgkmcnt(8)
    v_mfma_f32_32x32x16_bf16 v[144:159], v[196:199], v[120:123], v[144:159]
    s_waitcnt vmcnt(4)
    s_barrier
    s_waitcnt lgkmcnt(0)
    s_cmp_eq_u32 s14, 1
    s_cbranch_scc1 L_pollok7
    s_mov_b32 s60, 0
L_poll7:
    s_sleep 4
    buffer_load_dword v18, off, s[28:31], s55 sc1
    s_add_u32 s60, s60, 1
    s_waitcnt vmcnt(0)
    v_readfirstlane_b32 s14, v18
    s_nop 0
    s_cmp_eq_u32 s14, 1
    s_cbranch_scc1 L_pollok7
    s_cmp_lt_u32 s60, 20000
    s_cbranch_scc1 L_poll7
L_pollok7:
    v_xor_b32 v21, 131072, v21
    ds_read_b64_tr_b16 v[192:193], v38 offset:49152
    buffer_load_dwordx4 v[232:235], v21, s[28:31], 0 offen offset:0 sc1
    ds_read_b64_tr_b16 v[194:195], v38 offset:53248
    ds_read_b128 v[112:115], v40 offset:16384
    v_mfma_f32_32x32x16_bf16 v[160:175], v[196:199], v[124:127], v[160:175]
    buffer_load_dwordx4 v[236:239], v21, s[28:31], 0 offen offset:1024 sc1
    ds_read_b128 v[116:119], v41 offset:16384
    v_mfma_f32_32x32x16_bf16 v[144:159], v[200:203], v[128:131], v[144:159]
    buffer_load_dwordx4 v[240:243], v21, s[28:31], 0 offen offset:2048 sc1
    ds_read_b64_tr_b16 v[196:197], v38 offset:50176
    ds_read_b64_tr_b16 v[198:199], v38 offset:54272
    ds_read_b128 v[120:123], v40 offset:16896
    v_mfma_f32_32x32x16_bf16 v[160:175], v[200:203], v[132:135], v[160:175]
    buffer_load_dwordx4 v[244:247], v21, s[28:31], 0 offen offset:3072 sc1
    ds_read_b128 v[124:127], v41 offset:16896
    v_mfma_f32_32x32x16_bf16 v[144:159], v[204:207], v[136:139], v[144:159]
    ds_read_b64_tr_b16 v[200:201], v38 offset:51200
    ds_read_b64_tr_b16 v[202:203], v38 offset:55296
    ds_read_b128 v[128:131], v40 offset:18432
    v_mfma_f32_32x32x16_bf16 v[160:175], v[204:207], v[140:143], v[160:175]
    ds_read_b128 v[132:135], v41 offset:18432
    s_waitcnt lgkmcnt(8)
    v_mfma_f32_32x32x16_bf16 v[144:159], v[192:195], v[112:115], v[144:159]
    ds_read_b64_tr_b16 v[204:205], v38 offset:52224
    ds_read_b64_tr_b16 v[206:207], v38 offset:56320
    ds_read_b128 v[136:139], v40 offset:18944
    v_mfma_f32_32x32x16_bf16 v[160:175], v[192:195], v[116:119], v[160:175]
    ds_read_b128 v[140:143], v41 offset:18944
    s_waitcnt lgkmcnt(8)
    v_mfma_f32_32x32x16_bf16 v[144:159], v[196:199], v[120:123], v[144:159]
    s_waitcnt vmcnt(4)
    s_barrier
    ds_read_b64_tr_b16 v[192:193], v37 offset:0
    ds_read_b64_tr_b16 v[194:195], v37 offset:4096
    ds_read_b128 v[112:115], v42 offset:0
    v_mfma_f32_32x32x16_bf16 v[160:175], v[196:199], v[124:127], v[160:175]
    ds_read_b128 v[116:119], v43 offset:0
    s_waitcnt lgkmcnt(8)
    v_mfma_f32_32x32x16_bf16 v[144:159], v[200:203], v[128:131], v[144:159]
    ds_read_b64_tr_b16 v[196:197], v37 offset:1024
    ds_read_b64_tr_b16 v[198:199], v37 offset:5120
    ds_read_b128 v[120:123], v42 offset:512
    v_mfma_f32_32x32x16_bf16 v[160:175], v[200:203], v[132:135], v[160:175]
    ds_read_b128 v[124:127], v43 offset:512
    s_waitcnt lgkmcnt(8)
    v_mfma_f32_32x32x16_bf16 v[144:159], v[204:207], v[136:139], v[144:159]
    ds_read_b64_tr_b16 v[200:201], v37 offset:2048
    ds_read_b64_tr_b16 v[202:203], v37 offset:6144
    ds_read_b128 v[128:131], v42 offset:2048
    v_mfma_f32_32x32x16_bf16 v[160:175], v[204:207], v[140:143], v[160:175]
    ds_read_b128 v[132:135], v43 offset:2048
    s_waitcnt lgkmcnt(8)
    v_mfma_f32_32x32x16_bf16 v[144:159], v[192:195], v[112:115], v[144:159]
    ds_read_b64_tr_b16 v[204:205], v37 offset:3072
    ds_read_b64_tr_b16 v[206:207], v37 offset:7168
    ds_read_b128 v[136:139], v42 offset:2560
    v_mfma_f32_32x32x16_bf16 v[160:175], v[192:195], v[116:119], v[160:175]
    ds_read_b128 v[140:143], v43 offset:2560
    s_waitcnt lgkmcnt(8)
    v_mfma_f32_32x32x16_bf16 v[144:159], v[196:199], v[120:123], v[144:159]
    v_mfma_f32_32x32x16_bf16 v[160:175], v[196:199], v[124:127], v[160:175]
    s_waitcnt lgkmcnt(4)
    v_mfma_f32_32x32x16_bf16 v[144:159], v[200:203], v[128:131], v[144:159]
    v_mfma_f32_32x32x16_bf16 v[160:175], v[200:203], v[132:135], v[160:175]
    s_waitcnt lgkmcnt(0)
    v_mfma_f32_32x32x16_bf16 v[144:159], v[204:207], v[136:139], v[144:159]
    v_mfma_f32_32x32x16_bf16 v[160:175], v[204:207], v[140:143], v[160:175]
    s_waitcnt vmcnt(3)
    v_lshlrev_b32 v176, 16, v232
    v_and_b32 v177, 0xffff0000, v232
    s_nop 7
    v_pk_add_f32 v[144:145], v[144:145], v[176:177]
    v_lshlrev_b32 v178, 16, v233
    v_and_b32 v179, 0xffff0000, v233
    v_pk_add_f32 v[146:147], v[146:147], v[178:179]
    ds_write_b128 v80, v[144:147] offset:0
    v_lshlrev_b32 v176, 16, v234
    v_and_b32 v177, 0xffff0000, v234
    v_pk_add_f32 v[148:149], v[148:149], v[176:177]
    v_lshlrev_b32 v178, 16, v235
    v_and_b32 v179, 0xffff0000, v235
    v_pk_add_f32 v[150:151], v[150:151], v[178:179]
    ds_write_b128 v81, v[148:151] offset:0
    s_waitcnt vmcnt(2)
    v_lshlrev_b32 v176, 16, v236
    v_and_b32 v177, 0xffff0000, v236
    v_pk_add_f32 v[152:153], v[152:153], v[176:177]
    v_lshlrev_b32 v178, 16, v237
    v_and_b32 v179, 0xffff0000, v237
    v_pk_add_f32 v[154:155], v[154:155], v[178:179]
    ds_write_b128 v82, v[152:155] offset:0
    v_lshlrev_b32 v176, 16, v238
    v_and_b32 v177, 0xffff0000, v238
    v_pk_add_f32 v[156:157], v[156:157], v[176:177]
    v_lshlrev_b32 v178, 16, v239
    v_and_b32 v179, 0xffff0000, v239
    v_pk_add_f32 v[158:159], v[158:159], v[178:179]
    ds_write_b128 v83, v[156:159] offset:0
    s_waitcnt vmcnt(1)
    v_lshlrev_b32 v176, 16, v240
    v_and_b32 v177, 0xffff0000, v240
    v_pk_add_f32 v[160:161], v[160:161], v[176:177]
    v_lshlrev_b32 v178, 16, v241
    v_and_b32 v179, 0xffff0000, v241
    v_pk_add_f32 v[162:163], v[162:163], v[178:179]
    ds_write_b128 v80, v[160:163] offset:8192
    v_lshlrev_b32 v176, 16, v242
    v_and_b32 v177, 0xffff0000, v242
    v_pk_add_f32 v[164:165], v[164:165], v[176:177]
    v_lshlrev_b32 v178, 16, v243
    v_and_b32 v179, 0xffff0000, v243
    v_pk_add_f32 v[166:167], v[166:167], v[178:179]
    ds_write_b128 v81, v[164:167] offset:8192
    s_waitcnt vmcnt(0)
    v_lshlrev_b32 v176, 16, v244
    v_and_b32 v177, 0xffff0000, v244
    v_pk_add_f32 v[168:169], v[168:169], v[176:177]
    v_lshlrev_b32 v178, 16, v245
    v_and_b32 v179, 0xffff0000, v245
    v_pk_add_f32 v[170:171], v[170:171], v[178:179]
    ds_write_b128 v82, v[168:171] offset:8192
    v_lshlrev_b32 v176, 16, v246
    v_and_b32 v177, 0xffff0000, v246
    v_pk_add_f32 v[172:173], v[172:173], v[176:177]
    v_lshlrev_b32 v178, 16, v247
    v_and_b32 v179, 0xffff0000, v247
    v_pk_add_f32 v[174:175], v[174:175], v[178:179]
    ds_write_b128 v83, v[172:175] offset:8192
    s_waitcnt lgkmcnt(0)
    s_barrier
    ds_read_b128 v[112:115], v84 offset:0
    ds_read_b128 v[116:119], v85 offset:0
    ds_read_b128 v[120:123], v86 offset:0
    ds_read_b128 v[124:127], v87 offset:0
    ds_read_b128 v[128:131], v84 offset:2048
    ds_read_b128 v[132:135], v85 offset:2048
    ds_read_b128 v[136:139], v86 offset:2048
    ds_read_b128 v[140:143], v87 offset:2048
    s_waitcnt lgkmcnt(7)
    v_pk_add_f32 v[216:217], v[216:217], v[112:113]
    v_pk_add_f32 v[218:219], v[218:219], v[114:115]
    s_waitcnt lgkmcnt(6)
    v_pk_add_f32 v[220:221], v[220:221], v[116:117]
    v_pk_add_f32 v[222:223], v[222:223], v[118:119]
    s_waitcnt lgkmcnt(5)
    v_pk_add_f32 v[216:217], v[216:217], v[120:121]
    v_pk_add_f32 v[218:219], v[218:219], v[122:123]
    s_waitcnt lgkmcnt(4)
    v_pk_add_f32 v[220:221], v[220:221], v[124:125]
    v_pk_add_f32 v[222:223], v[222:223], v[126:127]
    v_cvt_pk_bf16_f32 v104, v216, v217
    v_cvt_pk_bf16_f32 v105, v218, v219
    v_cvt_pk_bf16_f32 v106, v220, v221
    v_cvt_pk_bf16_f32 v107, v222, v223
    buffer_store_dwordx4 v[104:107], v78, s[32:35], 0 offen
    s_waitcnt lgkmcnt(3)
    v_pk_add_f32 v[224:225], v[224:225], v[128:129]
    v_pk_add_f32 v[226:227], v[226:227], v[130:131]
    s_waitcnt lgkmcnt(2)
    v_pk_add_f32 v[228:229], v[228:229], v[132:133]
    v_pk_add_f32 v[230:231], v[230:231], v[134:135]
    s_waitcnt lgkmcnt(1)
    v_pk_add_f32 v[224:225], v[224:225], v[136:137]
    v_pk_add_f32 v[226:227], v[226:227], v[138:139]
    s_waitcnt lgkmcnt(0)
    v_pk_add_f32 v[228:229], v[228:229], v[140:141]
    v_pk_add_f32 v[230:231], v[230:231], v[142:143]
    v_cvt_pk_bf16_f32 v108, v224, v225
    v_cvt_pk_bf16_f32 v109, v226, v227
    v_cvt_pk_bf16_f32 v110, v228, v229
    v_cvt_pk_bf16_f32 v111, v230, v231
    buffer_store_dwordx4 v[108:111], v79, s[32:35], 0 offen
L_fin:
L_end:
    s_endpgm
.section .rodata,"a"
.p2align 6
.amdhsa_kernel parallel_sum__sliding_local_dilated__mixer_token_mlp__prompt_kernel
  .amdhsa_next_free_vgpr 512
  .amdhsa_next_free_sgpr 102
  .amdhsa_accum_offset 256
  .amdhsa_group_segment_fixed_size 0
  .amdhsa_kernarg_size 88
  .amdhsa_user_sgpr_count 2
  .amdhsa_user_sgpr_kernarg_segment_ptr 1
  .amdhsa_system_sgpr_workgroup_id_x 1
.end_amdhsa_kernel
```

```asm
; @launch grid=(256,1,1) block=(256,1,1) lds=163840
.amdgcn_target "amdgcn-amd-amdhsa--gfx950"
.text
.globl parallel_sum__sliding_local_dilated__mixer_token_mlp__prompt_kernel
.p2align 8
.type parallel_sum__sliding_local_dilated__mixer_token_mlp__prompt_kernel,@function
parallel_sum__sliding_local_dilated__mixer_token_mlp__prompt_kernel:
    s_cmp_ge_u32 s2, 256
    s_cbranch_scc1 L_end
    s_load_dwordx2 s[8:9], s[0:1], 0
    s_load_dwordx2 s[20:21], s[0:1], 32
    s_load_dwordx2 s[28:29], s[0:1], 80
    s_load_dwordx2 s[44:45], s[0:1], 72
    s_load_dwordx2 s[12:13], s[0:1], 8
    s_load_dwordx2 s[16:17], s[0:1], 16
    s_load_dwordx2 s[24:25], s[0:1], 48
    s_load_dwordx2 s[32:33], s[0:1], 64
    s_load_dwordx2 s[36:37], s[0:1], 40
    s_load_dwordx2 s[40:41], s[0:1], 56
    s_memrealtime s[78:79]
    s_getpc_b64 s[6:7]
L_pc:
    s_and_b32 s3, s2, 0xf8
    v_lshrrev_b32 v14, 5, v0
    v_add_lshl_u32 v14, s3, v14, 7
    v_min_u32 v14, L_end-L_pc-4, v14
    global_load_dword v18, v14, s[6:7]
    v_lshrrev_b32 v14, 6, v0
    v_and_b32 v10, 31, v0
    v_readfirstlane_b32 s48, v14
    v_bfe_u32 v9, v0, 5, 1
    v_mul_u32_u24 v15, 896, v9
    v_lshl_add_u32 v15, v10, 4, v15
    v_cmp_gt_u32 vcc, 28, v10
    v_mov_b32 v16, 268435456
    s_mov_b32 s10, 1835008
    s_mov_b32 s11, 0x20000
    v_cndmask_b32 v15, v16, v15, vcc
    s_lshr_b32 s4, s48, 1
    s_and_b32 s5, s48, 1
    s_and_b32 s3, s2, 0xfe
    s_add_u32 s3, s3, s4
    s_lshl_b32 s3, s3, 1
    s_and_b32 s60, s2, 1
    s_add_u32 s3, s3, s60
    s_lshl_b32 s3, s3, 1
    s_add_u32 s3, s3, s5
    s_mul_i32 s3, s3, 1792
    s_waitcnt lgkmcnt(0)
    buffer_load_dwordx4 v[176:179], v15, s[8:11], s3 offen
    buffer_load_dwordx4 v[180:183], v15, s[8:11], s3 offen offset:448
    v_and_b32 v1, 63, v0
    s_mov_b32 s46, 256
    s_mov_b32 s47, 0x20000
    s_lshl_b32 s3, s48, 8
    s_add_u32 s3, s3, s2
    s_cmp_lt_u32 s3, 8
    s_cselect_b32 s3, 0, 268435456
    s_or_b32 s78, s78, 1
    v_mov_b32 v228, s78
    v_mov_b32 v229, 0
    v_lshlrev_b32 v11, 25, v1
    v_lshrrev_b32 v13, 4, v0
    v_lshlrev_b32 v13, 23, v13
    v_add_lshl_u32 v13, v13, v10, 2
    buffer_atomic_cmpswap v[228:229], v11, s[44:47], s3 offen sc1
    s_bfe_u32 s6, s2, 0x20001
    s_and_b32 s7, s2, 1
    s_and_b32 s61, s2, 7
    s_lshr_b32 s101, s2, 3
    s_mul_i32 s52, s7, 25
    s_add_u32 s52, s52, s101
    s_mul_i32 s51, s52, 37
    s_lshr_b32 s51, s51, 8
    s_mul_i32 s3, s51, 7
    s_sub_u32 s52, s52, s3
    s_and_b32 s3, s6, 1
    s_mul_i32 s3, s3, 6
    s_add_u32 s51, s51, s3
    s_add_u32 s51, s51, 1
    s_add_u32 s3, s3, s51
    s_cmp_eq_u32 s3, 7
    s_cselect_b32 s51, 0, s51
    s_lshr_b32 s59, s6, 1
    s_lshl_b32 s51, s51, 1
    s_add_u32 s51, s51, s59
    s_max_u32 s60, s101, 25
    s_sub_u32 s60, s60, 25
    s_add_u32 s3, s101, s7
    s_cmp_lt_u32 s3, 25
    s_cselect_b32 s55, 1, 0
    s_cselect_b32 s52, s52, s60
    s_mov_b32 s22, 7340032
    s_mov_b32 s23, 0x20000
    s_lshl_b32 s3, s52, 1
    s_sub_u32 s60, s3, 7
    s_cmp_ge_u32 s3, 7
    s_cselect_b32 s3, s60, s3
    s_and_b32 s3, s3, 7
    s_mul_i32 s60, s61, 2
    s_add_u32 s3, s3, s60
    s_and_b32 s3, s3, 7
    s_mul_i32 s0, s3, 458752
    s_lshl_b32 s1, s3, 13
    s_lshl_b32 s58, s48, 12
    v_lshrrev_b32 v3, 4, v1
    v_lshrrev_b32 v5, 3, v1
    v_and_b32 v6, 7, v1
    v_and_b32 v14, 1, v3
    v_lshlrev_b32 v15, 2, v14
    v_xor_b32 v15, v15, v6
    v_lshlrev_b32 v76, 4, v15
    s_cmp_eq_u32 s55, 0
    s_cbranch_scc1 L_nog1
    v_mul_u32_u24 v15, 3584, v5
    s_lshl_b32 s3, s59, 5
    s_add_u32 s3, s3, s48
    s_mul_i32 s3, s3, 114688
    s_lshl_b32 s60, s51, 7
    s_add_u32 s3, s3, s60
    v_add3_u32 v48, v15, v76, s3
    v_add_u32 v49, 27648, v48
    v_add_u32 v50, 55296, v48
    v_add_u32 v51, 82944, v48
    s_mov_b32 s38, 3584
    s_mov_b32 s39, 0x20000
    v_lshlrev_b32 v14, 3, v9
    s_lshl_b32 s3, s51, 1
    s_add_u32 s3, s3, s4
    s_lshl_b32 s3, s3, 6
    buffer_load_dwordx2 v[240:241], v14, s[36:39], s3 offen offset:0
    buffer_load_dwordx2 v[242:243], v14, s[36:39], s3 offen offset:16
    buffer_load_dwordx2 v[244:245], v14, s[36:39], s3 offen offset:32
    buffer_load_dwordx2 v[246:247], v14, s[36:39], s3 offen offset:48
    s_add_u32 m0, s58, 0
    v_xor_b32 v48, 128, v48
    buffer_load_dwordx4 v48, s[20:23], s0 offen lds
    v_xor_b32 v49, 128, v49
    buffer_load_dwordx4 v49, s[20:23], s0 offen offset:1024 lds
    v_xor_b32 v50, 128, v50
    buffer_load_dwordx4 v50, s[20:23], s0 offen offset:2048 lds
    v_xor_b32 v51, 128, v51
    buffer_load_dwordx4 v51, s[20:23], s0 offen offset:3072 lds
    s_mul_i32 s53, s101, 37
    s_lshr_b32 s53, s53, 8
    s_mul_i32 s54, s53, 7
    s_sub_u32 s54, s101, s54
    s_and_b32 s53, s53, 3
    s_lshl_b32 s3, s6, 2
    s_add_u32 s53, s53, s3
    s_lshl_b32 s53, s53, 1
    s_add_u32 s53, s53, s7
    s_mov_b32 s42, 4096
    s_mov_b32 s43, 0x20000
    s_lshl_b32 s3, s53, 2
    s_add_u32 s3, s3, s48
    s_lshl_b32 s60, s3, 5
    v_lshl_add_u32 v75, v5, 1, s60
    s_mul_i32 s3, s3, 14336
    s_lshl_b32 s60, s54, 7
    s_add_u32 s3, s3, s60
    v_mul_u32_u24 v15, 896, v5
    v_lshl_add_u32 v15, v6, 4, v15
    v_add_u32 v78, s3, v15
    v_add_u32 v79, 7168, v78
    s_cmp_lt_u32 s101, 28
    s_cselect_b32 s56, 1, 0
    s_lshl_b32 s50, s7, 3
    s_and_b32 s3, s101, 7
    s_add_u32 s50, s50, s3
    s_lshr_b32 s60, s101, 3
    s_lshl_b32 s49, s6, 2
    s_add_u32 s49, s49, s60
    s_lshl_b32 s49, s49, 2
    s_add_u32 s49, s49, s48
    s_mul_i32 s60, s60, 0
    s_add_u32 s3, s3, s60
    s_sub_u32 s60, s3, 7
    s_cmp_ge_u32 s3, 7
    s_cselect_b32 s3, s60, s3
    s_lshl_b32 s62, s3, 18
    s_mul_i32 s63, s3, 12288
    s_mov_b32 s30, 20971520
    s_mov_b32 s31, 0x20000
    s_mov_b32 s75, 0x3727c5ac
    s_mov_b32 s76, 0x3b124925
    s_mov_b32 s77, 0x3f803f80
    v_lshlrev_b32 v4, 4, v1
    v_bfe_u32 v7, v1, 2, 2
    v_and_b32 v8, 3, v1
    v_mul_u32_u24 v14, 960, v9
    v_lshl_add_u32 v14, v10, 4, v14
    s_mul_i32 s3, s48, 1920
    s_add_u32 s3, s3, 147456
    v_add_u32 v224, s3, v14
    v_mul_u32_u24 v14, 960, v7
    v_lshl_add_u32 v14, v3, 5, v14
    v_lshl_add_u32 v14, v8, 3, v14
    s_lshl_b32 s3, s48, 8
    s_add_u32 s3, s3, 147456
    v_add_u32 v225, s3, v14
    s_lshl_b32 s3, s48, 3
    s_add_u32 s3, s3, 155648
    v_lshl_add_u32 v226, v9, 2, s3
    v_lshlrev_b32 v231, 2, v6
    v_and_b32 v2, 15, v1
    v_lshlrev_b32 v232, 14, v3
    v_add_lshl_u32 v232, v232, v2, 2
    v_add_u32 v231, 155648, v231
    v_lshlrev_b32 v14, 17, v9
    v_lshl_add_u32 v227, v10, 4, v14
    s_cmp_eq_u32 s48, 3
    s_cselect_b32 s60, 268435456, 0
    s_lshl_b32 s70, s48, 10
    s_add_u32 s70, s70, s2
    s_lshl_b32 s70, s70, 9
    s_add_u32 s71, s70, 262144
    s_add_u32 s71, s71, s60
    s_xor_b32 s60, s60, 268435456
    s_lshl_b32 s72, s2, 7
    s_add_u32 s72, s72, s60
    s_add_u32 s72, s72, 6291456
    s_lshr_b32 s74, s2, 2
    s_lshl_b32 s74, s74, 5
    s_and_b32 s3, s2, 3
    s_add_u32 s74, s74, s3
    s_lshl_b32 s74, s74, 2
    s_add_u32 s74, s74, 10485760
    v_cmp_gt_u32 vcc, 8, v0
    v_lshlrev_b32 v230, 13, v0
    v_mov_b32 v14, 268435456
    s_and_b32 s3, s2, 7
    s_lshl_b32 s3, s3, 13
    s_add_u32 s3, s3, 10485760
    v_lshrrev_b32 v15, 2, v0
    v_lshl_add_u32 v15, v15, 7, s3
    v_lshl_add_u32 v20, v8, 2, v15
    v_cndmask_b32 v230, v14, v230, vcc
    v_mov_b32 v17, 0
    s_lshl_b32 s3, s48, 14
    s_add_u32 s74, s74, s3
    s_add_u32 s73, s74, 8192
    s_waitcnt vmcnt(10)
    v_dot2_f32_bf16 v220, v176, s77, 0
    v_dot2_f32_bf16 v221, v176, v176, 0
    v_dot2_f32_bf16 v220, v177, s77, v220
    v_dot2_f32_bf16 v221, v177, v177, v221
    v_dot2_f32_bf16 v220, v178, s77, v220
    v_dot2_f32_bf16 v221, v178, v178, v221
    v_dot2_f32_bf16 v220, v179, s77, v220
    v_dot2_f32_bf16 v221, v179, v179, v221
    s_waitcnt vmcnt(9)
    v_dot2_f32_bf16 v220, v180, s77, v220
    v_dot2_f32_bf16 v221, v180, v180, v221
    v_dot2_f32_bf16 v220, v181, s77, v220
    v_dot2_f32_bf16 v221, v181, v181, v221
    v_dot2_f32_bf16 v220, v182, s77, v220
    v_dot2_f32_bf16 v221, v182, v182, v221
    v_dot2_f32_bf16 v220, v183, s77, v220
    v_dot2_f32_bf16 v221, v183, v183, v221
    buffer_load_dword v12, v17, s[44:47], 0 offen sc1
    v_lshlrev_b32 v184, 16, v176
    v_and_b32 v185, 0xffff0000, v176
    v_add_f32_dpp v220, v220, v220 quad_perm:[1,0,3,2] row_mask:0xf bank_mask:0xf
    v_add_f32_dpp v221, v221, v221 quad_perm:[1,0,3,2] row_mask:0xf bank_mask:0xf
    v_lshlrev_b32 v186, 16, v177
    v_add_f32_dpp v220, v220, v220 quad_perm:[2,3,0,1] row_mask:0xf bank_mask:0xf
    v_add_f32_dpp v221, v221, v221 quad_perm:[2,3,0,1] row_mask:0xf bank_mask:0xf
    v_and_b32 v187, 0xffff0000, v177
    v_add_f32_dpp v220, v220, v220 row_half_mirror row_mask:0xf bank_mask:0xf
    v_add_f32_dpp v221, v221, v221 row_half_mirror row_mask:0xf bank_mask:0xf
    v_lshlrev_b32 v188, 16, v178
    v_add_f32_dpp v220, v220, v220 row_mirror row_mask:0xf bank_mask:0xf
    v_add_f32_dpp v221, v221, v221 row_mirror row_mask:0xf bank_mask:0xf
    v_and_b32 v189, 0xffff0000, v178
    v_mov_b32 v222, v220
    v_mov_b32 v223, v221
    v_lshlrev_b32 v190, 16, v179
    v_permlane16_swap_b32 v220, v222
    v_permlane16_swap_b32 v221, v223
    v_add_f32 v220, v220, v222
    v_add_f32 v221, v221, v223
    v_mul_f32_e64 v220, -v220, s76
    v_mul_f32 v222, v220, v220
    v_fma_f32 v221, v221, s76, -v222
    v_max_f32 v221, 0, v221
    v_add_f32 v222, s75, v221
    v_rsq_f32 v216, v222
    v_and_b32 v191, 0xffff0000, v179
    v_mul_f32 v222, v216, v216
    v_fma_f32 v223, v222, v221, s75
    v_rsq_f32 v222, v223
    v_mul_f32 v217, v220, v216
    v_mul_f32 v218, v216, v222
    v_mul_f32 v219, v217, v222
    v_mul_f32 v223, v223, v222
    ds_write_b32 v226, v223
    v_lshlrev_b32 v192, 16, v180
    v_and_b32 v193, 0xffff0000, v180
    v_lshlrev_b32 v194, 16, v181
    v_and_b32 v195, 0xffff0000, v181
    v_lshlrev_b32 v196, 16, v182
    v_and_b32 v197, 0xffff0000, v182
    v_lshlrev_b32 v198, 16, v183
    v_and_b32 v199, 0xffff0000, v183
    v_pk_fma_f32 v[200:201], v[184:185], v[218:219], v[218:219] op_sel:[0,0,1] op_sel_hi:[1,0,1]
    v_pk_fma_f32 v[202:203], v[186:187], v[218:219], v[218:219] op_sel:[0,0,1] op_sel_hi:[1,0,1]
    v_pk_fma_f32 v[204:205], v[188:189], v[218:219], v[218:219] op_sel:[0,0,1] op_sel_hi:[1,0,1]
    v_pk_fma_f32 v[206:207], v[190:191], v[218:219], v[218:219] op_sel:[0,0,1] op_sel_hi:[1,0,1]
    v_cvt_pk_bf16_f32 v176, v200, v201
    v_cvt_pk_bf16_f32 v177, v202, v203
    v_cvt_pk_bf16_f32 v178, v204, v205
    v_cvt_pk_bf16_f32 v179, v206, v207
    ds_write_b128 v224, v[176:179] offset:0
    v_pk_fma_f32 v[208:209], v[192:193], v[218:219], v[218:219] op_sel:[0,0,1] op_sel_hi:[1,0,1]
    v_pk_fma_f32 v[210:211], v[194:195], v[218:219], v[218:219] op_sel:[0,0,1] op_sel_hi:[1,0,1]
    v_pk_fma_f32 v[212:213], v[196:197], v[218:219], v[218:219] op_sel:[0,0,1] op_sel_hi:[1,0,1]
    v_pk_fma_f32 v[214:215], v[198:199], v[218:219], v[218:219] op_sel:[0,0,1] op_sel_hi:[1,0,1]
    v_cvt_pk_bf16_f32 v180, v208, v209
    v_cvt_pk_bf16_f32 v181, v210, v211
    v_cvt_pk_bf16_f32 v182, v212, v213
    v_cvt_pk_bf16_f32 v183, v214, v215
    ds_write_b128 v224, v[180:183] offset:448
    s_waitcnt lgkmcnt(0)
    s_barrier
    ds_read_b64_tr_b16 v[104:105], v225 offset:0
    ds_read_b64_tr_b16 v[106:107], v225 offset:3840
    ds_read_b64_tr_b16 v[108:109], v225 offset:128
    ds_read_b64_tr_b16 v[110:111], v225 offset:3968
    ds_read_b32 v223, v231
    s_waitcnt lgkmcnt(3)
    buffer_store_dwordx4 v[104:107], v227, s[28:31], s70 offen sc1
    s_waitcnt lgkmcnt(1)
    buffer_store_dwordx4 v[108:111], v227, s[28:31], s71 offen sc1
    v_cmp_gt_u32 vcc, 16, v1
    s_waitcnt lgkmcnt(0)
    s_nop 0
    v_cndmask_b32 v223, 0, v223, vcc
    buffer_store_dword v223, v232, s[28:31], s72 offen sc1
    s_add_u32 m0, s58, 16384
    s_add_u32 s0, s0, 458752
    s_cmp_eq_u32 s0, 3670016
    s_cselect_b32 s0, 0, s0
    buffer_load_dwordx4 v48, s[20:23], s0 offen lds
    buffer_load_dwordx4 v49, s[20:23], s0 offen offset:1024 lds
    buffer_load_dwordx4 v50, s[20:23], s0 offen offset:2048 lds
    buffer_load_dwordx4 v51, s[20:23], s0 offen offset:3072 lds
    s_mov_b32 s18, 401408
    s_mov_b32 s19, 0x20000
    s_mov_b32 s26, 7340032
    s_mov_b32 s27, 0x20000
    s_mov_b32 s34, 1835008
    s_mov_b32 s35, 0x20000
    s_mov_b32 s36, 1
    v_lshl_add_u32 v15, v9, 2, v7
    v_lshlrev_b32 v15, 7, v15
    v_lshl_add_u32 v15, v8, 3, v15
    v_and_b32 v16, 2, v7
    v_and_b32 v14, 1, v3
    v_add_u32 v16, v16, v14
    v_lshl_add_u32 v15, v16, 5, v15
    s_mul_i32 s3, s4, 8256
    v_xor_b32 v31, s3, v15
    v_xor_b32 v32, 64, v31
    v_add_u32 v33, 65536, v31
    v_add_u32 v34, 65536, v32
    v_add_u32 v35, 131072, v31
    v_add_u32 v36, 131072, v32
    s_lshl_b32 s6, s52, 1
    s_add_u32 s6, s6, s5
    s_lshl_b32 s3, s6, 1
    s_add_u32 s3, s3, s59
    s_lshl_b32 s3, s3, 4
    s_add_u32 s3, s3, s4
    s_lshl_b32 s3, s3, 12
    v_add_u32 v71, s3, v4
    s_xor_b32 s37, s51, 1
    s_lshl_b32 s37, s37, 3
    s_add_u32 s37, s37, s52
    s_lshl_b32 s3, s37, 14
    s_add_u32 s3, s3, s58
    s_add_u32 s3, s3, 16777216
    v_add_u32 v23, s3, v4
    s_lshl_b32 s37, s37, 5
    s_add_u32 s37, s37, s5
    s_lshl_b32 s37, s37, 2
    s_add_u32 s37, s37, 6422528
    s_mul_i32 s67, s6, 56
    s_lshl_b32 s3, s51, 1
    s_add_u32 s3, s3, s4
    s_add_u32 s67, s67, s3
    s_lshl_b32 s67, s67, 11
    s_add_u32 s67, s67, 2097152
    v_add_u32 v74, s58, v4
    s_lshl_b32 s68, s52, 2
    s_and_b32 s3, s51, 1
    s_add_u32 s68, s68, s3
    s_cmp_ge_u32 s51, 14
    s_cselect_b32 s3, 2, 0
    s_add_u32 s68, s68, s3
    s_lshl_b32 s68, s68, 7
    s_add_u32 s68, s68, 6356992
    s_waitcnt vmcnt(7)
    v_readfirstlane_b32 s57, v12
    s_mov_b32 s60, 0
    s_cmp_lg_u32 s57, 0
    s_cbranch_scc1 L_nonce_ok
L_nonce:
    buffer_load_dword v12, v17, s[44:47], 0 offen sc1
    s_add_u32 s60, s60, 1
    s_waitcnt vmcnt(0)
    v_readfirstlane_b32 s57, v12
    s_cmp_ge_u32 s60, 20000
    s_cbranch_scc1 L_nonce_ok
    s_cmp_eq_u32 s57, 0
    s_cbranch_scc1 L_nonce
L_nonce_ok:
    s_waitcnt vmcnt(4)
    s_barrier
    s_atomic_swap s57, s[28:29], s74
    s_atomic_swap s57, s[28:29], s73
    buffer_load_dwordx4 v[90:93], v78, s[8:11], 0 offen
    buffer_load_ushort v88, v75, s[40:43], 0 offen offset:0
    buffer_load_dwordx4 v[94:97], v79, s[8:11], 0 offen
    buffer_load_ushort v89, v75, s[40:43], 0 offen offset:16
    v_add_u32 v46, 65536, v4
    s_add_u32 m0, s58, 32768
    s_add_u32 s0, s0, 458752
    s_cmp_eq_u32 s0, 3670016
    s_cselect_b32 s0, 0, s0
    buffer_load_dwordx4 v48, s[20:23], s0 offen lds
    v_add_u32 v47, 131072, v4
    s_mul_i32 s59, s48, 3072
    s_mul_i32 s3, s50, 86016
    s_add_u32 s3, s3, s59
    s_add_u32 s3, s3, 8388608
    v_add_u32 v73, s3, v4
    v_lshlrev_b32 v15, 7, v9
    v_xor_b32 v15, v15, v4
    s_lshl_b32 s3, s49, 11
    v_add_u32 v60, s3, v15
    v_add_u32 v61, 129024, v60
    s_lshr_b32 s3, s49, 2
    s_lshl_b32 s3, s3, 3
    s_max_u32 s3, s3, 1
    s_sub_u32 s3, s3, 1
    s_lshl_b32 s3, s3, 10
    s_lshl_b32 s6, s5, 17
    s_add_u32 s3, s3, s6
    s_lshl_b32 s6, s4, 28
    s_add_u32 s3, s3, s6
    v_add_u32 v62, s3, v15
    buffer_load_dwordx4 v49, s[20:23], s0 offen offset:1024 lds
    s_lshl_b32 s100, s5, 1
    s_add_u32 s100, s100, s4
    s_lshl_b32 s100, s100, 10
    v_and_b32 v15, 1, v1
    v_mul_u32_u24 v15, 640, v15
    v_lshrrev_b32 v16, 2, v1
    v_lshlrev_b32 v16, 4, v16
    v_xor_b32 v15, v15, v16
    v_bfe_u32 v16, v1, 1, 1
    v_lshl_add_u32 v15, v16, 3, v15
    buffer_load_dwordx4 v50, s[20:23], s0 offen offset:2048 lds
    s_add_u32 s3, s58, 12288
    v_add_u32 v63, s3, v15
    s_sub_u32 s3, s3, 3072
    s_cmp_eq_u32 s48, 0
    s_cselect_b32 s3, 28672, s3
    v_add_u32 v64, s3, v15
    v_add_u32 v65, 65536, v63
    v_add_u32 v66, 65536, v64
    v_add_u32 v67, 131072, v63
    v_add_u32 v68, 131072, v64
    s_lshl_b32 s3, s49, 1
    v_min_u32 v15, 2, v3
    v_add_u32 v15, s3, v15
    v_max_u32 v15, 1, v15
    v_lshlrev_b32 v15, 1, v15
    v_and_b32 v16, 1, v7
    buffer_load_dwordx4 v51, s[20:23], s0 offen offset:3072 lds
    v_add_lshl_u32 v15, v15, v16, 7
    v_lshrrev_b32 v16, 1, v7
    v_lshl_add_u32 v16, v16, 2, v8
    v_lshl_add_u32 v15, v16, 2, v15
    v_add_u32 v70, 6291200, v15
    s_min_u32 s15, s48, 2
    s_lshl_b32 s15, s15, 6
    s_add_u32 s15, s15, 64
    s_lshl_b32 s82, s49, 5
    s_add_u32 s82, s82, s50
    s_lshl_b32 s82, s82, 10
    s_add_u32 s82, s82, 4194304
    s_lshr_b32 s69, s49, 2
    s_lshl_b32 s69, s69, 1
    s_and_b32 s3, s50, 1
    s_add_u32 s69, s69, s3
    s_lshl_b32 s69, s69, 7
    s_add_u32 s69, s69, 6361088
    s_and_b32 s7, s53, 1
    s_mul_i32 s3, s7, 28
    s_add_u32 s3, s3, s48
    s_lshl_b32 s3, s3, 17
    s_xor_b32 s6, s53, 1
    s_lshl_b32 s55, s6, 3
    s_lshl_b32 s6, s53, 7
    s_add_u32 s3, s3, s6
    v_lshlrev_b32 v15, 12, v5
    s_add_u32 m0, s58, 49152
    s_add_u32 s0, s0, 458752
    s_cmp_eq_u32 s0, 3670016
    s_cselect_b32 s0, 0, s0
    buffer_load_dwordx4 v48, s[20:23], s0 offen lds
    v_add3_u32 v52, v15, v76, s3
    v_add_u32 v53, 31744, v52
    v_add_u32 v54, 63488, v52
    v_add_u32 v55, 95232, v52
    v_mul_u32_u24 v15, 896, v5
    s_mul_i32 s3, s4, 25088
    s_mul_i32 s6, s5, 14336
    s_add_u32 s3, s3, s6
    s_lshl_b32 s6, s54, 7
    s_add_u32 s3, s3, s6
    v_add3_u32 v56, v15, v76, s3
    buffer_load_dwordx4 v49, s[20:23], s0 offen offset:1024 lds
    v_add_u32 v57, 6144, v56
    s_lshl_b32 s6, s53, 1
    s_add_u32 s6, s6, s5
    s_and_b32 s3, s53, 30
    s_add_u32 s3, s3, s4
    s_lshl_b32 s3, s3, 7
    s_add_u32 s39, s3, 6361088
    s_lshl_b32 s3, s6, 5
    s_add_u32 s3, s3, s4
    s_lshl_b32 s3, s3, 10
    s_add_u32 s3, s3, 4194304
    v_add_u32 v58, s3, v4
    v_add_u32 v59, 15360, v58
    s_xor_b32 s3, s4, s5
    s_lshl_b32 s3, s3, 6
    v_xor_b32 v37, s3, v31
    buffer_load_dwordx4 v50, s[20:23], s0 offen offset:2048 lds
    v_add_u32 v38, 65536, v37
    v_add_u32 v39, 131072, v37
    v_lshlrev_b32 v14, 10, v14
    v_lshl_add_u32 v14, v9, 8, v14
    v_lshl_add_u32 v14, v2, 4, v14
    s_mul_i32 s3, s4, 12288
    v_add_u32 v40, s3, v14
    v_xor_b32 v41, 4096, v40
    v_add_u32 v42, 65536, v40
    v_add_u32 v43, 65536, v41
    v_add_u32 v44, 131072, v40
    v_add_u32 v45, 131072, v41
    s_lshl_b32 s6, s54, 1
    s_add_u32 s6, s6, s5
    s_lshl_b32 s3, s6, 1
    s_add_u32 s3, s3, s7
    s_mul_i32 s3, s3, 14
    s_add_u32 s3, s3, s4
    s_lshl_b32 s3, s3, 12
    s_add_u32 s3, s3, 2097152
    v_add_u32 v72, s3, v4
    buffer_load_dwordx4 v51, s[20:23], s0 offen offset:3072 lds
    s_lshl_b32 s3, s54, 1
    s_add_u32 s3, s3, s7
    s_lshl_b32 s3, s3, 1
    s_add_u32 s3, s3, s4
    s_lshl_b32 s3, s3, 7
    s_add_u32 s38, s3, 6356992
    s_and_b32 s3, s2, 6
    s_add_u32 s3, s3, s54
    s_sub_u32 s6, s3, 7
    s_cmp_ge_u32 s3, 7
    s_cselect_b32 s3, s6, s3
    s_lshl_b32 s64, s3, 19
    s_lshl_b32 s65, s3, 13
    s_add_u32 s55, s55, s54
    s_lshl_b32 s3, s55, 14
    s_add_u32 s3, s3, s58
    s_add_u32 s3, s3, 12582912
    v_add_u32 v21, s3, v4
    s_add_u32 m0, s58, 65536
    s_add_u32 s0, s0, 458752
    s_cmp_eq_u32 s0, 3670016
    s_cselect_b32 s0, 0, s0
    buffer_load_dwordx4 v48, s[20:23], s0 offen lds
    s_lshl_b32 s55, s55, 5
    s_add_u32 s55, s55, s48
    s_lshl_b32 s55, s55, 2
    s_add_u32 s55, s55, 6488064
    s_lshl_b32 s3, s5, 3
    v_add_u32 v14, s3, v9
    v_xor_b32 v14, v14, v6
    v_lshlrev_b32 v14, 4, v14
    v_lshl_add_u32 v14, v10, 8, v14
    buffer_load_dwordx4 v49, s[20:23], s0 offen offset:1024 lds
    s_lshl_b32 s3, s4, 14
    s_add_u32 s3, s3, 131072
    v_add_u32 v80, s3, v14
    v_xor_b32 v81, 32, v80
    v_xor_b32 v82, 64, v80
    v_xor_b32 v83, 96, v80
    s_lshr_b32 s3, s53, 1
    s_add_u32 s66, s3, s54
    v_lshlrev_b32 v14, 1, v6
    v_xor_b32 v14, v14, v5
    v_lshlrev_b32 v14, 4, v14
    v_lshl_add_u32 v14, v5, 8, v14
    s_add_u32 s3, s58, 131072
    v_add_u32 v84, s3, v14
    v_xor_b32 v85, 16, v84
    v_xor_b32 v86, 24576, v84
    buffer_load_dwordx4 v50, s[20:23], s0 offen offset:2048 lds
    v_xor_b32 v87, 24592, v84
    v_lshlrev_b32 v144, 16, v240
    v_and_b32 v145, 0xffff0000, v240
    v_lshlrev_b32 v146, 16, v241
    v_and_b32 v147, 0xffff0000, v241
    v_lshlrev_b32 v148, 16, v242
    v_and_b32 v149, 0xffff0000, v242
    v_lshlrev_b32 v150, 16, v243
    v_and_b32 v151, 0xffff0000, v243
    v_lshlrev_b32 v152, 16, v244
    v_and_b32 v153, 0xffff0000, v244
    v_lshlrev_b32 v154, 16, v245
    v_and_b32 v155, 0xffff0000, v245
    v_lshlrev_b32 v156, 16, v246
    v_and_b32 v157, 0xffff0000, v246
    v_lshlrev_b32 v158, 16, v247
    buffer_load_dwordx4 v51, s[20:23], s0 offen offset:3072 lds
    v_and_b32 v159, 0xffff0000, v247
    s_add_u32 m0, s58, 81920
    s_add_u32 s0, s0, 458752
    s_cmp_eq_u32 s0, 3670016
    s_cselect_b32 s0, 0, s0
    buffer_load_dwordx4 v48, s[20:23], s0 offen lds
    buffer_load_dwordx4 v49, s[20:23], s0 offen offset:1024 lds
    buffer_load_dwordx4 v50, s[20:23], s0 offen offset:2048 lds
    buffer_load_dwordx4 v51, s[20:23], s0 offen offset:3072 lds
    buffer_load_dword v18, v20, s[28:31], 0 offen sc1
    s_add_u32 m0, s58, 98304
    s_add_u32 s0, s0, 458752
    s_cmp_eq_u32 s0, 3670016
    s_cselect_b32 s0, 0, s0
    buffer_load_dwordx4 v48, s[20:23], s0 offen lds
    buffer_load_dwordx4 v49, s[20:23], s0 offen offset:1024 lds
    buffer_load_dwordx4 v50, s[20:23], s0 offen offset:2048 lds
    buffer_load_dwordx4 v51, s[20:23], s0 offen offset:3072 lds
    s_add_u32 m0, s58, 114688
    s_add_u32 s0, s0, 458752
    s_cmp_eq_u32 s0, 3670016
    s_cselect_b32 s0, 0, s0
    buffer_load_dwordx4 v48, s[20:23], s0 offen lds
    buffer_load_dwordx4 v49, s[20:23], s0 offen offset:1024 lds
    buffer_load_dwordx4 v50, s[20:23], s0 offen offset:2048 lds
    buffer_load_dwordx4 v51, s[20:23], s0 offen offset:3072 lds
    s_waitcnt vmcnt(8)
    v_cmp_ne_u32 vcc, s57, v18
    s_cbranch_vccz L_pollok0
    s_mov_b32 s60, 0
L_poll0:
    s_sleep 4
    buffer_load_dword v18, v20, s[28:31], 0 offen sc1
    s_add_u32 s60, s60, 1
    s_waitcnt vmcnt(0)
    v_cmp_ne_u32 vcc, s57, v18
    s_cbranch_vccz L_pollok0
    s_cmp_lt_u32 s60, 20000
    s_cbranch_scc1 L_poll0
L_pollok0:
    s_barrier
    buffer_load_dwordx4 a[0:3], v71, s[28:31], s1 offen offset:0 sc1
    buffer_load_dwordx4 a[4:7], v71, s[28:31], s1 offen offset:1024 sc1
    buffer_load_dwordx4 a[8:11], v71, s[28:31], s1 offen offset:2048 sc1
    buffer_load_dwordx4 a[12:15], v71, s[28:31], s1 offen offset:3072 sc1
    buffer_load_dword v69, v70, s[28:31], 0 offen sc1
    s_add_u32 s1, s1, 8192
    s_and_b32 s1, s1, 0xffff
    buffer_load_dwordx4 a[16:19], v71, s[28:31], s1 offen offset:0 sc1
    buffer_load_dwordx4 a[20:23], v71, s[28:31], s1 offen offset:1024 sc1
    buffer_load_dwordx4 a[24:27], v71, s[28:31], s1 offen offset:2048 sc1
    buffer_load_dwordx4 a[28:31], v71, s[28:31], s1 offen offset:3072 sc1
    s_add_u32 s1, s1, 8192
    s_and_b32 s1, s1, 0xffff
    buffer_load_dwordx4 a[32:35], v71, s[28:31], s1 offen offset:0 sc1
    buffer_load_dwordx4 a[36:39], v71, s[28:31], s1 offen offset:1024 sc1
    buffer_load_dwordx4 a[40:43], v71, s[28:31], s1 offen offset:2048 sc1
    buffer_load_dwordx4 a[44:47], v71, s[28:31], s1 offen offset:3072 sc1
    ds_read_b64_tr_b16 a[200:201], v31 offset:0
    ds_read_b64_tr_b16 a[202:203], v31 offset:1024
    ds_read_b64_tr_b16 a[204:205], v32 offset:0
    ds_read_b64_tr_b16 a[206:207], v32 offset:1024
    ds_read_b64_tr_b16 a[208:209], v31 offset:2048
    ds_read_b64_tr_b16 a[210:211], v31 offset:3072
    ds_read_b64_tr_b16 a[212:213], v32 offset:2048
    ds_read_b64_tr_b16 a[214:215], v32 offset:3072
    ds_read_b64_tr_b16 a[216:217], v31 offset:4096
    ds_read_b64_tr_b16 a[218:219], v31 offset:5120
    ds_read_b64_tr_b16 a[220:221], v32 offset:4096
    ds_read_b64_tr_b16 a[222:223], v32 offset:5120
    s_waitcnt vmcnt(12) lgkmcnt(8)
    v_mfma_f32_32x32x16_bf16 v[176:191], a[200:203], a[0:3], 0
    ds_read_b64_tr_b16 a[224:225], v31 offset:6144
    ds_read_b64_tr_b16 a[226:227], v31 offset:7168
    s_mov_b32 s70, 0xaaaaaaaa
    s_mov_b32 s71, 0xaaaaaaaa
    s_mov_b32 s72, 0xfff0ffff
    s_mov_b32 s73, 0xf000ff00
    s_mov_b32 s74, 0xffc0fffc
    s_mov_b32 s75, 0xc000fc00
    s_mov_b32 s83, 0x3e8b97f6
    v_mfma_f32_32x32x16_bf16 v[192:207], a[204:207], a[0:3], 0
    s_add_u32 s1, s1, 8192
    s_and_b32 s1, s1, 0xffff
    buffer_load_dwordx4 a[48:51], v71, s[28:31], s1 offen offset:0 sc1
    ds_read_b64_tr_b16 a[228:229], v32 offset:6144
    ds_read_b64_tr_b16 a[230:231], v32 offset:7168
    v_lshlrev_b32 v14, 2, v2
    s_waitcnt vmcnt(12) lgkmcnt(8)
    v_mfma_f32_32x32x16_bf16 v[176:191], a[208:211], a[4:7], v[176:191]
    buffer_load_dwordx4 a[52:55], v71, s[28:31], s1 offen offset:1024 sc1
    ds_read_b64_tr_b16 a[200:201], v31 offset:16384
    ds_read_b64_tr_b16 a[202:203], v31 offset:17408
    v_and_b32 v15, 1, v1
    v_mfma_f32_32x32x16_bf16 v[192:207], a[212:215], a[4:7], v[192:207]
    ds_read_b64_tr_b16 a[204:205], v32 offset:16384
    ds_read_b64_tr_b16 a[206:207], v32 offset:17408
    v_lshl_add_u32 v15, v3, 2, v15
    s_waitcnt vmcnt(12) lgkmcnt(8)
    v_mfma_f32_32x32x16_bf16 v[176:191], a[216:219], a[8:11], v[176:191]
    buffer_load_dwordx4 a[56:59], v71, s[28:31], s1 offen offset:2048 sc1
    ds_read_b64_tr_b16 a[208:209], v31 offset:18432
    ds_read_b64_tr_b16 a[210:211], v31 offset:19456
    v_lshlrev_b32 v15, 2, v15
    v_mfma_f32_32x32x16_bf16 v[192:207], a[220:223], a[8:11], v[192:207]
    buffer_load_dwordx4 a[60:63], v71, s[28:31], s1 offen offset:3072 sc1
    ds_read_b64_tr_b16 a[212:213], v32 offset:18432
    ds_read_b64_tr_b16 a[214:215], v32 offset:19456
    v_add_u32 v16, 64, v15
    s_waitcnt vmcnt(13) lgkmcnt(8)
    v_mfma_f32_32x32x16_bf16 v[176:191], a[224:227], a[12:15], v[176:191]
    ds_read_b64_tr_b16 a[216:217], v31 offset:20480
    ds_read_b64_tr_b16 a[218:219], v31 offset:21504
    v_cndmask_b32 v17, v15, v16, s[72:73]
    v_mfma_f32_32x32x16_bf16 v[192:207], a[228:231], a[12:15], v[192:207]
    s_add_u32 m0, s58, 131072
    s_add_u32 s0, s0, 458752
    s_cmp_eq_u32 s0, 3670016
    s_cselect_b32 s0, 0, s0
    v_xor_b32 v48, 128, v48
    buffer_load_dwordx4 v48, s[20:23], s0 offen lds
    ds_read_b64_tr_b16 a[220:221], v32 offset:20480
    ds_read_b64_tr_b16 a[222:223], v32 offset:21504
    v_cndmask_b32 v15, v15, v16, s[74:75]
    s_waitcnt vmcnt(12) lgkmcnt(8)
    v_mfma_f32_32x32x16_bf16 v[176:191], a[200:203], a[16:19], v[176:191]
    v_xor_b32 v49, 128, v49
    buffer_load_dwordx4 v49, s[20:23], s0 offen offset:1024 lds
    ds_read_b64_tr_b16 a[224:225], v31 offset:22528
    ds_read_b64_tr_b16 a[226:227], v31 offset:23552
    ds_bpermute_b32 v25, v14, v69 offset:64
    v_mfma_f32_32x32x16_bf16 v[192:207], a[204:207], a[16:19], v[192:207]
    ds_read_b64_tr_b16 a[228:229], v32 offset:22528
    ds_read_b64_tr_b16 a[230:231], v32 offset:23552
    ds_bpermute_b32 v27, v17, v69 offset:0
    s_waitcnt vmcnt(12) lgkmcnt(10)
    v_mfma_f32_32x32x16_bf16 v[176:191], a[208:211], a[20:23], v[176:191]
    v_xor_b32 v50, 128, v50
    buffer_load_dwordx4 v50, s[20:23], s0 offen offset:2048 lds
    ds_read_b64_tr_b16 a[200:201], v31 offset:32768
    ds_read_b64_tr_b16 a[202:203], v31 offset:33792
    ds_bpermute_b32 v28, v15, v69 offset:8
    v_mfma_f32_32x32x16_bf16 v[192:207], a[212:215], a[20:23], v[192:207]
    ds_read_b64_tr_b16 a[204:205], v32 offset:32768
    ds_read_b64_tr_b16 a[206:207], v32 offset:33792
    ds_bpermute_b32 v26, v14, v69 offset:128
    s_waitcnt vmcnt(12) lgkmcnt(12)
    v_mfma_f32_32x32x16_bf16 v[176:191], a[216:219], a[24:27], v[176:191]
    v_xor_b32 v51, 128, v51
    buffer_load_dwordx4 v51, s[20:23], s0 offen offset:3072 lds
    ds_read_b64_tr_b16 a[208:209], v31 offset:34816
    ds_read_b64_tr_b16 a[210:211], v31 offset:35840
    ds_bpermute_b32 v29, v17, v69 offset:64
    v_mfma_f32_32x32x16_bf16 v[192:207], a[220:223], a[24:27], v[192:207]
    ds_read_b64_tr_b16 a[212:213], v32 offset:34816
    ds_read_b64_tr_b16 a[214:215], v32 offset:35840
    ds_bpermute_b32 v30, v15, v69 offset:72
    s_waitcnt vmcnt(12) lgkmcnt(13)
    v_mfma_f32_32x32x16_bf16 v[176:191], a[224:227], a[28:31], v[176:191]
    s_add_u32 s1, s1, 8192
    s_and_b32 s1, s1, 0xffff
    buffer_load_dwordx4 a[64:67], v71, s[28:31], s1 offen offset:0 sc1
    ds_read_b64_tr_b16 a[216:217], v31 offset:36864
    ds_read_b64_tr_b16 a[218:219], v31 offset:37888
    v_mfma_f32_32x32x16_bf16 v[192:207], a[228:231], a[28:31], v[192:207]
    buffer_load_dwordx4 a[68:71], v71, s[28:31], s1 offen offset:1024 sc1
    ds_read_b64_tr_b16 a[220:221], v32 offset:36864
    ds_read_b64_tr_b16 a[222:223], v32 offset:37888
    s_waitcnt vmcnt(13) lgkmcnt(11)
    v_mfma_f32_32x32x16_bf16 v[176:191], a[200:203], a[32:35], v[176:191]
    ds_read_b64_tr_b16 a[224:225], v31 offset:38912
    ds_read_b64_tr_b16 a[226:227], v31 offset:39936
    v_mfma_f32_32x32x16_bf16 v[192:207], a[204:207], a[32:35], v[192:207]
    buffer_load_dwordx4 a[72:75], v71, s[28:31], s1 offen offset:2048 sc1
    ds_read_b64_tr_b16 a[228:229], v32 offset:38912
    ds_read_b64_tr_b16 a[230:231], v32 offset:39936
    s_waitcnt vmcnt(13) lgkmcnt(9)
    v_mfma_f32_32x32x16_bf16 v[176:191], a[208:211], a[36:39], v[176:191]
    s_barrier
    ds_read_b64_tr_b16 a[200:201], v31 offset:49152
    ds_read_b64_tr_b16 a[202:203], v31 offset:50176
    v_mfma_f32_32x32x16_bf16 v[192:207], a[212:215], a[36:39], v[192:207]
    buffer_load_dwordx4 a[76:79], v71, s[28:31], s1 offen offset:3072 sc1
    ds_read_b64_tr_b16 a[204:205], v32 offset:49152
    ds_read_b64_tr_b16 a[206:207], v32 offset:50176
    s_waitcnt vmcnt(13) lgkmcnt(8)
    v_mfma_f32_32x32x16_bf16 v[176:191], a[216:219], a[40:43], v[176:191]
    ds_read_b64_tr_b16 a[208:209], v31 offset:51200
    ds_read_b64_tr_b16 a[210:211], v31 offset:52224
    v_mul_f32 v25, s83, v25
    s_add_u32 m0, s58, 147456
    s_add_u32 s0, s0, 458752
    s_cmp_eq_u32 s0, 3670016
    s_cselect_b32 s0, 0, s0
    buffer_load_dwordx4 v48, s[20:23], s0 offen lds
    v_mfma_f32_32x32x16_bf16 v[192:207], a[220:223], a[40:43], v[192:207]
    ds_read_b64_tr_b16 a[212:213], v32 offset:51200
    ds_read_b64_tr_b16 a[214:215], v32 offset:52224
    v_mul_f32 v26, s83, v26
    s_waitcnt vmcnt(13) lgkmcnt(8)
    v_mfma_f32_32x32x16_bf16 v[176:191], a[224:227], a[44:47], v[176:191]
    buffer_load_dwordx4 v49, s[20:23], s0 offen offset:1024 lds
    ds_read_b64_tr_b16 a[216:217], v31 offset:53248
    ds_read_b64_tr_b16 a[218:219], v31 offset:54272
    s_cmp_eq_u32 s49, 0
    s_cselect_b64 s[76:77], 0, -1
    v_mfma_f32_32x32x16_bf16 v[192:207], a[228:231], a[44:47], v[192:207]
    ds_read_b64_tr_b16 a[220:221], v32 offset:53248
    ds_read_b64_tr_b16 a[222:223], v32 offset:54272
    v_mov_b32 v14, 0xffff
    buffer_load_dwordx4 v50, s[20:23], s0 offen offset:2048 lds
    s_waitcnt vmcnt(14) lgkmcnt(8)
    v_mfma_f32_32x32x16_bf16 v[176:191], a[200:203], a[48:51], v[176:191]
    ds_read_b64_tr_b16 a[224:225], v31 offset:55296
    ds_read_b64_tr_b16 a[226:227], v31 offset:56320
    v_mov_b32 v15, 0xffff0000
    v_mfma_f32_32x32x16_bf16 v[192:207], a[204:207], a[48:51], v[192:207]
    buffer_load_dwordx4 v51, s[20:23], s0 offen offset:3072 lds
    ds_read_b64_tr_b16 a[228:229], v32 offset:55296
    ds_read_b64_tr_b16 a[230:231], v32 offset:56320
    v_cndmask_b32 v14, v14, v15, s[70:71]
    s_waitcnt vmcnt(14) lgkmcnt(8)
    v_mfma_f32_32x32x16_bf16 v[176:191], a[208:211], a[52:55], v[176:191]
    ds_read_b64_tr_b16 a[200:201], v33 offset:0
    ds_read_b64_tr_b16 a[202:203], v33 offset:1024
    v_cndmask_b32 v98, v14, 0, s[72:73]
    v_mfma_f32_32x32x16_bf16 v[192:207], a[212:215], a[52:55], v[192:207]
    s_add_u32 s1, s1, 8192
    s_and_b32 s1, s1, 0xffff
    buffer_load_dwordx4 a[80:83], v71, s[28:31], s1 offen offset:0 sc1
    ds_read_b64_tr_b16 a[204:205], v34 offset:0
    ds_read_b64_tr_b16 a[206:207], v34 offset:1024
    v_cndmask_b32 v100, 0, v14, s[72:73]
    s_waitcnt vmcnt(14) lgkmcnt(8)
    v_mfma_f32_32x32x16_bf16 v[176:191], a[216:219], a[56:59], v[176:191]
    buffer_load_dwordx4 a[84:87], v71, s[28:31], s1 offen offset:1024 sc1
    ds_read_b64_tr_b16 a[208:209], v33 offset:2048
    ds_read_b64_tr_b16 a[210:211], v33 offset:3072
    v_cndmask_b32 v99, v14, 0, s[74:75]
    v_mfma_f32_32x32x16_bf16 v[192:207], a[220:223], a[56:59], v[192:207]
    ds_read_b64_tr_b16 a[212:213], v34 offset:2048
    ds_read_b64_tr_b16 a[214:215], v34 offset:3072
    v_cndmask_b32 v101, 0, v14, s[74:75]
    s_waitcnt vmcnt(14) lgkmcnt(8)
    v_mfma_f32_32x32x16_bf16 v[176:191], a[224:227], a[60:63], v[176:191]
    buffer_load_dwordx4 a[88:91], v71, s[28:31], s1 offen offset:2048 sc1
    ds_read_b64_tr_b16 a[216:217], v33 offset:4096
    ds_read_b64_tr_b16 a[218:219], v33 offset:5120
    v_mov_b32 v77, 0xf149f2ca
    v_mfma_f32_32x32x16_bf16 v[192:207], a[228:231], a[60:63], v[192:207]
    buffer_load_dwordx4 a[92:95], v71, s[28:31], s1 offen offset:3072 sc1
    ds_read_b64_tr_b16 a[220:221], v34 offset:4096
    ds_read_b64_tr_b16 a[222:223], v34 offset:5120
    s_mov_b32 s83, 0x3e8b97f6
    s_waitcnt vmcnt(11) lgkmcnt(8)
    v_mfma_f32_32x32x16_bf16 v[176:191], a[200:203], a[64:67], v[176:191]
    ds_read_b64_tr_b16 a[224:225], v33 offset:6144
    ds_read_b64_tr_b16 a[226:227], v33 offset:7168
    s_mov_b32 s78, 0xbdd2d3e8
    s_mov_b32 s79, 0xbdd2d3e8
    v_mfma_f32_32x32x16_bf16 v[192:207], a[204:207], a[64:67], v[192:207]
    s_add_u32 s1, s1, 8192
    s_and_b32 s1, s1, 0xffff
    buffer_load_dwordx4 a[96:99], v71, s[28:31], s1 offen offset:0 sc1
    ds_read_b64_tr_b16 a[228:229], v34 offset:6144
    ds_read_b64_tr_b16 a[230:231], v34 offset:7168
    s_mov_b32 s80, 1.0
    s_mov_b32 s81, 1.0
    s_waitcnt vmcnt(11) lgkmcnt(8)
    v_mfma_f32_32x32x16_bf16 v[176:191], a[208:211], a[68:71], v[176:191]
    buffer_load_dwordx4 a[100:103], v71, s[28:31], s1 offen offset:1024 sc1
    s_barrier
    s_load_dword s14, s[44:45], s15
    ds_read_b64_tr_b16 a[200:201], v33 offset:16384
    ds_read_b64_tr_b16 a[202:203], v33 offset:17408
    v_mov_b32 v102, 0xc0135761
    v_mfma_f32_32x32x16_bf16 v[192:207], a[212:215], a[68:71], v[192:207]
    ds_read_b64_tr_b16 a[204:205], v34 offset:16384
    ds_read_b64_tr_b16 a[206:207], v34 offset:17408
    v_mov_b32 v103, 0xc0135761
    buffer_load_dwordx4 a[104:107], v71, s[28:31], s1 offen offset:2048 sc1
    s_waitcnt vmcnt(12) lgkmcnt(8)
    v_mfma_f32_32x32x16_bf16 v[176:191], a[216:219], a[72:75], v[176:191]
    ds_read_b64_tr_b16 a[208:209], v33 offset:18432
    ds_read_b64_tr_b16 a[210:211], v33 offset:19456
    v_lshlrev_b32 v14, 2, v9
    v_mfma_f32_32x32x16_bf16 v[192:207], a[220:223], a[72:75], v[192:207]
    buffer_load_dwordx4 a[108:111], v71, s[28:31], s1 offen offset:3072 sc1
    ds_read_b64_tr_b16 a[212:213], v34 offset:18432
    ds_read_b64_tr_b16 a[214:215], v34 offset:19456
    v_sub_u32 v14, v10, v14
    s_waitcnt vmcnt(12) lgkmcnt(8)
    v_mfma_f32_32x32x16_bf16 v[176:191], a[224:227], a[76:79], v[176:191]
    ds_read_b64_tr_b16 a[216:217], v33 offset:20480
    ds_read_b64_tr_b16 a[218:219], v33 offset:21504
    v_ashrrev_i32 v14, 1, v14
    v_mfma_f32_32x32x16_bf16 v[192:207], a[228:231], a[76:79], v[192:207]
    s_add_u32 s1, s1, 8192
    s_and_b32 s1, s1, 0xffff
    buffer_load_dwordx4 a[112:115], v71, s[28:31], s1 offen offset:0 sc1
    ds_read_b64_tr_b16 a[220:221], v34 offset:20480
    ds_read_b64_tr_b16 a[222:223], v34 offset:21504
    v_mov_b32 v15, 0x3f80
    s_waitcnt vmcnt(8) lgkmcnt(8)
    v_mfma_f32_32x32x16_bf16 v[176:191], a[200:203], a[80:83], v[176:191]
    buffer_load_dwordx4 a[116:119], v71, s[28:31], s1 offen offset:1024 sc1
    ds_read_b64_tr_b16 a[224:225], v33 offset:22528
    ds_read_b64_tr_b16 a[226:227], v33 offset:23552
    v_cndmask_b32 v15, v15, 1.0, s[70:71]
    v_mfma_f32_32x32x16_bf16 v[192:207], a[204:207], a[80:83], v[192:207]
    ds_read_b64_tr_b16 a[228:229], v34 offset:22528
    ds_read_b64_tr_b16 a[230:231], v34 offset:23552
    v_cmp_eq_i32 vcc, 0, v14
    s_waitcnt vmcnt(8) lgkmcnt(8)
    v_mfma_f32_32x32x16_bf16 v[176:191], a[208:211], a[84:87], v[176:191]
    buffer_load_dwordx4 a[120:123], v71, s[28:31], s1 offen offset:2048 sc1
    ds_read_b64_tr_b16 a[200:201], v33 offset:32768
    ds_read_b64_tr_b16 a[202:203], v33 offset:33792
    v_cndmask_b32 v16, 0, v15, vcc
    v_accvgpr_write_b32 a248, v16
    v_mfma_f32_32x32x16_bf16 v[192:207], a[212:215], a[84:87], v[192:207]
    buffer_load_dwordx4 a[124:127], v71, s[28:31], s1 offen offset:3072 sc1
    ds_read_b64_tr_b16 a[204:205], v34 offset:32768
    ds_read_b64_tr_b16 a[206:207], v34 offset:33792
    v_cmp_eq_i32 vcc, 1, v14
    s_waitcnt vmcnt(9) lgkmcnt(8)
    v_mfma_f32_32x32x16_bf16 v[176:191], a[216:219], a[88:91], v[176:191]
    ds_read_b64_tr_b16 a[208:209], v33 offset:34816
    ds_read_b64_tr_b16 a[210:211], v33 offset:35840
    v_cndmask_b32 v16, 0, v15, vcc
    v_accvgpr_write_b32 a249, v16
    v_mfma_f32_32x32x16_bf16 v[192:207], a[220:223], a[88:91], v[192:207]
    s_add_u32 m0, s58, 0
    s_add_u32 s0, s0, 458752
    s_cmp_eq_u32 s0, 3670016
    s_cselect_b32 s0, 0, s0
    buffer_load_dwordx4 v48, s[20:23], s0 offen lds
    ds_read_b64_tr_b16 a[212:213], v34 offset:34816
    ds_read_b64_tr_b16 a[214:215], v34 offset:35840
    v_cmp_eq_i32 vcc, 4, v14
    s_waitcnt vmcnt(9) lgkmcnt(8)
    v_mfma_f32_32x32x16_bf16 v[176:191], a[224:227], a[92:95], v[176:191]
    buffer_load_dwordx4 v49, s[20:23], s0 offen offset:1024 lds
    ds_read_b64_tr_b16 a[216:217], v33 offset:36864
    ds_read_b64_tr_b16 a[218:219], v33 offset:37888
    v_cndmask_b32 v16, 0, v15, vcc
    v_accvgpr_write_b32 a250, v16
    v_mfma_f32_32x32x16_bf16 v[192:207], a[228:231], a[92:95], v[192:207]
    buffer_load_dwordx4 v50, s[20:23], s0 offen offset:2048 lds
    ds_read_b64_tr_b16 a[220:221], v34 offset:36864
    ds_read_b64_tr_b16 a[222:223], v34 offset:37888
    v_cmp_eq_i32 vcc, 5, v14
    s_waitcnt vmcnt(10) lgkmcnt(8)
    v_mfma_f32_32x32x16_bf16 v[176:191], a[200:203], a[96:99], v[176:191]
    ds_read_b64_tr_b16 a[224:225], v33 offset:38912
    ds_read_b64_tr_b16 a[226:227], v33 offset:39936
    v_cndmask_b32 v16, 0, v15, vcc
    v_accvgpr_write_b32 a251, v16
    v_mfma_f32_32x32x16_bf16 v[192:207], a[204:207], a[96:99], v[192:207]
    buffer_load_dwordx4 v51, s[20:23], s0 offen offset:3072 lds
    ds_read_b64_tr_b16 a[228:229], v34 offset:38912
    ds_read_b64_tr_b16 a[230:231], v34 offset:39936
    v_cmp_eq_i32 vcc, 8, v14
    s_waitcnt vmcnt(10) lgkmcnt(8)
    v_mfma_f32_32x32x16_bf16 v[176:191], a[208:211], a[100:103], v[176:191]
    s_add_u32 m0, s58, 16384
    s_add_u32 s0, s0, 458752
    s_cmp_eq_u32 s0, 3670016
    s_cselect_b32 s0, 0, s0
    buffer_load_dwordx4 v48, s[20:23], s0 offen lds
    s_barrier
    ds_read_b64_tr_b16 a[200:201], v33 offset:49152
    ds_read_b64_tr_b16 a[202:203], v33 offset:50176
    v_cndmask_b32 v16, 0, v15, vcc
    v_accvgpr_write_b32 a252, v16
    v_mfma_f32_32x32x16_bf16 v[192:207], a[212:215], a[100:103], v[192:207]
    buffer_load_dwordx4 v49, s[20:23], s0 offen offset:1024 lds
    ds_read_b64_tr_b16 a[204:205], v34 offset:49152
    ds_read_b64_tr_b16 a[206:207], v34 offset:50176
    v_cmp_eq_i32 vcc, 9, v14
    s_waitcnt vmcnt(11) lgkmcnt(8)
    v_mfma_f32_32x32x16_bf16 v[176:191], a[216:219], a[104:107], v[176:191]
    ds_read_b64_tr_b16 a[208:209], v33 offset:51200
    ds_read_b64_tr_b16 a[210:211], v33 offset:52224
    v_cndmask_b32 v16, 0, v15, vcc
    v_accvgpr_write_b32 a253, v16
    v_mfma_f32_32x32x16_bf16 v[192:207], a[220:223], a[104:107], v[192:207]
    buffer_load_dwordx4 v50, s[20:23], s0 offen offset:2048 lds
    ds_read_b64_tr_b16 a[212:213], v34 offset:51200
    ds_read_b64_tr_b16 a[214:215], v34 offset:52224
    v_cmp_eq_i32 vcc, 12, v14
    s_waitcnt vmcnt(11) lgkmcnt(8)
    v_mfma_f32_32x32x16_bf16 v[176:191], a[224:227], a[108:111], v[176:191]
    buffer_load_dwordx4 v51, s[20:23], s0 offen offset:3072 lds
    ds_read_b64_tr_b16 a[216:217], v33 offset:53248
    ds_read_b64_tr_b16 a[218:219], v33 offset:54272
    v_cndmask_b32 v16, 0, v15, vcc
    v_accvgpr_write_b32 a254, v16
    v_mfma_f32_32x32x16_bf16 v[192:207], a[228:231], a[108:111], v[192:207]
    ds_read_b64_tr_b16 a[220:221], v34 offset:53248
    ds_read_b64_tr_b16 a[222:223], v34 offset:54272
    v_cmp_eq_i32 vcc, 13, v14
    s_waitcnt vmcnt(11) lgkmcnt(8)
    v_mfma_f32_32x32x16_bf16 v[176:191], a[200:203], a[112:115], v[176:191]
    s_add_u32 m0, s58, 32768
    s_add_u32 s0, s0, 458752
    s_cmp_eq_u32 s0, 3670016
    s_cselect_b32 s0, 0, s0
    buffer_load_dwordx4 v48, s[20:23], s0 offen lds
    v_cndmask_b32 v16, 0, v15, vcc
    v_accvgpr_write_b32 a255, v16
    v_mfma_f32_32x32x16_bf16 v[192:207], a[204:207], a[112:115], v[192:207]
    buffer_load_dwordx4 v49, s[20:23], s0 offen offset:1024 lds
    s_waitcnt vmcnt(12) lgkmcnt(4)
    v_mfma_f32_32x32x16_bf16 v[176:191], a[208:211], a[116:119], v[176:191]
    s_waitcnt lgkmcnt(0)
    s_cmp_ge_u32 s14, 14
    s_cbranch_scc1 L_pollok1
    s_mov_b32 s60, 0
L_poll1:
    s_sleep 8
    buffer_load_dword v18, off, s[44:47], s15 sc1
    s_add_u32 s60, s60, 1
    s_waitcnt vmcnt(0)
    v_readfirstlane_b32 s14, v18
    s_nop 0
    s_cmp_ge_u32 s14, 14
    s_cbranch_scc1 L_pollok1
    s_cmp_lt_u32 s60, 20000
    s_cbranch_scc1 L_poll1
L_pollok1:
    ds_read_b64_tr_b16 a[224:225], v33 offset:55296
    buffer_load_dwordx4 v50, s[20:23], s0 offen offset:2048 lds
    ds_read_b64_tr_b16 a[226:227], v33 offset:56320
    ds_read_b64_tr_b16 a[228:229], v34 offset:55296
    ds_read_b64_tr_b16 a[230:231], v34 offset:56320
    v_mfma_f32_32x32x16_bf16 v[192:207], a[212:215], a[116:119], v[192:207]
    ds_read_b64_tr_b16 a[200:201], v35 offset:0
    ds_read_b64_tr_b16 a[202:203], v35 offset:1024
    ds_read_b64_tr_b16 a[204:205], v36 offset:0
    ds_read_b64_tr_b16 a[206:207], v36 offset:1024
    s_waitcnt vmcnt(12)
    v_mfma_f32_32x32x16_bf16 v[176:191], a[216:219], a[120:123], v[176:191]
    buffer_load_dwordx4 v51, s[20:23], s0 offen offset:3072 lds
    ds_read_b64_tr_b16 a[208:209], v35 offset:2048
    ds_read_b64_tr_b16 a[210:211], v35 offset:3072
    v_mfma_f32_32x32x16_bf16 v[192:207], a[220:223], a[120:123], v[192:207]
    ds_read_b64_tr_b16 a[212:213], v36 offset:2048
    ds_read_b64_tr_b16 a[214:215], v36 offset:3072
    s_waitcnt vmcnt(12) lgkmcnt(8)
    v_mfma_f32_32x32x16_bf16 v[176:191], a[224:227], a[124:127], v[176:191]
    s_add_u32 m0, s58, 49152
    s_add_u32 s0, s0, 458752
    s_cmp_eq_u32 s0, 3670016
    s_cselect_b32 s0, 0, s0
    buffer_load_dwordx4 v48, s[20:23], s0 offen lds
    ds_read_b64_tr_b16 a[216:217], v35 offset:4096
    ds_read_b64_tr_b16 a[218:219], v35 offset:5120
    v_mfma_f32_32x32x16_bf16 v[192:207], a[228:231], a[124:127], v[192:207]
    buffer_load_dwordx4 v49, s[20:23], s0 offen offset:1024 lds
    ds_read_b64_tr_b16 a[220:221], v36 offset:4096
    ds_read_b64_tr_b16 a[222:223], v36 offset:5120
    s_waitcnt lgkmcnt(8)
    v_mfma_f32_32x32x16_bf16 v[144:159], a[200:203], a[0:3], v[144:159]
    ds_read_b64_tr_b16 a[224:225], v35 offset:6144
    ds_read_b64_tr_b16 a[226:227], v35 offset:7168
    v_mfma_f32_32x32x16_bf16 v[160:175], a[204:207], a[0:3], 0
    buffer_load_dwordx4 v50, s[20:23], s0 offen offset:2048 lds
    ds_read_b64_tr_b16 a[228:229], v36 offset:6144
    ds_read_b64_tr_b16 a[230:231], v36 offset:7168
    v_cvt_pk_bf16_f32 v176, v176, v177
    v_cvt_pk_bf16_f32 v177, v178, v179
    v_cvt_pk_bf16_f32 v178, v180, v181
    v_cvt_pk_bf16_f32 v179, v182, v183
    buffer_store_dwordx4 v[176:179], v23, s[28:31], 0 offen offset:0 sc1
    s_waitcnt lgkmcnt(8)
    v_mfma_f32_32x32x16_bf16 v[144:159], a[208:211], a[4:7], v[144:159]
    buffer_load_dwordx4 v51, s[20:23], s0 offen offset:3072 lds
    s_waitcnt vmcnt(9)
    s_barrier
    ds_read_b64_tr_b16 a[200:201], v35 offset:16384
    ds_read_b64_tr_b16 a[202:203], v35 offset:17408
    v_cvt_pk_bf16_f32 v184, v184, v185
    v_cvt_pk_bf16_f32 v185, v186, v187
    v_cvt_pk_bf16_f32 v186, v188, v189
    v_cvt_pk_bf16_f32 v187, v190, v191
    buffer_store_dwordx4 v[184:187], v23, s[28:31], 0 offen offset:1024 sc1
    v_mfma_f32_32x32x16_bf16 v[160:175], a[212:215], a[4:7], v[160:175]
    s_add_u32 m0, s58, 65536
    s_add_u32 s0, s0, 458752
    s_cmp_eq_u32 s0, 3670016
    s_cselect_b32 s0, 0, s0
    buffer_load_dwordx4 v48, s[20:23], s0 offen lds
    ds_read_b64_tr_b16 a[204:205], v36 offset:16384
    ds_read_b64_tr_b16 a[206:207], v36 offset:17408
    v_cvt_pk_bf16_f32 v192, v192, v193
    v_cvt_pk_bf16_f32 v193, v194, v195
    v_cvt_pk_bf16_f32 v194, v196, v197
    v_cvt_pk_bf16_f32 v195, v198, v199
    buffer_store_dwordx4 v[192:195], v23, s[28:31], 0 offen offset:2048 sc1
    s_waitcnt lgkmcnt(8)
    v_mfma_f32_32x32x16_bf16 v[144:159], a[216:219], a[8:11], v[144:159]
    buffer_load_dwordx4 v49, s[20:23], s0 offen offset:1024 lds
    ds_read_b64_tr_b16 a[208:209], v35 offset:18432
    ds_read_b64_tr_b16 a[210:211], v35 offset:19456
    v_cvt_pk_bf16_f32 v200, v200, v201
    v_cvt_pk_bf16_f32 v201, v202, v203
    v_cvt_pk_bf16_f32 v202, v204, v205
    v_cvt_pk_bf16_f32 v203, v206, v207
    buffer_store_dwordx4 v[200:203], v23, s[28:31], 0 offen offset:3072 sc1
    v_mfma_f32_32x32x16_bf16 v[160:175], a[220:223], a[8:11], v[160:175]
    buffer_load_dwordx4 v50, s[20:23], s0 offen offset:2048 lds
    ds_read_b64_tr_b16 a[212:213], v36 offset:18432
    ds_read_b64_tr_b16 a[214:215], v36 offset:19456
    s_waitcnt lgkmcnt(8)
    v_mfma_f32_32x32x16_bf16 v[144:159], a[224:227], a[12:15], v[144:159]
    buffer_load_dwordx4 v51, s[20:23], s0 offen offset:3072 lds
    ds_read_b64_tr_b16 a[216:217], v35 offset:20480
    ds_read_b64_tr_b16 a[218:219], v35 offset:21504
    v_mfma_f32_32x32x16_bf16 v[160:175], a[228:231], a[12:15], v[160:175]
    ds_read_b64_tr_b16 a[220:221], v36 offset:20480
    ds_read_b64_tr_b16 a[222:223], v36 offset:21504
    s_waitcnt lgkmcnt(8)
    v_mfma_f32_32x32x16_bf16 v[144:159], a[200:203], a[16:19], v[144:159]
    s_add_u32 m0, s58, 81920
    s_add_u32 s0, s0, 458752
    s_cmp_eq_u32 s0, 3670016
    s_cselect_b32 s0, 0, s0
    buffer_load_dwordx4 v48, s[20:23], s0 offen lds
    ds_read_b64_tr_b16 a[224:225], v35 offset:22528
    ds_read_b64_tr_b16 a[226:227], v35 offset:23552
    v_mfma_f32_32x32x16_bf16 v[160:175], a[204:207], a[16:19], v[160:175]
    buffer_load_dwordx4 v49, s[20:23], s0 offen offset:1024 lds
    ds_read_b64_tr_b16 a[228:229], v36 offset:22528
    ds_read_b64_tr_b16 a[230:231], v36 offset:23552
    s_waitcnt lgkmcnt(8)
    v_mfma_f32_32x32x16_bf16 v[144:159], a[208:211], a[20:23], v[144:159]
    ds_read_b64_tr_b16 a[200:201], v31 offset:0
    ds_read_b64_tr_b16 a[202:203], v31 offset:1024
    v_mfma_f32_32x32x16_bf16 v[160:175], a[212:215], a[20:23], v[160:175]
    buffer_load_dwordx4 v50, s[20:23], s0 offen offset:2048 lds
    ds_read_b64_tr_b16 a[204:205], v32 offset:0
    ds_read_b64_tr_b16 a[206:207], v32 offset:1024
    s_waitcnt lgkmcnt(8)
    v_mfma_f32_32x32x16_bf16 v[144:159], a[216:219], a[24:27], v[144:159]
    ds_read_b64_tr_b16 a[208:209], v31 offset:2048
    ds_read_b64_tr_b16 a[210:211], v31 offset:3072
    v_mfma_f32_32x32x16_bf16 v[160:175], a[220:223], a[24:27], v[160:175]
    buffer_load_dwordx4 v51, s[20:23], s0 offen offset:3072 lds
    ds_read_b64_tr_b16 a[212:213], v32 offset:2048
    ds_read_b64_tr_b16 a[214:215], v32 offset:3072
    s_waitcnt lgkmcnt(8)
    v_mfma_f32_32x32x16_bf16 v[144:159], a[224:227], a[28:31], v[144:159]
    s_add_u32 m0, s59, 98304
    s_nop 0
    buffer_load_dwordx4 v73, s[28:31], s63 offen sc1 lds
    ds_read_b64_tr_b16 a[216:217], v31 offset:4096
    ds_read_b64_tr_b16 a[218:219], v31 offset:5120
    v_mfma_f32_32x32x16_bf16 v[160:175], a[228:231], a[28:31], v[160:175]
    ds_read_b64_tr_b16 a[220:221], v32 offset:4096
    ds_read_b64_tr_b16 a[222:223], v32 offset:5120
    s_waitcnt lgkmcnt(8)
    v_mfma_f32_32x32x16_bf16 v[144:159], a[200:203], a[32:35], v[144:159]
    buffer_load_dwordx4 v73, s[28:31], s63 offen offset:1024 sc1 lds
    ds_read_b64_tr_b16 a[224:225], v31 offset:6144
    ds_read_b64_tr_b16 a[226:227], v31 offset:7168
    v_mfma_f32_32x32x16_bf16 v[160:175], a[204:207], a[32:35], v[160:175]
    ds_read_b64_tr_b16 a[228:229], v32 offset:6144
    ds_read_b64_tr_b16 a[230:231], v32 offset:7168
    s_waitcnt lgkmcnt(8)
    v_mfma_f32_32x32x16_bf16 v[144:159], a[208:211], a[36:39], v[144:159]
    buffer_load_dwordx4 v73, s[28:31], s63 offen offset:2048 sc1 lds
    s_waitcnt vmcnt(14)
    s_barrier
    s_waitcnt vmcnt(9)
    s_atomic_add s36, s[28:29], s37
    ds_read_b64_tr_b16 a[200:201], v31 offset:16384
    ds_read_b64_tr_b16 a[202:203], v31 offset:17408
    v_mfma_f32_32x32x16_bf16 v[160:175], a[212:215], a[36:39], v[160:175]
    s_add_u32 m0, s100, 126976
    s_nop 0
    buffer_load_dwordx4 v62, s[28:31], s62 offen sc1 lds
    ds_read_b64_tr_b16 a[204:205], v32 offset:16384
    ds_read_b64_tr_b16 a[206:207], v32 offset:17408
    s_waitcnt lgkmcnt(8)
    v_mfma_f32_32x32x16_bf16 v[144:159], a[216:219], a[40:43], v[144:159]
    ds_read_b64_tr_b16 a[208:209], v31 offset:18432
    ds_read_b64_tr_b16 a[210:211], v31 offset:19456
    v_mfma_f32_32x32x16_bf16 v[160:175], a[220:223], a[40:43], v[160:175]
    s_add_u32 m0, s58, 110592
    s_nop 0
    buffer_load_dwordx4 v60, s[28:31], s62 offen sc1 lds
    ds_read_b64_tr_b16 a[212:213], v32 offset:18432
    ds_read_b64_tr_b16 a[214:215], v32 offset:19456
    s_waitcnt lgkmcnt(8)
    v_mfma_f32_32x32x16_bf16 v[144:159], a[224:227], a[44:47], v[144:159]
    ds_read_b64_tr_b16 a[216:217], v31 offset:20480
    ds_read_b64_tr_b16 a[218:219], v31 offset:21504
    v_mfma_f32_32x32x16_bf16 v[160:175], a[228:231], a[44:47], v[160:175]
    buffer_load_dwordx4 v60, s[28:31], s62 offen offset:1024 sc1 lds
    ds_read_b64_tr_b16 a[220:221], v32 offset:20480
    ds_read_b64_tr_b16 a[222:223], v32 offset:21504
    s_waitcnt lgkmcnt(8)
    v_mfma_f32_32x32x16_bf16 v[144:159], a[200:203], a[48:51], v[144:159]
    ds_read_b64_tr_b16 a[224:225], v31 offset:22528
    ds_read_b64_tr_b16 a[226:227], v31 offset:23552
    v_mfma_f32_32x32x16_bf16 v[160:175], a[204:207], a[48:51], v[160:175]
    buffer_load_dwordx4 v61, s[28:31], s62 offen offset:2048 sc1 lds
    ds_read_b64_tr_b16 a[228:229], v32 offset:22528
    ds_read_b64_tr_b16 a[230:231], v32 offset:23552
    s_waitcnt lgkmcnt(8)
    v_mfma_f32_32x32x16_bf16 v[144:159], a[208:211], a[52:55], v[144:159]
    buffer_load_dwordx4 v61, s[28:31], s62 offen offset:3072 sc1 lds
    ds_read_b64_tr_b16 a[200:201], v31 offset:32768
    ds_read_b64_tr_b16 a[202:203], v31 offset:33792
    v_mfma_f32_32x32x16_bf16 v[160:175], a[212:215], a[52:55], v[160:175]
    ds_read_b64_tr_b16 a[204:205], v32 offset:32768
    ds_read_b64_tr_b16 a[206:207], v32 offset:33792
    s_waitcnt lgkmcnt(8)
    v_mfma_f32_32x32x16_bf16 v[144:159], a[216:219], a[56:59], v[144:159]
    s_add_u32 m0, s59, 131072
    s_add_u32 s63, s63, 12288
    s_cmp_eq_u32 s63, 86016
    s_cselect_b32 s63, 0, s63
    buffer_load_dwordx4 v73, s[28:31], s63 offen sc1 lds
    ds_read_b64_tr_b16 a[208:209], v31 offset:34816
    ds_read_b64_tr_b16 a[210:211], v31 offset:35840
    v_mfma_f32_32x32x16_bf16 v[160:175], a[220:223], a[56:59], v[160:175]
    ds_read_b64_tr_b16 a[212:213], v32 offset:34816
    ds_read_b64_tr_b16 a[214:215], v32 offset:35840
    s_waitcnt lgkmcnt(8)
    v_mfma_f32_32x32x16_bf16 v[144:159], a[224:227], a[60:63], v[144:159]
    buffer_load_dwordx4 v73, s[28:31], s63 offen offset:1024 sc1 lds
    ds_read_b64_tr_b16 a[216:217], v31 offset:36864
    ds_read_b64_tr_b16 a[218:219], v31 offset:37888
    v_mfma_f32_32x32x16_bf16 v[160:175], a[228:231], a[60:63], v[160:175]
    ds_read_b64_tr_b16 a[220:221], v32 offset:36864
    ds_read_b64_tr_b16 a[222:223], v32 offset:37888
    s_waitcnt lgkmcnt(8)
    v_mfma_f32_32x32x16_bf16 v[144:159], a[200:203], a[64:67], v[144:159]
    buffer_load_dwordx4 v73, s[28:31], s63 offen offset:2048 sc1 lds
    ds_read_b64_tr_b16 a[224:225], v31 offset:38912
    ds_read_b64_tr_b16 a[226:227], v31 offset:39936
    v_mfma_f32_32x32x16_bf16 v[160:175], a[204:207], a[64:67], v[160:175]
    s_add_u32 m0, s100, 159744
    s_add_u32 s62, s62, 262144
    s_cmp_eq_u32 s62, 1835008
    s_cselect_b32 s62, 0, s62
    buffer_load_dwordx4 v62, s[28:31], s62 offen sc1 lds
    ds_read_b64_tr_b16 a[228:229], v32 offset:38912
    ds_read_b64_tr_b16 a[230:231], v32 offset:39936
    s_waitcnt lgkmcnt(8)
    v_mfma_f32_32x32x16_bf16 v[144:159], a[208:211], a[68:71], v[144:159]
    s_waitcnt vmcnt(12)
    s_barrier
    s_xor_b32 s37, s37, 1024
    s_load_dword s14, s[28:29], s37
    ds_read_b64_tr_b16 a[200:201], v31 offset:49152
    ds_read_b64_tr_b16 a[202:203], v31 offset:50176
    v_mfma_f32_32x32x16_bf16 v[160:175], a[212:215], a[68:71], v[160:175]
    s_add_u32 m0, s58, 143360
    s_nop 0
    buffer_load_dwordx4 v60, s[28:31], s62 offen sc1 lds
    ds_read_b64_tr_b16 a[204:205], v32 offset:49152
    ds_read_b64_tr_b16 a[206:207], v32 offset:50176
    s_waitcnt lgkmcnt(8)
    v_mfma_f32_32x32x16_bf16 v[144:159], a[216:219], a[72:75], v[144:159]
    buffer_load_dwordx4 v60, s[28:31], s62 offen offset:1024 sc1 lds
    ds_read_b64_tr_b16 a[208:209], v31 offset:51200
    ds_read_b64_tr_b16 a[210:211], v31 offset:52224
    v_mfma_f32_32x32x16_bf16 v[160:175], a[220:223], a[72:75], v[160:175]
    ds_read_b64_tr_b16 a[212:213], v32 offset:51200
    ds_read_b64_tr_b16 a[214:215], v32 offset:52224
    s_waitcnt lgkmcnt(8)
    v_mfma_f32_32x32x16_bf16 v[144:159], a[224:227], a[76:79], v[144:159]
    buffer_load_dwordx4 v61, s[28:31], s62 offen offset:2048 sc1 lds
    ds_read_b64_tr_b16 a[216:217], v31 offset:53248
    ds_read_b64_tr_b16 a[218:219], v31 offset:54272
    v_mfma_f32_32x32x16_bf16 v[160:175], a[228:231], a[76:79], v[160:175]
    ds_read_b64_tr_b16 a[220:221], v32 offset:53248
    ds_read_b64_tr_b16 a[222:223], v32 offset:54272
    s_waitcnt lgkmcnt(8)
    v_mfma_f32_32x32x16_bf16 v[144:159], a[200:203], a[80:83], v[144:159]
    buffer_load_dwordx4 v61, s[28:31], s62 offen offset:3072 sc1 lds
    ds_read_b64_tr_b16 a[224:225], v31 offset:55296
    ds_read_b64_tr_b16 a[226:227], v31 offset:56320
    v_mfma_f32_32x32x16_bf16 v[160:175], a[204:207], a[80:83], v[160:175]
    ds_read_b64_tr_b16 a[228:229], v32 offset:55296
    ds_read_b64_tr_b16 a[230:231], v32 offset:56320
    s_waitcnt lgkmcnt(8)
    v_mfma_f32_32x32x16_bf16 v[144:159], a[208:211], a[84:87], v[144:159]
    s_add_u32 m0, s59, 0
    s_add_u32 s63, s63, 12288
    s_cmp_eq_u32 s63, 86016
    s_cselect_b32 s63, 0, s63
    buffer_load_dwordx4 v73, s[28:31], s63 offen sc1 lds
    s_barrier
    ds_read_b64_tr_b16 a[200:201], v34 offset:0
    ds_read_b64_tr_b16 a[202:203], v34 offset:1024
    v_mfma_f32_32x32x16_bf16 v[160:175], a[212:215], a[84:87], v[160:175]
    buffer_load_dwordx4 v73, s[28:31], s63 offen offset:1024 sc1 lds
    ds_read_b64_tr_b16 a[204:205], v34 offset:2048
    ds_read_b64_tr_b16 a[206:207], v34 offset:3072
    s_waitcnt lgkmcnt(8)
    v_mfma_f32_32x32x16_bf16 v[144:159], a[216:219], a[88:91], v[144:159]
    ds_read_b64_tr_b16 a[208:209], v34 offset:4096
    ds_read_b64_tr_b16 a[210:211], v34 offset:5120
    v_mfma_f32_32x32x16_bf16 v[160:175], a[220:223], a[88:91], v[160:175]
    buffer_load_dwordx4 v73, s[28:31], s63 offen offset:2048 sc1 lds
    ds_read_b64_tr_b16 a[212:213], v34 offset:6144
    ds_read_b64_tr_b16 a[214:215], v34 offset:7168
    s_waitcnt lgkmcnt(8)
    v_mfma_f32_32x32x16_bf16 v[144:159], a[224:227], a[92:95], v[144:159]
    v_mfma_f32_32x32x16_bf16 v[160:175], a[228:231], a[92:95], v[160:175]
    s_add_u32 m0, s100, 28672
    s_add_u32 s62, s62, 262144
    s_cmp_eq_u32 s62, 1835008
    s_cselect_b32 s62, 0, s62
    buffer_load_dwordx4 v62, s[28:31], s62 offen sc1 lds
    s_waitcnt lgkmcnt(4)
    v_mfma_f32_32x32x16_bf16 v[160:175], a[200:203], a[96:99], v[160:175]
    s_waitcnt lgkmcnt(0)
    s_cmp_ge_u32 s14, 2
    s_cbranch_scc1 L_pollok2
    s_mov_b32 s60, 0
L_poll2:
    s_sleep 4
    buffer_load_dword v18, off, s[28:31], s37 sc1
    s_add_u32 s60, s60, 1
    s_waitcnt vmcnt(0)
    v_readfirstlane_b32 s14, v18
    s_nop 0
    s_cmp_ge_u32 s14, 2
    s_cbranch_scc1 L_pollok2
    s_cmp_lt_u32 s60, 20000
    s_cbranch_scc1 L_poll2
L_pollok2:
    v_xor_b32 v23, 131072, v23
    s_add_u32 m0, s58, 12288
    s_nop 0
    buffer_load_dwordx4 v60, s[28:31], s62 offen sc1 lds
    v_xor_b32 v22, 8192, v23
    ds_read_b64_tr_b16 a[216:217], v34 offset:16384
    ds_read_b64_tr_b16 a[218:219], v34 offset:17408
    ds_read_b64_tr_b16 a[220:221], v34 offset:18432
    ds_read_b64_tr_b16 a[222:223], v34 offset:19456
    v_mfma_f32_32x32x16_bf16 v[160:175], a[204:207], a[100:103], v[160:175]
    ds_read_b64_tr_b16 a[224:225], v34 offset:20480
    ds_read_b64_tr_b16 a[226:227], v34 offset:21504
    ds_read_b64_tr_b16 a[228:229], v34 offset:22528
    ds_read_b64_tr_b16 a[230:231], v34 offset:23552
    v_mfma_f32_32x32x16_bf16 v[160:175], a[208:211], a[104:107], v[160:175]
    buffer_load_dwordx4 v[208:211], v23, s[28:31], 0 offen offset:0 sc1
    ds_read_b64_tr_b16 a[200:201], v33 offset:0
    ds_read_b64_tr_b16 a[202:203], v33 offset:1024
    v_mfma_f32_32x32x16_bf16 v[160:175], a[212:215], a[108:111], v[160:175]
    buffer_load_dwordx4 v[212:215], v23, s[28:31], 0 offen offset:1024 sc1
    ds_read_b64_tr_b16 a[204:205], v33 offset:2048
    ds_read_b64_tr_b16 a[206:207], v33 offset:3072
    s_waitcnt lgkmcnt(8)
    v_mfma_f32_32x32x16_bf16 v[160:175], a[216:219], a[112:115], v[160:175]
    buffer_load_dwordx4 v[216:219], v22, s[28:31], 0 offen offset:2048 sc1
    ds_read_b64_tr_b16 a[208:209], v33 offset:4096
    ds_read_b64_tr_b16 a[210:211], v33 offset:5120
    v_mfma_f32_32x32x16_bf16 v[160:175], a[220:223], a[116:119], v[160:175]
    buffer_load_dwordx4 v[220:223], v22, s[28:31], 0 offen offset:3072 sc1
    ds_read_b64_tr_b16 a[212:213], v33 offset:6144
    ds_read_b64_tr_b16 a[214:215], v33 offset:7168
    s_waitcnt lgkmcnt(8)
    v_mfma_f32_32x32x16_bf16 v[160:175], a[224:227], a[120:123], v[160:175]
    buffer_load_dwordx4 v60, s[28:31], s62 offen offset:1024 sc1 lds
    ds_read_b64_tr_b16 a[216:217], v33 offset:16384
    ds_read_b64_tr_b16 a[218:219], v33 offset:17408
    v_mfma_f32_32x32x16_bf16 v[160:175], a[228:231], a[124:127], v[160:175]
    ds_read_b64_tr_b16 a[220:221], v33 offset:18432
    ds_read_b64_tr_b16 a[222:223], v33 offset:19456
    s_waitcnt lgkmcnt(8)
    v_mfma_f32_32x32x16_bf16 v[144:159], a[200:203], a[96:99], v[144:159]
    buffer_load_dwordx4 v61, s[28:31], s62 offen offset:2048 sc1 lds
    ds_read_b64_tr_b16 a[224:225], v33 offset:20480
    ds_read_b64_tr_b16 a[226:227], v33 offset:21504
    v_mfma_f32_32x32x16_bf16 v[144:159], a[204:207], a[100:103], v[144:159]
    buffer_load_dwordx4 v61, s[28:31], s62 offen offset:3072 sc1 lds
    ds_read_b64_tr_b16 a[228:229], v33 offset:22528
    ds_read_b64_tr_b16 a[230:231], v33 offset:23552
    s_waitcnt lgkmcnt(8)
    v_mfma_f32_32x32x16_bf16 v[144:159], a[208:211], a[104:107], v[144:159]
    ds_write_b128 v74, v[160:163] offset:32768
    v_mfma_f32_32x32x16_bf16 v[144:159], a[212:215], a[108:111], v[144:159]
    ds_write_b128 v74, v[164:167] offset:33792
    s_waitcnt lgkmcnt(6)
    v_mfma_f32_32x32x16_bf16 v[144:159], a[216:219], a[112:115], v[144:159]
    ds_write_b128 v74, v[168:171] offset:34816
    v_mfma_f32_32x32x16_bf16 v[144:159], a[220:223], a[116:119], v[144:159]
    ds_write_b128 v74, v[172:175] offset:35840
    s_waitcnt lgkmcnt(4)
    v_mfma_f32_32x32x16_bf16 v[144:159], a[224:227], a[120:123], v[144:159]
    v_mfma_f32_32x32x16_bf16 v[144:159], a[228:231], a[124:127], v[144:159]
    s_waitcnt vmcnt(6)
    v_mfma_f32_32x32x16_bf16 v[144:159], a[248:251], v[208:211], v[144:159]
    s_waitcnt vmcnt(5)
    v_mfma_f32_32x32x16_bf16 v[144:159], a[252:255], v[212:215], v[144:159]
    v_xor_b32 v74, 8192, v74
    s_waitcnt lgkmcnt(0)
    s_barrier
    ds_read_b128 v[176:179], v74 offset:32768
    s_add_u32 m0, s59, 65536
    s_add_u32 s63, s63, 12288
    s_cmp_eq_u32 s63, 86016
    s_cselect_b32 s63, 0, s63
    buffer_load_dwordx4 v73, s[28:31], s63 offen sc1 lds
    ds_read_b128 v[180:183], v74 offset:33792
    ds_read_b128 v[184:187], v74 offset:34816
    ds_read_b128 v[188:191], v74 offset:35840
    s_waitcnt vmcnt(5)
    v_mfma_f32_32x32x16_bf16 v[144:159], a[248:251], v[216:219], v[144:159]
    buffer_load_dwordx4 v73, s[28:31], s63 offen offset:1024 sc1 lds
    s_waitcnt vmcnt(5)
    v_mfma_f32_32x32x16_bf16 v[144:159], a[252:255], v[220:223], v[144:159]
    s_waitcnt lgkmcnt(3)
    s_nop 10
    v_pk_add_f32 v[144:145], v[144:145], v[176:177]
    v_pk_add_f32 v[146:147], v[146:147], v[178:179]
    s_waitcnt lgkmcnt(2)
    v_pk_add_f32 v[148:149], v[148:149], v[180:181]
    v_pk_add_f32 v[150:151], v[150:151], v[182:183]
    v_pk_mul_f32 v[176:177], v[144:145], v[144:145]
    buffer_load_dwordx4 v73, s[28:31], s63 offen offset:2048 sc1 lds
    v_pk_mul_f32 v[178:179], v[146:147], v[146:147]
    v_pk_mul_f32 v[180:181], v[148:149], v[148:149]
    v_pk_mul_f32 v[182:183], v[150:151], v[150:151]
    v_pk_fma_f32 v[176:177], v[176:177], s[78:79], v[102:103]
    v_pk_fma_f32 v[178:179], v[178:179], s[78:79], v[102:103]
    v_pk_fma_f32 v[180:181], v[180:181], s[78:79], v[102:103]
    v_pk_fma_f32 v[182:183], v[182:183], s[78:79], v[102:103]
    v_pk_mul_f32 v[176:177], v[176:177], v[144:145]
    v_pk_mul_f32 v[178:179], v[178:179], v[146:147]
    v_pk_mul_f32 v[180:181], v[180:181], v[148:149]
    v_pk_mul_f32 v[182:183], v[182:183], v[150:151]
    v_exp_f32 v176, v176
    v_exp_f32 v177, v177
    s_add_u32 m0, s100, 94208
    s_add_u32 s62, s62, 262144
    s_cmp_eq_u32 s62, 1835008
    s_cselect_b32 s62, 0, s62
    buffer_load_dwordx4 v62, s[28:31], s62 offen sc1 lds
    v_exp_f32 v178, v178
    v_exp_f32 v179, v179
    v_exp_f32 v180, v180
    v_exp_f32 v181, v181
    v_exp_f32 v182, v182
    v_exp_f32 v183, v183
    v_pk_add_f32 v[176:177], v[176:177], s[80:81]
    s_add_u32 m0, s58, 77824
    s_nop 0
    buffer_load_dwordx4 v60, s[28:31], s62 offen sc1 lds
    v_pk_add_f32 v[178:179], v[178:179], s[80:81]
    v_pk_add_f32 v[180:181], v[180:181], s[80:81]
    v_pk_add_f32 v[182:183], v[182:183], s[80:81]
    v_rcp_f32 v176, v176
    v_rcp_f32 v177, v177
    v_rcp_f32 v178, v178
    v_rcp_f32 v179, v179
    v_rcp_f32 v180, v180
    v_rcp_f32 v181, v181
    buffer_load_dwordx4 v60, s[28:31], s62 offen offset:1024 sc1 lds
    v_rcp_f32 v182, v182
    v_rcp_f32 v183, v183
    v_pk_mul_f32 v[176:177], v[176:177], v[144:145]
    v_pk_mul_f32 v[178:179], v[178:179], v[146:147]
    v_pk_mul_f32 v[180:181], v[180:181], v[148:149]
    v_pk_mul_f32 v[182:183], v[182:183], v[150:151]
    v_cvt_pk_bf16_f32 v104, v176, v177
    v_cvt_pk_bf16_f32 v105, v178, v179
    v_cvt_pk_bf16_f32 v106, v180, v181
    v_cvt_pk_bf16_f32 v107, v182, v183
    s_waitcnt lgkmcnt(1)
    v_pk_add_f32 v[152:153], v[152:153], v[184:185]
    buffer_load_dwordx4 v61, s[28:31], s62 offen offset:2048 sc1 lds
    v_pk_add_f32 v[154:155], v[154:155], v[186:187]
    s_waitcnt lgkmcnt(0)
    v_pk_add_f32 v[156:157], v[156:157], v[188:189]
    v_pk_add_f32 v[158:159], v[158:159], v[190:191]
    v_pk_mul_f32 v[184:185], v[152:153], v[152:153]
    v_pk_mul_f32 v[186:187], v[154:155], v[154:155]
    v_pk_mul_f32 v[188:189], v[156:157], v[156:157]
    v_pk_mul_f32 v[190:191], v[158:159], v[158:159]
    v_pk_fma_f32 v[184:185], v[184:185], s[78:79], v[102:103]
    v_pk_fma_f32 v[186:187], v[186:187], s[78:79], v[102:103]
    v_pk_fma_f32 v[188:189], v[188:189], s[78:79], v[102:103]
    v_pk_fma_f32 v[190:191], v[190:191], s[78:79], v[102:103]
    v_pk_mul_f32 v[184:185], v[184:185], v[152:153]
    v_pk_mul_f32 v[186:187], v[186:187], v[154:155]
    v_pk_mul_f32 v[188:189], v[188:189], v[156:157]
    buffer_load_dwordx4 v61, s[28:31], s62 offen offset:3072 sc1 lds
    v_pk_mul_f32 v[190:191], v[190:191], v[158:159]
    v_exp_f32 v184, v184
    v_exp_f32 v185, v185
    v_exp_f32 v186, v186
    v_exp_f32 v187, v187
    v_exp_f32 v188, v188
    v_exp_f32 v189, v189
    v_exp_f32 v190, v190
    v_exp_f32 v191, v191
    v_pk_add_f32 v[184:185], v[184:185], s[80:81]
    v_pk_add_f32 v[186:187], v[186:187], s[80:81]
    v_pk_add_f32 v[188:189], v[188:189], s[80:81]
    v_pk_add_f32 v[190:191], v[190:191], s[80:81]
    v_rcp_f32 v184, v184
    v_rcp_f32 v185, v185
    v_rcp_f32 v186, v186
    v_rcp_f32 v187, v187
    v_rcp_f32 v188, v188
    v_rcp_f32 v189, v189
    v_rcp_f32 v190, v190
    v_rcp_f32 v191, v191
    v_pk_mul_f32 v[184:185], v[184:185], v[152:153]
    v_pk_mul_f32 v[186:187], v[186:187], v[154:155]
    v_pk_mul_f32 v[188:189], v[188:189], v[156:157]
    v_pk_mul_f32 v[190:191], v[190:191], v[158:159]
    v_cvt_pk_bf16_f32 v108, v184, v185
    v_cvt_pk_bf16_f32 v109, v186, v187
    v_cvt_pk_bf16_f32 v110, v188, v189
    v_cvt_pk_bf16_f32 v111, v190, v191
    ds_read_b64_tr_b16 a[180:181], v65 offset:32768
    ds_read_b64_tr_b16 a[182:183], v65 offset:33024
    ds_read_b128 a[128:131], v46 offset:32768
    ds_read_b64_tr_b16 a[184:185], v65 offset:33792
    ds_read_b64_tr_b16 a[186:187], v65 offset:34048
    ds_read_b128 a[132:135], v46 offset:33792
    ds_read_b128 a[136:139], v46 offset:34816
    ds_read_b64_tr_b16 a[176:177], v66 offset:32768
    ds_read_b64_tr_b16 a[178:179], v66 offset:33024
    ds_read_b128 a[140:143], v46 offset:35840
    ds_read_b128 a[144:147], v46 offset:36864
    ds_read_b128 a[148:151], v46 offset:37888
    buffer_store_dwordx4 v[104:107], v4, s[28:31], s67 offen offset:0 sc1
    buffer_store_dwordx4 v[108:111], v4, s[28:31], s67 offen offset:1024 sc1
    s_branch L_q
L_nog1:
    s_nop 1
    s_mov_b32 s14, 1204224
    s_mov_b32 s15, 0x20000
    s_sub_u32 s3, s2, 200
    s_cmp_lt_u32 s3, 42
    s_cselect_b32 s81, 0, 268435456
    s_cselect_b32 s3, s3, 0
    s_mul_i32 s79, s3, 43
    s_lshr_b32 s79, s79, 7
    s_mul_i32 s80, s79, 3
    s_sub_u32 s80, s3, s80
    v_min_u32 v14, 55, v1
    s_lshl_b32 s3, s79, 2
    s_add_u32 s3, s3, s48
    s_mul_i32 s3, s3, 21504
    s_mul_i32 s60, s80, 896
    s_add_u32 s3, s3, s60
    s_add_u32 s3, s3, s81
    v_lshl_add_u32 v236, v14, 4, s3
    s_mul_i32 s60, s48, 8448
    s_add_u32 m0, s60, 0
    s_mov_b32 s3, 0
    buffer_load_dwordx4 v236, s[12:15], s3 offen lds
    s_add_u32 m0, s60, 1056
    s_mov_b32 s3, 2688
    buffer_load_dwordx4 v236, s[12:15], s3 offen lds
    s_add_u32 m0, s60, 2112
    s_mov_b32 s3, 5376
    buffer_load_dwordx4 v236, s[12:15], s3 offen lds
    s_add_u32 m0, s60, 3168
    s_mov_b32 s3, 8064
    buffer_load_dwordx4 v236, s[12:15], s3 offen lds
    s_add_u32 m0, s60, 4224
    s_mov_b32 s3, 10752
    buffer_load_dwordx4 v236, s[12:15], s3 offen lds
    s_add_u32 m0, s60, 5280
    s_mov_b32 s3, 13440
    buffer_load_dwordx4 v236, s[12:15], s3 offen lds
    s_add_u32 m0, s60, 6336
    s_mov_b32 s3, 16128
    buffer_load_dwordx4 v236, s[12:15], s3 offen lds
    s_add_u32 m0, s60, 7392
    s_mov_b32 s3, 18816
    buffer_load_dwordx4 v236, s[12:15], s3 offen lds
    s_mul_i32 s53, s101, 37
    s_lshr_b32 s53, s53, 8
    s_mul_i32 s54, s53, 7
    s_sub_u32 s54, s101, s54
    s_and_b32 s53, s53, 3
    s_lshl_b32 s3, s6, 2
    s_add_u32 s53, s53, s3
    s_lshl_b32 s53, s53, 1
    s_add_u32 s53, s53, s7
    s_mov_b32 s42, 4096
    s_mov_b32 s43, 0x20000
    s_lshl_b32 s3, s53, 2
    s_add_u32 s3, s3, s48
    s_lshl_b32 s60, s3, 5
    v_lshl_add_u32 v75, v5, 1, s60
    s_mul_i32 s3, s3, 14336
    s_lshl_b32 s60, s54, 7
    s_add_u32 s3, s3, s60
    v_mul_u32_u24 v15, 896, v5
    v_lshl_add_u32 v15, v6, 4, v15
    v_add_u32 v78, s3, v15
    v_add_u32 v79, 7168, v78
    s_cmp_lt_u32 s101, 28
    s_cselect_b32 s56, 1, 0
    s_lshl_b32 s50, s7, 3
    s_and_b32 s3, s101, 7
    s_add_u32 s50, s50, s3
    s_lshr_b32 s60, s101, 3
    s_lshl_b32 s49, s6, 2
    s_add_u32 s49, s49, s60
    s_lshl_b32 s49, s49, 2
    s_add_u32 s49, s49, s48
    s_mul_i32 s60, s60, 0
    s_add_u32 s3, s3, s60
    s_sub_u32 s60, s3, 7
    s_cmp_ge_u32 s3, 7
    s_cselect_b32 s3, s60, s3
    s_lshl_b32 s62, s3, 18
    s_mul_i32 s63, s3, 12288
    s_mov_b32 s30, 20971520
    s_mov_b32 s31, 0x20000
    s_mov_b32 s75, 0x3727c5ac
    s_mov_b32 s76, 0x3b124925
    s_mov_b32 s77, 0x3f803f80
    v_lshlrev_b32 v4, 4, v1
    v_bfe_u32 v7, v1, 2, 2
    v_and_b32 v8, 3, v1
    v_mul_u32_u24 v14, 960, v9
    v_lshl_add_u32 v14, v10, 4, v14
    s_mul_i32 s3, s48, 1920
    s_add_u32 s3, s3, 147456
    v_add_u32 v224, s3, v14
    v_mul_u32_u24 v14, 960, v7
    v_lshl_add_u32 v14, v3, 5, v14
    v_lshl_add_u32 v14, v8, 3, v14
    s_lshl_b32 s3, s48, 8
    s_add_u32 s3, s3, 147456
    v_add_u32 v225, s3, v14
    s_lshl_b32 s3, s48, 3
    s_add_u32 s3, s3, 155648
    v_lshl_add_u32 v226, v9, 2, s3
    v_lshlrev_b32 v231, 2, v6
    v_and_b32 v2, 15, v1
    v_lshlrev_b32 v232, 14, v3
    v_add_lshl_u32 v232, v232, v2, 2
    v_add_u32 v231, 155648, v231
    v_lshlrev_b32 v14, 17, v9
    v_lshl_add_u32 v227, v10, 4, v14
    s_cmp_eq_u32 s48, 3
    s_cselect_b32 s60, 268435456, 0
    s_lshl_b32 s70, s48, 10
    s_add_u32 s70, s70, s2
    s_lshl_b32 s70, s70, 9
    s_add_u32 s71, s70, 262144
    s_add_u32 s71, s71, s60
    s_xor_b32 s60, s60, 268435456
    s_lshl_b32 s72, s2, 7
    s_add_u32 s72, s72, s60
    s_add_u32 s72, s72, 6291456
    s_lshr_b32 s74, s2, 2
    s_lshl_b32 s74, s74, 5
    s_and_b32 s3, s2, 3
    s_add_u32 s74, s74, s3
    s_lshl_b32 s74, s74, 2
    s_add_u32 s74, s74, 10485760
    v_cmp_gt_u32 vcc, 8, v0
    v_lshlrev_b32 v230, 13, v0
    v_mov_b32 v14, 268435456
    s_and_b32 s3, s2, 7
    s_lshl_b32 s3, s3, 13
    s_add_u32 s3, s3, 10485760
    v_lshrrev_b32 v15, 2, v0
    v_lshl_add_u32 v15, v15, 7, s3
    v_lshl_add_u32 v20, v8, 2, v15
    v_cndmask_b32 v230, v14, v230, vcc
    v_mov_b32 v17, 0
    s_lshl_b32 s3, s48, 14
    s_add_u32 s74, s74, s3
    s_add_u32 s73, s74, 8192
    s_waitcnt vmcnt(10)
    v_dot2_f32_bf16 v220, v176, s77, 0
    v_dot2_f32_bf16 v221, v176, v176, 0
    v_dot2_f32_bf16 v220, v177, s77, v220
    v_dot2_f32_bf16 v221, v177, v177, v221
    v_dot2_f32_bf16 v220, v178, s77, v220
    v_dot2_f32_bf16 v221, v178, v178, v221
    v_dot2_f32_bf16 v220, v179, s77, v220
    v_dot2_f32_bf16 v221, v179, v179, v221
    s_waitcnt vmcnt(9)
    v_dot2_f32_bf16 v220, v180, s77, v220
    v_dot2_f32_bf16 v221, v180, v180, v221
    v_dot2_f32_bf16 v220, v181, s77, v220
    v_dot2_f32_bf16 v221, v181, v181, v221
    v_dot2_f32_bf16 v220, v182, s77, v220
    v_dot2_f32_bf16 v221, v182, v182, v221
    v_dot2_f32_bf16 v220, v183, s77, v220
    v_dot2_f32_bf16 v221, v183, v183, v221
    buffer_load_dword v12, v17, s[44:47], 0 offen sc1
    v_lshlrev_b32 v184, 16, v176
    v_and_b32 v185, 0xffff0000, v176
    v_add_f32_dpp v220, v220, v220 quad_perm:[1,0,3,2] row_mask:0xf bank_mask:0xf
    v_add_f32_dpp v221, v221, v221 quad_perm:[1,0,3,2] row_mask:0xf bank_mask:0xf
    v_lshlrev_b32 v186, 16, v177
    v_add_f32_dpp v220, v220, v220 quad_perm:[2,3,0,1] row_mask:0xf bank_mask:0xf
    v_add_f32_dpp v221, v221, v221 quad_perm:[2,3,0,1] row_mask:0xf bank_mask:0xf
    v_and_b32 v187, 0xffff0000, v177
    v_add_f32_dpp v220, v220, v220 row_half_mirror row_mask:0xf bank_mask:0xf
    v_add_f32_dpp v221, v221, v221 row_half_mirror row_mask:0xf bank_mask:0xf
    v_lshlrev_b32 v188, 16, v178
    v_add_f32_dpp v220, v220, v220 row_mirror row_mask:0xf bank_mask:0xf
    v_add_f32_dpp v221, v221, v221 row_mirror row_mask:0xf bank_mask:0xf
    v_and_b32 v189, 0xffff0000, v178
    v_mov_b32 v222, v220
    v_mov_b32 v223, v221
    v_lshlrev_b32 v190, 16, v179
    v_permlane16_swap_b32 v220, v222
    v_permlane16_swap_b32 v221, v223
    v_add_f32 v220, v220, v222
    v_add_f32 v221, v221, v223
    v_mul_f32_e64 v220, -v220, s76
    v_mul_f32 v222, v220, v220
    v_fma_f32 v221, v221, s76, -v222
    v_max_f32 v221, 0, v221
    v_add_f32 v222, s75, v221
    v_rsq_f32 v216, v222
    v_and_b32 v191, 0xffff0000, v179
    v_mul_f32 v222, v216, v216
    v_fma_f32 v223, v222, v221, s75
    v_rsq_f32 v222, v223
    v_mul_f32 v217, v220, v216
    v_mul_f32 v218, v216, v222
    v_mul_f32 v219, v217, v222
    v_mul_f32 v223, v223, v222
    ds_write_b32 v226, v223
    v_lshlrev_b32 v192, 16, v180
    v_and_b32 v193, 0xffff0000, v180
    v_lshlrev_b32 v194, 16, v181
    v_and_b32 v195, 0xffff0000, v181
    v_lshlrev_b32 v196, 16, v182
    v_and_b32 v197, 0xffff0000, v182
    v_lshlrev_b32 v198, 16, v183
    v_and_b32 v199, 0xffff0000, v183
    v_pk_fma_f32 v[200:201], v[184:185], v[218:219], v[218:219] op_sel:[0,0,1] op_sel_hi:[1,0,1]
    v_pk_fma_f32 v[202:203], v[186:187], v[218:219], v[218:219] op_sel:[0,0,1] op_sel_hi:[1,0,1]
    v_pk_fma_f32 v[204:205], v[188:189], v[218:219], v[218:219] op_sel:[0,0,1] op_sel_hi:[1,0,1]
    v_pk_fma_f32 v[206:207], v[190:191], v[218:219], v[218:219] op_sel:[0,0,1] op_sel_hi:[1,0,1]
    v_cvt_pk_bf16_f32 v176, v200, v201
    v_cvt_pk_bf16_f32 v177, v202, v203
    v_cvt_pk_bf16_f32 v178, v204, v205
    v_cvt_pk_bf16_f32 v179, v206, v207
    ds_write_b128 v224, v[176:179] offset:0
    v_pk_fma_f32 v[208:209], v[192:193], v[218:219], v[218:219] op_sel:[0,0,1] op_sel_hi:[1,0,1]
    v_pk_fma_f32 v[210:211], v[194:195], v[218:219], v[218:219] op_sel:[0,0,1] op_sel_hi:[1,0,1]
    v_pk_fma_f32 v[212:213], v[196:197], v[218:219], v[218:219] op_sel:[0,0,1] op_sel_hi:[1,0,1]
    v_pk_fma_f32 v[214:215], v[198:199], v[218:219], v[218:219] op_sel:[0,0,1] op_sel_hi:[1,0,1]
    v_cvt_pk_bf16_f32 v180, v208, v209
    v_cvt_pk_bf16_f32 v181, v210, v211
    v_cvt_pk_bf16_f32 v182, v212, v213
    v_cvt_pk_bf16_f32 v183, v214, v215
    ds_write_b128 v224, v[180:183] offset:448
    s_waitcnt lgkmcnt(0)
    s_barrier
    ds_read_b64_tr_b16 v[104:105], v225 offset:0
    ds_read_b64_tr_b16 v[106:107], v225 offset:3840
    ds_read_b64_tr_b16 v[108:109], v225 offset:128
    ds_read_b64_tr_b16 v[110:111], v225 offset:3968
    ds_read_b32 v223, v231
    s_waitcnt lgkmcnt(3)
    buffer_store_dwordx4 v[104:107], v227, s[28:31], s70 offen sc1
    s_waitcnt lgkmcnt(1)
    buffer_store_dwordx4 v[108:111], v227, s[28:31], s71 offen sc1
    v_cmp_gt_u32 vcc, 16, v1
    s_waitcnt lgkmcnt(0)
    s_nop 0
    v_cndmask_b32 v223, 0, v223, vcc
    buffer_store_dword v223, v232, s[28:31], s72 offen sc1
    v_lshrrev_b32 v14, 2, v1
    v_mul_u32_u24 v14, 1056, v14
    v_lshl_add_u32 v14, v8, 3, v14
    s_mul_i32 s3, s48, 224
    v_add_u32 v237, s3, v14
    s_mov_b32 s18, 401408
    s_mov_b32 s19, 0x20000
    s_mov_b32 s26, 7340032
    s_mov_b32 s27, 0x20000
    s_mov_b32 s34, 1835008
    s_mov_b32 s35, 0x20000
    s_mov_b32 s36, 1
    v_lshl_add_u32 v15, v9, 2, v7
    v_lshlrev_b32 v15, 7, v15
    v_lshl_add_u32 v15, v8, 3, v15
    v_and_b32 v16, 2, v7
    v_and_b32 v14, 1, v3
    v_add_u32 v16, v16, v14
    v_lshl_add_u32 v15, v16, 5, v15
    s_mul_i32 s3, s4, 8256
    v_xor_b32 v31, s3, v15
    v_xor_b32 v32, 64, v31
    v_add_u32 v33, 65536, v31
    v_add_u32 v34, 65536, v32
    v_add_u32 v35, 131072, v31
    v_add_u32 v36, 131072, v32
    s_lshl_b32 s6, s52, 1
    s_add_u32 s6, s6, s5
    s_lshl_b32 s3, s6, 1
    s_add_u32 s3, s3, s59
    s_lshl_b32 s3, s3, 4
    s_add_u32 s3, s3, s4
    s_lshl_b32 s3, s3, 12
    v_add_u32 v71, s3, v4
    s_xor_b32 s37, s51, 1
    s_lshl_b32 s37, s37, 3
    s_add_u32 s37, s37, s52
    s_lshl_b32 s3, s37, 14
    s_add_u32 s3, s3, s58
    s_add_u32 s3, s3, 16777216
    v_add_u32 v23, s3, v4
    s_lshl_b32 s37, s37, 5
    s_add_u32 s37, s37, s5
    s_lshl_b32 s37, s37, 2
    s_add_u32 s37, s37, 6422528
    s_mul_i32 s67, s6, 56
    s_lshl_b32 s3, s51, 1
    s_add_u32 s3, s3, s4
    s_add_u32 s67, s67, s3
    s_lshl_b32 s67, s67, 11
    s_add_u32 s67, s67, 2097152
    v_add_u32 v74, s58, v4
    s_lshl_b32 s68, s52, 2
    s_and_b32 s3, s51, 1
    s_add_u32 s68, s68, s3
    s_cmp_ge_u32 s51, 14
    s_cselect_b32 s3, 2, 0
    s_add_u32 s68, s68, s3
    s_lshl_b32 s68, s68, 7
    s_add_u32 s68, s68, 6356992
    s_waitcnt vmcnt(3)
    v_readfirstlane_b32 s57, v12
    s_mov_b32 s60, 0
    s_cmp_lg_u32 s57, 0
    s_cbranch_scc1 L_nonce_okh
L_nonceh:
    buffer_load_dword v12, v17, s[44:47], 0 offen sc1
    s_add_u32 s60, s60, 1
    s_waitcnt vmcnt(0)
    v_readfirstlane_b32 s57, v12
    s_cmp_ge_u32 s60, 20000
    s_cbranch_scc1 L_nonce_okh
    s_cmp_eq_u32 s57, 0
    s_cbranch_scc1 L_nonceh
L_nonce_okh:
    s_waitcnt vmcnt(0)
    s_barrier
    s_atomic_swap s57, s[28:29], s74
    s_atomic_swap s57, s[28:29], s73
    buffer_load_dwordx4 v[90:93], v78, s[8:11], 0 offen
    buffer_load_ushort v88, v75, s[40:43], 0 offen offset:0
    buffer_load_dwordx4 v[94:97], v79, s[8:11], 0 offen
    buffer_load_ushort v89, v75, s[40:43], 0 offen offset:16
    v_cmp_gt_u32 vcc, 12, v2
    s_mul_i32 s3, s48, 56
    s_add_u32 s3, s3, s79
    s_mul_i32 s3, s3, 3
    s_add_u32 s3, s3, s80
    s_lshl_b32 s3, s3, 11
    s_add_u32 s3, s3, 8388608
    s_add_u32 s3, s3, s81
    ds_read_b64_tr_b16 v[176:177], v237 offset:0
    ds_read_b64_tr_b16 v[178:179], v237 offset:16896
    ds_read_b64_tr_b16 v[180:181], v237 offset:32
    ds_read_b64_tr_b16 v[182:183], v237 offset:16928
    ds_read_b64_tr_b16 v[184:185], v237 offset:56
    ds_read_b64_tr_b16 v[186:187], v237 offset:16952
    ds_read_b64_tr_b16 v[188:189], v237 offset:88
    ds_read_b64_tr_b16 v[190:191], v237 offset:16984
    ds_read_b64_tr_b16 v[192:193], v237 offset:112
    ds_read_b64_tr_b16 v[194:195], v237 offset:17008
    ds_read_b64_tr_b16 v[196:197], v237 offset:144
    ds_read_b64_tr_b16 v[198:199], v237 offset:17040
    ds_read_b64_tr_b16 v[200:201], v237 offset:168
    ds_read_b64_tr_b16 v[202:203], v237 offset:17064
    ds_read_b64_tr_b16 v[204:205], v237 offset:200
    ds_read_b64_tr_b16 v[206:207], v237 offset:17096
    s_waitcnt lgkmcnt(13)
    v_cndmask_b32 v180, 0, v180, vcc
    v_cndmask_b32 v181, 0, v181, vcc
    s_waitcnt lgkmcnt(12)
    v_cndmask_b32 v182, 0, v182, vcc
    v_cndmask_b32 v183, 0, v183, vcc
    buffer_store_dwordx4 v[176:179], v4, s[28:31], s3 offen offset:0 sc1
    buffer_store_dwordx4 v[180:183], v4, s[28:31], s3 offen offset:1024 sc1
    s_add_u32 s3, s3, 86016
    s_waitcnt lgkmcnt(9)
    v_cndmask_b32 v188, 0, v188, vcc
    v_cndmask_b32 v189, 0, v189, vcc
    s_waitcnt lgkmcnt(8)
    v_cndmask_b32 v190, 0, v190, vcc
    v_cndmask_b32 v191, 0, v191, vcc
    buffer_store_dwordx4 v[184:187], v4, s[28:31], s3 offen offset:0 sc1
    buffer_store_dwordx4 v[188:191], v4, s[28:31], s3 offen offset:1024 sc1
    s_add_u32 s3, s3, 86016
    s_waitcnt lgkmcnt(5)
    v_cndmask_b32 v196, 0, v196, vcc
    v_cndmask_b32 v197, 0, v197, vcc
    s_waitcnt lgkmcnt(4)
    v_cndmask_b32 v198, 0, v198, vcc
    v_cndmask_b32 v199, 0, v199, vcc
    buffer_store_dwordx4 v[192:195], v4, s[28:31], s3 offen offset:0 sc1
    buffer_store_dwordx4 v[196:199], v4, s[28:31], s3 offen offset:1024 sc1
    s_add_u32 s3, s3, 86016
    ds_read_b32 v24, v4
    s_waitcnt lgkmcnt(2)
    v_cndmask_b32 v204, 0, v204, vcc
    v_cndmask_b32 v205, 0, v205, vcc
    ds_read_b32 v24, v4
    s_waitcnt lgkmcnt(2)
    v_cndmask_b32 v206, 0, v206, vcc
    v_cndmask_b32 v207, 0, v207, vcc
    buffer_store_dwordx4 v[200:203], v4, s[28:31], s3 offen offset:0 sc1
    buffer_store_dwordx4 v[204:207], v4, s[28:31], s3 offen offset:1024 sc1
    s_add_u32 s3, s3, 86016
    s_lshl_b32 s67, s80, 6
    s_add_u32 s67, s67, 64
    s_cmp_eq_u32 s81, 0
    s_cselect_b32 s37, s48, 1
    s_mov_b32 s68, 6369792
    s_and_b32 s3, s2, 1
    s_mul_i32 s3, s3, 3
    s_bfe_u32 s6, s2, 0x10001
    s_mul_i32 s7, s6, 6
    s_add_u32 s3, s3, s7
    s_add_u32 s3, s3, 1
    v_add_u32 v15, s3, v8
    s_mul_i32 s6, s6, 64
    s_add_u32 s6, s6, 7
    v_cmp_ne_u32 vcc, s6, v15
    v_lshrrev_b32 v16, 2, v1
    v_mul_u32_u24 v16, 3584, v16
    v_cndmask_b32 v15, 0, v15, vcc
    v_lshl_add_u32 v15, v15, 8, v16
    s_lshl_b32 s3, s52, 2
    s_add_u32 s3, s3, s48
    s_mul_i32 s3, s3, 37
    s_min_u32 s3, s3, 976
    s_mul_i32 s3, s3, 3584
    s_mul_i32 s6, s59, 3670144
    s_add_u32 s3, s3, s6
    buffer_load_dword v220, v15, s[20:23], s3 offen
    s_add_u32 s3, s3, 57344
    buffer_load_dword v221, v15, s[20:23], s3 offen
    s_add_u32 s3, s3, 57344
    buffer_load_dword v222, v15, s[20:23], s3 offen
    s_add_u32 s3, s3, 57344
    v_add_u32 v46, 65536, v4
    v_add_u32 v47, 131072, v4
    s_mul_i32 s59, s48, 3072
    s_mul_i32 s3, s50, 86016
    s_add_u32 s3, s3, s59
    s_add_u32 s3, s3, 8388608
    v_add_u32 v73, s3, v4
    v_lshlrev_b32 v15, 7, v9
    v_xor_b32 v15, v15, v4
    s_lshl_b32 s3, s49, 11
    v_add_u32 v60, s3, v15
    v_add_u32 v61, 129024, v60
    s_lshr_b32 s3, s49, 2
    s_lshl_b32 s3, s3, 3
    s_max_u32 s3, s3, 1
    s_sub_u32 s3, s3, 1
    s_lshl_b32 s3, s3, 10
    s_lshl_b32 s6, s5, 17
    s_add_u32 s3, s3, s6
    s_lshl_b32 s6, s4, 28
    s_add_u32 s3, s3, s6
    v_add_u32 v62, s3, v15
    s_lshl_b32 s100, s5, 1
    s_add_u32 s100, s100, s4
    s_lshl_b32 s100, s100, 10
    v_and_b32 v15, 1, v1
    v_mul_u32_u24 v15, 640, v15
    v_lshrrev_b32 v16, 2, v1
    v_lshlrev_b32 v16, 4, v16
    v_xor_b32 v15, v15, v16
    v_bfe_u32 v16, v1, 1, 1
    v_lshl_add_u32 v15, v16, 3, v15
    s_add_u32 s3, s58, 12288
    v_add_u32 v63, s3, v15
    s_sub_u32 s3, s3, 3072
    s_cmp_eq_u32 s48, 0
    s_cselect_b32 s3, 28672, s3
    v_add_u32 v64, s3, v15
    v_add_u32 v65, 65536, v63
    v_add_u32 v66, 65536, v64
    v_add_u32 v67, 131072, v63
    v_add_u32 v68, 131072, v64
    s_lshl_b32 s3, s49, 1
    v_min_u32 v15, 2, v3
    v_add_u32 v15, s3, v15
    v_max_u32 v15, 1, v15
    v_lshlrev_b32 v15, 1, v15
    v_and_b32 v16, 1, v7
    v_add_lshl_u32 v15, v15, v16, 7
    v_lshrrev_b32 v16, 1, v7
    v_lshl_add_u32 v16, v16, 2, v8
    v_lshl_add_u32 v15, v16, 2, v15
    v_add_u32 v70, 6291200, v15
    s_min_u32 s15, s48, 2
    s_lshl_b32 s15, s15, 6
    s_add_u32 s15, s15, 64
    s_lshl_b32 s82, s49, 5
    s_add_u32 s82, s82, s50
    s_lshl_b32 s82, s82, 10
    s_add_u32 s82, s82, 4194304
    s_lshr_b32 s69, s49, 2
    s_lshl_b32 s69, s69, 1
    s_and_b32 s3, s50, 1
    s_add_u32 s69, s69, s3
    s_lshl_b32 s69, s69, 7
    s_add_u32 s69, s69, 6361088
    s_and_b32 s7, s53, 1
    s_mul_i32 s3, s7, 28
    s_add_u32 s3, s3, s48
    s_lshl_b32 s3, s3, 17
    s_xor_b32 s6, s53, 1
    s_lshl_b32 s55, s6, 3
    s_lshl_b32 s6, s53, 7
    s_add_u32 s3, s3, s6
    v_lshlrev_b32 v15, 12, v5
    v_add3_u32 v52, v15, v76, s3
    v_add_u32 v53, 31744, v52
    v_add_u32 v54, 63488, v52
    v_add_u32 v55, 95232, v52
    v_mul_u32_u24 v15, 896, v5
    s_mul_i32 s3, s4, 25088
    s_mul_i32 s6, s5, 14336
    s_add_u32 s3, s3, s6
    s_lshl_b32 s6, s54, 7
    s_add_u32 s3, s3, s6
    v_add3_u32 v56, v15, v76, s3
    v_add_u32 v57, 6144, v56
    s_lshl_b32 s6, s53, 1
    s_add_u32 s6, s6, s5
    s_and_b32 s3, s53, 30
    s_add_u32 s3, s3, s4
    s_lshl_b32 s3, s3, 7
    s_add_u32 s39, s3, 6361088
    s_lshl_b32 s3, s6, 5
    s_add_u32 s3, s3, s4
    s_lshl_b32 s3, s3, 10
    s_add_u32 s3, s3, 4194304
    v_add_u32 v58, s3, v4
    v_add_u32 v59, 15360, v58
    s_xor_b32 s3, s4, s5
    s_lshl_b32 s3, s3, 6
    v_xor_b32 v37, s3, v31
    v_add_u32 v38, 65536, v37
    v_add_u32 v39, 131072, v37
    v_lshlrev_b32 v14, 10, v14
    v_lshl_add_u32 v14, v9, 8, v14
    v_lshl_add_u32 v14, v2, 4, v14
    s_mul_i32 s3, s4, 12288
    v_add_u32 v40, s3, v14
    v_xor_b32 v41, 4096, v40
    v_add_u32 v42, 65536, v40
    v_add_u32 v43, 65536, v41
    v_add_u32 v44, 131072, v40
    v_add_u32 v45, 131072, v41
    s_lshl_b32 s6, s54, 1
    s_add_u32 s6, s6, s5
    s_lshl_b32 s3, s6, 1
    s_add_u32 s3, s3, s7
    s_mul_i32 s3, s3, 14
    s_add_u32 s3, s3, s4
    s_lshl_b32 s3, s3, 12
    s_add_u32 s3, s3, 2097152
    v_add_u32 v72, s3, v4
    s_lshl_b32 s3, s54, 1
    s_add_u32 s3, s3, s7
    s_lshl_b32 s3, s3, 1
    s_add_u32 s3, s3, s4
    s_lshl_b32 s3, s3, 7
    s_add_u32 s38, s3, 6356992
    s_and_b32 s3, s2, 6
    s_add_u32 s3, s3, s54
    s_sub_u32 s6, s3, 7
    s_cmp_ge_u32 s3, 7
    s_cselect_b32 s3, s6, s3
    s_lshl_b32 s64, s3, 19
    s_lshl_b32 s65, s3, 13
    s_add_u32 s55, s55, s54
    s_lshl_b32 s3, s55, 14
    s_add_u32 s3, s3, s58
    s_add_u32 s3, s3, 12582912
    v_add_u32 v21, s3, v4
    s_lshl_b32 s55, s55, 5
    s_add_u32 s55, s55, s48
    s_lshl_b32 s55, s55, 2
    s_add_u32 s55, s55, 6488064
    s_lshl_b32 s3, s5, 3
    v_add_u32 v14, s3, v9
    v_xor_b32 v14, v14, v6
    v_lshlrev_b32 v14, 4, v14
    v_lshl_add_u32 v14, v10, 8, v14
    s_lshl_b32 s3, s4, 14
    s_add_u32 s3, s3, 131072
    v_add_u32 v80, s3, v14
    v_xor_b32 v81, 32, v80
    v_xor_b32 v82, 64, v80
    v_xor_b32 v83, 96, v80
    s_lshr_b32 s3, s53, 1
    s_add_u32 s66, s3, s54
    v_lshlrev_b32 v14, 1, v6
    v_xor_b32 v14, v14, v5
    v_lshlrev_b32 v14, 4, v14
    v_lshl_add_u32 v14, v5, 8, v14
    s_add_u32 s3, s58, 131072
    v_add_u32 v84, s3, v14
    v_xor_b32 v85, 16, v84
    v_xor_b32 v86, 24576, v84
    v_xor_b32 v87, 24592, v84
    s_mov_b32 s70, 0xaaaaaaaa
    s_mov_b32 s71, 0xaaaaaaaa
    s_mov_b32 s72, 0xfff0ffff
    s_mov_b32 s73, 0xf000ff00
    s_mov_b32 s74, 0xffc0fffc
    s_mov_b32 s75, 0xc000fc00
    s_cmp_eq_u32 s49, 0
    s_cselect_b64 s[76:77], 0, -1
    v_mov_b32 v14, 0xffff
    v_mov_b32 v15, 0xffff0000
    v_cndmask_b32 v14, v14, v15, s[70:71]
    v_cndmask_b32 v98, v14, 0, s[72:73]
    v_cndmask_b32 v100, 0, v14, s[72:73]
    v_cndmask_b32 v99, v14, 0, s[74:75]
    v_cndmask_b32 v101, 0, v14, s[74:75]
    v_mov_b32 v77, 0xf149f2ca
    s_mov_b32 s83, 0x3e8b97f6
    s_mov_b32 s78, 0xbdd2d3e8
    s_mov_b32 s79, 0xbdd2d3e8
    s_mov_b32 s80, 1.0
    s_mov_b32 s81, 1.0
    v_mov_b32 v102, 0xc0135761
    v_mov_b32 v103, 0xc0135761
    v_lshlrev_b32 v14, 2, v9
    v_sub_u32 v14, v10, v14
    v_ashrrev_i32 v14, 1, v14
    v_mov_b32 v15, 0x3f80
    v_cndmask_b32 v15, v15, 1.0, s[70:71]
    v_cmp_eq_i32 vcc, 0, v14
    s_nop 1
    v_cndmask_b32 v16, 0, v15, vcc
    v_accvgpr_write_b32 a248, v16
    v_cmp_eq_i32 vcc, 1, v14
    s_nop 1
    v_cndmask_b32 v16, 0, v15, vcc
    v_accvgpr_write_b32 a249, v16
    v_cmp_eq_i32 vcc, 4, v14
    s_nop 1
    v_cndmask_b32 v16, 0, v15, vcc
    v_accvgpr_write_b32 a250, v16
    v_cmp_eq_i32 vcc, 5, v14
    s_nop 1
    v_cndmask_b32 v16, 0, v15, vcc
    v_accvgpr_write_b32 a251, v16
    v_cmp_eq_i32 vcc, 8, v14
    s_nop 1
    v_cndmask_b32 v16, 0, v15, vcc
    v_accvgpr_write_b32 a252, v16
    v_cmp_eq_i32 vcc, 9, v14
    s_nop 1
    v_cndmask_b32 v16, 0, v15, vcc
    v_accvgpr_write_b32 a253, v16
    v_cmp_eq_i32 vcc, 12, v14
    s_nop 1
    v_cndmask_b32 v16, 0, v15, vcc
    v_accvgpr_write_b32 a254, v16
    v_cmp_eq_i32 vcc, 13, v14
    s_nop 1
    v_cndmask_b32 v16, 0, v15, vcc
    v_accvgpr_write_b32 a255, v16
    s_waitcnt vmcnt(3)
    s_barrier
    s_cmp_lg_u32 s37, 0
    s_cbranch_scc1 L_nowsig
    s_atomic_add s36, s[44:45], s67
L_nowsig:
    buffer_load_dword v18, v20, s[28:31], 0 offen sc1
    s_cmp_eq_u32 s56, 0
    s_cselect_b32 s26, 0, s26
    v_sub_u32 v14, v71, v4
    v_lshl_add_u32 v14, v10, 7, v14
    s_add_u32 s3, s1, 8192
    v_lshl_add_u32 v15, v9, 13, s3
    s_waitcnt vmcnt(0)
    v_cmp_ne_u32 vcc, s57, v18
    s_cbranch_vccz L_pollok3
    s_mov_b32 s60, 0
L_poll3:
    s_sleep 8
    buffer_load_dword v18, v20, s[28:31], 0 offen sc1
    s_add_u32 s60, s60, 1
    s_waitcnt vmcnt(0)
    v_cmp_ne_u32 vcc, s57, v18
    s_cbranch_vccz L_pollok3
    s_cmp_lt_u32 s60, 20000
    s_cbranch_scc1 L_poll3
L_pollok3:
    s_barrier
    buffer_load_dword v69, v70, s[28:31], 0 offen sc1
    s_mov_b32 s26, 7340032
    s_and_b32 s3, s2, 1
    s_mul_i32 s3, s3, 7
    s_add_u32 s3, s3, s52
    s_lshl_b32 s3, s3, 2
    s_add_u32 s3, s3, s48
    s_lshl_b32 s3, s3, 17
    s_and_b32 s6, s2, 6
    s_lshl_b32 s6, s6, 9
    s_add_u32 s3, s3, s6
    v_lshlrev_b32 v14, 12, v10
    v_lshl_add_u32 v14, v9, 9, v14
    buffer_load_dword v226, v14, s[24:27], s3 offen offset:384
    buffer_load_dword v227, v14, s[24:27], s3 offen offset:256
    s_cmp_eq_u32 s56, 0
    s_cselect_b32 s26, 0, s26
    v_lshlrev_b32 v14, 2, v2
    v_and_b32 v15, 1, v1
    v_lshl_add_u32 v15, v3, 2, v15
    v_lshlrev_b32 v15, 2, v15
    v_add_u32 v16, 64, v15
    v_cndmask_b32 v17, v15, v16, s[72:73]
    v_cndmask_b32 v15, v15, v16, s[74:75]
    s_waitcnt vmcnt(2)
    ds_bpermute_b32 v25, v14, v69 offset:64
    ds_bpermute_b32 v27, v17, v69 offset:0
    ds_bpermute_b32 v28, v15, v69 offset:8
    ds_bpermute_b32 v26, v14, v69 offset:128
    ds_bpermute_b32 v29, v17, v69 offset:64
    ds_bpermute_b32 v30, v15, v69 offset:72
    s_waitcnt lgkmcnt(5)
    v_mul_f32 v25, s83, v25
    ds_read_b32 v24, v4
    s_waitcnt lgkmcnt(3)
    v_mul_f32 v26, s83, v26
    s_load_dword s14, s[44:45], s15
    s_waitcnt lgkmcnt(0)
    s_cmp_ge_u32 s14, 14
    s_cbranch_scc1 L_pollok4
    s_mov_b32 s60, 0
L_poll4:
    s_sleep 16
    buffer_load_dword v18, off, s[44:47], s15 sc1
    s_add_u32 s60, s60, 1
    s_waitcnt vmcnt(0)
    v_readfirstlane_b32 s14, v18
    s_nop 0
    s_cmp_ge_u32 s14, 14
    s_cbranch_scc1 L_pollok4
    s_cmp_lt_u32 s60, 20000
    s_cbranch_scc1 L_poll4
L_pollok4:
    s_barrier
    s_cmp_eq_u32 s56, 0
    s_cselect_b32 s3, 268435456, 0
    v_add_u32 v72, s3, v72
    s_add_u32 m0, s59, 98304
    s_nop 0
    buffer_load_dwordx4 v73, s[28:31], s63 offen sc1 lds
    buffer_load_dwordx4 v73, s[28:31], s63 offen offset:1024 sc1 lds
    buffer_load_dwordx4 v73, s[28:31], s63 offen offset:2048 sc1 lds
    s_add_u32 m0, s100, 126976
    s_nop 0
    buffer_load_dwordx4 v62, s[28:31], s62 offen sc1 lds
    s_add_u32 m0, s58, 110592
    s_nop 0
    buffer_load_dwordx4 v60, s[28:31], s62 offen sc1 lds
    buffer_load_dwordx4 v60, s[28:31], s62 offen offset:1024 sc1 lds
    buffer_load_dwordx4 v61, s[28:31], s62 offen offset:2048 sc1 lds
    buffer_load_dwordx4 v61, s[28:31], s62 offen offset:3072 sc1 lds
    s_add_u32 m0, s59, 131072
    s_add_u32 s63, s63, 12288
    s_cmp_eq_u32 s63, 86016
    s_cselect_b32 s63, 0, s63
    buffer_load_dwordx4 v73, s[28:31], s63 offen sc1 lds
    buffer_load_dwordx4 v73, s[28:31], s63 offen offset:1024 sc1 lds
    buffer_load_dwordx4 v73, s[28:31], s63 offen offset:2048 sc1 lds
    s_add_u32 m0, s100, 159744
    s_add_u32 s62, s62, 262144
    s_cmp_eq_u32 s62, 1835008
    s_cselect_b32 s62, 0, s62
    buffer_load_dwordx4 v62, s[28:31], s62 offen sc1 lds
    s_add_u32 m0, s58, 143360
    s_nop 0
    buffer_load_dwordx4 v60, s[28:31], s62 offen sc1 lds
    buffer_load_dwordx4 v60, s[28:31], s62 offen offset:1024 sc1 lds
    buffer_load_dwordx4 v61, s[28:31], s62 offen offset:2048 sc1 lds
    buffer_load_dwordx4 v61, s[28:31], s62 offen offset:3072 sc1 lds
    s_add_u32 m0, s59, 0
    s_add_u32 s63, s63, 12288
    s_cmp_eq_u32 s63, 86016
    s_cselect_b32 s63, 0, s63
    buffer_load_dwordx4 v73, s[28:31], s63 offen sc1 lds
    buffer_load_dwordx4 v73, s[28:31], s63 offen offset:1024 sc1 lds
    buffer_load_dwordx4 v73, s[28:31], s63 offen offset:2048 sc1 lds
    s_add_u32 m0, s100, 28672
    s_add_u32 s62, s62, 262144
    s_cmp_eq_u32 s62, 1835008
    s_cselect_b32 s62, 0, s62
    buffer_load_dwordx4 v62, s[28:31], s62 offen sc1 lds
    s_add_u32 m0, s58, 12288
    s_nop 0
    buffer_load_dwordx4 v60, s[28:31], s62 offen sc1 lds
    buffer_load_dwordx4 v60, s[28:31], s62 offen offset:1024 sc1 lds
    buffer_load_dwordx4 v61, s[28:31], s62 offen offset:2048 sc1 lds
    buffer_load_dwordx4 v61, s[28:31], s62 offen offset:3072 sc1 lds
    s_add_u32 m0, s59, 65536
    s_add_u32 s63, s63, 12288
    s_cmp_eq_u32 s63, 86016
    s_cselect_b32 s63, 0, s63
    buffer_load_dwordx4 v73, s[28:31], s63 offen sc1 lds
    buffer_load_dwordx4 v73, s[28:31], s63 offen offset:1024 sc1 lds
    buffer_load_dwordx4 v73, s[28:31], s63 offen offset:2048 sc1 lds
    s_add_u32 m0, s100, 94208
    s_add_u32 s62, s62, 262144
    s_cmp_eq_u32 s62, 1835008
    s_cselect_b32 s62, 0, s62
    buffer_load_dwordx4 v62, s[28:31], s62 offen sc1 lds
    s_add_u32 m0, s58, 77824
    s_nop 0
    buffer_load_dwordx4 v60, s[28:31], s62 offen sc1 lds
    buffer_load_dwordx4 v60, s[28:31], s62 offen offset:1024 sc1 lds
    buffer_load_dwordx4 v61, s[28:31], s62 offen offset:2048 sc1 lds
    buffer_load_dwordx4 v61, s[28:31], s62 offen offset:3072 sc1 lds
    s_mov_b32 s3, 268435456
    buffer_store_dword v12, v11, s[28:31], s3 offen
    buffer_store_dword v12, v11, s[28:31], s3 offen
    s_waitcnt vmcnt(18)
    s_barrier
    ds_read_b64_tr_b16 a[180:181], v65 offset:32768
    ds_read_b64_tr_b16 a[182:183], v65 offset:33024
    ds_read_b128 a[128:131], v46 offset:32768
    ds_read_b64_tr_b16 a[184:185], v65 offset:33792
    ds_read_b64_tr_b16 a[186:187], v65 offset:34048
    ds_read_b128 a[132:135], v46 offset:33792
    ds_read_b128 a[136:139], v46 offset:34816
    ds_read_b64_tr_b16 a[176:177], v66 offset:32768
    ds_read_b64_tr_b16 a[178:179], v66 offset:33024
    ds_read_b128 a[140:143], v46 offset:35840
    ds_read_b128 a[144:147], v46 offset:36864
    ds_read_b128 a[148:151], v46 offset:37888
    s_waitcnt lgkmcnt(0)
    s_nop 3
L_q:
    s_waitcnt lgkmcnt(6)
    v_mfma_f32_16x16x32_bf16 v[176:179], a[128:131], a[180:183], 0
    ds_read_b64_tr_b16 a[192:193], v65 offset:34816
    ds_read_b64_tr_b16 a[194:195], v65 offset:35072
    v_mfma_f32_16x16x32_bf16 v[184:187], a[128:131], a[184:187], 0
    ds_read_b128 a[152:155], v46 offset:38912
    ds_read_b64_tr_b16 a[196:197], v65 offset:35840
    v_mfma_f32_16x16x32_bf16 v[180:183], a[132:135], a[180:183], 0
    ds_read_b64_tr_b16 a[198:199], v65 offset:36096
    ds_read_b128 a[156:159], v46 offset:39936
    v_mfma_f32_16x16x32_bf16 v[188:191], a[132:135], a[184:187], 0
    ds_read_b128 a[160:163], v46 offset:40960
    ds_read_b64_tr_b16 a[188:189], v66 offset:34816
    s_waitcnt lgkmcnt(8)
    v_mfma_f32_16x16x32_bf16 v[200:203], a[136:139], a[180:183], 0
    ds_read_b64_tr_b16 a[190:191], v66 offset:35072
    v_mfma_f32_16x16x32_bf16 v[208:211], a[136:139], a[184:187], 0
    ds_read_b128 a[164:167], v46 offset:41984
    v_mfma_f32_16x16x32_bf16 v[192:195], a[136:139], a[176:179], 0
    ds_read_b128 a[168:171], v46 offset:43008
    v_mfma_f32_16x16x32_bf16 v[204:207], a[140:143], a[180:183], 0
    ds_read_b128 a[172:175], v46 offset:44032
    v_mfma_f32_16x16x32_bf16 v[212:215], a[140:143], a[184:187], 0
    v_mfma_f32_16x16x32_bf16 v[196:199], a[140:143], a[176:179], 0
    v_mfma_f32_16x16x32_bf16 v[224:227], a[180:183], a[144:147], 0
    v_mfma_f32_16x16x32_bf16 v[232:235], a[184:187], a[144:147], 0
    v_mfma_f32_16x16x32_bf16 v[216:219], a[176:179], a[144:147], 0
    v_mfma_f32_16x16x32_bf16 v[228:231], a[180:183], a[148:151], 0
    v_mfma_f32_16x16x32_bf16 v[236:239], a[184:187], a[148:151], 0
    v_mfma_f32_16x16x32_bf16 v[220:223], a[176:179], a[148:151], 0
    s_waitcnt lgkmcnt(0)
    s_barrier
    v_mfma_f32_16x16x32_bf16 v[176:179], a[152:155], a[192:195], v[176:179]
    ds_read_b64_tr_b16 a[180:181], v67 offset:0
    s_add_u32 m0, s59, 32768
    v_mfma_f32_16x16x32_bf16 v[184:187], a[152:155], a[196:199], v[184:187]
    ds_read_b64_tr_b16 a[182:183], v67 offset:256
    s_add_u32 s63, s63, 12288
    v_mfma_f32_16x16x32_bf16 v[180:183], a[156:159], a[192:195], v[180:183]
    ds_read_b128 a[128:131], v47 offset:0
    s_cmp_eq_u32 s63, 86016
    v_mfma_f32_16x16x32_bf16 v[188:191], a[156:159], a[196:199], v[188:191]
    ds_read_b64_tr_b16 a[184:185], v67 offset:1024
    v_mfma_f32_16x16x32_bf16 v[200:203], a[160:163], a[192:195], v[200:203]
    ds_read_b64_tr_b16 a[186:187], v67 offset:1280
    s_cselect_b32 s63, 0, s63
    v_mfma_f32_16x16x32_bf16 v[208:211], a[160:163], a[196:199], v[208:211]
    ds_read_b128 a[132:135], v47 offset:1024
    buffer_load_dwordx4 v73, s[28:31], s63 offen sc1 lds
    v_mfma_f32_16x16x32_bf16 v[192:195], a[160:163], a[188:191], v[192:195]
    ds_read_b128 a[136:139], v47 offset:2048
    v_mfma_f32_16x16x32_bf16 v[204:207], a[164:167], a[192:195], v[204:207]
    ds_read_b64_tr_b16 a[176:177], v68 offset:0
    buffer_load_dwordx4 v73, s[28:31], s63 offen offset:1024 sc1 lds
    v_mfma_f32_16x16x32_bf16 v[212:215], a[164:167], a[196:199], v[212:215]
    ds_read_b64_tr_b16 a[178:179], v68 offset:256
    v_mfma_f32_16x16x32_bf16 v[196:199], a[164:167], a[188:191], v[196:199]
    ds_read_b128 a[140:143], v47 offset:3072
    v_mfma_f32_16x16x32_bf16 v[224:227], a[192:195], a[168:171], v[224:227]
    ds_read_b128 a[144:147], v47 offset:4096
    buffer_load_dwordx4 v73, s[28:31], s63 offen offset:2048 sc1 lds
    v_mfma_f32_16x16x32_bf16 v[232:235], a[196:199], a[168:171], v[232:235]
    ds_read_b128 a[148:151], v47 offset:5120
    s_add_u32 m0, s100, 61440
    v_mfma_f32_16x16x32_bf16 v[216:219], a[188:191], a[168:171], v[216:219]
    s_add_u32 s62, s62, 262144
    s_cmp_eq_u32 s62, 1835008
    v_mfma_f32_16x16x32_bf16 v[228:231], a[192:195], a[172:175], v[228:231]
    s_cselect_b32 s62, 0, s62
    buffer_load_dwordx4 v62, s[28:31], s62 offen sc1 lds
    v_mfma_f32_16x16x32_bf16 v[236:239], a[196:199], a[172:175], v[236:239]
    s_add_u32 m0, s58, 45056
    v_mfma_f32_16x16x32_bf16 v[220:223], a[188:191], a[172:175], v[220:223]
    s_waitcnt lgkmcnt(6)
    v_mfma_f32_16x16x32_bf16 v[176:179], a[128:131], a[180:183], v[176:179]
    ds_read_b64_tr_b16 a[192:193], v67 offset:2048
    ds_read_b64_tr_b16 a[194:195], v67 offset:2304
    v_mfma_f32_16x16x32_bf16 v[184:187], a[128:131], a[184:187], v[184:187]
    ds_read_b128 a[152:155], v47 offset:6144
    ds_read_b64_tr_b16 a[196:197], v67 offset:3072
    v_mfma_f32_16x16x32_bf16 v[180:183], a[132:135], a[180:183], v[180:183]
    ds_read_b64_tr_b16 a[198:199], v67 offset:3328
    ds_read_b128 a[156:159], v47 offset:7168
    v_mfma_f32_16x16x32_bf16 v[188:191], a[132:135], a[184:187], v[188:191]
    ds_read_b128 a[160:163], v47 offset:8192
    ds_read_b64_tr_b16 a[188:189], v68 offset:2048
    s_waitcnt lgkmcnt(8)
    v_mfma_f32_16x16x32_bf16 v[200:203], a[136:139], a[180:183], v[200:203]
    ds_read_b64_tr_b16 a[190:191], v68 offset:2304
    buffer_load_dwordx4 v60, s[28:31], s62 offen sc1 lds
    v_mfma_f32_16x16x32_bf16 v[208:211], a[136:139], a[184:187], v[208:211]
    ds_read_b128 a[164:167], v47 offset:9216
    v_mfma_f32_16x16x32_bf16 v[192:195], a[136:139], a[176:179], v[192:195]
    ds_read_b128 a[168:171], v47 offset:10240
    buffer_load_dwordx4 v60, s[28:31], s62 offen offset:1024 sc1 lds
    v_mfma_f32_16x16x32_bf16 v[204:207], a[140:143], a[180:183], v[204:207]
    ds_read_b128 a[172:175], v47 offset:11264
    v_mfma_f32_16x16x32_bf16 v[212:215], a[140:143], a[184:187], v[212:215]
    v_mfma_f32_16x16x32_bf16 v[196:199], a[140:143], a[176:179], v[196:199]
    buffer_load_dwordx4 v61, s[28:31], s62 offen offset:2048 sc1 lds
    v_mfma_f32_16x16x32_bf16 v[224:227], a[180:183], a[144:147], v[224:227]
    v_mfma_f32_16x16x32_bf16 v[232:235], a[184:187], a[144:147], v[232:235]
    v_mfma_f32_16x16x32_bf16 v[216:219], a[176:179], a[144:147], v[216:219]
    buffer_load_dwordx4 v61, s[28:31], s62 offen offset:3072 sc1 lds
    s_add_u32 m0, s59, 98304
    v_mfma_f32_16x16x32_bf16 v[228:231], a[180:183], a[148:151], v[228:231]
    s_add_u32 s63, s63, 12288
    s_cmp_eq_u32 s63, 86016
    v_mfma_f32_16x16x32_bf16 v[236:239], a[184:187], a[148:151], v[236:239]
    s_cselect_b32 s63, 0, s63
    v_mfma_f32_16x16x32_bf16 v[220:223], a[176:179], a[148:151], v[220:223]
    s_waitcnt vmcnt(8) lgkmcnt(0)
    s_barrier
    s_cmp_lg_u32 s48, 0
    s_cbranch_scc1 L_sig2
    s_atomic_add s36, s[28:29], s68
L_sig2:
    v_mfma_f32_16x16x32_bf16 v[176:179], a[152:155], a[192:195], v[176:179]
    ds_read_b64_tr_b16 a[180:181], v63 offset:0
    buffer_load_dwordx4 v73, s[28:31], s63 offen sc1 lds
    v_mfma_f32_16x16x32_bf16 v[184:187], a[152:155], a[196:199], v[184:187]
    ds_read_b64_tr_b16 a[182:183], v63 offset:256
    v_mfma_f32_16x16x32_bf16 v[180:183], a[156:159], a[192:195], v[180:183]
    ds_read_b128 a[128:131], v4 offset:0
    buffer_load_dwordx4 v73, s[28:31], s63 offen offset:1024 sc1 lds
    v_mfma_f32_16x16x32_bf16 v[188:191], a[156:159], a[196:199], v[188:191]
    ds_read_b64_tr_b16 a[184:185], v63 offset:1024
    v_mfma_f32_16x16x32_bf16 v[200:203], a[160:163], a[192:195], v[200:203]
    ds_read_b64_tr_b16 a[186:187], v63 offset:1280
    v_mfma_f32_16x16x32_bf16 v[208:211], a[160:163], a[196:199], v[208:211]
    ds_read_b128 a[132:135], v4 offset:1024
    buffer_load_dwordx4 v73, s[28:31], s63 offen offset:2048 sc1 lds
    v_mfma_f32_16x16x32_bf16 v[192:195], a[160:163], a[188:191], v[192:195]
    ds_read_b128 a[136:139], v4 offset:2048
    s_add_u32 m0, s100, 126976
    v_mfma_f32_16x16x32_bf16 v[204:207], a[164:167], a[192:195], v[204:207]
    ds_read_b64_tr_b16 a[176:177], v64 offset:0
    s_add_u32 s62, s62, 262144
    v_mfma_f32_16x16x32_bf16 v[212:215], a[164:167], a[196:199], v[212:215]
    ds_read_b64_tr_b16 a[178:179], v64 offset:256
    s_cmp_eq_u32 s62, 1835008
    v_mfma_f32_16x16x32_bf16 v[196:199], a[164:167], a[188:191], v[196:199]
    ds_read_b128 a[140:143], v4 offset:3072
    s_cselect_b32 s62, 0, s62
    v_mfma_f32_16x16x32_bf16 v[224:227], a[192:195], a[168:171], v[224:227]
    ds_read_b128 a[144:147], v4 offset:4096
    buffer_load_dwordx4 v62, s[28:31], s62 offen sc1 lds
    v_mfma_f32_16x16x32_bf16 v[232:235], a[196:199], a[168:171], v[232:235]
    ds_read_b128 a[148:151], v4 offset:5120
    s_add_u32 m0, s58, 110592
    v_mfma_f32_16x16x32_bf16 v[216:219], a[188:191], a[168:171], v[216:219]
    buffer_load_dwordx4 v60, s[28:31], s62 offen sc1 lds
    v_mfma_f32_16x16x32_bf16 v[228:231], a[192:195], a[172:175], v[228:231]
    v_mfma_f32_16x16x32_bf16 v[236:239], a[196:199], a[172:175], v[236:239]
    v_mfma_f32_16x16x32_bf16 v[220:223], a[188:191], a[172:175], v[220:223]
    buffer_load_dwordx4 v60, s[28:31], s62 offen offset:1024 sc1 lds
    s_waitcnt lgkmcnt(6)
    v_mfma_f32_16x16x32_bf16 v[176:179], a[128:131], a[180:183], v[176:179]
    ds_read_b64_tr_b16 a[192:193], v63 offset:2048
    ds_read_b64_tr_b16 a[194:195], v63 offset:2304
    v_mfma_f32_16x16x32_bf16 v[184:187], a[128:131], a[184:187], v[184:187]
    ds_read_b128 a[152:155], v4 offset:6144
    ds_read_b64_tr_b16 a[196:197], v63 offset:3072
    v_mfma_f32_16x16x32_bf16 v[180:183], a[132:135], a[180:183], v[180:183]
    ds_read_b64_tr_b16 a[198:199], v63 offset:3328
    ds_read_b128 a[156:159], v4 offset:7168
    v_mfma_f32_16x16x32_bf16 v[188:191], a[132:135], a[184:187], v[188:191]
    ds_read_b128 a[160:163], v4 offset:8192
    ds_read_b64_tr_b16 a[188:189], v64 offset:2048
    s_waitcnt lgkmcnt(8)
    v_mfma_f32_16x16x32_bf16 v[200:203], a[136:139], a[180:183], v[200:203]
    ds_read_b64_tr_b16 a[190:191], v64 offset:2304
    buffer_load_dwordx4 v61, s[28:31], s62 offen offset:2048 sc1 lds
    v_mfma_f32_16x16x32_bf16 v[208:211], a[136:139], a[184:187], v[208:211]
    ds_read_b128 a[164:167], v4 offset:9216
    v_mfma_f32_16x16x32_bf16 v[192:195], a[136:139], a[176:179], v[192:195]
    ds_read_b128 a[168:171], v4 offset:10240
    buffer_load_dwordx4 v61, s[28:31], s62 offen offset:3072 sc1 lds
    v_mfma_f32_16x16x32_bf16 v[204:207], a[140:143], a[180:183], v[204:207]
    ds_read_b128 a[172:175], v4 offset:11264
    s_add_u32 m0, s59, 131072
    v_mfma_f32_16x16x32_bf16 v[212:215], a[140:143], a[184:187], v[212:215]
    s_add_u32 s63, s63, 12288
    s_cmp_eq_u32 s63, 86016
    v_mfma_f32_16x16x32_bf16 v[196:199], a[140:143], a[176:179], v[196:199]
    s_cselect_b32 s63, 0, s63
    buffer_load_dwordx4 v73, s[28:31], s63 offen sc1 lds
    v_mfma_f32_16x16x32_bf16 v[224:227], a[180:183], a[144:147], v[224:227]
    v_mfma_f32_16x16x32_bf16 v[232:235], a[184:187], a[144:147], v[232:235]
    v_mfma_f32_16x16x32_bf16 v[216:219], a[176:179], a[144:147], v[216:219]
    buffer_load_dwordx4 v73, s[28:31], s63 offen offset:1024 sc1 lds
    v_mfma_f32_16x16x32_bf16 v[228:231], a[180:183], a[148:151], v[228:231]
    v_mfma_f32_16x16x32_bf16 v[236:239], a[184:187], a[148:151], v[236:239]
    v_mfma_f32_16x16x32_bf16 v[220:223], a[176:179], a[148:151], v[220:223]
    ds_read_b32 v24, v4
    s_waitcnt lgkmcnt(1)
    s_barrier
    v_mfma_f32_16x16x32_bf16 v[176:179], a[152:155], a[192:195], v[176:179]
    ds_read_b64_tr_b16 a[180:181], v65 offset:0
    buffer_load_dwordx4 v73, s[28:31], s63 offen offset:2048 sc1 lds
    v_mfma_f32_16x16x32_bf16 v[184:187], a[152:155], a[196:199], v[184:187]
    ds_read_b64_tr_b16 a[182:183], v65 offset:256
    s_add_u32 m0, s100, 159744
    v_mfma_f32_16x16x32_bf16 v[180:183], a[156:159], a[192:195], v[180:183]
    ds_read_b128 a[128:131], v46 offset:0
    s_add_u32 s62, s62, 262144
    v_mfma_f32_16x16x32_bf16 v[188:191], a[156:159], a[196:199], v[188:191]
    ds_read_b64_tr_b16 a[184:185], v65 offset:1024
    v_mfma_f32_16x16x32_bf16 v[200:203], a[160:163], a[192:195], v[200:203]
    ds_read_b64_tr_b16 a[186:187], v65 offset:1280
    s_cmp_eq_u32 s62, 1835008
    v_mfma_f32_16x16x32_bf16 v[208:211], a[160:163], a[196:199], v[208:211]
    ds_read_b128 a[132:135], v46 offset:1024
    s_cselect_b32 s62, 0, s62
    v_mfma_f32_16x16x32_bf16 v[192:195], a[160:163], a[188:191], v[192:195]
    ds_read_b128 a[136:139], v46 offset:2048
    buffer_load_dwordx4 v62, s[28:31], s62 offen sc1 lds
    v_mfma_f32_16x16x32_bf16 v[204:207], a[164:167], a[192:195], v[204:207]
    ds_read_b64_tr_b16 a[176:177], v66 offset:0
    s_add_u32 m0, s58, 143360
    v_mfma_f32_16x16x32_bf16 v[212:215], a[164:167], a[196:199], v[212:215]
    ds_read_b64_tr_b16 a[178:179], v66 offset:256
    buffer_load_dwordx4 v60, s[28:31], s62 offen sc1 lds
    v_mfma_f32_16x16x32_bf16 v[196:199], a[164:167], a[188:191], v[196:199]
    ds_read_b128 a[140:143], v46 offset:3072
    v_mfma_f32_16x16x32_bf16 v[224:227], a[192:195], a[168:171], v[224:227]
    ds_read_b128 a[144:147], v46 offset:4096
    v_mfma_f32_16x16x32_bf16 v[232:235], a[196:199], a[168:171], v[232:235]
    ds_read_b128 a[148:151], v46 offset:5120
    buffer_load_dwordx4 v60, s[28:31], s62 offen offset:1024 sc1 lds
    v_mfma_f32_16x16x32_bf16 v[216:219], a[188:191], a[168:171], v[216:219]
    v_mfma_f32_16x16x32_bf16 v[228:231], a[192:195], a[172:175], v[228:231]
    v_mfma_f32_16x16x32_bf16 v[236:239], a[196:199], a[172:175], v[236:239]
    buffer_load_dwordx4 v61, s[28:31], s62 offen offset:2048 sc1 lds
    v_mfma_f32_16x16x32_bf16 v[220:223], a[188:191], a[172:175], v[220:223]
    s_waitcnt lgkmcnt(6)
    v_mfma_f32_16x16x32_bf16 v[176:179], a[128:131], a[180:183], v[176:179]
    ds_read_b64_tr_b16 a[192:193], v65 offset:2048
    ds_read_b64_tr_b16 a[194:195], v65 offset:2304
    v_mfma_f32_16x16x32_bf16 v[184:187], a[128:131], a[184:187], v[184:187]
    ds_read_b128 a[152:155], v46 offset:6144
    ds_read_b64_tr_b16 a[196:197], v65 offset:3072
    v_mfma_f32_16x16x32_bf16 v[180:183], a[132:135], a[180:183], v[180:183]
    ds_read_b64_tr_b16 a[198:199], v65 offset:3328
    ds_read_b128 a[156:159], v46 offset:7168
    v_mfma_f32_16x16x32_bf16 v[188:191], a[132:135], a[184:187], v[188:191]
    ds_read_b128 a[160:163], v46 offset:8192
    ds_read_b64_tr_b16 a[188:189], v66 offset:2048
    s_waitcnt lgkmcnt(8)
    v_mfma_f32_16x16x32_bf16 v[200:203], a[136:139], a[180:183], v[200:203]
    ds_read_b64_tr_b16 a[190:191], v66 offset:2304
    buffer_load_dwordx4 v61, s[28:31], s62 offen offset:3072 sc1 lds
    v_mfma_f32_16x16x32_bf16 v[208:211], a[136:139], a[184:187], v[208:211]
    ds_read_b128 a[164:167], v46 offset:9216
    s_add_u32 m0, s58, 0
    v_mfma_f32_16x16x32_bf16 v[192:195], a[136:139], a[176:179], v[192:195]
    ds_read_b128 a[168:171], v46 offset:10240
    buffer_load_dwordx4 v52, s[24:27], s64 offen lds
    v_mfma_f32_16x16x32_bf16 v[204:207], a[140:143], a[180:183], v[204:207]
    ds_read_b128 a[172:175], v46 offset:11264
    v_mfma_f32_16x16x32_bf16 v[212:215], a[140:143], a[184:187], v[212:215]
    v_mfma_f32_16x16x32_bf16 v[196:199], a[140:143], a[176:179], v[196:199]
    buffer_load_dwordx4 v53, s[24:27], s64 offen offset:1024 lds
    v_mfma_f32_16x16x32_bf16 v[224:227], a[180:183], a[144:147], v[224:227]
    v_mfma_f32_16x16x32_bf16 v[232:235], a[184:187], a[144:147], v[232:235]
    v_mfma_f32_16x16x32_bf16 v[216:219], a[176:179], a[144:147], v[216:219]
    buffer_load_dwordx4 v54, s[24:27], s64 offen offset:2048 lds
    v_mfma_f32_16x16x32_bf16 v[228:231], a[180:183], a[148:151], v[228:231]
    v_mfma_f32_16x16x32_bf16 v[236:239], a[184:187], a[148:151], v[236:239]
    v_mfma_f32_16x16x32_bf16 v[220:223], a[176:179], a[148:151], v[220:223]
    ds_read_b32 v24, v4
    s_waitcnt vmcnt(19) lgkmcnt(1)
    s_barrier
    v_mfma_f32_16x16x32_bf16 v[176:179], a[152:155], a[192:195], v[176:179]
    ds_read_b64_tr_b16 a[180:181], v63 offset:32768
    buffer_load_dwordx4 v55, s[24:27], s64 offen offset:3072 lds
    v_mfma_f32_16x16x32_bf16 v[184:187], a[152:155], a[196:199], v[184:187]
    ds_read_b64_tr_b16 a[182:183], v63 offset:33024
    s_add_u32 m0, s58, 16384
    v_mfma_f32_16x16x32_bf16 v[180:183], a[156:159], a[192:195], v[180:183]
    ds_read_b128 a[128:131], v4 offset:32768
    v_xor_b32 v52, 128, v52
    v_mfma_f32_16x16x32_bf16 v[188:191], a[156:159], a[196:199], v[188:191]
    ds_read_b64_tr_b16 a[184:185], v63 offset:33792
    v_mfma_f32_16x16x32_bf16 v[200:203], a[160:163], a[192:195], v[200:203]
    ds_read_b64_tr_b16 a[186:187], v63 offset:34048
    buffer_load_dwordx4 v52, s[24:27], s64 offen lds
    v_mfma_f32_16x16x32_bf16 v[208:211], a[160:163], a[196:199], v[208:211]
    ds_read_b128 a[132:135], v4 offset:33792
    v_xor_b32 v53, 128, v53
    v_mfma_f32_16x16x32_bf16 v[192:195], a[160:163], a[188:191], v[192:195]
    ds_read_b128 a[136:139], v4 offset:34816
    buffer_load_dwordx4 v53, s[24:27], s64 offen offset:1024 lds
    v_mfma_f32_16x16x32_bf16 v[204:207], a[164:167], a[192:195], v[204:207]
    ds_read_b64_tr_b16 a[176:177], v64 offset:32768
    v_xor_b32 v54, 128, v54
    v_mfma_f32_16x16x32_bf16 v[212:215], a[164:167], a[196:199], v[212:215]
    ds_read_b64_tr_b16 a[178:179], v64 offset:33024
    v_mfma_f32_16x16x32_bf16 v[196:199], a[164:167], a[188:191], v[196:199]
    ds_read_b128 a[140:143], v4 offset:35840
    buffer_load_dwordx4 v54, s[24:27], s64 offen offset:2048 lds
    v_mfma_f32_16x16x32_bf16 v[224:227], a[192:195], a[168:171], v[224:227]
    ds_read_b128 a[144:147], v4 offset:36864
    v_xor_b32 v55, 128, v55
    v_mfma_f32_16x16x32_bf16 v[232:235], a[196:199], a[168:171], v[232:235]
    ds_read_b128 a[148:151], v4 offset:37888
    v_mfma_f32_16x16x32_bf16 v[216:219], a[188:191], a[168:171], v[216:219]
    buffer_load_dwordx4 v55, s[24:27], s64 offen offset:3072 lds
    s_add_u32 m0, s58, 65536
    v_mfma_f32_16x16x32_bf16 v[228:231], a[192:195], a[172:175], v[228:231]
    s_add_u32 s64, s64, 524288
    s_cmp_eq_u32 s64, 3670016
    v_mfma_f32_16x16x32_bf16 v[236:239], a[196:199], a[172:175], v[236:239]
    s_cselect_b32 s64, 0, s64
    v_mfma_f32_16x16x32_bf16 v[220:223], a[188:191], a[172:175], v[220:223]
    s_waitcnt lgkmcnt(6)
    v_mfma_f32_16x16x32_bf16 v[176:179], a[128:131], a[180:183], v[176:179]
    ds_read_b64_tr_b16 a[192:193], v63 offset:34816
    ds_read_b64_tr_b16 a[194:195], v63 offset:35072
    v_mfma_f32_16x16x32_bf16 v[184:187], a[128:131], a[184:187], v[184:187]
    ds_read_b128 a[152:155], v4 offset:38912
    ds_read_b64_tr_b16 a[196:197], v63 offset:35840
    v_mfma_f32_16x16x32_bf16 v[180:183], a[132:135], a[180:183], v[180:183]
    ds_read_b64_tr_b16 a[198:199], v63 offset:36096
    ds_read_b128 a[156:159], v4 offset:39936
    v_mfma_f32_16x16x32_bf16 v[188:191], a[132:135], a[184:187], v[188:191]
    ds_read_b128 a[160:163], v4 offset:40960
    ds_read_b64_tr_b16 a[188:189], v64 offset:34816
    s_waitcnt lgkmcnt(8)
    v_mfma_f32_16x16x32_bf16 v[200:203], a[136:139], a[180:183], v[200:203]
    ds_read_b64_tr_b16 a[190:191], v64 offset:35072
    buffer_load_dwordx4 v52, s[24:27], s64 offen lds
    v_mfma_f32_16x16x32_bf16 v[208:211], a[136:139], a[184:187], v[208:211]
    ds_read_b128 a[164:167], v4 offset:41984
    v_mfma_f32_16x16x32_bf16 v[192:195], a[136:139], a[176:179], v[192:195]
    ds_read_b128 a[168:171], v4 offset:43008
    buffer_load_dwordx4 v53, s[24:27], s64 offen offset:1024 lds
    v_mfma_f32_16x16x32_bf16 v[204:207], a[140:143], a[180:183], v[204:207]
    ds_read_b128 a[172:175], v4 offset:44032
    v_mfma_f32_16x16x32_bf16 v[212:215], a[140:143], a[184:187], v[212:215]
    v_mfma_f32_16x16x32_bf16 v[196:199], a[140:143], a[176:179], v[196:199]
    buffer_load_dwordx4 v54, s[24:27], s64 offen offset:2048 lds
    v_mfma_f32_16x16x32_bf16 v[224:227], a[180:183], a[144:147], v[224:227]
    v_mfma_f32_16x16x32_bf16 v[232:235], a[184:187], a[144:147], v[232:235]
    v_mfma_f32_16x16x32_bf16 v[216:219], a[176:179], a[144:147], v[216:219]
    buffer_load_dwordx4 v55, s[24:27], s64 offen offset:3072 lds
    s_add_u32 m0, s58, 81920
    v_mfma_f32_16x16x32_bf16 v[228:231], a[180:183], a[148:151], v[228:231]
    s_add_u32 s64, s64, 524288
    s_cmp_eq_u32 s64, 3670016
    v_mfma_f32_16x16x32_bf16 v[236:239], a[184:187], a[148:151], v[236:239]
    s_cselect_b32 s64, 0, s64
    v_mfma_f32_16x16x32_bf16 v[220:223], a[176:179], a[148:151], v[220:223]
    ds_read_b32 v24, v4
    s_waitcnt vmcnt(20) lgkmcnt(1)
    s_barrier
    v_mfma_f32_16x16x32_bf16 v[176:179], a[152:155], a[192:195], v[176:179]
    ds_read_b64_tr_b16 a[180:181], v65 offset:32768
    buffer_load_dwordx4 v52, s[24:27], s64 offen lds
    v_mfma_f32_16x16x32_bf16 v[184:187], a[152:155], a[196:199], v[184:187]
    ds_read_b64_tr_b16 a[182:183], v65 offset:33024
    v_mfma_f32_16x16x32_bf16 v[180:183], a[156:159], a[192:195], v[180:183]
    ds_read_b128 a[128:131], v46 offset:32768
    v_mfma_f32_16x16x32_bf16 v[188:191], a[156:159], a[196:199], v[188:191]
    ds_read_b64_tr_b16 a[184:185], v65 offset:33792
    v_mfma_f32_16x16x32_bf16 v[200:203], a[160:163], a[192:195], v[200:203]
    ds_read_b64_tr_b16 a[186:187], v65 offset:34048
    buffer_load_dwordx4 v53, s[24:27], s64 offen offset:1024 lds
    v_mfma_f32_16x16x32_bf16 v[208:211], a[160:163], a[196:199], v[208:211]
    ds_read_b128 a[132:135], v46 offset:33792
    v_mfma_f32_16x16x32_bf16 v[192:195], a[160:163], a[188:191], v[192:195]
    ds_read_b128 a[136:139], v46 offset:34816
    buffer_load_dwordx4 v54, s[24:27], s64 offen offset:2048 lds
    v_mfma_f32_16x16x32_bf16 v[204:207], a[164:167], a[192:195], v[204:207]
    ds_read_b64_tr_b16 a[176:177], v66 offset:32768
    v_mfma_f32_16x16x32_bf16 v[212:215], a[164:167], a[196:199], v[212:215]
    ds_read_b64_tr_b16 a[178:179], v66 offset:33024
    v_mfma_f32_16x16x32_bf16 v[196:199], a[164:167], a[188:191], v[196:199]
    ds_read_b128 a[140:143], v46 offset:35840
    buffer_load_dwordx4 v55, s[24:27], s64 offen offset:3072 lds
    v_mfma_f32_16x16x32_bf16 v[224:227], a[192:195], a[168:171], v[224:227]
    ds_read_b128 a[144:147], v46 offset:36864
    s_add_u32 m0, s58, 32768
    v_mfma_f32_16x16x32_bf16 v[232:235], a[196:199], a[168:171], v[232:235]
    ds_read_b128 a[148:151], v46 offset:37888
    s_add_u32 s64, s64, 524288
    v_mfma_f32_16x16x32_bf16 v[216:219], a[188:191], a[168:171], v[216:219]
    s_cmp_eq_u32 s64, 3670016
    s_cselect_b32 s64, 0, s64
    v_mfma_f32_16x16x32_bf16 v[228:231], a[192:195], a[172:175], v[228:231]
    buffer_load_dwordx4 v52, s[24:27], s64 offen lds
    v_mfma_f32_16x16x32_bf16 v[236:239], a[196:199], a[172:175], v[236:239]
    v_mfma_f32_16x16x32_bf16 v[220:223], a[188:191], a[172:175], v[220:223]
    s_load_dword s14, s[28:29], s38
    s_waitcnt lgkmcnt(6)
    v_mfma_f32_16x16x32_bf16 v[176:179], a[128:131], a[180:183], v[176:179]
    ds_read_b64_tr_b16 a[192:193], v65 offset:34816
    ds_read_b64_tr_b16 a[194:195], v65 offset:35072
    v_mfma_f32_16x16x32_bf16 v[184:187], a[128:131], a[184:187], v[184:187]
    ds_read_b128 a[152:155], v46 offset:38912
    ds_read_b64_tr_b16 a[196:197], v65 offset:35840
    v_mfma_f32_16x16x32_bf16 v[180:183], a[132:135], a[180:183], v[180:183]
    ds_read_b64_tr_b16 a[198:199], v65 offset:36096
    ds_read_b128 a[156:159], v46 offset:39936
    v_mfma_f32_16x16x32_bf16 v[188:191], a[132:135], a[184:187], v[188:191]
    ds_read_b128 a[160:163], v46 offset:40960
    ds_read_b64_tr_b16 a[188:189], v66 offset:34816
    s_waitcnt lgkmcnt(8)
    v_mfma_f32_16x16x32_bf16 v[200:203], a[136:139], a[180:183], v[200:203]
    ds_read_b64_tr_b16 a[190:191], v66 offset:35072
    buffer_load_dwordx4 v53, s[24:27], s64 offen offset:1024 lds
    v_mfma_f32_16x16x32_bf16 v[208:211], a[136:139], a[184:187], v[208:211]
    ds_read_b128 a[164:167], v46 offset:41984
    v_mfma_f32_16x16x32_bf16 v[192:195], a[136:139], a[176:179], v[192:195]
    ds_read_b128 a[168:171], v46 offset:43008
    buffer_load_dwordx4 v54, s[24:27], s64 offen offset:2048 lds
    v_mfma_f32_16x16x32_bf16 v[204:207], a[140:143], a[180:183], v[204:207]
    ds_read_b128 a[172:175], v46 offset:44032
    v_mfma_f32_16x16x32_bf16 v[212:215], a[140:143], a[184:187], v[212:215]
    v_mfma_f32_16x16x32_bf16 v[196:199], a[140:143], a[176:179], v[196:199]
    buffer_load_dwordx4 v55, s[24:27], s64 offen offset:3072 lds
    s_add_u32 m0, s58, 49152
    v_mfma_f32_16x16x32_bf16 v[224:227], a[180:183], a[144:147], v[224:227]
    s_add_u32 s64, s64, 524288
    s_cmp_eq_u32 s64, 3670016
    v_mfma_f32_16x16x32_bf16 v[232:235], a[184:187], a[144:147], v[232:235]
    s_cselect_b32 s64, 0, s64
    v_mfma_f32_16x16x32_bf16 v[216:219], a[176:179], a[144:147], v[216:219]
    buffer_load_dwordx4 v52, s[24:27], s64 offen lds
    v_mfma_f32_16x16x32_bf16 v[228:231], a[180:183], a[148:151], v[228:231]
    v_mfma_f32_16x16x32_bf16 v[236:239], a[184:187], a[148:151], v[236:239]
    v_mfma_f32_16x16x32_bf16 v[220:223], a[176:179], a[148:151], v[220:223]
    ds_read_b32 v24, v4
    s_waitcnt vmcnt(21) lgkmcnt(1)
    s_barrier
    v_mfma_f32_16x16x32_bf16 v[176:179], a[152:155], a[192:195], v[176:179]
    ds_read_b64_tr_b16 a[180:181], v67 offset:0
    buffer_load_dwordx4 v53, s[24:27], s64 offen offset:1024 lds
    v_mfma_f32_16x16x32_bf16 v[184:187], a[152:155], a[196:199], v[184:187]
    ds_read_b64_tr_b16 a[182:183], v67 offset:256
    v_mfma_f32_16x16x32_bf16 v[180:183], a[156:159], a[192:195], v[180:183]
    ds_read_b128 a[128:131], v47 offset:0
    v_mfma_f32_16x16x32_bf16 v[188:191], a[156:159], a[196:199], v[188:191]
    ds_read_b64_tr_b16 a[184:185], v67 offset:1024
    v_mfma_f32_16x16x32_bf16 v[200:203], a[160:163], a[192:195], v[200:203]
    ds_read_b64_tr_b16 a[186:187], v67 offset:1280
    buffer_load_dwordx4 v54, s[24:27], s64 offen offset:2048 lds
    v_mfma_f32_16x16x32_bf16 v[208:211], a[160:163], a[196:199], v[208:211]
    ds_read_b128 a[132:135], v47 offset:1024
    v_mfma_f32_16x16x32_bf16 v[192:195], a[160:163], a[188:191], v[192:195]
    ds_read_b128 a[136:139], v47 offset:2048
    buffer_load_dwordx4 v55, s[24:27], s64 offen offset:3072 lds
    v_mfma_f32_16x16x32_bf16 v[204:207], a[164:167], a[192:195], v[204:207]
    ds_read_b64_tr_b16 a[176:177], v68 offset:0
    s_add_u32 m0, s58, 98304
    v_mfma_f32_16x16x32_bf16 v[212:215], a[164:167], a[196:199], v[212:215]
    ds_read_b64_tr_b16 a[178:179], v68 offset:256
    s_add_u32 s64, s64, 524288
    v_mfma_f32_16x16x32_bf16 v[196:199], a[164:167], a[188:191], v[196:199]
    ds_read_b128 a[140:143], v47 offset:3072
    s_cmp_eq_u32 s64, 3670016
    v_mfma_f32_16x16x32_bf16 v[224:227], a[192:195], a[168:171], v[224:227]
    ds_read_b128 a[144:147], v47 offset:4096
    s_cselect_b32 s64, 0, s64
    v_mfma_f32_16x16x32_bf16 v[232:235], a[196:199], a[168:171], v[232:235]
    ds_read_b128 a[148:151], v47 offset:5120
    buffer_load_dwordx4 v52, s[24:27], s64 offen lds
    v_mfma_f32_16x16x32_bf16 v[216:219], a[188:191], a[168:171], v[216:219]
    v_mfma_f32_16x16x32_bf16 v[228:231], a[192:195], a[172:175], v[228:231]
    buffer_load_dwordx4 v53, s[24:27], s64 offen offset:1024 lds
    v_mfma_f32_16x16x32_bf16 v[236:239], a[196:199], a[172:175], v[236:239]
    v_mfma_f32_16x16x32_bf16 v[220:223], a[188:191], a[172:175], v[220:223]
    s_waitcnt lgkmcnt(6)
    v_mfma_f32_16x16x32_bf16 v[176:179], a[128:131], a[180:183], v[176:179]
    ds_read_b64_tr_b16 a[192:193], v67 offset:2048
    ds_read_b64_tr_b16 a[194:195], v67 offset:2304
    v_mfma_f32_16x16x32_bf16 v[184:187], a[128:131], a[184:187], v[184:187]
    ds_read_b128 a[152:155], v47 offset:6144
    ds_read_b64_tr_b16 a[196:197], v67 offset:3072
    v_mfma_f32_16x16x32_bf16 v[180:183], a[132:135], a[180:183], v[180:183]
    ds_read_b64_tr_b16 a[198:199], v67 offset:3328
    ds_read_b128 a[156:159], v47 offset:7168
    v_mfma_f32_16x16x32_bf16 v[188:191], a[132:135], a[184:187], v[188:191]
    ds_read_b128 a[160:163], v47 offset:8192
    ds_read_b64_tr_b16 a[188:189], v68 offset:2048
    s_waitcnt lgkmcnt(8)
    v_mfma_f32_16x16x32_bf16 v[200:203], a[136:139], a[180:183], v[200:203]
    ds_read_b64_tr_b16 a[190:191], v68 offset:2304
    buffer_load_dwordx4 v54, s[24:27], s64 offen offset:2048 lds
    v_mfma_f32_16x16x32_bf16 v[208:211], a[136:139], a[184:187], v[208:211]
    ds_read_b128 a[164:167], v47 offset:9216
    v_mfma_f32_16x16x32_bf16 v[192:195], a[136:139], a[176:179], v[192:195]
    ds_read_b128 a[168:171], v47 offset:10240
    buffer_load_dwordx4 v55, s[24:27], s64 offen offset:3072 lds
    v_mfma_f32_16x16x32_bf16 v[204:207], a[140:143], a[180:183], v[204:207]
    ds_read_b128 a[172:175], v47 offset:11264
    s_add_u32 m0, s58, 114688
    v_mfma_f32_16x16x32_bf16 v[212:215], a[140:143], a[184:187], v[212:215]
    s_add_u32 s64, s64, 524288
    s_cmp_eq_u32 s64, 3670016
    v_mfma_f32_16x16x32_bf16 v[196:199], a[140:143], a[176:179], v[196:199]
    s_cselect_b32 s64, 0, s64
    buffer_load_dwordx4 v52, s[24:27], s64 offen lds
    v_mfma_f32_16x16x32_bf16 v[224:227], a[180:183], a[144:147], v[224:227]
    v_mfma_f32_16x16x32_bf16 v[232:235], a[184:187], a[144:147], v[232:235]
    v_mfma_f32_16x16x32_bf16 v[216:219], a[176:179], a[144:147], v[216:219]
    buffer_load_dwordx4 v53, s[24:27], s64 offen offset:1024 lds
    v_mfma_f32_16x16x32_bf16 v[228:231], a[180:183], a[148:151], v[228:231]
    v_mfma_f32_16x16x32_bf16 v[236:239], a[184:187], a[148:151], v[236:239]
    v_mfma_f32_16x16x32_bf16 v[220:223], a[176:179], a[148:151], v[220:223]
    s_waitcnt lgkmcnt(0)
    s_cmp_eq_u32 s56, 0
    s_cbranch_scc1 L_pollok5
    s_cmp_ge_u32 s14, 7
    s_cbranch_scc1 L_pollok5
    s_mov_b32 s60, 0
L_poll5:
    s_sleep 8
    buffer_load_dword v18, off, s[28:31], s38 sc1
    s_add_u32 s60, s60, 1
    s_waitcnt vmcnt(0)
    v_readfirstlane_b32 s14, v18
    s_nop 0
    s_cmp_ge_u32 s14, 7
    s_cbranch_scc1 L_pollok5
    s_cmp_lt_u32 s60, 20000
    s_cbranch_scc1 L_poll5
L_pollok5:
    s_waitcnt vmcnt(14)
    s_barrier
    v_mfma_f32_16x16x32_bf16 v[176:179], a[152:155], a[192:195], v[176:179]
    ds_read_b64_tr_b16 a[200:201], v31 offset:16384
    buffer_load_dwordx4 a[0:3], v72, s[28:31], s65 offen offset:0 sc1
    v_mfma_f32_16x16x32_bf16 v[184:187], a[152:155], a[196:199], v[184:187]
    ds_read_b64_tr_b16 a[202:203], v31 offset:17408
    v_mfma_f32_16x16x32_bf16 v[180:183], a[156:159], a[192:195], v[180:183]
    ds_read_b64_tr_b16 a[204:205], v32 offset:16384
    buffer_load_dwordx4 a[4:7], v72, s[28:31], s65 offen offset:1024 sc1
    v_mfma_f32_16x16x32_bf16 v[188:191], a[156:159], a[196:199], v[188:191]
    ds_read_b64_tr_b16 a[206:207], v32 offset:17408
    v_mfma_f32_16x16x32_bf16 v[200:203], a[160:163], a[192:195], v[200:203]
    ds_read_b64_tr_b16 a[208:209], v31 offset:18432
    v_mfma_f32_16x16x32_bf16 v[208:211], a[160:163], a[196:199], v[208:211]
    ds_read_b64_tr_b16 a[210:211], v31 offset:19456
    v_mfma_f32_16x16x32_bf16 v[192:195], a[160:163], a[188:191], v[192:195]
    ds_read_b64_tr_b16 a[212:213], v32 offset:18432
    buffer_load_dwordx4 a[8:11], v72, s[28:31], s65 offen offset:2048 sc1
    v_mfma_f32_16x16x32_bf16 v[204:207], a[164:167], a[192:195], v[204:207]
    ds_read_b64_tr_b16 a[214:215], v32 offset:19456
    v_mfma_f32_16x16x32_bf16 v[212:215], a[164:167], a[196:199], v[212:215]
    ds_read_b64_tr_b16 a[216:217], v31 offset:20480
    v_mfma_f32_16x16x32_bf16 v[196:199], a[164:167], a[188:191], v[196:199]
    ds_read_b64_tr_b16 a[218:219], v31 offset:21504
    buffer_load_dwordx4 a[12:15], v72, s[28:31], s65 offen offset:3072 sc1
    v_mfma_f32_16x16x32_bf16 v[224:227], a[192:195], a[168:171], v[224:227]
    ds_read_b64_tr_b16 a[220:221], v32 offset:20480
    s_add_u32 s65, s65, 8192
    v_mfma_f32_16x16x32_bf16 v[232:235], a[196:199], a[168:171], v[232:235]
    ds_read_b64_tr_b16 a[222:223], v32 offset:21504
    s_cmp_eq_u32 s65, 57344
    v_mfma_f32_16x16x32_bf16 v[216:219], a[188:191], a[168:171], v[216:219]
    s_cselect_b32 s65, 0, s65
    v_mfma_f32_16x16x32_bf16 v[228:231], a[192:195], a[172:175], v[228:231]
    buffer_load_dwordx4 a[16:19], v72, s[28:31], s65 offen offset:0 sc1
    v_mfma_f32_16x16x32_bf16 v[236:239], a[196:199], a[172:175], v[236:239]
    v_mfma_f32_16x16x32_bf16 v[220:223], a[188:191], a[172:175], v[220:223]
    v_cvt_pk_bf16_f32 v112, v176, v177
    v_cvt_pk_bf16_f32 v113, v178, v179
    v_cvt_pk_bf16_f32 v114, v180, v181
    buffer_load_dwordx4 a[20:23], v72, s[28:31], s65 offen offset:1024 sc1
    v_cvt_pk_bf16_f32 v115, v182, v183
    v_cvt_pk_bf16_f32 v116, v184, v185
    v_cvt_pk_bf16_f32 v117, v186, v187
    v_cvt_pk_bf16_f32 v118, v188, v189
    v_cvt_pk_bf16_f32 v119, v190, v191
    v_cvt_pk_bf16_f32 v124, v200, v201
    v_cvt_pk_bf16_f32 v125, v202, v203
    v_cvt_pk_bf16_f32 v126, v204, v205
    v_cvt_pk_bf16_f32 v127, v206, v207
    v_cvt_pk_bf16_f32 v128, v208, v209
    v_cvt_pk_bf16_f32 v129, v210, v211
    v_cvt_pk_bf16_f32 v130, v212, v213
    v_cvt_pk_bf16_f32 v131, v214, v215
    v_cvt_pk_bf16_f32 v120, v192, v193
    buffer_load_dwordx4 a[24:27], v72, s[28:31], s65 offen offset:2048 sc1
    v_cvt_pk_bf16_f32 v121, v194, v195
    v_cvt_pk_bf16_f32 v122, v196, v197
    v_cvt_pk_bf16_f32 v123, v198, v199
    v_mfma_f32_16x16x32_bf16 v[148:151], v[124:127], v[112:115], 0
    v_mfma_f32_16x16x32_bf16 v[152:155], v[124:127], v[116:119], 0
    v_mfma_f32_16x16x32_bf16 v[156:159], v[128:131], v[116:119], 0
    buffer_load_dwordx4 a[28:31], v72, s[28:31], s65 offen offset:3072 sc1
    v_mfma_f32_16x16x32_bf16 v[144:147], v[120:123], v[112:115], 0
    v_cvt_pk_bf16_f32 v160, v216, v217
    v_cvt_pk_bf16_f32 v161, v218, v219
    v_cvt_pk_bf16_f32 v162, v224, v225
    v_cvt_pk_bf16_f32 v163, v226, v227
    v_cvt_pk_bf16_f32 v164, v232, v233
    v_cvt_pk_bf16_f32 v165, v234, v235
    v_cndmask_b32 v244, v152, v153, s[70:71]
    v_cndmask_b32 v247, v156, v157, s[70:71]
    v_cndmask_b32 v244, v244, v247, s[72:73]
    s_add_u32 s65, s65, 8192
    s_cmp_eq_u32 s65, 57344
    s_cselect_b32 s65, 0, s65
    buffer_load_dwordx4 a[32:35], v72, s[28:31], s65 offen offset:0 sc1
    v_mul_f32 v244, v244, v29
    v_cndmask_b32 v245, v154, v155, s[70:71]
    v_cndmask_b32 v247, v158, v159, s[70:71]
    v_cndmask_b32 v245, v245, v247, s[74:75]
    v_mul_f32 v245, v245, v30
    v_cndmask_b32 v240, v144, v145, s[70:71]
    v_cndmask_b32 v240, v77, v240, s[76:77]
    v_cndmask_b32 v243, v148, v149, s[70:71]
    v_cndmask_b32 v240, v240, v243, s[72:73]
    v_mul_f32 v240, v240, v27
    v_cndmask_b32 v241, v146, v147, s[70:71]
    v_cndmask_b32 v241, v77, v241, s[76:77]
    v_cndmask_b32 v243, v150, v151, s[70:71]
    v_cndmask_b32 v241, v241, v243, s[74:75]
    buffer_load_dwordx4 a[36:39], v72, s[28:31], s65 offen offset:1024 sc1
    v_mul_f32 v241, v241, v28
    v_max_f32 v242, v240, v241
    v_max_f32 v246, v244, v245
    v_mov_b32 v243, v242
    v_mov_b32 v247, v246
    v_cvt_pk_bf16_f32 v166, v220, v221
    v_permlane16_swap_b32 v242, v243
    v_permlane16_swap_b32 v246, v247
    v_max_f32 v242, v242, v243
    v_max_f32 v246, v246, v247
    v_mov_b32 v243, v242
    v_mov_b32 v247, v246
    v_cvt_pk_bf16_f32 v167, v222, v223
    v_permlane32_swap_b32 v242, v243
    buffer_load_dwordx4 a[40:43], v72, s[28:31], s65 offen offset:2048 sc1
    v_permlane32_swap_b32 v246, v247
    v_max_f32 v242, v242, v243
    v_max_f32 v246, v246, v247
    v_mul_f32 v242, v25, v242
    v_mul_f32 v246, v26, v246
    v_fma_f32 v240, v240, v25, -v242
    v_fma_f32 v241, v241, v25, -v242
    v_fma_f32 v244, v244, v26, -v246
    v_fma_f32 v245, v245, v26, -v246
    v_exp_f32 v240, v240
    v_exp_f32 v241, v241
    v_exp_f32 v244, v244
    buffer_load_dwordx4 a[44:47], v72, s[28:31], s65 offen offset:3072 sc1
    v_exp_f32 v245, v245
    v_add_f32 v242, v240, v241
    v_add_f32 v246, v244, v245
    v_mov_b32 v243, v242
    v_mov_b32 v247, v246
    v_cvt_pk_bf16_f32 v168, v228, v229
    v_permlane16_swap_b32 v242, v243
    v_permlane16_swap_b32 v246, v247
    v_add_f32 v242, v242, v243
    v_add_f32 v246, v246, v247
    v_mov_b32 v243, v242
    v_mov_b32 v247, v246
    buffer_load_dwordx4 v54, s[24:27], s64 offen offset:2048 lds
    v_cvt_pk_bf16_f32 v169, v230, v231
    v_permlane32_swap_b32 v242, v243
    v_permlane32_swap_b32 v246, v247
    v_add_f32 v242, v242, v243
    v_add_f32 v246, v246, v247
    v_rcp_f32 v242, v242
    v_rcp_f32 v246, v246
    v_cvt_pk_bf16_f32 v170, v236, v237
    v_cvt_pk_bf16_f32 v171, v238, v239
    v_mul_f32 v240, v240, v27
    v_mul_f32 v241, v241, v28
    buffer_load_dwordx4 v55, s[24:27], s64 offen offset:3072 lds
    v_mul_f32 v244, v244, v29
    v_mul_f32 v245, v245, v30
    v_mul_f32 v240, v240, v242
    v_mul_f32 v241, v241, v242
    v_mul_f32 v244, v244, v246
    v_mul_f32 v245, v245, v246
    v_cvt_pk_bf16_f32 v240, v240, v240
    v_cvt_pk_bf16_f32 v241, v241, v241
    v_cvt_pk_bf16_f32 v244, v244, v244
    v_cvt_pk_bf16_f32 v245, v245, v245
    v_and_b32 v132, v240, v98
    v_and_b32 v133, v241, v99
    v_and_b32 v134, v240, v100
    s_add_u32 m0, s58, 131072
    s_add_u32 s64, s64, 524288
    s_cmp_eq_u32 s64, 3670016
    s_cselect_b32 s64, 0, s64
    s_add_u32 s64, s64, 524288
    s_cmp_eq_u32 s64, 3670016
    s_cselect_b32 s64, 0, s64
    v_xor_b32 v52, 128, v52
    buffer_load_dwordx4 v52, s[24:27], s64 offen lds
    v_and_b32 v135, v241, v101
    v_and_b32 v136, v244, v98
    v_and_b32 v137, v245, v99
    v_and_b32 v138, v244, v100
    v_and_b32 v139, v245, v101
    v_mfma_f32_16x16x32_bf16 v[176:179], v[160:163], v[132:135], 0
    v_mfma_f32_16x16x32_bf16 v[180:183], v[166:169], v[132:135], 0
    v_xor_b32 v53, 128, v53
    buffer_load_dwordx4 v53, s[24:27], s64 offen offset:1024 lds
    v_mfma_f32_16x16x32_bf16 v[184:187], v[162:165], v[136:139], 0
    v_mfma_f32_16x16x32_bf16 v[188:191], v[168:171], v[136:139], 0
    s_add_u32 s83, s82, 16384
    s_nop 1
    v_cvt_pk_bf16_f32 v104, v176, v177
    v_cvt_pk_bf16_f32 v105, v178, v179
    v_cvt_pk_bf16_f32 v106, v180, v181
    v_cvt_pk_bf16_f32 v107, v182, v183
    v_xor_b32 v54, 128, v54
    buffer_load_dwordx4 v54, s[24:27], s64 offen offset:2048 lds
    v_cvt_pk_bf16_f32 v108, v184, v185
    v_cvt_pk_bf16_f32 v109, v186, v187
    v_cvt_pk_bf16_f32 v110, v188, v189
    v_cvt_pk_bf16_f32 v111, v190, v191
    buffer_store_dwordx4 v[104:107], v4, s[28:31], s82 offen sc1
    buffer_store_dwordx4 v[108:111], v4, s[28:31], s83 offen sc1
    s_cmp_lg_u32 s56, 0
    s_cbranch_scc1 L_f
    s_waitcnt vmcnt(0)
    s_barrier
    s_cmp_lg_u32 s48, 0
    s_cbranch_scc1 L_sig3
    s_atomic_add s36, s[28:29], s69
L_sig3:
    v_lshlrev_b32 v15, 7, v1
    s_lshl_b32 s3, s54, 2
    s_add_u32 s3, s3, s48
    s_mul_i32 s3, s3, 25088
    buffer_load_dword v176, v15, s[16:19], s3 offen
    s_add_u32 s3, s3, 5632
    buffer_load_dword v177, v15, s[16:19], s3 offen
    s_add_u32 s3, s3, 5632
    buffer_load_dword v178, v15, s[16:19], s3 offen
    s_add_u32 s3, s3, 5632
    buffer_load_dword v179, v15, s[16:19], s3 offen
    s_add_u32 s3, s3, 5632
    s_branch L_fin
L_f:
    s_waitcnt vmcnt(18) lgkmcnt(8)
    v_mfma_f32_32x32x16_bf16 v[176:191], a[0:3], a[200:203], 0
    v_xor_b32 v55, 128, v55
    buffer_load_dwordx4 v55, s[24:27], s64 offen offset:3072 lds
    ds_read_b64_tr_b16 a[224:225], v31 offset:22528
    ds_read_b64_tr_b16 a[226:227], v31 offset:23552
    v_lshlrev_b32 v88, 16, v88
    v_mfma_f32_32x32x16_bf16 v[232:247], a[0:3], a[204:207], 0
    s_add_u32 m0, s58, 147456
    s_add_u32 s64, s64, 524288
    s_cmp_eq_u32 s64, 3670016
    s_cselect_b32 s64, 0, s64
    buffer_load_dwordx4 v52, s[24:27], s64 offen lds
    ds_read_b64_tr_b16 a[228:229], v32 offset:22528
    ds_read_b64_tr_b16 a[230:231], v32 offset:23552
    v_lshlrev_b32 v216, 16, v90
    s_waitcnt vmcnt(19) lgkmcnt(8)
    v_mfma_f32_32x32x16_bf16 v[176:191], a[4:7], a[208:211], v[176:191]
    ds_read_b64_tr_b16 a[200:201], v33 offset:0
    ds_read_b64_tr_b16 a[202:203], v33 offset:1024
    v_and_b32 v217, 0xffff0000, v90
    buffer_load_dwordx4 v53, s[24:27], s64 offen offset:1024 lds
    v_mfma_f32_32x32x16_bf16 v[232:247], a[4:7], a[212:215], v[232:247]
    ds_read_b64_tr_b16 a[204:205], v34 offset:0
    ds_read_b64_tr_b16 a[206:207], v34 offset:1024
    v_add_f32 v216, v216, v88
    s_waitcnt vmcnt(19) lgkmcnt(8)
    v_mfma_f32_32x32x16_bf16 v[176:191], a[8:11], a[216:219], v[176:191]
    buffer_load_dwordx4 v54, s[24:27], s64 offen offset:2048 lds
    ds_read_b64_tr_b16 a[208:209], v33 offset:2048
    ds_read_b64_tr_b16 a[210:211], v33 offset:3072
    v_add_f32 v217, v217, v88
    v_mfma_f32_32x32x16_bf16 v[232:247], a[8:11], a[220:223], v[232:247]
    buffer_load_dwordx4 v55, s[24:27], s64 offen offset:3072 lds
    ds_read_b64_tr_b16 a[212:213], v34 offset:2048
    ds_read_b64_tr_b16 a[214:215], v34 offset:3072
    v_lshlrev_b32 v218, 16, v91
    s_waitcnt vmcnt(20) lgkmcnt(8)
    v_mfma_f32_32x32x16_bf16 v[176:191], a[12:15], a[224:227], v[176:191]
    ds_read_b64_tr_b16 a[216:217], v33 offset:4096
    ds_read_b64_tr_b16 a[218:219], v33 offset:5120
    v_and_b32 v219, 0xffff0000, v91
    v_mfma_f32_32x32x16_bf16 v[232:247], a[12:15], a[228:231], v[232:247]
    s_add_u32 s65, s65, 8192
    s_cmp_eq_u32 s65, 57344
    s_cselect_b32 s65, 0, s65
    buffer_load_dwordx4 a[48:51], v72, s[28:31], s65 offen offset:0 sc1
    ds_read_b64_tr_b16 a[220:221], v34 offset:4096
    ds_read_b64_tr_b16 a[222:223], v34 offset:5120
    v_add_f32 v218, v218, v88
    s_waitcnt vmcnt(20) lgkmcnt(8)
    v_mfma_f32_32x32x16_bf16 v[176:191], a[16:19], a[200:203], v[176:191]
    buffer_load_dwordx4 a[52:55], v72, s[28:31], s65 offen offset:1024 sc1
    ds_read_b64_tr_b16 a[224:225], v33 offset:6144
    ds_read_b64_tr_b16 a[226:227], v33 offset:7168
    v_add_f32 v219, v219, v88
    v_mfma_f32_32x32x16_bf16 v[232:247], a[16:19], a[204:207], v[232:247]
    ds_read_b64_tr_b16 a[228:229], v34 offset:6144
    ds_read_b64_tr_b16 a[230:231], v34 offset:7168
    v_lshlrev_b32 v220, 16, v92
    s_waitcnt vmcnt(20) lgkmcnt(8)
    v_mfma_f32_32x32x16_bf16 v[176:191], a[20:23], a[208:211], v[176:191]
    buffer_load_dwordx4 a[56:59], v72, s[28:31], s65 offen offset:2048 sc1
    ds_read_b64_tr_b16 a[200:201], v33 offset:16384
    ds_read_b64_tr_b16 a[202:203], v33 offset:17408
    v_and_b32 v221, 0xffff0000, v92
    v_mfma_f32_32x32x16_bf16 v[232:247], a[20:23], a[212:215], v[232:247]
    ds_read_b64_tr_b16 a[204:205], v34 offset:16384
    ds_read_b64_tr_b16 a[206:207], v34 offset:17408
    v_add_f32 v220, v220, v88
    buffer_load_dwordx4 a[60:63], v72, s[28:31], s65 offen offset:3072 sc1
    s_waitcnt vmcnt(21) lgkmcnt(8)
    v_mfma_f32_32x32x16_bf16 v[176:191], a[24:27], a[216:219], v[176:191]
    ds_read_b64_tr_b16 a[208:209], v33 offset:18432
    ds_read_b64_tr_b16 a[210:211], v33 offset:19456
    v_add_f32 v221, v221, v88
    v_mfma_f32_32x32x16_bf16 v[232:247], a[24:27], a[220:223], v[232:247]
    s_add_u32 s65, s65, 8192
    s_cmp_eq_u32 s65, 57344
    s_cselect_b32 s65, 0, s65
    buffer_load_dwordx4 a[64:67], v72, s[28:31], s65 offen offset:0 sc1
    ds_read_b64_tr_b16 a[212:213], v34 offset:18432
    ds_read_b64_tr_b16 a[214:215], v34 offset:19456
    v_lshlrev_b32 v222, 16, v93
    s_waitcnt vmcnt(21) lgkmcnt(8)
    v_mfma_f32_32x32x16_bf16 v[176:191], a[28:31], a[224:227], v[176:191]
    ds_read_b64_tr_b16 a[216:217], v33 offset:20480
    ds_read_b64_tr_b16 a[218:219], v33 offset:21504
    v_and_b32 v223, 0xffff0000, v93
    v_mfma_f32_32x32x16_bf16 v[232:247], a[28:31], a[228:231], v[232:247]
    buffer_load_dwordx4 a[68:71], v72, s[28:31], s65 offen offset:1024 sc1
    ds_read_b64_tr_b16 a[220:221], v34 offset:20480
    ds_read_b64_tr_b16 a[222:223], v34 offset:21504
    v_add_f32 v222, v222, v88
    s_waitcnt vmcnt(21) lgkmcnt(8)
    v_mfma_f32_32x32x16_bf16 v[176:191], a[32:35], a[200:203], v[176:191]
    buffer_load_dwordx4 a[72:75], v72, s[28:31], s65 offen offset:2048 sc1
    ds_read_b64_tr_b16 a[224:225], v33 offset:22528
    ds_read_b64_tr_b16 a[226:227], v33 offset:23552
    v_add_f32 v223, v223, v88
    v_mfma_f32_32x32x16_bf16 v[232:247], a[32:35], a[204:207], v[232:247]
    ds_read_b64_tr_b16 a[228:229], v34 offset:22528
    ds_read_b64_tr_b16 a[230:231], v34 offset:23552
    v_lshlrev_b32 v89, 16, v89
    s_waitcnt vmcnt(21) lgkmcnt(8)
    v_mfma_f32_32x32x16_bf16 v[176:191], a[36:39], a[208:211], v[176:191]
    buffer_load_dwordx4 a[76:79], v72, s[28:31], s65 offen offset:3072 sc1
    s_waitcnt vmcnt(8)
    s_barrier
    s_cmp_lg_u32 s48, 0
    s_cbranch_scc1 L_sig4
    s_atomic_add s36, s[28:29], s69
L_sig4:
    ds_read_b64_tr_b16 a[200:201], v31 offset:32768
    ds_read_b64_tr_b16 a[202:203], v31 offset:33792
    v_lshlrev_b32 v224, 16, v94
    v_mfma_f32_32x32x16_bf16 v[232:247], a[36:39], a[212:215], v[232:247]
    s_add_u32 s65, s65, 8192
    s_cmp_eq_u32 s65, 57344
    s_cselect_b32 s65, 0, s65
    buffer_load_dwordx4 a[80:83], v72, s[28:31], s65 offen offset:0 sc1
    ds_read_b64_tr_b16 a[204:205], v32 offset:32768
    ds_read_b64_tr_b16 a[206:207], v32 offset:33792
    v_and_b32 v225, 0xffff0000, v94
    s_waitcnt lgkmcnt(8)
    v_mfma_f32_32x32x16_bf16 v[176:191], a[40:43], a[216:219], v[176:191]
    buffer_load_dwordx4 a[84:87], v72, s[28:31], s65 offen offset:1024 sc1
    ds_read_b64_tr_b16 a[208:209], v31 offset:34816
    ds_read_b64_tr_b16 a[210:211], v31 offset:35840
    v_add_f32 v224, v224, v89
    v_mfma_f32_32x32x16_bf16 v[232:247], a[40:43], a[220:223], v[232:247]
    ds_read_b64_tr_b16 a[212:213], v32 offset:34816
    ds_read_b64_tr_b16 a[214:215], v32 offset:35840
    v_add_f32 v225, v225, v89
    s_waitcnt lgkmcnt(8)
    v_mfma_f32_32x32x16_bf16 v[176:191], a[44:47], a[224:227], v[176:191]
    buffer_load_dwordx4 a[88:91], v72, s[28:31], s65 offen offset:2048 sc1
    ds_read_b64_tr_b16 a[216:217], v31 offset:36864
    ds_read_b64_tr_b16 a[218:219], v31 offset:37888
    v_lshlrev_b32 v226, 16, v95
    v_mfma_f32_32x32x16_bf16 v[232:247], a[44:47], a[228:231], v[232:247]
    ds_read_b64_tr_b16 a[220:221], v32 offset:36864
    ds_read_b64_tr_b16 a[222:223], v32 offset:37888
    v_and_b32 v227, 0xffff0000, v95
    buffer_load_dwordx4 a[92:95], v72, s[28:31], s65 offen offset:3072 sc1
    s_waitcnt vmcnt(11) lgkmcnt(8)
    v_mfma_f32_32x32x16_bf16 v[176:191], a[48:51], a[200:203], v[176:191]
    ds_read_b64_tr_b16 a[224:225], v31 offset:38912
    ds_read_b64_tr_b16 a[226:227], v31 offset:39936
    v_add_f32 v226, v226, v89
    v_mfma_f32_32x32x16_bf16 v[232:247], a[48:51], a[204:207], v[232:247]
    s_add_u32 s65, s65, 8192
    s_cmp_eq_u32 s65, 57344
    s_cselect_b32 s65, 0, s65
    buffer_load_dwordx4 a[96:99], v72, s[28:31], s65 offen offset:0 sc1
    ds_read_b64_tr_b16 a[228:229], v32 offset:38912
    ds_read_b64_tr_b16 a[230:231], v32 offset:39936
    v_add_f32 v227, v227, v89
    s_waitcnt vmcnt(11) lgkmcnt(8)
    v_mfma_f32_32x32x16_bf16 v[176:191], a[52:55], a[208:211], v[176:191]
    ds_read_b64_tr_b16 a[200:201], v31 offset:49152
    ds_read_b64_tr_b16 a[202:203], v31 offset:50176
    v_lshlrev_b32 v228, 16, v96
    v_mfma_f32_32x32x16_bf16 v[232:247], a[52:55], a[212:215], v[232:247]
    buffer_load_dwordx4 a[100:103], v72, s[28:31], s65 offen offset:1024 sc1
    ds_read_b64_tr_b16 a[204:205], v32 offset:49152
    ds_read_b64_tr_b16 a[206:207], v32 offset:50176
    v_and_b32 v229, 0xffff0000, v96
    s_waitcnt vmcnt(11) lgkmcnt(8)
    v_mfma_f32_32x32x16_bf16 v[176:191], a[56:59], a[216:219], v[176:191]
    buffer_load_dwordx4 a[104:107], v72, s[28:31], s65 offen offset:2048 sc1
    ds_read_b64_tr_b16 a[208:209], v31 offset:51200
    ds_read_b64_tr_b16 a[210:211], v31 offset:52224
    v_add_f32 v228, v228, v89
    v_mfma_f32_32x32x16_bf16 v[232:247], a[56:59], a[220:223], v[232:247]
    ds_read_b64_tr_b16 a[212:213], v32 offset:51200
    ds_read_b64_tr_b16 a[214:215], v32 offset:52224
    v_add_f32 v229, v229, v89
    s_waitcnt vmcnt(11) lgkmcnt(8)
    v_mfma_f32_32x32x16_bf16 v[176:191], a[60:63], a[224:227], v[176:191]
    buffer_load_dwordx4 a[108:111], v72, s[28:31], s65 offen offset:3072 sc1
    ds_read_b64_tr_b16 a[216:217], v31 offset:53248
    ds_read_b64_tr_b16 a[218:219], v31 offset:54272
    v_lshlrev_b32 v230, 16, v97
    v_mfma_f32_32x32x16_bf16 v[232:247], a[60:63], a[228:231], v[232:247]
    s_add_u32 m0, s58, 16384
    s_add_u32 s64, s64, 524288
    s_cmp_eq_u32 s64, 3670016
    s_cselect_b32 s64, 0, s64
    buffer_load_dwordx4 v52, s[24:27], s64 offen lds
    ds_read_b64_tr_b16 a[220:221], v32 offset:53248
    ds_read_b64_tr_b16 a[222:223], v32 offset:54272
    v_and_b32 v231, 0xffff0000, v97
    s_waitcnt vmcnt(12) lgkmcnt(8)
    v_mfma_f32_32x32x16_bf16 v[176:191], a[64:67], a[200:203], v[176:191]
    ds_read_b64_tr_b16 a[224:225], v31 offset:55296
    ds_read_b64_tr_b16 a[226:227], v31 offset:56320
    v_add_f32 v230, v230, v89
    v_mfma_f32_32x32x16_bf16 v[232:247], a[64:67], a[204:207], v[232:247]
    buffer_load_dwordx4 v53, s[24:27], s64 offen offset:1024 lds
    ds_read_b64_tr_b16 a[228:229], v32 offset:55296
    ds_read_b64_tr_b16 a[230:231], v32 offset:56320
    v_add_f32 v231, v231, v89
    s_waitcnt vmcnt(12) lgkmcnt(8)
    v_mfma_f32_32x32x16_bf16 v[176:191], a[68:71], a[208:211], v[176:191]
    buffer_load_dwordx4 v54, s[24:27], s64 offen offset:2048 lds
    s_barrier
    ds_read_b64_tr_b16 a[200:201], v33 offset:32768
    ds_read_b64_tr_b16 a[202:203], v33 offset:33792
    v_mfma_f32_32x32x16_bf16 v[232:247], a[68:71], a[212:215], v[232:247]
    ds_read_b64_tr_b16 a[204:205], v34 offset:32768
    ds_read_b64_tr_b16 a[206:207], v34 offset:33792
    s_waitcnt vmcnt(12) lgkmcnt(8)
    v_mfma_f32_32x32x16_bf16 v[176:191], a[72:75], a[216:219], v[176:191]
    buffer_load_dwordx4 v55, s[24:27], s64 offen offset:3072 lds
    ds_read_b64_tr_b16 a[208:209], v33 offset:34816
    ds_read_b64_tr_b16 a[210:211], v33 offset:35840
    v_mfma_f32_32x32x16_bf16 v[232:247], a[72:75], a[220:223], v[232:247]
    ds_read_b64_tr_b16 a[212:213], v34 offset:34816
    ds_read_b64_tr_b16 a[214:215], v34 offset:35840
    s_waitcnt vmcnt(12) lgkmcnt(8)
    v_mfma_f32_32x32x16_bf16 v[176:191], a[76:79], a[224:227], v[176:191]
    s_add_u32 m0, s58, 65536
    s_add_u32 s64, s64, 524288
    s_cmp_eq_u32 s64, 3670016
    s_cselect_b32 s64, 0, s64
    buffer_load_dwordx4 v52, s[24:27], s64 offen lds
    ds_read_b64_tr_b16 a[216:217], v33 offset:36864
    ds_read_b64_tr_b16 a[218:219], v33 offset:37888
    v_mfma_f32_32x32x16_bf16 v[232:247], a[76:79], a[228:231], v[232:247]
    ds_read_b64_tr_b16 a[220:221], v34 offset:36864
    ds_read_b64_tr_b16 a[222:223], v34 offset:37888
    s_waitcnt vmcnt(12) lgkmcnt(8)
    v_mfma_f32_32x32x16_bf16 v[176:191], a[80:83], a[200:203], v[176:191]
    buffer_load_dwordx4 v53, s[24:27], s64 offen offset:1024 lds
    ds_read_b64_tr_b16 a[224:225], v33 offset:38912
    ds_read_b64_tr_b16 a[226:227], v33 offset:39936
    v_mfma_f32_32x32x16_bf16 v[232:247], a[80:83], a[204:207], v[232:247]
    buffer_load_dwordx4 v54, s[24:27], s64 offen offset:2048 lds
    ds_read_b64_tr_b16 a[228:229], v34 offset:38912
    ds_read_b64_tr_b16 a[230:231], v34 offset:39936
    s_waitcnt vmcnt(13) lgkmcnt(8)
    v_mfma_f32_32x32x16_bf16 v[176:191], a[84:87], a[208:211], v[176:191]
    ds_read_b64_tr_b16 a[200:201], v33 offset:49152
    ds_read_b64_tr_b16 a[202:203], v33 offset:50176
    v_mfma_f32_32x32x16_bf16 v[232:247], a[84:87], a[212:215], v[232:247]
    buffer_load_dwordx4 v55, s[24:27], s64 offen offset:3072 lds
    ds_read_b64_tr_b16 a[204:205], v34 offset:49152
    ds_read_b64_tr_b16 a[206:207], v34 offset:50176
    s_waitcnt vmcnt(13) lgkmcnt(8)
    v_mfma_f32_32x32x16_bf16 v[176:191], a[88:91], a[216:219], v[176:191]
    ds_read_b64_tr_b16 a[208:209], v33 offset:51200
    ds_read_b64_tr_b16 a[210:211], v33 offset:52224
    v_mfma_f32_32x32x16_bf16 v[232:247], a[88:91], a[220:223], v[232:247]
    s_add_u32 m0, s58, 81920
    s_add_u32 s64, s64, 524288
    s_cmp_eq_u32 s64, 3670016
    s_cselect_b32 s64, 0, s64
    buffer_load_dwordx4 v52, s[24:27], s64 offen lds
    ds_read_b64_tr_b16 a[212:213], v34 offset:51200
    ds_read_b64_tr_b16 a[214:215], v34 offset:52224
    s_waitcnt vmcnt(13) lgkmcnt(8)
    v_mfma_f32_32x32x16_bf16 v[176:191], a[92:95], a[224:227], v[176:191]
    ds_read_b64_tr_b16 a[216:217], v33 offset:53248
    ds_read_b64_tr_b16 a[218:219], v33 offset:54272
    v_mfma_f32_32x32x16_bf16 v[232:247], a[92:95], a[228:231], v[232:247]
    buffer_load_dwordx4 v53, s[24:27], s64 offen offset:1024 lds
    ds_read_b64_tr_b16 a[220:221], v34 offset:53248
    ds_read_b64_tr_b16 a[222:223], v34 offset:54272
    s_waitcnt vmcnt(13) lgkmcnt(8)
    v_mfma_f32_32x32x16_bf16 v[176:191], a[96:99], a[200:203], v[176:191]
    buffer_load_dwordx4 v54, s[24:27], s64 offen offset:2048 lds
    ds_read_b64_tr_b16 a[224:225], v33 offset:55296
    ds_read_b64_tr_b16 a[226:227], v33 offset:56320
    v_mfma_f32_32x32x16_bf16 v[232:247], a[96:99], a[204:207], v[232:247]
    ds_read_b64_tr_b16 a[228:229], v34 offset:55296
    ds_read_b64_tr_b16 a[230:231], v34 offset:56320
    s_waitcnt vmcnt(13) lgkmcnt(8)
    v_mfma_f32_32x32x16_bf16 v[176:191], a[100:103], a[208:211], v[176:191]
    buffer_load_dwordx4 v55, s[24:27], s64 offen offset:3072 lds
    s_barrier
    ds_read_b64_tr_b16 a[200:201], v31 offset:0
    ds_read_b64_tr_b16 a[202:203], v31 offset:1024
    v_mfma_f32_32x32x16_bf16 v[232:247], a[100:103], a[212:215], v[232:247]
    ds_read_b64_tr_b16 a[204:205], v32 offset:0
    ds_read_b64_tr_b16 a[206:207], v32 offset:1024
    s_waitcnt vmcnt(13) lgkmcnt(8)
    v_mfma_f32_32x32x16_bf16 v[176:191], a[104:107], a[216:219], v[176:191]
    s_add_u32 m0, s58, 32768
    s_add_u32 s64, s64, 524288
    s_cmp_eq_u32 s64, 3670016
    s_cselect_b32 s64, 0, s64
    buffer_load_dwordx4 v52, s[24:27], s64 offen lds
    ds_read_b64_tr_b16 a[208:209], v31 offset:2048
    ds_read_b64_tr_b16 a[210:211], v31 offset:3072
    v_mfma_f32_32x32x16_bf16 v[232:247], a[104:107], a[220:223], v[232:247]
    buffer_load_dwordx4 v53, s[24:27], s64 offen offset:1024 lds
    ds_read_b64_tr_b16 a[212:213], v32 offset:2048
    ds_read_b64_tr_b16 a[214:215], v32 offset:3072
    s_waitcnt vmcnt(14) lgkmcnt(8)
    v_mfma_f32_32x32x16_bf16 v[176:191], a[108:111], a[224:227], v[176:191]
    ds_read_b64_tr_b16 a[216:217], v31 offset:4096
    ds_read_b64_tr_b16 a[218:219], v31 offset:5120
    v_mfma_f32_32x32x16_bf16 v[232:247], a[108:111], a[228:231], v[232:247]
    buffer_load_dwordx4 v54, s[24:27], s64 offen offset:2048 lds
    ds_read_b64_tr_b16 a[220:221], v32 offset:4096
    ds_read_b64_tr_b16 a[222:223], v32 offset:5120
    s_waitcnt lgkmcnt(8)
    v_mfma_f32_32x32x16_bf16 v[144:159], a[0:3], a[200:203], 0
    ds_read_b64_tr_b16 a[224:225], v31 offset:6144
    ds_read_b64_tr_b16 a[226:227], v31 offset:7168
    v_mfma_f32_32x32x16_bf16 v[160:175], a[0:3], a[204:207], 0
    buffer_load_dwordx4 v55, s[24:27], s64 offen offset:3072 lds
    ds_read_b64_tr_b16 a[228:229], v32 offset:6144
    ds_read_b64_tr_b16 a[230:231], v32 offset:7168
    v_cvt_pk_bf16_f32 v176, v176, v177
    v_cvt_pk_bf16_f32 v177, v178, v179
    v_cvt_pk_bf16_f32 v178, v180, v181
    v_cvt_pk_bf16_f32 v179, v182, v183
    buffer_store_dwordx4 v[176:179], v21, s[28:31], 0 offen offset:0 sc1
    s_waitcnt lgkmcnt(8)
    v_mfma_f32_32x32x16_bf16 v[144:159], a[4:7], a[208:211], v[144:159]
    s_add_u32 m0, s58, 49152
    s_add_u32 s66, s66, 1
    s_and_b32 s66, s66, 3
    s_mul_i32 s61, s66, 100352
    buffer_load_dwordx4 v56, s[16:19], s61 offen lds
    s_load_dword s14, s[28:29], s39
    ds_read_b64_tr_b16 a[200:201], v35 offset:0
    ds_read_b64_tr_b16 a[202:203], v35 offset:1024
    v_cvt_pk_bf16_f32 v184, v184, v185
    v_cvt_pk_bf16_f32 v185, v186, v187
    v_cvt_pk_bf16_f32 v186, v188, v189
    v_cvt_pk_bf16_f32 v187, v190, v191
    buffer_store_dwordx4 v[184:187], v21, s[28:31], 0 offen offset:1024 sc1
    v_mfma_f32_32x32x16_bf16 v[160:175], a[4:7], a[212:215], v[160:175]
    buffer_load_dwordx4 v57, s[16:19], s61 offen offset:1024 lds
    ds_read_b64_tr_b16 a[204:205], v36 offset:0
    ds_read_b64_tr_b16 a[206:207], v36 offset:1024
    v_cvt_pk_bf16_f32 v232, v232, v233
    v_cvt_pk_bf16_f32 v233, v234, v235
    v_cvt_pk_bf16_f32 v234, v236, v237
    v_cvt_pk_bf16_f32 v235, v238, v239
    buffer_store_dwordx4 v[232:235], v21, s[28:31], 0 offen offset:2048 sc1
    s_waitcnt lgkmcnt(8)
    v_mfma_f32_32x32x16_bf16 v[144:159], a[8:11], a[216:219], v[144:159]
    s_add_u32 s61, s61, 48128
    buffer_load_dwordx4 v56, s[16:19], s61 offen offset:2048 lds
    ds_read_b64_tr_b16 a[208:209], v35 offset:2048
    ds_read_b64_tr_b16 a[210:211], v35 offset:3072
    v_cvt_pk_bf16_f32 v240, v240, v241
    v_cvt_pk_bf16_f32 v241, v242, v243
    v_cvt_pk_bf16_f32 v242, v244, v245
    v_cvt_pk_bf16_f32 v243, v246, v247
    buffer_store_dwordx4 v[240:243], v21, s[28:31], 0 offen offset:3072 sc1
    v_mfma_f32_32x32x16_bf16 v[160:175], a[8:11], a[220:223], v[160:175]
    buffer_load_dwordx4 v57, s[16:19], s61 offen offset:3072 lds
    ds_read_b64_tr_b16 a[212:213], v36 offset:2048
    ds_read_b64_tr_b16 a[214:215], v36 offset:3072
    s_waitcnt lgkmcnt(8)
    v_mfma_f32_32x32x16_bf16 v[144:159], a[12:15], a[224:227], v[144:159]
    s_add_u32 m0, s58, 98304
    s_add_u32 s66, s66, 1
    s_and_b32 s66, s66, 3
    s_mul_i32 s61, s66, 100352
    buffer_load_dwordx4 v56, s[16:19], s61 offen lds
    ds_read_b64_tr_b16 a[216:217], v35 offset:4096
    ds_read_b64_tr_b16 a[218:219], v35 offset:5120
    v_mfma_f32_32x32x16_bf16 v[160:175], a[12:15], a[228:231], v[160:175]
    ds_read_b64_tr_b16 a[220:221], v36 offset:4096
    ds_read_b64_tr_b16 a[222:223], v36 offset:5120
    s_waitcnt lgkmcnt(8)
    v_mfma_f32_32x32x16_bf16 v[144:159], a[16:19], a[200:203], v[144:159]
    buffer_load_dwordx4 v57, s[16:19], s61 offen offset:1024 lds
    ds_read_b64_tr_b16 a[224:225], v35 offset:6144
    ds_read_b64_tr_b16 a[226:227], v35 offset:7168
    v_mfma_f32_32x32x16_bf16 v[160:175], a[16:19], a[204:207], v[160:175]
    ds_read_b64_tr_b16 a[228:229], v36 offset:6144
    ds_read_b64_tr_b16 a[230:231], v36 offset:7168
    s_waitcnt lgkmcnt(8)
    v_mfma_f32_32x32x16_bf16 v[144:159], a[20:23], a[208:211], v[144:159]
    s_add_u32 s61, s61, 48128
    buffer_load_dwordx4 v56, s[16:19], s61 offen offset:2048 lds
    s_waitcnt vmcnt(11)
    s_barrier
    ds_read_b64_tr_b16 a[200:201], v35 offset:16384
    ds_read_b64_tr_b16 a[202:203], v35 offset:17408
    v_mfma_f32_32x32x16_bf16 v[160:175], a[20:23], a[212:215], v[160:175]
    buffer_load_dwordx4 v57, s[16:19], s61 offen offset:3072 lds
    ds_read_b64_tr_b16 a[204:205], v36 offset:16384
    ds_read_b64_tr_b16 a[206:207], v36 offset:17408
    s_waitcnt lgkmcnt(8)
    v_mfma_f32_32x32x16_bf16 v[144:159], a[24:27], a[216:219], v[144:159]
    ds_read_b64_tr_b16 a[208:209], v35 offset:18432
    ds_read_b64_tr_b16 a[210:211], v35 offset:19456
    v_mfma_f32_32x32x16_bf16 v[160:175], a[24:27], a[220:223], v[160:175]
    s_add_u32 m0, s58, 114688
    s_add_u32 s66, s66, 1
    s_and_b32 s66, s66, 3
    s_mul_i32 s61, s66, 100352
    buffer_load_dwordx4 v56, s[16:19], s61 offen lds
    ds_read_b64_tr_b16 a[212:213], v36 offset:18432
    ds_read_b64_tr_b16 a[214:215], v36 offset:19456
    s_waitcnt lgkmcnt(8)
    v_mfma_f32_32x32x16_bf16 v[144:159], a[28:31], a[224:227], v[144:159]
    ds_read_b64_tr_b16 a[216:217], v35 offset:20480
    ds_read_b64_tr_b16 a[218:219], v35 offset:21504
    v_mfma_f32_32x32x16_bf16 v[160:175], a[28:31], a[228:231], v[160:175]
    buffer_load_dwordx4 v57, s[16:19], s61 offen offset:1024 lds
    ds_read_b64_tr_b16 a[220:221], v36 offset:20480
    ds_read_b64_tr_b16 a[222:223], v36 offset:21504
    s_waitcnt lgkmcnt(8)
    v_mfma_f32_32x32x16_bf16 v[144:159], a[32:35], a[200:203], v[144:159]
    ds_read_b64_tr_b16 a[224:225], v35 offset:22528
    ds_read_b64_tr_b16 a[226:227], v35 offset:23552
    v_mfma_f32_32x32x16_bf16 v[160:175], a[32:35], a[204:207], v[160:175]
    s_add_u32 s61, s61, 48128
    buffer_load_dwordx4 v56, s[16:19], s61 offen offset:2048 lds
    ds_read_b64_tr_b16 a[228:229], v36 offset:22528
    ds_read_b64_tr_b16 a[230:231], v36 offset:23552
    s_waitcnt lgkmcnt(8)
    v_mfma_f32_32x32x16_bf16 v[144:159], a[36:39], a[208:211], v[144:159]
    buffer_load_dwordx4 v57, s[16:19], s61 offen offset:3072 lds
    ds_read_b64_tr_b16 a[200:201], v31 offset:16384
    ds_read_b64_tr_b16 a[202:203], v31 offset:17408
    v_mfma_f32_32x32x16_bf16 v[160:175], a[36:39], a[212:215], v[160:175]
    ds_read_b64_tr_b16 a[204:205], v32 offset:16384
    ds_read_b64_tr_b16 a[206:207], v32 offset:17408
    s_waitcnt lgkmcnt(8)
    v_mfma_f32_32x32x16_bf16 v[144:159], a[40:43], a[216:219], v[144:159]
    s_add_u32 m0, s58, 0
    s_add_u32 s66, s66, 1
    s_and_b32 s66, s66, 3
    s_mul_i32 s61, s66, 100352
    buffer_load_dwordx4 v56, s[16:19], s61 offen lds
    ds_read_b64_tr_b16 a[208:209], v31 offset:18432
    ds_read_b64_tr_b16 a[210:211], v31 offset:19456
    v_mfma_f32_32x32x16_bf16 v[160:175], a[40:43], a[220:223], v[160:175]
    ds_read_b64_tr_b16 a[212:213], v32 offset:18432
    ds_read_b64_tr_b16 a[214:215], v32 offset:19456
    s_waitcnt lgkmcnt(8)
    v_mfma_f32_32x32x16_bf16 v[144:159], a[44:47], a[224:227], v[144:159]
    buffer_load_dwordx4 v57, s[16:19], s61 offen offset:1024 lds
    v_mfma_f32_32x32x16_bf16 v[160:175], a[44:47], a[228:231], v[160:175]
    s_waitcnt lgkmcnt(4)
    v_mfma_f32_32x32x16_bf16 v[144:159], a[48:51], a[200:203], v[144:159]
    s_add_u32 s61, s61, 48128
    buffer_load_dwordx4 v56, s[16:19], s61 offen offset:2048 lds
    s_waitcnt lgkmcnt(0)
    s_cmp_ge_u32 s14, 8
    s_cbranch_scc1 L_pollok6
    s_mov_b32 s60, 0
L_poll6:
    s_sleep 8
    buffer_load_dword v18, off, s[28:31], s39 sc1
    s_add_u32 s60, s60, 1
    s_waitcnt vmcnt(0)
    v_readfirstlane_b32 s14, v18
    s_nop 0
    s_cmp_ge_u32 s14, 8
    s_cbranch_scc1 L_pollok6
    s_cmp_lt_u32 s60, 20000
    s_cbranch_scc1 L_poll6
L_pollok6:
    ds_read_b64_tr_b16 a[216:217], v31 offset:20480
    ds_read_b64_tr_b16 a[218:219], v31 offset:21504
    ds_read_b64_tr_b16 a[220:221], v32 offset:20480
    ds_read_b64_tr_b16 a[222:223], v32 offset:21504
    v_mfma_f32_32x32x16_bf16 v[160:175], a[48:51], a[204:207], v[160:175]
    buffer_load_dwordx4 v57, s[16:19], s61 offen offset:3072 lds
    ds_read_b64_tr_b16 a[224:225], v31 offset:22528
    ds_read_b64_tr_b16 a[226:227], v31 offset:23552
    ds_read_b64_tr_b16 a[228:229], v32 offset:22528
    ds_read_b64_tr_b16 a[230:231], v32 offset:23552
    v_mfma_f32_32x32x16_bf16 v[144:159], a[52:55], a[208:211], v[144:159]
    s_barrier
    s_waitcnt vmcnt(13)
    s_atomic_add s36, s[28:29], s55
    ds_read_b64_tr_b16 a[200:201], v33 offset:0
    ds_read_b64_tr_b16 a[202:203], v33 offset:1024
    v_mfma_f32_32x32x16_bf16 v[160:175], a[52:55], a[212:215], v[160:175]
    s_add_u32 m0, s58, 131072
    s_add_u32 s66, s66, 1
    s_and_b32 s66, s66, 3
    s_lshl_b32 s61, s66, 12
    buffer_load_dwordx4 v58, s[28:31], s61 offen sc1 lds
    ds_read_b64_tr_b16 a[204:205], v34 offset:0
    ds_read_b64_tr_b16 a[206:207], v34 offset:1024
    s_waitcnt lgkmcnt(8)
    v_mfma_f32_32x32x16_bf16 v[144:159], a[56:59], a[216:219], v[144:159]
    buffer_load_dwordx4 v59, s[28:31], s61 offen offset:1024 sc1 lds
    ds_read_b64_tr_b16 a[208:209], v33 offset:2048
    ds_read_b64_tr_b16 a[210:211], v33 offset:3072
    v_mfma_f32_32x32x16_bf16 v[160:175], a[56:59], a[220:223], v[160:175]
    ds_read_b64_tr_b16 a[212:213], v34 offset:2048
    ds_read_b64_tr_b16 a[214:215], v34 offset:3072
    s_waitcnt lgkmcnt(8)
    v_mfma_f32_32x32x16_bf16 v[144:159], a[60:63], a[224:227], v[144:159]
    buffer_load_dwordx4 v58, s[28:31], s61 offen offset:2048 sc1 lds
    ds_read_b64_tr_b16 a[216:217], v33 offset:4096
    ds_read_b64_tr_b16 a[218:219], v33 offset:5120
    v_mfma_f32_32x32x16_bf16 v[160:175], a[60:63], a[228:231], v[160:175]
    buffer_load_dwordx4 v59, s[28:31], s61 offen offset:3072 sc1 lds
    ds_read_b64_tr_b16 a[220:221], v34 offset:4096
    ds_read_b64_tr_b16 a[222:223], v34 offset:5120
    s_waitcnt lgkmcnt(8)
    v_mfma_f32_32x32x16_bf16 v[144:159], a[64:67], a[200:203], v[144:159]
    ds_read_b64_tr_b16 a[224:225], v33 offset:6144
    ds_read_b64_tr_b16 a[226:227], v33 offset:7168
    v_mfma_f32_32x32x16_bf16 v[160:175], a[64:67], a[204:207], v[160:175]
    s_add_u32 m0, s58, 147456
    s_add_u32 s66, s66, 1
    s_and_b32 s66, s66, 3
    s_lshl_b32 s61, s66, 12
    buffer_load_dwordx4 v58, s[28:31], s61 offen sc1 lds
    ds_read_b64_tr_b16 a[228:229], v34 offset:6144
    ds_read_b64_tr_b16 a[230:231], v34 offset:7168
    s_waitcnt lgkmcnt(8)
    v_mfma_f32_32x32x16_bf16 v[144:159], a[68:71], a[208:211], v[144:159]
    buffer_load_dwordx4 v59, s[28:31], s61 offen offset:1024 sc1 lds
    ds_read_b64_tr_b16 a[200:201], v33 offset:16384
    ds_read_b64_tr_b16 a[202:203], v33 offset:17408
    v_mfma_f32_32x32x16_bf16 v[160:175], a[68:71], a[212:215], v[160:175]
    ds_read_b64_tr_b16 a[204:205], v34 offset:16384
    ds_read_b64_tr_b16 a[206:207], v34 offset:17408
    s_waitcnt lgkmcnt(8)
    v_mfma_f32_32x32x16_bf16 v[144:159], a[72:75], a[216:219], v[144:159]
    buffer_load_dwordx4 v58, s[28:31], s61 offen offset:2048 sc1 lds
    ds_read_b64_tr_b16 a[208:209], v33 offset:18432
    ds_read_b64_tr_b16 a[210:211], v33 offset:19456
    v_mfma_f32_32x32x16_bf16 v[160:175], a[72:75], a[220:223], v[160:175]
    buffer_load_dwordx4 v59, s[28:31], s61 offen offset:3072 sc1 lds
    ds_read_b64_tr_b16 a[212:213], v34 offset:18432
    ds_read_b64_tr_b16 a[214:215], v34 offset:19456
    s_waitcnt lgkmcnt(8)
    v_mfma_f32_32x32x16_bf16 v[144:159], a[76:79], a[224:227], v[144:159]
    ds_read_b64_tr_b16 a[216:217], v33 offset:20480
    ds_read_b64_tr_b16 a[218:219], v33 offset:21504
    v_mfma_f32_32x32x16_bf16 v[160:175], a[76:79], a[228:231], v[160:175]
    ds_read_b64_tr_b16 a[220:221], v34 offset:20480
    ds_read_b64_tr_b16 a[222:223], v34 offset:21504
    s_waitcnt lgkmcnt(8)
    v_mfma_f32_32x32x16_bf16 v[144:159], a[80:83], a[200:203], v[144:159]
    ds_read_b64_tr_b16 a[224:225], v33 offset:22528
    ds_read_b64_tr_b16 a[226:227], v33 offset:23552
    v_mfma_f32_32x32x16_bf16 v[160:175], a[80:83], a[204:207], v[160:175]
    ds_read_b64_tr_b16 a[228:229], v34 offset:22528
    ds_read_b64_tr_b16 a[230:231], v34 offset:23552
    s_waitcnt lgkmcnt(8)
    v_mfma_f32_32x32x16_bf16 v[144:159], a[84:87], a[208:211], v[144:159]
    s_barrier
    ds_read_b64_tr_b16 a[200:201], v31 offset:32768
    s_add_u32 m0, s58, 16384
    s_add_u32 s66, s66, 1
    s_and_b32 s66, s66, 3
    s_lshl_b32 s61, s66, 12
    buffer_load_dwordx4 v58, s[28:31], s61 offen sc1 lds
    ds_read_b64_tr_b16 a[202:203], v31 offset:33792
    v_mfma_f32_32x32x16_bf16 v[160:175], a[84:87], a[212:215], v[160:175]
    buffer_load_dwordx4 v59, s[28:31], s61 offen offset:1024 sc1 lds
    ds_read_b64_tr_b16 a[204:205], v32 offset:32768
    ds_read_b64_tr_b16 a[206:207], v32 offset:33792
    s_waitcnt lgkmcnt(8)
    v_mfma_f32_32x32x16_bf16 v[144:159], a[88:91], a[216:219], v[144:159]
    ds_read_b64_tr_b16 a[208:209], v31 offset:34816
    ds_read_b64_tr_b16 a[210:211], v31 offset:35840
    v_mfma_f32_32x32x16_bf16 v[160:175], a[88:91], a[220:223], v[160:175]
    buffer_load_dwordx4 v58, s[28:31], s61 offen offset:2048 sc1 lds
    ds_read_b64_tr_b16 a[212:213], v32 offset:34816
    ds_read_b64_tr_b16 a[214:215], v32 offset:35840
    s_waitcnt lgkmcnt(8)
    v_mfma_f32_32x32x16_bf16 v[144:159], a[92:95], a[224:227], v[144:159]
    buffer_load_dwordx4 v59, s[28:31], s61 offen offset:3072 sc1 lds
    ds_read_b64_tr_b16 a[216:217], v31 offset:36864
    ds_read_b64_tr_b16 a[218:219], v31 offset:37888
    v_mfma_f32_32x32x16_bf16 v[160:175], a[92:95], a[228:231], v[160:175]
    ds_read_b64_tr_b16 a[220:221], v32 offset:36864
    ds_read_b64_tr_b16 a[222:223], v32 offset:37888
    s_waitcnt lgkmcnt(8)
    v_mfma_f32_32x32x16_bf16 v[144:159], a[96:99], a[200:203], v[144:159]
    s_add_u32 m0, s58, 65536
    s_add_u32 s66, s66, 1
    s_and_b32 s66, s66, 3
    s_lshl_b32 s61, s66, 12
    buffer_load_dwordx4 v58, s[28:31], s61 offen sc1 lds
    ds_read_b64_tr_b16 a[224:225], v31 offset:38912
    ds_read_b64_tr_b16 a[226:227], v31 offset:39936
    v_mfma_f32_32x32x16_bf16 v[160:175], a[96:99], a[204:207], v[160:175]
    buffer_load_dwordx4 v59, s[28:31], s61 offen offset:1024 sc1 lds
    ds_read_b64_tr_b16 a[228:229], v32 offset:38912
    ds_read_b64_tr_b16 a[230:231], v32 offset:39936
    s_waitcnt lgkmcnt(8)
    v_mfma_f32_32x32x16_bf16 v[144:159], a[100:103], a[208:211], v[144:159]
    s_waitcnt vmcnt(10)
    s_barrier
    s_xor_b32 s55, s55, 1024
    s_load_dword s14, s[28:29], s55
    ds_read_b64_tr_b16 v[192:193], v37 offset:49152
    buffer_load_dwordx4 v58, s[28:31], s61 offen offset:2048 sc1 lds
    ds_read_b64_tr_b16 v[194:195], v37 offset:53248
    ds_read_b128 a[200:203], v44 offset:0
    v_mfma_f32_32x32x16_bf16 v[160:175], a[100:103], a[212:215], v[160:175]
    ds_read_b128 a[204:207], v45 offset:0
    s_waitcnt lgkmcnt(8)
    v_mfma_f32_32x32x16_bf16 v[144:159], a[104:107], a[216:219], v[144:159]
    buffer_load_dwordx4 v59, s[28:31], s61 offen offset:3072 sc1 lds
    ds_read_b64_tr_b16 v[196:197], v37 offset:50176
    ds_read_b64_tr_b16 v[198:199], v37 offset:54272
    ds_read_b128 a[208:211], v44 offset:512
    v_mfma_f32_32x32x16_bf16 v[160:175], a[104:107], a[220:223], v[160:175]
    ds_read_b128 a[212:215], v45 offset:512
    s_waitcnt lgkmcnt(8)
    v_mfma_f32_32x32x16_bf16 v[144:159], a[108:111], a[224:227], v[144:159]
    ds_read_b64_tr_b16 v[200:201], v37 offset:51200
    ds_read_b64_tr_b16 v[202:203], v37 offset:55296
    ds_read_b128 a[216:219], v44 offset:2048
    v_mfma_f32_32x32x16_bf16 v[160:175], a[108:111], a[228:231], v[160:175]
    ds_read_b128 a[220:223], v45 offset:2048
    s_waitcnt lgkmcnt(8)
    v_mfma_f32_32x32x16_bf16 v[144:159], v[192:195], a[200:203], v[144:159]
    ds_read_b64_tr_b16 v[204:205], v37 offset:52224
    ds_read_b64_tr_b16 v[206:207], v37 offset:56320
    ds_read_b128 a[224:227], v44 offset:2560
    v_mfma_f32_32x32x16_bf16 v[160:175], v[192:195], a[204:207], v[160:175]
    ds_read_b128 a[228:231], v45 offset:2560
    s_waitcnt lgkmcnt(8)
    v_mfma_f32_32x32x16_bf16 v[144:159], v[196:199], a[208:211], v[144:159]
    s_waitcnt vmcnt(8)
    s_barrier
    ds_read_b64_tr_b16 v[208:209], v38 offset:32768
    ds_read_b64_tr_b16 v[210:211], v38 offset:36864
    ds_read_b128 a[200:203], v44 offset:16384
    v_mfma_f32_32x32x16_bf16 v[160:175], v[196:199], a[212:215], v[160:175]
    ds_read_b128 a[204:207], v45 offset:16384
    s_waitcnt lgkmcnt(8)
    v_mfma_f32_32x32x16_bf16 v[144:159], v[200:203], a[216:219], v[144:159]
    v_mfma_f32_32x32x16_bf16 v[160:175], v[200:203], a[220:223], v[160:175]
    s_waitcnt lgkmcnt(4)
    v_mfma_f32_32x32x16_bf16 v[144:159], v[204:207], a[224:227], v[144:159]
    s_waitcnt lgkmcnt(0)
    s_cmp_ge_u32 s14, 1
    s_cbranch_scc1 L_pollok7
    s_mov_b32 s60, 0
L_poll7:
    s_sleep 4
    buffer_load_dword v18, off, s[28:31], s55 sc1
    s_add_u32 s60, s60, 1
    s_waitcnt vmcnt(0)
    v_readfirstlane_b32 s14, v18
    s_nop 0
    s_cmp_ge_u32 s14, 1
    s_cbranch_scc1 L_pollok7
    s_cmp_lt_u32 s60, 20000
    s_cbranch_scc1 L_poll7
L_pollok7:
    v_xor_b32 v21, 131072, v21
    ds_read_b64_tr_b16 v[212:213], v38 offset:33792
    buffer_load_dwordx4 v[240:243], v21, s[28:31], 0 offen offset:2048 sc1
    ds_read_b64_tr_b16 v[214:215], v38 offset:37888
    ds_read_b128 a[208:211], v44 offset:16896
    ds_read_b128 a[212:215], v45 offset:16896
    v_mfma_f32_32x32x16_bf16 v[160:175], v[204:207], a[228:231], v[160:175]
    buffer_load_dwordx4 v[244:247], v21, s[28:31], 0 offen offset:3072 sc1
    ds_read_b64_tr_b16 v[192:193], v38 offset:34816
    ds_read_b64_tr_b16 v[194:195], v38 offset:38912
    ds_read_b128 a[216:219], v44 offset:18432
    ds_read_b128 a[220:223], v45 offset:18432
    v_mfma_f32_32x32x16_bf16 v[144:159], v[208:211], a[200:203], v[144:159]
    buffer_load_dwordx4 v[232:235], v21, s[28:31], 0 offen offset:0 sc1
    ds_read_b64_tr_b16 v[196:197], v38 offset:35840
    ds_read_b64_tr_b16 v[198:199], v38 offset:39936
    ds_read_b128 a[224:227], v44 offset:18944
    v_mfma_f32_32x32x16_bf16 v[160:175], v[208:211], a[204:207], v[160:175]
    buffer_load_dwordx4 v[236:239], v21, s[28:31], 0 offen offset:1024 sc1
    ds_read_b128 a[228:231], v45 offset:18944
    s_waitcnt lgkmcnt(8)
    v_mfma_f32_32x32x16_bf16 v[144:159], v[212:215], a[208:211], v[144:159]
    s_waitcnt vmcnt(8)
    s_barrier
    ds_read_b64_tr_b16 v[200:201], v38 offset:49152
    ds_read_b64_tr_b16 v[202:203], v38 offset:53248
    ds_read_b128 a[200:203], v40 offset:16384
    v_mfma_f32_32x32x16_bf16 v[160:175], v[212:215], a[212:215], v[160:175]
    ds_read_b128 a[204:207], v41 offset:16384
    s_waitcnt lgkmcnt(8)
    v_mfma_f32_32x32x16_bf16 v[144:159], v[192:195], a[216:219], v[144:159]
    ds_read_b64_tr_b16 v[204:205], v38 offset:50176
    ds_read_b64_tr_b16 v[206:207], v38 offset:54272
    ds_read_b128 a[208:211], v40 offset:16896
    v_mfma_f32_32x32x16_bf16 v[160:175], v[192:195], a[220:223], v[160:175]
    ds_read_b128 a[212:215], v41 offset:16896
    s_waitcnt lgkmcnt(8)
    v_mfma_f32_32x32x16_bf16 v[144:159], v[196:199], a[224:227], v[144:159]
    ds_read_b64_tr_b16 v[208:209], v38 offset:51200
    ds_read_b64_tr_b16 v[210:211], v38 offset:55296
    ds_read_b128 a[216:219], v40 offset:18432
    v_mfma_f32_32x32x16_bf16 v[160:175], v[196:199], a[228:231], v[160:175]
    ds_read_b128 a[220:223], v41 offset:18432
    s_waitcnt lgkmcnt(8)
    v_mfma_f32_32x32x16_bf16 v[144:159], v[200:203], a[200:203], v[144:159]
    ds_read_b64_tr_b16 v[212:213], v38 offset:52224
    ds_read_b64_tr_b16 v[214:215], v38 offset:56320
    ds_read_b128 a[224:227], v40 offset:18944
    v_mfma_f32_32x32x16_bf16 v[160:175], v[200:203], a[204:207], v[160:175]
    ds_read_b128 a[228:231], v41 offset:18944
    s_waitcnt lgkmcnt(8)
    v_mfma_f32_32x32x16_bf16 v[144:159], v[204:207], a[208:211], v[144:159]
    s_waitcnt vmcnt(4)
    s_barrier
    ds_read_b64_tr_b16 v[192:193], v37 offset:0
    ds_read_b64_tr_b16 v[194:195], v37 offset:4096
    ds_read_b128 a[200:203], v43 offset:0
    v_mfma_f32_32x32x16_bf16 v[160:175], v[204:207], a[212:215], v[160:175]
    ds_read_b64_tr_b16 v[196:197], v37 offset:1024
    ds_read_b64_tr_b16 v[198:199], v37 offset:5120
    ds_read_b128 a[204:207], v43 offset:512
    s_waitcnt lgkmcnt(10)
    v_mfma_f32_32x32x16_bf16 v[144:159], v[208:211], a[216:219], v[144:159]
    ds_read_b64_tr_b16 v[200:201], v37 offset:2048
    ds_read_b64_tr_b16 v[202:203], v37 offset:6144
    ds_read_b128 a[208:211], v43 offset:2048
    v_mfma_f32_32x32x16_bf16 v[160:175], v[208:211], a[220:223], v[160:175]
    ds_read_b64_tr_b16 v[204:205], v37 offset:3072
    ds_read_b64_tr_b16 v[206:207], v37 offset:7168
    ds_read_b128 a[212:215], v43 offset:2560
    s_waitcnt lgkmcnt(12)
    v_mfma_f32_32x32x16_bf16 v[144:159], v[212:215], a[224:227], v[144:159]
    v_mfma_f32_32x32x16_bf16 v[160:175], v[212:215], a[228:231], v[160:175]
    s_waitcnt lgkmcnt(6)
    v_mfma_f32_32x32x16_bf16 v[160:175], v[192:195], a[200:203], v[160:175]
    ds_read_b128 a[224:227], v42 offset:0
    v_mfma_f32_32x32x16_bf16 v[160:175], v[196:199], a[204:207], v[160:175]
    ds_read_b128 a[228:231], v42 offset:512
    s_waitcnt lgkmcnt(2)
    v_mfma_f32_32x32x16_bf16 v[160:175], v[200:203], a[208:211], v[160:175]
    ds_read_b128 a[200:203], v42 offset:2048
    v_mfma_f32_32x32x16_bf16 v[160:175], v[204:207], a[212:215], v[160:175]
    ds_read_b128 a[204:207], v42 offset:2560
    s_waitcnt vmcnt(3)
    v_mfma_f32_32x32x16_bf16 v[160:175], a[248:251], v[240:243], v[160:175]
    s_waitcnt vmcnt(2)
    v_mfma_f32_32x32x16_bf16 v[160:175], a[252:255], v[244:247], v[160:175]
    s_waitcnt lgkmcnt(2)
    v_mfma_f32_32x32x16_bf16 v[144:159], v[192:195], a[224:227], v[144:159]
    v_mfma_f32_32x32x16_bf16 v[144:159], v[196:199], a[228:231], v[144:159]
    s_waitcnt lgkmcnt(0)
    v_mfma_f32_32x32x16_bf16 v[144:159], v[200:203], a[200:203], v[144:159]
    s_nop 6
    ds_write_b128 v80, v[160:163] offset:8192
    v_mfma_f32_32x32x16_bf16 v[144:159], v[204:207], a[204:207], v[144:159]
    ds_write_b128 v81, v[164:167] offset:8192
    s_waitcnt vmcnt(1)
    v_mfma_f32_32x32x16_bf16 v[144:159], a[248:251], v[232:235], v[144:159]
    ds_write_b128 v82, v[168:171] offset:8192
    s_waitcnt vmcnt(0)
    v_mfma_f32_32x32x16_bf16 v[144:159], a[252:255], v[236:239], v[144:159]
    ds_write_b128 v83, v[172:175] offset:8192
    s_nop 10
    ds_write_b128 v80, v[144:147]
    ds_write_b128 v81, v[148:151]
    ds_write_b128 v82, v[152:155]
    ds_write_b128 v83, v[156:159]
    s_waitcnt lgkmcnt(0)
    s_barrier
    ds_read_b128 v[112:115], v84 offset:0
    ds_read_b128 v[116:119], v85 offset:0
    ds_read_b128 v[120:123], v86 offset:0
    ds_read_b128 v[124:127], v87 offset:0
    ds_read_b128 v[128:131], v84 offset:2048
    ds_read_b128 v[132:135], v85 offset:2048
    ds_read_b128 v[136:139], v86 offset:2048
    ds_read_b128 v[140:143], v87 offset:2048
    s_waitcnt lgkmcnt(7)
    v_pk_add_f32 v[216:217], v[216:217], v[112:113]
    v_pk_add_f32 v[218:219], v[218:219], v[114:115]
    s_waitcnt lgkmcnt(6)
    v_pk_add_f32 v[220:221], v[220:221], v[116:117]
    v_pk_add_f32 v[222:223], v[222:223], v[118:119]
    s_waitcnt lgkmcnt(5)
    v_pk_add_f32 v[216:217], v[216:217], v[120:121]
    v_pk_add_f32 v[218:219], v[218:219], v[122:123]
    s_waitcnt lgkmcnt(4)
    v_pk_add_f32 v[220:221], v[220:221], v[124:125]
    v_pk_add_f32 v[222:223], v[222:223], v[126:127]
    v_cvt_pk_bf16_f32 v104, v216, v217
    v_cvt_pk_bf16_f32 v105, v218, v219
    v_cvt_pk_bf16_f32 v106, v220, v221
    v_cvt_pk_bf16_f32 v107, v222, v223
    buffer_store_dwordx4 v[104:107], v78, s[32:35], 0 offen
    s_waitcnt lgkmcnt(3)
    v_pk_add_f32 v[224:225], v[224:225], v[128:129]
    v_pk_add_f32 v[226:227], v[226:227], v[130:131]
    s_waitcnt lgkmcnt(2)
    v_pk_add_f32 v[228:229], v[228:229], v[132:133]
    v_pk_add_f32 v[230:231], v[230:231], v[134:135]
    s_waitcnt lgkmcnt(1)
    v_pk_add_f32 v[224:225], v[224:225], v[136:137]
    v_pk_add_f32 v[226:227], v[226:227], v[138:139]
    s_waitcnt lgkmcnt(0)
    v_pk_add_f32 v[228:229], v[228:229], v[140:141]
    v_pk_add_f32 v[230:231], v[230:231], v[142:143]
    v_cvt_pk_bf16_f32 v108, v224, v225
    v_cvt_pk_bf16_f32 v109, v226, v227
    v_cvt_pk_bf16_f32 v110, v228, v229
    v_cvt_pk_bf16_f32 v111, v230, v231
    buffer_store_dwordx4 v[108:111], v79, s[32:35], 0 offen
L_fin:
L_end:
    s_endpgm
.section .rodata,"a"
.p2align 6
.amdhsa_kernel parallel_sum__sliding_local_dilated__mixer_token_mlp__prompt_kernel
  .amdhsa_next_free_vgpr 512
  .amdhsa_next_free_sgpr 102
  .amdhsa_accum_offset 256
  .amdhsa_group_segment_fixed_size 0
  .amdhsa_kernarg_size 88
  .amdhsa_user_sgpr_count 2
  .amdhsa_user_sgpr_kernarg_segment_ptr 1
  .amdhsa_system_sgpr_workgroup_id_x 1
.end_amdhsa_kernel
```

```asm
; @launch grid=(256,1,1) block=(256,1,1) lds=163840
.amdgcn_target "amdgcn-amd-amdhsa--gfx950"
.text
.globl parallel_sum__sliding_local_dilated__mixer_token_mlp__prompt_kernel
.p2align 8
.type parallel_sum__sliding_local_dilated__mixer_token_mlp__prompt_kernel,@function
parallel_sum__sliding_local_dilated__mixer_token_mlp__prompt_kernel:
    s_cmp_ge_u32 s2, 256
    s_cbranch_scc1 L_end
    s_load_dwordx2 s[8:9], s[0:1], 0
    s_load_dwordx2 s[20:21], s[0:1], 32
    s_load_dwordx2 s[28:29], s[0:1], 80
    s_load_dwordx2 s[44:45], s[0:1], 72
    s_load_dwordx2 s[12:13], s[0:1], 8
    s_load_dwordx2 s[16:17], s[0:1], 16
    s_load_dwordx2 s[24:25], s[0:1], 48
    s_load_dwordx2 s[32:33], s[0:1], 64
    s_load_dwordx2 s[36:37], s[0:1], 40
    s_load_dwordx2 s[40:41], s[0:1], 56
    s_memrealtime s[78:79]
    s_getpc_b64 s[6:7]
L_pc:
    s_and_b32 s3, s2, 0xf8
    v_lshrrev_b32 v13, 5, v0
    v_add_lshl_u32 v13, s3, v13, 7
    v_min_u32 v13, L_end-L_pc-4, v13
    global_load_dword v18, v13, s[6:7]
    v_lshrrev_b32 v13, 6, v0
    v_and_b32 v10, 31, v0
    v_readfirstlane_b32 s48, v13
    v_bfe_u32 v9, v0, 5, 1
    v_mul_u32_u24 v14, 896, v9
    v_lshl_add_u32 v14, v10, 4, v14
    v_cmp_gt_u32 vcc, 28, v10
    v_mov_b32 v15, 268435456
    s_mov_b32 s10, 1835008
    s_mov_b32 s11, 0x20000
    v_cndmask_b32 v14, v15, v14, vcc
    s_lshr_b32 s4, s48, 1
    s_and_b32 s5, s48, 1
    s_and_b32 s3, s2, 0xfe
    s_add_u32 s3, s3, s4
    s_lshl_b32 s3, s3, 1
    s_and_b32 s60, s2, 1
    s_add_u32 s3, s3, s60
    s_lshl_b32 s3, s3, 1
    s_add_u32 s3, s3, s5
    s_mul_i32 s3, s3, 1792
    s_waitcnt lgkmcnt(0)
    buffer_load_dwordx4 v[182:185], v14, s[8:11], s3 offen
    buffer_load_dwordx4 v[186:189], v14, s[8:11], s3 offen offset:448
    v_and_b32 v1, 63, v0
    s_mov_b32 s46, 256
    s_mov_b32 s47, 0x20000
    s_lshl_b32 s3, s48, 8
    s_add_u32 s3, s3, s2
    s_cmp_lt_u32 s3, 8
    s_cselect_b32 s3, 0, 268435456
    s_or_b32 s78, s78, 1
    v_mov_b32 v234, s78
    v_mov_b32 v235, 0
    v_lshlrev_b32 v11, 25, v1
    buffer_atomic_cmpswap v[234:235], v11, s[44:47], s3 offen sc1
    s_bfe_u32 s6, s2, 0x20001
    s_and_b32 s7, s2, 1
    s_and_b32 s61, s2, 7
    s_lshr_b32 s101, s2, 3
    s_mul_i32 s52, s7, 25
    s_add_u32 s52, s52, s101
    s_mul_i32 s51, s52, 37
    s_lshr_b32 s51, s51, 8
    s_mul_i32 s3, s51, 7
    s_sub_u32 s52, s52, s3
    s_and_b32 s3, s6, 1
    s_mul_i32 s3, s3, 6
    s_add_u32 s51, s51, s3
    s_add_u32 s51, s51, 1
    s_add_u32 s3, s3, s51
    s_cmp_eq_u32 s3, 7
    s_cselect_b32 s51, 0, s51
    s_lshr_b32 s59, s6, 1
    s_lshl_b32 s51, s51, 1
    s_add_u32 s51, s51, s59
    s_max_u32 s60, s101, 25
    s_sub_u32 s60, s60, 25
    s_add_u32 s3, s101, s7
    s_cmp_lt_u32 s3, 25
    s_cselect_b32 s55, 1, 0
    s_cselect_b32 s52, s52, s60
    s_mov_b32 s22, 7340032
    s_mov_b32 s23, 0x20000
    s_lshl_b32 s3, s52, 1
    s_sub_u32 s60, s3, 7
    s_cmp_ge_u32 s3, 7
    s_cselect_b32 s3, s60, s3
    s_and_b32 s3, s3, 7
    s_mul_i32 s60, s61, 2
    s_add_u32 s3, s3, s60
    s_and_b32 s3, s3, 7
    s_mul_i32 s0, s3, 458752
    s_lshl_b32 s1, s3, 13
    s_lshl_b32 s58, s48, 12
    v_lshrrev_b32 v3, 4, v1
    v_lshrrev_b32 v5, 3, v1
    v_and_b32 v6, 7, v1
    v_lshlrev_b32 v14, 1, v3
    v_xor_b32 v14, v14, v6
    v_lshlrev_b32 v83, 4, v14
    s_cmp_eq_u32 s55, 0
    s_cbranch_scc1 L_nog1
    v_mul_u32_u24 v14, 3584, v5
    s_lshl_b32 s3, s59, 5
    s_add_u32 s3, s3, s48
    s_mul_i32 s3, s3, 114688
    s_lshl_b32 s60, s51, 7
    s_add_u32 s3, s3, s60
    v_add3_u32 v55, v14, v83, s3
    v_add_u32 v56, 56320, v55
    v_add_u32 v57, 26624, v55
    v_add_u32 v58, 82944, v55
    s_mov_b32 s38, 3584
    s_mov_b32 s39, 0x20000
    v_lshlrev_b32 v13, 3, v3
    s_lshl_b32 s3, s51, 1
    s_add_u32 s3, s3, s4
    s_lshl_b32 s3, s3, 6
    buffer_load_dwordx2 v[246:247], v13, s[36:39], s3 offen offset:0
    buffer_load_dwordx2 v[248:249], v13, s[36:39], s3 offen offset:32
    s_add_u32 m0, s58, 0
    v_xor_b32 v55, 128, v55
    buffer_load_dwordx4 v55, s[20:23], s0 offen lds
    v_xor_b32 v56, 128, v56
    buffer_load_dwordx4 v56, s[20:23], s0 offen offset:1024 lds
    v_xor_b32 v57, 128, v57
    buffer_load_dwordx4 v57, s[20:23], s0 offen offset:2048 lds
    v_xor_b32 v58, 128, v58
    buffer_load_dwordx4 v58, s[20:23], s0 offen offset:3072 lds
    s_mul_i32 s53, s101, 37
    s_lshr_b32 s53, s53, 8
    s_mul_i32 s54, s53, 7
    s_sub_u32 s54, s101, s54
    s_and_b32 s53, s53, 3
    s_lshl_b32 s3, s6, 2
    s_add_u32 s53, s53, s3
    s_lshl_b32 s53, s53, 1
    s_add_u32 s53, s53, s7
    s_mov_b32 s42, 4096
    s_mov_b32 s43, 0x20000
    s_lshl_b32 s3, s53, 2
    s_add_u32 s3, s3, s48
    s_lshl_b32 s60, s3, 5
    v_lshl_add_u32 v82, v5, 1, s60
    s_mul_i32 s3, s3, 14336
    s_lshl_b32 s60, s54, 7
    s_add_u32 s3, s3, s60
    v_mul_u32_u24 v14, 896, v5
    v_lshl_add_u32 v14, v6, 4, v14
    v_add_u32 v85, s3, v14
    v_add_u32 v86, 7168, v85
    s_cmp_lt_u32 s101, 28
    s_cselect_b32 s56, 1, 0
    s_lshl_b32 s50, s7, 3
    s_and_b32 s3, s101, 7
    s_add_u32 s50, s50, s3
    s_lshr_b32 s60, s101, 3
    s_lshl_b32 s49, s6, 2
    s_add_u32 s49, s49, s60
    s_lshl_b32 s49, s49, 2
    s_add_u32 s49, s49, s48
    s_mul_i32 s60, s60, 0
    s_add_u32 s3, s3, s60
    s_sub_u32 s60, s3, 7
    s_cmp_ge_u32 s3, 7
    s_cselect_b32 s3, s60, s3
    s_lshl_b32 s62, s3, 18
    s_mul_i32 s63, s3, 12288
    s_mov_b32 s30, 20971520
    s_mov_b32 s31, 0x20000
    s_mov_b32 s75, 0x3727c5ac
    s_mov_b32 s76, 0x3b124925
    s_mov_b32 s77, 0x3f803f80
    v_lshlrev_b32 v4, 4, v1
    v_bfe_u32 v7, v1, 2, 2
    v_and_b32 v8, 3, v1
    v_mul_u32_u24 v13, 960, v9
    v_lshl_add_u32 v13, v10, 4, v13
    s_mul_i32 s3, s48, 1920
    s_add_u32 s3, s3, 147456
    v_add_u32 v230, s3, v13
    v_mul_u32_u24 v13, 960, v7
    v_lshl_add_u32 v13, v3, 5, v13
    v_lshl_add_u32 v13, v8, 3, v13
    s_lshl_b32 s3, s48, 8
    s_add_u32 s3, s3, 147456
    v_add_u32 v231, s3, v13
    s_lshl_b32 s3, s48, 3
    s_add_u32 s3, s3, 155648
    v_lshl_add_u32 v232, v9, 2, s3
    v_lshlrev_b32 v237, 2, v6
    v_and_b32 v2, 15, v1
    v_lshlrev_b32 v238, 14, v3
    v_add_lshl_u32 v238, v238, v2, 2
    v_add_u32 v237, 155648, v237
    v_lshlrev_b32 v13, 17, v9
    v_lshl_add_u32 v233, v10, 4, v13
    s_cmp_eq_u32 s48, 3
    s_cselect_b32 s60, 268435456, 0
    s_lshl_b32 s70, s48, 10
    s_add_u32 s70, s70, s2
    s_lshl_b32 s70, s70, 9
    s_add_u32 s71, s70, 262144
    s_add_u32 s71, s71, s60
    s_xor_b32 s60, s60, 268435456
    s_lshl_b32 s72, s2, 7
    s_add_u32 s72, s72, s60
    s_add_u32 s72, s72, 6291456
    s_lshr_b32 s74, s2, 2
    s_lshl_b32 s74, s74, 5
    s_and_b32 s3, s2, 3
    s_add_u32 s74, s74, s3
    s_lshl_b32 s74, s74, 2
    s_add_u32 s74, s74, 10485760
    v_cmp_gt_u32 vcc, 8, v0
    v_lshlrev_b32 v236, 13, v0
    v_mov_b32 v13, 268435456
    s_and_b32 s3, s2, 7
    s_lshl_b32 s3, s3, 13
    s_add_u32 s3, s3, 10485760
    v_lshrrev_b32 v14, 2, v0
    v_lshl_add_u32 v14, v14, 7, s3
    v_lshl_add_u32 v20, v8, 2, v14
    v_cndmask_b32 v236, v13, v236, vcc
    v_mov_b32 v16, 0
    s_lshl_b32 s3, s48, 14
    s_add_u32 s74, s74, s3
    s_add_u32 s73, s74, 8192
    s_waitcnt vmcnt(8)
    v_dot2_f32_bf16 v226, v182, s77, 0
    v_dot2_f32_bf16 v227, v182, v182, 0
    v_dot2_f32_bf16 v226, v183, s77, v226
    v_dot2_f32_bf16 v227, v183, v183, v227
    v_dot2_f32_bf16 v226, v184, s77, v226
    v_dot2_f32_bf16 v227, v184, v184, v227
    v_dot2_f32_bf16 v226, v185, s77, v226
    v_dot2_f32_bf16 v227, v185, v185, v227
    s_waitcnt vmcnt(7)
    v_dot2_f32_bf16 v226, v186, s77, v226
    v_dot2_f32_bf16 v227, v186, v186, v227
    v_dot2_f32_bf16 v226, v187, s77, v226
    v_dot2_f32_bf16 v227, v187, v187, v227
    v_dot2_f32_bf16 v226, v188, s77, v226
    v_dot2_f32_bf16 v227, v188, v188, v227
    v_dot2_f32_bf16 v226, v189, s77, v226
    v_dot2_f32_bf16 v227, v189, v189, v227
    buffer_load_dword v12, v16, s[44:47], 0 offen sc1
    v_lshlrev_b32 v190, 16, v182
    v_and_b32 v191, 0xffff0000, v182
    v_add_f32_dpp v226, v226, v226 quad_perm:[1,0,3,2] row_mask:0xf bank_mask:0xf
    v_add_f32_dpp v227, v227, v227 quad_perm:[1,0,3,2] row_mask:0xf bank_mask:0xf
    v_lshlrev_b32 v192, 16, v183
    v_add_f32_dpp v226, v226, v226 quad_perm:[2,3,0,1] row_mask:0xf bank_mask:0xf
    v_add_f32_dpp v227, v227, v227 quad_perm:[2,3,0,1] row_mask:0xf bank_mask:0xf
    v_and_b32 v193, 0xffff0000, v183
    v_add_f32_dpp v226, v226, v226 row_half_mirror row_mask:0xf bank_mask:0xf
    v_add_f32_dpp v227, v227, v227 row_half_mirror row_mask:0xf bank_mask:0xf
    v_lshlrev_b32 v194, 16, v184
    v_add_f32_dpp v226, v226, v226 row_mirror row_mask:0xf bank_mask:0xf
    v_add_f32_dpp v227, v227, v227 row_mirror row_mask:0xf bank_mask:0xf
    v_and_b32 v195, 0xffff0000, v184
    v_mov_b32 v228, v226
    v_mov_b32 v229, v227
    v_lshlrev_b32 v196, 16, v185
    v_permlane16_swap_b32 v226, v228
    v_permlane16_swap_b32 v227, v229
    v_add_f32 v226, v226, v228
    v_add_f32 v227, v227, v229
    v_mul_f32_e64 v226, -v226, s76
    v_mul_f32 v228, v226, v226
    v_fma_f32 v227, v227, s76, -v228
    v_max_f32 v227, 0, v227
    v_add_f32 v228, s75, v227
    v_rsq_f32 v222, v228
    v_and_b32 v197, 0xffff0000, v185
    v_mul_f32 v228, v222, v222
    v_fma_f32 v229, v228, v227, s75
    v_rsq_f32 v228, v229
    v_mul_f32 v223, v226, v222
    v_mul_f32 v224, v222, v228
    v_mul_f32 v225, v223, v228
    v_mul_f32 v229, v229, v228
    ds_write_b32 v232, v229
    v_lshlrev_b32 v198, 16, v186
    v_and_b32 v199, 0xffff0000, v186
    v_lshlrev_b32 v200, 16, v187
    v_and_b32 v201, 0xffff0000, v187
    v_lshlrev_b32 v202, 16, v188
    v_and_b32 v203, 0xffff0000, v188
    v_lshlrev_b32 v204, 16, v189
    v_and_b32 v205, 0xffff0000, v189
    v_pk_fma_f32 v[206:207], v[190:191], v[224:225], v[224:225] op_sel:[0,0,1] op_sel_hi:[1,0,1]
    v_pk_fma_f32 v[208:209], v[192:193], v[224:225], v[224:225] op_sel:[0,0,1] op_sel_hi:[1,0,1]
    v_pk_fma_f32 v[210:211], v[194:195], v[224:225], v[224:225] op_sel:[0,0,1] op_sel_hi:[1,0,1]
    v_pk_fma_f32 v[212:213], v[196:197], v[224:225], v[224:225] op_sel:[0,0,1] op_sel_hi:[1,0,1]
    v_cvt_pk_bf16_f32 v182, v206, v207
    v_cvt_pk_bf16_f32 v183, v208, v209
    v_cvt_pk_bf16_f32 v184, v210, v211
    v_cvt_pk_bf16_f32 v185, v212, v213
    ds_write_b128 v230, v[182:185] offset:0
    v_pk_fma_f32 v[214:215], v[198:199], v[224:225], v[224:225] op_sel:[0,0,1] op_sel_hi:[1,0,1]
    v_pk_fma_f32 v[216:217], v[200:201], v[224:225], v[224:225] op_sel:[0,0,1] op_sel_hi:[1,0,1]
    v_pk_fma_f32 v[218:219], v[202:203], v[224:225], v[224:225] op_sel:[0,0,1] op_sel_hi:[1,0,1]
    v_pk_fma_f32 v[220:221], v[204:205], v[224:225], v[224:225] op_sel:[0,0,1] op_sel_hi:[1,0,1]
    v_cvt_pk_bf16_f32 v186, v214, v215
    v_cvt_pk_bf16_f32 v187, v216, v217
    v_cvt_pk_bf16_f32 v188, v218, v219
    v_cvt_pk_bf16_f32 v189, v220, v221
    ds_write_b128 v230, v[186:189] offset:448
    s_waitcnt lgkmcnt(0)
    s_barrier
    ds_read_b64_tr_b16 v[110:111], v231 offset:0
    ds_read_b64_tr_b16 v[112:113], v231 offset:3840
    ds_read_b64_tr_b16 v[114:115], v231 offset:128
    ds_read_b64_tr_b16 v[116:117], v231 offset:3968
    ds_read_b32 v229, v237
    s_waitcnt lgkmcnt(3)
    buffer_store_dwordx4 v[110:113], v233, s[28:31], s70 offen sc1
    s_waitcnt lgkmcnt(1)
    buffer_store_dwordx4 v[114:117], v233, s[28:31], s71 offen sc1
    v_cmp_gt_u32 vcc, 16, v1
    s_waitcnt lgkmcnt(0)
    s_nop 0
    v_cndmask_b32 v229, 0, v229, vcc
    buffer_store_dword v229, v238, s[28:31], s72 offen sc1
    s_add_u32 m0, s58, 16384
    s_add_u32 s0, s0, 458752
    s_cmp_eq_u32 s0, 3670016
    s_cselect_b32 s0, 0, s0
    buffer_load_dwordx4 v55, s[20:23], s0 offen lds
    buffer_load_dwordx4 v56, s[20:23], s0 offen offset:1024 lds
    buffer_load_dwordx4 v57, s[20:23], s0 offen offset:2048 lds
    buffer_load_dwordx4 v58, s[20:23], s0 offen offset:3072 lds
    s_mov_b32 s18, 401408
    s_mov_b32 s19, 0x20000
    s_mov_b32 s26, 7340032
    s_mov_b32 s27, 0x20000
    s_mov_b32 s34, 1835008
    s_mov_b32 s35, 0x20000
    s_mov_b32 s36, 1
    v_lshrrev_b32 v14, 2, v1
    v_lshlrev_b32 v14, 7, v14
    v_lshl_add_u32 v14, v8, 3, v14
    v_and_b32 v15, 3, v5
    v_lshl_add_u32 v14, v15, 5, v14
    s_mul_i32 s3, s4, 8256
    v_xor_b32 v31, s3, v14
    v_xor_b32 v32, 32, v31
    v_xor_b32 v33, 64, v31
    v_xor_b32 v34, 96, v31
    v_add_u32 v35, 65536, v31
    v_add_u32 v36, 65536, v32
    v_add_u32 v37, 65536, v33
    v_add_u32 v38, 65536, v34
    v_add_u32 v39, 131072, v31
    v_add_u32 v40, 131072, v32
    v_add_u32 v41, 131072, v33
    v_add_u32 v42, 131072, v34
    s_lshl_b32 s6, s52, 1
    s_add_u32 s6, s6, s5
    s_lshl_b32 s3, s6, 1
    s_add_u32 s3, s3, s59
    s_lshl_b32 s3, s3, 4
    s_add_u32 s3, s3, s4
    s_lshl_b32 s3, s3, 12
    v_lshl_add_u32 v78, v3, 8, v4
    v_add_u32 v78, s3, v78
    s_xor_b32 s37, s51, 1
    s_lshl_b32 s37, s37, 3
    s_add_u32 s37, s37, s52
    s_lshl_b32 s3, s37, 14
    s_add_u32 s3, s3, s58
    s_add_u32 s3, s3, 16777216
    v_add_u32 v23, s3, v4
    s_lshl_b32 s37, s37, 5
    s_add_u32 s37, s37, s5
    s_lshl_b32 s37, s37, 2
    s_add_u32 s37, s37, 6422528
    s_mul_i32 s67, s6, 56
    s_lshl_b32 s3, s51, 1
    s_add_u32 s3, s3, s4
    s_add_u32 s67, s67, s3
    s_lshl_b32 s67, s67, 11
    s_add_u32 s67, s67, 2097152
    v_add_u32 v81, s58, v4
    s_lshl_b32 s68, s52, 2
    s_and_b32 s3, s51, 1
    s_add_u32 s68, s68, s3
    s_cmp_ge_u32 s51, 14
    s_cselect_b32 s3, 2, 0
    s_add_u32 s68, s68, s3
    s_lshl_b32 s68, s68, 7
    s_add_u32 s68, s68, 6356992
    s_waitcnt vmcnt(7)
    v_readfirstlane_b32 s57, v12
    s_mov_b32 s60, 0
    s_cmp_lg_u32 s57, 0
    s_cbranch_scc1 L_nonce_ok
L_nonce:
    buffer_load_dword v12, v16, s[44:47], 0 offen sc1
    s_add_u32 s60, s60, 1
    s_waitcnt vmcnt(0)
    v_readfirstlane_b32 s57, v12
    s_cmp_ge_u32 s60, 20000
    s_cbranch_scc1 L_nonce_ok
    s_cmp_eq_u32 s57, 0
    s_cbranch_scc1 L_nonce
L_nonce_ok:
    s_waitcnt vmcnt(4)
    s_barrier
    s_atomic_swap s57, s[28:29], s74
    s_atomic_swap s57, s[28:29], s73
    buffer_load_dwordx4 v[96:99], v85, s[8:11], 0 offen
    buffer_load_ushort v93, v82, s[40:43], 0 offen offset:0
    buffer_load_dwordx4 v[100:103], v86, s[8:11], 0 offen
    buffer_load_ushort v94, v82, s[40:43], 0 offen offset:16
    v_add_u32 v53, 65536, v4
    s_add_u32 m0, s58, 32768
    s_add_u32 s0, s0, 458752
    s_cmp_eq_u32 s0, 3670016
    s_cselect_b32 s0, 0, s0
    buffer_load_dwordx4 v55, s[20:23], s0 offen lds
    v_add_u32 v54, 131072, v4
    s_mul_i32 s59, s48, 3072
    s_mul_i32 s3, s50, 86016
    s_add_u32 s3, s3, s59
    s_add_u32 s3, s3, 8388608
    v_add_u32 v80, s3, v4
    v_lshlrev_b32 v14, 7, v9
    v_xor_b32 v14, v14, v4
    s_lshl_b32 s3, s49, 11
    v_add_u32 v67, s3, v14
    v_add_u32 v68, 129024, v67
    s_lshr_b32 s3, s49, 2
    s_lshl_b32 s3, s3, 3
    s_max_u32 s3, s3, 1
    s_sub_u32 s3, s3, 1
    s_lshl_b32 s3, s3, 10
    s_lshl_b32 s6, s5, 17
    s_add_u32 s3, s3, s6
    s_lshl_b32 s6, s4, 28
    s_add_u32 s3, s3, s6
    v_add_u32 v69, s3, v14
    buffer_load_dwordx4 v56, s[20:23], s0 offen offset:1024 lds
    s_lshl_b32 s100, s5, 1
    s_add_u32 s100, s100, s4
    s_lshl_b32 s100, s100, 10
    v_and_b32 v14, 1, v1
    v_mul_u32_u24 v14, 640, v14
    v_lshrrev_b32 v15, 2, v1
    v_lshlrev_b32 v15, 4, v15
    v_xor_b32 v14, v14, v15
    v_bfe_u32 v15, v1, 1, 1
    v_lshl_add_u32 v14, v15, 3, v14
    buffer_load_dwordx4 v57, s[20:23], s0 offen offset:2048 lds
    s_add_u32 s3, s58, 12288
    v_add_u32 v70, s3, v14
    s_sub_u32 s3, s3, 3072
    s_cmp_eq_u32 s48, 0
    s_cselect_b32 s3, 28672, s3
    v_add_u32 v71, s3, v14
    v_add_u32 v72, 65536, v70
    v_add_u32 v73, 65536, v71
    v_add_u32 v74, 131072, v70
    v_add_u32 v75, 131072, v71
    s_lshl_b32 s3, s49, 1
    v_min_u32 v14, 2, v3
    v_add_u32 v14, s3, v14
    v_max_u32 v14, 1, v14
    v_lshlrev_b32 v14, 1, v14
    v_and_b32 v15, 1, v7
    buffer_load_dwordx4 v58, s[20:23], s0 offen offset:3072 lds
    v_add_lshl_u32 v14, v14, v15, 7
    v_lshrrev_b32 v15, 1, v7
    v_lshl_add_u32 v15, v15, 2, v8
    v_lshl_add_u32 v14, v15, 2, v14
    v_add_u32 v77, 6291200, v14
    s_min_u32 s15, s48, 2
    s_lshl_b32 s15, s15, 6
    s_add_u32 s15, s15, 64
    s_lshl_b32 s82, s49, 5
    s_add_u32 s82, s82, s50
    s_lshl_b32 s82, s82, 10
    s_add_u32 s82, s82, 4194304
    s_lshr_b32 s69, s49, 2
    s_lshl_b32 s69, s69, 1
    s_and_b32 s3, s50, 1
    s_add_u32 s69, s69, s3
    s_lshl_b32 s69, s69, 7
    s_add_u32 s69, s69, 6361088
    s_and_b32 s7, s53, 1
    s_mul_i32 s3, s7, 28
    s_add_u32 s3, s3, s48
    s_lshl_b32 s3, s3, 17
    s_xor_b32 s6, s53, 1
    s_lshl_b32 s55, s6, 3
    s_lshl_b32 s6, s53, 7
    s_add_u32 s3, s3, s6
    v_lshlrev_b32 v14, 12, v5
    s_add_u32 m0, s58, 49152
    s_add_u32 s0, s0, 458752
    s_cmp_eq_u32 s0, 3670016
    s_cselect_b32 s0, 0, s0
    buffer_load_dwordx4 v55, s[20:23], s0 offen lds
    v_add3_u32 v59, v14, v83, s3
    v_add_u32 v60, 31744, v59
    v_add_u32 v61, 63488, v59
    v_add_u32 v62, 95232, v59
    v_mul_u32_u24 v14, 896, v5
    s_mul_i32 s3, s4, 25088
    s_mul_i32 s6, s5, 14336
    s_add_u32 s3, s3, s6
    s_lshl_b32 s6, s54, 7
    s_add_u32 s3, s3, s6
    v_add3_u32 v63, v14, v83, s3
    buffer_load_dwordx4 v56, s[20:23], s0 offen offset:1024 lds
    v_add_u32 v64, 6144, v63
    s_lshl_b32 s6, s53, 1
    s_add_u32 s6, s6, s5
    s_and_b32 s3, s53, 30
    s_add_u32 s3, s3, s4
    s_lshl_b32 s3, s3, 7
    s_add_u32 s39, s3, 6361088
    s_lshl_b32 s3, s6, 5
    s_add_u32 s3, s3, s4
    s_lshl_b32 s3, s3, 10
    s_add_u32 s3, s3, 4194304
    v_add_u32 v65, s3, v4
    v_add_u32 v66, 15360, v65
    s_xor_b32 s3, s4, s5
    s_lshl_b32 s3, s3, 6
    v_xor_b32 v43, s3, v31
    buffer_load_dwordx4 v57, s[20:23], s0 offen offset:2048 lds
    v_xor_b32 v44, 32, v43
    v_add_u32 v45, 65536, v43
    v_add_u32 v46, 65536, v44
    s_mul_i32 s3, s4, 12288
    v_add_u32 v47, s3, v4
    v_xor_b32 v48, 4096, v47
    v_add_u32 v49, 65536, v47
    v_add_u32 v50, 65536, v48
    v_add_u32 v51, 131072, v47
    v_add_u32 v52, 131072, v48
    s_lshl_b32 s6, s54, 1
    s_add_u32 s6, s6, s5
    s_lshl_b32 s3, s6, 1
    s_add_u32 s3, s3, s7
    s_mul_i32 s3, s3, 14
    s_add_u32 s3, s3, s4
    s_lshl_b32 s3, s3, 12
    s_add_u32 s3, s3, 2097152
    v_add_u32 v79, s3, v4
    buffer_load_dwordx4 v58, s[20:23], s0 offen offset:3072 lds
    s_lshl_b32 s3, s54, 1
    s_add_u32 s3, s3, s7
    s_lshl_b32 s3, s3, 1
    s_add_u32 s3, s3, s4
    s_lshl_b32 s3, s3, 7
    s_add_u32 s38, s3, 6356992
    s_and_b32 s3, s2, 6
    s_add_u32 s3, s3, s54
    s_sub_u32 s6, s3, 7
    s_cmp_ge_u32 s3, 7
    s_cselect_b32 s3, s6, s3
    s_lshl_b32 s64, s3, 19
    s_lshl_b32 s65, s3, 13
    s_add_u32 s55, s55, s54
    s_lshl_b32 s3, s55, 14
    s_add_u32 s3, s3, s58
    s_add_u32 s3, s3, 12582912
    v_add_u32 v21, s3, v4
    s_add_u32 m0, s58, 65536
    s_add_u32 s0, s0, 458752
    s_cmp_eq_u32 s0, 3670016
    s_cselect_b32 s0, 0, s0
    buffer_load_dwordx4 v55, s[20:23], s0 offen lds
    s_lshl_b32 s55, s55, 5
    s_add_u32 s55, s55, s48
    s_lshl_b32 s55, s55, 2
    s_add_u32 s55, s55, 6488064
    s_lshl_b32 s3, s5, 3
    v_add_u32 v13, s3, v3
    v_xor_b32 v13, v13, v6
    v_lshlrev_b32 v13, 4, v13
    v_lshl_add_u32 v13, v2, 8, v13
    buffer_load_dwordx4 v56, s[20:23], s0 offen offset:1024 lds
    s_lshl_b32 s3, s4, 14
    s_add_u32 s3, s3, 131072
    v_add_u32 v87, s3, v13
    v_xor_b32 v88, 64, v87
    s_lshr_b32 s3, s53, 1
    s_add_u32 s66, s3, s54
    v_lshlrev_b32 v13, 1, v6
    v_xor_b32 v13, v13, v5
    v_lshlrev_b32 v13, 4, v13
    v_lshl_add_u32 v13, v5, 8, v13
    s_add_u32 s3, s58, 131072
    v_add_u32 v89, s3, v13
    v_xor_b32 v90, 16, v89
    v_xor_b32 v91, 24576, v89
    v_xor_b32 v92, 24592, v89
    v_lshlrev_b32 v150, 16, v246
    buffer_load_dwordx4 v57, s[20:23], s0 offen offset:2048 lds
    v_and_b32 v151, 0xffff0000, v246
    v_lshlrev_b32 v152, 16, v247
    v_and_b32 v153, 0xffff0000, v247
    v_lshlrev_b32 v154, 16, v248
    v_and_b32 v155, 0xffff0000, v248
    v_lshlrev_b32 v156, 16, v249
    v_and_b32 v157, 0xffff0000, v249
    v_lshlrev_b32 v158, 16, v246
    v_and_b32 v159, 0xffff0000, v246
    v_lshlrev_b32 v160, 16, v247
    v_and_b32 v161, 0xffff0000, v247
    v_lshlrev_b32 v162, 16, v248
    v_and_b32 v163, 0xffff0000, v248
    v_lshlrev_b32 v164, 16, v249
    v_and_b32 v165, 0xffff0000, v249
    buffer_load_dwordx4 v58, s[20:23], s0 offen offset:3072 lds
    s_add_u32 m0, s58, 81920
    s_add_u32 s0, s0, 458752
    s_cmp_eq_u32 s0, 3670016
    s_cselect_b32 s0, 0, s0
    buffer_load_dwordx4 v55, s[20:23], s0 offen lds
    buffer_load_dwordx4 v56, s[20:23], s0 offen offset:1024 lds
    buffer_load_dwordx4 v57, s[20:23], s0 offen offset:2048 lds
    buffer_load_dwordx4 v58, s[20:23], s0 offen offset:3072 lds
    buffer_load_dword v18, v20, s[28:31], 0 offen sc1
    s_add_u32 m0, s58, 98304
    s_add_u32 s0, s0, 458752
    s_cmp_eq_u32 s0, 3670016
    s_cselect_b32 s0, 0, s0
    buffer_load_dwordx4 v55, s[20:23], s0 offen lds
    buffer_load_dwordx4 v56, s[20:23], s0 offen offset:1024 lds
    buffer_load_dwordx4 v57, s[20:23], s0 offen offset:2048 lds
    buffer_load_dwordx4 v58, s[20:23], s0 offen offset:3072 lds
    s_add_u32 m0, s58, 114688
    s_add_u32 s0, s0, 458752
    s_cmp_eq_u32 s0, 3670016
    s_cselect_b32 s0, 0, s0
    buffer_load_dwordx4 v55, s[20:23], s0 offen lds
    buffer_load_dwordx4 v56, s[20:23], s0 offen offset:1024 lds
    buffer_load_dwordx4 v57, s[20:23], s0 offen offset:2048 lds
    buffer_load_dwordx4 v58, s[20:23], s0 offen offset:3072 lds
    s_waitcnt vmcnt(8)
    v_cmp_ne_u32 vcc, s57, v18
    s_cbranch_vccz L_pollok0
    s_mov_b32 s60, 0
L_poll0:
    s_sleep 4
    buffer_load_dword v18, v20, s[28:31], 0 offen sc1
    s_add_u32 s60, s60, 1
    s_waitcnt vmcnt(0)
    v_cmp_ne_u32 vcc, s57, v18
    s_cbranch_vccz L_pollok0
    s_cmp_lt_u32 s60, 20000
    s_cbranch_scc1 L_poll0
L_pollok0:
    s_barrier
    buffer_load_dwordx4 a[0:3], v78, s[28:31], s1 offen offset:0 sc1
    buffer_load_dwordx4 a[4:7], v78, s[28:31], s1 offen offset:256 sc1
    buffer_load_dwordx4 a[8:11], v78, s[28:31], s1 offen offset:2048 sc1
    buffer_load_dwordx4 a[12:15], v78, s[28:31], s1 offen offset:2304 sc1
    buffer_load_dword v76, v77, s[28:31], 0 offen sc1
    s_add_u32 s1, s1, 8192
    s_and_b32 s1, s1, 0xffff
    buffer_load_dwordx4 a[16:19], v78, s[28:31], s1 offen offset:0 sc1
    buffer_load_dwordx4 a[20:23], v78, s[28:31], s1 offen offset:256 sc1
    buffer_load_dwordx4 a[24:27], v78, s[28:31], s1 offen offset:2048 sc1
    buffer_load_dwordx4 a[28:31], v78, s[28:31], s1 offen offset:2304 sc1
    s_add_u32 s1, s1, 8192
    s_and_b32 s1, s1, 0xffff
    buffer_load_dwordx4 a[32:35], v78, s[28:31], s1 offen offset:0 sc1
    buffer_load_dwordx4 a[36:39], v78, s[28:31], s1 offen offset:256 sc1
    buffer_load_dwordx4 a[40:43], v78, s[28:31], s1 offen offset:2048 sc1
    buffer_load_dwordx4 a[44:47], v78, s[28:31], s1 offen offset:2304 sc1
    ds_read_b64_tr_b16 a[200:201], v31 offset:0
    ds_read_b64_tr_b16 a[202:203], v31 offset:2048
    ds_read_b64_tr_b16 a[204:205], v33 offset:0
    ds_read_b64_tr_b16 a[206:207], v33 offset:2048
    ds_read_b64_tr_b16 a[208:209], v32 offset:0
    ds_read_b64_tr_b16 a[210:211], v32 offset:2048
    ds_read_b64_tr_b16 a[212:213], v34 offset:0
    ds_read_b64_tr_b16 a[214:215], v34 offset:2048
    ds_read_b64_tr_b16 a[216:217], v31 offset:4096
    ds_read_b64_tr_b16 a[218:219], v31 offset:6144
    ds_read_b64_tr_b16 a[220:221], v33 offset:4096
    ds_read_b64_tr_b16 a[222:223], v33 offset:6144
    s_waitcnt vmcnt(11) lgkmcnt(8)
    v_mfma_f32_16x16x32_bf16 v[182:185], a[200:203], a[0:3], 0
    ds_read_b64_tr_b16 a[224:225], v32 offset:4096
    s_add_u32 s1, s1, 8192
    v_mfma_f32_16x16x32_bf16 v[190:193], a[200:203], a[4:7], 0
    ds_read_b64_tr_b16 a[226:227], v32 offset:6144
    s_and_b32 s1, s1, 0xffff
    s_mov_b32 s70, 0xaaaaaaaa
    s_mov_b32 s71, 0xaaaaaaaa
    s_mov_b32 s72, 0xfff0ffff
    s_mov_b32 s73, 0xf000ff00
    s_mov_b32 s74, 0xffc0fffc
    v_mfma_f32_16x16x32_bf16 v[198:201], a[204:207], a[0:3], 0
    ds_read_b64_tr_b16 a[228:229], v34 offset:4096
    buffer_load_dwordx4 a[48:51], v78, s[28:31], s1 offen offset:0 sc1
    v_mfma_f32_16x16x32_bf16 v[206:209], a[204:207], a[4:7], 0
    ds_read_b64_tr_b16 a[230:231], v34 offset:6144
    s_mov_b32 s75, 0xc000fc00
    s_waitcnt lgkmcnt(8)
    v_mfma_f32_16x16x32_bf16 v[186:189], a[208:211], a[0:3], 0
    ds_read_b64_tr_b16 a[200:201], v31 offset:16384
    s_mov_b32 s83, 0x3e8b97f6
    v_mfma_f32_16x16x32_bf16 v[194:197], a[208:211], a[4:7], 0
    ds_read_b64_tr_b16 a[202:203], v31 offset:18432
    buffer_load_dwordx4 a[52:55], v78, s[28:31], s1 offen offset:256 sc1
    v_lshlrev_b32 v13, 2, v2
    v_mfma_f32_16x16x32_bf16 v[202:205], a[212:215], a[0:3], 0
    ds_read_b64_tr_b16 a[204:205], v33 offset:16384
    v_and_b32 v14, 1, v1
    v_mfma_f32_16x16x32_bf16 v[210:213], a[212:215], a[4:7], 0
    ds_read_b64_tr_b16 a[206:207], v33 offset:18432
    s_waitcnt vmcnt(11) lgkmcnt(8)
    v_mfma_f32_16x16x32_bf16 v[182:185], a[216:219], a[8:11], v[182:185]
    ds_read_b64_tr_b16 a[208:209], v32 offset:16384
    buffer_load_dwordx4 a[56:59], v78, s[28:31], s1 offen offset:2048 sc1
    v_mfma_f32_16x16x32_bf16 v[190:193], a[216:219], a[12:15], v[190:193]
    ds_read_b64_tr_b16 a[210:211], v32 offset:18432
    v_lshl_add_u32 v14, v3, 2, v14
    v_mfma_f32_16x16x32_bf16 v[198:201], a[220:223], a[8:11], v[198:201]
    ds_read_b64_tr_b16 a[212:213], v34 offset:16384
    v_lshlrev_b32 v14, 2, v14
    v_mfma_f32_16x16x32_bf16 v[206:209], a[220:223], a[12:15], v[206:209]
    ds_read_b64_tr_b16 a[214:215], v34 offset:18432
    s_waitcnt lgkmcnt(8)
    v_mfma_f32_16x16x32_bf16 v[186:189], a[224:227], a[8:11], v[186:189]
    ds_read_b64_tr_b16 a[216:217], v31 offset:20480
    buffer_load_dwordx4 a[60:63], v78, s[28:31], s1 offen offset:2304 sc1
    v_mfma_f32_16x16x32_bf16 v[194:197], a[224:227], a[12:15], v[194:197]
    ds_read_b64_tr_b16 a[218:219], v31 offset:22528
    s_add_u32 m0, s58, 131072
    v_add_u32 v15, 64, v14
    v_mfma_f32_16x16x32_bf16 v[202:205], a[228:231], a[8:11], v[202:205]
    ds_read_b64_tr_b16 a[220:221], v33 offset:20480
    s_add_u32 s0, s0, 458752
    v_mfma_f32_16x16x32_bf16 v[210:213], a[228:231], a[12:15], v[210:213]
    ds_read_b64_tr_b16 a[222:223], v33 offset:22528
    s_waitcnt vmcnt(10) lgkmcnt(8)
    v_mfma_f32_16x16x32_bf16 v[182:185], a[200:203], a[16:19], v[182:185]
    ds_read_b64_tr_b16 a[224:225], v32 offset:20480
    s_cmp_eq_u32 s0, 3670016
    s_cselect_b32 s0, 0, s0
    v_xor_b32 v55, 128, v55
    buffer_load_dwordx4 v55, s[20:23], s0 offen lds
    v_mfma_f32_16x16x32_bf16 v[190:193], a[200:203], a[20:23], v[190:193]
    ds_read_b64_tr_b16 a[226:227], v32 offset:22528
    v_xor_b32 v56, 128, v56
    v_cndmask_b32 v16, v14, v15, s[72:73]
    v_mfma_f32_16x16x32_bf16 v[198:201], a[204:207], a[16:19], v[198:201]
    ds_read_b64_tr_b16 a[228:229], v34 offset:20480
    buffer_load_dwordx4 v56, s[20:23], s0 offen offset:1024 lds
    v_mfma_f32_16x16x32_bf16 v[206:209], a[204:207], a[20:23], v[206:209]
    ds_read_b64_tr_b16 a[230:231], v34 offset:22528
    v_cndmask_b32 v14, v14, v15, s[74:75]
    s_waitcnt lgkmcnt(8)
    v_mfma_f32_16x16x32_bf16 v[186:189], a[208:211], a[16:19], v[186:189]
    ds_read_b64_tr_b16 a[200:201], v31 offset:32768
    v_xor_b32 v57, 128, v57
    v_mfma_f32_16x16x32_bf16 v[194:197], a[208:211], a[20:23], v[194:197]
    ds_read_b64_tr_b16 a[202:203], v31 offset:34816
    buffer_load_dwordx4 v57, s[20:23], s0 offen offset:2048 lds
    ds_bpermute_b32 v25, v13, v76 offset:64
    v_mfma_f32_16x16x32_bf16 v[202:205], a[212:215], a[16:19], v[202:205]
    ds_read_b64_tr_b16 a[204:205], v33 offset:32768
    v_xor_b32 v58, 128, v58
    v_mfma_f32_16x16x32_bf16 v[210:213], a[212:215], a[20:23], v[210:213]
    ds_read_b64_tr_b16 a[206:207], v33 offset:34816
    ds_bpermute_b32 v27, v16, v76 offset:0
    s_waitcnt vmcnt(11) lgkmcnt(10)
    v_mfma_f32_16x16x32_bf16 v[182:185], a[216:219], a[24:27], v[182:185]
    ds_read_b64_tr_b16 a[208:209], v32 offset:32768
    ds_bpermute_b32 v28, v14, v76 offset:8
    v_mfma_f32_16x16x32_bf16 v[190:193], a[216:219], a[28:31], v[190:193]
    ds_read_b64_tr_b16 a[210:211], v32 offset:34816
    buffer_load_dwordx4 v58, s[20:23], s0 offen offset:3072 lds
    ds_bpermute_b32 v26, v13, v76 offset:128
    v_mfma_f32_16x16x32_bf16 v[198:201], a[220:223], a[24:27], v[198:201]
    ds_read_b64_tr_b16 a[212:213], v34 offset:32768
    s_add_u32 s1, s1, 8192
    v_mfma_f32_16x16x32_bf16 v[206:209], a[220:223], a[28:31], v[206:209]
    ds_read_b64_tr_b16 a[214:215], v34 offset:34816
    s_waitcnt lgkmcnt(12)
    v_mfma_f32_16x16x32_bf16 v[186:189], a[224:227], a[24:27], v[186:189]
    ds_read_b64_tr_b16 a[216:217], v31 offset:36864
    s_and_b32 s1, s1, 0xffff
    v_mfma_f32_16x16x32_bf16 v[194:197], a[224:227], a[28:31], v[194:197]
    ds_read_b64_tr_b16 a[218:219], v31 offset:38912
    buffer_load_dwordx4 a[64:67], v78, s[28:31], s1 offen offset:0 sc1
    ds_bpermute_b32 v29, v16, v76 offset:64
    v_mfma_f32_16x16x32_bf16 v[202:205], a[228:231], a[24:27], v[202:205]
    ds_read_b64_tr_b16 a[220:221], v33 offset:36864
    ds_bpermute_b32 v30, v14, v76 offset:72
    v_mfma_f32_16x16x32_bf16 v[210:213], a[228:231], a[28:31], v[210:213]
    ds_read_b64_tr_b16 a[222:223], v33 offset:38912
    s_waitcnt vmcnt(11) lgkmcnt(13)
    v_mfma_f32_16x16x32_bf16 v[182:185], a[200:203], a[32:35], v[182:185]
    ds_read_b64_tr_b16 a[224:225], v32 offset:36864
    buffer_load_dwordx4 a[68:71], v78, s[28:31], s1 offen offset:256 sc1
    v_mfma_f32_16x16x32_bf16 v[190:193], a[200:203], a[36:39], v[190:193]
    ds_read_b64_tr_b16 a[226:227], v32 offset:38912
    v_mfma_f32_16x16x32_bf16 v[198:201], a[204:207], a[32:35], v[198:201]
    ds_read_b64_tr_b16 a[228:229], v34 offset:36864
    v_mfma_f32_16x16x32_bf16 v[206:209], a[204:207], a[36:39], v[206:209]
    ds_read_b64_tr_b16 a[230:231], v34 offset:38912
    s_waitcnt lgkmcnt(10)
    v_mfma_f32_16x16x32_bf16 v[186:189], a[208:211], a[32:35], v[186:189]
    s_barrier
    ds_read_b64_tr_b16 a[200:201], v31 offset:49152
    buffer_load_dwordx4 a[72:75], v78, s[28:31], s1 offen offset:2048 sc1
    v_mfma_f32_16x16x32_bf16 v[194:197], a[208:211], a[36:39], v[194:197]
    ds_read_b64_tr_b16 a[202:203], v31 offset:51200
    v_mfma_f32_16x16x32_bf16 v[202:205], a[212:215], a[32:35], v[202:205]
    ds_read_b64_tr_b16 a[204:205], v33 offset:49152
    buffer_load_dwordx4 a[76:79], v78, s[28:31], s1 offen offset:2304 sc1
    v_mfma_f32_16x16x32_bf16 v[210:213], a[212:215], a[36:39], v[210:213]
    ds_read_b64_tr_b16 a[206:207], v33 offset:51200
    s_waitcnt vmcnt(12) lgkmcnt(8)
    v_mfma_f32_16x16x32_bf16 v[182:185], a[216:219], a[40:43], v[182:185]
    ds_read_b64_tr_b16 a[208:209], v32 offset:49152
    s_add_u32 m0, s58, 147456
    v_mfma_f32_16x16x32_bf16 v[190:193], a[216:219], a[44:47], v[190:193]
    ds_read_b64_tr_b16 a[210:211], v32 offset:51200
    s_add_u32 s0, s0, 458752
    v_mul_f32 v25, s83, v25
    v_mfma_f32_16x16x32_bf16 v[198:201], a[220:223], a[40:43], v[198:201]
    ds_read_b64_tr_b16 a[212:213], v34 offset:49152
    s_cmp_eq_u32 s0, 3670016
    v_mfma_f32_16x16x32_bf16 v[206:209], a[220:223], a[44:47], v[206:209]
    ds_read_b64_tr_b16 a[214:215], v34 offset:51200
    s_cselect_b32 s0, 0, s0
    buffer_load_dwordx4 v55, s[20:23], s0 offen lds
    s_waitcnt lgkmcnt(8)
    v_mfma_f32_16x16x32_bf16 v[186:189], a[224:227], a[40:43], v[186:189]
    ds_read_b64_tr_b16 a[216:217], v31 offset:53248
    v_mul_f32 v26, s83, v26
    v_mfma_f32_16x16x32_bf16 v[194:197], a[224:227], a[44:47], v[194:197]
    ds_read_b64_tr_b16 a[218:219], v31 offset:55296
    buffer_load_dwordx4 v56, s[20:23], s0 offen offset:1024 lds
    s_cmp_eq_u32 s49, 0
    s_cselect_b64 s[76:77], 0, -1
    v_mfma_f32_16x16x32_bf16 v[202:205], a[228:231], a[40:43], v[202:205]
    ds_read_b64_tr_b16 a[220:221], v33 offset:53248
    v_mov_b32 v13, 0xffff
    v_mfma_f32_16x16x32_bf16 v[210:213], a[228:231], a[44:47], v[210:213]
    ds_read_b64_tr_b16 a[222:223], v33 offset:55296
    s_waitcnt vmcnt(12) lgkmcnt(8)
    v_mfma_f32_16x16x32_bf16 v[182:185], a[200:203], a[48:51], v[182:185]
    ds_read_b64_tr_b16 a[224:225], v32 offset:53248
    buffer_load_dwordx4 v57, s[20:23], s0 offen offset:2048 lds
    v_mfma_f32_16x16x32_bf16 v[190:193], a[200:203], a[52:55], v[190:193]
    ds_read_b64_tr_b16 a[226:227], v32 offset:55296
    v_mov_b32 v14, 0xffff0000
    v_mfma_f32_16x16x32_bf16 v[198:201], a[204:207], a[48:51], v[198:201]
    ds_read_b64_tr_b16 a[228:229], v34 offset:53248
    v_cndmask_b32 v13, v13, v14, s[70:71]
    v_mfma_f32_16x16x32_bf16 v[206:209], a[204:207], a[52:55], v[206:209]
    ds_read_b64_tr_b16 a[230:231], v34 offset:55296
    s_waitcnt lgkmcnt(8)
    v_mfma_f32_16x16x32_bf16 v[186:189], a[208:211], a[48:51], v[186:189]
    ds_read_b64_tr_b16 a[200:201], v35 offset:0
    buffer_load_dwordx4 v58, s[20:23], s0 offen offset:3072 lds
    v_mfma_f32_16x16x32_bf16 v[194:197], a[208:211], a[52:55], v[194:197]
    ds_read_b64_tr_b16 a[202:203], v35 offset:2048
    s_add_u32 s1, s1, 8192
    v_cndmask_b32 v104, v13, 0, s[72:73]
    v_mfma_f32_16x16x32_bf16 v[202:205], a[212:215], a[48:51], v[202:205]
    ds_read_b64_tr_b16 a[204:205], v37 offset:0
    s_and_b32 s1, s1, 0xffff
    v_mfma_f32_16x16x32_bf16 v[210:213], a[212:215], a[52:55], v[210:213]
    ds_read_b64_tr_b16 a[206:207], v37 offset:2048
    buffer_load_dwordx4 a[80:83], v78, s[28:31], s1 offen offset:0 sc1
    s_waitcnt vmcnt(13) lgkmcnt(8)
    v_mfma_f32_16x16x32_bf16 v[182:185], a[216:219], a[56:59], v[182:185]
    ds_read_b64_tr_b16 a[208:209], v36 offset:0
    v_cndmask_b32 v106, 0, v13, s[72:73]
    v_mfma_f32_16x16x32_bf16 v[190:193], a[216:219], a[60:63], v[190:193]
    ds_read_b64_tr_b16 a[210:211], v36 offset:2048
    buffer_load_dwordx4 a[84:87], v78, s[28:31], s1 offen offset:256 sc1
    v_cndmask_b32 v105, v13, 0, s[74:75]
    v_mfma_f32_16x16x32_bf16 v[198:201], a[220:223], a[56:59], v[198:201]
    ds_read_b64_tr_b16 a[212:213], v38 offset:0
    v_cndmask_b32 v107, 0, v13, s[74:75]
    v_mfma_f32_16x16x32_bf16 v[206:209], a[220:223], a[60:63], v[206:209]
    ds_read_b64_tr_b16 a[214:215], v38 offset:2048
    s_waitcnt lgkmcnt(8)
    v_mfma_f32_16x16x32_bf16 v[186:189], a[224:227], a[56:59], v[186:189]
    ds_read_b64_tr_b16 a[216:217], v35 offset:4096
    buffer_load_dwordx4 a[88:91], v78, s[28:31], s1 offen offset:2048 sc1
    v_mfma_f32_16x16x32_bf16 v[194:197], a[224:227], a[60:63], v[194:197]
    ds_read_b64_tr_b16 a[218:219], v35 offset:6144
    v_mov_b32 v84, 0xf149f2ca
    v_mfma_f32_16x16x32_bf16 v[202:205], a[228:231], a[56:59], v[202:205]
    ds_read_b64_tr_b16 a[220:221], v37 offset:4096
    s_mov_b32 s83, 0x3e8b97f6
    v_mfma_f32_16x16x32_bf16 v[210:213], a[228:231], a[60:63], v[210:213]
    ds_read_b64_tr_b16 a[222:223], v37 offset:6144
    s_waitcnt vmcnt(9) lgkmcnt(8)
    v_mfma_f32_16x16x32_bf16 v[182:185], a[200:203], a[64:67], v[182:185]
    ds_read_b64_tr_b16 a[224:225], v36 offset:4096
    buffer_load_dwordx4 a[92:95], v78, s[28:31], s1 offen offset:2304 sc1
    v_mfma_f32_16x16x32_bf16 v[190:193], a[200:203], a[68:71], v[190:193]
    ds_read_b64_tr_b16 a[226:227], v36 offset:6144
    s_add_u32 s1, s1, 8192
    s_mov_b32 s78, 0xbdd2d3e8
    v_mfma_f32_16x16x32_bf16 v[198:201], a[204:207], a[64:67], v[198:201]
    ds_read_b64_tr_b16 a[228:229], v38 offset:4096
    s_and_b32 s1, s1, 0xffff
    v_mfma_f32_16x16x32_bf16 v[206:209], a[204:207], a[68:71], v[206:209]
    ds_read_b64_tr_b16 a[230:231], v38 offset:6144
    s_mov_b32 s79, 0xbdd2d3e8
    s_waitcnt lgkmcnt(8)
    v_mfma_f32_16x16x32_bf16 v[186:189], a[208:211], a[64:67], v[186:189]
    s_barrier
    s_load_dword s14, s[44:45], s15
    ds_read_b64_tr_b16 a[200:201], v35 offset:16384
    buffer_load_dwordx4 a[96:99], v78, s[28:31], s1 offen offset:0 sc1
    v_mfma_f32_16x16x32_bf16 v[194:197], a[208:211], a[68:71], v[194:197]
    ds_read_b64_tr_b16 a[202:203], v35 offset:18432
    s_mov_b32 s80, 1.0
    v_mfma_f32_16x16x32_bf16 v[202:205], a[212:215], a[64:67], v[202:205]
    ds_read_b64_tr_b16 a[204:205], v37 offset:16384
    buffer_load_dwordx4 a[100:103], v78, s[28:31], s1 offen offset:256 sc1
    v_mfma_f32_16x16x32_bf16 v[210:213], a[212:215], a[68:71], v[210:213]
    ds_read_b64_tr_b16 a[206:207], v37 offset:18432
    s_mov_b32 s81, 1.0
    s_waitcnt vmcnt(10) lgkmcnt(8)
    v_mfma_f32_16x16x32_bf16 v[182:185], a[216:219], a[72:75], v[182:185]
    ds_read_b64_tr_b16 a[208:209], v36 offset:16384
    v_mov_b32 v108, 0xc0135761
    v_mfma_f32_16x16x32_bf16 v[190:193], a[216:219], a[76:79], v[190:193]
    ds_read_b64_tr_b16 a[210:211], v36 offset:18432
    buffer_load_dwordx4 a[104:107], v78, s[28:31], s1 offen offset:2048 sc1
    v_mov_b32 v109, 0xc0135761
    v_mfma_f32_16x16x32_bf16 v[198:201], a[220:223], a[72:75], v[198:201]
    ds_read_b64_tr_b16 a[212:213], v38 offset:16384
    v_lshrrev_b32 v13, 1, v2
    v_mfma_f32_16x16x32_bf16 v[206:209], a[220:223], a[76:79], v[206:209]
    ds_read_b64_tr_b16 a[214:215], v38 offset:18432
    s_waitcnt lgkmcnt(8)
    v_mfma_f32_16x16x32_bf16 v[186:189], a[224:227], a[72:75], v[186:189]
    ds_read_b64_tr_b16 a[216:217], v35 offset:20480
    buffer_load_dwordx4 a[108:111], v78, s[28:31], s1 offen offset:2304 sc1
    v_mfma_f32_16x16x32_bf16 v[194:197], a[224:227], a[76:79], v[194:197]
    ds_read_b64_tr_b16 a[218:219], v35 offset:22528
    s_add_u32 s1, s1, 8192
    v_lshlrev_b32 v14, 1, v3
    v_mfma_f32_16x16x32_bf16 v[202:205], a[228:231], a[72:75], v[202:205]
    ds_read_b64_tr_b16 a[220:221], v37 offset:20480
    s_and_b32 s1, s1, 0xffff
    v_mfma_f32_16x16x32_bf16 v[210:213], a[228:231], a[76:79], v[210:213]
    ds_read_b64_tr_b16 a[222:223], v37 offset:22528
    s_waitcnt vmcnt(6) lgkmcnt(8)
    v_mfma_f32_16x16x32_bf16 v[182:185], a[200:203], a[80:83], v[182:185]
    ds_read_b64_tr_b16 a[224:225], v36 offset:20480
    buffer_load_dwordx4 a[112:115], v78, s[28:31], s1 offen offset:0 sc1
    v_mfma_f32_16x16x32_bf16 v[190:193], a[200:203], a[84:87], v[190:193]
    ds_read_b64_tr_b16 a[226:227], v36 offset:22528
    v_sub_u32 v13, v13, v14
    v_mfma_f32_16x16x32_bf16 v[198:201], a[204:207], a[80:83], v[198:201]
    ds_read_b64_tr_b16 a[228:229], v38 offset:20480
    buffer_load_dwordx4 a[116:119], v78, s[28:31], s1 offen offset:256 sc1
    v_mfma_f32_16x16x32_bf16 v[206:209], a[204:207], a[84:87], v[206:209]
    ds_read_b64_tr_b16 a[230:231], v38 offset:22528
    v_mov_b32 v14, 0x3f80
    s_waitcnt lgkmcnt(8)
    v_mfma_f32_16x16x32_bf16 v[186:189], a[208:211], a[80:83], v[186:189]
    ds_read_b64_tr_b16 a[200:201], v35 offset:32768
    v_cndmask_b32 v14, v14, 1.0, s[70:71]
    v_mfma_f32_16x16x32_bf16 v[194:197], a[208:211], a[84:87], v[194:197]
    ds_read_b64_tr_b16 a[202:203], v35 offset:34816
    buffer_load_dwordx4 a[120:123], v78, s[28:31], s1 offen offset:2048 sc1
    v_cmp_eq_i32 vcc, 0, v13
    v_mfma_f32_16x16x32_bf16 v[202:205], a[212:215], a[80:83], v[202:205]
    ds_read_b64_tr_b16 a[204:205], v37 offset:32768
    v_accvgpr_write_b32 a248, 0
    v_mfma_f32_16x16x32_bf16 v[210:213], a[212:215], a[84:87], v[210:213]
    ds_read_b64_tr_b16 a[206:207], v37 offset:34816
    s_waitcnt vmcnt(7) lgkmcnt(8)
    v_mfma_f32_16x16x32_bf16 v[182:185], a[216:219], a[88:91], v[182:185]
    ds_read_b64_tr_b16 a[208:209], v36 offset:32768
    buffer_load_dwordx4 a[124:127], v78, s[28:31], s1 offen offset:2304 sc1
    v_mfma_f32_16x16x32_bf16 v[190:193], a[216:219], a[92:95], v[190:193]
    ds_read_b64_tr_b16 a[210:211], v36 offset:34816
    s_add_u32 m0, s58, 0
    v_accvgpr_write_b32 a252, 0
    v_mfma_f32_16x16x32_bf16 v[198:201], a[220:223], a[88:91], v[198:201]
    ds_read_b64_tr_b16 a[212:213], v38 offset:32768
    s_add_u32 s0, s0, 458752
    v_mfma_f32_16x16x32_bf16 v[206:209], a[220:223], a[92:95], v[206:209]
    ds_read_b64_tr_b16 a[214:215], v38 offset:34816
    s_waitcnt lgkmcnt(8)
    v_mfma_f32_16x16x32_bf16 v[186:189], a[224:227], a[88:91], v[186:189]
    ds_read_b64_tr_b16 a[216:217], v35 offset:36864
    s_cmp_eq_u32 s0, 3670016
    v_mfma_f32_16x16x32_bf16 v[194:197], a[224:227], a[92:95], v[194:197]
    ds_read_b64_tr_b16 a[218:219], v35 offset:38912
    s_cselect_b32 s0, 0, s0
    buffer_load_dwordx4 v55, s[20:23], s0 offen lds
    v_cndmask_b32 v15, 0, v14, vcc
    v_mfma_f32_16x16x32_bf16 v[202:205], a[228:231], a[88:91], v[202:205]
    ds_read_b64_tr_b16 a[220:221], v37 offset:36864
    v_accvgpr_write_b32 a250, v15
    v_mfma_f32_16x16x32_bf16 v[210:213], a[228:231], a[92:95], v[210:213]
    ds_read_b64_tr_b16 a[222:223], v37 offset:38912
    s_waitcnt vmcnt(7) lgkmcnt(8)
    v_mfma_f32_16x16x32_bf16 v[182:185], a[200:203], a[96:99], v[182:185]
    ds_read_b64_tr_b16 a[224:225], v36 offset:36864
    buffer_load_dwordx4 v56, s[20:23], s0 offen offset:1024 lds
    v_mfma_f32_16x16x32_bf16 v[190:193], a[200:203], a[100:103], v[190:193]
    ds_read_b64_tr_b16 a[226:227], v36 offset:38912
    v_cmp_eq_i32 vcc, 1, v13
    v_mfma_f32_16x16x32_bf16 v[198:201], a[204:207], a[96:99], v[198:201]
    ds_read_b64_tr_b16 a[228:229], v38 offset:36864
    buffer_load_dwordx4 v57, s[20:23], s0 offen offset:2048 lds
    v_mfma_f32_16x16x32_bf16 v[206:209], a[204:207], a[100:103], v[206:209]
    ds_read_b64_tr_b16 a[230:231], v38 offset:38912
    v_accvgpr_write_b32 a249, 0
    s_waitcnt lgkmcnt(8)
    v_mfma_f32_16x16x32_bf16 v[186:189], a[208:211], a[96:99], v[186:189]
    s_barrier
    ds_read_b64_tr_b16 a[200:201], v35 offset:49152
    buffer_load_dwordx4 v58, s[20:23], s0 offen offset:3072 lds
    v_mfma_f32_16x16x32_bf16 v[194:197], a[208:211], a[100:103], v[194:197]
    ds_read_b64_tr_b16 a[202:203], v35 offset:51200
    s_add_u32 m0, s58, 16384
    v_accvgpr_write_b32 a253, 0
    v_mfma_f32_16x16x32_bf16 v[202:205], a[212:215], a[96:99], v[202:205]
    ds_read_b64_tr_b16 a[204:205], v37 offset:49152
    s_add_u32 s0, s0, 458752
    v_mfma_f32_16x16x32_bf16 v[210:213], a[212:215], a[100:103], v[210:213]
    ds_read_b64_tr_b16 a[206:207], v37 offset:51200
    s_waitcnt vmcnt(8) lgkmcnt(8)
    v_mfma_f32_16x16x32_bf16 v[182:185], a[216:219], a[104:107], v[182:185]
    ds_read_b64_tr_b16 a[208:209], v36 offset:49152
    s_cmp_eq_u32 s0, 3670016
    v_mfma_f32_16x16x32_bf16 v[190:193], a[216:219], a[108:111], v[190:193]
    ds_read_b64_tr_b16 a[210:211], v36 offset:51200
    s_cselect_b32 s0, 0, s0
    buffer_load_dwordx4 v55, s[20:23], s0 offen lds
    v_cndmask_b32 v15, 0, v14, vcc
    v_mfma_f32_16x16x32_bf16 v[198:201], a[220:223], a[104:107], v[198:201]
    ds_read_b64_tr_b16 a[212:213], v38 offset:49152
    v_accvgpr_write_b32 a251, v15
    v_mfma_f32_16x16x32_bf16 v[206:209], a[220:223], a[108:111], v[206:209]
    ds_read_b64_tr_b16 a[214:215], v38 offset:51200
    s_waitcnt lgkmcnt(8)
    v_mfma_f32_16x16x32_bf16 v[186:189], a[224:227], a[104:107], v[186:189]
    ds_read_b64_tr_b16 a[216:217], v35 offset:53248
    buffer_load_dwordx4 v56, s[20:23], s0 offen offset:1024 lds
    v_mfma_f32_16x16x32_bf16 v[194:197], a[224:227], a[108:111], v[194:197]
    ds_read_b64_tr_b16 a[218:219], v35 offset:55296
    v_mfma_f32_16x16x32_bf16 v[202:205], a[228:231], a[104:107], v[202:205]
    ds_read_b64_tr_b16 a[220:221], v37 offset:53248
    buffer_load_dwordx4 v57, s[20:23], s0 offen offset:2048 lds
    v_mfma_f32_16x16x32_bf16 v[210:213], a[228:231], a[108:111], v[210:213]
    ds_read_b64_tr_b16 a[222:223], v37 offset:55296
    s_waitcnt vmcnt(9) lgkmcnt(8)
    v_mfma_f32_16x16x32_bf16 v[182:185], a[200:203], a[112:115], v[182:185]
    ds_read_b64_tr_b16 a[224:225], v36 offset:53248
    v_mfma_f32_16x16x32_bf16 v[190:193], a[200:203], a[116:119], v[190:193]
    ds_read_b64_tr_b16 a[226:227], v36 offset:55296
    buffer_load_dwordx4 v58, s[20:23], s0 offen offset:3072 lds
    v_mfma_f32_16x16x32_bf16 v[198:201], a[204:207], a[112:115], v[198:201]
    ds_read_b64_tr_b16 a[228:229], v38 offset:53248
    s_add_u32 m0, s58, 32768
    v_mfma_f32_16x16x32_bf16 v[206:209], a[204:207], a[116:119], v[206:209]
    ds_read_b64_tr_b16 a[230:231], v38 offset:55296
    s_waitcnt lgkmcnt(8)
    v_mfma_f32_16x16x32_bf16 v[186:189], a[208:211], a[112:115], v[186:189]
    s_waitcnt lgkmcnt(0)
    s_cmp_ge_u32 s14, 14
    s_cbranch_scc1 L_pollok1
    s_mov_b32 s60, 0
L_poll1:
    s_sleep 8
    buffer_load_dword v18, off, s[44:47], s15 sc1
    s_add_u32 s60, s60, 1
    s_waitcnt vmcnt(0)
    v_readfirstlane_b32 s14, v18
    s_nop 0
    s_cmp_ge_u32 s14, 14
    s_cbranch_scc1 L_pollok1
    s_cmp_lt_u32 s60, 20000
    s_cbranch_scc1 L_poll1
L_pollok1:
    ds_read_b64_tr_b16 a[200:201], v39 offset:0
    s_add_u32 s0, s0, 458752
    v_mfma_f32_16x16x32_bf16 v[194:197], a[208:211], a[116:119], v[194:197]
    ds_read_b64_tr_b16 a[202:203], v39 offset:2048
    s_cmp_eq_u32 s0, 3670016
    s_cselect_b32 s0, 0, s0
    buffer_load_dwordx4 v55, s[20:23], s0 offen lds
    v_mfma_f32_16x16x32_bf16 v[202:205], a[212:215], a[112:115], v[202:205]
    ds_read_b64_tr_b16 a[204:205], v41 offset:0
    v_mfma_f32_16x16x32_bf16 v[210:213], a[212:215], a[116:119], v[210:213]
    ds_read_b64_tr_b16 a[206:207], v41 offset:2048
    s_waitcnt vmcnt(9)
    v_mfma_f32_16x16x32_bf16 v[182:185], a[216:219], a[120:123], v[182:185]
    ds_read_b64_tr_b16 a[208:209], v40 offset:0
    buffer_load_dwordx4 v56, s[20:23], s0 offen offset:1024 lds
    v_mfma_f32_16x16x32_bf16 v[190:193], a[216:219], a[124:127], v[190:193]
    ds_read_b64_tr_b16 a[210:211], v40 offset:2048
    v_mfma_f32_16x16x32_bf16 v[198:201], a[220:223], a[120:123], v[198:201]
    ds_read_b64_tr_b16 a[212:213], v42 offset:0
    buffer_load_dwordx4 v57, s[20:23], s0 offen offset:2048 lds
    v_mfma_f32_16x16x32_bf16 v[206:209], a[220:223], a[124:127], v[206:209]
    ds_read_b64_tr_b16 a[214:215], v42 offset:2048
    v_mfma_f32_16x16x32_bf16 v[186:189], a[224:227], a[120:123], v[186:189]
    ds_read_b64_tr_b16 a[216:217], v39 offset:4096
    v_mfma_f32_16x16x32_bf16 v[194:197], a[224:227], a[124:127], v[194:197]
    ds_read_b64_tr_b16 a[218:219], v39 offset:6144
    v_mfma_f32_16x16x32_bf16 v[202:205], a[228:231], a[120:123], v[202:205]
    ds_read_b64_tr_b16 a[220:221], v41 offset:4096
    buffer_load_dwordx4 v58, s[20:23], s0 offen offset:3072 lds
    v_mfma_f32_16x16x32_bf16 v[210:213], a[228:231], a[124:127], v[210:213]
    ds_read_b64_tr_b16 a[222:223], v41 offset:6144
    s_waitcnt lgkmcnt(8)
    v_mfma_f32_16x16x32_bf16 v[150:153], a[200:203], a[0:3], v[150:153]
    ds_read_b64_tr_b16 a[224:225], v40 offset:4096
    s_add_u32 m0, s58, 49152
    v_mfma_f32_16x16x32_bf16 v[158:161], a[200:203], a[4:7], v[158:161]
    ds_read_b64_tr_b16 a[226:227], v40 offset:6144
    s_add_u32 s0, s0, 458752
    v_mfma_f32_16x16x32_bf16 v[166:169], a[204:207], a[0:3], 0
    ds_read_b64_tr_b16 a[228:229], v42 offset:4096
    s_cmp_eq_u32 s0, 3670016
    s_cselect_b32 s0, 0, s0
    buffer_load_dwordx4 v55, s[20:23], s0 offen lds
    v_mfma_f32_16x16x32_bf16 v[174:177], a[204:207], a[4:7], 0
    ds_read_b64_tr_b16 a[230:231], v42 offset:6144
    v_cvt_pk_bf16_f32 v182, v182, v183
    v_cvt_pk_bf16_f32 v183, v184, v185
    v_cvt_pk_bf16_f32 v184, v186, v187
    s_waitcnt lgkmcnt(8)
    v_mfma_f32_16x16x32_bf16 v[154:157], a[208:211], a[0:3], v[154:157]
    s_waitcnt vmcnt(5)
    s_barrier
    ds_read_b64_tr_b16 a[200:201], v39 offset:16384
    buffer_load_dwordx4 v56, s[20:23], s0 offen offset:1024 lds
    v_mfma_f32_16x16x32_bf16 v[162:165], a[208:211], a[4:7], v[162:165]
    ds_read_b64_tr_b16 a[202:203], v39 offset:18432
    v_cvt_pk_bf16_f32 v185, v188, v189
    buffer_store_dwordx4 v[182:185], v23, s[28:31], 0 offen offset:0 sc1
    v_cvt_pk_bf16_f32 v190, v190, v191
    v_cvt_pk_bf16_f32 v191, v192, v193
    v_cvt_pk_bf16_f32 v192, v194, v195
    v_mfma_f32_16x16x32_bf16 v[170:173], a[212:215], a[0:3], 0
    ds_read_b64_tr_b16 a[204:205], v41 offset:16384
    v_cvt_pk_bf16_f32 v193, v196, v197
    v_mfma_f32_16x16x32_bf16 v[178:181], a[212:215], a[4:7], 0
    ds_read_b64_tr_b16 a[206:207], v41 offset:18432
    buffer_store_dwordx4 v[190:193], v23, s[28:31], 0 offen offset:1024 sc1
    v_cvt_pk_bf16_f32 v198, v198, v199
    v_cvt_pk_bf16_f32 v199, v200, v201
    v_cvt_pk_bf16_f32 v200, v202, v203
    s_waitcnt lgkmcnt(8)
    v_mfma_f32_16x16x32_bf16 v[150:153], a[216:219], a[8:11], v[150:153]
    ds_read_b64_tr_b16 a[208:209], v40 offset:16384
    buffer_load_dwordx4 v57, s[20:23], s0 offen offset:2048 lds
    v_mfma_f32_16x16x32_bf16 v[158:161], a[216:219], a[12:15], v[158:161]
    ds_read_b64_tr_b16 a[210:211], v40 offset:18432
    v_cvt_pk_bf16_f32 v201, v204, v205
    buffer_store_dwordx4 v[198:201], v23, s[28:31], 0 offen offset:2048 sc1
    v_cvt_pk_bf16_f32 v206, v206, v207
    v_cvt_pk_bf16_f32 v207, v208, v209
    v_cvt_pk_bf16_f32 v208, v210, v211
    v_mfma_f32_16x16x32_bf16 v[166:169], a[220:223], a[8:11], v[166:169]
    ds_read_b64_tr_b16 a[212:213], v42 offset:16384
    v_cvt_pk_bf16_f32 v209, v212, v213
    v_mfma_f32_16x16x32_bf16 v[174:177], a[220:223], a[12:15], v[174:177]
    ds_read_b64_tr_b16 a[214:215], v42 offset:18432
    s_waitcnt lgkmcnt(8)
    v_mfma_f32_16x16x32_bf16 v[154:157], a[224:227], a[8:11], v[154:157]
    ds_read_b64_tr_b16 a[216:217], v39 offset:20480
    buffer_load_dwordx4 v58, s[20:23], s0 offen offset:3072 lds
    v_mfma_f32_16x16x32_bf16 v[162:165], a[224:227], a[12:15], v[162:165]
    ds_read_b64_tr_b16 a[218:219], v39 offset:22528
    s_add_u32 m0, s58, 65536
    buffer_store_dwordx4 v[206:209], v23, s[28:31], 0 offen offset:3072 sc1
    v_mfma_f32_16x16x32_bf16 v[170:173], a[228:231], a[8:11], v[170:173]
    ds_read_b64_tr_b16 a[220:221], v41 offset:20480
    s_add_u32 s0, s0, 458752
    v_mfma_f32_16x16x32_bf16 v[178:181], a[228:231], a[12:15], v[178:181]
    ds_read_b64_tr_b16 a[222:223], v41 offset:22528
    s_waitcnt lgkmcnt(8)
    v_mfma_f32_16x16x32_bf16 v[150:153], a[200:203], a[16:19], v[150:153]
    ds_read_b64_tr_b16 a[224:225], v40 offset:20480
    s_cmp_eq_u32 s0, 3670016
    v_mfma_f32_16x16x32_bf16 v[158:161], a[200:203], a[20:23], v[158:161]
    ds_read_b64_tr_b16 a[226:227], v40 offset:22528
    s_cselect_b32 s0, 0, s0
    buffer_load_dwordx4 v55, s[20:23], s0 offen lds
    v_mfma_f32_16x16x32_bf16 v[166:169], a[204:207], a[16:19], v[166:169]
    ds_read_b64_tr_b16 a[228:229], v42 offset:20480
    v_mfma_f32_16x16x32_bf16 v[174:177], a[204:207], a[20:23], v[174:177]
    ds_read_b64_tr_b16 a[230:231], v42 offset:22528
    s_waitcnt lgkmcnt(8)
    v_mfma_f32_16x16x32_bf16 v[154:157], a[208:211], a[16:19], v[154:157]
    ds_read_b64_tr_b16 a[200:201], v31 offset:0
    buffer_load_dwordx4 v56, s[20:23], s0 offen offset:1024 lds
    v_mfma_f32_16x16x32_bf16 v[162:165], a[208:211], a[20:23], v[162:165]
    ds_read_b64_tr_b16 a[202:203], v31 offset:2048
    v_mfma_f32_16x16x32_bf16 v[170:173], a[212:215], a[16:19], v[170:173]
    ds_read_b64_tr_b16 a[204:205], v33 offset:0
    buffer_load_dwordx4 v57, s[20:23], s0 offen offset:2048 lds
    v_mfma_f32_16x16x32_bf16 v[178:181], a[212:215], a[20:23], v[178:181]
    ds_read_b64_tr_b16 a[206:207], v33 offset:2048
    s_waitcnt lgkmcnt(8)
    v_mfma_f32_16x16x32_bf16 v[150:153], a[216:219], a[24:27], v[150:153]
    ds_read_b64_tr_b16 a[208:209], v32 offset:0
    v_mfma_f32_16x16x32_bf16 v[158:161], a[216:219], a[28:31], v[158:161]
    ds_read_b64_tr_b16 a[210:211], v32 offset:2048
    buffer_load_dwordx4 v58, s[20:23], s0 offen offset:3072 lds
    v_mfma_f32_16x16x32_bf16 v[166:169], a[220:223], a[24:27], v[166:169]
    ds_read_b64_tr_b16 a[212:213], v34 offset:0
    s_add_u32 m0, s58, 81920
    v_mfma_f32_16x16x32_bf16 v[174:177], a[220:223], a[28:31], v[174:177]
    ds_read_b64_tr_b16 a[214:215], v34 offset:2048
    s_waitcnt lgkmcnt(8)
    v_mfma_f32_16x16x32_bf16 v[154:157], a[224:227], a[24:27], v[154:157]
    ds_read_b64_tr_b16 a[216:217], v31 offset:4096
    s_add_u32 s0, s0, 458752
    v_mfma_f32_16x16x32_bf16 v[162:165], a[224:227], a[28:31], v[162:165]
    ds_read_b64_tr_b16 a[218:219], v31 offset:6144
    s_cmp_eq_u32 s0, 3670016
    v_mfma_f32_16x16x32_bf16 v[170:173], a[228:231], a[24:27], v[170:173]
    ds_read_b64_tr_b16 a[220:221], v33 offset:4096
    s_cselect_b32 s0, 0, s0
    buffer_load_dwordx4 v55, s[20:23], s0 offen lds
    v_mfma_f32_16x16x32_bf16 v[178:181], a[228:231], a[28:31], v[178:181]
    ds_read_b64_tr_b16 a[222:223], v33 offset:6144
    s_waitcnt lgkmcnt(8)
    v_mfma_f32_16x16x32_bf16 v[150:153], a[200:203], a[32:35], v[150:153]
    ds_read_b64_tr_b16 a[224:225], v32 offset:4096
    buffer_load_dwordx4 v56, s[20:23], s0 offen offset:1024 lds
    v_mfma_f32_16x16x32_bf16 v[158:161], a[200:203], a[36:39], v[158:161]
    ds_read_b64_tr_b16 a[226:227], v32 offset:6144
    v_mfma_f32_16x16x32_bf16 v[166:169], a[204:207], a[32:35], v[166:169]
    ds_read_b64_tr_b16 a[228:229], v34 offset:4096
    v_mfma_f32_16x16x32_bf16 v[174:177], a[204:207], a[36:39], v[174:177]
    ds_read_b64_tr_b16 a[230:231], v34 offset:6144
    s_waitcnt lgkmcnt(8)
    v_mfma_f32_16x16x32_bf16 v[154:157], a[208:211], a[32:35], v[154:157]
    s_waitcnt vmcnt(7)
    s_barrier
    s_waitcnt vmcnt(6)
    s_atomic_add s36, s[28:29], s37
    ds_read_b64_tr_b16 a[200:201], v31 offset:16384
    buffer_load_dwordx4 v57, s[20:23], s0 offen offset:2048 lds
    v_mfma_f32_16x16x32_bf16 v[162:165], a[208:211], a[36:39], v[162:165]
    ds_read_b64_tr_b16 a[202:203], v31 offset:18432
    v_mfma_f32_16x16x32_bf16 v[170:173], a[212:215], a[32:35], v[170:173]
    ds_read_b64_tr_b16 a[204:205], v33 offset:16384
    buffer_load_dwordx4 v58, s[20:23], s0 offen offset:3072 lds
    v_mfma_f32_16x16x32_bf16 v[178:181], a[212:215], a[36:39], v[178:181]
    ds_read_b64_tr_b16 a[206:207], v33 offset:18432
    s_waitcnt lgkmcnt(8)
    v_mfma_f32_16x16x32_bf16 v[150:153], a[216:219], a[40:43], v[150:153]
    ds_read_b64_tr_b16 a[208:209], v32 offset:16384
    s_add_u32 m0, s59, 98304
    v_mfma_f32_16x16x32_bf16 v[158:161], a[216:219], a[44:47], v[158:161]
    ds_read_b64_tr_b16 a[210:211], v32 offset:18432
    buffer_load_dwordx4 v80, s[28:31], s63 offen sc1 lds
    v_mfma_f32_16x16x32_bf16 v[166:169], a[220:223], a[40:43], v[166:169]
    ds_read_b64_tr_b16 a[212:213], v34 offset:16384
    v_mfma_f32_16x16x32_bf16 v[174:177], a[220:223], a[44:47], v[174:177]
    ds_read_b64_tr_b16 a[214:215], v34 offset:18432
    s_waitcnt lgkmcnt(8)
    v_mfma_f32_16x16x32_bf16 v[154:157], a[224:227], a[40:43], v[154:157]
    ds_read_b64_tr_b16 a[216:217], v31 offset:20480
    v_mfma_f32_16x16x32_bf16 v[162:165], a[224:227], a[44:47], v[162:165]
    ds_read_b64_tr_b16 a[218:219], v31 offset:22528
    buffer_load_dwordx4 v80, s[28:31], s63 offen offset:1024 sc1 lds
    v_mfma_f32_16x16x32_bf16 v[170:173], a[228:231], a[40:43], v[170:173]
    ds_read_b64_tr_b16 a[220:221], v33 offset:20480
    v_mfma_f32_16x16x32_bf16 v[178:181], a[228:231], a[44:47], v[178:181]
    ds_read_b64_tr_b16 a[222:223], v33 offset:22528
    s_waitcnt lgkmcnt(8)
    v_mfma_f32_16x16x32_bf16 v[150:153], a[200:203], a[48:51], v[150:153]
    ds_read_b64_tr_b16 a[224:225], v32 offset:20480
    buffer_load_dwordx4 v80, s[28:31], s63 offen offset:2048 sc1 lds
    v_mfma_f32_16x16x32_bf16 v[158:161], a[200:203], a[52:55], v[158:161]
    ds_read_b64_tr_b16 a[226:227], v32 offset:22528
    s_add_u32 m0, s100, 126976
    v_mfma_f32_16x16x32_bf16 v[166:169], a[204:207], a[48:51], v[166:169]
    ds_read_b64_tr_b16 a[228:229], v34 offset:20480
    v_mfma_f32_16x16x32_bf16 v[174:177], a[204:207], a[52:55], v[174:177]
    ds_read_b64_tr_b16 a[230:231], v34 offset:22528
    s_waitcnt lgkmcnt(8)
    v_mfma_f32_16x16x32_bf16 v[154:157], a[208:211], a[48:51], v[154:157]
    ds_read_b64_tr_b16 a[200:201], v31 offset:32768
    buffer_load_dwordx4 v69, s[28:31], s62 offen sc1 lds
    v_mfma_f32_16x16x32_bf16 v[162:165], a[208:211], a[52:55], v[162:165]
    ds_read_b64_tr_b16 a[202:203], v31 offset:34816
    s_add_u32 m0, s58, 110592
    v_mfma_f32_16x16x32_bf16 v[170:173], a[212:215], a[48:51], v[170:173]
    ds_read_b64_tr_b16 a[204:205], v33 offset:32768
    v_mfma_f32_16x16x32_bf16 v[178:181], a[212:215], a[52:55], v[178:181]
    ds_read_b64_tr_b16 a[206:207], v33 offset:34816
    s_waitcnt lgkmcnt(8)
    v_mfma_f32_16x16x32_bf16 v[150:153], a[216:219], a[56:59], v[150:153]
    ds_read_b64_tr_b16 a[208:209], v32 offset:32768
    buffer_load_dwordx4 v67, s[28:31], s62 offen sc1 lds
    v_mfma_f32_16x16x32_bf16 v[158:161], a[216:219], a[60:63], v[158:161]
    ds_read_b64_tr_b16 a[210:211], v32 offset:34816
    v_mfma_f32_16x16x32_bf16 v[166:169], a[220:223], a[56:59], v[166:169]
    ds_read_b64_tr_b16 a[212:213], v34 offset:32768
    v_mfma_f32_16x16x32_bf16 v[174:177], a[220:223], a[60:63], v[174:177]
    ds_read_b64_tr_b16 a[214:215], v34 offset:34816
    s_waitcnt lgkmcnt(8)
    v_mfma_f32_16x16x32_bf16 v[154:157], a[224:227], a[56:59], v[154:157]
    ds_read_b64_tr_b16 a[216:217], v31 offset:36864
    buffer_load_dwordx4 v67, s[28:31], s62 offen offset:1024 sc1 lds
    v_mfma_f32_16x16x32_bf16 v[162:165], a[224:227], a[60:63], v[162:165]
    ds_read_b64_tr_b16 a[218:219], v31 offset:38912
    v_mfma_f32_16x16x32_bf16 v[170:173], a[228:231], a[56:59], v[170:173]
    ds_read_b64_tr_b16 a[220:221], v33 offset:36864
    buffer_load_dwordx4 v68, s[28:31], s62 offen offset:2048 sc1 lds
    v_mfma_f32_16x16x32_bf16 v[178:181], a[228:231], a[60:63], v[178:181]
    ds_read_b64_tr_b16 a[222:223], v33 offset:38912
    s_waitcnt lgkmcnt(8)
    v_mfma_f32_16x16x32_bf16 v[150:153], a[200:203], a[64:67], v[150:153]
    ds_read_b64_tr_b16 a[224:225], v32 offset:36864
    v_mfma_f32_16x16x32_bf16 v[158:161], a[200:203], a[68:71], v[158:161]
    ds_read_b64_tr_b16 a[226:227], v32 offset:38912
    v_mfma_f32_16x16x32_bf16 v[166:169], a[204:207], a[64:67], v[166:169]
    ds_read_b64_tr_b16 a[228:229], v34 offset:36864
    buffer_load_dwordx4 v68, s[28:31], s62 offen offset:3072 sc1 lds
    v_mfma_f32_16x16x32_bf16 v[174:177], a[204:207], a[68:71], v[174:177]
    ds_read_b64_tr_b16 a[230:231], v34 offset:38912
    s_waitcnt lgkmcnt(8)
    v_mfma_f32_16x16x32_bf16 v[154:157], a[208:211], a[64:67], v[154:157]
    s_waitcnt vmcnt(8)
    s_barrier
    s_xor_b32 s37, s37, 1024
    s_load_dword s14, s[28:29], s37
    ds_read_b64_tr_b16 a[200:201], v31 offset:49152
    s_add_u32 m0, s59, 131072
    v_mfma_f32_16x16x32_bf16 v[162:165], a[208:211], a[68:71], v[162:165]
    ds_read_b64_tr_b16 a[202:203], v31 offset:51200
    s_add_u32 s63, s63, 12288
    v_mfma_f32_16x16x32_bf16 v[170:173], a[212:215], a[64:67], v[170:173]
    ds_read_b64_tr_b16 a[204:205], v33 offset:49152
    s_cmp_eq_u32 s63, 86016
    s_cselect_b32 s63, 0, s63
    buffer_load_dwordx4 v80, s[28:31], s63 offen sc1 lds
    v_mfma_f32_16x16x32_bf16 v[178:181], a[212:215], a[68:71], v[178:181]
    ds_read_b64_tr_b16 a[206:207], v33 offset:51200
    s_waitcnt lgkmcnt(8)
    v_mfma_f32_16x16x32_bf16 v[150:153], a[216:219], a[72:75], v[150:153]
    ds_read_b64_tr_b16 a[208:209], v32 offset:49152
    buffer_load_dwordx4 v80, s[28:31], s63 offen offset:1024 sc1 lds
    v_mfma_f32_16x16x32_bf16 v[158:161], a[216:219], a[76:79], v[158:161]
    ds_read_b64_tr_b16 a[210:211], v32 offset:51200
    v_mfma_f32_16x16x32_bf16 v[166:169], a[220:223], a[72:75], v[166:169]
    ds_read_b64_tr_b16 a[212:213], v34 offset:49152
    v_mfma_f32_16x16x32_bf16 v[174:177], a[220:223], a[76:79], v[174:177]
    ds_read_b64_tr_b16 a[214:215], v34 offset:51200
    s_waitcnt lgkmcnt(8)
    v_mfma_f32_16x16x32_bf16 v[154:157], a[224:227], a[72:75], v[154:157]
    ds_read_b64_tr_b16 a[216:217], v31 offset:53248
    buffer_load_dwordx4 v80, s[28:31], s63 offen offset:2048 sc1 lds
    v_mfma_f32_16x16x32_bf16 v[162:165], a[224:227], a[76:79], v[162:165]
    ds_read_b64_tr_b16 a[218:219], v31 offset:55296
    s_add_u32 m0, s100, 159744
    v_mfma_f32_16x16x32_bf16 v[170:173], a[228:231], a[72:75], v[170:173]
    ds_read_b64_tr_b16 a[220:221], v33 offset:53248
    s_add_u32 s62, s62, 262144
    v_mfma_f32_16x16x32_bf16 v[178:181], a[228:231], a[76:79], v[178:181]
    ds_read_b64_tr_b16 a[222:223], v33 offset:55296
    s_waitcnt lgkmcnt(8)
    v_mfma_f32_16x16x32_bf16 v[150:153], a[200:203], a[80:83], v[150:153]
    ds_read_b64_tr_b16 a[224:225], v32 offset:53248
    s_cmp_eq_u32 s62, 1835008
    v_mfma_f32_16x16x32_bf16 v[158:161], a[200:203], a[84:87], v[158:161]
    ds_read_b64_tr_b16 a[226:227], v32 offset:55296
    s_cselect_b32 s62, 0, s62
    buffer_load_dwordx4 v69, s[28:31], s62 offen sc1 lds
    v_mfma_f32_16x16x32_bf16 v[166:169], a[204:207], a[80:83], v[166:169]
    ds_read_b64_tr_b16 a[228:229], v34 offset:53248
    s_add_u32 m0, s58, 143360
    v_mfma_f32_16x16x32_bf16 v[174:177], a[204:207], a[84:87], v[174:177]
    ds_read_b64_tr_b16 a[230:231], v34 offset:55296
    s_waitcnt lgkmcnt(8)
    v_mfma_f32_16x16x32_bf16 v[154:157], a[208:211], a[80:83], v[154:157]
    s_barrier
    ds_read_b64_tr_b16 a[200:201], v37 offset:0
    buffer_load_dwordx4 v67, s[28:31], s62 offen sc1 lds
    v_mfma_f32_16x16x32_bf16 v[162:165], a[208:211], a[84:87], v[162:165]
    ds_read_b64_tr_b16 a[202:203], v37 offset:2048
    v_mfma_f32_16x16x32_bf16 v[170:173], a[212:215], a[80:83], v[170:173]
    ds_read_b64_tr_b16 a[204:205], v38 offset:0
    buffer_load_dwordx4 v67, s[28:31], s62 offen offset:1024 sc1 lds
    v_mfma_f32_16x16x32_bf16 v[178:181], a[212:215], a[84:87], v[178:181]
    ds_read_b64_tr_b16 a[206:207], v38 offset:2048
    s_waitcnt lgkmcnt(8)
    v_mfma_f32_16x16x32_bf16 v[150:153], a[216:219], a[88:91], v[150:153]
    ds_read_b64_tr_b16 a[208:209], v37 offset:4096
    v_mfma_f32_16x16x32_bf16 v[158:161], a[216:219], a[92:95], v[158:161]
    ds_read_b64_tr_b16 a[210:211], v37 offset:6144
    v_mfma_f32_16x16x32_bf16 v[166:169], a[220:223], a[88:91], v[166:169]
    ds_read_b64_tr_b16 a[212:213], v38 offset:4096
    buffer_load_dwordx4 v68, s[28:31], s62 offen offset:2048 sc1 lds
    v_mfma_f32_16x16x32_bf16 v[174:177], a[220:223], a[92:95], v[174:177]
    ds_read_b64_tr_b16 a[214:215], v38 offset:6144
    s_waitcnt lgkmcnt(8)
    v_mfma_f32_16x16x32_bf16 v[154:157], a[224:227], a[88:91], v[154:157]
    ds_read_b64_tr_b16 a[216:217], v37 offset:16384
    v_mfma_f32_16x16x32_bf16 v[162:165], a[224:227], a[92:95], v[162:165]
    ds_read_b64_tr_b16 a[218:219], v37 offset:18432
    buffer_load_dwordx4 v68, s[28:31], s62 offen offset:3072 sc1 lds
    v_mfma_f32_16x16x32_bf16 v[170:173], a[228:231], a[88:91], v[170:173]
    ds_read_b64_tr_b16 a[220:221], v38 offset:16384
    s_add_u32 m0, s59, 0
    v_mfma_f32_16x16x32_bf16 v[178:181], a[228:231], a[92:95], v[178:181]
    ds_read_b64_tr_b16 a[222:223], v38 offset:18432
    s_waitcnt lgkmcnt(8)
    v_mfma_f32_16x16x32_bf16 v[166:169], a[200:203], a[96:99], v[166:169]
    s_waitcnt lgkmcnt(0)
    s_cmp_ge_u32 s14, 2
    s_cbranch_scc1 L_pollok2
    s_mov_b32 s60, 0
L_poll2:
    s_sleep 4
    buffer_load_dword v18, off, s[28:31], s37 sc1
    s_add_u32 s60, s60, 1
    s_waitcnt vmcnt(0)
    v_readfirstlane_b32 s14, v18
    s_nop 0
    s_cmp_ge_u32 s14, 2
    s_cbranch_scc1 L_pollok2
    s_cmp_lt_u32 s60, 20000
    s_cbranch_scc1 L_poll2
L_pollok2:
    v_xor_b32 v23, 131072, v23
    v_xor_b32 v22, 8192, v23
    ds_read_b64_tr_b16 a[224:225], v37 offset:20480
    buffer_load_dwordx4 v[214:217], v23, s[28:31], 0 offen offset:0 sc1
    v_mfma_f32_16x16x32_bf16 v[174:177], a[200:203], a[100:103], v[174:177]
    ds_read_b64_tr_b16 a[226:227], v37 offset:22528
    v_mfma_f32_16x16x32_bf16 v[170:173], a[204:207], a[96:99], v[170:173]
    ds_read_b64_tr_b16 a[228:229], v38 offset:20480
    buffer_load_dwordx4 v[218:221], v23, s[28:31], 0 offen offset:1024 sc1
    v_mfma_f32_16x16x32_bf16 v[178:181], a[204:207], a[100:103], v[178:181]
    ds_read_b64_tr_b16 a[230:231], v38 offset:22528
    v_mfma_f32_16x16x32_bf16 v[166:169], a[208:211], a[104:107], v[166:169]
    ds_read_b64_tr_b16 a[200:201], v35 offset:0
    buffer_load_dwordx4 v[222:225], v22, s[28:31], 0 offen offset:2048 sc1
    v_mfma_f32_16x16x32_bf16 v[174:177], a[208:211], a[108:111], v[174:177]
    ds_read_b64_tr_b16 a[202:203], v35 offset:2048
    v_mfma_f32_16x16x32_bf16 v[170:173], a[212:215], a[104:107], v[170:173]
    ds_read_b64_tr_b16 a[204:205], v36 offset:0
    buffer_load_dwordx4 v[226:229], v22, s[28:31], 0 offen offset:3072 sc1
    v_mfma_f32_16x16x32_bf16 v[178:181], a[212:215], a[108:111], v[178:181]
    ds_read_b64_tr_b16 a[206:207], v36 offset:2048
    v_mfma_f32_16x16x32_bf16 v[166:169], a[216:219], a[112:115], v[166:169]
    ds_read_b64_tr_b16 a[208:209], v35 offset:4096
    s_add_u32 s63, s63, 12288
    v_mfma_f32_16x16x32_bf16 v[174:177], a[216:219], a[116:119], v[174:177]
    ds_read_b64_tr_b16 a[210:211], v35 offset:6144
    s_cmp_eq_u32 s63, 86016
    s_cselect_b32 s63, 0, s63
    buffer_load_dwordx4 v80, s[28:31], s63 offen sc1 lds
    v_mfma_f32_16x16x32_bf16 v[170:173], a[220:223], a[112:115], v[170:173]
    ds_read_b64_tr_b16 a[212:213], v36 offset:4096
    v_mfma_f32_16x16x32_bf16 v[178:181], a[220:223], a[116:119], v[178:181]
    ds_read_b64_tr_b16 a[214:215], v36 offset:6144
    s_waitcnt lgkmcnt(8)
    v_mfma_f32_16x16x32_bf16 v[166:169], a[224:227], a[120:123], v[166:169]
    ds_read_b64_tr_b16 a[216:217], v35 offset:16384
    buffer_load_dwordx4 v80, s[28:31], s63 offen offset:1024 sc1 lds
    v_mfma_f32_16x16x32_bf16 v[174:177], a[224:227], a[124:127], v[174:177]
    ds_read_b64_tr_b16 a[218:219], v35 offset:18432
    v_mfma_f32_16x16x32_bf16 v[170:173], a[228:231], a[120:123], v[170:173]
    ds_read_b64_tr_b16 a[220:221], v36 offset:16384
    v_mfma_f32_16x16x32_bf16 v[178:181], a[228:231], a[124:127], v[178:181]
    ds_read_b64_tr_b16 a[222:223], v36 offset:18432
    s_waitcnt lgkmcnt(8)
    v_mfma_f32_16x16x32_bf16 v[150:153], a[200:203], a[96:99], v[150:153]
    ds_read_b64_tr_b16 a[224:225], v35 offset:20480
    buffer_load_dwordx4 v80, s[28:31], s63 offen offset:2048 sc1 lds
    v_mfma_f32_16x16x32_bf16 v[158:161], a[200:203], a[100:103], v[158:161]
    ds_read_b64_tr_b16 a[226:227], v35 offset:22528
    s_add_u32 m0, s100, 28672
    v_mfma_f32_16x16x32_bf16 v[154:157], a[204:207], a[96:99], v[154:157]
    ds_read_b64_tr_b16 a[228:229], v36 offset:20480
    s_add_u32 s62, s62, 262144
    v_mfma_f32_16x16x32_bf16 v[162:165], a[204:207], a[100:103], v[162:165]
    ds_read_b64_tr_b16 a[230:231], v36 offset:22528
    ds_write_b128 v81, v[166:169] offset:32768
    s_waitcnt lgkmcnt(9)
    v_mfma_f32_16x16x32_bf16 v[150:153], a[208:211], a[104:107], v[150:153]
    s_cmp_eq_u32 s62, 1835008
    s_cselect_b32 s62, 0, s62
    buffer_load_dwordx4 v69, s[28:31], s62 offen sc1 lds
    v_mfma_f32_16x16x32_bf16 v[158:161], a[208:211], a[108:111], v[158:161]
    s_add_u32 m0, s58, 12288
    ds_write_b128 v81, v[170:173] offset:33792
    v_mfma_f32_16x16x32_bf16 v[154:157], a[212:215], a[104:107], v[154:157]
    buffer_load_dwordx4 v67, s[28:31], s62 offen sc1 lds
    ds_write_b128 v81, v[174:177] offset:34816
    v_mfma_f32_16x16x32_bf16 v[162:165], a[212:215], a[108:111], v[162:165]
    s_waitcnt lgkmcnt(7)
    v_mfma_f32_16x16x32_bf16 v[150:153], a[216:219], a[112:115], v[150:153]
    ds_write_b128 v81, v[178:181] offset:35840
    v_mfma_f32_16x16x32_bf16 v[158:161], a[216:219], a[116:119], v[158:161]
    v_mfma_f32_16x16x32_bf16 v[154:157], a[220:223], a[112:115], v[154:157]
    buffer_load_dwordx4 v67, s[28:31], s62 offen offset:1024 sc1 lds
    v_mfma_f32_16x16x32_bf16 v[162:165], a[220:223], a[116:119], v[162:165]
    s_waitcnt lgkmcnt(4)
    v_mfma_f32_16x16x32_bf16 v[150:153], a[224:227], a[120:123], v[150:153]
    v_mfma_f32_16x16x32_bf16 v[158:161], a[224:227], a[124:127], v[158:161]
    buffer_load_dwordx4 v68, s[28:31], s62 offen offset:2048 sc1 lds
    v_mfma_f32_16x16x32_bf16 v[154:157], a[228:231], a[120:123], v[154:157]
    v_mfma_f32_16x16x32_bf16 v[162:165], a[228:231], a[124:127], v[162:165]
    s_waitcnt vmcnt(10)
    v_mfma_f32_16x16x32_bf16 v[150:153], a[250:253], v[214:217], v[150:153]
    v_xor_b32 v81, 8192, v81
    s_waitcnt lgkmcnt(0)
    s_barrier
    ds_read_b128 v[182:185], v81 offset:32768
    ds_read_b128 v[186:189], v81 offset:33792
    ds_read_b128 v[190:193], v81 offset:34816
    ds_read_b128 v[194:197], v81 offset:35840
    v_mfma_f32_16x16x32_bf16 v[154:157], a[248:251], v[214:217], v[154:157]
    buffer_load_dwordx4 v68, s[28:31], s62 offen offset:3072 sc1 lds
    s_add_u32 m0, s59, 65536
    s_waitcnt vmcnt(10)
    v_mfma_f32_16x16x32_bf16 v[158:161], a[250:253], v[218:221], v[158:161]
    s_add_u32 s63, s63, 12288
    s_cmp_eq_u32 s63, 86016
    v_mfma_f32_16x16x32_bf16 v[162:165], a[248:251], v[218:221], v[162:165]
    s_cselect_b32 s63, 0, s63
    s_waitcnt vmcnt(9)
    v_mfma_f32_16x16x32_bf16 v[150:153], a[250:253], v[222:225], v[150:153]
    buffer_load_dwordx4 v80, s[28:31], s63 offen sc1 lds
    v_mfma_f32_16x16x32_bf16 v[154:157], a[248:251], v[222:225], v[154:157]
    s_waitcnt vmcnt(9)
    v_mfma_f32_16x16x32_bf16 v[158:161], a[250:253], v[226:229], v[158:161]
    v_mfma_f32_16x16x32_bf16 v[162:165], a[248:251], v[226:229], v[162:165]
    buffer_load_dwordx4 v80, s[28:31], s63 offen offset:1024 sc1 lds
    s_waitcnt lgkmcnt(3)
    s_nop 0
    v_pk_add_f32 v[150:151], v[150:151], v[182:183]
    v_pk_add_f32 v[152:153], v[152:153], v[184:185]
    s_waitcnt lgkmcnt(2)
    v_pk_add_f32 v[154:155], v[154:155], v[186:187]
    v_pk_add_f32 v[156:157], v[156:157], v[188:189]
    v_pk_mul_f32 v[182:183], v[150:151], v[150:151]
    v_pk_mul_f32 v[184:185], v[152:153], v[152:153]
    v_pk_mul_f32 v[186:187], v[154:155], v[154:155]
    v_pk_mul_f32 v[188:189], v[156:157], v[156:157]
    v_pk_fma_f32 v[182:183], v[182:183], s[78:79], v[108:109]
    v_pk_fma_f32 v[184:185], v[184:185], s[78:79], v[108:109]
    v_pk_fma_f32 v[186:187], v[186:187], s[78:79], v[108:109]
    v_pk_fma_f32 v[188:189], v[188:189], s[78:79], v[108:109]
    v_pk_mul_f32 v[182:183], v[182:183], v[150:151]
    buffer_load_dwordx4 v80, s[28:31], s63 offen offset:2048 sc1 lds
    v_pk_mul_f32 v[184:185], v[184:185], v[152:153]
    v_pk_mul_f32 v[186:187], v[186:187], v[154:155]
    v_pk_mul_f32 v[188:189], v[188:189], v[156:157]
    v_exp_f32 v182, v182
    v_exp_f32 v183, v183
    v_exp_f32 v184, v184
    v_exp_f32 v185, v185
    v_exp_f32 v186, v186
    v_exp_f32 v187, v187
    s_add_u32 m0, s100, 94208
    s_add_u32 s62, s62, 262144
    s_cmp_eq_u32 s62, 1835008
    s_cselect_b32 s62, 0, s62
    buffer_load_dwordx4 v69, s[28:31], s62 offen sc1 lds
    v_exp_f32 v188, v188
    v_exp_f32 v189, v189
    v_pk_add_f32 v[182:183], v[182:183], s[80:81]
    v_pk_add_f32 v[184:185], v[184:185], s[80:81]
    v_pk_add_f32 v[186:187], v[186:187], s[80:81]
    v_pk_add_f32 v[188:189], v[188:189], s[80:81]
    v_rcp_f32 v182, v182
    v_rcp_f32 v183, v183
    v_rcp_f32 v184, v184
    s_add_u32 m0, s58, 77824
    s_nop 0
    buffer_load_dwordx4 v67, s[28:31], s62 offen sc1 lds
    v_rcp_f32 v185, v185
    v_rcp_f32 v186, v186
    v_rcp_f32 v187, v187
    v_rcp_f32 v188, v188
    v_rcp_f32 v189, v189
    v_pk_mul_f32 v[182:183], v[182:183], v[150:151]
    v_pk_mul_f32 v[184:185], v[184:185], v[152:153]
    v_pk_mul_f32 v[186:187], v[186:187], v[154:155]
    buffer_load_dwordx4 v67, s[28:31], s62 offen offset:1024 sc1 lds
    v_pk_mul_f32 v[188:189], v[188:189], v[156:157]
    v_cvt_pk_bf16_f32 v110, v182, v183
    v_cvt_pk_bf16_f32 v111, v184, v185
    v_cvt_pk_bf16_f32 v112, v186, v187
    v_cvt_pk_bf16_f32 v113, v188, v189
    s_waitcnt lgkmcnt(1)
    v_pk_add_f32 v[158:159], v[158:159], v[190:191]
    v_pk_add_f32 v[160:161], v[160:161], v[192:193]
    s_waitcnt lgkmcnt(0)
    v_pk_add_f32 v[162:163], v[162:163], v[194:195]
    v_pk_add_f32 v[164:165], v[164:165], v[196:197]
    v_pk_mul_f32 v[190:191], v[158:159], v[158:159]
    v_pk_mul_f32 v[192:193], v[160:161], v[160:161]
    v_pk_mul_f32 v[194:195], v[162:163], v[162:163]
    v_pk_mul_f32 v[196:197], v[164:165], v[164:165]
    v_pk_fma_f32 v[190:191], v[190:191], s[78:79], v[108:109]
    buffer_load_dwordx4 v68, s[28:31], s62 offen offset:2048 sc1 lds
    v_pk_fma_f32 v[192:193], v[192:193], s[78:79], v[108:109]
    v_pk_fma_f32 v[194:195], v[194:195], s[78:79], v[108:109]
    v_pk_fma_f32 v[196:197], v[196:197], s[78:79], v[108:109]
    v_pk_mul_f32 v[190:191], v[190:191], v[158:159]
    v_pk_mul_f32 v[192:193], v[192:193], v[160:161]
    v_pk_mul_f32 v[194:195], v[194:195], v[162:163]
    v_pk_mul_f32 v[196:197], v[196:197], v[164:165]
    v_exp_f32 v190, v190
    v_exp_f32 v191, v191
    v_exp_f32 v192, v192
    v_exp_f32 v193, v193
    buffer_load_dwordx4 v68, s[28:31], s62 offen offset:3072 sc1 lds
    v_exp_f32 v194, v194
    v_exp_f32 v195, v195
    v_exp_f32 v196, v196
    v_exp_f32 v197, v197
    v_pk_add_f32 v[190:191], v[190:191], s[80:81]
    v_pk_add_f32 v[192:193], v[192:193], s[80:81]
    v_pk_add_f32 v[194:195], v[194:195], s[80:81]
    v_pk_add_f32 v[196:197], v[196:197], s[80:81]
    v_rcp_f32 v190, v190
    v_rcp_f32 v191, v191
    v_rcp_f32 v192, v192
    v_rcp_f32 v193, v193
    v_rcp_f32 v194, v194
    v_rcp_f32 v195, v195
    v_rcp_f32 v196, v196
    v_rcp_f32 v197, v197
    v_pk_mul_f32 v[190:191], v[190:191], v[158:159]
    v_pk_mul_f32 v[192:193], v[192:193], v[160:161]
    v_pk_mul_f32 v[194:195], v[194:195], v[162:163]
    v_pk_mul_f32 v[196:197], v[196:197], v[164:165]
    v_cvt_pk_bf16_f32 v114, v190, v191
    v_cvt_pk_bf16_f32 v115, v192, v193
    v_cvt_pk_bf16_f32 v116, v194, v195
    v_cvt_pk_bf16_f32 v117, v196, v197
    ds_read_b64_tr_b16 a[180:181], v72 offset:32768
    ds_read_b64_tr_b16 a[182:183], v72 offset:33024
    ds_read_b128 a[128:131], v53 offset:32768
    ds_read_b64_tr_b16 a[184:185], v72 offset:33792
    ds_read_b64_tr_b16 a[186:187], v72 offset:34048
    ds_read_b128 a[132:135], v53 offset:33792
    ds_read_b128 a[136:139], v53 offset:34816
    ds_read_b64_tr_b16 a[176:177], v73 offset:32768
    ds_read_b64_tr_b16 a[178:179], v73 offset:33024
    ds_read_b128 a[140:143], v53 offset:35840
    ds_read_b128 a[144:147], v53 offset:36864
    ds_read_b128 a[148:151], v53 offset:37888
    buffer_store_dwordx4 v[110:113], v4, s[28:31], s67 offen offset:0 sc1
    buffer_store_dwordx4 v[114:117], v4, s[28:31], s67 offen offset:1024 sc1
    s_branch L_q
L_nog1:
    s_nop 1
    s_mov_b32 s14, 1204224
    s_mov_b32 s15, 0x20000
    s_sub_u32 s3, s2, 200
    s_cmp_lt_u32 s3, 42
    s_cselect_b32 s81, 0, 268435456
    s_cselect_b32 s3, s3, 0
    s_mul_i32 s79, s3, 43
    s_lshr_b32 s79, s79, 7
    s_mul_i32 s80, s79, 3
    s_sub_u32 s80, s3, s80
    v_min_u32 v13, 55, v1
    s_lshl_b32 s3, s79, 2
    s_add_u32 s3, s3, s48
    s_mul_i32 s3, s3, 21504
    s_mul_i32 s60, s80, 896
    s_add_u32 s3, s3, s60
    s_add_u32 s3, s3, s81
    v_lshl_add_u32 v242, v13, 4, s3
    s_mul_i32 s60, s48, 8448
    s_add_u32 m0, s60, 0
    s_mov_b32 s3, 0
    buffer_load_dwordx4 v242, s[12:15], s3 offen lds
    s_add_u32 m0, s60, 1056
    s_mov_b32 s3, 2688
    buffer_load_dwordx4 v242, s[12:15], s3 offen lds
    s_add_u32 m0, s60, 2112
    s_mov_b32 s3, 5376
    buffer_load_dwordx4 v242, s[12:15], s3 offen lds
    s_add_u32 m0, s60, 3168
    s_mov_b32 s3, 8064
    buffer_load_dwordx4 v242, s[12:15], s3 offen lds
    s_add_u32 m0, s60, 4224
    s_mov_b32 s3, 10752
    buffer_load_dwordx4 v242, s[12:15], s3 offen lds
    s_add_u32 m0, s60, 5280
    s_mov_b32 s3, 13440
    buffer_load_dwordx4 v242, s[12:15], s3 offen lds
    s_add_u32 m0, s60, 6336
    s_mov_b32 s3, 16128
    buffer_load_dwordx4 v242, s[12:15], s3 offen lds
    s_add_u32 m0, s60, 7392
    s_mov_b32 s3, 18816
    buffer_load_dwordx4 v242, s[12:15], s3 offen lds
    s_mul_i32 s53, s101, 37
    s_lshr_b32 s53, s53, 8
    s_mul_i32 s54, s53, 7
    s_sub_u32 s54, s101, s54
    s_and_b32 s53, s53, 3
    s_lshl_b32 s3, s6, 2
    s_add_u32 s53, s53, s3
    s_lshl_b32 s53, s53, 1
    s_add_u32 s53, s53, s7
    s_mov_b32 s42, 4096
    s_mov_b32 s43, 0x20000
    s_lshl_b32 s3, s53, 2
    s_add_u32 s3, s3, s48
    s_lshl_b32 s60, s3, 5
    v_lshl_add_u32 v82, v5, 1, s60
    s_mul_i32 s3, s3, 14336
    s_lshl_b32 s60, s54, 7
    s_add_u32 s3, s3, s60
    v_mul_u32_u24 v14, 896, v5
    v_lshl_add_u32 v14, v6, 4, v14
    v_add_u32 v85, s3, v14
    v_add_u32 v86, 7168, v85
    s_cmp_lt_u32 s101, 28
    s_cselect_b32 s56, 1, 0
    s_lshl_b32 s50, s7, 3
    s_and_b32 s3, s101, 7
    s_add_u32 s50, s50, s3
    s_lshr_b32 s60, s101, 3
    s_lshl_b32 s49, s6, 2
    s_add_u32 s49, s49, s60
    s_lshl_b32 s49, s49, 2
    s_add_u32 s49, s49, s48
    s_mul_i32 s60, s60, 0
    s_add_u32 s3, s3, s60
    s_sub_u32 s60, s3, 7
    s_cmp_ge_u32 s3, 7
    s_cselect_b32 s3, s60, s3
    s_lshl_b32 s62, s3, 18
    s_mul_i32 s63, s3, 12288
    s_mov_b32 s30, 20971520
    s_mov_b32 s31, 0x20000
    s_mov_b32 s75, 0x3727c5ac
    s_mov_b32 s76, 0x3b124925
    s_mov_b32 s77, 0x3f803f80
    v_lshlrev_b32 v4, 4, v1
    v_bfe_u32 v7, v1, 2, 2
    v_and_b32 v8, 3, v1
    v_mul_u32_u24 v13, 960, v9
    v_lshl_add_u32 v13, v10, 4, v13
    s_mul_i32 s3, s48, 1920
    s_add_u32 s3, s3, 147456
    v_add_u32 v230, s3, v13
    v_mul_u32_u24 v13, 960, v7
    v_lshl_add_u32 v13, v3, 5, v13
    v_lshl_add_u32 v13, v8, 3, v13
    s_lshl_b32 s3, s48, 8
    s_add_u32 s3, s3, 147456
    v_add_u32 v231, s3, v13
    s_lshl_b32 s3, s48, 3
    s_add_u32 s3, s3, 155648
    v_lshl_add_u32 v232, v9, 2, s3
    v_lshlrev_b32 v237, 2, v6
    v_and_b32 v2, 15, v1
    v_lshlrev_b32 v238, 14, v3
    v_add_lshl_u32 v238, v238, v2, 2
    v_add_u32 v237, 155648, v237
    v_lshlrev_b32 v13, 17, v9
    v_lshl_add_u32 v233, v10, 4, v13
    s_cmp_eq_u32 s48, 3
    s_cselect_b32 s60, 268435456, 0
    s_lshl_b32 s70, s48, 10
    s_add_u32 s70, s70, s2
    s_lshl_b32 s70, s70, 9
    s_add_u32 s71, s70, 262144
    s_add_u32 s71, s71, s60
    s_xor_b32 s60, s60, 268435456
    s_lshl_b32 s72, s2, 7
    s_add_u32 s72, s72, s60
    s_add_u32 s72, s72, 6291456
    s_lshr_b32 s74, s2, 2
    s_lshl_b32 s74, s74, 5
    s_and_b32 s3, s2, 3
    s_add_u32 s74, s74, s3
    s_lshl_b32 s74, s74, 2
    s_add_u32 s74, s74, 10485760
    v_cmp_gt_u32 vcc, 8, v0
    v_lshlrev_b32 v236, 13, v0
    v_mov_b32 v13, 268435456
    s_and_b32 s3, s2, 7
    s_lshl_b32 s3, s3, 13
    s_add_u32 s3, s3, 10485760
    v_lshrrev_b32 v14, 2, v0
    v_lshl_add_u32 v14, v14, 7, s3
    v_lshl_add_u32 v20, v8, 2, v14
    v_cndmask_b32 v236, v13, v236, vcc
    v_mov_b32 v16, 0
    s_lshl_b32 s3, s48, 14
    s_add_u32 s74, s74, s3
    s_add_u32 s73, s74, 8192
    s_waitcnt vmcnt(10)
    v_dot2_f32_bf16 v226, v182, s77, 0
    v_dot2_f32_bf16 v227, v182, v182, 0
    v_dot2_f32_bf16 v226, v183, s77, v226
    v_dot2_f32_bf16 v227, v183, v183, v227
    v_dot2_f32_bf16 v226, v184, s77, v226
    v_dot2_f32_bf16 v227, v184, v184, v227
    v_dot2_f32_bf16 v226, v185, s77, v226
    v_dot2_f32_bf16 v227, v185, v185, v227
    s_waitcnt vmcnt(9)
    v_dot2_f32_bf16 v226, v186, s77, v226
    v_dot2_f32_bf16 v227, v186, v186, v227
    v_dot2_f32_bf16 v226, v187, s77, v226
    v_dot2_f32_bf16 v227, v187, v187, v227
    v_dot2_f32_bf16 v226, v188, s77, v226
    v_dot2_f32_bf16 v227, v188, v188, v227
    v_dot2_f32_bf16 v226, v189, s77, v226
    v_dot2_f32_bf16 v227, v189, v189, v227
    buffer_load_dword v12, v16, s[44:47], 0 offen sc1
    v_lshlrev_b32 v190, 16, v182
    v_and_b32 v191, 0xffff0000, v182
    v_add_f32_dpp v226, v226, v226 quad_perm:[1,0,3,2] row_mask:0xf bank_mask:0xf
    v_add_f32_dpp v227, v227, v227 quad_perm:[1,0,3,2] row_mask:0xf bank_mask:0xf
    v_lshlrev_b32 v192, 16, v183
    v_add_f32_dpp v226, v226, v226 quad_perm:[2,3,0,1] row_mask:0xf bank_mask:0xf
    v_add_f32_dpp v227, v227, v227 quad_perm:[2,3,0,1] row_mask:0xf bank_mask:0xf
    v_and_b32 v193, 0xffff0000, v183
    v_add_f32_dpp v226, v226, v226 row_half_mirror row_mask:0xf bank_mask:0xf
    v_add_f32_dpp v227, v227, v227 row_half_mirror row_mask:0xf bank_mask:0xf
    v_lshlrev_b32 v194, 16, v184
    v_add_f32_dpp v226, v226, v226 row_mirror row_mask:0xf bank_mask:0xf
    v_add_f32_dpp v227, v227, v227 row_mirror row_mask:0xf bank_mask:0xf
    v_and_b32 v195, 0xffff0000, v184
    v_mov_b32 v228, v226
    v_mov_b32 v229, v227
    v_lshlrev_b32 v196, 16, v185
    v_permlane16_swap_b32 v226, v228
    v_permlane16_swap_b32 v227, v229
    v_add_f32 v226, v226, v228
    v_add_f32 v227, v227, v229
    v_mul_f32_e64 v226, -v226, s76
    v_mul_f32 v228, v226, v226
    v_fma_f32 v227, v227, s76, -v228
    v_max_f32 v227, 0, v227
    v_add_f32 v228, s75, v227
    v_rsq_f32 v222, v228
    v_and_b32 v197, 0xffff0000, v185
    v_mul_f32 v228, v222, v222
    v_fma_f32 v229, v228, v227, s75
    v_rsq_f32 v228, v229
    v_mul_f32 v223, v226, v222
    v_mul_f32 v224, v222, v228
    v_mul_f32 v225, v223, v228
    v_mul_f32 v229, v229, v228
    ds_write_b32 v232, v229
    v_lshlrev_b32 v198, 16, v186
    v_and_b32 v199, 0xffff0000, v186
    v_lshlrev_b32 v200, 16, v187
    v_and_b32 v201, 0xffff0000, v187
    v_lshlrev_b32 v202, 16, v188
    v_and_b32 v203, 0xffff0000, v188
    v_lshlrev_b32 v204, 16, v189
    v_and_b32 v205, 0xffff0000, v189
    v_pk_fma_f32 v[206:207], v[190:191], v[224:225], v[224:225] op_sel:[0,0,1] op_sel_hi:[1,0,1]
    v_pk_fma_f32 v[208:209], v[192:193], v[224:225], v[224:225] op_sel:[0,0,1] op_sel_hi:[1,0,1]
    v_pk_fma_f32 v[210:211], v[194:195], v[224:225], v[224:225] op_sel:[0,0,1] op_sel_hi:[1,0,1]
    v_pk_fma_f32 v[212:213], v[196:197], v[224:225], v[224:225] op_sel:[0,0,1] op_sel_hi:[1,0,1]
    v_cvt_pk_bf16_f32 v182, v206, v207
    v_cvt_pk_bf16_f32 v183, v208, v209
    v_cvt_pk_bf16_f32 v184, v210, v211
    v_cvt_pk_bf16_f32 v185, v212, v213
    ds_write_b128 v230, v[182:185] offset:0
    v_pk_fma_f32 v[214:215], v[198:199], v[224:225], v[224:225] op_sel:[0,0,1] op_sel_hi:[1,0,1]
    v_pk_fma_f32 v[216:217], v[200:201], v[224:225], v[224:225] op_sel:[0,0,1] op_sel_hi:[1,0,1]
    v_pk_fma_f32 v[218:219], v[202:203], v[224:225], v[224:225] op_sel:[0,0,1] op_sel_hi:[1,0,1]
    v_pk_fma_f32 v[220:221], v[204:205], v[224:225], v[224:225] op_sel:[0,0,1] op_sel_hi:[1,0,1]
    v_cvt_pk_bf16_f32 v186, v214, v215
    v_cvt_pk_bf16_f32 v187, v216, v217
    v_cvt_pk_bf16_f32 v188, v218, v219
    v_cvt_pk_bf16_f32 v189, v220, v221
    ds_write_b128 v230, v[186:189] offset:448
    s_waitcnt lgkmcnt(0)
    s_barrier
    ds_read_b64_tr_b16 v[110:111], v231 offset:0
    ds_read_b64_tr_b16 v[112:113], v231 offset:3840
    ds_read_b64_tr_b16 v[114:115], v231 offset:128
    ds_read_b64_tr_b16 v[116:117], v231 offset:3968
    ds_read_b32 v229, v237
    s_waitcnt lgkmcnt(3)
    buffer_store_dwordx4 v[110:113], v233, s[28:31], s70 offen sc1
    s_waitcnt lgkmcnt(1)
    buffer_store_dwordx4 v[114:117], v233, s[28:31], s71 offen sc1
    v_cmp_gt_u32 vcc, 16, v1
    s_waitcnt lgkmcnt(0)
    s_nop 0
    v_cndmask_b32 v229, 0, v229, vcc
    buffer_store_dword v229, v238, s[28:31], s72 offen sc1
    v_lshrrev_b32 v13, 2, v1
    v_mul_u32_u24 v13, 1056, v13
    v_lshl_add_u32 v13, v8, 3, v13
    s_mul_i32 s3, s48, 224
    v_add_u32 v243, s3, v13
    s_mov_b32 s18, 401408
    s_mov_b32 s19, 0x20000
    s_mov_b32 s26, 7340032
    s_mov_b32 s27, 0x20000
    s_mov_b32 s34, 1835008
    s_mov_b32 s35, 0x20000
    s_mov_b32 s36, 1
    v_lshrrev_b32 v14, 2, v1
    v_lshlrev_b32 v14, 7, v14
    v_lshl_add_u32 v14, v8, 3, v14
    v_and_b32 v15, 3, v5
    v_lshl_add_u32 v14, v15, 5, v14
    s_mul_i32 s3, s4, 8256
    v_xor_b32 v31, s3, v14
    v_xor_b32 v32, 32, v31
    v_xor_b32 v33, 64, v31
    v_xor_b32 v34, 96, v31
    v_add_u32 v35, 65536, v31
    v_add_u32 v36, 65536, v32
    v_add_u32 v37, 65536, v33
    v_add_u32 v38, 65536, v34
    v_add_u32 v39, 131072, v31
    v_add_u32 v40, 131072, v32
    v_add_u32 v41, 131072, v33
    v_add_u32 v42, 131072, v34
    s_lshl_b32 s6, s52, 1
    s_add_u32 s6, s6, s5
    s_lshl_b32 s3, s6, 1
    s_add_u32 s3, s3, s59
    s_lshl_b32 s3, s3, 4
    s_add_u32 s3, s3, s4
    s_lshl_b32 s3, s3, 12
    v_lshl_add_u32 v78, v3, 8, v4
    v_add_u32 v78, s3, v78
    s_xor_b32 s37, s51, 1
    s_lshl_b32 s37, s37, 3
    s_add_u32 s37, s37, s52
    s_lshl_b32 s3, s37, 14
    s_add_u32 s3, s3, s58
    s_add_u32 s3, s3, 16777216
    v_add_u32 v23, s3, v4
    s_lshl_b32 s37, s37, 5
    s_add_u32 s37, s37, s5
    s_lshl_b32 s37, s37, 2
    s_add_u32 s37, s37, 6422528
    s_mul_i32 s67, s6, 56
    s_lshl_b32 s3, s51, 1
    s_add_u32 s3, s3, s4
    s_add_u32 s67, s67, s3
    s_lshl_b32 s67, s67, 11
    s_add_u32 s67, s67, 2097152
    v_add_u32 v81, s58, v4
    s_lshl_b32 s68, s52, 2
    s_and_b32 s3, s51, 1
    s_add_u32 s68, s68, s3
    s_cmp_ge_u32 s51, 14
    s_cselect_b32 s3, 2, 0
    s_add_u32 s68, s68, s3
    s_lshl_b32 s68, s68, 7
    s_add_u32 s68, s68, 6356992
    s_waitcnt vmcnt(3)
    v_readfirstlane_b32 s57, v12
    s_mov_b32 s60, 0
    s_cmp_lg_u32 s57, 0
    s_cbranch_scc1 L_nonce_okh
L_nonceh:
    buffer_load_dword v12, v16, s[44:47], 0 offen sc1
    s_add_u32 s60, s60, 1
    s_waitcnt vmcnt(0)
    v_readfirstlane_b32 s57, v12
    s_cmp_ge_u32 s60, 20000
    s_cbranch_scc1 L_nonce_okh
    s_cmp_eq_u32 s57, 0
    s_cbranch_scc1 L_nonceh
L_nonce_okh:
    s_waitcnt vmcnt(0)
    s_barrier
    s_atomic_swap s57, s[28:29], s74
    s_atomic_swap s57, s[28:29], s73
    buffer_load_dwordx4 v[96:99], v85, s[8:11], 0 offen
    buffer_load_ushort v93, v82, s[40:43], 0 offen offset:0
    buffer_load_dwordx4 v[100:103], v86, s[8:11], 0 offen
    buffer_load_ushort v94, v82, s[40:43], 0 offen offset:16
    v_cmp_gt_u32 vcc, 12, v2
    s_mul_i32 s3, s48, 56
    s_add_u32 s3, s3, s79
    s_mul_i32 s3, s3, 3
    s_add_u32 s3, s3, s80
    s_lshl_b32 s3, s3, 11
    s_add_u32 s3, s3, 8388608
    s_add_u32 s3, s3, s81
    ds_read_b64_tr_b16 v[182:183], v243 offset:0
    ds_read_b64_tr_b16 v[184:185], v243 offset:16896
    ds_read_b64_tr_b16 v[186:187], v243 offset:32
    ds_read_b64_tr_b16 v[188:189], v243 offset:16928
    ds_read_b64_tr_b16 v[190:191], v243 offset:56
    ds_read_b64_tr_b16 v[192:193], v243 offset:16952
    ds_read_b64_tr_b16 v[194:195], v243 offset:88
    ds_read_b64_tr_b16 v[196:197], v243 offset:16984
    ds_read_b64_tr_b16 v[198:199], v243 offset:112
    ds_read_b64_tr_b16 v[200:201], v243 offset:17008
    ds_read_b64_tr_b16 v[202:203], v243 offset:144
    ds_read_b64_tr_b16 v[204:205], v243 offset:17040
    ds_read_b64_tr_b16 v[206:207], v243 offset:168
    ds_read_b64_tr_b16 v[208:209], v243 offset:17064
    ds_read_b64_tr_b16 v[210:211], v243 offset:200
    ds_read_b64_tr_b16 v[212:213], v243 offset:17096
    s_waitcnt lgkmcnt(13)
    v_cndmask_b32 v186, 0, v186, vcc
    v_cndmask_b32 v187, 0, v187, vcc
    s_waitcnt lgkmcnt(12)
    v_cndmask_b32 v188, 0, v188, vcc
    v_cndmask_b32 v189, 0, v189, vcc
    buffer_store_dwordx4 v[182:185], v4, s[28:31], s3 offen offset:0 sc1
    buffer_store_dwordx4 v[186:189], v4, s[28:31], s3 offen offset:1024 sc1
    s_add_u32 s3, s3, 86016
    s_waitcnt lgkmcnt(9)
    v_cndmask_b32 v194, 0, v194, vcc
    v_cndmask_b32 v195, 0, v195, vcc
    s_waitcnt lgkmcnt(8)
    v_cndmask_b32 v196, 0, v196, vcc
    v_cndmask_b32 v197, 0, v197, vcc
    buffer_store_dwordx4 v[190:193], v4, s[28:31], s3 offen offset:0 sc1
    buffer_store_dwordx4 v[194:197], v4, s[28:31], s3 offen offset:1024 sc1
    s_add_u32 s3, s3, 86016
    s_waitcnt lgkmcnt(5)
    v_cndmask_b32 v202, 0, v202, vcc
    v_cndmask_b32 v203, 0, v203, vcc
    s_waitcnt lgkmcnt(4)
    v_cndmask_b32 v204, 0, v204, vcc
    v_cndmask_b32 v205, 0, v205, vcc
    buffer_store_dwordx4 v[198:201], v4, s[28:31], s3 offen offset:0 sc1
    buffer_store_dwordx4 v[202:205], v4, s[28:31], s3 offen offset:1024 sc1
    s_add_u32 s3, s3, 86016
    ds_read_b32 v24, v4
    s_waitcnt lgkmcnt(2)
    v_cndmask_b32 v210, 0, v210, vcc
    v_cndmask_b32 v211, 0, v211, vcc
    ds_read_b32 v24, v4
    s_waitcnt lgkmcnt(2)
    v_cndmask_b32 v212, 0, v212, vcc
    v_cndmask_b32 v213, 0, v213, vcc
    buffer_store_dwordx4 v[206:209], v4, s[28:31], s3 offen offset:0 sc1
    buffer_store_dwordx4 v[210:213], v4, s[28:31], s3 offen offset:1024 sc1
    s_add_u32 s3, s3, 86016
    s_lshl_b32 s67, s80, 6
    s_add_u32 s67, s67, 64
    s_cmp_eq_u32 s81, 0
    s_cselect_b32 s37, s48, 1
    s_mov_b32 s68, 6369792
    s_and_b32 s3, s2, 1
    s_mul_i32 s3, s3, 3
    s_bfe_u32 s6, s2, 0x10001
    s_mul_i32 s7, s6, 6
    s_add_u32 s3, s3, s7
    s_add_u32 s3, s3, 1
    v_add_u32 v14, s3, v8
    s_mul_i32 s6, s6, 64
    s_add_u32 s6, s6, 7
    v_cmp_ne_u32 vcc, s6, v14
    v_lshrrev_b32 v15, 2, v1
    v_mul_u32_u24 v15, 3584, v15
    v_cndmask_b32 v14, 0, v14, vcc
    v_lshl_add_u32 v14, v14, 8, v15
    s_lshl_b32 s3, s52, 2
    s_add_u32 s3, s3, s48
    s_mul_i32 s3, s3, 37
    s_min_u32 s3, s3, 976
    s_mul_i32 s3, s3, 3584
    s_mul_i32 s6, s59, 3670144
    s_add_u32 s3, s3, s6
    buffer_load_dword v226, v14, s[20:23], s3 offen
    s_add_u32 s3, s3, 57344
    buffer_load_dword v227, v14, s[20:23], s3 offen
    s_add_u32 s3, s3, 57344
    buffer_load_dword v228, v14, s[20:23], s3 offen
    s_add_u32 s3, s3, 57344
    v_add_u32 v53, 65536, v4
    v_add_u32 v54, 131072, v4
    s_mul_i32 s59, s48, 3072
    s_mul_i32 s3, s50, 86016
    s_add_u32 s3, s3, s59
    s_add_u32 s3, s3, 8388608
    v_add_u32 v80, s3, v4
    v_lshlrev_b32 v14, 7, v9
    v_xor_b32 v14, v14, v4
    s_lshl_b32 s3, s49, 11
    v_add_u32 v67, s3, v14
    v_add_u32 v68, 129024, v67
    s_lshr_b32 s3, s49, 2
    s_lshl_b32 s3, s3, 3
    s_max_u32 s3, s3, 1
    s_sub_u32 s3, s3, 1
    s_lshl_b32 s3, s3, 10
    s_lshl_b32 s6, s5, 17
    s_add_u32 s3, s3, s6
    s_lshl_b32 s6, s4, 28
    s_add_u32 s3, s3, s6
    v_add_u32 v69, s3, v14
    s_lshl_b32 s100, s5, 1
    s_add_u32 s100, s100, s4
    s_lshl_b32 s100, s100, 10
    v_and_b32 v14, 1, v1
    v_mul_u32_u24 v14, 640, v14
    v_lshrrev_b32 v15, 2, v1
    v_lshlrev_b32 v15, 4, v15
    v_xor_b32 v14, v14, v15
    v_bfe_u32 v15, v1, 1, 1
    v_lshl_add_u32 v14, v15, 3, v14
    s_add_u32 s3, s58, 12288
    v_add_u32 v70, s3, v14
    s_sub_u32 s3, s3, 3072
    s_cmp_eq_u32 s48, 0
    s_cselect_b32 s3, 28672, s3
    v_add_u32 v71, s3, v14
    v_add_u32 v72, 65536, v70
    v_add_u32 v73, 65536, v71
    v_add_u32 v74, 131072, v70
    v_add_u32 v75, 131072, v71
    s_lshl_b32 s3, s49, 1
    v_min_u32 v14, 2, v3
    v_add_u32 v14, s3, v14
    v_max_u32 v14, 1, v14
    v_lshlrev_b32 v14, 1, v14
    v_and_b32 v15, 1, v7
    v_add_lshl_u32 v14, v14, v15, 7
    v_lshrrev_b32 v15, 1, v7
    v_lshl_add_u32 v15, v15, 2, v8
    v_lshl_add_u32 v14, v15, 2, v14
    v_add_u32 v77, 6291200, v14
    s_min_u32 s15, s48, 2
    s_lshl_b32 s15, s15, 6
    s_add_u32 s15, s15, 64
    s_lshl_b32 s82, s49, 5
    s_add_u32 s82, s82, s50
    s_lshl_b32 s82, s82, 10
    s_add_u32 s82, s82, 4194304
    s_lshr_b32 s69, s49, 2
    s_lshl_b32 s69, s69, 1
    s_and_b32 s3, s50, 1
    s_add_u32 s69, s69, s3
    s_lshl_b32 s69, s69, 7
    s_add_u32 s69, s69, 6361088
    s_and_b32 s7, s53, 1
    s_mul_i32 s3, s7, 28
    s_add_u32 s3, s3, s48
    s_lshl_b32 s3, s3, 17
    s_xor_b32 s6, s53, 1
    s_lshl_b32 s55, s6, 3
    s_lshl_b32 s6, s53, 7
    s_add_u32 s3, s3, s6
    v_lshlrev_b32 v14, 12, v5
    v_add3_u32 v59, v14, v83, s3
    v_add_u32 v60, 31744, v59
    v_add_u32 v61, 63488, v59
    v_add_u32 v62, 95232, v59
    v_mul_u32_u24 v14, 896, v5
    s_mul_i32 s3, s4, 25088
    s_mul_i32 s6, s5, 14336
    s_add_u32 s3, s3, s6
    s_lshl_b32 s6, s54, 7
    s_add_u32 s3, s3, s6
    v_add3_u32 v63, v14, v83, s3
    v_add_u32 v64, 6144, v63
    s_lshl_b32 s6, s53, 1
    s_add_u32 s6, s6, s5
    s_and_b32 s3, s53, 30
    s_add_u32 s3, s3, s4
    s_lshl_b32 s3, s3, 7
    s_add_u32 s39, s3, 6361088
    s_lshl_b32 s3, s6, 5
    s_add_u32 s3, s3, s4
    s_lshl_b32 s3, s3, 10
    s_add_u32 s3, s3, 4194304
    v_add_u32 v65, s3, v4
    v_add_u32 v66, 15360, v65
    s_xor_b32 s3, s4, s5
    s_lshl_b32 s3, s3, 6
    v_xor_b32 v43, s3, v31
    v_xor_b32 v44, 32, v43
    v_add_u32 v45, 65536, v43
    v_add_u32 v46, 65536, v44
    s_mul_i32 s3, s4, 12288
    v_add_u32 v47, s3, v4
    v_xor_b32 v48, 4096, v47
    v_add_u32 v49, 65536, v47
    v_add_u32 v50, 65536, v48
    v_add_u32 v51, 131072, v47
    v_add_u32 v52, 131072, v48
    s_lshl_b32 s6, s54, 1
    s_add_u32 s6, s6, s5
    s_lshl_b32 s3, s6, 1
    s_add_u32 s3, s3, s7
    s_mul_i32 s3, s3, 14
    s_add_u32 s3, s3, s4
    s_lshl_b32 s3, s3, 12
    s_add_u32 s3, s3, 2097152
    v_add_u32 v79, s3, v4
    s_lshl_b32 s3, s54, 1
    s_add_u32 s3, s3, s7
    s_lshl_b32 s3, s3, 1
    s_add_u32 s3, s3, s4
    s_lshl_b32 s3, s3, 7
    s_add_u32 s38, s3, 6356992
    s_and_b32 s3, s2, 6
    s_add_u32 s3, s3, s54
    s_sub_u32 s6, s3, 7
    s_cmp_ge_u32 s3, 7
    s_cselect_b32 s3, s6, s3
    s_lshl_b32 s64, s3, 19
    s_lshl_b32 s65, s3, 13
    s_add_u32 s55, s55, s54
    s_lshl_b32 s3, s55, 14
    s_add_u32 s3, s3, s58
    s_add_u32 s3, s3, 12582912
    v_add_u32 v21, s3, v4
    s_lshl_b32 s55, s55, 5
    s_add_u32 s55, s55, s48
    s_lshl_b32 s55, s55, 2
    s_add_u32 s55, s55, 6488064
    s_lshl_b32 s3, s5, 3
    v_add_u32 v13, s3, v3
    v_xor_b32 v13, v13, v6
    v_lshlrev_b32 v13, 4, v13
    v_lshl_add_u32 v13, v2, 8, v13
    s_lshl_b32 s3, s4, 14
    s_add_u32 s3, s3, 131072
    v_add_u32 v87, s3, v13
    v_xor_b32 v88, 64, v87
    s_lshr_b32 s3, s53, 1
    s_add_u32 s66, s3, s54
    v_lshlrev_b32 v13, 1, v6
    v_xor_b32 v13, v13, v5
    v_lshlrev_b32 v13, 4, v13
    v_lshl_add_u32 v13, v5, 8, v13
    s_add_u32 s3, s58, 131072
    v_add_u32 v89, s3, v13
    v_xor_b32 v90, 16, v89
    v_xor_b32 v91, 24576, v89
    v_xor_b32 v92, 24592, v89
    s_mov_b32 s70, 0xaaaaaaaa
    s_mov_b32 s71, 0xaaaaaaaa
    s_mov_b32 s72, 0xfff0ffff
    s_mov_b32 s73, 0xf000ff00
    s_mov_b32 s74, 0xffc0fffc
    s_mov_b32 s75, 0xc000fc00
    s_cmp_eq_u32 s49, 0
    s_cselect_b64 s[76:77], 0, -1
    v_mov_b32 v13, 0xffff
    v_mov_b32 v14, 0xffff0000
    v_cndmask_b32 v13, v13, v14, s[70:71]
    v_cndmask_b32 v104, v13, 0, s[72:73]
    v_cndmask_b32 v106, 0, v13, s[72:73]
    v_cndmask_b32 v105, v13, 0, s[74:75]
    v_cndmask_b32 v107, 0, v13, s[74:75]
    v_mov_b32 v84, 0xf149f2ca
    s_mov_b32 s83, 0x3e8b97f6
    s_mov_b32 s78, 0xbdd2d3e8
    s_mov_b32 s79, 0xbdd2d3e8
    s_mov_b32 s80, 1.0
    s_mov_b32 s81, 1.0
    v_mov_b32 v108, 0xc0135761
    v_mov_b32 v109, 0xc0135761
    v_lshrrev_b32 v13, 1, v2
    v_lshlrev_b32 v14, 1, v3
    v_sub_u32 v13, v13, v14
    v_mov_b32 v14, 0x3f80
    v_cndmask_b32 v14, v14, 1.0, s[70:71]
    v_cmp_eq_i32 vcc, 0, v13
    v_accvgpr_write_b32 a248, 0
    v_accvgpr_write_b32 a252, 0
    v_cndmask_b32 v15, 0, v14, vcc
    v_accvgpr_write_b32 a250, v15
    v_cmp_eq_i32 vcc, 1, v13
    v_accvgpr_write_b32 a249, 0
    v_accvgpr_write_b32 a253, 0
    v_cndmask_b32 v15, 0, v14, vcc
    v_accvgpr_write_b32 a251, v15
    s_waitcnt vmcnt(3)
    s_barrier
    s_cmp_lg_u32 s37, 0
    s_cbranch_scc1 L_nowsig
    s_atomic_add s36, s[44:45], s67
L_nowsig:
    buffer_load_dword v18, v20, s[28:31], 0 offen sc1
    s_cmp_eq_u32 s56, 0
    s_cselect_b32 s26, 0, s26
    v_and_b32 v13, 0xfffff000, v78
    v_lshl_add_u32 v13, v10, 7, v13
    s_add_u32 s3, s1, 8192
    v_lshl_add_u32 v14, v9, 13, s3
    s_waitcnt vmcnt(0)
    v_cmp_ne_u32 vcc, s57, v18
    s_cbranch_vccz L_pollok3
    s_mov_b32 s60, 0
L_poll3:
    s_sleep 8
    buffer_load_dword v18, v20, s[28:31], 0 offen sc1
    s_add_u32 s60, s60, 1
    s_waitcnt vmcnt(0)
    v_cmp_ne_u32 vcc, s57, v18
    s_cbranch_vccz L_pollok3
    s_cmp_lt_u32 s60, 20000
    s_cbranch_scc1 L_poll3
L_pollok3:
    s_barrier
    buffer_load_dword v76, v77, s[28:31], 0 offen sc1
    s_mov_b32 s26, 7340032
    s_and_b32 s3, s2, 1
    s_mul_i32 s3, s3, 7
    s_add_u32 s3, s3, s52
    s_lshl_b32 s3, s3, 2
    s_add_u32 s3, s3, s48
    s_lshl_b32 s3, s3, 17
    s_and_b32 s6, s2, 6
    s_lshl_b32 s6, s6, 9
    s_add_u32 s3, s3, s6
    v_lshlrev_b32 v13, 12, v10
    v_lshl_add_u32 v13, v9, 9, v13
    buffer_load_dword v232, v13, s[24:27], s3 offen offset:384
    buffer_load_dword v233, v13, s[24:27], s3 offen offset:256
    s_cmp_eq_u32 s56, 0
    s_cselect_b32 s26, 0, s26
    v_lshlrev_b32 v13, 2, v2
    v_and_b32 v14, 1, v1
    v_lshl_add_u32 v14, v3, 2, v14
    v_lshlrev_b32 v14, 2, v14
    v_add_u32 v15, 64, v14
    v_cndmask_b32 v16, v14, v15, s[72:73]
    v_cndmask_b32 v14, v14, v15, s[74:75]
    s_waitcnt vmcnt(2)
    ds_bpermute_b32 v25, v13, v76 offset:64
    ds_bpermute_b32 v27, v16, v76 offset:0
    ds_bpermute_b32 v28, v14, v76 offset:8
    ds_bpermute_b32 v26, v13, v76 offset:128
    ds_bpermute_b32 v29, v16, v76 offset:64
    ds_bpermute_b32 v30, v14, v76 offset:72
    s_waitcnt lgkmcnt(5)
    v_mul_f32 v25, s83, v25
    ds_read_b32 v24, v4
    s_waitcnt lgkmcnt(3)
    v_mul_f32 v26, s83, v26
    s_load_dword s14, s[44:45], s15
    s_waitcnt lgkmcnt(0)
    s_cmp_ge_u32 s14, 14
    s_cbranch_scc1 L_pollok4
    s_mov_b32 s60, 0
L_poll4:
    s_sleep 16
    buffer_load_dword v18, off, s[44:47], s15 sc1
    s_add_u32 s60, s60, 1
    s_waitcnt vmcnt(0)
    v_readfirstlane_b32 s14, v18
    s_nop 0
    s_cmp_ge_u32 s14, 14
    s_cbranch_scc1 L_pollok4
    s_cmp_lt_u32 s60, 20000
    s_cbranch_scc1 L_poll4
L_pollok4:
    s_barrier
    s_cmp_eq_u32 s56, 0
    s_cselect_b32 s3, 268435456, 0
    v_add_u32 v79, s3, v79
    s_add_u32 m0, s59, 98304
    s_nop 0
    buffer_load_dwordx4 v80, s[28:31], s63 offen sc1 lds
    buffer_load_dwordx4 v80, s[28:31], s63 offen offset:1024 sc1 lds
    buffer_load_dwordx4 v80, s[28:31], s63 offen offset:2048 sc1 lds
    s_add_u32 m0, s100, 126976
    s_nop 0
    buffer_load_dwordx4 v69, s[28:31], s62 offen sc1 lds
    s_add_u32 m0, s58, 110592
    s_nop 0
    buffer_load_dwordx4 v67, s[28:31], s62 offen sc1 lds
    buffer_load_dwordx4 v67, s[28:31], s62 offen offset:1024 sc1 lds
    buffer_load_dwordx4 v68, s[28:31], s62 offen offset:2048 sc1 lds
    buffer_load_dwordx4 v68, s[28:31], s62 offen offset:3072 sc1 lds
    s_add_u32 m0, s59, 131072
    s_add_u32 s63, s63, 12288
    s_cmp_eq_u32 s63, 86016
    s_cselect_b32 s63, 0, s63
    buffer_load_dwordx4 v80, s[28:31], s63 offen sc1 lds
    buffer_load_dwordx4 v80, s[28:31], s63 offen offset:1024 sc1 lds
    buffer_load_dwordx4 v80, s[28:31], s63 offen offset:2048 sc1 lds
    s_add_u32 m0, s100, 159744
    s_add_u32 s62, s62, 262144
    s_cmp_eq_u32 s62, 1835008
    s_cselect_b32 s62, 0, s62
    buffer_load_dwordx4 v69, s[28:31], s62 offen sc1 lds
    s_add_u32 m0, s58, 143360
    s_nop 0
    buffer_load_dwordx4 v67, s[28:31], s62 offen sc1 lds
    buffer_load_dwordx4 v67, s[28:31], s62 offen offset:1024 sc1 lds
    buffer_load_dwordx4 v68, s[28:31], s62 offen offset:2048 sc1 lds
    buffer_load_dwordx4 v68, s[28:31], s62 offen offset:3072 sc1 lds
    s_add_u32 m0, s59, 0
    s_add_u32 s63, s63, 12288
    s_cmp_eq_u32 s63, 86016
    s_cselect_b32 s63, 0, s63
    buffer_load_dwordx4 v80, s[28:31], s63 offen sc1 lds
    buffer_load_dwordx4 v80, s[28:31], s63 offen offset:1024 sc1 lds
    buffer_load_dwordx4 v80, s[28:31], s63 offen offset:2048 sc1 lds
    s_add_u32 m0, s100, 28672
    s_add_u32 s62, s62, 262144
    s_cmp_eq_u32 s62, 1835008
    s_cselect_b32 s62, 0, s62
    buffer_load_dwordx4 v69, s[28:31], s62 offen sc1 lds
    s_add_u32 m0, s58, 12288
    s_nop 0
    buffer_load_dwordx4 v67, s[28:31], s62 offen sc1 lds
    buffer_load_dwordx4 v67, s[28:31], s62 offen offset:1024 sc1 lds
    buffer_load_dwordx4 v68, s[28:31], s62 offen offset:2048 sc1 lds
    buffer_load_dwordx4 v68, s[28:31], s62 offen offset:3072 sc1 lds
    s_add_u32 m0, s59, 65536
    s_add_u32 s63, s63, 12288
    s_cmp_eq_u32 s63, 86016
    s_cselect_b32 s63, 0, s63
    buffer_load_dwordx4 v80, s[28:31], s63 offen sc1 lds
    buffer_load_dwordx4 v80, s[28:31], s63 offen offset:1024 sc1 lds
    buffer_load_dwordx4 v80, s[28:31], s63 offen offset:2048 sc1 lds
    s_add_u32 m0, s100, 94208
    s_add_u32 s62, s62, 262144
    s_cmp_eq_u32 s62, 1835008
    s_cselect_b32 s62, 0, s62
    buffer_load_dwordx4 v69, s[28:31], s62 offen sc1 lds
    s_add_u32 m0, s58, 77824
    s_nop 0
    buffer_load_dwordx4 v67, s[28:31], s62 offen sc1 lds
    buffer_load_dwordx4 v67, s[28:31], s62 offen offset:1024 sc1 lds
    buffer_load_dwordx4 v68, s[28:31], s62 offen offset:2048 sc1 lds
    buffer_load_dwordx4 v68, s[28:31], s62 offen offset:3072 sc1 lds
    s_mov_b32 s3, 268435456
    buffer_store_dword v12, v11, s[28:31], s3 offen
    buffer_store_dword v12, v11, s[28:31], s3 offen
    s_waitcnt vmcnt(18)
    s_barrier
    ds_read_b64_tr_b16 a[180:181], v72 offset:32768
    ds_read_b64_tr_b16 a[182:183], v72 offset:33024
    ds_read_b128 a[128:131], v53 offset:32768
    ds_read_b64_tr_b16 a[184:185], v72 offset:33792
    ds_read_b64_tr_b16 a[186:187], v72 offset:34048
    ds_read_b128 a[132:135], v53 offset:33792
    ds_read_b128 a[136:139], v53 offset:34816
    ds_read_b64_tr_b16 a[176:177], v73 offset:32768
    ds_read_b64_tr_b16 a[178:179], v73 offset:33024
    ds_read_b128 a[140:143], v53 offset:35840
    ds_read_b128 a[144:147], v53 offset:36864
    ds_read_b128 a[148:151], v53 offset:37888
    s_waitcnt lgkmcnt(0)
    s_nop 3
L_q:
    s_waitcnt lgkmcnt(6)
    v_mfma_f32_16x16x32_bf16 v[182:185], a[128:131], a[180:183], 0
    ds_read_b64_tr_b16 a[192:193], v72 offset:34816
    ds_read_b64_tr_b16 a[194:195], v72 offset:35072
    v_mfma_f32_16x16x32_bf16 v[190:193], a[128:131], a[184:187], 0
    ds_read_b128 a[152:155], v53 offset:38912
    ds_read_b64_tr_b16 a[196:197], v72 offset:35840
    v_mfma_f32_16x16x32_bf16 v[186:189], a[132:135], a[180:183], 0
    ds_read_b64_tr_b16 a[198:199], v72 offset:36096
    ds_read_b128 a[156:159], v53 offset:39936
    v_mfma_f32_16x16x32_bf16 v[194:197], a[132:135], a[184:187], 0
    ds_read_b128 a[160:163], v53 offset:40960
    ds_read_b64_tr_b16 a[188:189], v73 offset:34816
    s_waitcnt lgkmcnt(8)
    v_mfma_f32_16x16x32_bf16 v[206:209], a[136:139], a[180:183], 0
    ds_read_b64_tr_b16 a[190:191], v73 offset:35072
    v_mfma_f32_16x16x32_bf16 v[214:217], a[136:139], a[184:187], 0
    ds_read_b128 a[164:167], v53 offset:41984
    v_mfma_f32_16x16x32_bf16 v[198:201], a[136:139], a[176:179], 0
    ds_read_b128 a[168:171], v53 offset:43008
    v_mfma_f32_16x16x32_bf16 v[210:213], a[140:143], a[180:183], 0
    ds_read_b128 a[172:175], v53 offset:44032
    v_mfma_f32_16x16x32_bf16 v[218:221], a[140:143], a[184:187], 0
    v_mfma_f32_16x16x32_bf16 v[202:205], a[140:143], a[176:179], 0
    v_mfma_f32_16x16x32_bf16 v[230:233], a[180:183], a[144:147], 0
    v_mfma_f32_16x16x32_bf16 v[238:241], a[184:187], a[144:147], 0
    v_mfma_f32_16x16x32_bf16 v[222:225], a[176:179], a[144:147], 0
    v_mfma_f32_16x16x32_bf16 v[234:237], a[180:183], a[148:151], 0
    v_mfma_f32_16x16x32_bf16 v[242:245], a[184:187], a[148:151], 0
    v_mfma_f32_16x16x32_bf16 v[226:229], a[176:179], a[148:151], 0
    s_waitcnt lgkmcnt(0)
    s_barrier
    v_mfma_f32_16x16x32_bf16 v[182:185], a[152:155], a[192:195], v[182:185]
    ds_read_b64_tr_b16 a[180:181], v74 offset:0
    s_add_u32 m0, s59, 32768
    v_mfma_f32_16x16x32_bf16 v[190:193], a[152:155], a[196:199], v[190:193]
    ds_read_b64_tr_b16 a[182:183], v74 offset:256
    s_add_u32 s63, s63, 12288
    v_mfma_f32_16x16x32_bf16 v[186:189], a[156:159], a[192:195], v[186:189]
    ds_read_b128 a[128:131], v54 offset:0
    s_cmp_eq_u32 s63, 86016
    v_mfma_f32_16x16x32_bf16 v[194:197], a[156:159], a[196:199], v[194:197]
    ds_read_b64_tr_b16 a[184:185], v74 offset:1024
    v_mfma_f32_16x16x32_bf16 v[206:209], a[160:163], a[192:195], v[206:209]
    ds_read_b64_tr_b16 a[186:187], v74 offset:1280
    s_cselect_b32 s63, 0, s63
    v_mfma_f32_16x16x32_bf16 v[214:217], a[160:163], a[196:199], v[214:217]
    ds_read_b128 a[132:135], v54 offset:1024
    buffer_load_dwordx4 v80, s[28:31], s63 offen sc1 lds
    v_mfma_f32_16x16x32_bf16 v[198:201], a[160:163], a[188:191], v[198:201]
    ds_read_b128 a[136:139], v54 offset:2048
    v_mfma_f32_16x16x32_bf16 v[210:213], a[164:167], a[192:195], v[210:213]
    ds_read_b64_tr_b16 a[176:177], v75 offset:0
    buffer_load_dwordx4 v80, s[28:31], s63 offen offset:1024 sc1 lds
    v_mfma_f32_16x16x32_bf16 v[218:221], a[164:167], a[196:199], v[218:221]
    ds_read_b64_tr_b16 a[178:179], v75 offset:256
    v_mfma_f32_16x16x32_bf16 v[202:205], a[164:167], a[188:191], v[202:205]
    ds_read_b128 a[140:143], v54 offset:3072
    v_mfma_f32_16x16x32_bf16 v[230:233], a[192:195], a[168:171], v[230:233]
    ds_read_b128 a[144:147], v54 offset:4096
    buffer_load_dwordx4 v80, s[28:31], s63 offen offset:2048 sc1 lds
    v_mfma_f32_16x16x32_bf16 v[238:241], a[196:199], a[168:171], v[238:241]
    ds_read_b128 a[148:151], v54 offset:5120
    s_add_u32 m0, s100, 61440
    v_mfma_f32_16x16x32_bf16 v[222:225], a[188:191], a[168:171], v[222:225]
    s_add_u32 s62, s62, 262144
    s_cmp_eq_u32 s62, 1835008
    v_mfma_f32_16x16x32_bf16 v[234:237], a[192:195], a[172:175], v[234:237]
    s_cselect_b32 s62, 0, s62
    buffer_load_dwordx4 v69, s[28:31], s62 offen sc1 lds
    v_mfma_f32_16x16x32_bf16 v[242:245], a[196:199], a[172:175], v[242:245]
    s_add_u32 m0, s58, 45056
    v_mfma_f32_16x16x32_bf16 v[226:229], a[188:191], a[172:175], v[226:229]
    s_waitcnt lgkmcnt(6)
    v_mfma_f32_16x16x32_bf16 v[182:185], a[128:131], a[180:183], v[182:185]
    ds_read_b64_tr_b16 a[192:193], v74 offset:2048
    ds_read_b64_tr_b16 a[194:195], v74 offset:2304
    v_mfma_f32_16x16x32_bf16 v[190:193], a[128:131], a[184:187], v[190:193]
    ds_read_b128 a[152:155], v54 offset:6144
    ds_read_b64_tr_b16 a[196:197], v74 offset:3072
    v_mfma_f32_16x16x32_bf16 v[186:189], a[132:135], a[180:183], v[186:189]
    ds_read_b64_tr_b16 a[198:199], v74 offset:3328
    ds_read_b128 a[156:159], v54 offset:7168
    v_mfma_f32_16x16x32_bf16 v[194:197], a[132:135], a[184:187], v[194:197]
    ds_read_b128 a[160:163], v54 offset:8192
    ds_read_b64_tr_b16 a[188:189], v75 offset:2048
    s_waitcnt lgkmcnt(8)
    v_mfma_f32_16x16x32_bf16 v[206:209], a[136:139], a[180:183], v[206:209]
    ds_read_b64_tr_b16 a[190:191], v75 offset:2304
    buffer_load_dwordx4 v67, s[28:31], s62 offen sc1 lds
    v_mfma_f32_16x16x32_bf16 v[214:217], a[136:139], a[184:187], v[214:217]
    ds_read_b128 a[164:167], v54 offset:9216
    v_mfma_f32_16x16x32_bf16 v[198:201], a[136:139], a[176:179], v[198:201]
    ds_read_b128 a[168:171], v54 offset:10240
    buffer_load_dwordx4 v67, s[28:31], s62 offen offset:1024 sc1 lds
    v_mfma_f32_16x16x32_bf16 v[210:213], a[140:143], a[180:183], v[210:213]
    ds_read_b128 a[172:175], v54 offset:11264
    v_mfma_f32_16x16x32_bf16 v[218:221], a[140:143], a[184:187], v[218:221]
    v_mfma_f32_16x16x32_bf16 v[202:205], a[140:143], a[176:179], v[202:205]
    buffer_load_dwordx4 v68, s[28:31], s62 offen offset:2048 sc1 lds
    v_mfma_f32_16x16x32_bf16 v[230:233], a[180:183], a[144:147], v[230:233]
    v_mfma_f32_16x16x32_bf16 v[238:241], a[184:187], a[144:147], v[238:241]
    v_mfma_f32_16x16x32_bf16 v[222:225], a[176:179], a[144:147], v[222:225]
    buffer_load_dwordx4 v68, s[28:31], s62 offen offset:3072 sc1 lds
    s_add_u32 m0, s59, 98304
    v_mfma_f32_16x16x32_bf16 v[234:237], a[180:183], a[148:151], v[234:237]
    s_add_u32 s63, s63, 12288
    s_cmp_eq_u32 s63, 86016
    v_mfma_f32_16x16x32_bf16 v[242:245], a[184:187], a[148:151], v[242:245]
    s_cselect_b32 s63, 0, s63
    v_mfma_f32_16x16x32_bf16 v[226:229], a[176:179], a[148:151], v[226:229]
    s_waitcnt vmcnt(8) lgkmcnt(0)
    s_barrier
    s_cmp_lg_u32 s48, 0
    s_cbranch_scc1 L_sig2
    s_atomic_add s36, s[28:29], s68
L_sig2:
    v_mfma_f32_16x16x32_bf16 v[182:185], a[152:155], a[192:195], v[182:185]
    ds_read_b64_tr_b16 a[180:181], v70 offset:0
    buffer_load_dwordx4 v80, s[28:31], s63 offen sc1 lds
    v_mfma_f32_16x16x32_bf16 v[190:193], a[152:155], a[196:199], v[190:193]
    ds_read_b64_tr_b16 a[182:183], v70 offset:256
    v_mfma_f32_16x16x32_bf16 v[186:189], a[156:159], a[192:195], v[186:189]
    ds_read_b128 a[128:131], v4 offset:0
    buffer_load_dwordx4 v80, s[28:31], s63 offen offset:1024 sc1 lds
    v_mfma_f32_16x16x32_bf16 v[194:197], a[156:159], a[196:199], v[194:197]
    ds_read_b64_tr_b16 a[184:185], v70 offset:1024
    v_mfma_f32_16x16x32_bf16 v[206:209], a[160:163], a[192:195], v[206:209]
    ds_read_b64_tr_b16 a[186:187], v70 offset:1280
    v_mfma_f32_16x16x32_bf16 v[214:217], a[160:163], a[196:199], v[214:217]
    ds_read_b128 a[132:135], v4 offset:1024
    buffer_load_dwordx4 v80, s[28:31], s63 offen offset:2048 sc1 lds
    v_mfma_f32_16x16x32_bf16 v[198:201], a[160:163], a[188:191], v[198:201]
    ds_read_b128 a[136:139], v4 offset:2048
    s_add_u32 m0, s100, 126976
    v_mfma_f32_16x16x32_bf16 v[210:213], a[164:167], a[192:195], v[210:213]
    ds_read_b64_tr_b16 a[176:177], v71 offset:0
    s_add_u32 s62, s62, 262144
    v_mfma_f32_16x16x32_bf16 v[218:221], a[164:167], a[196:199], v[218:221]
    ds_read_b64_tr_b16 a[178:179], v71 offset:256
    s_cmp_eq_u32 s62, 1835008
    v_mfma_f32_16x16x32_bf16 v[202:205], a[164:167], a[188:191], v[202:205]
    ds_read_b128 a[140:143], v4 offset:3072
    s_cselect_b32 s62, 0, s62
    v_mfma_f32_16x16x32_bf16 v[230:233], a[192:195], a[168:171], v[230:233]
    ds_read_b128 a[144:147], v4 offset:4096
    buffer_load_dwordx4 v69, s[28:31], s62 offen sc1 lds
    v_mfma_f32_16x16x32_bf16 v[238:241], a[196:199], a[168:171], v[238:241]
    ds_read_b128 a[148:151], v4 offset:5120
    s_add_u32 m0, s58, 110592
    v_mfma_f32_16x16x32_bf16 v[222:225], a[188:191], a[168:171], v[222:225]
    buffer_load_dwordx4 v67, s[28:31], s62 offen sc1 lds
    v_mfma_f32_16x16x32_bf16 v[234:237], a[192:195], a[172:175], v[234:237]
    v_mfma_f32_16x16x32_bf16 v[242:245], a[196:199], a[172:175], v[242:245]
    v_mfma_f32_16x16x32_bf16 v[226:229], a[188:191], a[172:175], v[226:229]
    buffer_load_dwordx4 v67, s[28:31], s62 offen offset:1024 sc1 lds
    s_waitcnt lgkmcnt(6)
    v_mfma_f32_16x16x32_bf16 v[182:185], a[128:131], a[180:183], v[182:185]
    ds_read_b64_tr_b16 a[192:193], v70 offset:2048
    ds_read_b64_tr_b16 a[194:195], v70 offset:2304
    v_mfma_f32_16x16x32_bf16 v[190:193], a[128:131], a[184:187], v[190:193]
    ds_read_b128 a[152:155], v4 offset:6144
    ds_read_b64_tr_b16 a[196:197], v70 offset:3072
    v_mfma_f32_16x16x32_bf16 v[186:189], a[132:135], a[180:183], v[186:189]
    ds_read_b64_tr_b16 a[198:199], v70 offset:3328
    ds_read_b128 a[156:159], v4 offset:7168
    v_mfma_f32_16x16x32_bf16 v[194:197], a[132:135], a[184:187], v[194:197]
    ds_read_b128 a[160:163], v4 offset:8192
    ds_read_b64_tr_b16 a[188:189], v71 offset:2048
    s_waitcnt lgkmcnt(8)
    v_mfma_f32_16x16x32_bf16 v[206:209], a[136:139], a[180:183], v[206:209]
    ds_read_b64_tr_b16 a[190:191], v71 offset:2304
    buffer_load_dwordx4 v68, s[28:31], s62 offen offset:2048 sc1 lds
    v_mfma_f32_16x16x32_bf16 v[214:217], a[136:139], a[184:187], v[214:217]
    ds_read_b128 a[164:167], v4 offset:9216
    v_mfma_f32_16x16x32_bf16 v[198:201], a[136:139], a[176:179], v[198:201]
    ds_read_b128 a[168:171], v4 offset:10240
    buffer_load_dwordx4 v68, s[28:31], s62 offen offset:3072 sc1 lds
    v_mfma_f32_16x16x32_bf16 v[210:213], a[140:143], a[180:183], v[210:213]
    ds_read_b128 a[172:175], v4 offset:11264
    s_add_u32 m0, s59, 131072
    v_mfma_f32_16x16x32_bf16 v[218:221], a[140:143], a[184:187], v[218:221]
    s_add_u32 s63, s63, 12288
    s_cmp_eq_u32 s63, 86016
    v_mfma_f32_16x16x32_bf16 v[202:205], a[140:143], a[176:179], v[202:205]
    s_cselect_b32 s63, 0, s63
    buffer_load_dwordx4 v80, s[28:31], s63 offen sc1 lds
    v_mfma_f32_16x16x32_bf16 v[230:233], a[180:183], a[144:147], v[230:233]
    v_mfma_f32_16x16x32_bf16 v[238:241], a[184:187], a[144:147], v[238:241]
    v_mfma_f32_16x16x32_bf16 v[222:225], a[176:179], a[144:147], v[222:225]
    buffer_load_dwordx4 v80, s[28:31], s63 offen offset:1024 sc1 lds
    v_mfma_f32_16x16x32_bf16 v[234:237], a[180:183], a[148:151], v[234:237]
    v_mfma_f32_16x16x32_bf16 v[242:245], a[184:187], a[148:151], v[242:245]
    v_mfma_f32_16x16x32_bf16 v[226:229], a[176:179], a[148:151], v[226:229]
    ds_read_b32 v24, v4
    s_waitcnt lgkmcnt(1)
    s_barrier
    v_mfma_f32_16x16x32_bf16 v[182:185], a[152:155], a[192:195], v[182:185]
    ds_read_b64_tr_b16 a[180:181], v72 offset:0
    buffer_load_dwordx4 v80, s[28:31], s63 offen offset:2048 sc1 lds
    v_mfma_f32_16x16x32_bf16 v[190:193], a[152:155], a[196:199], v[190:193]
    ds_read_b64_tr_b16 a[182:183], v72 offset:256
    s_add_u32 m0, s100, 159744
    v_mfma_f32_16x16x32_bf16 v[186:189], a[156:159], a[192:195], v[186:189]
    ds_read_b128 a[128:131], v53 offset:0
    s_add_u32 s62, s62, 262144
    v_mfma_f32_16x16x32_bf16 v[194:197], a[156:159], a[196:199], v[194:197]
    ds_read_b64_tr_b16 a[184:185], v72 offset:1024
    v_mfma_f32_16x16x32_bf16 v[206:209], a[160:163], a[192:195], v[206:209]
    ds_read_b64_tr_b16 a[186:187], v72 offset:1280
    s_cmp_eq_u32 s62, 1835008
    v_mfma_f32_16x16x32_bf16 v[214:217], a[160:163], a[196:199], v[214:217]
    ds_read_b128 a[132:135], v53 offset:1024
    s_cselect_b32 s62, 0, s62
    v_mfma_f32_16x16x32_bf16 v[198:201], a[160:163], a[188:191], v[198:201]
    ds_read_b128 a[136:139], v53 offset:2048
    buffer_load_dwordx4 v69, s[28:31], s62 offen sc1 lds
    v_mfma_f32_16x16x32_bf16 v[210:213], a[164:167], a[192:195], v[210:213]
    ds_read_b64_tr_b16 a[176:177], v73 offset:0
    s_add_u32 m0, s58, 143360
    v_mfma_f32_16x16x32_bf16 v[218:221], a[164:167], a[196:199], v[218:221]
    ds_read_b64_tr_b16 a[178:179], v73 offset:256
    buffer_load_dwordx4 v67, s[28:31], s62 offen sc1 lds
    v_mfma_f32_16x16x32_bf16 v[202:205], a[164:167], a[188:191], v[202:205]
    ds_read_b128 a[140:143], v53 offset:3072
    v_mfma_f32_16x16x32_bf16 v[230:233], a[192:195], a[168:171], v[230:233]
    ds_read_b128 a[144:147], v53 offset:4096
    v_mfma_f32_16x16x32_bf16 v[238:241], a[196:199], a[168:171], v[238:241]
    ds_read_b128 a[148:151], v53 offset:5120
    buffer_load_dwordx4 v67, s[28:31], s62 offen offset:1024 sc1 lds
    v_mfma_f32_16x16x32_bf16 v[222:225], a[188:191], a[168:171], v[222:225]
    v_mfma_f32_16x16x32_bf16 v[234:237], a[192:195], a[172:175], v[234:237]
    v_mfma_f32_16x16x32_bf16 v[242:245], a[196:199], a[172:175], v[242:245]
    buffer_load_dwordx4 v68, s[28:31], s62 offen offset:2048 sc1 lds
    v_mfma_f32_16x16x32_bf16 v[226:229], a[188:191], a[172:175], v[226:229]
    s_waitcnt lgkmcnt(6)
    v_mfma_f32_16x16x32_bf16 v[182:185], a[128:131], a[180:183], v[182:185]
    ds_read_b64_tr_b16 a[192:193], v72 offset:2048
    ds_read_b64_tr_b16 a[194:195], v72 offset:2304
    v_mfma_f32_16x16x32_bf16 v[190:193], a[128:131], a[184:187], v[190:193]
    ds_read_b128 a[152:155], v53 offset:6144
    ds_read_b64_tr_b16 a[196:197], v72 offset:3072
    v_mfma_f32_16x16x32_bf16 v[186:189], a[132:135], a[180:183], v[186:189]
    ds_read_b64_tr_b16 a[198:199], v72 offset:3328
    ds_read_b128 a[156:159], v53 offset:7168
    v_mfma_f32_16x16x32_bf16 v[194:197], a[132:135], a[184:187], v[194:197]
    ds_read_b128 a[160:163], v53 offset:8192
    ds_read_b64_tr_b16 a[188:189], v73 offset:2048
    s_waitcnt lgkmcnt(8)
    v_mfma_f32_16x16x32_bf16 v[206:209], a[136:139], a[180:183], v[206:209]
    ds_read_b64_tr_b16 a[190:191], v73 offset:2304
    buffer_load_dwordx4 v68, s[28:31], s62 offen offset:3072 sc1 lds
    v_mfma_f32_16x16x32_bf16 v[214:217], a[136:139], a[184:187], v[214:217]
    ds_read_b128 a[164:167], v53 offset:9216
    s_add_u32 m0, s58, 0
    v_mfma_f32_16x16x32_bf16 v[198:201], a[136:139], a[176:179], v[198:201]
    ds_read_b128 a[168:171], v53 offset:10240
    buffer_load_dwordx4 v59, s[24:27], s64 offen lds
    v_mfma_f32_16x16x32_bf16 v[210:213], a[140:143], a[180:183], v[210:213]
    ds_read_b128 a[172:175], v53 offset:11264
    v_mfma_f32_16x16x32_bf16 v[218:221], a[140:143], a[184:187], v[218:221]
    v_mfma_f32_16x16x32_bf16 v[202:205], a[140:143], a[176:179], v[202:205]
    buffer_load_dwordx4 v60, s[24:27], s64 offen offset:1024 lds
    v_mfma_f32_16x16x32_bf16 v[230:233], a[180:183], a[144:147], v[230:233]
    v_mfma_f32_16x16x32_bf16 v[238:241], a[184:187], a[144:147], v[238:241]
    v_mfma_f32_16x16x32_bf16 v[222:225], a[176:179], a[144:147], v[222:225]
    buffer_load_dwordx4 v61, s[24:27], s64 offen offset:2048 lds
    v_mfma_f32_16x16x32_bf16 v[234:237], a[180:183], a[148:151], v[234:237]
    v_mfma_f32_16x16x32_bf16 v[242:245], a[184:187], a[148:151], v[242:245]
    v_mfma_f32_16x16x32_bf16 v[226:229], a[176:179], a[148:151], v[226:229]
    ds_read_b32 v24, v4
    s_waitcnt vmcnt(19) lgkmcnt(1)
    s_barrier
    v_mfma_f32_16x16x32_bf16 v[182:185], a[152:155], a[192:195], v[182:185]
    ds_read_b64_tr_b16 a[180:181], v70 offset:32768
    buffer_load_dwordx4 v62, s[24:27], s64 offen offset:3072 lds
    v_mfma_f32_16x16x32_bf16 v[190:193], a[152:155], a[196:199], v[190:193]
    ds_read_b64_tr_b16 a[182:183], v70 offset:33024
    s_add_u32 m0, s58, 16384
    v_mfma_f32_16x16x32_bf16 v[186:189], a[156:159], a[192:195], v[186:189]
    ds_read_b128 a[128:131], v4 offset:32768
    v_xor_b32 v59, 128, v59
    v_mfma_f32_16x16x32_bf16 v[194:197], a[156:159], a[196:199], v[194:197]
    ds_read_b64_tr_b16 a[184:185], v70 offset:33792
    v_mfma_f32_16x16x32_bf16 v[206:209], a[160:163], a[192:195], v[206:209]
    ds_read_b64_tr_b16 a[186:187], v70 offset:34048
    buffer_load_dwordx4 v59, s[24:27], s64 offen lds
    v_mfma_f32_16x16x32_bf16 v[214:217], a[160:163], a[196:199], v[214:217]
    ds_read_b128 a[132:135], v4 offset:33792
    v_xor_b32 v60, 128, v60
    v_mfma_f32_16x16x32_bf16 v[198:201], a[160:163], a[188:191], v[198:201]
    ds_read_b128 a[136:139], v4 offset:34816
    buffer_load_dwordx4 v60, s[24:27], s64 offen offset:1024 lds
    v_mfma_f32_16x16x32_bf16 v[210:213], a[164:167], a[192:195], v[210:213]
    ds_read_b64_tr_b16 a[176:177], v71 offset:32768
    v_xor_b32 v61, 128, v61
    v_mfma_f32_16x16x32_bf16 v[218:221], a[164:167], a[196:199], v[218:221]
    ds_read_b64_tr_b16 a[178:179], v71 offset:33024
    v_mfma_f32_16x16x32_bf16 v[202:205], a[164:167], a[188:191], v[202:205]
    ds_read_b128 a[140:143], v4 offset:35840
    buffer_load_dwordx4 v61, s[24:27], s64 offen offset:2048 lds
    v_mfma_f32_16x16x32_bf16 v[230:233], a[192:195], a[168:171], v[230:233]
    ds_read_b128 a[144:147], v4 offset:36864
    v_xor_b32 v62, 128, v62
    v_mfma_f32_16x16x32_bf16 v[238:241], a[196:199], a[168:171], v[238:241]
    ds_read_b128 a[148:151], v4 offset:37888
    v_mfma_f32_16x16x32_bf16 v[222:225], a[188:191], a[168:171], v[222:225]
    buffer_load_dwordx4 v62, s[24:27], s64 offen offset:3072 lds
    s_add_u32 m0, s58, 65536
    v_mfma_f32_16x16x32_bf16 v[234:237], a[192:195], a[172:175], v[234:237]
    s_add_u32 s64, s64, 524288
    s_cmp_eq_u32 s64, 3670016
    v_mfma_f32_16x16x32_bf16 v[242:245], a[196:199], a[172:175], v[242:245]
    s_cselect_b32 s64, 0, s64
    v_mfma_f32_16x16x32_bf16 v[226:229], a[188:191], a[172:175], v[226:229]
    s_waitcnt lgkmcnt(6)
    v_mfma_f32_16x16x32_bf16 v[182:185], a[128:131], a[180:183], v[182:185]
    ds_read_b64_tr_b16 a[192:193], v70 offset:34816
    ds_read_b64_tr_b16 a[194:195], v70 offset:35072
    v_mfma_f32_16x16x32_bf16 v[190:193], a[128:131], a[184:187], v[190:193]
    ds_read_b128 a[152:155], v4 offset:38912
    ds_read_b64_tr_b16 a[196:197], v70 offset:35840
    v_mfma_f32_16x16x32_bf16 v[186:189], a[132:135], a[180:183], v[186:189]
    ds_read_b64_tr_b16 a[198:199], v70 offset:36096
    ds_read_b128 a[156:159], v4 offset:39936
    v_mfma_f32_16x16x32_bf16 v[194:197], a[132:135], a[184:187], v[194:197]
    ds_read_b128 a[160:163], v4 offset:40960
    ds_read_b64_tr_b16 a[188:189], v71 offset:34816
    s_waitcnt lgkmcnt(8)
    v_mfma_f32_16x16x32_bf16 v[206:209], a[136:139], a[180:183], v[206:209]
    ds_read_b64_tr_b16 a[190:191], v71 offset:35072
    buffer_load_dwordx4 v59, s[24:27], s64 offen lds
    v_mfma_f32_16x16x32_bf16 v[214:217], a[136:139], a[184:187], v[214:217]
    ds_read_b128 a[164:167], v4 offset:41984
    v_mfma_f32_16x16x32_bf16 v[198:201], a[136:139], a[176:179], v[198:201]
    ds_read_b128 a[168:171], v4 offset:43008
    buffer_load_dwordx4 v60, s[24:27], s64 offen offset:1024 lds
    v_mfma_f32_16x16x32_bf16 v[210:213], a[140:143], a[180:183], v[210:213]
    ds_read_b128 a[172:175], v4 offset:44032
    v_mfma_f32_16x16x32_bf16 v[218:221], a[140:143], a[184:187], v[218:221]
    v_mfma_f32_16x16x32_bf16 v[202:205], a[140:143], a[176:179], v[202:205]
    buffer_load_dwordx4 v61, s[24:27], s64 offen offset:2048 lds
    v_mfma_f32_16x16x32_bf16 v[230:233], a[180:183], a[144:147], v[230:233]
    v_mfma_f32_16x16x32_bf16 v[238:241], a[184:187], a[144:147], v[238:241]
    v_mfma_f32_16x16x32_bf16 v[222:225], a[176:179], a[144:147], v[222:225]
    buffer_load_dwordx4 v62, s[24:27], s64 offen offset:3072 lds
    s_add_u32 m0, s58, 81920
    v_mfma_f32_16x16x32_bf16 v[234:237], a[180:183], a[148:151], v[234:237]
    s_add_u32 s64, s64, 524288
    s_cmp_eq_u32 s64, 3670016
    v_mfma_f32_16x16x32_bf16 v[242:245], a[184:187], a[148:151], v[242:245]
    s_cselect_b32 s64, 0, s64
    v_mfma_f32_16x16x32_bf16 v[226:229], a[176:179], a[148:151], v[226:229]
    ds_read_b32 v24, v4
    s_waitcnt vmcnt(20) lgkmcnt(1)
    s_barrier
    v_mfma_f32_16x16x32_bf16 v[182:185], a[152:155], a[192:195], v[182:185]
    ds_read_b64_tr_b16 a[180:181], v72 offset:32768
    buffer_load_dwordx4 v59, s[24:27], s64 offen lds
    v_mfma_f32_16x16x32_bf16 v[190:193], a[152:155], a[196:199], v[190:193]
    ds_read_b64_tr_b16 a[182:183], v72 offset:33024
    v_mfma_f32_16x16x32_bf16 v[186:189], a[156:159], a[192:195], v[186:189]
    ds_read_b128 a[128:131], v53 offset:32768
    v_mfma_f32_16x16x32_bf16 v[194:197], a[156:159], a[196:199], v[194:197]
    ds_read_b64_tr_b16 a[184:185], v72 offset:33792
    v_mfma_f32_16x16x32_bf16 v[206:209], a[160:163], a[192:195], v[206:209]
    ds_read_b64_tr_b16 a[186:187], v72 offset:34048
    buffer_load_dwordx4 v60, s[24:27], s64 offen offset:1024 lds
    v_mfma_f32_16x16x32_bf16 v[214:217], a[160:163], a[196:199], v[214:217]
    ds_read_b128 a[132:135], v53 offset:33792
    v_mfma_f32_16x16x32_bf16 v[198:201], a[160:163], a[188:191], v[198:201]
    ds_read_b128 a[136:139], v53 offset:34816
    buffer_load_dwordx4 v61, s[24:27], s64 offen offset:2048 lds
    v_mfma_f32_16x16x32_bf16 v[210:213], a[164:167], a[192:195], v[210:213]
    ds_read_b64_tr_b16 a[176:177], v73 offset:32768
    v_mfma_f32_16x16x32_bf16 v[218:221], a[164:167], a[196:199], v[218:221]
    ds_read_b64_tr_b16 a[178:179], v73 offset:33024
    v_mfma_f32_16x16x32_bf16 v[202:205], a[164:167], a[188:191], v[202:205]
    ds_read_b128 a[140:143], v53 offset:35840
    buffer_load_dwordx4 v62, s[24:27], s64 offen offset:3072 lds
    v_mfma_f32_16x16x32_bf16 v[230:233], a[192:195], a[168:171], v[230:233]
    ds_read_b128 a[144:147], v53 offset:36864
    s_add_u32 m0, s58, 32768
    v_mfma_f32_16x16x32_bf16 v[238:241], a[196:199], a[168:171], v[238:241]
    ds_read_b128 a[148:151], v53 offset:37888
    s_add_u32 s64, s64, 524288
    v_mfma_f32_16x16x32_bf16 v[222:225], a[188:191], a[168:171], v[222:225]
    s_cmp_eq_u32 s64, 3670016
    s_cselect_b32 s64, 0, s64
    v_mfma_f32_16x16x32_bf16 v[234:237], a[192:195], a[172:175], v[234:237]
    buffer_load_dwordx4 v59, s[24:27], s64 offen lds
    v_mfma_f32_16x16x32_bf16 v[242:245], a[196:199], a[172:175], v[242:245]
    v_mfma_f32_16x16x32_bf16 v[226:229], a[188:191], a[172:175], v[226:229]
    s_load_dword s14, s[28:29], s38
    s_waitcnt lgkmcnt(6)
    v_mfma_f32_16x16x32_bf16 v[182:185], a[128:131], a[180:183], v[182:185]
    ds_read_b64_tr_b16 a[192:193], v72 offset:34816
    ds_read_b64_tr_b16 a[194:195], v72 offset:35072
    v_mfma_f32_16x16x32_bf16 v[190:193], a[128:131], a[184:187], v[190:193]
    ds_read_b128 a[152:155], v53 offset:38912
    ds_read_b64_tr_b16 a[196:197], v72 offset:35840
    v_mfma_f32_16x16x32_bf16 v[186:189], a[132:135], a[180:183], v[186:189]
    ds_read_b64_tr_b16 a[198:199], v72 offset:36096
    ds_read_b128 a[156:159], v53 offset:39936
    v_mfma_f32_16x16x32_bf16 v[194:197], a[132:135], a[184:187], v[194:197]
    ds_read_b128 a[160:163], v53 offset:40960
    ds_read_b64_tr_b16 a[188:189], v73 offset:34816
    s_waitcnt lgkmcnt(8)
    v_mfma_f32_16x16x32_bf16 v[206:209], a[136:139], a[180:183], v[206:209]
    ds_read_b64_tr_b16 a[190:191], v73 offset:35072
    buffer_load_dwordx4 v60, s[24:27], s64 offen offset:1024 lds
    v_mfma_f32_16x16x32_bf16 v[214:217], a[136:139], a[184:187], v[214:217]
    ds_read_b128 a[164:167], v53 offset:41984
    v_mfma_f32_16x16x32_bf16 v[198:201], a[136:139], a[176:179], v[198:201]
    ds_read_b128 a[168:171], v53 offset:43008
    buffer_load_dwordx4 v61, s[24:27], s64 offen offset:2048 lds
    v_mfma_f32_16x16x32_bf16 v[210:213], a[140:143], a[180:183], v[210:213]
    ds_read_b128 a[172:175], v53 offset:44032
    v_mfma_f32_16x16x32_bf16 v[218:221], a[140:143], a[184:187], v[218:221]
    v_mfma_f32_16x16x32_bf16 v[202:205], a[140:143], a[176:179], v[202:205]
    buffer_load_dwordx4 v62, s[24:27], s64 offen offset:3072 lds
    s_add_u32 m0, s58, 49152
    v_mfma_f32_16x16x32_bf16 v[230:233], a[180:183], a[144:147], v[230:233]
    s_add_u32 s64, s64, 524288
    s_cmp_eq_u32 s64, 3670016
    v_mfma_f32_16x16x32_bf16 v[238:241], a[184:187], a[144:147], v[238:241]
    s_cselect_b32 s64, 0, s64
    v_mfma_f32_16x16x32_bf16 v[222:225], a[176:179], a[144:147], v[222:225]
    buffer_load_dwordx4 v59, s[24:27], s64 offen lds
    v_mfma_f32_16x16x32_bf16 v[234:237], a[180:183], a[148:151], v[234:237]
    v_mfma_f32_16x16x32_bf16 v[242:245], a[184:187], a[148:151], v[242:245]
    v_mfma_f32_16x16x32_bf16 v[226:229], a[176:179], a[148:151], v[226:229]
    ds_read_b32 v24, v4
    s_waitcnt vmcnt(21) lgkmcnt(1)
    s_barrier
    v_mfma_f32_16x16x32_bf16 v[182:185], a[152:155], a[192:195], v[182:185]
    ds_read_b64_tr_b16 a[180:181], v74 offset:0
    buffer_load_dwordx4 v60, s[24:27], s64 offen offset:1024 lds
    v_mfma_f32_16x16x32_bf16 v[190:193], a[152:155], a[196:199], v[190:193]
    ds_read_b64_tr_b16 a[182:183], v74 offset:256
    v_mfma_f32_16x16x32_bf16 v[186:189], a[156:159], a[192:195], v[186:189]
    ds_read_b128 a[128:131], v54 offset:0
    v_mfma_f32_16x16x32_bf16 v[194:197], a[156:159], a[196:199], v[194:197]
    ds_read_b64_tr_b16 a[184:185], v74 offset:1024
    v_mfma_f32_16x16x32_bf16 v[206:209], a[160:163], a[192:195], v[206:209]
    ds_read_b64_tr_b16 a[186:187], v74 offset:1280
    buffer_load_dwordx4 v61, s[24:27], s64 offen offset:2048 lds
    v_mfma_f32_16x16x32_bf16 v[214:217], a[160:163], a[196:199], v[214:217]
    ds_read_b128 a[132:135], v54 offset:1024
    v_mfma_f32_16x16x32_bf16 v[198:201], a[160:163], a[188:191], v[198:201]
    ds_read_b128 a[136:139], v54 offset:2048
    buffer_load_dwordx4 v62, s[24:27], s64 offen offset:3072 lds
    v_mfma_f32_16x16x32_bf16 v[210:213], a[164:167], a[192:195], v[210:213]
    ds_read_b64_tr_b16 a[176:177], v75 offset:0
    s_add_u32 m0, s58, 98304
    v_mfma_f32_16x16x32_bf16 v[218:221], a[164:167], a[196:199], v[218:221]
    ds_read_b64_tr_b16 a[178:179], v75 offset:256
    s_add_u32 s64, s64, 524288
    v_mfma_f32_16x16x32_bf16 v[202:205], a[164:167], a[188:191], v[202:205]
    ds_read_b128 a[140:143], v54 offset:3072
    s_cmp_eq_u32 s64, 3670016
    v_mfma_f32_16x16x32_bf16 v[230:233], a[192:195], a[168:171], v[230:233]
    ds_read_b128 a[144:147], v54 offset:4096
    s_cselect_b32 s64, 0, s64
    v_mfma_f32_16x16x32_bf16 v[238:241], a[196:199], a[168:171], v[238:241]
    ds_read_b128 a[148:151], v54 offset:5120
    buffer_load_dwordx4 v59, s[24:27], s64 offen lds
    v_mfma_f32_16x16x32_bf16 v[222:225], a[188:191], a[168:171], v[222:225]
    v_mfma_f32_16x16x32_bf16 v[234:237], a[192:195], a[172:175], v[234:237]
    buffer_load_dwordx4 v60, s[24:27], s64 offen offset:1024 lds
    v_mfma_f32_16x16x32_bf16 v[242:245], a[196:199], a[172:175], v[242:245]
    v_mfma_f32_16x16x32_bf16 v[226:229], a[188:191], a[172:175], v[226:229]
    s_waitcnt lgkmcnt(6)
    v_mfma_f32_16x16x32_bf16 v[182:185], a[128:131], a[180:183], v[182:185]
    ds_read_b64_tr_b16 a[192:193], v74 offset:2048
    ds_read_b64_tr_b16 a[194:195], v74 offset:2304
    v_mfma_f32_16x16x32_bf16 v[190:193], a[128:131], a[184:187], v[190:193]
    ds_read_b128 a[152:155], v54 offset:6144
    ds_read_b64_tr_b16 a[196:197], v74 offset:3072
    v_mfma_f32_16x16x32_bf16 v[186:189], a[132:135], a[180:183], v[186:189]
    ds_read_b64_tr_b16 a[198:199], v74 offset:3328
    ds_read_b128 a[156:159], v54 offset:7168
    v_mfma_f32_16x16x32_bf16 v[194:197], a[132:135], a[184:187], v[194:197]
    ds_read_b128 a[160:163], v54 offset:8192
    ds_read_b64_tr_b16 a[188:189], v75 offset:2048
    s_waitcnt lgkmcnt(8)
    v_mfma_f32_16x16x32_bf16 v[206:209], a[136:139], a[180:183], v[206:209]
    ds_read_b64_tr_b16 a[190:191], v75 offset:2304
    buffer_load_dwordx4 v61, s[24:27], s64 offen offset:2048 lds
    v_mfma_f32_16x16x32_bf16 v[214:217], a[136:139], a[184:187], v[214:217]
    ds_read_b128 a[164:167], v54 offset:9216
    v_mfma_f32_16x16x32_bf16 v[198:201], a[136:139], a[176:179], v[198:201]
    ds_read_b128 a[168:171], v54 offset:10240
    buffer_load_dwordx4 v62, s[24:27], s64 offen offset:3072 lds
    v_mfma_f32_16x16x32_bf16 v[210:213], a[140:143], a[180:183], v[210:213]
    ds_read_b128 a[172:175], v54 offset:11264
    s_add_u32 m0, s58, 114688
    v_mfma_f32_16x16x32_bf16 v[218:221], a[140:143], a[184:187], v[218:221]
    s_add_u32 s64, s64, 524288
    s_cmp_eq_u32 s64, 3670016
    v_mfma_f32_16x16x32_bf16 v[202:205], a[140:143], a[176:179], v[202:205]
    s_cselect_b32 s64, 0, s64
    buffer_load_dwordx4 v59, s[24:27], s64 offen lds
    v_mfma_f32_16x16x32_bf16 v[230:233], a[180:183], a[144:147], v[230:233]
    v_mfma_f32_16x16x32_bf16 v[238:241], a[184:187], a[144:147], v[238:241]
    v_mfma_f32_16x16x32_bf16 v[222:225], a[176:179], a[144:147], v[222:225]
    buffer_load_dwordx4 v60, s[24:27], s64 offen offset:1024 lds
    v_mfma_f32_16x16x32_bf16 v[234:237], a[180:183], a[148:151], v[234:237]
    v_mfma_f32_16x16x32_bf16 v[242:245], a[184:187], a[148:151], v[242:245]
    v_mfma_f32_16x16x32_bf16 v[226:229], a[176:179], a[148:151], v[226:229]
    s_waitcnt lgkmcnt(0)
    s_cmp_eq_u32 s56, 0
    s_cbranch_scc1 L_pollok5
    s_cmp_ge_u32 s14, 7
    s_cbranch_scc1 L_pollok5
    s_mov_b32 s60, 0
L_poll5:
    s_sleep 8
    buffer_load_dword v18, off, s[28:31], s38 sc1
    s_add_u32 s60, s60, 1
    s_waitcnt vmcnt(0)
    v_readfirstlane_b32 s14, v18
    s_nop 0
    s_cmp_ge_u32 s14, 7
    s_cbranch_scc1 L_pollok5
    s_cmp_lt_u32 s60, 20000
    s_cbranch_scc1 L_poll5
L_pollok5:
    s_waitcnt vmcnt(14)
    s_barrier
    v_mfma_f32_16x16x32_bf16 v[182:185], a[152:155], a[192:195], v[182:185]
    ds_read_b64_tr_b16 a[200:201], v31 offset:16384
    buffer_load_dwordx4 a[0:3], v79, s[28:31], s65 offen offset:0 sc1
    v_mfma_f32_16x16x32_bf16 v[190:193], a[152:155], a[196:199], v[190:193]
    ds_read_b64_tr_b16 a[202:203], v31 offset:18432
    v_mfma_f32_16x16x32_bf16 v[186:189], a[156:159], a[192:195], v[186:189]
    ds_read_b64_tr_b16 a[204:205], v33 offset:16384
    buffer_load_dwordx4 a[4:7], v79, s[28:31], s65 offen offset:1024 sc1
    v_mfma_f32_16x16x32_bf16 v[194:197], a[156:159], a[196:199], v[194:197]
    ds_read_b64_tr_b16 a[206:207], v33 offset:18432
    v_mfma_f32_16x16x32_bf16 v[206:209], a[160:163], a[192:195], v[206:209]
    ds_read_b64_tr_b16 a[208:209], v32 offset:16384
    v_mfma_f32_16x16x32_bf16 v[214:217], a[160:163], a[196:199], v[214:217]
    ds_read_b64_tr_b16 a[210:211], v32 offset:18432
    v_mfma_f32_16x16x32_bf16 v[198:201], a[160:163], a[188:191], v[198:201]
    ds_read_b64_tr_b16 a[212:213], v34 offset:16384
    buffer_load_dwordx4 a[8:11], v79, s[28:31], s65 offen offset:2048 sc1
    v_mfma_f32_16x16x32_bf16 v[210:213], a[164:167], a[192:195], v[210:213]
    ds_read_b64_tr_b16 a[214:215], v34 offset:18432
    v_mfma_f32_16x16x32_bf16 v[218:221], a[164:167], a[196:199], v[218:221]
    ds_read_b64_tr_b16 a[216:217], v31 offset:20480
    v_mfma_f32_16x16x32_bf16 v[202:205], a[164:167], a[188:191], v[202:205]
    ds_read_b64_tr_b16 a[218:219], v31 offset:22528
    buffer_load_dwordx4 a[12:15], v79, s[28:31], s65 offen offset:3072 sc1
    v_mfma_f32_16x16x32_bf16 v[230:233], a[192:195], a[168:171], v[230:233]
    ds_read_b64_tr_b16 a[220:221], v33 offset:20480
    s_add_u32 s65, s65, 8192
    v_mfma_f32_16x16x32_bf16 v[238:241], a[196:199], a[168:171], v[238:241]
    ds_read_b64_tr_b16 a[222:223], v33 offset:22528
    s_cmp_eq_u32 s65, 57344
    v_mfma_f32_16x16x32_bf16 v[222:225], a[188:191], a[168:171], v[222:225]
    s_cselect_b32 s65, 0, s65
    v_mfma_f32_16x16x32_bf16 v[234:237], a[192:195], a[172:175], v[234:237]
    buffer_load_dwordx4 a[16:19], v79, s[28:31], s65 offen offset:0 sc1
    v_mfma_f32_16x16x32_bf16 v[242:245], a[196:199], a[172:175], v[242:245]
    v_mfma_f32_16x16x32_bf16 v[226:229], a[188:191], a[172:175], v[226:229]
    v_cvt_pk_bf16_f32 v118, v182, v183
    v_cvt_pk_bf16_f32 v119, v184, v185
    v_cvt_pk_bf16_f32 v120, v186, v187
    buffer_load_dwordx4 a[20:23], v79, s[28:31], s65 offen offset:1024 sc1
    v_cvt_pk_bf16_f32 v121, v188, v189
    v_cvt_pk_bf16_f32 v122, v190, v191
    v_cvt_pk_bf16_f32 v123, v192, v193
    v_cvt_pk_bf16_f32 v124, v194, v195
    v_cvt_pk_bf16_f32 v125, v196, v197
    v_cvt_pk_bf16_f32 v130, v206, v207
    v_cvt_pk_bf16_f32 v131, v208, v209
    v_cvt_pk_bf16_f32 v132, v210, v211
    v_cvt_pk_bf16_f32 v133, v212, v213
    v_cvt_pk_bf16_f32 v134, v214, v215
    v_cvt_pk_bf16_f32 v135, v216, v217
    v_cvt_pk_bf16_f32 v136, v218, v219
    v_cvt_pk_bf16_f32 v137, v220, v221
    v_cvt_pk_bf16_f32 v126, v198, v199
    buffer_load_dwordx4 a[24:27], v79, s[28:31], s65 offen offset:2048 sc1
    v_cvt_pk_bf16_f32 v127, v200, v201
    v_cvt_pk_bf16_f32 v128, v202, v203
    v_cvt_pk_bf16_f32 v129, v204, v205
    v_mfma_f32_16x16x32_bf16 v[154:157], v[130:133], v[118:121], 0
    v_mfma_f32_16x16x32_bf16 v[158:161], v[130:133], v[122:125], 0
    v_mfma_f32_16x16x32_bf16 v[162:165], v[134:137], v[122:125], 0
    buffer_load_dwordx4 a[28:31], v79, s[28:31], s65 offen offset:3072 sc1
    v_mfma_f32_16x16x32_bf16 v[150:153], v[126:129], v[118:121], 0
    v_cvt_pk_bf16_f32 v166, v222, v223
    v_cvt_pk_bf16_f32 v167, v224, v225
    v_cvt_pk_bf16_f32 v168, v230, v231
    v_cvt_pk_bf16_f32 v169, v232, v233
    v_cvt_pk_bf16_f32 v170, v238, v239
    v_cvt_pk_bf16_f32 v171, v240, v241
    v_cndmask_b32 v250, v158, v159, s[70:71]
    v_cndmask_b32 v253, v162, v163, s[70:71]
    v_cndmask_b32 v250, v250, v253, s[72:73]
    s_add_u32 s65, s65, 8192
    s_cmp_eq_u32 s65, 57344
    s_cselect_b32 s65, 0, s65
    buffer_load_dwordx4 a[32:35], v79, s[28:31], s65 offen offset:0 sc1
    v_mul_f32 v250, v250, v29
    v_cndmask_b32 v251, v160, v161, s[70:71]
    v_cndmask_b32 v253, v164, v165, s[70:71]
    v_cndmask_b32 v251, v251, v253, s[74:75]
    v_mul_f32 v251, v251, v30
    v_cndmask_b32 v246, v150, v151, s[70:71]
    v_cndmask_b32 v246, v84, v246, s[76:77]
    v_cndmask_b32 v249, v154, v155, s[70:71]
    v_cndmask_b32 v246, v246, v249, s[72:73]
    v_mul_f32 v246, v246, v27
    v_cndmask_b32 v247, v152, v153, s[70:71]
    v_cndmask_b32 v247, v84, v247, s[76:77]
    v_cndmask_b32 v249, v156, v157, s[70:71]
    v_cndmask_b32 v247, v247, v249, s[74:75]
    buffer_load_dwordx4 a[36:39], v79, s[28:31], s65 offen offset:1024 sc1
    v_mul_f32 v247, v247, v28
    v_max_f32 v248, v246, v247
    v_max_f32 v252, v250, v251
    v_mov_b32 v249, v248
    v_mov_b32 v253, v252
    v_cvt_pk_bf16_f32 v172, v226, v227
    v_permlane16_swap_b32 v248, v249
    v_permlane16_swap_b32 v252, v253
    v_max_f32 v248, v248, v249
    v_max_f32 v252, v252, v253
    v_mov_b32 v249, v248
    v_mov_b32 v253, v252
    v_cvt_pk_bf16_f32 v173, v228, v229
    v_permlane32_swap_b32 v248, v249
    buffer_load_dwordx4 a[40:43], v79, s[28:31], s65 offen offset:2048 sc1
    v_permlane32_swap_b32 v252, v253
    v_max_f32 v248, v248, v249
    v_max_f32 v252, v252, v253
    v_mul_f32 v248, v25, v248
    v_mul_f32 v252, v26, v252
    v_fma_f32 v246, v246, v25, -v248
    v_fma_f32 v247, v247, v25, -v248
    v_fma_f32 v250, v250, v26, -v252
    v_fma_f32 v251, v251, v26, -v252
    v_exp_f32 v246, v246
    v_exp_f32 v247, v247
    v_exp_f32 v250, v250
    buffer_load_dwordx4 a[44:47], v79, s[28:31], s65 offen offset:3072 sc1
    v_exp_f32 v251, v251
    v_add_f32 v248, v246, v247
    v_add_f32 v252, v250, v251
    v_mov_b32 v249, v248
    v_mov_b32 v253, v252
    v_cvt_pk_bf16_f32 v174, v234, v235
    v_permlane16_swap_b32 v248, v249
    v_permlane16_swap_b32 v252, v253
    v_add_f32 v248, v248, v249
    v_add_f32 v252, v252, v253
    v_mov_b32 v249, v248
    v_mov_b32 v253, v252
    buffer_load_dwordx4 v61, s[24:27], s64 offen offset:2048 lds
    v_cvt_pk_bf16_f32 v175, v236, v237
    v_permlane32_swap_b32 v248, v249
    v_permlane32_swap_b32 v252, v253
    v_add_f32 v248, v248, v249
    v_add_f32 v252, v252, v253
    v_rcp_f32 v248, v248
    v_rcp_f32 v252, v252
    v_cvt_pk_bf16_f32 v176, v242, v243
    v_cvt_pk_bf16_f32 v177, v244, v245
    v_mul_f32 v246, v246, v27
    v_mul_f32 v247, v247, v28
    buffer_load_dwordx4 v62, s[24:27], s64 offen offset:3072 lds
    v_mul_f32 v250, v250, v29
    v_mul_f32 v251, v251, v30
    v_mul_f32 v246, v246, v248
    v_mul_f32 v247, v247, v248
    v_mul_f32 v250, v250, v252
    v_mul_f32 v251, v251, v252
    v_cvt_pk_bf16_f32 v246, v246, v246
    v_cvt_pk_bf16_f32 v247, v247, v247
    v_cvt_pk_bf16_f32 v250, v250, v250
    v_cvt_pk_bf16_f32 v251, v251, v251
    v_and_b32 v138, v246, v104
    v_and_b32 v139, v247, v105
    v_and_b32 v140, v246, v106
    s_add_u32 m0, s58, 131072
    s_add_u32 s64, s64, 524288
    s_cmp_eq_u32 s64, 3670016
    s_cselect_b32 s64, 0, s64
    s_add_u32 s64, s64, 524288
    s_cmp_eq_u32 s64, 3670016
    s_cselect_b32 s64, 0, s64
    v_xor_b32 v59, 128, v59
    buffer_load_dwordx4 v59, s[24:27], s64 offen lds
    v_and_b32 v141, v247, v107
    v_and_b32 v142, v250, v104
    v_and_b32 v143, v251, v105
    v_and_b32 v144, v250, v106
    v_and_b32 v145, v251, v107
    v_mfma_f32_16x16x32_bf16 v[182:185], v[166:169], v[138:141], 0
    v_mfma_f32_16x16x32_bf16 v[186:189], v[172:175], v[138:141], 0
    v_xor_b32 v60, 128, v60
    buffer_load_dwordx4 v60, s[24:27], s64 offen offset:1024 lds
    v_mfma_f32_16x16x32_bf16 v[190:193], v[168:171], v[142:145], 0
    v_mfma_f32_16x16x32_bf16 v[194:197], v[174:177], v[142:145], 0
    s_add_u32 s83, s82, 16384
    s_nop 1
    v_cvt_pk_bf16_f32 v110, v182, v183
    v_cvt_pk_bf16_f32 v111, v184, v185
    v_cvt_pk_bf16_f32 v112, v186, v187
    v_cvt_pk_bf16_f32 v113, v188, v189
    v_xor_b32 v61, 128, v61
    buffer_load_dwordx4 v61, s[24:27], s64 offen offset:2048 lds
    v_cvt_pk_bf16_f32 v114, v190, v191
    v_cvt_pk_bf16_f32 v115, v192, v193
    v_cvt_pk_bf16_f32 v116, v194, v195
    v_cvt_pk_bf16_f32 v117, v196, v197
    buffer_store_dwordx4 v[110:113], v4, s[28:31], s82 offen sc1
    buffer_store_dwordx4 v[114:117], v4, s[28:31], s83 offen sc1
    s_cmp_lg_u32 s56, 0
    s_cbranch_scc1 L_f
    s_waitcnt vmcnt(0)
    s_barrier
    s_cmp_lg_u32 s48, 0
    s_cbranch_scc1 L_sig3
    s_atomic_add s36, s[28:29], s69
L_sig3:
    v_lshlrev_b32 v14, 7, v1
    s_lshl_b32 s3, s54, 2
    s_add_u32 s3, s3, s48
    s_mul_i32 s3, s3, 25088
    buffer_load_dword v182, v14, s[16:19], s3 offen
    s_add_u32 s3, s3, 5632
    buffer_load_dword v183, v14, s[16:19], s3 offen
    s_add_u32 s3, s3, 5632
    buffer_load_dword v184, v14, s[16:19], s3 offen
    s_add_u32 s3, s3, 5632
    buffer_load_dword v185, v14, s[16:19], s3 offen
    s_add_u32 s3, s3, 5632
    s_branch L_fin
L_f:
    s_waitcnt vmcnt(17) lgkmcnt(8)
    v_mfma_f32_16x16x32_bf16 v[182:185], a[0:3], a[200:203], 0
    ds_read_b64_tr_b16 a[224:225], v32 offset:20480
    v_xor_b32 v62, 128, v62
    buffer_load_dwordx4 v62, s[24:27], s64 offen offset:3072 lds
    v_mfma_f32_16x16x32_bf16 v[186:189], a[4:7], a[200:203], 0
    ds_read_b64_tr_b16 a[226:227], v32 offset:22528
    s_add_u32 m0, s58, 147456
    v_lshlrev_b32 v93, 16, v93
    v_mfma_f32_16x16x32_bf16 v[238:241], a[0:3], a[204:207], 0
    ds_read_b64_tr_b16 a[228:229], v34 offset:20480
    s_add_u32 s64, s64, 524288
    v_mfma_f32_16x16x32_bf16 v[242:245], a[4:7], a[204:207], 0
    ds_read_b64_tr_b16 a[230:231], v34 offset:22528
    s_cmp_eq_u32 s64, 3670016
    s_cselect_b32 s64, 0, s64
    buffer_load_dwordx4 v59, s[24:27], s64 offen lds
    s_waitcnt lgkmcnt(8)
    v_mfma_f32_16x16x32_bf16 v[190:193], a[0:3], a[208:211], 0
    ds_read_b64_tr_b16 a[200:201], v35 offset:0
    v_lshlrev_b32 v222, 16, v96
    v_mfma_f32_16x16x32_bf16 v[194:197], a[4:7], a[208:211], 0
    ds_read_b64_tr_b16 a[202:203], v35 offset:2048
    buffer_load_dwordx4 v60, s[24:27], s64 offen offset:1024 lds
    v_and_b32 v223, 0xffff0000, v96
    v_mfma_f32_16x16x32_bf16 v[246:249], a[0:3], a[212:215], 0
    ds_read_b64_tr_b16 a[204:205], v37 offset:0
    v_add_f32 v222, v222, v93
    v_mfma_f32_16x16x32_bf16 v[250:253], a[4:7], a[212:215], 0
    ds_read_b64_tr_b16 a[206:207], v37 offset:2048
    s_waitcnt vmcnt(18) lgkmcnt(8)
    v_mfma_f32_16x16x32_bf16 v[182:185], a[8:11], a[216:219], v[182:185]
    ds_read_b64_tr_b16 a[208:209], v36 offset:0
    buffer_load_dwordx4 v61, s[24:27], s64 offen offset:2048 lds
    v_mfma_f32_16x16x32_bf16 v[186:189], a[12:15], a[216:219], v[186:189]
    ds_read_b64_tr_b16 a[210:211], v36 offset:2048
    v_add_f32 v223, v223, v93
    v_mfma_f32_16x16x32_bf16 v[238:241], a[8:11], a[220:223], v[238:241]
    ds_read_b64_tr_b16 a[212:213], v38 offset:0
    buffer_load_dwordx4 v62, s[24:27], s64 offen offset:3072 lds
    v_mfma_f32_16x16x32_bf16 v[242:245], a[12:15], a[220:223], v[242:245]
    ds_read_b64_tr_b16 a[214:215], v38 offset:2048
    s_waitcnt lgkmcnt(8)
    v_mfma_f32_16x16x32_bf16 v[190:193], a[8:11], a[224:227], v[190:193]
    ds_read_b64_tr_b16 a[216:217], v35 offset:4096
    s_add_u32 s65, s65, 8192
    v_mfma_f32_16x16x32_bf16 v[194:197], a[12:15], a[224:227], v[194:197]
    ds_read_b64_tr_b16 a[218:219], v35 offset:6144
    s_cmp_eq_u32 s65, 57344
    v_lshlrev_b32 v224, 16, v97
    v_mfma_f32_16x16x32_bf16 v[246:249], a[8:11], a[228:231], v[246:249]
    ds_read_b64_tr_b16 a[220:221], v37 offset:4096
    s_cselect_b32 s65, 0, s65
    v_mfma_f32_16x16x32_bf16 v[250:253], a[12:15], a[228:231], v[250:253]
    ds_read_b64_tr_b16 a[222:223], v37 offset:6144
    buffer_load_dwordx4 a[48:51], v79, s[28:31], s65 offen offset:0 sc1
    s_waitcnt vmcnt(19) lgkmcnt(8)
    v_mfma_f32_16x16x32_bf16 v[182:185], a[16:19], a[200:203], v[182:185]
    ds_read_b64_tr_b16 a[224:225], v36 offset:4096
    v_and_b32 v225, 0xffff0000, v97
    v_mfma_f32_16x16x32_bf16 v[186:189], a[20:23], a[200:203], v[186:189]
    ds_read_b64_tr_b16 a[226:227], v36 offset:6144
    buffer_load_dwordx4 a[52:55], v79, s[28:31], s65 offen offset:1024 sc1
    v_add_f32 v224, v224, v93
    v_mfma_f32_16x16x32_bf16 v[238:241], a[16:19], a[204:207], v[238:241]
    ds_read_b64_tr_b16 a[228:229], v38 offset:4096
    v_add_f32 v225, v225, v93
    v_mfma_f32_16x16x32_bf16 v[242:245], a[20:23], a[204:207], v[242:245]
    ds_read_b64_tr_b16 a[230:231], v38 offset:6144
    s_waitcnt lgkmcnt(8)
    v_mfma_f32_16x16x32_bf16 v[190:193], a[16:19], a[208:211], v[190:193]
    ds_read_b64_tr_b16 a[200:201], v35 offset:16384
    buffer_load_dwordx4 a[56:59], v79, s[28:31], s65 offen offset:2048 sc1
    v_mfma_f32_16x16x32_bf16 v[194:197], a[20:23], a[208:211], v[194:197]
    ds_read_b64_tr_b16 a[202:203], v35 offset:18432
    v_lshlrev_b32 v226, 16, v98
    v_mfma_f32_16x16x32_bf16 v[246:249], a[16:19], a[212:215], v[246:249]
    ds_read_b64_tr_b16 a[204:205], v37 offset:16384
    v_and_b32 v227, 0xffff0000, v98
    v_mfma_f32_16x16x32_bf16 v[250:253], a[20:23], a[212:215], v[250:253]
    ds_read_b64_tr_b16 a[206:207], v37 offset:18432
    s_waitcnt vmcnt(19) lgkmcnt(8)
    v_mfma_f32_16x16x32_bf16 v[182:185], a[24:27], a[216:219], v[182:185]
    ds_read_b64_tr_b16 a[208:209], v36 offset:16384
    buffer_load_dwordx4 a[60:63], v79, s[28:31], s65 offen offset:3072 sc1
    v_mfma_f32_16x16x32_bf16 v[186:189], a[28:31], a[216:219], v[186:189]
    ds_read_b64_tr_b16 a[210:211], v36 offset:18432
    s_add_u32 s65, s65, 8192
    v_add_f32 v226, v226, v93
    v_mfma_f32_16x16x32_bf16 v[238:241], a[24:27], a[220:223], v[238:241]
    ds_read_b64_tr_b16 a[212:213], v38 offset:16384
    s_cmp_eq_u32 s65, 57344
    v_mfma_f32_16x16x32_bf16 v[242:245], a[28:31], a[220:223], v[242:245]
    ds_read_b64_tr_b16 a[214:215], v38 offset:18432
    s_waitcnt lgkmcnt(8)
    v_mfma_f32_16x16x32_bf16 v[190:193], a[24:27], a[224:227], v[190:193]
    ds_read_b64_tr_b16 a[216:217], v35 offset:20480
    s_cselect_b32 s65, 0, s65
    buffer_load_dwordx4 a[64:67], v79, s[28:31], s65 offen offset:0 sc1
    v_mfma_f32_16x16x32_bf16 v[194:197], a[28:31], a[224:227], v[194:197]
    ds_read_b64_tr_b16 a[218:219], v35 offset:22528
    v_add_f32 v227, v227, v93
    v_mfma_f32_16x16x32_bf16 v[246:249], a[24:27], a[228:231], v[246:249]
    ds_read_b64_tr_b16 a[220:221], v37 offset:20480
    buffer_load_dwordx4 a[68:71], v79, s[28:31], s65 offen offset:1024 sc1
    v_mfma_f32_16x16x32_bf16 v[250:253], a[28:31], a[228:231], v[250:253]
    ds_read_b64_tr_b16 a[222:223], v37 offset:22528
    v_lshlrev_b32 v228, 16, v99
    s_waitcnt vmcnt(20) lgkmcnt(8)
    v_mfma_f32_16x16x32_bf16 v[182:185], a[32:35], a[200:203], v[182:185]
    ds_read_b64_tr_b16 a[224:225], v36 offset:20480
    v_and_b32 v229, 0xffff0000, v99
    v_mfma_f32_16x16x32_bf16 v[186:189], a[36:39], a[200:203], v[186:189]
    ds_read_b64_tr_b16 a[226:227], v36 offset:22528
    buffer_load_dwordx4 a[72:75], v79, s[28:31], s65 offen offset:2048 sc1
    v_add_f32 v228, v228, v93
    v_mfma_f32_16x16x32_bf16 v[238:241], a[32:35], a[204:207], v[238:241]
    ds_read_b64_tr_b16 a[228:229], v38 offset:20480
    v_add_f32 v229, v229, v93
    v_mfma_f32_16x16x32_bf16 v[242:245], a[36:39], a[204:207], v[242:245]
    ds_read_b64_tr_b16 a[230:231], v38 offset:22528
    s_waitcnt lgkmcnt(8)
    v_mfma_f32_16x16x32_bf16 v[190:193], a[32:35], a[208:211], v[190:193]
    s_waitcnt vmcnt(12)
    s_barrier
    s_cmp_lg_u32 s48, 0
    s_cbranch_scc1 L_sig4
    s_atomic_add s36, s[28:29], s69
L_sig4:
    ds_read_b64_tr_b16 a[200:201], v31 offset:32768
    buffer_load_dwordx4 a[76:79], v79, s[28:31], s65 offen offset:3072 sc1
    v_mfma_f32_16x16x32_bf16 v[194:197], a[36:39], a[208:211], v[194:197]
    ds_read_b64_tr_b16 a[202:203], v31 offset:34816
    s_add_u32 s65, s65, 8192
    v_lshlrev_b32 v94, 16, v94
    v_mfma_f32_16x16x32_bf16 v[246:249], a[32:35], a[212:215], v[246:249]
    ds_read_b64_tr_b16 a[204:205], v33 offset:32768
    s_cmp_eq_u32 s65, 57344
    v_mfma_f32_16x16x32_bf16 v[250:253], a[36:39], a[212:215], v[250:253]
    ds_read_b64_tr_b16 a[206:207], v33 offset:34816
    s_waitcnt lgkmcnt(8)
    v_mfma_f32_16x16x32_bf16 v[182:185], a[40:43], a[216:219], v[182:185]
    ds_read_b64_tr_b16 a[208:209], v32 offset:32768
    s_cselect_b32 s65, 0, s65
    buffer_load_dwordx4 a[80:83], v79, s[28:31], s65 offen offset:0 sc1
    v_mfma_f32_16x16x32_bf16 v[186:189], a[44:47], a[216:219], v[186:189]
    ds_read_b64_tr_b16 a[210:211], v32 offset:34816
    v_lshlrev_b32 v230, 16, v100
    v_mfma_f32_16x16x32_bf16 v[238:241], a[40:43], a[220:223], v[238:241]
    ds_read_b64_tr_b16 a[212:213], v34 offset:32768
    buffer_load_dwordx4 a[84:87], v79, s[28:31], s65 offen offset:1024 sc1
    v_mfma_f32_16x16x32_bf16 v[242:245], a[44:47], a[220:223], v[242:245]
    ds_read_b64_tr_b16 a[214:215], v34 offset:34816
    v_and_b32 v231, 0xffff0000, v100
    s_waitcnt lgkmcnt(8)
    v_mfma_f32_16x16x32_bf16 v[190:193], a[40:43], a[224:227], v[190:193]
    ds_read_b64_tr_b16 a[216:217], v31 offset:36864
    v_add_f32 v230, v230, v94
    v_mfma_f32_16x16x32_bf16 v[194:197], a[44:47], a[224:227], v[194:197]
    ds_read_b64_tr_b16 a[218:219], v31 offset:38912
    buffer_load_dwordx4 a[88:91], v79, s[28:31], s65 offen offset:2048 sc1
    v_add_f32 v231, v231, v94
    v_mfma_f32_16x16x32_bf16 v[246:249], a[40:43], a[228:231], v[246:249]
    ds_read_b64_tr_b16 a[220:221], v33 offset:36864
    v_lshlrev_b32 v232, 16, v101
    v_mfma_f32_16x16x32_bf16 v[250:253], a[44:47], a[228:231], v[250:253]
    ds_read_b64_tr_b16 a[222:223], v33 offset:38912
    s_waitcnt vmcnt(9) lgkmcnt(8)
    v_mfma_f32_16x16x32_bf16 v[182:185], a[48:51], a[200:203], v[182:185]
    ds_read_b64_tr_b16 a[224:225], v32 offset:36864
    buffer_load_dwordx4 a[92:95], v79, s[28:31], s65 offen offset:3072 sc1
    v_mfma_f32_16x16x32_bf16 v[186:189], a[52:55], a[200:203], v[186:189]
    ds_read_b64_tr_b16 a[226:227], v32 offset:38912
    s_add_u32 s65, s65, 8192
    v_and_b32 v233, 0xffff0000, v101
    v_mfma_f32_16x16x32_bf16 v[238:241], a[48:51], a[204:207], v[238:241]
    ds_read_b64_tr_b16 a[228:229], v34 offset:36864
    s_cmp_eq_u32 s65, 57344
    v_mfma_f32_16x16x32_bf16 v[242:245], a[52:55], a[204:207], v[242:245]
    ds_read_b64_tr_b16 a[230:231], v34 offset:38912
    s_waitcnt lgkmcnt(8)
    v_mfma_f32_16x16x32_bf16 v[190:193], a[48:51], a[208:211], v[190:193]
    ds_read_b64_tr_b16 a[200:201], v31 offset:49152
    s_cselect_b32 s65, 0, s65
    v_mfma_f32_16x16x32_bf16 v[194:197], a[52:55], a[208:211], v[194:197]
    ds_read_b64_tr_b16 a[202:203], v31 offset:51200
    buffer_load_dwordx4 a[96:99], v79, s[28:31], s65 offen offset:0 sc1
    v_add_f32 v232, v232, v94
    v_mfma_f32_16x16x32_bf16 v[246:249], a[48:51], a[212:215], v[246:249]
    ds_read_b64_tr_b16 a[204:205], v33 offset:49152
    v_add_f32 v233, v233, v94
    v_mfma_f32_16x16x32_bf16 v[250:253], a[52:55], a[212:215], v[250:253]
    ds_read_b64_tr_b16 a[206:207], v33 offset:51200
    s_waitcnt vmcnt(9) lgkmcnt(8)
    v_mfma_f32_16x16x32_bf16 v[182:185], a[56:59], a[216:219], v[182:185]
    ds_read_b64_tr_b16 a[208:209], v32 offset:49152
    buffer_load_dwordx4 a[100:103], v79, s[28:31], s65 offen offset:1024 sc1
    v_mfma_f32_16x16x32_bf16 v[186:189], a[60:63], a[216:219], v[186:189]
    ds_read_b64_tr_b16 a[210:211], v32 offset:51200
    v_lshlrev_b32 v234, 16, v102
    v_mfma_f32_16x16x32_bf16 v[238:241], a[56:59], a[220:223], v[238:241]
    ds_read_b64_tr_b16 a[212:213], v34 offset:49152
    buffer_load_dwordx4 a[104:107], v79, s[28:31], s65 offen offset:2048 sc1
    v_mfma_f32_16x16x32_bf16 v[242:245], a[60:63], a[220:223], v[242:245]
    ds_read_b64_tr_b16 a[214:215], v34 offset:51200
    v_and_b32 v235, 0xffff0000, v102
    s_waitcnt lgkmcnt(8)
    v_mfma_f32_16x16x32_bf16 v[190:193], a[56:59], a[224:227], v[190:193]
    ds_read_b64_tr_b16 a[216:217], v31 offset:53248
    v_add_f32 v234, v234, v94
    v_mfma_f32_16x16x32_bf16 v[194:197], a[60:63], a[224:227], v[194:197]
    ds_read_b64_tr_b16 a[218:219], v31 offset:55296
    buffer_load_dwordx4 a[108:111], v79, s[28:31], s65 offen offset:3072 sc1
    v_add_f32 v235, v235, v94
    v_mfma_f32_16x16x32_bf16 v[246:249], a[56:59], a[228:231], v[246:249]
    ds_read_b64_tr_b16 a[220:221], v33 offset:53248
    s_add_u32 m0, s58, 16384
    v_mfma_f32_16x16x32_bf16 v[250:253], a[60:63], a[228:231], v[250:253]
    ds_read_b64_tr_b16 a[222:223], v33 offset:55296
    s_waitcnt vmcnt(10) lgkmcnt(8)
    v_mfma_f32_16x16x32_bf16 v[182:185], a[64:67], a[200:203], v[182:185]
    ds_read_b64_tr_b16 a[224:225], v32 offset:53248
    s_add_u32 s64, s64, 524288
    v_mfma_f32_16x16x32_bf16 v[186:189], a[68:71], a[200:203], v[186:189]
    ds_read_b64_tr_b16 a[226:227], v32 offset:55296
    s_cmp_eq_u32 s64, 3670016
    v_lshlrev_b32 v236, 16, v103
    v_mfma_f32_16x16x32_bf16 v[238:241], a[64:67], a[204:207], v[238:241]
    ds_read_b64_tr_b16 a[228:229], v34 offset:53248
    s_cselect_b32 s64, 0, s64
    buffer_load_dwordx4 v59, s[24:27], s64 offen lds
    v_mfma_f32_16x16x32_bf16 v[242:245], a[68:71], a[204:207], v[242:245]
    ds_read_b64_tr_b16 a[230:231], v34 offset:55296
    v_and_b32 v237, 0xffff0000, v103
    s_waitcnt lgkmcnt(8)
    v_mfma_f32_16x16x32_bf16 v[190:193], a[64:67], a[208:211], v[190:193]
    s_barrier
    ds_read_b64_tr_b16 a[200:201], v35 offset:32768
    buffer_load_dwordx4 v60, s[24:27], s64 offen offset:1024 lds
    v_mfma_f32_16x16x32_bf16 v[194:197], a[68:71], a[208:211], v[194:197]
    ds_read_b64_tr_b16 a[202:203], v35 offset:34816
    v_add_f32 v236, v236, v94
    v_mfma_f32_16x16x32_bf16 v[246:249], a[64:67], a[212:215], v[246:249]
    ds_read_b64_tr_b16 a[204:205], v37 offset:32768
    v_add_f32 v237, v237, v94
    v_mfma_f32_16x16x32_bf16 v[250:253], a[68:71], a[212:215], v[250:253]
    ds_read_b64_tr_b16 a[206:207], v37 offset:34816
    s_waitcnt vmcnt(10) lgkmcnt(8)
    v_mfma_f32_16x16x32_bf16 v[182:185], a[72:75], a[216:219], v[182:185]
    ds_read_b64_tr_b16 a[208:209], v36 offset:32768
    buffer_load_dwordx4 v61, s[24:27], s64 offen offset:2048 lds
    v_mfma_f32_16x16x32_bf16 v[186:189], a[76:79], a[216:219], v[186:189]
    ds_read_b64_tr_b16 a[210:211], v36 offset:34816
    v_mfma_f32_16x16x32_bf16 v[238:241], a[72:75], a[220:223], v[238:241]
    ds_read_b64_tr_b16 a[212:213], v38 offset:32768
    buffer_load_dwordx4 v62, s[24:27], s64 offen offset:3072 lds
    v_mfma_f32_16x16x32_bf16 v[242:245], a[76:79], a[220:223], v[242:245]
    ds_read_b64_tr_b16 a[214:215], v38 offset:34816
    s_waitcnt lgkmcnt(8)
    v_mfma_f32_16x16x32_bf16 v[190:193], a[72:75], a[224:227], v[190:193]
    ds_read_b64_tr_b16 a[216:217], v35 offset:36864
    s_add_u32 m0, s58, 65536
    v_mfma_f32_16x16x32_bf16 v[194:197], a[76:79], a[224:227], v[194:197]
    ds_read_b64_tr_b16 a[218:219], v35 offset:38912
    s_add_u32 s64, s64, 524288
    v_mfma_f32_16x16x32_bf16 v[246:249], a[72:75], a[228:231], v[246:249]
    ds_read_b64_tr_b16 a[220:221], v37 offset:36864
    s_cmp_eq_u32 s64, 3670016
    v_mfma_f32_16x16x32_bf16 v[250:253], a[76:79], a[228:231], v[250:253]
    ds_read_b64_tr_b16 a[222:223], v37 offset:38912
    s_cselect_b32 s64, 0, s64
    buffer_load_dwordx4 v59, s[24:27], s64 offen lds
    s_waitcnt vmcnt(11) lgkmcnt(8)
    v_mfma_f32_16x16x32_bf16 v[182:185], a[80:83], a[200:203], v[182:185]
    ds_read_b64_tr_b16 a[224:225], v36 offset:36864
    v_mfma_f32_16x16x32_bf16 v[186:189], a[84:87], a[200:203], v[186:189]
    ds_read_b64_tr_b16 a[226:227], v36 offset:38912
    buffer_load_dwordx4 v60, s[24:27], s64 offen offset:1024 lds
    v_mfma_f32_16x16x32_bf16 v[238:241], a[80:83], a[204:207], v[238:241]
    ds_read_b64_tr_b16 a[228:229], v38 offset:36864
    v_mfma_f32_16x16x32_bf16 v[242:245], a[84:87], a[204:207], v[242:245]
    ds_read_b64_tr_b16 a[230:231], v38 offset:38912
    s_waitcnt lgkmcnt(8)
    v_mfma_f32_16x16x32_bf16 v[190:193], a[80:83], a[208:211], v[190:193]
    ds_read_b64_tr_b16 a[200:201], v35 offset:49152
    v_mfma_f32_16x16x32_bf16 v[194:197], a[84:87], a[208:211], v[194:197]
    ds_read_b64_tr_b16 a[202:203], v35 offset:51200
    buffer_load_dwordx4 v61, s[24:27], s64 offen offset:2048 lds
    v_mfma_f32_16x16x32_bf16 v[246:249], a[80:83], a[212:215], v[246:249]
    ds_read_b64_tr_b16 a[204:205], v37 offset:49152
    v_mfma_f32_16x16x32_bf16 v[250:253], a[84:87], a[212:215], v[250:253]
    ds_read_b64_tr_b16 a[206:207], v37 offset:51200
    s_waitcnt vmcnt(11) lgkmcnt(8)
    v_mfma_f32_16x16x32_bf16 v[182:185], a[88:91], a[216:219], v[182:185]
    ds_read_b64_tr_b16 a[208:209], v36 offset:49152
    buffer_load_dwordx4 v62, s[24:27], s64 offen offset:3072 lds
    v_mfma_f32_16x16x32_bf16 v[186:189], a[92:95], a[216:219], v[186:189]
    ds_read_b64_tr_b16 a[210:211], v36 offset:51200
    s_add_u32 m0, s58, 81920
    v_mfma_f32_16x16x32_bf16 v[238:241], a[88:91], a[220:223], v[238:241]
    ds_read_b64_tr_b16 a[212:213], v38 offset:49152
    s_add_u32 s64, s64, 524288
    v_mfma_f32_16x16x32_bf16 v[242:245], a[92:95], a[220:223], v[242:245]
    ds_read_b64_tr_b16 a[214:215], v38 offset:51200
    s_waitcnt lgkmcnt(8)
    v_mfma_f32_16x16x32_bf16 v[190:193], a[88:91], a[224:227], v[190:193]
    ds_read_b64_tr_b16 a[216:217], v35 offset:53248
    s_cmp_eq_u32 s64, 3670016
    v_mfma_f32_16x16x32_bf16 v[194:197], a[92:95], a[224:227], v[194:197]
    ds_read_b64_tr_b16 a[218:219], v35 offset:55296
    s_cselect_b32 s64, 0, s64
    buffer_load_dwordx4 v59, s[24:27], s64 offen lds
    v_mfma_f32_16x16x32_bf16 v[246:249], a[88:91], a[228:231], v[246:249]
    ds_read_b64_tr_b16 a[220:221], v37 offset:53248
    v_mfma_f32_16x16x32_bf16 v[250:253], a[92:95], a[228:231], v[250:253]
    ds_read_b64_tr_b16 a[222:223], v37 offset:55296
    s_waitcnt vmcnt(11) lgkmcnt(8)
    v_mfma_f32_16x16x32_bf16 v[182:185], a[96:99], a[200:203], v[182:185]
    ds_read_b64_tr_b16 a[224:225], v36 offset:53248
    buffer_load_dwordx4 v60, s[24:27], s64 offen offset:1024 lds
    v_mfma_f32_16x16x32_bf16 v[186:189], a[100:103], a[200:203], v[186:189]
    ds_read_b64_tr_b16 a[226:227], v36 offset:55296
    v_mfma_f32_16x16x32_bf16 v[238:241], a[96:99], a[204:207], v[238:241]
    ds_read_b64_tr_b16 a[228:229], v38 offset:53248
    v_mfma_f32_16x16x32_bf16 v[242:245], a[100:103], a[204:207], v[242:245]
    ds_read_b64_tr_b16 a[230:231], v38 offset:55296
    s_waitcnt lgkmcnt(8)
    v_mfma_f32_16x16x32_bf16 v[190:193], a[96:99], a[208:211], v[190:193]
    s_barrier
    ds_read_b64_tr_b16 a[200:201], v31 offset:0
    buffer_load_dwordx4 v61, s[24:27], s64 offen offset:2048 lds
    v_mfma_f32_16x16x32_bf16 v[194:197], a[100:103], a[208:211], v[194:197]
    ds_read_b64_tr_b16 a[202:203], v31 offset:2048
    v_mfma_f32_16x16x32_bf16 v[246:249], a[96:99], a[212:215], v[246:249]
    ds_read_b64_tr_b16 a[204:205], v33 offset:0
    buffer_load_dwordx4 v62, s[24:27], s64 offen offset:3072 lds
    v_mfma_f32_16x16x32_bf16 v[250:253], a[100:103], a[212:215], v[250:253]
    ds_read_b64_tr_b16 a[206:207], v33 offset:2048
    s_waitcnt vmcnt(12) lgkmcnt(8)
    v_mfma_f32_16x16x32_bf16 v[182:185], a[104:107], a[216:219], v[182:185]
    ds_read_b64_tr_b16 a[208:209], v32 offset:0
    s_add_u32 m0, s58, 32768
    v_mfma_f32_16x16x32_bf16 v[186:189], a[108:111], a[216:219], v[186:189]
    ds_read_b64_tr_b16 a[210:211], v32 offset:2048
    s_add_u32 s64, s64, 524288
    v_mfma_f32_16x16x32_bf16 v[238:241], a[104:107], a[220:223], v[238:241]
    ds_read_b64_tr_b16 a[212:213], v34 offset:0
    s_cmp_eq_u32 s64, 3670016
    v_mfma_f32_16x16x32_bf16 v[242:245], a[108:111], a[220:223], v[242:245]
    ds_read_b64_tr_b16 a[214:215], v34 offset:2048
    s_cselect_b32 s64, 0, s64
    buffer_load_dwordx4 v59, s[24:27], s64 offen lds
    s_waitcnt lgkmcnt(8)
    v_mfma_f32_16x16x32_bf16 v[190:193], a[104:107], a[224:227], v[190:193]
    ds_read_b64_tr_b16 a[216:217], v31 offset:4096
    v_mfma_f32_16x16x32_bf16 v[194:197], a[108:111], a[224:227], v[194:197]
    ds_read_b64_tr_b16 a[218:219], v31 offset:6144
    buffer_load_dwordx4 v60, s[24:27], s64 offen offset:1024 lds
    v_mfma_f32_16x16x32_bf16 v[246:249], a[104:107], a[228:231], v[246:249]
    ds_read_b64_tr_b16 a[220:221], v33 offset:4096
    v_mfma_f32_16x16x32_bf16 v[250:253], a[108:111], a[228:231], v[250:253]
    ds_read_b64_tr_b16 a[222:223], v33 offset:6144
    s_waitcnt lgkmcnt(8)
    v_mfma_f32_16x16x32_bf16 v[150:153], a[0:3], a[200:203], 0
    ds_read_b64_tr_b16 a[224:225], v32 offset:4096
    v_mfma_f32_16x16x32_bf16 v[154:157], a[4:7], a[200:203], 0
    ds_read_b64_tr_b16 a[226:227], v32 offset:6144
    buffer_load_dwordx4 v61, s[24:27], s64 offen offset:2048 lds
    v_mfma_f32_16x16x32_bf16 v[166:169], a[0:3], a[204:207], 0
    ds_read_b64_tr_b16 a[228:229], v34 offset:4096
    v_cvt_pk_bf16_f32 v182, v182, v183
    v_mfma_f32_16x16x32_bf16 v[170:173], a[4:7], a[204:207], 0
    ds_read_b64_tr_b16 a[230:231], v34 offset:6144
    v_cvt_pk_bf16_f32 v183, v184, v185
    v_cvt_pk_bf16_f32 v184, v186, v187
    s_waitcnt lgkmcnt(8)
    v_mfma_f32_16x16x32_bf16 v[158:161], a[0:3], a[208:211], 0
    s_load_dword s14, s[28:29], s39
    ds_read_b64_tr_b16 a[200:201], v39 offset:0
    buffer_load_dwordx4 v62, s[24:27], s64 offen offset:3072 lds
    v_mfma_f32_16x16x32_bf16 v[162:165], a[4:7], a[208:211], 0
    ds_read_b64_tr_b16 a[202:203], v39 offset:2048
    s_add_u32 m0, s58, 49152
    v_cvt_pk_bf16_f32 v185, v188, v189
    buffer_store_dwordx4 v[182:185], v21, s[28:31], 0 offen offset:0 sc1
    v_cvt_pk_bf16_f32 v190, v190, v191
    v_cvt_pk_bf16_f32 v191, v192, v193
    v_cvt_pk_bf16_f32 v192, v194, v195
    v_mfma_f32_16x16x32_bf16 v[174:177], a[0:3], a[212:215], 0
    ds_read_b64_tr_b16 a[204:205], v41 offset:0
    s_add_u32 s66, s66, 1
    v_mfma_f32_16x16x32_bf16 v[178:181], a[4:7], a[212:215], 0
    ds_read_b64_tr_b16 a[206:207], v41 offset:2048
    v_cvt_pk_bf16_f32 v193, v196, v197
    buffer_store_dwordx4 v[190:193], v21, s[28:31], 0 offen offset:1024 sc1
    v_cvt_pk_bf16_f32 v238, v238, v239
    v_cvt_pk_bf16_f32 v239, v240, v241
    v_cvt_pk_bf16_f32 v240, v242, v243
    s_waitcnt lgkmcnt(8)
    v_mfma_f32_16x16x32_bf16 v[150:153], a[8:11], a[216:219], v[150:153]
    ds_read_b64_tr_b16 a[208:209], v40 offset:0
    s_and_b32 s66, s66, 3
    v_mfma_f32_16x16x32_bf16 v[154:157], a[12:15], a[216:219], v[154:157]
    ds_read_b64_tr_b16 a[210:211], v40 offset:2048
    s_mul_i32 s61, s66, 100352
    buffer_load_dwordx4 v63, s[16:19], s61 offen lds
    v_cvt_pk_bf16_f32 v241, v244, v245
    buffer_store_dwordx4 v[238:241], v21, s[28:31], 0 offen offset:2048 sc1
    v_cvt_pk_bf16_f32 v246, v246, v247
    v_cvt_pk_bf16_f32 v247, v248, v249
    v_cvt_pk_bf16_f32 v248, v250, v251
    v_mfma_f32_16x16x32_bf16 v[166:169], a[8:11], a[220:223], v[166:169]
    ds_read_b64_tr_b16 a[212:213], v42 offset:0
    v_cvt_pk_bf16_f32 v249, v252, v253
    v_mfma_f32_16x16x32_bf16 v[170:173], a[12:15], a[220:223], v[170:173]
    ds_read_b64_tr_b16 a[214:215], v42 offset:2048
    s_waitcnt lgkmcnt(8)
    v_mfma_f32_16x16x32_bf16 v[158:161], a[8:11], a[224:227], v[158:161]
    ds_read_b64_tr_b16 a[216:217], v39 offset:4096
    buffer_load_dwordx4 v64, s[16:19], s61 offen offset:1024 lds
    v_mfma_f32_16x16x32_bf16 v[162:165], a[12:15], a[224:227], v[162:165]
    ds_read_b64_tr_b16 a[218:219], v39 offset:6144
    s_add_u32 s61, s61, 48128
    buffer_store_dwordx4 v[246:249], v21, s[28:31], 0 offen offset:3072 sc1
    v_mfma_f32_16x16x32_bf16 v[174:177], a[8:11], a[228:231], v[174:177]
    ds_read_b64_tr_b16 a[220:221], v41 offset:4096
    v_mfma_f32_16x16x32_bf16 v[178:181], a[12:15], a[228:231], v[178:181]
    ds_read_b64_tr_b16 a[222:223], v41 offset:6144
    s_waitcnt lgkmcnt(8)
    v_mfma_f32_16x16x32_bf16 v[150:153], a[16:19], a[200:203], v[150:153]
    ds_read_b64_tr_b16 a[224:225], v40 offset:4096
    buffer_load_dwordx4 v63, s[16:19], s61 offen offset:2048 lds
    v_mfma_f32_16x16x32_bf16 v[154:157], a[20:23], a[200:203], v[154:157]
    ds_read_b64_tr_b16 a[226:227], v40 offset:6144
    v_mfma_f32_16x16x32_bf16 v[166:169], a[16:19], a[204:207], v[166:169]
    ds_read_b64_tr_b16 a[228:229], v42 offset:4096
    v_mfma_f32_16x16x32_bf16 v[170:173], a[20:23], a[204:207], v[170:173]
    ds_read_b64_tr_b16 a[230:231], v42 offset:6144
    s_waitcnt lgkmcnt(8)
    v_mfma_f32_16x16x32_bf16 v[158:161], a[16:19], a[208:211], v[158:161]
    s_waitcnt vmcnt(7)
    s_barrier
    ds_read_b64_tr_b16 a[200:201], v39 offset:16384
    buffer_load_dwordx4 v64, s[16:19], s61 offen offset:3072 lds
    v_mfma_f32_16x16x32_bf16 v[162:165], a[20:23], a[208:211], v[162:165]
    ds_read_b64_tr_b16 a[202:203], v39 offset:18432
    s_add_u32 m0, s58, 98304
    v_mfma_f32_16x16x32_bf16 v[174:177], a[16:19], a[212:215], v[174:177]
    ds_read_b64_tr_b16 a[204:205], v41 offset:16384
    s_add_u32 s66, s66, 1
    v_mfma_f32_16x16x32_bf16 v[178:181], a[20:23], a[212:215], v[178:181]
    ds_read_b64_tr_b16 a[206:207], v41 offset:18432
    s_waitcnt lgkmcnt(8)
    v_mfma_f32_16x16x32_bf16 v[150:153], a[24:27], a[216:219], v[150:153]
    ds_read_b64_tr_b16 a[208:209], v40 offset:16384
    s_and_b32 s66, s66, 3
    s_mul_i32 s61, s66, 100352
    buffer_load_dwordx4 v63, s[16:19], s61 offen lds
    v_mfma_f32_16x16x32_bf16 v[154:157], a[28:31], a[216:219], v[154:157]
    ds_read_b64_tr_b16 a[210:211], v40 offset:18432
    v_mfma_f32_16x16x32_bf16 v[166:169], a[24:27], a[220:223], v[166:169]
    ds_read_b64_tr_b16 a[212:213], v42 offset:16384
    buffer_load_dwordx4 v64, s[16:19], s61 offen offset:1024 lds
    v_mfma_f32_16x16x32_bf16 v[170:173], a[28:31], a[220:223], v[170:173]
    ds_read_b64_tr_b16 a[214:215], v42 offset:18432
    s_waitcnt lgkmcnt(8)
    v_mfma_f32_16x16x32_bf16 v[158:161], a[24:27], a[224:227], v[158:161]
    ds_read_b64_tr_b16 a[216:217], v39 offset:20480
    s_add_u32 s61, s61, 48128
    v_mfma_f32_16x16x32_bf16 v[162:165], a[28:31], a[224:227], v[162:165]
    ds_read_b64_tr_b16 a[218:219], v39 offset:22528
    v_mfma_f32_16x16x32_bf16 v[174:177], a[24:27], a[228:231], v[174:177]
    ds_read_b64_tr_b16 a[220:221], v41 offset:20480
    buffer_load_dwordx4 v63, s[16:19], s61 offen offset:2048 lds
    v_mfma_f32_16x16x32_bf16 v[178:181], a[28:31], a[228:231], v[178:181]
    ds_read_b64_tr_b16 a[222:223], v41 offset:22528
    s_waitcnt lgkmcnt(8)
    v_mfma_f32_16x16x32_bf16 v[150:153], a[32:35], a[200:203], v[150:153]
    ds_read_b64_tr_b16 a[224:225], v40 offset:20480
    v_mfma_f32_16x16x32_bf16 v[154:157], a[36:39], a[200:203], v[154:157]
    ds_read_b64_tr_b16 a[226:227], v40 offset:22528
    buffer_load_dwordx4 v64, s[16:19], s61 offen offset:3072 lds
    v_mfma_f32_16x16x32_bf16 v[166:169], a[32:35], a[204:207], v[166:169]
    ds_read_b64_tr_b16 a[228:229], v42 offset:20480
    s_add_u32 m0, s58, 114688
    v_mfma_f32_16x16x32_bf16 v[170:173], a[36:39], a[204:207], v[170:173]
    ds_read_b64_tr_b16 a[230:231], v42 offset:22528
    s_waitcnt lgkmcnt(8)
    v_mfma_f32_16x16x32_bf16 v[158:161], a[32:35], a[208:211], v[158:161]
    ds_read_b64_tr_b16 a[200:201], v31 offset:16384
    s_add_u32 s66, s66, 1
    v_mfma_f32_16x16x32_bf16 v[162:165], a[36:39], a[208:211], v[162:165]
    ds_read_b64_tr_b16 a[202:203], v31 offset:18432
    s_and_b32 s66, s66, 3
    v_mfma_f32_16x16x32_bf16 v[174:177], a[32:35], a[212:215], v[174:177]
    ds_read_b64_tr_b16 a[204:205], v33 offset:16384
    s_mul_i32 s61, s66, 100352
    buffer_load_dwordx4 v63, s[16:19], s61 offen lds
    v_mfma_f32_16x16x32_bf16 v[178:181], a[36:39], a[212:215], v[178:181]
    ds_read_b64_tr_b16 a[206:207], v33 offset:18432
    s_waitcnt lgkmcnt(8)
    v_mfma_f32_16x16x32_bf16 v[150:153], a[40:43], a[216:219], v[150:153]
    ds_read_b64_tr_b16 a[208:209], v32 offset:16384
    buffer_load_dwordx4 v64, s[16:19], s61 offen offset:1024 lds
    v_mfma_f32_16x16x32_bf16 v[154:157], a[44:47], a[216:219], v[154:157]
    ds_read_b64_tr_b16 a[210:211], v32 offset:18432
    s_add_u32 s61, s61, 48128
    v_mfma_f32_16x16x32_bf16 v[166:169], a[40:43], a[220:223], v[166:169]
    ds_read_b64_tr_b16 a[212:213], v34 offset:16384
    v_mfma_f32_16x16x32_bf16 v[170:173], a[44:47], a[220:223], v[170:173]
    ds_read_b64_tr_b16 a[214:215], v34 offset:18432
    s_waitcnt lgkmcnt(8)
    v_mfma_f32_16x16x32_bf16 v[158:161], a[40:43], a[224:227], v[158:161]
    ds_read_b64_tr_b16 a[216:217], v31 offset:20480
    buffer_load_dwordx4 v63, s[16:19], s61 offen offset:2048 lds
    v_mfma_f32_16x16x32_bf16 v[162:165], a[44:47], a[224:227], v[162:165]
    ds_read_b64_tr_b16 a[218:219], v31 offset:22528
    v_mfma_f32_16x16x32_bf16 v[174:177], a[40:43], a[228:231], v[174:177]
    ds_read_b64_tr_b16 a[220:221], v33 offset:20480
    v_mfma_f32_16x16x32_bf16 v[178:181], a[44:47], a[228:231], v[178:181]
    ds_read_b64_tr_b16 a[222:223], v33 offset:22528
    s_waitcnt lgkmcnt(8)
    v_mfma_f32_16x16x32_bf16 v[150:153], a[48:51], a[200:203], v[150:153]
    s_waitcnt lgkmcnt(0)
    s_cmp_ge_u32 s14, 8
    s_cbranch_scc1 L_pollok6
    s_mov_b32 s60, 0
L_poll6:
    s_sleep 8
    buffer_load_dword v18, off, s[28:31], s39 sc1
    s_add_u32 s60, s60, 1
    s_waitcnt vmcnt(0)
    v_readfirstlane_b32 s14, v18
    s_nop 0
    s_cmp_ge_u32 s14, 8
    s_cbranch_scc1 L_pollok6
    s_cmp_lt_u32 s60, 20000
    s_cbranch_scc1 L_poll6
L_pollok6:
    ds_read_b64_tr_b16 a[224:225], v32 offset:20480
    buffer_load_dwordx4 v64, s[16:19], s61 offen offset:3072 lds
    v_mfma_f32_16x16x32_bf16 v[154:157], a[52:55], a[200:203], v[154:157]
    ds_read_b64_tr_b16 a[226:227], v32 offset:22528
    s_add_u32 m0, s58, 0
    v_mfma_f32_16x16x32_bf16 v[166:169], a[48:51], a[204:207], v[166:169]
    ds_read_b64_tr_b16 a[228:229], v34 offset:20480
    s_add_u32 s66, s66, 1
    v_mfma_f32_16x16x32_bf16 v[170:173], a[52:55], a[204:207], v[170:173]
    ds_read_b64_tr_b16 a[230:231], v34 offset:22528
    v_mfma_f32_16x16x32_bf16 v[158:161], a[48:51], a[208:211], v[158:161]
    s_barrier
    s_waitcnt vmcnt(10)
    s_atomic_add s36, s[28:29], s55
    ds_read_b64_tr_b16 a[200:201], v35 offset:0
    s_and_b32 s66, s66, 3
    s_mul_i32 s61, s66, 100352
    buffer_load_dwordx4 v63, s[16:19], s61 offen lds
    v_mfma_f32_16x16x32_bf16 v[162:165], a[52:55], a[208:211], v[162:165]
    ds_read_b64_tr_b16 a[202:203], v35 offset:2048
    v_mfma_f32_16x16x32_bf16 v[174:177], a[48:51], a[212:215], v[174:177]
    ds_read_b64_tr_b16 a[204:205], v37 offset:0
    buffer_load_dwordx4 v64, s[16:19], s61 offen offset:1024 lds
    v_mfma_f32_16x16x32_bf16 v[178:181], a[52:55], a[212:215], v[178:181]
    ds_read_b64_tr_b16 a[206:207], v37 offset:2048
    v_mfma_f32_16x16x32_bf16 v[150:153], a[56:59], a[216:219], v[150:153]
    ds_read_b64_tr_b16 a[208:209], v36 offset:0
    s_add_u32 s61, s61, 48128
    v_mfma_f32_16x16x32_bf16 v[154:157], a[60:63], a[216:219], v[154:157]
    ds_read_b64_tr_b16 a[210:211], v36 offset:2048
    v_mfma_f32_16x16x32_bf16 v[166:169], a[56:59], a[220:223], v[166:169]
    ds_read_b64_tr_b16 a[212:213], v38 offset:0
    buffer_load_dwordx4 v63, s[16:19], s61 offen offset:2048 lds
    v_mfma_f32_16x16x32_bf16 v[170:173], a[60:63], a[220:223], v[170:173]
    ds_read_b64_tr_b16 a[214:215], v38 offset:2048
    s_waitcnt lgkmcnt(8)
    v_mfma_f32_16x16x32_bf16 v[158:161], a[56:59], a[224:227], v[158:161]
    ds_read_b64_tr_b16 a[216:217], v35 offset:4096
    v_mfma_f32_16x16x32_bf16 v[162:165], a[60:63], a[224:227], v[162:165]
    ds_read_b64_tr_b16 a[218:219], v35 offset:6144
    buffer_load_dwordx4 v64, s[16:19], s61 offen offset:3072 lds
    v_mfma_f32_16x16x32_bf16 v[174:177], a[56:59], a[228:231], v[174:177]
    ds_read_b64_tr_b16 a[220:221], v37 offset:4096
    s_add_u32 m0, s58, 131072
    v_mfma_f32_16x16x32_bf16 v[178:181], a[60:63], a[228:231], v[178:181]
    ds_read_b64_tr_b16 a[222:223], v37 offset:6144
    s_waitcnt lgkmcnt(8)
    v_mfma_f32_16x16x32_bf16 v[150:153], a[64:67], a[200:203], v[150:153]
    ds_read_b64_tr_b16 a[224:225], v36 offset:4096
    s_add_u32 s66, s66, 1
    v_mfma_f32_16x16x32_bf16 v[154:157], a[68:71], a[200:203], v[154:157]
    ds_read_b64_tr_b16 a[226:227], v36 offset:6144
    s_and_b32 s66, s66, 3
    v_mfma_f32_16x16x32_bf16 v[166:169], a[64:67], a[204:207], v[166:169]
    ds_read_b64_tr_b16 a[228:229], v38 offset:4096
    s_lshl_b32 s61, s66, 12
    buffer_load_dwordx4 v65, s[28:31], s61 offen sc1 lds
    v_mfma_f32_16x16x32_bf16 v[170:173], a[68:71], a[204:207], v[170:173]
    ds_read_b64_tr_b16 a[230:231], v38 offset:6144
    s_waitcnt lgkmcnt(8)
    v_mfma_f32_16x16x32_bf16 v[158:161], a[64:67], a[208:211], v[158:161]
    ds_read_b64_tr_b16 a[200:201], v35 offset:16384
    buffer_load_dwordx4 v66, s[28:31], s61 offen offset:1024 sc1 lds
    v_mfma_f32_16x16x32_bf16 v[162:165], a[68:71], a[208:211], v[162:165]
    ds_read_b64_tr_b16 a[202:203], v35 offset:18432
    v_mfma_f32_16x16x32_bf16 v[174:177], a[64:67], a[212:215], v[174:177]
    ds_read_b64_tr_b16 a[204:205], v37 offset:16384
    v_mfma_f32_16x16x32_bf16 v[178:181], a[68:71], a[212:215], v[178:181]
    ds_read_b64_tr_b16 a[206:207], v37 offset:18432
    s_waitcnt lgkmcnt(8)
    v_mfma_f32_16x16x32_bf16 v[150:153], a[72:75], a[216:219], v[150:153]
    ds_read_b64_tr_b16 a[208:209], v36 offset:16384
    buffer_load_dwordx4 v65, s[28:31], s61 offen offset:2048 sc1 lds
    v_mfma_f32_16x16x32_bf16 v[154:157], a[76:79], a[216:219], v[154:157]
    ds_read_b64_tr_b16 a[210:211], v36 offset:18432
    v_mfma_f32_16x16x32_bf16 v[166:169], a[72:75], a[220:223], v[166:169]
    ds_read_b64_tr_b16 a[212:213], v38 offset:16384
    buffer_load_dwordx4 v66, s[28:31], s61 offen offset:3072 sc1 lds
    v_mfma_f32_16x16x32_bf16 v[170:173], a[76:79], a[220:223], v[170:173]
    ds_read_b64_tr_b16 a[214:215], v38 offset:18432
    s_waitcnt lgkmcnt(8)
    v_mfma_f32_16x16x32_bf16 v[158:161], a[72:75], a[224:227], v[158:161]
    ds_read_b64_tr_b16 a[216:217], v35 offset:20480
    s_add_u32 m0, s58, 147456
    v_mfma_f32_16x16x32_bf16 v[162:165], a[76:79], a[224:227], v[162:165]
    ds_read_b64_tr_b16 a[218:219], v35 offset:22528
    s_add_u32 s66, s66, 1
    v_mfma_f32_16x16x32_bf16 v[174:177], a[72:75], a[228:231], v[174:177]
    ds_read_b64_tr_b16 a[220:221], v37 offset:20480
    s_and_b32 s66, s66, 3
    s_lshl_b32 s61, s66, 12
    buffer_load_dwordx4 v65, s[28:31], s61 offen sc1 lds
    v_mfma_f32_16x16x32_bf16 v[178:181], a[76:79], a[228:231], v[178:181]
    ds_read_b64_tr_b16 a[222:223], v37 offset:22528
    s_waitcnt lgkmcnt(8)
    v_mfma_f32_16x16x32_bf16 v[150:153], a[80:83], a[200:203], v[150:153]
    ds_read_b64_tr_b16 a[224:225], v36 offset:20480
    buffer_load_dwordx4 v66, s[28:31], s61 offen offset:1024 sc1 lds
    v_mfma_f32_16x16x32_bf16 v[154:157], a[84:87], a[200:203], v[154:157]
    ds_read_b64_tr_b16 a[226:227], v36 offset:22528
    v_mfma_f32_16x16x32_bf16 v[166:169], a[80:83], a[204:207], v[166:169]
    ds_read_b64_tr_b16 a[228:229], v38 offset:20480
    v_mfma_f32_16x16x32_bf16 v[170:173], a[84:87], a[204:207], v[170:173]
    ds_read_b64_tr_b16 a[230:231], v38 offset:22528
    s_waitcnt lgkmcnt(8)
    v_mfma_f32_16x16x32_bf16 v[158:161], a[80:83], a[208:211], v[158:161]
    s_barrier
    ds_read_b64_tr_b16 a[200:201], v31 offset:32768
    buffer_load_dwordx4 v65, s[28:31], s61 offen offset:2048 sc1 lds
    v_mfma_f32_16x16x32_bf16 v[162:165], a[84:87], a[208:211], v[162:165]
    ds_read_b64_tr_b16 a[202:203], v31 offset:34816
    v_mfma_f32_16x16x32_bf16 v[174:177], a[80:83], a[212:215], v[174:177]
    ds_read_b64_tr_b16 a[204:205], v33 offset:32768
    buffer_load_dwordx4 v66, s[28:31], s61 offen offset:3072 sc1 lds
    v_mfma_f32_16x16x32_bf16 v[178:181], a[84:87], a[212:215], v[178:181]
    ds_read_b64_tr_b16 a[206:207], v33 offset:34816
    s_waitcnt lgkmcnt(8)
    v_mfma_f32_16x16x32_bf16 v[150:153], a[88:91], a[216:219], v[150:153]
    ds_read_b64_tr_b16 a[208:209], v32 offset:32768
    s_add_u32 m0, s58, 16384
    v_mfma_f32_16x16x32_bf16 v[154:157], a[92:95], a[216:219], v[154:157]
    ds_read_b64_tr_b16 a[210:211], v32 offset:34816
    s_add_u32 s66, s66, 1
    v_mfma_f32_16x16x32_bf16 v[166:169], a[88:91], a[220:223], v[166:169]
    ds_read_b64_tr_b16 a[212:213], v34 offset:32768
    s_and_b32 s66, s66, 3
    s_lshl_b32 s61, s66, 12
    buffer_load_dwordx4 v65, s[28:31], s61 offen sc1 lds
    v_mfma_f32_16x16x32_bf16 v[170:173], a[92:95], a[220:223], v[170:173]
    ds_read_b64_tr_b16 a[214:215], v34 offset:34816
    s_waitcnt lgkmcnt(8)
    v_mfma_f32_16x16x32_bf16 v[158:161], a[88:91], a[224:227], v[158:161]
    ds_read_b64_tr_b16 a[216:217], v31 offset:36864
    buffer_load_dwordx4 v66, s[28:31], s61 offen offset:1024 sc1 lds
    v_mfma_f32_16x16x32_bf16 v[162:165], a[92:95], a[224:227], v[162:165]
    ds_read_b64_tr_b16 a[218:219], v31 offset:38912
    v_mfma_f32_16x16x32_bf16 v[174:177], a[88:91], a[228:231], v[174:177]
    ds_read_b64_tr_b16 a[220:221], v33 offset:36864
    v_mfma_f32_16x16x32_bf16 v[178:181], a[92:95], a[228:231], v[178:181]
    ds_read_b64_tr_b16 a[222:223], v33 offset:38912
    s_waitcnt lgkmcnt(8)
    v_mfma_f32_16x16x32_bf16 v[150:153], a[96:99], a[200:203], v[150:153]
    ds_read_b64_tr_b16 a[224:225], v32 offset:36864
    buffer_load_dwordx4 v65, s[28:31], s61 offen offset:2048 sc1 lds
    v_mfma_f32_16x16x32_bf16 v[154:157], a[100:103], a[200:203], v[154:157]
    ds_read_b64_tr_b16 a[226:227], v32 offset:38912
    v_mfma_f32_16x16x32_bf16 v[166:169], a[96:99], a[204:207], v[166:169]
    ds_read_b64_tr_b16 a[228:229], v34 offset:36864
    buffer_load_dwordx4 v66, s[28:31], s61 offen offset:3072 sc1 lds
    v_mfma_f32_16x16x32_bf16 v[170:173], a[100:103], a[204:207], v[170:173]
    ds_read_b64_tr_b16 a[230:231], v34 offset:38912
    s_waitcnt lgkmcnt(8)
    v_mfma_f32_16x16x32_bf16 v[158:161], a[96:99], a[208:211], v[158:161]
    s_waitcnt vmcnt(8)
    s_barrier
    s_xor_b32 s55, s55, 1024
    s_load_dword s14, s[28:29], s55
    ds_read_b64_tr_b16 v[198:199], v43 offset:49152
    ds_read_b64_tr_b16 v[200:201], v43 offset:53248
    v_mfma_f32_16x16x32_bf16 v[162:165], a[100:103], a[208:211], v[162:165]
    ds_read_b64_tr_b16 v[202:203], v44 offset:49152
    s_add_u32 m0, s58, 65536
    s_add_u32 s66, s66, 1
    s_and_b32 s66, s66, 3
    s_lshl_b32 s61, s66, 12
    buffer_load_dwordx4 v65, s[28:31], s61 offen sc1 lds
    v_mfma_f32_16x16x32_bf16 v[174:177], a[96:99], a[212:215], v[174:177]
    ds_read_b64_tr_b16 v[204:205], v44 offset:53248
    v_mfma_f32_16x16x32_bf16 v[178:181], a[100:103], a[212:215], v[178:181]
    ds_read_b128 a[200:203], v51 offset:0
    s_waitcnt lgkmcnt(9)
    v_mfma_f32_16x16x32_bf16 v[150:153], a[104:107], a[216:219], v[150:153]
    ds_read_b128 a[204:207], v52 offset:0
    buffer_load_dwordx4 v66, s[28:31], s61 offen offset:1024 sc1 lds
    v_mfma_f32_16x16x32_bf16 v[154:157], a[108:111], a[216:219], v[154:157]
    ds_read_b128 a[208:211], v51 offset:1024
    v_mfma_f32_16x16x32_bf16 v[166:169], a[104:107], a[220:223], v[166:169]
    ds_read_b128 a[212:215], v52 offset:1024
    buffer_load_dwordx4 v65, s[28:31], s61 offen offset:2048 sc1 lds
    v_mfma_f32_16x16x32_bf16 v[170:173], a[108:111], a[220:223], v[170:173]
    s_waitcnt lgkmcnt(8)
    v_mfma_f32_16x16x32_bf16 v[158:161], a[104:107], a[224:227], v[158:161]
    ds_read_b64_tr_b16 v[206:207], v43 offset:51200
    ds_read_b64_tr_b16 v[208:209], v43 offset:55296
    v_mfma_f32_16x16x32_bf16 v[162:165], a[108:111], a[224:227], v[162:165]
    ds_read_b64_tr_b16 v[210:211], v44 offset:51200
    buffer_load_dwordx4 v66, s[28:31], s61 offen offset:3072 sc1 lds
    v_mfma_f32_16x16x32_bf16 v[174:177], a[104:107], a[228:231], v[174:177]
    ds_read_b64_tr_b16 v[212:213], v44 offset:55296
    v_mfma_f32_16x16x32_bf16 v[178:181], a[108:111], a[228:231], v[178:181]
    ds_read_b128 a[216:219], v51 offset:2048
    s_waitcnt lgkmcnt(7)
    v_mfma_f32_16x16x32_bf16 v[150:153], v[198:201], a[200:203], v[150:153]
    ds_read_b128 a[220:223], v52 offset:2048
    v_mfma_f32_16x16x32_bf16 v[154:157], v[202:205], a[200:203], v[154:157]
    ds_read_b128 a[224:227], v51 offset:3072
    v_mfma_f32_16x16x32_bf16 v[166:169], v[198:201], a[204:207], v[166:169]
    ds_read_b128 a[228:231], v52 offset:3072
    v_mfma_f32_16x16x32_bf16 v[170:173], v[202:205], a[204:207], v[170:173]
    s_waitcnt lgkmcnt(8)
    v_mfma_f32_16x16x32_bf16 v[158:161], v[198:201], a[208:211], v[158:161]
    s_waitcnt vmcnt(8)
    s_barrier
    ds_read_b64_tr_b16 v[214:215], v45 offset:32768
    ds_read_b64_tr_b16 v[216:217], v45 offset:36864
    v_mfma_f32_16x16x32_bf16 v[162:165], v[202:205], a[208:211], v[162:165]
    ds_read_b64_tr_b16 v[218:219], v46 offset:32768
    v_mfma_f32_16x16x32_bf16 v[174:177], v[198:201], a[212:215], v[174:177]
    ds_read_b64_tr_b16 v[220:221], v46 offset:36864
    v_mfma_f32_16x16x32_bf16 v[178:181], v[202:205], a[212:215], v[178:181]
    ds_read_b128 a[200:203], v51 offset:16384
    s_waitcnt lgkmcnt(7)
    v_mfma_f32_16x16x32_bf16 v[150:153], v[206:209], a[216:219], v[150:153]
    ds_read_b128 a[204:207], v52 offset:16384
    v_mfma_f32_16x16x32_bf16 v[154:157], v[210:213], a[216:219], v[154:157]
    ds_read_b128 a[208:211], v51 offset:17408
    v_mfma_f32_16x16x32_bf16 v[166:169], v[206:209], a[220:223], v[166:169]
    ds_read_b128 a[212:215], v52 offset:17408
    v_mfma_f32_16x16x32_bf16 v[170:173], v[210:213], a[220:223], v[170:173]
    s_waitcnt lgkmcnt(8)
    v_mfma_f32_16x16x32_bf16 v[158:161], v[206:209], a[224:227], v[158:161]
    s_waitcnt lgkmcnt(0)
    s_cmp_ge_u32 s14, 1
    s_cbranch_scc1 L_pollok7
    s_mov_b32 s60, 0
L_poll7:
    s_sleep 4
    buffer_load_dword v18, off, s[28:31], s55 sc1
    s_add_u32 s60, s60, 1
    s_waitcnt vmcnt(0)
    v_readfirstlane_b32 s14, v18
    s_nop 0
    s_cmp_ge_u32 s14, 1
    s_cbranch_scc1 L_pollok7
    s_cmp_lt_u32 s60, 20000
    s_cbranch_scc1 L_poll7
L_pollok7:
    v_xor_b32 v21, 131072, v21
    ds_read_b64_tr_b16 v[198:199], v45 offset:34816
    ds_read_b64_tr_b16 v[200:201], v45 offset:38912
    buffer_load_dwordx4 v[246:249], v21, s[28:31], 0 offen offset:2048 sc1
    v_mfma_f32_16x16x32_bf16 v[162:165], v[210:213], a[224:227], v[162:165]
    ds_read_b64_tr_b16 v[202:203], v46 offset:34816
    buffer_load_dwordx4 v[250:253], v21, s[28:31], 0 offen offset:3072 sc1
    v_mfma_f32_16x16x32_bf16 v[174:177], v[206:209], a[228:231], v[174:177]
    ds_read_b64_tr_b16 v[204:205], v46 offset:38912
    v_mfma_f32_16x16x32_bf16 v[178:181], v[210:213], a[228:231], v[178:181]
    ds_read_b128 a[216:219], v51 offset:18432
    v_mfma_f32_16x16x32_bf16 v[150:153], v[214:217], a[200:203], v[150:153]
    ds_read_b128 a[220:223], v52 offset:18432
    buffer_load_dwordx4 v[238:241], v21, s[28:31], 0 offen offset:0 sc1
    v_mfma_f32_16x16x32_bf16 v[154:157], v[218:221], a[200:203], v[154:157]
    ds_read_b128 a[224:227], v51 offset:19456
    buffer_load_dwordx4 v[242:245], v21, s[28:31], 0 offen offset:1024 sc1
    v_mfma_f32_16x16x32_bf16 v[166:169], v[214:217], a[204:207], v[166:169]
    ds_read_b128 a[228:231], v52 offset:19456
    v_mfma_f32_16x16x32_bf16 v[170:173], v[218:221], a[204:207], v[170:173]
    v_mfma_f32_16x16x32_bf16 v[158:161], v[214:217], a[208:211], v[158:161]
    s_waitcnt vmcnt(8)
    s_barrier
    ds_read_b64_tr_b16 v[206:207], v45 offset:49152
    ds_read_b64_tr_b16 v[208:209], v45 offset:53248
    v_mfma_f32_16x16x32_bf16 v[162:165], v[218:221], a[208:211], v[162:165]
    ds_read_b64_tr_b16 v[210:211], v46 offset:49152
    v_mfma_f32_16x16x32_bf16 v[174:177], v[214:217], a[212:215], v[174:177]
    ds_read_b64_tr_b16 v[212:213], v46 offset:53248
    v_mfma_f32_16x16x32_bf16 v[178:181], v[218:221], a[212:215], v[178:181]
    ds_read_b128 a[200:203], v47 offset:16384
    s_waitcnt lgkmcnt(7)
    v_mfma_f32_16x16x32_bf16 v[150:153], v[198:201], a[216:219], v[150:153]
    ds_read_b128 a[204:207], v48 offset:16384
    v_mfma_f32_16x16x32_bf16 v[154:157], v[202:205], a[216:219], v[154:157]
    ds_read_b128 a[208:211], v47 offset:17408
    v_mfma_f32_16x16x32_bf16 v[166:169], v[198:201], a[220:223], v[166:169]
    ds_read_b128 a[212:215], v48 offset:17408
    v_mfma_f32_16x16x32_bf16 v[170:173], v[202:205], a[220:223], v[170:173]
    s_waitcnt lgkmcnt(8)
    v_mfma_f32_16x16x32_bf16 v[158:161], v[198:201], a[224:227], v[158:161]
    ds_read_b64_tr_b16 v[214:215], v45 offset:51200
    ds_read_b64_tr_b16 v[216:217], v45 offset:55296
    v_mfma_f32_16x16x32_bf16 v[162:165], v[202:205], a[224:227], v[162:165]
    ds_read_b64_tr_b16 v[218:219], v46 offset:51200
    v_mfma_f32_16x16x32_bf16 v[174:177], v[198:201], a[228:231], v[174:177]
    ds_read_b64_tr_b16 v[220:221], v46 offset:55296
    v_mfma_f32_16x16x32_bf16 v[178:181], v[202:205], a[228:231], v[178:181]
    ds_read_b128 a[216:219], v47 offset:18432
    s_waitcnt lgkmcnt(7)
    v_mfma_f32_16x16x32_bf16 v[150:153], v[206:209], a[200:203], v[150:153]
    ds_read_b128 a[220:223], v48 offset:18432
    v_mfma_f32_16x16x32_bf16 v[154:157], v[210:213], a[200:203], v[154:157]
    ds_read_b128 a[224:227], v47 offset:19456
    v_mfma_f32_16x16x32_bf16 v[166:169], v[206:209], a[204:207], v[166:169]
    ds_read_b128 a[228:231], v48 offset:19456
    v_mfma_f32_16x16x32_bf16 v[170:173], v[210:213], a[204:207], v[170:173]
    s_waitcnt lgkmcnt(8)
    v_mfma_f32_16x16x32_bf16 v[158:161], v[206:209], a[208:211], v[158:161]
    s_waitcnt vmcnt(4)
    s_barrier
    ds_read_b64_tr_b16 v[198:199], v43 offset:0
    ds_read_b64_tr_b16 v[200:201], v43 offset:4096
    v_mfma_f32_16x16x32_bf16 v[162:165], v[210:213], a[208:211], v[162:165]
    ds_read_b64_tr_b16 v[202:203], v44 offset:0
    v_mfma_f32_16x16x32_bf16 v[174:177], v[206:209], a[212:215], v[174:177]
    ds_read_b64_tr_b16 v[204:205], v44 offset:4096
    v_mfma_f32_16x16x32_bf16 v[178:181], v[210:213], a[212:215], v[178:181]
    ds_read_b128 a[200:203], v50 offset:0
    s_waitcnt lgkmcnt(7)
    v_mfma_f32_16x16x32_bf16 v[150:153], v[214:217], a[216:219], v[150:153]
    ds_read_b128 a[204:207], v50 offset:1024
    ds_read_b64_tr_b16 v[206:207], v43 offset:2048
    v_mfma_f32_16x16x32_bf16 v[154:157], v[218:221], a[216:219], v[154:157]
    ds_read_b64_tr_b16 v[208:209], v43 offset:6144
    ds_read_b64_tr_b16 v[210:211], v44 offset:2048
    v_mfma_f32_16x16x32_bf16 v[166:169], v[214:217], a[220:223], v[166:169]
    ds_read_b64_tr_b16 v[212:213], v44 offset:6144
    v_mfma_f32_16x16x32_bf16 v[170:173], v[218:221], a[220:223], v[170:173]
    ds_read_b128 a[208:211], v50 offset:2048
    s_waitcnt lgkmcnt(11)
    v_mfma_f32_16x16x32_bf16 v[158:161], v[214:217], a[224:227], v[158:161]
    ds_read_b128 a[212:215], v50 offset:3072
    v_mfma_f32_16x16x32_bf16 v[162:165], v[218:221], a[224:227], v[162:165]
    v_mfma_f32_16x16x32_bf16 v[174:177], v[214:217], a[228:231], v[174:177]
    v_mfma_f32_16x16x32_bf16 v[178:181], v[218:221], a[228:231], v[178:181]
    s_waitcnt lgkmcnt(6)
    v_mfma_f32_16x16x32_bf16 v[166:169], v[198:201], a[200:203], v[166:169]
    ds_read_b128 a[224:227], v49 offset:0
    v_mfma_f32_16x16x32_bf16 v[170:173], v[202:205], a[200:203], v[170:173]
    v_mfma_f32_16x16x32_bf16 v[174:177], v[198:201], a[204:207], v[174:177]
    ds_read_b128 a[228:231], v49 offset:1024
    v_mfma_f32_16x16x32_bf16 v[178:181], v[202:205], a[204:207], v[178:181]
    s_waitcnt lgkmcnt(2)
    v_mfma_f32_16x16x32_bf16 v[166:169], v[206:209], a[208:211], v[166:169]
    ds_read_b128 a[200:203], v49 offset:2048
    v_mfma_f32_16x16x32_bf16 v[170:173], v[210:213], a[208:211], v[170:173]
    v_mfma_f32_16x16x32_bf16 v[174:177], v[206:209], a[212:215], v[174:177]
    ds_read_b128 a[204:207], v49 offset:3072
    v_mfma_f32_16x16x32_bf16 v[178:181], v[210:213], a[212:215], v[178:181]
    s_waitcnt vmcnt(3)
    v_mfma_f32_16x16x32_bf16 v[166:169], a[250:253], v[246:249], v[166:169]
    v_mfma_f32_16x16x32_bf16 v[170:173], a[248:251], v[246:249], v[170:173]
    s_waitcnt vmcnt(2)
    v_mfma_f32_16x16x32_bf16 v[174:177], a[250:253], v[250:253], v[174:177]
    v_mfma_f32_16x16x32_bf16 v[178:181], a[248:251], v[250:253], v[178:181]
    s_waitcnt lgkmcnt(2)
    v_mfma_f32_16x16x32_bf16 v[150:153], v[198:201], a[224:227], v[150:153]
    v_mfma_f32_16x16x32_bf16 v[154:157], v[202:205], a[224:227], v[154:157]
    v_mfma_f32_16x16x32_bf16 v[158:161], v[198:201], a[228:231], v[158:161]
    ds_write_b128 v87, v[166:169] offset:8192
    v_mfma_f32_16x16x32_bf16 v[162:165], v[202:205], a[228:231], v[162:165]
    s_waitcnt lgkmcnt(1)
    v_mfma_f32_16x16x32_bf16 v[150:153], v[206:209], a[200:203], v[150:153]
    ds_write_b128 v88, v[170:173] offset:8192
    v_mfma_f32_16x16x32_bf16 v[154:157], v[210:213], a[200:203], v[154:157]
    v_mfma_f32_16x16x32_bf16 v[158:161], v[206:209], a[204:207], v[158:161]
    ds_write_b128 v87, v[174:177] offset:12288
    v_mfma_f32_16x16x32_bf16 v[162:165], v[210:213], a[204:207], v[162:165]
    s_waitcnt vmcnt(1)
    v_mfma_f32_16x16x32_bf16 v[150:153], a[250:253], v[238:241], v[150:153]
    ds_write_b128 v88, v[178:181] offset:12288
    v_mfma_f32_16x16x32_bf16 v[154:157], a[248:251], v[238:241], v[154:157]
    s_waitcnt vmcnt(0)
    v_mfma_f32_16x16x32_bf16 v[158:161], a[250:253], v[242:245], v[158:161]
    v_mfma_f32_16x16x32_bf16 v[162:165], a[248:251], v[242:245], v[162:165]
    s_nop 2
    ds_write_b128 v87, v[150:153] offset:0
    s_nop 0
    ds_write_b128 v88, v[154:157] offset:0
    s_nop 0
    ds_write_b128 v87, v[158:161] offset:4096
    ds_write_b128 v88, v[162:165] offset:4096
    s_waitcnt lgkmcnt(0)
    s_barrier
    ds_read_b128 v[118:121], v89 offset:0
    ds_read_b128 v[122:125], v90 offset:0
    ds_read_b128 v[126:129], v91 offset:0
    ds_read_b128 v[130:133], v92 offset:0
    ds_read_b128 v[134:137], v89 offset:2048
    ds_read_b128 v[138:141], v90 offset:2048
    ds_read_b128 v[142:145], v91 offset:2048
    ds_read_b128 v[146:149], v92 offset:2048
    s_waitcnt lgkmcnt(7)
    v_pk_add_f32 v[222:223], v[222:223], v[118:119]
    v_pk_add_f32 v[224:225], v[224:225], v[120:121]
    s_waitcnt lgkmcnt(6)
    v_pk_add_f32 v[226:227], v[226:227], v[122:123]
    v_pk_add_f32 v[228:229], v[228:229], v[124:125]
    s_waitcnt lgkmcnt(5)
    v_pk_add_f32 v[222:223], v[222:223], v[126:127]
    v_pk_add_f32 v[224:225], v[224:225], v[128:129]
    s_waitcnt lgkmcnt(4)
    v_pk_add_f32 v[226:227], v[226:227], v[130:131]
    v_pk_add_f32 v[228:229], v[228:229], v[132:133]
    v_cvt_pk_bf16_f32 v110, v222, v223
    v_cvt_pk_bf16_f32 v111, v224, v225
    v_cvt_pk_bf16_f32 v112, v226, v227
    v_cvt_pk_bf16_f32 v113, v228, v229
    buffer_store_dwordx4 v[110:113], v85, s[32:35], 0 offen
    s_waitcnt lgkmcnt(3)
    v_pk_add_f32 v[230:231], v[230:231], v[134:135]
    v_pk_add_f32 v[232:233], v[232:233], v[136:137]
    s_waitcnt lgkmcnt(2)
    v_pk_add_f32 v[234:235], v[234:235], v[138:139]
    v_pk_add_f32 v[236:237], v[236:237], v[140:141]
    s_waitcnt lgkmcnt(1)
    v_pk_add_f32 v[230:231], v[230:231], v[142:143]
    v_pk_add_f32 v[232:233], v[232:233], v[144:145]
    s_waitcnt lgkmcnt(0)
    v_pk_add_f32 v[234:235], v[234:235], v[146:147]
    v_pk_add_f32 v[236:237], v[236:237], v[148:149]
    v_cvt_pk_bf16_f32 v114, v230, v231
    v_cvt_pk_bf16_f32 v115, v232, v233
    v_cvt_pk_bf16_f32 v116, v234, v235
    v_cvt_pk_bf16_f32 v117, v236, v237
    buffer_store_dwordx4 v[114:117], v86, s[32:35], 0 offen
L_fin:
L_end:
    s_endpgm
.section .rodata,"a"
.p2align 6
.amdhsa_kernel parallel_sum__sliding_local_dilated__mixer_token_mlp__prompt_kernel
  .amdhsa_next_free_vgpr 512
  .amdhsa_next_free_sgpr 102
  .amdhsa_accum_offset 256
  .amdhsa_group_segment_fixed_size 0
  .amdhsa_kernarg_size 88
  .amdhsa_user_sgpr_count 2
  .amdhsa_user_sgpr_kernarg_segment_ptr 1
  .amdhsa_system_sgpr_workgroup_id_x 1
.end_amdhsa_kernel
```

```asm
; @launch grid=(256,1,1) block=(256,1,1) lds=163840
.amdgcn_target "amdgcn-amd-amdhsa--gfx950"
.text
.globl parallel_sum__sliding_local_dilated__mixer_token_mlp__prompt_kernel
.p2align 8
.type parallel_sum__sliding_local_dilated__mixer_token_mlp__prompt_kernel,@function
parallel_sum__sliding_local_dilated__mixer_token_mlp__prompt_kernel:
    s_cmp_ge_u32 s2, 256
    s_cbranch_scc1 L_end
    s_load_dwordx2 s[8:9], s[0:1], 0
    s_load_dwordx2 s[20:21], s[0:1], 32
    s_load_dwordx2 s[28:29], s[0:1], 80
    s_load_dwordx2 s[44:45], s[0:1], 72
    s_load_dwordx2 s[12:13], s[0:1], 8
    s_load_dwordx2 s[16:17], s[0:1], 16
    s_load_dwordx2 s[24:25], s[0:1], 48
    s_load_dwordx2 s[32:33], s[0:1], 64
    s_load_dwordx2 s[36:37], s[0:1], 40
    s_load_dwordx2 s[40:41], s[0:1], 56
    s_memrealtime s[78:79]
    s_getpc_b64 s[6:7]
L_pc:
    s_and_b32 s3, s2, 0xf8
    v_lshrrev_b32 v13, 5, v0
    v_add_lshl_u32 v13, s3, v13, 7
    v_min_u32 v13, L_last-L_pc, v13
    global_load_dword v18, v13, s[6:7]
    v_lshrrev_b32 v13, 6, v0
    v_and_b32 v10, 31, v0
    v_readfirstlane_b32 s48, v13
    v_bfe_u32 v9, v0, 5, 1
    v_mul_u32_u24 v14, 896, v9
    v_lshl_add_u32 v14, v10, 4, v14
    v_cmp_gt_u32 vcc, 28, v10
    v_mov_b32 v15, 268435456
    s_mov_b32 s10, 1835008
    s_mov_b32 s11, 0x20000
    v_cndmask_b32 v14, v15, v14, vcc
    s_lshr_b32 s4, s48, 1
    s_and_b32 s5, s48, 1
    s_and_b32 s3, s2, 0xfe
    s_add_u32 s3, s3, s4
    s_lshl_b32 s3, s3, 1
    s_and_b32 s60, s2, 1
    s_add_u32 s3, s3, s60
    s_lshl_b32 s3, s3, 1
    s_add_u32 s3, s3, s5
    s_mul_i32 s3, s3, 1792
    s_waitcnt lgkmcnt(0)
    buffer_load_dwordx4 v[182:185], v14, s[8:11], s3 offen
    buffer_load_dwordx4 v[186:189], v14, s[8:11], s3 offen offset:448
    v_and_b32 v1, 63, v0
    s_mov_b32 s46, 256
    s_mov_b32 s47, 0x20000
    s_lshl_b32 s3, s48, 8
    s_add_u32 s3, s3, s2
    s_cmp_lt_u32 s3, 8
    s_cselect_b32 s3, 0, 268435456
    s_or_b32 s78, s78, 1
    v_mov_b32 v234, s78
    v_mov_b32 v235, 0
    v_lshlrev_b32 v11, 25, v1
    buffer_atomic_cmpswap v[234:235], v11, s[44:47], s3 offen sc1
    s_bfe_u32 s6, s2, 0x20001
    s_and_b32 s7, s2, 1
    s_and_b32 s61, s2, 7
    s_lshr_b32 s101, s2, 3
    s_mul_i32 s52, s7, 25
    s_add_u32 s52, s52, s101
    s_mul_i32 s51, s52, 37
    s_lshr_b32 s51, s51, 8
    s_mul_i32 s3, s51, 7
    s_sub_u32 s52, s52, s3
    s_and_b32 s3, s6, 1
    s_mul_i32 s3, s3, 6
    s_add_u32 s51, s51, s3
    s_add_u32 s51, s51, 1
    s_add_u32 s3, s3, s51
    s_cmp_eq_u32 s3, 7
    s_cselect_b32 s51, 0, s51
    s_lshr_b32 s59, s6, 1
    s_lshl_b32 s51, s51, 1
    s_add_u32 s51, s51, s59
    s_max_u32 s60, s101, 25
    s_sub_u32 s60, s60, 25
    s_add_u32 s3, s101, s7
    s_cmp_lt_u32 s3, 25
    s_cselect_b32 s55, 1, 0
    s_cselect_b32 s52, s52, s60
    s_mov_b32 s22, 7340032
    s_mov_b32 s23, 0x20000
    s_lshl_b32 s3, s52, 1
    s_sub_u32 s60, s3, 7
    s_cmp_ge_u32 s3, 7
    s_cselect_b32 s3, s60, s3
    s_and_b32 s3, s3, 7
    s_mul_i32 s60, s61, 2
    s_add_u32 s3, s3, s60
    s_and_b32 s3, s3, 7
    s_mul_i32 s0, s3, 458752
    s_lshl_b32 s1, s3, 13
    s_lshl_b32 s58, s48, 12
    v_lshrrev_b32 v3, 4, v1
    v_lshrrev_b32 v5, 3, v1
    v_and_b32 v6, 7, v1
    v_lshlrev_b32 v14, 1, v3
    v_xor_b32 v14, v14, v6
    v_lshlrev_b32 v83, 4, v14
    s_cmp_eq_u32 s55, 0
    s_cbranch_scc1 L_nog1
    v_mul_u32_u24 v14, 3584, v5
    s_lshl_b32 s3, s59, 5
    s_add_u32 s3, s3, s48
    s_mul_i32 s3, s3, 114688
    s_lshl_b32 s60, s51, 7
    s_add_u32 s3, s3, s60
    v_add3_u32 v55, v14, v83, s3
    v_add_u32 v56, 56320, v55
    v_add_u32 v57, 26624, v55
    v_add_u32 v58, 82944, v55
    s_mov_b32 s38, 3584
    s_mov_b32 s39, 0x20000
    v_lshlrev_b32 v13, 3, v3
    s_lshl_b32 s3, s51, 1
    s_add_u32 s3, s3, s4
    s_lshl_b32 s3, s3, 6
    buffer_load_dwordx2 v[246:247], v13, s[36:39], s3 offen offset:0
    buffer_load_dwordx2 v[248:249], v13, s[36:39], s3 offen offset:32
    s_add_u32 m0, s58, 0
    v_xor_b32 v55, 128, v55
    buffer_load_dwordx4 v55, s[20:23], s0 offen lds
    v_xor_b32 v56, 128, v56
    buffer_load_dwordx4 v56, s[20:23], s0 offen offset:1024 lds
    v_xor_b32 v57, 128, v57
    buffer_load_dwordx4 v57, s[20:23], s0 offen offset:2048 lds
    v_xor_b32 v58, 128, v58
    buffer_load_dwordx4 v58, s[20:23], s0 offen offset:3072 lds
    s_mul_i32 s53, s101, 37
    s_lshr_b32 s53, s53, 8
    s_mul_i32 s54, s53, 7
    s_sub_u32 s54, s101, s54
    s_and_b32 s53, s53, 3
    s_lshl_b32 s3, s6, 2
    s_add_u32 s53, s53, s3
    s_lshl_b32 s53, s53, 1
    s_add_u32 s53, s53, s7
    s_mov_b32 s42, 4096
    s_mov_b32 s43, 0x20000
    s_lshl_b32 s3, s53, 2
    s_add_u32 s3, s3, s48
    s_lshl_b32 s60, s3, 5
    v_lshl_add_u32 v82, v5, 1, s60
    s_mul_i32 s3, s3, 14336
    s_lshl_b32 s60, s54, 7
    s_add_u32 s3, s3, s60
    v_mul_u32_u24 v14, 896, v5
    v_lshl_add_u32 v14, v6, 4, v14
    v_add_u32 v85, s3, v14
    v_add_u32 v86, 7168, v85
    s_cmp_lt_u32 s101, 28
    s_cselect_b32 s56, 1, 0
    s_lshl_b32 s50, s7, 3
    s_and_b32 s3, s101, 7
    s_add_u32 s50, s50, s3
    s_lshr_b32 s60, s101, 3
    s_lshl_b32 s49, s6, 2
    s_add_u32 s49, s49, s60
    s_lshl_b32 s49, s49, 2
    s_add_u32 s49, s49, s48
    s_mul_i32 s60, s60, 0
    s_add_u32 s3, s3, s60
    s_sub_u32 s60, s3, 7
    s_cmp_ge_u32 s3, 7
    s_cselect_b32 s3, s60, s3
    s_lshl_b32 s62, s3, 18
    s_mul_i32 s63, s3, 12288
    s_mov_b32 s30, 20971520
    s_mov_b32 s31, 0x20000
    s_mov_b32 s75, 0x3727c5ac
    s_mov_b32 s76, 0x3b124925
    s_mov_b32 s77, 0x3f803f80
    v_lshlrev_b32 v4, 4, v1
    v_bfe_u32 v7, v1, 2, 2
    v_and_b32 v8, 3, v1
    v_mul_u32_u24 v13, 960, v9
    v_lshl_add_u32 v13, v10, 4, v13
    s_mul_i32 s3, s48, 1920
    s_add_u32 s3, s3, 147456
    v_add_u32 v230, s3, v13
    v_mul_u32_u24 v13, 960, v7
    v_lshl_add_u32 v13, v3, 5, v13
    v_lshl_add_u32 v13, v8, 3, v13
    s_lshl_b32 s3, s48, 8
    s_add_u32 s3, s3, 147456
    v_add_u32 v231, s3, v13
    s_lshl_b32 s3, s48, 3
    s_add_u32 s3, s3, 155648
    v_lshl_add_u32 v232, v9, 2, s3
    v_lshlrev_b32 v237, 2, v6
    v_and_b32 v2, 15, v1
    v_lshlrev_b32 v238, 14, v3
    v_add_lshl_u32 v238, v238, v2, 2
    v_add_u32 v237, 155648, v237
    v_lshlrev_b32 v13, 17, v9
    v_lshl_add_u32 v233, v10, 4, v13
    s_cmp_eq_u32 s48, 3
    s_cselect_b32 s60, 268435456, 0
    s_lshl_b32 s70, s48, 10
    s_add_u32 s70, s70, s2
    s_lshl_b32 s70, s70, 9
    s_add_u32 s71, s70, 262144
    s_add_u32 s71, s71, s60
    s_xor_b32 s60, s60, 268435456
    s_lshl_b32 s72, s2, 7
    s_add_u32 s72, s72, s60
    s_add_u32 s72, s72, 6291456
    s_lshr_b32 s74, s2, 2
    s_lshl_b32 s74, s74, 5
    s_and_b32 s3, s2, 3
    s_add_u32 s74, s74, s3
    s_lshl_b32 s74, s74, 2
    s_add_u32 s74, s74, 10485760
    v_cmp_gt_u32 vcc, 8, v0
    v_lshlrev_b32 v236, 13, v0
    v_mov_b32 v13, 268435456
    s_and_b32 s3, s2, 7
    s_lshl_b32 s3, s3, 13
    s_add_u32 s3, s3, 10485760
    v_lshrrev_b32 v14, 2, v0
    v_lshl_add_u32 v14, v14, 7, s3
    v_lshl_add_u32 v20, v8, 2, v14
    v_cndmask_b32 v236, v13, v236, vcc
    v_mov_b32 v16, 0
    s_lshl_b32 s3, s48, 14
    s_add_u32 s74, s74, s3
    s_add_u32 s73, s74, 8192
    s_waitcnt vmcnt(8)
    v_dot2_f32_bf16 v226, v182, s77, 0
    v_dot2_f32_bf16 v227, v182, v182, 0
    v_dot2_f32_bf16 v226, v183, s77, v226
    v_dot2_f32_bf16 v227, v183, v183, v227
    v_dot2_f32_bf16 v226, v184, s77, v226
    v_dot2_f32_bf16 v227, v184, v184, v227
    v_dot2_f32_bf16 v226, v185, s77, v226
    v_dot2_f32_bf16 v227, v185, v185, v227
    s_waitcnt vmcnt(7)
    v_dot2_f32_bf16 v226, v186, s77, v226
    v_dot2_f32_bf16 v227, v186, v186, v227
    v_dot2_f32_bf16 v226, v187, s77, v226
    v_dot2_f32_bf16 v227, v187, v187, v227
    v_dot2_f32_bf16 v226, v188, s77, v226
    v_dot2_f32_bf16 v227, v188, v188, v227
    v_dot2_f32_bf16 v226, v189, s77, v226
    v_dot2_f32_bf16 v227, v189, v189, v227
    buffer_load_dword v12, v16, s[44:47], 0 offen sc1
    v_lshlrev_b32 v190, 16, v182
    v_and_b32 v191, 0xffff0000, v182
    v_add_f32_dpp v226, v226, v226 quad_perm:[1,0,3,2] row_mask:0xf bank_mask:0xf
    v_add_f32_dpp v227, v227, v227 quad_perm:[1,0,3,2] row_mask:0xf bank_mask:0xf
    v_lshlrev_b32 v192, 16, v183
    v_add_f32_dpp v226, v226, v226 quad_perm:[2,3,0,1] row_mask:0xf bank_mask:0xf
    v_add_f32_dpp v227, v227, v227 quad_perm:[2,3,0,1] row_mask:0xf bank_mask:0xf
    v_and_b32 v193, 0xffff0000, v183
    v_add_f32_dpp v226, v226, v226 row_half_mirror row_mask:0xf bank_mask:0xf
    v_add_f32_dpp v227, v227, v227 row_half_mirror row_mask:0xf bank_mask:0xf
    v_lshlrev_b32 v194, 16, v184
    v_add_f32_dpp v226, v226, v226 row_mirror row_mask:0xf bank_mask:0xf
    v_add_f32_dpp v227, v227, v227 row_mirror row_mask:0xf bank_mask:0xf
    v_and_b32 v195, 0xffff0000, v184
    v_mov_b32 v228, v226
    v_mov_b32 v229, v227
    v_lshlrev_b32 v196, 16, v185
    v_permlane16_swap_b32 v226, v228
    v_permlane16_swap_b32 v227, v229
    v_add_f32 v226, v226, v228
    v_add_f32 v227, v227, v229
    v_mul_f32_e64 v226, -v226, s76
    v_mul_f32 v228, v226, v226
    v_fma_f32 v227, v227, s76, -v228
    v_max_f32 v227, 0, v227
    v_add_f32 v228, s75, v227
    v_rsq_f32 v222, v228
    v_and_b32 v197, 0xffff0000, v185
    v_mul_f32 v228, v222, v222
    v_fma_f32 v229, v228, v227, s75
    v_rsq_f32 v228, v229
    v_mul_f32 v223, v226, v222
    v_mul_f32 v224, v222, v228
    v_mul_f32 v225, v223, v228
    v_mul_f32 v229, v229, v228
    ds_write_b32 v232, v229
    v_lshlrev_b32 v198, 16, v186
    v_and_b32 v199, 0xffff0000, v186
    v_lshlrev_b32 v200, 16, v187
    v_and_b32 v201, 0xffff0000, v187
    v_lshlrev_b32 v202, 16, v188
    v_and_b32 v203, 0xffff0000, v188
    v_lshlrev_b32 v204, 16, v189
    v_and_b32 v205, 0xffff0000, v189
    v_pk_fma_f32 v[206:207], v[190:191], v[224:225], v[224:225] op_sel:[0,0,1] op_sel_hi:[1,0,1]
    v_pk_fma_f32 v[208:209], v[192:193], v[224:225], v[224:225] op_sel:[0,0,1] op_sel_hi:[1,0,1]
    v_pk_fma_f32 v[210:211], v[194:195], v[224:225], v[224:225] op_sel:[0,0,1] op_sel_hi:[1,0,1]
    v_pk_fma_f32 v[212:213], v[196:197], v[224:225], v[224:225] op_sel:[0,0,1] op_sel_hi:[1,0,1]
    v_cvt_pk_bf16_f32 v182, v206, v207
    v_cvt_pk_bf16_f32 v183, v208, v209
    v_cvt_pk_bf16_f32 v184, v210, v211
    v_cvt_pk_bf16_f32 v185, v212, v213
    ds_write_b128 v230, v[182:185] offset:0
    v_pk_fma_f32 v[214:215], v[198:199], v[224:225], v[224:225] op_sel:[0,0,1] op_sel_hi:[1,0,1]
    v_pk_fma_f32 v[216:217], v[200:201], v[224:225], v[224:225] op_sel:[0,0,1] op_sel_hi:[1,0,1]
    v_pk_fma_f32 v[218:219], v[202:203], v[224:225], v[224:225] op_sel:[0,0,1] op_sel_hi:[1,0,1]
    v_pk_fma_f32 v[220:221], v[204:205], v[224:225], v[224:225] op_sel:[0,0,1] op_sel_hi:[1,0,1]
    v_cvt_pk_bf16_f32 v186, v214, v215
    v_cvt_pk_bf16_f32 v187, v216, v217
    v_cvt_pk_bf16_f32 v188, v218, v219
    v_cvt_pk_bf16_f32 v189, v220, v221
    ds_write_b128 v230, v[186:189] offset:448
    s_waitcnt lgkmcnt(0)
    s_barrier
    ds_read_b64_tr_b16 v[110:111], v231 offset:0
    ds_read_b64_tr_b16 v[112:113], v231 offset:3840
    ds_read_b64_tr_b16 v[114:115], v231 offset:128
    ds_read_b64_tr_b16 v[116:117], v231 offset:3968
    ds_read_b32 v229, v237
    s_waitcnt lgkmcnt(3)
    buffer_store_dwordx4 v[110:113], v233, s[28:31], s70 offen sc1
    s_waitcnt lgkmcnt(1)
    buffer_store_dwordx4 v[114:117], v233, s[28:31], s71 offen sc1
    v_cmp_gt_u32 vcc, 16, v1
    s_waitcnt lgkmcnt(0)
    s_nop 0
    v_cndmask_b32 v229, 0, v229, vcc
    buffer_store_dword v229, v238, s[28:31], s72 offen sc1
    s_add_u32 m0, s58, 16384
    s_add_u32 s0, s0, 458752
    s_cmp_eq_u32 s0, 3670016
    s_cselect_b32 s0, 0, s0
    buffer_load_dwordx4 v55, s[20:23], s0 offen lds
    buffer_load_dwordx4 v56, s[20:23], s0 offen offset:1024 lds
    buffer_load_dwordx4 v57, s[20:23], s0 offen offset:2048 lds
    buffer_load_dwordx4 v58, s[20:23], s0 offen offset:3072 lds
    s_branch L_anchor
.p2align 12
L_anchor:
    s_mov_b32 s18, 401408
    s_mov_b32 s19, 0x20000
    s_mov_b32 s26, 7340032
    s_mov_b32 s27, 0x20000
    s_mov_b32 s34, 1835008
    s_mov_b32 s35, 0x20000
    s_mov_b32 s36, 1
    v_lshrrev_b32 v14, 2, v1
    v_lshlrev_b32 v14, 7, v14
    v_lshl_add_u32 v14, v8, 3, v14
    v_and_b32 v15, 3, v5
    v_lshl_add_u32 v14, v15, 5, v14
    s_mul_i32 s3, s4, 8256
    v_xor_b32 v31, s3, v14
    v_xor_b32 v32, 32, v31
    v_xor_b32 v33, 64, v31
    v_xor_b32 v34, 96, v31
    v_add_u32 v35, 65536, v31
    v_add_u32 v36, 65536, v32
    v_add_u32 v37, 65536, v33
    v_add_u32 v38, 65536, v34
    v_add_u32 v39, 131072, v31
    v_add_u32 v40, 131072, v32
    v_add_u32 v41, 131072, v33
    v_add_u32 v42, 131072, v34
    s_lshl_b32 s6, s52, 1
    s_add_u32 s6, s6, s5
    s_lshl_b32 s3, s6, 1
    s_add_u32 s3, s3, s59
    s_lshl_b32 s3, s3, 4
    s_add_u32 s3, s3, s4
    s_lshl_b32 s3, s3, 12
    v_lshl_add_u32 v78, v3, 8, v4
    v_add_u32 v78, s3, v78
    s_xor_b32 s37, s51, 1
    s_lshl_b32 s37, s37, 3
    s_add_u32 s37, s37, s52
    s_lshl_b32 s3, s37, 14
    s_add_u32 s3, s3, s58
    s_add_u32 s3, s3, 16777216
    v_add_u32 v23, s3, v4
    s_lshl_b32 s37, s37, 5
    s_add_u32 s37, s37, s5
    s_lshl_b32 s37, s37, 2
    s_add_u32 s37, s37, 6422528
    s_mul_i32 s67, s6, 56
    s_lshl_b32 s3, s51, 1
    s_add_u32 s3, s3, s4
    s_add_u32 s67, s67, s3
    s_lshl_b32 s67, s67, 11
    s_add_u32 s67, s67, 2097152
    v_add_u32 v81, s58, v4
    s_lshl_b32 s68, s52, 2
    s_and_b32 s3, s51, 1
    s_add_u32 s68, s68, s3
    s_cmp_ge_u32 s51, 14
    s_cselect_b32 s3, 2, 0
    s_add_u32 s68, s68, s3
    s_lshl_b32 s68, s68, 7
    s_add_u32 s68, s68, 6356992
    s_waitcnt vmcnt(7)
    v_readfirstlane_b32 s57, v12
    s_mov_b32 s60, 0
    s_cmp_lg_u32 s57, 0
    s_cbranch_scc0 L_nonce
L_nonce_ok:
    s_waitcnt vmcnt(4)
    s_barrier
    s_atomic_swap s57, s[28:29], s74
    s_atomic_swap s57, s[28:29], s73
    buffer_load_dwordx4 v[96:99], v85, s[8:11], 0 offen
    buffer_load_ushort v93, v82, s[40:43], 0 offen offset:0
    buffer_load_dwordx4 v[100:103], v86, s[8:11], 0 offen
    buffer_load_ushort v94, v82, s[40:43], 0 offen offset:16
    v_add_u32 v53, 65536, v4
    s_add_u32 m0, s58, 32768
    s_add_u32 s0, s0, 458752
    s_cmp_eq_u32 s0, 3670016
    s_cselect_b32 s0, 0, s0
    buffer_load_dwordx4 v55, s[20:23], s0 offen lds
    v_add_u32 v54, 131072, v4
    s_mul_i32 s59, s48, 3072
    s_mul_i32 s3, s50, 86016
    s_add_u32 s3, s3, s59
    s_add_u32 s3, s3, 8388608
    v_add_u32 v80, s3, v4
    v_lshlrev_b32 v14, 7, v9
    v_xor_b32 v14, v14, v4
    s_lshl_b32 s3, s49, 11
    v_add_u32 v67, s3, v14
    v_add_u32 v68, 129024, v67
    s_lshr_b32 s3, s49, 2
    s_lshl_b32 s3, s3, 3
    s_max_u32 s3, s3, 1
    s_sub_u32 s3, s3, 1
    s_lshl_b32 s3, s3, 10
    s_lshl_b32 s6, s5, 17
    s_add_u32 s3, s3, s6
    s_lshl_b32 s6, s4, 28
    s_add_u32 s3, s3, s6
    v_add_u32 v69, s3, v14
    buffer_load_dwordx4 v56, s[20:23], s0 offen offset:1024 lds
    s_lshl_b32 s100, s5, 1
    s_add_u32 s100, s100, s4
    s_lshl_b32 s100, s100, 10
    v_and_b32 v14, 1, v1
    v_mul_u32_u24 v14, 640, v14
    v_lshrrev_b32 v15, 2, v1
    v_lshlrev_b32 v15, 4, v15
    v_xor_b32 v14, v14, v15
    v_bfe_u32 v15, v1, 1, 1
    v_lshl_add_u32 v14, v15, 3, v14
    buffer_load_dwordx4 v57, s[20:23], s0 offen offset:2048 lds
    s_add_u32 s3, s58, 12288
    v_add_u32 v70, s3, v14
    s_sub_u32 s3, s3, 3072
    s_cmp_eq_u32 s48, 0
    s_cselect_b32 s3, 28672, s3
    v_add_u32 v71, s3, v14
    v_add_u32 v72, 65536, v70
    v_add_u32 v73, 65536, v71
    v_add_u32 v74, 131072, v70
    v_add_u32 v75, 131072, v71
    s_lshl_b32 s3, s49, 1
    v_min_u32 v14, 2, v3
    v_add_u32 v14, s3, v14
    v_max_u32 v14, 1, v14
    v_lshlrev_b32 v14, 1, v14
    v_and_b32 v15, 1, v7
    buffer_load_dwordx4 v58, s[20:23], s0 offen offset:3072 lds
    v_add_lshl_u32 v14, v14, v15, 7
    v_lshrrev_b32 v15, 1, v7
    v_lshl_add_u32 v15, v15, 2, v8
    v_lshl_add_u32 v14, v15, 2, v14
    v_add_u32 v77, 6291200, v14
    s_min_u32 s15, s48, 2
    s_lshl_b32 s15, s15, 6
    s_add_u32 s15, s15, 64
    s_lshl_b32 s82, s49, 5
    s_add_u32 s82, s82, s50
    s_lshl_b32 s82, s82, 10
    s_add_u32 s82, s82, 4194304
    s_lshr_b32 s69, s49, 2
    s_lshl_b32 s69, s69, 1
    s_and_b32 s3, s50, 1
    s_add_u32 s69, s69, s3
    s_lshl_b32 s69, s69, 7
    s_add_u32 s69, s69, 6361088
    s_and_b32 s7, s53, 1
    s_mul_i32 s3, s7, 28
    s_add_u32 s3, s3, s48
    s_lshl_b32 s3, s3, 17
    s_xor_b32 s6, s53, 1
    s_lshl_b32 s55, s6, 3
    s_lshl_b32 s6, s53, 7
    s_add_u32 s3, s3, s6
    v_lshlrev_b32 v14, 12, v5
    s_add_u32 m0, s58, 49152
    s_add_u32 s0, s0, 458752
    s_cmp_eq_u32 s0, 3670016
    s_cselect_b32 s0, 0, s0
    buffer_load_dwordx4 v55, s[20:23], s0 offen lds
    v_add3_u32 v59, v14, v83, s3
    v_add_u32 v60, 31744, v59
    v_add_u32 v61, 63488, v59
    v_add_u32 v62, 95232, v59
    v_mul_u32_u24 v14, 896, v5
    s_mul_i32 s3, s4, 25088
    s_mul_i32 s6, s5, 14336
    s_add_u32 s3, s3, s6
    s_lshl_b32 s6, s54, 7
    s_add_u32 s3, s3, s6
    v_add3_u32 v63, v14, v83, s3
    buffer_load_dwordx4 v56, s[20:23], s0 offen offset:1024 lds
    v_add_u32 v64, 6144, v63
    s_lshl_b32 s6, s53, 1
    s_add_u32 s6, s6, s5
    s_and_b32 s3, s53, 30
    s_add_u32 s3, s3, s4
    s_lshl_b32 s3, s3, 7
    s_add_u32 s39, s3, 6361088
    s_lshl_b32 s3, s6, 5
    s_add_u32 s3, s3, s4
    s_lshl_b32 s3, s3, 10
    s_add_u32 s3, s3, 4194304
    v_add_u32 v65, s3, v4
    v_add_u32 v66, 15360, v65
    s_xor_b32 s3, s4, s5
    s_lshl_b32 s3, s3, 6
    v_xor_b32 v43, s3, v31
    buffer_load_dwordx4 v57, s[20:23], s0 offen offset:2048 lds
    v_xor_b32 v44, 32, v43
    v_add_u32 v45, 65536, v43
    v_add_u32 v46, 65536, v44
    s_mul_i32 s3, s4, 12288
    v_add_u32 v47, s3, v4
    v_xor_b32 v48, 4096, v47
    v_add_u32 v49, 65536, v47
    v_add_u32 v50, 65536, v48
    v_add_u32 v51, 131072, v47
    v_add_u32 v52, 131072, v48
    s_lshl_b32 s6, s54, 1
    s_add_u32 s6, s6, s5
    s_lshl_b32 s3, s6, 1
    s_add_u32 s3, s3, s7
    s_mul_i32 s3, s3, 14
    s_add_u32 s3, s3, s4
    s_lshl_b32 s3, s3, 12
    s_add_u32 s3, s3, 2097152
    v_add_u32 v79, s3, v4
    buffer_load_dwordx4 v58, s[20:23], s0 offen offset:3072 lds
    s_lshl_b32 s3, s54, 1
    s_add_u32 s3, s3, s7
    s_lshl_b32 s3, s3, 1
    s_add_u32 s3, s3, s4
    s_lshl_b32 s3, s3, 7
    s_add_u32 s38, s3, 6356992
    s_and_b32 s3, s2, 6
    s_add_u32 s3, s3, s54
    s_sub_u32 s6, s3, 7
    s_cmp_ge_u32 s3, 7
    s_cselect_b32 s3, s6, s3
    s_lshl_b32 s64, s3, 19
    s_lshl_b32 s65, s3, 13
    s_add_u32 s55, s55, s54
    s_lshl_b32 s3, s55, 14
    s_add_u32 s3, s3, s58
    s_add_u32 s3, s3, 12582912
    v_add_u32 v21, s3, v4
    s_add_u32 m0, s58, 65536
    s_add_u32 s0, s0, 458752
    s_cmp_eq_u32 s0, 3670016
    s_cselect_b32 s0, 0, s0
    buffer_load_dwordx4 v55, s[20:23], s0 offen lds
    s_lshl_b32 s55, s55, 5
    s_add_u32 s55, s55, s48
    s_lshl_b32 s55, s55, 2
    s_add_u32 s55, s55, 6488064
    s_lshl_b32 s3, s5, 3
    v_add_u32 v13, s3, v3
    v_xor_b32 v13, v13, v6
    v_lshlrev_b32 v13, 4, v13
    v_lshl_add_u32 v13, v2, 8, v13
    buffer_load_dwordx4 v56, s[20:23], s0 offen offset:1024 lds
    s_lshl_b32 s3, s4, 14
    s_add_u32 s3, s3, 131072
    v_add_u32 v87, s3, v13
    v_xor_b32 v88, 64, v87
    s_lshr_b32 s3, s53, 1
    s_add_u32 s66, s3, s54
    v_lshlrev_b32 v13, 1, v6
    v_xor_b32 v13, v13, v5
    v_lshlrev_b32 v13, 4, v13
    v_lshl_add_u32 v13, v5, 8, v13
    s_add_u32 s3, s58, 131072
    v_add_u32 v89, s3, v13
    v_xor_b32 v90, 16, v89
    v_xor_b32 v91, 24576, v89
    v_xor_b32 v92, 24592, v89
    v_lshlrev_b32 v150, 16, v246
    buffer_load_dwordx4 v57, s[20:23], s0 offen offset:2048 lds
    v_and_b32 v151, 0xffff0000, v246
    v_lshlrev_b32 v152, 16, v247
    v_and_b32 v153, 0xffff0000, v247
    v_lshlrev_b32 v154, 16, v248
    v_and_b32 v155, 0xffff0000, v248
    v_lshlrev_b32 v156, 16, v249
    v_and_b32 v157, 0xffff0000, v249
    v_lshlrev_b32 v158, 16, v246
    v_and_b32 v159, 0xffff0000, v246
    v_lshlrev_b32 v160, 16, v247
    v_and_b32 v161, 0xffff0000, v247
    v_lshlrev_b32 v162, 16, v248
    v_and_b32 v163, 0xffff0000, v248
    v_lshlrev_b32 v164, 16, v249
    v_and_b32 v165, 0xffff0000, v249
    buffer_load_dwordx4 v58, s[20:23], s0 offen offset:3072 lds
    s_add_u32 m0, s58, 81920
    s_add_u32 s0, s0, 458752
    s_cmp_eq_u32 s0, 3670016
    s_cselect_b32 s0, 0, s0
    buffer_load_dwordx4 v55, s[20:23], s0 offen lds
    buffer_load_dwordx4 v56, s[20:23], s0 offen offset:1024 lds
    buffer_load_dwordx4 v57, s[20:23], s0 offen offset:2048 lds
    buffer_load_dwordx4 v58, s[20:23], s0 offen offset:3072 lds
    buffer_load_dword v18, v20, s[28:31], 0 offen sc1
    s_add_u32 m0, s58, 98304
    s_add_u32 s0, s0, 458752
    s_cmp_eq_u32 s0, 3670016
    s_cselect_b32 s0, 0, s0
    buffer_load_dwordx4 v55, s[20:23], s0 offen lds
    buffer_load_dwordx4 v56, s[20:23], s0 offen offset:1024 lds
    buffer_load_dwordx4 v57, s[20:23], s0 offen offset:2048 lds
    buffer_load_dwordx4 v58, s[20:23], s0 offen offset:3072 lds
    s_add_u32 m0, s58, 114688
    s_add_u32 s0, s0, 458752
    s_cmp_eq_u32 s0, 3670016
    s_cselect_b32 s0, 0, s0
    buffer_load_dwordx4 v55, s[20:23], s0 offen lds
    buffer_load_dwordx4 v56, s[20:23], s0 offen offset:1024 lds
    buffer_load_dwordx4 v57, s[20:23], s0 offen offset:2048 lds
    buffer_load_dwordx4 v58, s[20:23], s0 offen offset:3072 lds
    s_mov_b32 s3, s48
    s_mov_b64 exec, 0
L_warm:
    s_add_u32 s3, s3, 4
    s_cmp_eq_u32 s3, 4
    s_cbranch_scc1 L_pad0
    s_cmp_eq_u32 s3, 5
    s_cbranch_scc1 L_pad1
    s_cmp_eq_u32 s3, 6
    s_cbranch_scc1 L_pad2
    s_cmp_eq_u32 s3, 7
    s_cbranch_scc1 L_pad3
    s_cmp_eq_u32 s3, 8
    s_cbranch_scc1 L_pad4
    s_cmp_eq_u32 s3, 9
    s_nop 0
    s_mov_b64 exec, -1
    s_waitcnt vmcnt(8)
    v_cmp_ne_u32 vcc, s57, v18
    s_cbranch_vccnz L_pollin0
L_pollok0:
    s_barrier
    buffer_load_dwordx4 a[0:3], v78, s[28:31], s1 offen offset:0 sc1
    buffer_load_dwordx4 a[4:7], v78, s[28:31], s1 offen offset:256 sc1
    buffer_load_dwordx4 a[8:11], v78, s[28:31], s1 offen offset:2048 sc1
    buffer_load_dwordx4 a[12:15], v78, s[28:31], s1 offen offset:2304 sc1
    buffer_load_dword v76, v77, s[28:31], 0 offen sc1
    s_add_u32 s1, s1, 8192
    s_and_b32 s1, s1, 0xffff
    buffer_load_dwordx4 a[16:19], v78, s[28:31], s1 offen offset:0 sc1
    buffer_load_dwordx4 a[20:23], v78, s[28:31], s1 offen offset:256 sc1
    buffer_load_dwordx4 a[24:27], v78, s[28:31], s1 offen offset:2048 sc1
    buffer_load_dwordx4 a[28:31], v78, s[28:31], s1 offen offset:2304 sc1
    s_add_u32 s1, s1, 8192
    s_and_b32 s1, s1, 0xffff
    buffer_load_dwordx4 a[32:35], v78, s[28:31], s1 offen offset:0 sc1
    buffer_load_dwordx4 a[36:39], v78, s[28:31], s1 offen offset:256 sc1
    buffer_load_dwordx4 a[40:43], v78, s[28:31], s1 offen offset:2048 sc1
    buffer_load_dwordx4 a[44:47], v78, s[28:31], s1 offen offset:2304 sc1
    ds_read_b64_tr_b16 a[200:201], v31 offset:0
    ds_read_b64_tr_b16 a[202:203], v31 offset:2048
    ds_read_b64_tr_b16 a[204:205], v33 offset:0
    ds_read_b64_tr_b16 a[206:207], v33 offset:2048
    ds_read_b64_tr_b16 a[208:209], v32 offset:0
    ds_read_b64_tr_b16 a[210:211], v32 offset:2048
    ds_read_b64_tr_b16 a[212:213], v34 offset:0
    ds_read_b64_tr_b16 a[214:215], v34 offset:2048
    ds_read_b64_tr_b16 a[216:217], v31 offset:4096
    ds_read_b64_tr_b16 a[218:219], v31 offset:6144
    ds_read_b64_tr_b16 a[220:221], v33 offset:4096
    ds_read_b64_tr_b16 a[222:223], v33 offset:6144
    s_waitcnt vmcnt(11) lgkmcnt(8)
    v_mfma_f32_16x16x32_bf16 v[182:185], a[200:203], a[0:3], 0
    ds_read_b64_tr_b16 a[224:225], v32 offset:4096
    s_add_u32 s1, s1, 8192
    v_mfma_f32_16x16x32_bf16 v[190:193], a[200:203], a[4:7], 0
    ds_read_b64_tr_b16 a[226:227], v32 offset:6144
    s_and_b32 s1, s1, 0xffff
    s_mov_b32 s70, 0xaaaaaaaa
    s_mov_b32 s71, 0xaaaaaaaa
    s_mov_b32 s72, 0xfff0ffff
    s_mov_b32 s73, 0xf000ff00
    s_mov_b32 s74, 0xffc0fffc
    v_mfma_f32_16x16x32_bf16 v[198:201], a[204:207], a[0:3], 0
    ds_read_b64_tr_b16 a[228:229], v34 offset:4096
    buffer_load_dwordx4 a[48:51], v78, s[28:31], s1 offen offset:0 sc1
    v_mfma_f32_16x16x32_bf16 v[206:209], a[204:207], a[4:7], 0
    ds_read_b64_tr_b16 a[230:231], v34 offset:6144
    s_mov_b32 s75, 0xc000fc00
    s_waitcnt lgkmcnt(8)
    v_mfma_f32_16x16x32_bf16 v[186:189], a[208:211], a[0:3], 0
    ds_read_b64_tr_b16 a[200:201], v31 offset:16384
    s_mov_b32 s83, 0x3e8b97f6
    v_mfma_f32_16x16x32_bf16 v[194:197], a[208:211], a[4:7], 0
    ds_read_b64_tr_b16 a[202:203], v31 offset:18432
    buffer_load_dwordx4 a[52:55], v78, s[28:31], s1 offen offset:256 sc1
    v_lshlrev_b32 v13, 2, v2
    v_mfma_f32_16x16x32_bf16 v[202:205], a[212:215], a[0:3], 0
    ds_read_b64_tr_b16 a[204:205], v33 offset:16384
    v_and_b32 v14, 1, v1
    v_mfma_f32_16x16x32_bf16 v[210:213], a[212:215], a[4:7], 0
    ds_read_b64_tr_b16 a[206:207], v33 offset:18432
    s_waitcnt vmcnt(11) lgkmcnt(8)
    v_mfma_f32_16x16x32_bf16 v[182:185], a[216:219], a[8:11], v[182:185]
    ds_read_b64_tr_b16 a[208:209], v32 offset:16384
    buffer_load_dwordx4 a[56:59], v78, s[28:31], s1 offen offset:2048 sc1
    v_mfma_f32_16x16x32_bf16 v[190:193], a[216:219], a[12:15], v[190:193]
    ds_read_b64_tr_b16 a[210:211], v32 offset:18432
    v_lshl_add_u32 v14, v3, 2, v14
    v_mfma_f32_16x16x32_bf16 v[198:201], a[220:223], a[8:11], v[198:201]
    ds_read_b64_tr_b16 a[212:213], v34 offset:16384
    v_lshlrev_b32 v14, 2, v14
    v_mfma_f32_16x16x32_bf16 v[206:209], a[220:223], a[12:15], v[206:209]
    ds_read_b64_tr_b16 a[214:215], v34 offset:18432
    s_waitcnt lgkmcnt(8)
    v_mfma_f32_16x16x32_bf16 v[186:189], a[224:227], a[8:11], v[186:189]
    ds_read_b64_tr_b16 a[216:217], v31 offset:20480
    buffer_load_dwordx4 a[60:63], v78, s[28:31], s1 offen offset:2304 sc1
    v_mfma_f32_16x16x32_bf16 v[194:197], a[224:227], a[12:15], v[194:197]
    ds_read_b64_tr_b16 a[218:219], v31 offset:22528
    s_add_u32 s1, s1, 8192
    v_add_u32 v15, 64, v14
    v_mfma_f32_16x16x32_bf16 v[202:205], a[228:231], a[8:11], v[202:205]
    ds_read_b64_tr_b16 a[220:221], v33 offset:20480
    s_and_b32 s1, s1, 0xffff
    v_mfma_f32_16x16x32_bf16 v[210:213], a[228:231], a[12:15], v[210:213]
    ds_read_b64_tr_b16 a[222:223], v33 offset:22528
    s_waitcnt vmcnt(10) lgkmcnt(8)
    v_mfma_f32_16x16x32_bf16 v[182:185], a[200:203], a[16:19], v[182:185]
    ds_read_b64_tr_b16 a[224:225], v32 offset:20480
    buffer_load_dwordx4 a[64:67], v78, s[28:31], s1 offen offset:0 sc1
    v_mfma_f32_16x16x32_bf16 v[190:193], a[200:203], a[20:23], v[190:193]
    ds_read_b64_tr_b16 a[226:227], v32 offset:22528
    v_cndmask_b32 v16, v14, v15, s[72:73]
    v_mfma_f32_16x16x32_bf16 v[198:201], a[204:207], a[16:19], v[198:201]
    ds_read_b64_tr_b16 a[228:229], v34 offset:20480
    buffer_load_dwordx4 a[68:71], v78, s[28:31], s1 offen offset:256 sc1
    v_mfma_f32_16x16x32_bf16 v[206:209], a[204:207], a[20:23], v[206:209]
    ds_read_b64_tr_b16 a[230:231], v34 offset:22528
    v_cndmask_b32 v14, v14, v15, s[74:75]
    s_waitcnt lgkmcnt(8)
    v_mfma_f32_16x16x32_bf16 v[186:189], a[208:211], a[16:19], v[186:189]
    ds_read_b64_tr_b16 a[200:201], v31 offset:32768
    ds_bpermute_b32 v25, v13, v76 offset:64
    v_mfma_f32_16x16x32_bf16 v[194:197], a[208:211], a[20:23], v[194:197]
    ds_read_b64_tr_b16 a[202:203], v31 offset:34816
    buffer_load_dwordx4 a[72:75], v78, s[28:31], s1 offen offset:2048 sc1
    ds_bpermute_b32 v27, v16, v76 offset:0
    v_mfma_f32_16x16x32_bf16 v[202:205], a[212:215], a[16:19], v[202:205]
    ds_read_b64_tr_b16 a[204:205], v33 offset:32768
    ds_bpermute_b32 v28, v14, v76 offset:8
    v_mfma_f32_16x16x32_bf16 v[210:213], a[212:215], a[20:23], v[210:213]
    ds_read_b64_tr_b16 a[206:207], v33 offset:34816
    s_waitcnt vmcnt(11) lgkmcnt(11)
    v_mfma_f32_16x16x32_bf16 v[182:185], a[216:219], a[24:27], v[182:185]
    ds_read_b64_tr_b16 a[208:209], v32 offset:32768
    ds_bpermute_b32 v26, v13, v76 offset:128
    v_mfma_f32_16x16x32_bf16 v[190:193], a[216:219], a[28:31], v[190:193]
    ds_read_b64_tr_b16 a[210:211], v32 offset:34816
    buffer_load_dwordx4 a[76:79], v78, s[28:31], s1 offen offset:2304 sc1
    ds_bpermute_b32 v29, v16, v76 offset:64
    v_mfma_f32_16x16x32_bf16 v[198:201], a[220:223], a[24:27], v[198:201]
    ds_read_b64_tr_b16 a[212:213], v34 offset:32768
    s_add_u32 s1, s1, 8192
    v_mfma_f32_16x16x32_bf16 v[206:209], a[220:223], a[28:31], v[206:209]
    ds_read_b64_tr_b16 a[214:215], v34 offset:34816
    s_waitcnt lgkmcnt(13)
    v_mfma_f32_16x16x32_bf16 v[186:189], a[224:227], a[24:27], v[186:189]
    ds_read_b64_tr_b16 a[216:217], v31 offset:36864
    s_and_b32 s1, s1, 0xffff
    v_mfma_f32_16x16x32_bf16 v[194:197], a[224:227], a[28:31], v[194:197]
    ds_read_b64_tr_b16 a[218:219], v31 offset:38912
    buffer_load_dwordx4 a[80:83], v78, s[28:31], s1 offen offset:0 sc1
    ds_bpermute_b32 v30, v14, v76 offset:72
    v_mfma_f32_16x16x32_bf16 v[202:205], a[228:231], a[24:27], v[202:205]
    ds_read_b64_tr_b16 a[220:221], v33 offset:36864
    v_mfma_f32_16x16x32_bf16 v[210:213], a[228:231], a[28:31], v[210:213]
    ds_read_b64_tr_b16 a[222:223], v33 offset:38912
    s_waitcnt vmcnt(11) lgkmcnt(11)
    v_mfma_f32_16x16x32_bf16 v[182:185], a[200:203], a[32:35], v[182:185]
    ds_read_b64_tr_b16 a[224:225], v32 offset:36864
    buffer_load_dwordx4 a[84:87], v78, s[28:31], s1 offen offset:256 sc1
    v_mfma_f32_16x16x32_bf16 v[190:193], a[200:203], a[36:39], v[190:193]
    ds_read_b64_tr_b16 a[226:227], v32 offset:38912
    v_mfma_f32_16x16x32_bf16 v[198:201], a[204:207], a[32:35], v[198:201]
    ds_read_b64_tr_b16 a[228:229], v34 offset:36864
    v_mfma_f32_16x16x32_bf16 v[206:209], a[204:207], a[36:39], v[206:209]
    ds_read_b64_tr_b16 a[230:231], v34 offset:38912
    s_waitcnt lgkmcnt(9)
    v_mfma_f32_16x16x32_bf16 v[186:189], a[208:211], a[32:35], v[186:189]
    s_barrier
    ds_read_b64_tr_b16 a[200:201], v31 offset:49152
    buffer_load_dwordx4 a[88:91], v78, s[28:31], s1 offen offset:2048 sc1
    v_mfma_f32_16x16x32_bf16 v[194:197], a[208:211], a[36:39], v[194:197]
    ds_read_b64_tr_b16 a[202:203], v31 offset:51200
    v_mfma_f32_16x16x32_bf16 v[202:205], a[212:215], a[32:35], v[202:205]
    ds_read_b64_tr_b16 a[204:205], v33 offset:49152
    buffer_load_dwordx4 a[92:95], v78, s[28:31], s1 offen offset:2304 sc1
    v_mfma_f32_16x16x32_bf16 v[210:213], a[212:215], a[36:39], v[210:213]
    ds_read_b64_tr_b16 a[206:207], v33 offset:51200
    s_waitcnt vmcnt(12) lgkmcnt(8)
    v_mfma_f32_16x16x32_bf16 v[182:185], a[216:219], a[40:43], v[182:185]
    ds_read_b64_tr_b16 a[208:209], v32 offset:49152
    s_add_u32 m0, s58, 131072
    v_mfma_f32_16x16x32_bf16 v[190:193], a[216:219], a[44:47], v[190:193]
    ds_read_b64_tr_b16 a[210:211], v32 offset:51200
    s_add_u32 s0, s0, 458752
    v_mul_f32 v25, s83, v25
    v_mfma_f32_16x16x32_bf16 v[198:201], a[220:223], a[40:43], v[198:201]
    ds_read_b64_tr_b16 a[212:213], v34 offset:49152
    s_cmp_eq_u32 s0, 3670016
    v_mfma_f32_16x16x32_bf16 v[206:209], a[220:223], a[44:47], v[206:209]
    ds_read_b64_tr_b16 a[214:215], v34 offset:51200
    s_cselect_b32 s0, 0, s0
    v_xor_b32 v55, 128, v55
    buffer_load_dwordx4 v55, s[20:23], s0 offen lds
    s_waitcnt lgkmcnt(8)
    v_mfma_f32_16x16x32_bf16 v[186:189], a[224:227], a[40:43], v[186:189]
    ds_read_b64_tr_b16 a[216:217], v31 offset:53248
    v_xor_b32 v56, 128, v56
    v_mfma_f32_16x16x32_bf16 v[194:197], a[224:227], a[44:47], v[194:197]
    ds_read_b64_tr_b16 a[218:219], v31 offset:55296
    buffer_load_dwordx4 v56, s[20:23], s0 offen offset:1024 lds
    v_mul_f32 v26, s83, v26
    v_mfma_f32_16x16x32_bf16 v[202:205], a[228:231], a[40:43], v[202:205]
    ds_read_b64_tr_b16 a[220:221], v33 offset:53248
    v_xor_b32 v57, 128, v57
    v_mfma_f32_16x16x32_bf16 v[210:213], a[228:231], a[44:47], v[210:213]
    ds_read_b64_tr_b16 a[222:223], v33 offset:55296
    s_waitcnt vmcnt(12) lgkmcnt(8)
    v_mfma_f32_16x16x32_bf16 v[182:185], a[200:203], a[48:51], v[182:185]
    ds_read_b64_tr_b16 a[224:225], v32 offset:53248
    buffer_load_dwordx4 v57, s[20:23], s0 offen offset:2048 lds
    v_mfma_f32_16x16x32_bf16 v[190:193], a[200:203], a[52:55], v[190:193]
    ds_read_b64_tr_b16 a[226:227], v32 offset:55296
    v_xor_b32 v58, 128, v58
    s_cmp_eq_u32 s49, 0
    s_cselect_b64 s[76:77], 0, -1
    v_mfma_f32_16x16x32_bf16 v[198:201], a[204:207], a[48:51], v[198:201]
    ds_read_b64_tr_b16 a[228:229], v34 offset:53248
    v_mov_b32 v13, 0xffff
    v_mfma_f32_16x16x32_bf16 v[206:209], a[204:207], a[52:55], v[206:209]
    ds_read_b64_tr_b16 a[230:231], v34 offset:55296
    s_waitcnt lgkmcnt(8)
    v_mfma_f32_16x16x32_bf16 v[186:189], a[208:211], a[48:51], v[186:189]
    ds_read_b64_tr_b16 a[200:201], v35 offset:0
    buffer_load_dwordx4 v58, s[20:23], s0 offen offset:3072 lds
    v_mfma_f32_16x16x32_bf16 v[194:197], a[208:211], a[52:55], v[194:197]
    ds_read_b64_tr_b16 a[202:203], v35 offset:2048
    s_add_u32 s1, s1, 8192
    v_mov_b32 v14, 0xffff0000
    v_mfma_f32_16x16x32_bf16 v[202:205], a[212:215], a[48:51], v[202:205]
    ds_read_b64_tr_b16 a[204:205], v37 offset:0
    s_and_b32 s1, s1, 0xffff
    v_mfma_f32_16x16x32_bf16 v[210:213], a[212:215], a[52:55], v[210:213]
    ds_read_b64_tr_b16 a[206:207], v37 offset:2048
    v_cndmask_b32 v13, v13, v14, s[70:71]
    s_waitcnt vmcnt(12) lgkmcnt(8)
    v_mfma_f32_16x16x32_bf16 v[182:185], a[216:219], a[56:59], v[182:185]
    ds_read_b64_tr_b16 a[208:209], v36 offset:0
    buffer_load_dwordx4 a[96:99], v78, s[28:31], s1 offen offset:0 sc1
    v_mfma_f32_16x16x32_bf16 v[190:193], a[216:219], a[60:63], v[190:193]
    ds_read_b64_tr_b16 a[210:211], v36 offset:2048
    v_cndmask_b32 v104, v13, 0, s[72:73]
    v_mfma_f32_16x16x32_bf16 v[198:201], a[220:223], a[56:59], v[198:201]
    ds_read_b64_tr_b16 a[212:213], v38 offset:0
    buffer_load_dwordx4 a[100:103], v78, s[28:31], s1 offen offset:256 sc1
    v_mfma_f32_16x16x32_bf16 v[206:209], a[220:223], a[60:63], v[206:209]
    ds_read_b64_tr_b16 a[214:215], v38 offset:2048
    v_cndmask_b32 v106, 0, v13, s[72:73]
    s_waitcnt lgkmcnt(8)
    v_mfma_f32_16x16x32_bf16 v[186:189], a[224:227], a[56:59], v[186:189]
    ds_read_b64_tr_b16 a[216:217], v35 offset:4096
    v_cndmask_b32 v105, v13, 0, s[74:75]
    v_mfma_f32_16x16x32_bf16 v[194:197], a[224:227], a[60:63], v[194:197]
    ds_read_b64_tr_b16 a[218:219], v35 offset:6144
    buffer_load_dwordx4 a[104:107], v78, s[28:31], s1 offen offset:2048 sc1
    v_cndmask_b32 v107, 0, v13, s[74:75]
    v_mfma_f32_16x16x32_bf16 v[202:205], a[228:231], a[56:59], v[202:205]
    ds_read_b64_tr_b16 a[220:221], v37 offset:4096
    v_mov_b32 v84, 0xf149f2ca
    v_mfma_f32_16x16x32_bf16 v[210:213], a[228:231], a[60:63], v[210:213]
    ds_read_b64_tr_b16 a[222:223], v37 offset:6144
    s_waitcnt vmcnt(13) lgkmcnt(8)
    v_mfma_f32_16x16x32_bf16 v[182:185], a[200:203], a[64:67], v[182:185]
    ds_read_b64_tr_b16 a[224:225], v36 offset:4096
    buffer_load_dwordx4 a[108:111], v78, s[28:31], s1 offen offset:2304 sc1
    v_mfma_f32_16x16x32_bf16 v[190:193], a[200:203], a[68:71], v[190:193]
    ds_read_b64_tr_b16 a[226:227], v36 offset:6144
    s_add_u32 m0, s58, 147456
    s_mov_b32 s83, 0x3e8b97f6
    v_mfma_f32_16x16x32_bf16 v[198:201], a[204:207], a[64:67], v[198:201]
    ds_read_b64_tr_b16 a[228:229], v38 offset:4096
    s_add_u32 s0, s0, 458752
    v_mfma_f32_16x16x32_bf16 v[206:209], a[204:207], a[68:71], v[206:209]
    ds_read_b64_tr_b16 a[230:231], v38 offset:6144
    s_mov_b32 s78, 0xbdd2d3e8
    s_mov_b32 s79, 0xbdd2d3e8
    s_waitcnt lgkmcnt(8)
    v_mfma_f32_16x16x32_bf16 v[186:189], a[208:211], a[64:67], v[186:189]
    s_barrier
    s_load_dword s14, s[44:45], s15
    ds_read_b64_tr_b16 a[200:201], v35 offset:16384
    s_cmp_eq_u32 s0, 3670016
    s_cselect_b32 s0, 0, s0
    buffer_load_dwordx4 v55, s[20:23], s0 offen lds
    v_mfma_f32_16x16x32_bf16 v[194:197], a[208:211], a[68:71], v[194:197]
    ds_read_b64_tr_b16 a[202:203], v35 offset:18432
    s_mov_b32 s80, 1.0
    v_mfma_f32_16x16x32_bf16 v[202:205], a[212:215], a[64:67], v[202:205]
    ds_read_b64_tr_b16 a[204:205], v37 offset:16384
    buffer_load_dwordx4 v56, s[20:23], s0 offen offset:1024 lds
    v_mfma_f32_16x16x32_bf16 v[210:213], a[212:215], a[68:71], v[210:213]
    ds_read_b64_tr_b16 a[206:207], v37 offset:18432
    s_mov_b32 s81, 1.0
    s_waitcnt vmcnt(14) lgkmcnt(8)
    v_mfma_f32_16x16x32_bf16 v[182:185], a[216:219], a[72:75], v[182:185]
    ds_read_b64_tr_b16 a[208:209], v36 offset:16384
    v_mov_b32 v108, 0xc0135761
    v_mfma_f32_16x16x32_bf16 v[190:193], a[216:219], a[76:79], v[190:193]
    ds_read_b64_tr_b16 a[210:211], v36 offset:18432
    buffer_load_dwordx4 v57, s[20:23], s0 offen offset:2048 lds
    v_mov_b32 v109, 0xc0135761
    v_mfma_f32_16x16x32_bf16 v[198:201], a[220:223], a[72:75], v[198:201]
    ds_read_b64_tr_b16 a[212:213], v38 offset:16384
    v_lshrrev_b32 v13, 1, v2
    v_mfma_f32_16x16x32_bf16 v[206:209], a[220:223], a[76:79], v[206:209]
    ds_read_b64_tr_b16 a[214:215], v38 offset:18432
    s_waitcnt lgkmcnt(8)
    v_mfma_f32_16x16x32_bf16 v[186:189], a[224:227], a[72:75], v[186:189]
    ds_read_b64_tr_b16 a[216:217], v35 offset:20480
    buffer_load_dwordx4 v58, s[20:23], s0 offen offset:3072 lds
    v_mfma_f32_16x16x32_bf16 v[194:197], a[224:227], a[76:79], v[194:197]
    ds_read_b64_tr_b16 a[218:219], v35 offset:22528
    s_add_u32 s1, s1, 8192
    v_lshlrev_b32 v14, 1, v3
    v_mfma_f32_16x16x32_bf16 v[202:205], a[228:231], a[72:75], v[202:205]
    ds_read_b64_tr_b16 a[220:221], v37 offset:20480
    s_and_b32 s1, s1, 0xffff
    v_mfma_f32_16x16x32_bf16 v[210:213], a[228:231], a[76:79], v[210:213]
    ds_read_b64_tr_b16 a[222:223], v37 offset:22528
    s_waitcnt vmcnt(14) lgkmcnt(8)
    v_mfma_f32_16x16x32_bf16 v[182:185], a[200:203], a[80:83], v[182:185]
    ds_read_b64_tr_b16 a[224:225], v36 offset:20480
    buffer_load_dwordx4 a[112:115], v78, s[28:31], s1 offen offset:0 sc1
    v_mfma_f32_16x16x32_bf16 v[190:193], a[200:203], a[84:87], v[190:193]
L_pad0:
    s_cbranch_execz L_warm
    ds_read_b64_tr_b16 a[226:227], v36 offset:22528
    v_sub_u32 v13, v13, v14
    v_mfma_f32_16x16x32_bf16 v[198:201], a[204:207], a[80:83], v[198:201]
    ds_read_b64_tr_b16 a[228:229], v38 offset:20480
    buffer_load_dwordx4 a[116:119], v78, s[28:31], s1 offen offset:256 sc1
    v_mfma_f32_16x16x32_bf16 v[206:209], a[204:207], a[84:87], v[206:209]
    ds_read_b64_tr_b16 a[230:231], v38 offset:22528
    v_mov_b32 v14, 0x3f80
    s_waitcnt lgkmcnt(8)
    v_mfma_f32_16x16x32_bf16 v[186:189], a[208:211], a[80:83], v[186:189]
    ds_read_b64_tr_b16 a[200:201], v35 offset:32768
    v_cndmask_b32 v14, v14, 1.0, s[70:71]
    v_mfma_f32_16x16x32_bf16 v[194:197], a[208:211], a[84:87], v[194:197]
    ds_read_b64_tr_b16 a[202:203], v35 offset:34816
    buffer_load_dwordx4 a[120:123], v78, s[28:31], s1 offen offset:2048 sc1
    v_cmp_eq_i32 vcc, 0, v13
    v_mfma_f32_16x16x32_bf16 v[202:205], a[212:215], a[80:83], v[202:205]
    ds_read_b64_tr_b16 a[204:205], v37 offset:32768
    v_accvgpr_write_b32 a248, 0
    v_mfma_f32_16x16x32_bf16 v[210:213], a[212:215], a[84:87], v[210:213]
    ds_read_b64_tr_b16 a[206:207], v37 offset:34816
    s_waitcnt vmcnt(15) lgkmcnt(8)
    v_mfma_f32_16x16x32_bf16 v[182:185], a[216:219], a[88:91], v[182:185]
    ds_read_b64_tr_b16 a[208:209], v36 offset:32768
    buffer_load_dwordx4 a[124:127], v78, s[28:31], s1 offen offset:2304 sc1
    v_mfma_f32_16x16x32_bf16 v[190:193], a[216:219], a[92:95], v[190:193]
    ds_read_b64_tr_b16 a[210:211], v36 offset:34816
    s_add_u32 m0, s58, 0
    v_accvgpr_write_b32 a252, 0
    v_mfma_f32_16x16x32_bf16 v[198:201], a[220:223], a[88:91], v[198:201]
    ds_read_b64_tr_b16 a[212:213], v38 offset:32768
    s_add_u32 s0, s0, 458752
    v_mfma_f32_16x16x32_bf16 v[206:209], a[220:223], a[92:95], v[206:209]
    ds_read_b64_tr_b16 a[214:215], v38 offset:34816
    s_waitcnt lgkmcnt(8)
    v_mfma_f32_16x16x32_bf16 v[186:189], a[224:227], a[88:91], v[186:189]
    ds_read_b64_tr_b16 a[216:217], v35 offset:36864
    s_cmp_eq_u32 s0, 3670016
    v_mfma_f32_16x16x32_bf16 v[194:197], a[224:227], a[92:95], v[194:197]
    ds_read_b64_tr_b16 a[218:219], v35 offset:38912
    s_cselect_b32 s0, 0, s0
    buffer_load_dwordx4 v55, s[20:23], s0 offen lds
    v_cndmask_b32 v15, 0, v14, vcc
    v_mfma_f32_16x16x32_bf16 v[202:205], a[228:231], a[88:91], v[202:205]
    ds_read_b64_tr_b16 a[220:221], v37 offset:36864
    v_accvgpr_write_b32 a250, v15
    v_mfma_f32_16x16x32_bf16 v[210:213], a[228:231], a[92:95], v[210:213]
    ds_read_b64_tr_b16 a[222:223], v37 offset:38912
    s_waitcnt vmcnt(11) lgkmcnt(8)
    v_mfma_f32_16x16x32_bf16 v[182:185], a[200:203], a[96:99], v[182:185]
    ds_read_b64_tr_b16 a[224:225], v36 offset:36864
    buffer_load_dwordx4 v56, s[20:23], s0 offen offset:1024 lds
    v_mfma_f32_16x16x32_bf16 v[190:193], a[200:203], a[100:103], v[190:193]
    ds_read_b64_tr_b16 a[226:227], v36 offset:38912
    v_cmp_eq_i32 vcc, 1, v13
    v_mfma_f32_16x16x32_bf16 v[198:201], a[204:207], a[96:99], v[198:201]
    ds_read_b64_tr_b16 a[228:229], v38 offset:36864
    buffer_load_dwordx4 v57, s[20:23], s0 offen offset:2048 lds
    v_mfma_f32_16x16x32_bf16 v[206:209], a[204:207], a[100:103], v[206:209]
    ds_read_b64_tr_b16 a[230:231], v38 offset:38912
    v_accvgpr_write_b32 a249, 0
    s_waitcnt lgkmcnt(8)
    v_mfma_f32_16x16x32_bf16 v[186:189], a[208:211], a[96:99], v[186:189]
    s_waitcnt vmcnt(7)
    s_barrier
    ds_read_b64_tr_b16 a[200:201], v35 offset:49152
    buffer_load_dwordx4 v58, s[20:23], s0 offen offset:3072 lds
    v_mfma_f32_16x16x32_bf16 v[194:197], a[208:211], a[100:103], v[194:197]
    ds_read_b64_tr_b16 a[202:203], v35 offset:51200
    s_add_u32 m0, s58, 16384
    v_accvgpr_write_b32 a253, 0
    v_mfma_f32_16x16x32_bf16 v[202:205], a[212:215], a[96:99], v[202:205]
    ds_read_b64_tr_b16 a[204:205], v37 offset:49152
    s_add_u32 s0, s0, 458752
    v_mfma_f32_16x16x32_bf16 v[210:213], a[212:215], a[100:103], v[210:213]
    ds_read_b64_tr_b16 a[206:207], v37 offset:51200
    s_waitcnt lgkmcnt(8)
    v_mfma_f32_16x16x32_bf16 v[182:185], a[216:219], a[104:107], v[182:185]
    ds_read_b64_tr_b16 a[208:209], v36 offset:49152
    s_cmp_eq_u32 s0, 3670016
    v_mfma_f32_16x16x32_bf16 v[190:193], a[216:219], a[108:111], v[190:193]
    ds_read_b64_tr_b16 a[210:211], v36 offset:51200
    s_cselect_b32 s0, 0, s0
    buffer_load_dwordx4 v55, s[20:23], s0 offen lds
    v_cndmask_b32 v15, 0, v14, vcc
    v_mfma_f32_16x16x32_bf16 v[198:201], a[220:223], a[104:107], v[198:201]
    ds_read_b64_tr_b16 a[212:213], v38 offset:49152
    v_accvgpr_write_b32 a251, v15
    v_mfma_f32_16x16x32_bf16 v[206:209], a[220:223], a[108:111], v[206:209]
    ds_read_b64_tr_b16 a[214:215], v38 offset:51200
    s_waitcnt lgkmcnt(8)
    v_mfma_f32_16x16x32_bf16 v[186:189], a[224:227], a[104:107], v[186:189]
    ds_read_b64_tr_b16 a[216:217], v35 offset:53248
    buffer_load_dwordx4 v56, s[20:23], s0 offen offset:1024 lds
    v_mfma_f32_16x16x32_bf16 v[194:197], a[224:227], a[108:111], v[194:197]
    ds_read_b64_tr_b16 a[218:219], v35 offset:55296
    v_mfma_f32_16x16x32_bf16 v[202:205], a[228:231], a[104:107], v[202:205]
    ds_read_b64_tr_b16 a[220:221], v37 offset:53248
    buffer_load_dwordx4 v57, s[20:23], s0 offen offset:2048 lds
    v_mfma_f32_16x16x32_bf16 v[210:213], a[228:231], a[108:111], v[210:213]
    ds_read_b64_tr_b16 a[222:223], v37 offset:55296
    s_waitcnt vmcnt(9) lgkmcnt(8)
    v_mfma_f32_16x16x32_bf16 v[182:185], a[200:203], a[112:115], v[182:185]
    ds_read_b64_tr_b16 a[224:225], v36 offset:53248
    v_mfma_f32_16x16x32_bf16 v[190:193], a[200:203], a[116:119], v[190:193]
    ds_read_b64_tr_b16 a[226:227], v36 offset:55296
    buffer_load_dwordx4 v58, s[20:23], s0 offen offset:3072 lds
    v_mfma_f32_16x16x32_bf16 v[198:201], a[204:207], a[112:115], v[198:201]
    ds_read_b64_tr_b16 a[228:229], v38 offset:53248
    s_add_u32 m0, s58, 32768
    v_mfma_f32_16x16x32_bf16 v[206:209], a[204:207], a[116:119], v[206:209]
    ds_read_b64_tr_b16 a[230:231], v38 offset:55296
    s_waitcnt lgkmcnt(8)
    v_mfma_f32_16x16x32_bf16 v[186:189], a[208:211], a[112:115], v[186:189]
    s_waitcnt lgkmcnt(0)
    s_cmp_ge_u32 s14, 14
    s_cbranch_scc0 L_pollin1
L_pollok1:
    ds_read_b64_tr_b16 a[200:201], v39 offset:0
    s_add_u32 s0, s0, 458752
    v_mfma_f32_16x16x32_bf16 v[194:197], a[208:211], a[116:119], v[194:197]
    ds_read_b64_tr_b16 a[202:203], v39 offset:2048
    s_cmp_eq_u32 s0, 3670016
    s_cselect_b32 s0, 0, s0
    buffer_load_dwordx4 v55, s[20:23], s0 offen lds
    v_mfma_f32_16x16x32_bf16 v[202:205], a[212:215], a[112:115], v[202:205]
    ds_read_b64_tr_b16 a[204:205], v41 offset:0
    v_mfma_f32_16x16x32_bf16 v[210:213], a[212:215], a[116:119], v[210:213]
    ds_read_b64_tr_b16 a[206:207], v41 offset:2048
    s_waitcnt vmcnt(9)
    v_mfma_f32_16x16x32_bf16 v[182:185], a[216:219], a[120:123], v[182:185]
    ds_read_b64_tr_b16 a[208:209], v40 offset:0
    buffer_load_dwordx4 v56, s[20:23], s0 offen offset:1024 lds
    v_mfma_f32_16x16x32_bf16 v[190:193], a[216:219], a[124:127], v[190:193]
    ds_read_b64_tr_b16 a[210:211], v40 offset:2048
    v_mfma_f32_16x16x32_bf16 v[198:201], a[220:223], a[120:123], v[198:201]
    ds_read_b64_tr_b16 a[212:213], v42 offset:0
    buffer_load_dwordx4 v57, s[20:23], s0 offen offset:2048 lds
    v_mfma_f32_16x16x32_bf16 v[206:209], a[220:223], a[124:127], v[206:209]
    ds_read_b64_tr_b16 a[214:215], v42 offset:2048
    v_mfma_f32_16x16x32_bf16 v[186:189], a[224:227], a[120:123], v[186:189]
    ds_read_b64_tr_b16 a[216:217], v39 offset:4096
    v_mfma_f32_16x16x32_bf16 v[194:197], a[224:227], a[124:127], v[194:197]
    ds_read_b64_tr_b16 a[218:219], v39 offset:6144
    v_mfma_f32_16x16x32_bf16 v[202:205], a[228:231], a[120:123], v[202:205]
    ds_read_b64_tr_b16 a[220:221], v41 offset:4096
    buffer_load_dwordx4 v58, s[20:23], s0 offen offset:3072 lds
    v_mfma_f32_16x16x32_bf16 v[210:213], a[228:231], a[124:127], v[210:213]
    ds_read_b64_tr_b16 a[222:223], v41 offset:6144
    s_waitcnt lgkmcnt(8)
    v_mfma_f32_16x16x32_bf16 v[150:153], a[200:203], a[0:3], v[150:153]
    ds_read_b64_tr_b16 a[224:225], v40 offset:4096
    s_add_u32 m0, s58, 49152
    v_mfma_f32_16x16x32_bf16 v[158:161], a[200:203], a[4:7], v[158:161]
    ds_read_b64_tr_b16 a[226:227], v40 offset:6144
    s_add_u32 s0, s0, 458752
    v_mfma_f32_16x16x32_bf16 v[166:169], a[204:207], a[0:3], 0
    ds_read_b64_tr_b16 a[228:229], v42 offset:4096
    s_cmp_eq_u32 s0, 3670016
    s_cselect_b32 s0, 0, s0
    buffer_load_dwordx4 v55, s[20:23], s0 offen lds
    v_mfma_f32_16x16x32_bf16 v[174:177], a[204:207], a[4:7], 0
    ds_read_b64_tr_b16 a[230:231], v42 offset:6144
    v_cvt_pk_bf16_f32 v182, v182, v183
    v_cvt_pk_bf16_f32 v183, v184, v185
    v_cvt_pk_bf16_f32 v184, v186, v187
    s_waitcnt lgkmcnt(8)
    v_mfma_f32_16x16x32_bf16 v[154:157], a[208:211], a[0:3], v[154:157]
    s_waitcnt vmcnt(5)
    s_barrier
    ds_read_b64_tr_b16 a[200:201], v39 offset:16384
    buffer_load_dwordx4 v56, s[20:23], s0 offen offset:1024 lds
    v_mfma_f32_16x16x32_bf16 v[162:165], a[208:211], a[4:7], v[162:165]
    ds_read_b64_tr_b16 a[202:203], v39 offset:18432
    v_cvt_pk_bf16_f32 v185, v188, v189
    buffer_store_dwordx4 v[182:185], v23, s[28:31], 0 offen offset:0 sc1
    v_cvt_pk_bf16_f32 v190, v190, v191
    v_cvt_pk_bf16_f32 v191, v192, v193
    v_cvt_pk_bf16_f32 v192, v194, v195
    v_mfma_f32_16x16x32_bf16 v[170:173], a[212:215], a[0:3], 0
    ds_read_b64_tr_b16 a[204:205], v41 offset:16384
    v_cvt_pk_bf16_f32 v193, v196, v197
    v_mfma_f32_16x16x32_bf16 v[178:181], a[212:215], a[4:7], 0
    ds_read_b64_tr_b16 a[206:207], v41 offset:18432
    buffer_store_dwordx4 v[190:193], v23, s[28:31], 0 offen offset:1024 sc1
    v_cvt_pk_bf16_f32 v198, v198, v199
    v_cvt_pk_bf16_f32 v199, v200, v201
    v_cvt_pk_bf16_f32 v200, v202, v203
    s_waitcnt lgkmcnt(8)
    v_mfma_f32_16x16x32_bf16 v[150:153], a[216:219], a[8:11], v[150:153]
    ds_read_b64_tr_b16 a[208:209], v40 offset:16384
    buffer_load_dwordx4 v57, s[20:23], s0 offen offset:2048 lds
    v_mfma_f32_16x16x32_bf16 v[158:161], a[216:219], a[12:15], v[158:161]
    ds_read_b64_tr_b16 a[210:211], v40 offset:18432
    v_cvt_pk_bf16_f32 v201, v204, v205
    buffer_store_dwordx4 v[198:201], v23, s[28:31], 0 offen offset:2048 sc1
    v_cvt_pk_bf16_f32 v206, v206, v207
    v_cvt_pk_bf16_f32 v207, v208, v209
    v_cvt_pk_bf16_f32 v208, v210, v211
    v_mfma_f32_16x16x32_bf16 v[166:169], a[220:223], a[8:11], v[166:169]
    ds_read_b64_tr_b16 a[212:213], v42 offset:16384
    v_cvt_pk_bf16_f32 v209, v212, v213
    v_mfma_f32_16x16x32_bf16 v[174:177], a[220:223], a[12:15], v[174:177]
    ds_read_b64_tr_b16 a[214:215], v42 offset:18432
    s_waitcnt lgkmcnt(8)
    v_mfma_f32_16x16x32_bf16 v[154:157], a[224:227], a[8:11], v[154:157]
    ds_read_b64_tr_b16 a[216:217], v39 offset:20480
    buffer_load_dwordx4 v58, s[20:23], s0 offen offset:3072 lds
    v_mfma_f32_16x16x32_bf16 v[162:165], a[224:227], a[12:15], v[162:165]
    ds_read_b64_tr_b16 a[218:219], v39 offset:22528
    s_add_u32 m0, s58, 65536
    buffer_store_dwordx4 v[206:209], v23, s[28:31], 0 offen offset:3072 sc1
    v_mfma_f32_16x16x32_bf16 v[170:173], a[228:231], a[8:11], v[170:173]
    ds_read_b64_tr_b16 a[220:221], v41 offset:20480
    s_add_u32 s0, s0, 458752
    v_mfma_f32_16x16x32_bf16 v[178:181], a[228:231], a[12:15], v[178:181]
    ds_read_b64_tr_b16 a[222:223], v41 offset:22528
    s_waitcnt lgkmcnt(8)
    v_mfma_f32_16x16x32_bf16 v[150:153], a[200:203], a[16:19], v[150:153]
    ds_read_b64_tr_b16 a[224:225], v40 offset:20480
    s_cmp_eq_u32 s0, 3670016
    v_mfma_f32_16x16x32_bf16 v[158:161], a[200:203], a[20:23], v[158:161]
    ds_read_b64_tr_b16 a[226:227], v40 offset:22528
    s_cselect_b32 s0, 0, s0
    buffer_load_dwordx4 v55, s[20:23], s0 offen lds
    v_mfma_f32_16x16x32_bf16 v[166:169], a[204:207], a[16:19], v[166:169]
    ds_read_b64_tr_b16 a[228:229], v42 offset:20480
    v_mfma_f32_16x16x32_bf16 v[174:177], a[204:207], a[20:23], v[174:177]
    ds_read_b64_tr_b16 a[230:231], v42 offset:22528
    s_waitcnt lgkmcnt(8)
    v_mfma_f32_16x16x32_bf16 v[154:157], a[208:211], a[16:19], v[154:157]
    ds_read_b64_tr_b16 a[200:201], v31 offset:0
    buffer_load_dwordx4 v56, s[20:23], s0 offen offset:1024 lds
    v_mfma_f32_16x16x32_bf16 v[162:165], a[208:211], a[20:23], v[162:165]
    ds_read_b64_tr_b16 a[202:203], v31 offset:2048
    v_mfma_f32_16x16x32_bf16 v[170:173], a[212:215], a[16:19], v[170:173]
    ds_read_b64_tr_b16 a[204:205], v33 offset:0
    buffer_load_dwordx4 v57, s[20:23], s0 offen offset:2048 lds
    v_mfma_f32_16x16x32_bf16 v[178:181], a[212:215], a[20:23], v[178:181]
    ds_read_b64_tr_b16 a[206:207], v33 offset:2048
    s_waitcnt lgkmcnt(8)
    v_mfma_f32_16x16x32_bf16 v[150:153], a[216:219], a[24:27], v[150:153]
    ds_read_b64_tr_b16 a[208:209], v32 offset:0
    v_mfma_f32_16x16x32_bf16 v[158:161], a[216:219], a[28:31], v[158:161]
    ds_read_b64_tr_b16 a[210:211], v32 offset:2048
    buffer_load_dwordx4 v58, s[20:23], s0 offen offset:3072 lds
    v_mfma_f32_16x16x32_bf16 v[166:169], a[220:223], a[24:27], v[166:169]
    ds_read_b64_tr_b16 a[212:213], v34 offset:0
    s_add_u32 m0, s58, 81920
    v_mfma_f32_16x16x32_bf16 v[174:177], a[220:223], a[28:31], v[174:177]
    ds_read_b64_tr_b16 a[214:215], v34 offset:2048
    s_waitcnt lgkmcnt(8)
    v_mfma_f32_16x16x32_bf16 v[154:157], a[224:227], a[24:27], v[154:157]
    ds_read_b64_tr_b16 a[216:217], v31 offset:4096
    s_add_u32 s0, s0, 458752
    v_mfma_f32_16x16x32_bf16 v[162:165], a[224:227], a[28:31], v[162:165]
    ds_read_b64_tr_b16 a[218:219], v31 offset:6144
    s_cmp_eq_u32 s0, 3670016
    v_mfma_f32_16x16x32_bf16 v[170:173], a[228:231], a[24:27], v[170:173]
    ds_read_b64_tr_b16 a[220:221], v33 offset:4096
    s_cselect_b32 s0, 0, s0
    buffer_load_dwordx4 v55, s[20:23], s0 offen lds
    v_mfma_f32_16x16x32_bf16 v[178:181], a[228:231], a[28:31], v[178:181]
    ds_read_b64_tr_b16 a[222:223], v33 offset:6144
    s_waitcnt lgkmcnt(8)
    v_mfma_f32_16x16x32_bf16 v[150:153], a[200:203], a[32:35], v[150:153]
    ds_read_b64_tr_b16 a[224:225], v32 offset:4096
    buffer_load_dwordx4 v56, s[20:23], s0 offen offset:1024 lds
    v_mfma_f32_16x16x32_bf16 v[158:161], a[200:203], a[36:39], v[158:161]
    ds_read_b64_tr_b16 a[226:227], v32 offset:6144
    v_mfma_f32_16x16x32_bf16 v[166:169], a[204:207], a[32:35], v[166:169]
    ds_read_b64_tr_b16 a[228:229], v34 offset:4096
    v_mfma_f32_16x16x32_bf16 v[174:177], a[204:207], a[36:39], v[174:177]
    ds_read_b64_tr_b16 a[230:231], v34 offset:6144
    s_waitcnt lgkmcnt(8)
    v_mfma_f32_16x16x32_bf16 v[154:157], a[208:211], a[32:35], v[154:157]
    s_waitcnt vmcnt(7)
    s_barrier
    s_waitcnt vmcnt(6)
    s_atomic_add s36, s[28:29], s37
    ds_read_b64_tr_b16 a[200:201], v31 offset:16384
    buffer_load_dwordx4 v57, s[20:23], s0 offen offset:2048 lds
    v_mfma_f32_16x16x32_bf16 v[162:165], a[208:211], a[36:39], v[162:165]
    ds_read_b64_tr_b16 a[202:203], v31 offset:18432
    v_mfma_f32_16x16x32_bf16 v[170:173], a[212:215], a[32:35], v[170:173]
    ds_read_b64_tr_b16 a[204:205], v33 offset:16384
    buffer_load_dwordx4 v58, s[20:23], s0 offen offset:3072 lds
    v_mfma_f32_16x16x32_bf16 v[178:181], a[212:215], a[36:39], v[178:181]
    ds_read_b64_tr_b16 a[206:207], v33 offset:18432
    s_waitcnt lgkmcnt(8)
    v_mfma_f32_16x16x32_bf16 v[150:153], a[216:219], a[40:43], v[150:153]
    ds_read_b64_tr_b16 a[208:209], v32 offset:16384
    s_add_u32 m0, s59, 98304
    v_mfma_f32_16x16x32_bf16 v[158:161], a[216:219], a[44:47], v[158:161]
    ds_read_b64_tr_b16 a[210:211], v32 offset:18432
    buffer_load_dwordx4 v80, s[28:31], s63 offen sc1 lds
    v_mfma_f32_16x16x32_bf16 v[166:169], a[220:223], a[40:43], v[166:169]
    ds_read_b64_tr_b16 a[212:213], v34 offset:16384
    v_mfma_f32_16x16x32_bf16 v[174:177], a[220:223], a[44:47], v[174:177]
    ds_read_b64_tr_b16 a[214:215], v34 offset:18432
    s_waitcnt lgkmcnt(8)
    v_mfma_f32_16x16x32_bf16 v[154:157], a[224:227], a[40:43], v[154:157]
    ds_read_b64_tr_b16 a[216:217], v31 offset:20480
    v_mfma_f32_16x16x32_bf16 v[162:165], a[224:227], a[44:47], v[162:165]
    ds_read_b64_tr_b16 a[218:219], v31 offset:22528
    buffer_load_dwordx4 v80, s[28:31], s63 offen offset:1024 sc1 lds
    v_mfma_f32_16x16x32_bf16 v[170:173], a[228:231], a[40:43], v[170:173]
    ds_read_b64_tr_b16 a[220:221], v33 offset:20480
    v_mfma_f32_16x16x32_bf16 v[178:181], a[228:231], a[44:47], v[178:181]
    ds_read_b64_tr_b16 a[222:223], v33 offset:22528
    s_waitcnt lgkmcnt(8)
    v_mfma_f32_16x16x32_bf16 v[150:153], a[200:203], a[48:51], v[150:153]
    ds_read_b64_tr_b16 a[224:225], v32 offset:20480
    buffer_load_dwordx4 v80, s[28:31], s63 offen offset:2048 sc1 lds
    v_mfma_f32_16x16x32_bf16 v[158:161], a[200:203], a[52:55], v[158:161]
    ds_read_b64_tr_b16 a[226:227], v32 offset:22528
    s_add_u32 m0, s100, 126976
    v_mfma_f32_16x16x32_bf16 v[166:169], a[204:207], a[48:51], v[166:169]
    ds_read_b64_tr_b16 a[228:229], v34 offset:20480
    v_mfma_f32_16x16x32_bf16 v[174:177], a[204:207], a[52:55], v[174:177]
    ds_read_b64_tr_b16 a[230:231], v34 offset:22528
    s_waitcnt lgkmcnt(8)
    v_mfma_f32_16x16x32_bf16 v[154:157], a[208:211], a[48:51], v[154:157]
    ds_read_b64_tr_b16 a[200:201], v31 offset:32768
    buffer_load_dwordx4 v69, s[28:31], s62 offen sc1 lds
    v_mfma_f32_16x16x32_bf16 v[162:165], a[208:211], a[52:55], v[162:165]
    ds_read_b64_tr_b16 a[202:203], v31 offset:34816
    s_add_u32 m0, s58, 110592
    v_mfma_f32_16x16x32_bf16 v[170:173], a[212:215], a[48:51], v[170:173]
    ds_read_b64_tr_b16 a[204:205], v33 offset:32768
    v_mfma_f32_16x16x32_bf16 v[178:181], a[212:215], a[52:55], v[178:181]
    ds_read_b64_tr_b16 a[206:207], v33 offset:34816
    s_waitcnt lgkmcnt(8)
    v_mfma_f32_16x16x32_bf16 v[150:153], a[216:219], a[56:59], v[150:153]
    ds_read_b64_tr_b16 a[208:209], v32 offset:32768
    buffer_load_dwordx4 v67, s[28:31], s62 offen sc1 lds
    v_mfma_f32_16x16x32_bf16 v[158:161], a[216:219], a[60:63], v[158:161]
    ds_read_b64_tr_b16 a[210:211], v32 offset:34816
    v_mfma_f32_16x16x32_bf16 v[166:169], a[220:223], a[56:59], v[166:169]
    ds_read_b64_tr_b16 a[212:213], v34 offset:32768
    v_mfma_f32_16x16x32_bf16 v[174:177], a[220:223], a[60:63], v[174:177]
    ds_read_b64_tr_b16 a[214:215], v34 offset:34816
    s_waitcnt lgkmcnt(8)
    v_mfma_f32_16x16x32_bf16 v[154:157], a[224:227], a[56:59], v[154:157]
    ds_read_b64_tr_b16 a[216:217], v31 offset:36864
    buffer_load_dwordx4 v67, s[28:31], s62 offen offset:1024 sc1 lds
    v_mfma_f32_16x16x32_bf16 v[162:165], a[224:227], a[60:63], v[162:165]
    ds_read_b64_tr_b16 a[218:219], v31 offset:38912
    v_mfma_f32_16x16x32_bf16 v[170:173], a[228:231], a[56:59], v[170:173]
    ds_read_b64_tr_b16 a[220:221], v33 offset:36864
    buffer_load_dwordx4 v68, s[28:31], s62 offen offset:2048 sc1 lds
    v_mfma_f32_16x16x32_bf16 v[178:181], a[228:231], a[60:63], v[178:181]
    ds_read_b64_tr_b16 a[222:223], v33 offset:38912
    s_waitcnt lgkmcnt(8)
    v_mfma_f32_16x16x32_bf16 v[150:153], a[200:203], a[64:67], v[150:153]
    ds_read_b64_tr_b16 a[224:225], v32 offset:36864
    v_mfma_f32_16x16x32_bf16 v[158:161], a[200:203], a[68:71], v[158:161]
    ds_read_b64_tr_b16 a[226:227], v32 offset:38912
    v_mfma_f32_16x16x32_bf16 v[166:169], a[204:207], a[64:67], v[166:169]
    ds_read_b64_tr_b16 a[228:229], v34 offset:36864
    buffer_load_dwordx4 v68, s[28:31], s62 offen offset:3072 sc1 lds
    v_mfma_f32_16x16x32_bf16 v[174:177], a[204:207], a[68:71], v[174:177]
    ds_read_b64_tr_b16 a[230:231], v34 offset:38912
    s_waitcnt lgkmcnt(8)
    v_mfma_f32_16x16x32_bf16 v[154:157], a[208:211], a[64:67], v[154:157]
    s_waitcnt vmcnt(8)
    s_barrier
    s_xor_b32 s37, s37, 1024
    s_load_dword s14, s[28:29], s37
    ds_read_b64_tr_b16 a[200:201], v31 offset:49152
    s_add_u32 m0, s59, 131072
    v_mfma_f32_16x16x32_bf16 v[162:165], a[208:211], a[68:71], v[162:165]
    ds_read_b64_tr_b16 a[202:203], v31 offset:51200
    s_add_u32 s63, s63, 12288
    v_mfma_f32_16x16x32_bf16 v[170:173], a[212:215], a[64:67], v[170:173]
    ds_read_b64_tr_b16 a[204:205], v33 offset:49152
    s_cmp_eq_u32 s63, 86016
    s_cselect_b32 s63, 0, s63
    buffer_load_dwordx4 v80, s[28:31], s63 offen sc1 lds
    v_mfma_f32_16x16x32_bf16 v[178:181], a[212:215], a[68:71], v[178:181]
    ds_read_b64_tr_b16 a[206:207], v33 offset:51200
    s_waitcnt lgkmcnt(8)
    v_mfma_f32_16x16x32_bf16 v[150:153], a[216:219], a[72:75], v[150:153]
    ds_read_b64_tr_b16 a[208:209], v32 offset:49152
    buffer_load_dwordx4 v80, s[28:31], s63 offen offset:1024 sc1 lds
    v_mfma_f32_16x16x32_bf16 v[158:161], a[216:219], a[76:79], v[158:161]
    ds_read_b64_tr_b16 a[210:211], v32 offset:51200
    v_mfma_f32_16x16x32_bf16 v[166:169], a[220:223], a[72:75], v[166:169]
    ds_read_b64_tr_b16 a[212:213], v34 offset:49152
    v_mfma_f32_16x16x32_bf16 v[174:177], a[220:223], a[76:79], v[174:177]
    ds_read_b64_tr_b16 a[214:215], v34 offset:51200
    s_waitcnt lgkmcnt(8)
    v_mfma_f32_16x16x32_bf16 v[154:157], a[224:227], a[72:75], v[154:157]
    ds_read_b64_tr_b16 a[216:217], v31 offset:53248
    buffer_load_dwordx4 v80, s[28:31], s63 offen offset:2048 sc1 lds
    v_mfma_f32_16x16x32_bf16 v[162:165], a[224:227], a[76:79], v[162:165]
    ds_read_b64_tr_b16 a[218:219], v31 offset:55296
    s_add_u32 m0, s100, 159744
    v_mfma_f32_16x16x32_bf16 v[170:173], a[228:231], a[72:75], v[170:173]
    ds_read_b64_tr_b16 a[220:221], v33 offset:53248
    s_add_u32 s62, s62, 262144
    v_mfma_f32_16x16x32_bf16 v[178:181], a[228:231], a[76:79], v[178:181]
    ds_read_b64_tr_b16 a[222:223], v33 offset:55296
    s_waitcnt lgkmcnt(8)
    v_mfma_f32_16x16x32_bf16 v[150:153], a[200:203], a[80:83], v[150:153]
    ds_read_b64_tr_b16 a[224:225], v32 offset:53248
    s_cmp_eq_u32 s62, 1835008
    v_mfma_f32_16x16x32_bf16 v[158:161], a[200:203], a[84:87], v[158:161]
    ds_read_b64_tr_b16 a[226:227], v32 offset:55296
    s_cselect_b32 s62, 0, s62
    buffer_load_dwordx4 v69, s[28:31], s62 offen sc1 lds
    v_mfma_f32_16x16x32_bf16 v[166:169], a[204:207], a[80:83], v[166:169]
    ds_read_b64_tr_b16 a[228:229], v34 offset:53248
    s_add_u32 m0, s58, 143360
    v_mfma_f32_16x16x32_bf16 v[174:177], a[204:207], a[84:87], v[174:177]
    ds_read_b64_tr_b16 a[230:231], v34 offset:55296
    s_waitcnt lgkmcnt(8)
    v_mfma_f32_16x16x32_bf16 v[154:157], a[208:211], a[80:83], v[154:157]
    s_barrier
    ds_read_b64_tr_b16 a[200:201], v37 offset:0
    buffer_load_dwordx4 v67, s[28:31], s62 offen sc1 lds
    v_mfma_f32_16x16x32_bf16 v[162:165], a[208:211], a[84:87], v[162:165]
    ds_read_b64_tr_b16 a[202:203], v37 offset:2048
    v_mfma_f32_16x16x32_bf16 v[170:173], a[212:215], a[80:83], v[170:173]
    ds_read_b64_tr_b16 a[204:205], v38 offset:0
    buffer_load_dwordx4 v67, s[28:31], s62 offen offset:1024 sc1 lds
    v_mfma_f32_16x16x32_bf16 v[178:181], a[212:215], a[84:87], v[178:181]
    ds_read_b64_tr_b16 a[206:207], v38 offset:2048
    s_waitcnt lgkmcnt(8)
    v_mfma_f32_16x16x32_bf16 v[150:153], a[216:219], a[88:91], v[150:153]
    ds_read_b64_tr_b16 a[208:209], v37 offset:4096
    v_mfma_f32_16x16x32_bf16 v[158:161], a[216:219], a[92:95], v[158:161]
    ds_read_b64_tr_b16 a[210:211], v37 offset:6144
    v_mfma_f32_16x16x32_bf16 v[166:169], a[220:223], a[88:91], v[166:169]
    ds_read_b64_tr_b16 a[212:213], v38 offset:4096
    buffer_load_dwordx4 v68, s[28:31], s62 offen offset:2048 sc1 lds
    v_mfma_f32_16x16x32_bf16 v[174:177], a[220:223], a[92:95], v[174:177]
    ds_read_b64_tr_b16 a[214:215], v38 offset:6144
    s_waitcnt lgkmcnt(8)
    v_mfma_f32_16x16x32_bf16 v[154:157], a[224:227], a[88:91], v[154:157]
    ds_read_b64_tr_b16 a[216:217], v37 offset:16384
    v_mfma_f32_16x16x32_bf16 v[162:165], a[224:227], a[92:95], v[162:165]
    ds_read_b64_tr_b16 a[218:219], v37 offset:18432
    buffer_load_dwordx4 v68, s[28:31], s62 offen offset:3072 sc1 lds
    v_mfma_f32_16x16x32_bf16 v[170:173], a[228:231], a[88:91], v[170:173]
    ds_read_b64_tr_b16 a[220:221], v38 offset:16384
    s_add_u32 m0, s59, 0
    v_mfma_f32_16x16x32_bf16 v[178:181], a[228:231], a[92:95], v[178:181]
    ds_read_b64_tr_b16 a[222:223], v38 offset:18432
    s_waitcnt lgkmcnt(8)
    v_mfma_f32_16x16x32_bf16 v[166:169], a[200:203], a[96:99], v[166:169]
    s_waitcnt lgkmcnt(0)
    s_cmp_ge_u32 s14, 2
    s_cbranch_scc0 L_pollin2
L_pollok2:
    v_xor_b32 v23, 131072, v23
    v_xor_b32 v22, 8192, v23
    ds_read_b64_tr_b16 a[224:225], v37 offset:20480
    buffer_load_dwordx4 v[214:217], v23, s[28:31], 0 offen offset:0 sc1
    v_mfma_f32_16x16x32_bf16 v[174:177], a[200:203], a[100:103], v[174:177]
    ds_read_b64_tr_b16 a[226:227], v37 offset:22528
    v_mfma_f32_16x16x32_bf16 v[170:173], a[204:207], a[96:99], v[170:173]
    ds_read_b64_tr_b16 a[228:229], v38 offset:20480
    buffer_load_dwordx4 v[218:221], v23, s[28:31], 0 offen offset:1024 sc1
    v_mfma_f32_16x16x32_bf16 v[178:181], a[204:207], a[100:103], v[178:181]
    ds_read_b64_tr_b16 a[230:231], v38 offset:22528
    v_mfma_f32_16x16x32_bf16 v[166:169], a[208:211], a[104:107], v[166:169]
    ds_read_b64_tr_b16 a[200:201], v35 offset:0
    buffer_load_dwordx4 v[222:225], v22, s[28:31], 0 offen offset:2048 sc1
    v_mfma_f32_16x16x32_bf16 v[174:177], a[208:211], a[108:111], v[174:177]
    ds_read_b64_tr_b16 a[202:203], v35 offset:2048
    v_mfma_f32_16x16x32_bf16 v[170:173], a[212:215], a[104:107], v[170:173]
    ds_read_b64_tr_b16 a[204:205], v36 offset:0
    buffer_load_dwordx4 v[226:229], v22, s[28:31], 0 offen offset:3072 sc1
    v_mfma_f32_16x16x32_bf16 v[178:181], a[212:215], a[108:111], v[178:181]
    ds_read_b64_tr_b16 a[206:207], v36 offset:2048
    v_mfma_f32_16x16x32_bf16 v[166:169], a[216:219], a[112:115], v[166:169]
    ds_read_b64_tr_b16 a[208:209], v35 offset:4096
    s_add_u32 s63, s63, 12288
    v_mfma_f32_16x16x32_bf16 v[174:177], a[216:219], a[116:119], v[174:177]
    ds_read_b64_tr_b16 a[210:211], v35 offset:6144
    s_cmp_eq_u32 s63, 86016
    s_cselect_b32 s63, 0, s63
    buffer_load_dwordx4 v80, s[28:31], s63 offen sc1 lds
    v_mfma_f32_16x16x32_bf16 v[170:173], a[220:223], a[112:115], v[170:173]
    ds_read_b64_tr_b16 a[212:213], v36 offset:4096
    v_mfma_f32_16x16x32_bf16 v[178:181], a[220:223], a[116:119], v[178:181]
    ds_read_b64_tr_b16 a[214:215], v36 offset:6144
    s_waitcnt lgkmcnt(8)
    v_mfma_f32_16x16x32_bf16 v[166:169], a[224:227], a[120:123], v[166:169]
    ds_read_b64_tr_b16 a[216:217], v35 offset:16384
    buffer_load_dwordx4 v80, s[28:31], s63 offen offset:1024 sc1 lds
    v_mfma_f32_16x16x32_bf16 v[174:177], a[224:227], a[124:127], v[174:177]
    ds_read_b64_tr_b16 a[218:219], v35 offset:18432
    v_mfma_f32_16x16x32_bf16 v[170:173], a[228:231], a[120:123], v[170:173]
    ds_read_b64_tr_b16 a[220:221], v36 offset:16384
    v_mfma_f32_16x16x32_bf16 v[178:181], a[228:231], a[124:127], v[178:181]
    ds_read_b64_tr_b16 a[222:223], v36 offset:18432
    s_waitcnt lgkmcnt(8)
    v_mfma_f32_16x16x32_bf16 v[150:153], a[200:203], a[96:99], v[150:153]
    ds_read_b64_tr_b16 a[224:225], v35 offset:20480
    buffer_load_dwordx4 v80, s[28:31], s63 offen offset:2048 sc1 lds
    v_mfma_f32_16x16x32_bf16 v[158:161], a[200:203], a[100:103], v[158:161]
    ds_read_b64_tr_b16 a[226:227], v35 offset:22528
    s_add_u32 m0, s100, 28672
    v_mfma_f32_16x16x32_bf16 v[154:157], a[204:207], a[96:99], v[154:157]
    ds_read_b64_tr_b16 a[228:229], v36 offset:20480
    s_add_u32 s62, s62, 262144
    v_mfma_f32_16x16x32_bf16 v[162:165], a[204:207], a[100:103], v[162:165]
    ds_read_b64_tr_b16 a[230:231], v36 offset:22528
    ds_write_b128 v81, v[166:169] offset:32768
    s_waitcnt lgkmcnt(9)
    v_mfma_f32_16x16x32_bf16 v[150:153], a[208:211], a[104:107], v[150:153]
    s_cmp_eq_u32 s62, 1835008
    s_cselect_b32 s62, 0, s62
    buffer_load_dwordx4 v69, s[28:31], s62 offen sc1 lds
    v_mfma_f32_16x16x32_bf16 v[158:161], a[208:211], a[108:111], v[158:161]
    s_add_u32 m0, s58, 12288
    ds_write_b128 v81, v[170:173] offset:33792
    v_mfma_f32_16x16x32_bf16 v[154:157], a[212:215], a[104:107], v[154:157]
    buffer_load_dwordx4 v67, s[28:31], s62 offen sc1 lds
    ds_write_b128 v81, v[174:177] offset:34816
    v_mfma_f32_16x16x32_bf16 v[162:165], a[212:215], a[108:111], v[162:165]
    s_waitcnt lgkmcnt(7)
    v_mfma_f32_16x16x32_bf16 v[150:153], a[216:219], a[112:115], v[150:153]
    ds_write_b128 v81, v[178:181] offset:35840
    v_mfma_f32_16x16x32_bf16 v[158:161], a[216:219], a[116:119], v[158:161]
    v_mfma_f32_16x16x32_bf16 v[154:157], a[220:223], a[112:115], v[154:157]
    buffer_load_dwordx4 v67, s[28:31], s62 offen offset:1024 sc1 lds
    v_mfma_f32_16x16x32_bf16 v[162:165], a[220:223], a[116:119], v[162:165]
    s_waitcnt lgkmcnt(4)
    v_mfma_f32_16x16x32_bf16 v[150:153], a[224:227], a[120:123], v[150:153]
    v_mfma_f32_16x16x32_bf16 v[158:161], a[224:227], a[124:127], v[158:161]
    buffer_load_dwordx4 v68, s[28:31], s62 offen offset:2048 sc1 lds
    v_mfma_f32_16x16x32_bf16 v[154:157], a[228:231], a[120:123], v[154:157]
    v_mfma_f32_16x16x32_bf16 v[162:165], a[228:231], a[124:127], v[162:165]
    s_waitcnt vmcnt(10)
    v_mfma_f32_16x16x32_bf16 v[150:153], a[250:253], v[214:217], v[150:153]
    v_xor_b32 v81, 8192, v81
    s_waitcnt lgkmcnt(0)
    s_barrier
    ds_read_b128 v[182:185], v81 offset:32768
    ds_read_b128 v[186:189], v81 offset:33792
    ds_read_b128 v[190:193], v81 offset:34816
    ds_read_b128 v[194:197], v81 offset:35840
    v_mfma_f32_16x16x32_bf16 v[154:157], a[248:251], v[214:217], v[154:157]
    buffer_load_dwordx4 v68, s[28:31], s62 offen offset:3072 sc1 lds
    s_add_u32 m0, s59, 65536
    s_waitcnt vmcnt(10)
    v_mfma_f32_16x16x32_bf16 v[158:161], a[250:253], v[218:221], v[158:161]
    s_add_u32 s63, s63, 12288
    s_cmp_eq_u32 s63, 86016
L_pad1:
    s_cbranch_execz L_warm
    v_mfma_f32_16x16x32_bf16 v[162:165], a[248:251], v[218:221], v[162:165]
    s_cselect_b32 s63, 0, s63
    s_waitcnt vmcnt(9)
    v_mfma_f32_16x16x32_bf16 v[150:153], a[250:253], v[222:225], v[150:153]
    buffer_load_dwordx4 v80, s[28:31], s63 offen sc1 lds
    v_mfma_f32_16x16x32_bf16 v[154:157], a[248:251], v[222:225], v[154:157]
    s_waitcnt vmcnt(9)
    v_mfma_f32_16x16x32_bf16 v[158:161], a[250:253], v[226:229], v[158:161]
    v_mfma_f32_16x16x32_bf16 v[162:165], a[248:251], v[226:229], v[162:165]
    buffer_load_dwordx4 v80, s[28:31], s63 offen offset:1024 sc1 lds
    s_waitcnt lgkmcnt(3)
    s_nop 0
    v_pk_add_f32 v[150:151], v[150:151], v[182:183]
    v_pk_add_f32 v[152:153], v[152:153], v[184:185]
    s_waitcnt lgkmcnt(2)
    v_pk_add_f32 v[154:155], v[154:155], v[186:187]
    v_pk_add_f32 v[156:157], v[156:157], v[188:189]
    v_pk_mul_f32 v[182:183], v[150:151], v[150:151]
    v_pk_mul_f32 v[184:185], v[152:153], v[152:153]
    v_pk_mul_f32 v[186:187], v[154:155], v[154:155]
    v_pk_mul_f32 v[188:189], v[156:157], v[156:157]
    v_pk_fma_f32 v[182:183], v[182:183], s[78:79], v[108:109]
    v_pk_fma_f32 v[184:185], v[184:185], s[78:79], v[108:109]
    v_pk_fma_f32 v[186:187], v[186:187], s[78:79], v[108:109]
    v_pk_fma_f32 v[188:189], v[188:189], s[78:79], v[108:109]
    v_pk_mul_f32 v[182:183], v[182:183], v[150:151]
    buffer_load_dwordx4 v80, s[28:31], s63 offen offset:2048 sc1 lds
    v_pk_mul_f32 v[184:185], v[184:185], v[152:153]
    v_pk_mul_f32 v[186:187], v[186:187], v[154:155]
    v_pk_mul_f32 v[188:189], v[188:189], v[156:157]
    v_exp_f32 v182, v182
    v_exp_f32 v183, v183
    v_exp_f32 v184, v184
    v_exp_f32 v185, v185
    v_exp_f32 v186, v186
    v_exp_f32 v187, v187
    s_add_u32 m0, s100, 94208
    s_add_u32 s62, s62, 262144
    s_cmp_eq_u32 s62, 1835008
    s_cselect_b32 s62, 0, s62
    buffer_load_dwordx4 v69, s[28:31], s62 offen sc1 lds
    v_exp_f32 v188, v188
    v_exp_f32 v189, v189
    v_pk_add_f32 v[182:183], v[182:183], s[80:81]
    v_pk_add_f32 v[184:185], v[184:185], s[80:81]
    v_pk_add_f32 v[186:187], v[186:187], s[80:81]
    v_pk_add_f32 v[188:189], v[188:189], s[80:81]
    v_rcp_f32 v182, v182
    v_rcp_f32 v183, v183
    v_rcp_f32 v184, v184
    s_add_u32 m0, s58, 77824
    s_nop 0
    buffer_load_dwordx4 v67, s[28:31], s62 offen sc1 lds
    v_rcp_f32 v185, v185
    v_rcp_f32 v186, v186
    v_rcp_f32 v187, v187
    v_rcp_f32 v188, v188
    v_rcp_f32 v189, v189
    v_pk_mul_f32 v[182:183], v[182:183], v[150:151]
    v_pk_mul_f32 v[184:185], v[184:185], v[152:153]
    v_pk_mul_f32 v[186:187], v[186:187], v[154:155]
    buffer_load_dwordx4 v67, s[28:31], s62 offen offset:1024 sc1 lds
    v_pk_mul_f32 v[188:189], v[188:189], v[156:157]
    v_cvt_pk_bf16_f32 v110, v182, v183
    v_cvt_pk_bf16_f32 v111, v184, v185
    v_cvt_pk_bf16_f32 v112, v186, v187
    v_cvt_pk_bf16_f32 v113, v188, v189
    s_waitcnt lgkmcnt(1)
    v_pk_add_f32 v[158:159], v[158:159], v[190:191]
    v_pk_add_f32 v[160:161], v[160:161], v[192:193]
    s_waitcnt lgkmcnt(0)
    v_pk_add_f32 v[162:163], v[162:163], v[194:195]
    v_pk_add_f32 v[164:165], v[164:165], v[196:197]
    v_pk_mul_f32 v[190:191], v[158:159], v[158:159]
    v_pk_mul_f32 v[192:193], v[160:161], v[160:161]
    v_pk_mul_f32 v[194:195], v[162:163], v[162:163]
    v_pk_mul_f32 v[196:197], v[164:165], v[164:165]
    v_pk_fma_f32 v[190:191], v[190:191], s[78:79], v[108:109]
    buffer_load_dwordx4 v68, s[28:31], s62 offen offset:2048 sc1 lds
    v_pk_fma_f32 v[192:193], v[192:193], s[78:79], v[108:109]
    v_pk_fma_f32 v[194:195], v[194:195], s[78:79], v[108:109]
    v_pk_fma_f32 v[196:197], v[196:197], s[78:79], v[108:109]
    v_pk_mul_f32 v[190:191], v[190:191], v[158:159]
    v_pk_mul_f32 v[192:193], v[192:193], v[160:161]
    v_pk_mul_f32 v[194:195], v[194:195], v[162:163]
    v_pk_mul_f32 v[196:197], v[196:197], v[164:165]
    v_exp_f32 v190, v190
    v_exp_f32 v191, v191
    v_exp_f32 v192, v192
    v_exp_f32 v193, v193
    buffer_load_dwordx4 v68, s[28:31], s62 offen offset:3072 sc1 lds
    v_exp_f32 v194, v194
    v_exp_f32 v195, v195
    v_exp_f32 v196, v196
    v_exp_f32 v197, v197
    v_pk_add_f32 v[190:191], v[190:191], s[80:81]
    v_pk_add_f32 v[192:193], v[192:193], s[80:81]
    v_pk_add_f32 v[194:195], v[194:195], s[80:81]
    v_pk_add_f32 v[196:197], v[196:197], s[80:81]
    v_rcp_f32 v190, v190
    v_rcp_f32 v191, v191
    v_rcp_f32 v192, v192
    v_rcp_f32 v193, v193
    v_rcp_f32 v194, v194
    v_rcp_f32 v195, v195
    v_rcp_f32 v196, v196
    v_rcp_f32 v197, v197
    v_pk_mul_f32 v[190:191], v[190:191], v[158:159]
    v_pk_mul_f32 v[192:193], v[192:193], v[160:161]
    v_pk_mul_f32 v[194:195], v[194:195], v[162:163]
    v_pk_mul_f32 v[196:197], v[196:197], v[164:165]
    v_cvt_pk_bf16_f32 v114, v190, v191
    v_cvt_pk_bf16_f32 v115, v192, v193
    v_cvt_pk_bf16_f32 v116, v194, v195
    v_cvt_pk_bf16_f32 v117, v196, v197
    ds_read_b64_tr_b16 a[180:181], v72 offset:32768
    ds_read_b64_tr_b16 a[182:183], v72 offset:33024
    ds_read_b128 a[128:131], v53 offset:32768
    ds_read_b64_tr_b16 a[184:185], v72 offset:33792
    ds_read_b64_tr_b16 a[186:187], v72 offset:34048
    ds_read_b128 a[132:135], v53 offset:33792
    ds_read_b128 a[136:139], v53 offset:34816
    ds_read_b64_tr_b16 a[176:177], v73 offset:32768
    ds_read_b64_tr_b16 a[178:179], v73 offset:33024
    ds_read_b128 a[140:143], v53 offset:35840
    ds_read_b128 a[144:147], v53 offset:36864
    ds_read_b128 a[148:151], v53 offset:37888
    buffer_store_dwordx4 v[110:113], v4, s[28:31], s67 offen offset:0 sc1
    buffer_store_dwordx4 v[114:117], v4, s[28:31], s67 offen offset:1024 sc1
L_q:
    s_waitcnt lgkmcnt(6)
    v_mfma_f32_16x16x32_bf16 v[182:185], a[128:131], a[180:183], 0
    ds_read_b64_tr_b16 a[192:193], v72 offset:34816
    v_mfma_f32_16x16x32_bf16 v[190:193], a[128:131], a[184:187], 0
    ds_read_b64_tr_b16 a[194:195], v72 offset:35072
    v_mfma_f32_16x16x32_bf16 v[186:189], a[132:135], a[180:183], 0
    ds_read_b128 a[152:155], v53 offset:38912
    v_mfma_f32_16x16x32_bf16 v[194:197], a[132:135], a[184:187], 0
    ds_read_b64_tr_b16 a[196:197], v72 offset:35840
    s_waitcnt lgkmcnt(4)
    v_mfma_f32_16x16x32_bf16 v[206:209], a[136:139], a[180:183], 0
    ds_read_b64_tr_b16 a[198:199], v72 offset:36096
    v_mfma_f32_16x16x32_bf16 v[214:217], a[136:139], a[184:187], 0
    ds_read_b128 a[156:159], v53 offset:39936
    v_mfma_f32_16x16x32_bf16 v[198:201], a[136:139], a[176:179], 0
    ds_read_b128 a[160:163], v53 offset:40960
    v_mfma_f32_16x16x32_bf16 v[210:213], a[140:143], a[180:183], 0
    ds_read_b64_tr_b16 a[188:189], v73 offset:34816
    v_mfma_f32_16x16x32_bf16 v[218:221], a[140:143], a[184:187], 0
    ds_read_b64_tr_b16 a[190:191], v73 offset:35072
    v_mfma_f32_16x16x32_bf16 v[202:205], a[140:143], a[176:179], 0
    ds_read_b128 a[164:167], v53 offset:41984
    v_mfma_f32_16x16x32_bf16 v[230:233], a[180:183], a[144:147], 0
    ds_read_b128 a[168:171], v53 offset:43008
    v_mfma_f32_16x16x32_bf16 v[238:241], a[184:187], a[144:147], 0
    ds_read_b128 a[172:175], v53 offset:44032
    v_mfma_f32_16x16x32_bf16 v[222:225], a[176:179], a[144:147], 0
    v_mfma_f32_16x16x32_bf16 v[234:237], a[180:183], a[148:151], 0
    v_mfma_f32_16x16x32_bf16 v[242:245], a[184:187], a[148:151], 0
    v_mfma_f32_16x16x32_bf16 v[226:229], a[176:179], a[148:151], 0
    s_waitcnt lgkmcnt(0)
    s_barrier
    v_mfma_f32_16x16x32_bf16 v[182:185], a[152:155], a[192:195], v[182:185]
    ds_read_b64_tr_b16 a[180:181], v74 offset:0
    s_add_u32 m0, s59, 32768
    v_mfma_f32_16x16x32_bf16 v[190:193], a[152:155], a[196:199], v[190:193]
    ds_read_b64_tr_b16 a[182:183], v74 offset:256
    s_add_u32 s63, s63, 12288
    v_mfma_f32_16x16x32_bf16 v[186:189], a[156:159], a[192:195], v[186:189]
    ds_read_b128 a[128:131], v54 offset:0
    s_cmp_eq_u32 s63, 86016
    v_mfma_f32_16x16x32_bf16 v[194:197], a[156:159], a[196:199], v[194:197]
    ds_read_b64_tr_b16 a[184:185], v74 offset:1024
    v_mfma_f32_16x16x32_bf16 v[206:209], a[160:163], a[192:195], v[206:209]
    ds_read_b64_tr_b16 a[186:187], v74 offset:1280
    s_cselect_b32 s63, 0, s63
    v_mfma_f32_16x16x32_bf16 v[214:217], a[160:163], a[196:199], v[214:217]
    ds_read_b128 a[132:135], v54 offset:1024
    buffer_load_dwordx4 v80, s[28:31], s63 offen sc1 lds
    v_mfma_f32_16x16x32_bf16 v[198:201], a[160:163], a[188:191], v[198:201]
    ds_read_b128 a[136:139], v54 offset:2048
    v_mfma_f32_16x16x32_bf16 v[210:213], a[164:167], a[192:195], v[210:213]
    ds_read_b64_tr_b16 a[176:177], v75 offset:0
    buffer_load_dwordx4 v80, s[28:31], s63 offen offset:1024 sc1 lds
    v_mfma_f32_16x16x32_bf16 v[218:221], a[164:167], a[196:199], v[218:221]
    ds_read_b64_tr_b16 a[178:179], v75 offset:256
    v_mfma_f32_16x16x32_bf16 v[202:205], a[164:167], a[188:191], v[202:205]
    ds_read_b128 a[140:143], v54 offset:3072
    v_mfma_f32_16x16x32_bf16 v[230:233], a[192:195], a[168:171], v[230:233]
    ds_read_b128 a[144:147], v54 offset:4096
    buffer_load_dwordx4 v80, s[28:31], s63 offen offset:2048 sc1 lds
    v_mfma_f32_16x16x32_bf16 v[238:241], a[196:199], a[168:171], v[238:241]
    ds_read_b128 a[148:151], v54 offset:5120
    s_add_u32 m0, s100, 61440
    v_mfma_f32_16x16x32_bf16 v[222:225], a[188:191], a[168:171], v[222:225]
    s_add_u32 s62, s62, 262144
    s_cmp_eq_u32 s62, 1835008
    v_mfma_f32_16x16x32_bf16 v[234:237], a[192:195], a[172:175], v[234:237]
    s_cselect_b32 s62, 0, s62
    buffer_load_dwordx4 v69, s[28:31], s62 offen sc1 lds
    v_mfma_f32_16x16x32_bf16 v[242:245], a[196:199], a[172:175], v[242:245]
    s_add_u32 m0, s58, 45056
    v_mfma_f32_16x16x32_bf16 v[226:229], a[188:191], a[172:175], v[226:229]
    s_waitcnt lgkmcnt(6)
    v_mfma_f32_16x16x32_bf16 v[182:185], a[128:131], a[180:183], v[182:185]
    ds_read_b64_tr_b16 a[192:193], v74 offset:2048
    buffer_load_dwordx4 v67, s[28:31], s62 offen sc1 lds
    v_mfma_f32_16x16x32_bf16 v[190:193], a[128:131], a[184:187], v[190:193]
    ds_read_b64_tr_b16 a[194:195], v74 offset:2304
    v_mfma_f32_16x16x32_bf16 v[186:189], a[132:135], a[180:183], v[186:189]
    ds_read_b128 a[152:155], v54 offset:6144
    v_mfma_f32_16x16x32_bf16 v[194:197], a[132:135], a[184:187], v[194:197]
    ds_read_b64_tr_b16 a[196:197], v74 offset:3072
    s_waitcnt lgkmcnt(4)
    v_mfma_f32_16x16x32_bf16 v[206:209], a[136:139], a[180:183], v[206:209]
    ds_read_b64_tr_b16 a[198:199], v74 offset:3328
    buffer_load_dwordx4 v67, s[28:31], s62 offen offset:1024 sc1 lds
    v_mfma_f32_16x16x32_bf16 v[214:217], a[136:139], a[184:187], v[214:217]
    ds_read_b128 a[156:159], v54 offset:7168
    v_mfma_f32_16x16x32_bf16 v[198:201], a[136:139], a[176:179], v[198:201]
    ds_read_b128 a[160:163], v54 offset:8192
    buffer_load_dwordx4 v68, s[28:31], s62 offen offset:2048 sc1 lds
    v_mfma_f32_16x16x32_bf16 v[210:213], a[140:143], a[180:183], v[210:213]
    ds_read_b64_tr_b16 a[188:189], v75 offset:2048
    v_mfma_f32_16x16x32_bf16 v[218:221], a[140:143], a[184:187], v[218:221]
    ds_read_b64_tr_b16 a[190:191], v75 offset:2304
    v_mfma_f32_16x16x32_bf16 v[202:205], a[140:143], a[176:179], v[202:205]
    ds_read_b128 a[164:167], v54 offset:9216
    buffer_load_dwordx4 v68, s[28:31], s62 offen offset:3072 sc1 lds
    v_mfma_f32_16x16x32_bf16 v[230:233], a[180:183], a[144:147], v[230:233]
    ds_read_b128 a[168:171], v54 offset:10240
    s_add_u32 m0, s59, 98304
    v_mfma_f32_16x16x32_bf16 v[238:241], a[184:187], a[144:147], v[238:241]
    ds_read_b128 a[172:175], v54 offset:11264
    s_add_u32 s63, s63, 12288
    v_mfma_f32_16x16x32_bf16 v[222:225], a[176:179], a[144:147], v[222:225]
    s_cmp_eq_u32 s63, 86016
    s_cselect_b32 s63, 0, s63
    v_mfma_f32_16x16x32_bf16 v[234:237], a[180:183], a[148:151], v[234:237]
    buffer_load_dwordx4 v80, s[28:31], s63 offen sc1 lds
    v_mfma_f32_16x16x32_bf16 v[242:245], a[184:187], a[148:151], v[242:245]
    v_mfma_f32_16x16x32_bf16 v[226:229], a[176:179], a[148:151], v[226:229]
    s_waitcnt vmcnt(9) lgkmcnt(0)
    s_barrier
    s_cmp_lg_u32 s48, 0
    s_cbranch_scc1 L_sig2
    s_atomic_add s36, s[28:29], s68
L_sig2:
    v_mfma_f32_16x16x32_bf16 v[182:185], a[152:155], a[192:195], v[182:185]
    ds_read_b64_tr_b16 a[180:181], v70 offset:0
    buffer_load_dwordx4 v80, s[28:31], s63 offen offset:1024 sc1 lds
    v_mfma_f32_16x16x32_bf16 v[190:193], a[152:155], a[196:199], v[190:193]
    ds_read_b64_tr_b16 a[182:183], v70 offset:256
    v_mfma_f32_16x16x32_bf16 v[186:189], a[156:159], a[192:195], v[186:189]
    ds_read_b128 a[128:131], v4 offset:0
    buffer_load_dwordx4 v80, s[28:31], s63 offen offset:2048 sc1 lds
    v_mfma_f32_16x16x32_bf16 v[194:197], a[156:159], a[196:199], v[194:197]
    ds_read_b64_tr_b16 a[184:185], v70 offset:1024
    v_mfma_f32_16x16x32_bf16 v[206:209], a[160:163], a[192:195], v[206:209]
    ds_read_b64_tr_b16 a[186:187], v70 offset:1280
    s_add_u32 m0, s100, 126976
    v_mfma_f32_16x16x32_bf16 v[214:217], a[160:163], a[196:199], v[214:217]
    ds_read_b128 a[132:135], v4 offset:1024
    s_add_u32 s62, s62, 262144
    v_mfma_f32_16x16x32_bf16 v[198:201], a[160:163], a[188:191], v[198:201]
    ds_read_b128 a[136:139], v4 offset:2048
    s_cmp_eq_u32 s62, 1835008
    v_mfma_f32_16x16x32_bf16 v[210:213], a[164:167], a[192:195], v[210:213]
    ds_read_b64_tr_b16 a[176:177], v71 offset:0
    s_cselect_b32 s62, 0, s62
    v_mfma_f32_16x16x32_bf16 v[218:221], a[164:167], a[196:199], v[218:221]
    ds_read_b64_tr_b16 a[178:179], v71 offset:256
    buffer_load_dwordx4 v69, s[28:31], s62 offen sc1 lds
    v_mfma_f32_16x16x32_bf16 v[202:205], a[164:167], a[188:191], v[202:205]
    ds_read_b128 a[140:143], v4 offset:3072
    s_add_u32 m0, s58, 110592
    v_mfma_f32_16x16x32_bf16 v[230:233], a[192:195], a[168:171], v[230:233]
    ds_read_b128 a[144:147], v4 offset:4096
    buffer_load_dwordx4 v67, s[28:31], s62 offen sc1 lds
    v_mfma_f32_16x16x32_bf16 v[238:241], a[196:199], a[168:171], v[238:241]
    ds_read_b128 a[148:151], v4 offset:5120
    v_mfma_f32_16x16x32_bf16 v[222:225], a[188:191], a[168:171], v[222:225]
    v_mfma_f32_16x16x32_bf16 v[234:237], a[192:195], a[172:175], v[234:237]
    buffer_load_dwordx4 v67, s[28:31], s62 offen offset:1024 sc1 lds
    v_mfma_f32_16x16x32_bf16 v[242:245], a[196:199], a[172:175], v[242:245]
    v_mfma_f32_16x16x32_bf16 v[226:229], a[188:191], a[172:175], v[226:229]
    s_waitcnt lgkmcnt(6)
    v_mfma_f32_16x16x32_bf16 v[182:185], a[128:131], a[180:183], v[182:185]
    ds_read_b64_tr_b16 a[192:193], v70 offset:2048
    buffer_load_dwordx4 v68, s[28:31], s62 offen offset:2048 sc1 lds
    v_mfma_f32_16x16x32_bf16 v[190:193], a[128:131], a[184:187], v[190:193]
    ds_read_b64_tr_b16 a[194:195], v70 offset:2304
    v_mfma_f32_16x16x32_bf16 v[186:189], a[132:135], a[180:183], v[186:189]
    ds_read_b128 a[152:155], v4 offset:6144
    v_mfma_f32_16x16x32_bf16 v[194:197], a[132:135], a[184:187], v[194:197]
    ds_read_b64_tr_b16 a[196:197], v70 offset:3072
    s_waitcnt lgkmcnt(4)
    v_mfma_f32_16x16x32_bf16 v[206:209], a[136:139], a[180:183], v[206:209]
    ds_read_b64_tr_b16 a[198:199], v70 offset:3328
    buffer_load_dwordx4 v68, s[28:31], s62 offen offset:3072 sc1 lds
    v_mfma_f32_16x16x32_bf16 v[214:217], a[136:139], a[184:187], v[214:217]
    ds_read_b128 a[156:159], v4 offset:7168
    s_add_u32 m0, s59, 131072
    v_mfma_f32_16x16x32_bf16 v[198:201], a[136:139], a[176:179], v[198:201]
    ds_read_b128 a[160:163], v4 offset:8192
    s_add_u32 s63, s63, 12288
    v_mfma_f32_16x16x32_bf16 v[210:213], a[140:143], a[180:183], v[210:213]
    ds_read_b64_tr_b16 a[188:189], v71 offset:2048
    s_cmp_eq_u32 s63, 86016
    v_mfma_f32_16x16x32_bf16 v[218:221], a[140:143], a[184:187], v[218:221]
    ds_read_b64_tr_b16 a[190:191], v71 offset:2304
    s_cselect_b32 s63, 0, s63
    v_mfma_f32_16x16x32_bf16 v[202:205], a[140:143], a[176:179], v[202:205]
    ds_read_b128 a[164:167], v4 offset:9216
    buffer_load_dwordx4 v80, s[28:31], s63 offen sc1 lds
    v_mfma_f32_16x16x32_bf16 v[230:233], a[180:183], a[144:147], v[230:233]
    ds_read_b128 a[168:171], v4 offset:10240
    v_mfma_f32_16x16x32_bf16 v[238:241], a[184:187], a[144:147], v[238:241]
    ds_read_b128 a[172:175], v4 offset:11264
    buffer_load_dwordx4 v80, s[28:31], s63 offen offset:1024 sc1 lds
    v_mfma_f32_16x16x32_bf16 v[222:225], a[176:179], a[144:147], v[222:225]
    v_mfma_f32_16x16x32_bf16 v[234:237], a[180:183], a[148:151], v[234:237]
    v_mfma_f32_16x16x32_bf16 v[242:245], a[184:187], a[148:151], v[242:245]
    buffer_load_dwordx4 v80, s[28:31], s63 offen offset:2048 sc1 lds
    s_add_u32 m0, s100, 159744
    v_mfma_f32_16x16x32_bf16 v[226:229], a[176:179], a[148:151], v[226:229]
    s_add_u32 s62, s62, 262144
    ds_read_b32 v24, v4
    s_waitcnt lgkmcnt(1)
    s_barrier
    v_mfma_f32_16x16x32_bf16 v[182:185], a[152:155], a[192:195], v[182:185]
    ds_read_b64_tr_b16 a[180:181], v72 offset:0
    s_cmp_eq_u32 s62, 1835008
    v_mfma_f32_16x16x32_bf16 v[190:193], a[152:155], a[196:199], v[190:193]
    ds_read_b64_tr_b16 a[182:183], v72 offset:256
    s_cselect_b32 s62, 0, s62
    v_mfma_f32_16x16x32_bf16 v[186:189], a[156:159], a[192:195], v[186:189]
    ds_read_b128 a[128:131], v53 offset:0
    buffer_load_dwordx4 v69, s[28:31], s62 offen sc1 lds
    v_mfma_f32_16x16x32_bf16 v[194:197], a[156:159], a[196:199], v[194:197]
    ds_read_b64_tr_b16 a[184:185], v72 offset:1024
    v_mfma_f32_16x16x32_bf16 v[206:209], a[160:163], a[192:195], v[206:209]
    ds_read_b64_tr_b16 a[186:187], v72 offset:1280
    s_add_u32 m0, s58, 143360
    v_mfma_f32_16x16x32_bf16 v[214:217], a[160:163], a[196:199], v[214:217]
    ds_read_b128 a[132:135], v53 offset:1024
    buffer_load_dwordx4 v67, s[28:31], s62 offen sc1 lds
    v_mfma_f32_16x16x32_bf16 v[198:201], a[160:163], a[188:191], v[198:201]
    ds_read_b128 a[136:139], v53 offset:2048
    v_mfma_f32_16x16x32_bf16 v[210:213], a[164:167], a[192:195], v[210:213]
    ds_read_b64_tr_b16 a[176:177], v73 offset:0
    buffer_load_dwordx4 v67, s[28:31], s62 offen offset:1024 sc1 lds
    v_mfma_f32_16x16x32_bf16 v[218:221], a[164:167], a[196:199], v[218:221]
    ds_read_b64_tr_b16 a[178:179], v73 offset:256
    v_mfma_f32_16x16x32_bf16 v[202:205], a[164:167], a[188:191], v[202:205]
    ds_read_b128 a[140:143], v53 offset:3072
    v_mfma_f32_16x16x32_bf16 v[230:233], a[192:195], a[168:171], v[230:233]
    ds_read_b128 a[144:147], v53 offset:4096
    buffer_load_dwordx4 v68, s[28:31], s62 offen offset:2048 sc1 lds
    v_mfma_f32_16x16x32_bf16 v[238:241], a[196:199], a[168:171], v[238:241]
    ds_read_b128 a[148:151], v53 offset:5120
    v_mfma_f32_16x16x32_bf16 v[222:225], a[188:191], a[168:171], v[222:225]
    v_mfma_f32_16x16x32_bf16 v[234:237], a[192:195], a[172:175], v[234:237]
    buffer_load_dwordx4 v68, s[28:31], s62 offen offset:3072 sc1 lds
    s_add_u32 m0, s58, 0
    v_mfma_f32_16x16x32_bf16 v[242:245], a[196:199], a[172:175], v[242:245]
    v_mfma_f32_16x16x32_bf16 v[226:229], a[188:191], a[172:175], v[226:229]
    s_waitcnt lgkmcnt(6)
    v_mfma_f32_16x16x32_bf16 v[182:185], a[128:131], a[180:183], v[182:185]
    ds_read_b64_tr_b16 a[192:193], v72 offset:2048
    buffer_load_dwordx4 v59, s[24:27], s64 offen lds
    v_mfma_f32_16x16x32_bf16 v[190:193], a[128:131], a[184:187], v[190:193]
    ds_read_b64_tr_b16 a[194:195], v72 offset:2304
    v_mfma_f32_16x16x32_bf16 v[186:189], a[132:135], a[180:183], v[186:189]
    ds_read_b128 a[152:155], v53 offset:6144
    v_mfma_f32_16x16x32_bf16 v[194:197], a[132:135], a[184:187], v[194:197]
    ds_read_b64_tr_b16 a[196:197], v72 offset:3072
    s_waitcnt lgkmcnt(4)
    v_mfma_f32_16x16x32_bf16 v[206:209], a[136:139], a[180:183], v[206:209]
    ds_read_b64_tr_b16 a[198:199], v72 offset:3328
    buffer_load_dwordx4 v60, s[24:27], s64 offen offset:1024 lds
    v_mfma_f32_16x16x32_bf16 v[214:217], a[136:139], a[184:187], v[214:217]
    ds_read_b128 a[156:159], v53 offset:7168
    v_mfma_f32_16x16x32_bf16 v[198:201], a[136:139], a[176:179], v[198:201]
    ds_read_b128 a[160:163], v53 offset:8192
    v_mfma_f32_16x16x32_bf16 v[210:213], a[140:143], a[180:183], v[210:213]
    ds_read_b64_tr_b16 a[188:189], v73 offset:2048
    buffer_load_dwordx4 v61, s[24:27], s64 offen offset:2048 lds
    v_mfma_f32_16x16x32_bf16 v[218:221], a[140:143], a[184:187], v[218:221]
    ds_read_b64_tr_b16 a[190:191], v73 offset:2304
    v_mfma_f32_16x16x32_bf16 v[202:205], a[140:143], a[176:179], v[202:205]
    ds_read_b128 a[164:167], v53 offset:9216
    v_mfma_f32_16x16x32_bf16 v[230:233], a[180:183], a[144:147], v[230:233]
    ds_read_b128 a[168:171], v53 offset:10240
    buffer_load_dwordx4 v62, s[24:27], s64 offen offset:3072 lds
    v_mfma_f32_16x16x32_bf16 v[238:241], a[184:187], a[144:147], v[238:241]
    ds_read_b128 a[172:175], v53 offset:11264
    s_add_u32 m0, s58, 16384
    v_mfma_f32_16x16x32_bf16 v[222:225], a[176:179], a[144:147], v[222:225]
    v_xor_b32 v59, 128, v59
    v_mfma_f32_16x16x32_bf16 v[234:237], a[180:183], a[148:151], v[234:237]
    buffer_load_dwordx4 v59, s[24:27], s64 offen lds
    v_xor_b32 v60, 128, v60
    v_mfma_f32_16x16x32_bf16 v[242:245], a[184:187], a[148:151], v[242:245]
    v_mfma_f32_16x16x32_bf16 v[226:229], a[176:179], a[148:151], v[226:229]
    ds_read_b32 v24, v4
    s_waitcnt vmcnt(21) lgkmcnt(1)
    s_barrier
    v_mfma_f32_16x16x32_bf16 v[182:185], a[152:155], a[192:195], v[182:185]
    ds_read_b64_tr_b16 a[180:181], v70 offset:32768
    buffer_load_dwordx4 v60, s[24:27], s64 offen offset:1024 lds
    v_mfma_f32_16x16x32_bf16 v[190:193], a[152:155], a[196:199], v[190:193]
    ds_read_b64_tr_b16 a[182:183], v70 offset:33024
    v_xor_b32 v61, 128, v61
    v_mfma_f32_16x16x32_bf16 v[186:189], a[156:159], a[192:195], v[186:189]
    ds_read_b128 a[128:131], v4 offset:32768
    v_mfma_f32_16x16x32_bf16 v[194:197], a[156:159], a[196:199], v[194:197]
    ds_read_b64_tr_b16 a[184:185], v70 offset:33792
    v_mfma_f32_16x16x32_bf16 v[206:209], a[160:163], a[192:195], v[206:209]
    ds_read_b64_tr_b16 a[186:187], v70 offset:34048
    buffer_load_dwordx4 v61, s[24:27], s64 offen offset:2048 lds
    v_mfma_f32_16x16x32_bf16 v[214:217], a[160:163], a[196:199], v[214:217]
    ds_read_b128 a[132:135], v4 offset:33792
    v_xor_b32 v62, 128, v62
    v_mfma_f32_16x16x32_bf16 v[198:201], a[160:163], a[188:191], v[198:201]
    ds_read_b128 a[136:139], v4 offset:34816
    buffer_load_dwordx4 v62, s[24:27], s64 offen offset:3072 lds
    v_mfma_f32_16x16x32_bf16 v[210:213], a[164:167], a[192:195], v[210:213]
    ds_read_b64_tr_b16 a[176:177], v71 offset:32768
    s_add_u32 m0, s58, 65536
    v_mfma_f32_16x16x32_bf16 v[218:221], a[164:167], a[196:199], v[218:221]
    ds_read_b64_tr_b16 a[178:179], v71 offset:33024
    s_add_u32 s64, s64, 524288
    v_mfma_f32_16x16x32_bf16 v[202:205], a[164:167], a[188:191], v[202:205]
    ds_read_b128 a[140:143], v4 offset:35840
    s_cmp_eq_u32 s64, 3670016
    v_mfma_f32_16x16x32_bf16 v[230:233], a[192:195], a[168:171], v[230:233]
    ds_read_b128 a[144:147], v4 offset:36864
    s_cselect_b32 s64, 0, s64
    v_mfma_f32_16x16x32_bf16 v[238:241], a[196:199], a[168:171], v[238:241]
    ds_read_b128 a[148:151], v4 offset:37888
    buffer_load_dwordx4 v59, s[24:27], s64 offen lds
    v_mfma_f32_16x16x32_bf16 v[222:225], a[188:191], a[168:171], v[222:225]
    v_mfma_f32_16x16x32_bf16 v[234:237], a[192:195], a[172:175], v[234:237]
    buffer_load_dwordx4 v60, s[24:27], s64 offen offset:1024 lds
    v_mfma_f32_16x16x32_bf16 v[242:245], a[196:199], a[172:175], v[242:245]
    v_mfma_f32_16x16x32_bf16 v[226:229], a[188:191], a[172:175], v[226:229]
    s_waitcnt lgkmcnt(6)
    v_mfma_f32_16x16x32_bf16 v[182:185], a[128:131], a[180:183], v[182:185]
    ds_read_b64_tr_b16 a[192:193], v70 offset:34816
    buffer_load_dwordx4 v61, s[24:27], s64 offen offset:2048 lds
    v_mfma_f32_16x16x32_bf16 v[190:193], a[128:131], a[184:187], v[190:193]
    ds_read_b64_tr_b16 a[194:195], v70 offset:35072
    v_mfma_f32_16x16x32_bf16 v[186:189], a[132:135], a[180:183], v[186:189]
    ds_read_b128 a[152:155], v4 offset:38912
    v_mfma_f32_16x16x32_bf16 v[194:197], a[132:135], a[184:187], v[194:197]
    ds_read_b64_tr_b16 a[196:197], v70 offset:35840
    s_waitcnt lgkmcnt(4)
    v_mfma_f32_16x16x32_bf16 v[206:209], a[136:139], a[180:183], v[206:209]
    ds_read_b64_tr_b16 a[198:199], v70 offset:36096
    buffer_load_dwordx4 v62, s[24:27], s64 offen offset:3072 lds
    v_mfma_f32_16x16x32_bf16 v[214:217], a[136:139], a[184:187], v[214:217]
    ds_read_b128 a[156:159], v4 offset:39936
    s_add_u32 m0, s58, 81920
    v_mfma_f32_16x16x32_bf16 v[198:201], a[136:139], a[176:179], v[198:201]
    ds_read_b128 a[160:163], v4 offset:40960
    s_add_u32 s64, s64, 524288
    v_mfma_f32_16x16x32_bf16 v[210:213], a[140:143], a[180:183], v[210:213]
    ds_read_b64_tr_b16 a[188:189], v71 offset:34816
    s_cmp_eq_u32 s64, 3670016
    v_mfma_f32_16x16x32_bf16 v[218:221], a[140:143], a[184:187], v[218:221]
    ds_read_b64_tr_b16 a[190:191], v71 offset:35072
    s_cselect_b32 s64, 0, s64
    v_mfma_f32_16x16x32_bf16 v[202:205], a[140:143], a[176:179], v[202:205]
    ds_read_b128 a[164:167], v4 offset:41984
    buffer_load_dwordx4 v59, s[24:27], s64 offen lds
    v_mfma_f32_16x16x32_bf16 v[230:233], a[180:183], a[144:147], v[230:233]
    ds_read_b128 a[168:171], v4 offset:43008
    v_mfma_f32_16x16x32_bf16 v[238:241], a[184:187], a[144:147], v[238:241]
    ds_read_b128 a[172:175], v4 offset:44032
    buffer_load_dwordx4 v60, s[24:27], s64 offen offset:1024 lds
    v_mfma_f32_16x16x32_bf16 v[222:225], a[176:179], a[144:147], v[222:225]
    v_mfma_f32_16x16x32_bf16 v[234:237], a[180:183], a[148:151], v[234:237]
    v_mfma_f32_16x16x32_bf16 v[242:245], a[184:187], a[148:151], v[242:245]
    buffer_load_dwordx4 v61, s[24:27], s64 offen offset:2048 lds
    v_mfma_f32_16x16x32_bf16 v[226:229], a[176:179], a[148:151], v[226:229]
    ds_read_b32 v24, v4
    s_waitcnt vmcnt(23) lgkmcnt(1)
    s_barrier
    v_mfma_f32_16x16x32_bf16 v[182:185], a[152:155], a[192:195], v[182:185]
    ds_read_b64_tr_b16 a[180:181], v72 offset:32768
    v_mfma_f32_16x16x32_bf16 v[190:193], a[152:155], a[196:199], v[190:193]
    ds_read_b64_tr_b16 a[182:183], v72 offset:33024
    buffer_load_dwordx4 v62, s[24:27], s64 offen offset:3072 lds
    v_mfma_f32_16x16x32_bf16 v[186:189], a[156:159], a[192:195], v[186:189]
    ds_read_b128 a[128:131], v53 offset:32768
    s_add_u32 m0, s58, 32768
    v_mfma_f32_16x16x32_bf16 v[194:197], a[156:159], a[196:199], v[194:197]
    ds_read_b64_tr_b16 a[184:185], v72 offset:33792
    v_mfma_f32_16x16x32_bf16 v[206:209], a[160:163], a[192:195], v[206:209]
    ds_read_b64_tr_b16 a[186:187], v72 offset:34048
    s_add_u32 s64, s64, 524288
    v_mfma_f32_16x16x32_bf16 v[214:217], a[160:163], a[196:199], v[214:217]
    ds_read_b128 a[132:135], v53 offset:33792
    s_cmp_eq_u32 s64, 3670016
    v_mfma_f32_16x16x32_bf16 v[198:201], a[160:163], a[188:191], v[198:201]
    ds_read_b128 a[136:139], v53 offset:34816
    s_cselect_b32 s64, 0, s64
    v_mfma_f32_16x16x32_bf16 v[210:213], a[164:167], a[192:195], v[210:213]
    ds_read_b64_tr_b16 a[176:177], v73 offset:32768
    buffer_load_dwordx4 v59, s[24:27], s64 offen lds
    v_mfma_f32_16x16x32_bf16 v[218:221], a[164:167], a[196:199], v[218:221]
    ds_read_b64_tr_b16 a[178:179], v73 offset:33024
    v_mfma_f32_16x16x32_bf16 v[202:205], a[164:167], a[188:191], v[202:205]
    ds_read_b128 a[140:143], v53 offset:35840
    buffer_load_dwordx4 v60, s[24:27], s64 offen offset:1024 lds
    v_mfma_f32_16x16x32_bf16 v[230:233], a[192:195], a[168:171], v[230:233]
    ds_read_b128 a[144:147], v53 offset:36864
    v_mfma_f32_16x16x32_bf16 v[238:241], a[196:199], a[168:171], v[238:241]
    ds_read_b128 a[148:151], v53 offset:37888
    v_mfma_f32_16x16x32_bf16 v[222:225], a[188:191], a[168:171], v[222:225]
    buffer_load_dwordx4 v61, s[24:27], s64 offen offset:2048 lds
    v_mfma_f32_16x16x32_bf16 v[234:237], a[192:195], a[172:175], v[234:237]
    v_mfma_f32_16x16x32_bf16 v[242:245], a[196:199], a[172:175], v[242:245]
    v_mfma_f32_16x16x32_bf16 v[226:229], a[188:191], a[172:175], v[226:229]
    buffer_load_dwordx4 v62, s[24:27], s64 offen offset:3072 lds
    s_load_dword s14, s[28:29], s38
    s_waitcnt lgkmcnt(6)
    v_mfma_f32_16x16x32_bf16 v[182:185], a[128:131], a[180:183], v[182:185]
    ds_read_b64_tr_b16 a[192:193], v72 offset:34816
    s_add_u32 m0, s58, 49152
    v_mfma_f32_16x16x32_bf16 v[190:193], a[128:131], a[184:187], v[190:193]
    ds_read_b64_tr_b16 a[194:195], v72 offset:35072
    s_add_u32 s64, s64, 524288
    v_mfma_f32_16x16x32_bf16 v[186:189], a[132:135], a[180:183], v[186:189]
    ds_read_b128 a[152:155], v53 offset:38912
    s_cmp_eq_u32 s64, 3670016
    v_mfma_f32_16x16x32_bf16 v[194:197], a[132:135], a[184:187], v[194:197]
    ds_read_b64_tr_b16 a[196:197], v72 offset:35840
    s_waitcnt lgkmcnt(4)
    v_mfma_f32_16x16x32_bf16 v[206:209], a[136:139], a[180:183], v[206:209]
    ds_read_b64_tr_b16 a[198:199], v72 offset:36096
    s_cselect_b32 s64, 0, s64
    v_mfma_f32_16x16x32_bf16 v[214:217], a[136:139], a[184:187], v[214:217]
    ds_read_b128 a[156:159], v53 offset:39936
    buffer_load_dwordx4 v59, s[24:27], s64 offen lds
    v_mfma_f32_16x16x32_bf16 v[198:201], a[136:139], a[176:179], v[198:201]
    ds_read_b128 a[160:163], v53 offset:40960
    v_mfma_f32_16x16x32_bf16 v[210:213], a[140:143], a[180:183], v[210:213]
    ds_read_b64_tr_b16 a[188:189], v73 offset:34816
    buffer_load_dwordx4 v60, s[24:27], s64 offen offset:1024 lds
    v_mfma_f32_16x16x32_bf16 v[218:221], a[140:143], a[184:187], v[218:221]
L_pad2:
    s_cbranch_execz L_warm
    ds_read_b64_tr_b16 a[190:191], v73 offset:35072
    v_mfma_f32_16x16x32_bf16 v[202:205], a[140:143], a[176:179], v[202:205]
    ds_read_b128 a[164:167], v53 offset:41984
    v_mfma_f32_16x16x32_bf16 v[230:233], a[180:183], a[144:147], v[230:233]
    ds_read_b128 a[168:171], v53 offset:43008
    buffer_load_dwordx4 v61, s[24:27], s64 offen offset:2048 lds
    v_mfma_f32_16x16x32_bf16 v[238:241], a[184:187], a[144:147], v[238:241]
    ds_read_b128 a[172:175], v53 offset:44032
    v_mfma_f32_16x16x32_bf16 v[222:225], a[176:179], a[144:147], v[222:225]
    v_mfma_f32_16x16x32_bf16 v[234:237], a[180:183], a[148:151], v[234:237]
    buffer_load_dwordx4 v62, s[24:27], s64 offen offset:3072 lds
    v_mfma_f32_16x16x32_bf16 v[242:245], a[184:187], a[148:151], v[242:245]
    v_mfma_f32_16x16x32_bf16 v[226:229], a[176:179], a[148:151], v[226:229]
    ds_read_b32 v24, v4
    s_waitcnt vmcnt(24) lgkmcnt(1)
    s_barrier
    v_mfma_f32_16x16x32_bf16 v[182:185], a[152:155], a[192:195], v[182:185]
    ds_read_b64_tr_b16 a[180:181], v74 offset:0
    s_add_u32 m0, s58, 98304
    v_mfma_f32_16x16x32_bf16 v[190:193], a[152:155], a[196:199], v[190:193]
    ds_read_b64_tr_b16 a[182:183], v74 offset:256
    s_add_u32 s64, s64, 524288
    v_mfma_f32_16x16x32_bf16 v[186:189], a[156:159], a[192:195], v[186:189]
    ds_read_b128 a[128:131], v54 offset:0
    s_cmp_eq_u32 s64, 3670016
    v_mfma_f32_16x16x32_bf16 v[194:197], a[156:159], a[196:199], v[194:197]
    ds_read_b64_tr_b16 a[184:185], v74 offset:1024
    v_mfma_f32_16x16x32_bf16 v[206:209], a[160:163], a[192:195], v[206:209]
    ds_read_b64_tr_b16 a[186:187], v74 offset:1280
    s_cselect_b32 s64, 0, s64
    v_mfma_f32_16x16x32_bf16 v[214:217], a[160:163], a[196:199], v[214:217]
    ds_read_b128 a[132:135], v54 offset:1024
    buffer_load_dwordx4 v59, s[24:27], s64 offen lds
    v_mfma_f32_16x16x32_bf16 v[198:201], a[160:163], a[188:191], v[198:201]
    ds_read_b128 a[136:139], v54 offset:2048
    v_mfma_f32_16x16x32_bf16 v[210:213], a[164:167], a[192:195], v[210:213]
    ds_read_b64_tr_b16 a[176:177], v75 offset:0
    buffer_load_dwordx4 v60, s[24:27], s64 offen offset:1024 lds
    v_mfma_f32_16x16x32_bf16 v[218:221], a[164:167], a[196:199], v[218:221]
    ds_read_b64_tr_b16 a[178:179], v75 offset:256
    v_mfma_f32_16x16x32_bf16 v[202:205], a[164:167], a[188:191], v[202:205]
    ds_read_b128 a[140:143], v54 offset:3072
    v_mfma_f32_16x16x32_bf16 v[230:233], a[192:195], a[168:171], v[230:233]
    ds_read_b128 a[144:147], v54 offset:4096
    buffer_load_dwordx4 v61, s[24:27], s64 offen offset:2048 lds
    v_mfma_f32_16x16x32_bf16 v[238:241], a[196:199], a[168:171], v[238:241]
    ds_read_b128 a[148:151], v54 offset:5120
    v_mfma_f32_16x16x32_bf16 v[222:225], a[188:191], a[168:171], v[222:225]
    v_mfma_f32_16x16x32_bf16 v[234:237], a[192:195], a[172:175], v[234:237]
    buffer_load_dwordx4 v62, s[24:27], s64 offen offset:3072 lds
    s_add_u32 m0, s58, 114688
    v_mfma_f32_16x16x32_bf16 v[242:245], a[196:199], a[172:175], v[242:245]
    s_add_u32 s64, s64, 524288
    s_cmp_eq_u32 s64, 3670016
    v_mfma_f32_16x16x32_bf16 v[226:229], a[188:191], a[172:175], v[226:229]
    s_cselect_b32 s64, 0, s64
    s_waitcnt lgkmcnt(6)
    v_mfma_f32_16x16x32_bf16 v[182:185], a[128:131], a[180:183], v[182:185]
    ds_read_b64_tr_b16 a[192:193], v74 offset:2048
    buffer_load_dwordx4 v59, s[24:27], s64 offen lds
    v_mfma_f32_16x16x32_bf16 v[190:193], a[128:131], a[184:187], v[190:193]
    ds_read_b64_tr_b16 a[194:195], v74 offset:2304
    v_mfma_f32_16x16x32_bf16 v[186:189], a[132:135], a[180:183], v[186:189]
    ds_read_b128 a[152:155], v54 offset:6144
    v_mfma_f32_16x16x32_bf16 v[194:197], a[132:135], a[184:187], v[194:197]
    ds_read_b64_tr_b16 a[196:197], v74 offset:3072
    s_waitcnt lgkmcnt(4)
    v_mfma_f32_16x16x32_bf16 v[206:209], a[136:139], a[180:183], v[206:209]
    ds_read_b64_tr_b16 a[198:199], v74 offset:3328
    buffer_load_dwordx4 v60, s[24:27], s64 offen offset:1024 lds
    v_mfma_f32_16x16x32_bf16 v[214:217], a[136:139], a[184:187], v[214:217]
    ds_read_b128 a[156:159], v54 offset:7168
    v_mfma_f32_16x16x32_bf16 v[198:201], a[136:139], a[176:179], v[198:201]
    ds_read_b128 a[160:163], v54 offset:8192
    buffer_load_dwordx4 v61, s[24:27], s64 offen offset:2048 lds
    v_mfma_f32_16x16x32_bf16 v[210:213], a[140:143], a[180:183], v[210:213]
    ds_read_b64_tr_b16 a[188:189], v75 offset:2048
    v_mfma_f32_16x16x32_bf16 v[218:221], a[140:143], a[184:187], v[218:221]
    ds_read_b64_tr_b16 a[190:191], v75 offset:2304
    v_mfma_f32_16x16x32_bf16 v[202:205], a[140:143], a[176:179], v[202:205]
    ds_read_b128 a[164:167], v54 offset:9216
    buffer_load_dwordx4 v62, s[24:27], s64 offen offset:3072 lds
    v_mfma_f32_16x16x32_bf16 v[230:233], a[180:183], a[144:147], v[230:233]
    ds_read_b128 a[168:171], v54 offset:10240
    v_mfma_f32_16x16x32_bf16 v[238:241], a[184:187], a[144:147], v[238:241]
    ds_read_b128 a[172:175], v54 offset:11264
    v_mfma_f32_16x16x32_bf16 v[222:225], a[176:179], a[144:147], v[222:225]
    v_mfma_f32_16x16x32_bf16 v[234:237], a[180:183], a[148:151], v[234:237]
    v_mfma_f32_16x16x32_bf16 v[242:245], a[184:187], a[148:151], v[242:245]
    v_mfma_f32_16x16x32_bf16 v[226:229], a[176:179], a[148:151], v[226:229]
    s_waitcnt lgkmcnt(0)
    s_cmp_ge_u32 s14, 7
    s_cbranch_scc0 L_pollin5
L_pollok5:
    s_waitcnt vmcnt(16)
    s_barrier
    v_mfma_f32_16x16x32_bf16 v[182:185], a[152:155], a[192:195], v[182:185]
    ds_read_b64_tr_b16 a[200:201], v31 offset:16384
    buffer_load_dwordx4 a[0:3], v79, s[28:31], s65 offen offset:0 sc1
    v_mfma_f32_16x16x32_bf16 v[190:193], a[152:155], a[196:199], v[190:193]
    ds_read_b64_tr_b16 a[202:203], v31 offset:18432
    v_mfma_f32_16x16x32_bf16 v[186:189], a[156:159], a[192:195], v[186:189]
    ds_read_b64_tr_b16 a[204:205], v33 offset:16384
    buffer_load_dwordx4 a[4:7], v79, s[28:31], s65 offen offset:1024 sc1
    v_mfma_f32_16x16x32_bf16 v[194:197], a[156:159], a[196:199], v[194:197]
    ds_read_b64_tr_b16 a[206:207], v33 offset:18432
    v_mfma_f32_16x16x32_bf16 v[206:209], a[160:163], a[192:195], v[206:209]
    ds_read_b64_tr_b16 a[208:209], v32 offset:16384
    v_mfma_f32_16x16x32_bf16 v[214:217], a[160:163], a[196:199], v[214:217]
    ds_read_b64_tr_b16 a[210:211], v32 offset:18432
    v_mfma_f32_16x16x32_bf16 v[198:201], a[160:163], a[188:191], v[198:201]
    ds_read_b64_tr_b16 a[212:213], v34 offset:16384
    buffer_load_dwordx4 a[8:11], v79, s[28:31], s65 offen offset:2048 sc1
    v_mfma_f32_16x16x32_bf16 v[210:213], a[164:167], a[192:195], v[210:213]
    ds_read_b64_tr_b16 a[214:215], v34 offset:18432
    v_mfma_f32_16x16x32_bf16 v[218:221], a[164:167], a[196:199], v[218:221]
    ds_read_b64_tr_b16 a[216:217], v31 offset:20480
    v_mfma_f32_16x16x32_bf16 v[202:205], a[164:167], a[188:191], v[202:205]
    ds_read_b64_tr_b16 a[218:219], v31 offset:22528
    buffer_load_dwordx4 a[12:15], v79, s[28:31], s65 offen offset:3072 sc1
    v_mfma_f32_16x16x32_bf16 v[230:233], a[192:195], a[168:171], v[230:233]
    ds_read_b64_tr_b16 a[220:221], v33 offset:20480
    s_add_u32 s65, s65, 8192
    v_mfma_f32_16x16x32_bf16 v[238:241], a[196:199], a[168:171], v[238:241]
    ds_read_b64_tr_b16 a[222:223], v33 offset:22528
    s_cmp_eq_u32 s65, 57344
    v_mfma_f32_16x16x32_bf16 v[222:225], a[188:191], a[168:171], v[222:225]
    s_cselect_b32 s65, 0, s65
    v_mfma_f32_16x16x32_bf16 v[234:237], a[192:195], a[172:175], v[234:237]
    buffer_load_dwordx4 a[16:19], v79, s[28:31], s65 offen offset:0 sc1
    v_mfma_f32_16x16x32_bf16 v[242:245], a[196:199], a[172:175], v[242:245]
    v_mfma_f32_16x16x32_bf16 v[226:229], a[188:191], a[172:175], v[226:229]
    v_cvt_pk_bf16_f32 v118, v182, v183
    v_cvt_pk_bf16_f32 v119, v184, v185
    v_cvt_pk_bf16_f32 v120, v186, v187
    buffer_load_dwordx4 a[20:23], v79, s[28:31], s65 offen offset:1024 sc1
    v_cvt_pk_bf16_f32 v121, v188, v189
    v_cvt_pk_bf16_f32 v122, v190, v191
    v_cvt_pk_bf16_f32 v123, v192, v193
    v_cvt_pk_bf16_f32 v124, v194, v195
    v_cvt_pk_bf16_f32 v125, v196, v197
    v_cvt_pk_bf16_f32 v130, v206, v207
    v_cvt_pk_bf16_f32 v131, v208, v209
    v_cvt_pk_bf16_f32 v132, v210, v211
    v_cvt_pk_bf16_f32 v133, v212, v213
    v_cvt_pk_bf16_f32 v134, v214, v215
    v_cvt_pk_bf16_f32 v135, v216, v217
    v_cvt_pk_bf16_f32 v136, v218, v219
    v_cvt_pk_bf16_f32 v137, v220, v221
    v_cvt_pk_bf16_f32 v126, v198, v199
    buffer_load_dwordx4 a[24:27], v79, s[28:31], s65 offen offset:2048 sc1
    v_cvt_pk_bf16_f32 v127, v200, v201
    v_cvt_pk_bf16_f32 v128, v202, v203
    v_cvt_pk_bf16_f32 v129, v204, v205
    v_mfma_f32_16x16x32_bf16 v[154:157], v[130:133], v[118:121], 0
    v_mfma_f32_16x16x32_bf16 v[158:161], v[130:133], v[122:125], 0
    v_mfma_f32_16x16x32_bf16 v[162:165], v[134:137], v[122:125], 0
    buffer_load_dwordx4 a[28:31], v79, s[28:31], s65 offen offset:3072 sc1
    v_mfma_f32_16x16x32_bf16 v[150:153], v[126:129], v[118:121], 0
    v_cvt_pk_bf16_f32 v166, v222, v223
    v_cvt_pk_bf16_f32 v167, v224, v225
    v_cvt_pk_bf16_f32 v168, v230, v231
    v_cvt_pk_bf16_f32 v169, v232, v233
    v_cvt_pk_bf16_f32 v170, v238, v239
    v_cvt_pk_bf16_f32 v171, v240, v241
    v_cndmask_b32 v250, v158, v159, s[70:71]
    v_cndmask_b32 v253, v162, v163, s[70:71]
    v_cndmask_b32 v250, v250, v253, s[72:73]
    s_add_u32 s65, s65, 8192
    s_cmp_eq_u32 s65, 57344
    s_cselect_b32 s65, 0, s65
    buffer_load_dwordx4 a[32:35], v79, s[28:31], s65 offen offset:0 sc1
    v_mul_f32 v250, v250, v29
    v_cndmask_b32 v251, v160, v161, s[70:71]
    v_cndmask_b32 v253, v164, v165, s[70:71]
    v_cndmask_b32 v251, v251, v253, s[74:75]
    v_mul_f32 v251, v251, v30
    v_cndmask_b32 v246, v150, v151, s[70:71]
    v_cndmask_b32 v246, v84, v246, s[76:77]
    v_cndmask_b32 v249, v154, v155, s[70:71]
    v_cndmask_b32 v246, v246, v249, s[72:73]
    v_mul_f32 v246, v246, v27
    v_cndmask_b32 v247, v152, v153, s[70:71]
    v_cndmask_b32 v247, v84, v247, s[76:77]
    v_cndmask_b32 v249, v156, v157, s[70:71]
    v_cndmask_b32 v247, v247, v249, s[74:75]
    buffer_load_dwordx4 a[36:39], v79, s[28:31], s65 offen offset:1024 sc1
    v_mul_f32 v247, v247, v28
    v_max_f32 v248, v246, v247
    v_max_f32 v252, v250, v251
    v_mov_b32 v249, v248
    v_mov_b32 v253, v252
    v_cvt_pk_bf16_f32 v172, v226, v227
    v_permlane16_swap_b32 v248, v249
    v_permlane16_swap_b32 v252, v253
    v_max_f32 v248, v248, v249
    v_max_f32 v252, v252, v253
    v_mov_b32 v249, v248
    v_mov_b32 v253, v252
    v_cvt_pk_bf16_f32 v173, v228, v229
    v_permlane32_swap_b32 v248, v249
    buffer_load_dwordx4 a[40:43], v79, s[28:31], s65 offen offset:2048 sc1
    v_permlane32_swap_b32 v252, v253
    v_max_f32 v248, v248, v249
    v_max_f32 v252, v252, v253
    v_mul_f32 v248, v25, v248
    v_mul_f32 v252, v26, v252
    v_fma_f32 v246, v246, v25, -v248
    v_fma_f32 v247, v247, v25, -v248
    v_fma_f32 v250, v250, v26, -v252
    v_fma_f32 v251, v251, v26, -v252
    v_exp_f32 v246, v246
    v_exp_f32 v247, v247
    v_exp_f32 v250, v250
    buffer_load_dwordx4 a[44:47], v79, s[28:31], s65 offen offset:3072 sc1
    v_exp_f32 v251, v251
    v_add_f32 v248, v246, v247
    v_add_f32 v252, v250, v251
    v_mov_b32 v249, v248
    v_mov_b32 v253, v252
    v_cvt_pk_bf16_f32 v174, v234, v235
    v_permlane16_swap_b32 v248, v249
    v_permlane16_swap_b32 v252, v253
    v_add_f32 v248, v248, v249
    v_add_f32 v252, v252, v253
    v_mov_b32 v249, v248
    v_mov_b32 v253, v252
    s_add_u32 m0, s58, 131072
    s_add_u32 s64, s64, 524288
    s_cmp_eq_u32 s64, 3670016
    s_cselect_b32 s64, 0, s64
    s_add_u32 s64, s64, 524288
    s_cmp_eq_u32 s64, 3670016
    s_cselect_b32 s64, 0, s64
    v_xor_b32 v59, 128, v59
    buffer_load_dwordx4 v59, s[24:27], s64 offen lds
    v_cvt_pk_bf16_f32 v175, v236, v237
    v_permlane32_swap_b32 v248, v249
    v_permlane32_swap_b32 v252, v253
    v_add_f32 v248, v248, v249
    v_add_f32 v252, v252, v253
    v_rcp_f32 v248, v248
    v_rcp_f32 v252, v252
    v_cvt_pk_bf16_f32 v176, v242, v243
    v_cvt_pk_bf16_f32 v177, v244, v245
    v_mul_f32 v246, v246, v27
    v_xor_b32 v60, 128, v60
    buffer_load_dwordx4 v60, s[24:27], s64 offen offset:1024 lds
    v_mul_f32 v247, v247, v28
    v_mul_f32 v250, v250, v29
    v_mul_f32 v251, v251, v30
    v_mul_f32 v246, v246, v248
    v_mul_f32 v247, v247, v248
    v_mul_f32 v250, v250, v252
    v_mul_f32 v251, v251, v252
    v_cvt_pk_bf16_f32 v246, v246, v246
    v_cvt_pk_bf16_f32 v247, v247, v247
    v_cvt_pk_bf16_f32 v250, v250, v250
    v_cvt_pk_bf16_f32 v251, v251, v251
    v_and_b32 v138, v246, v104
    v_and_b32 v139, v247, v105
    v_xor_b32 v61, 128, v61
    buffer_load_dwordx4 v61, s[24:27], s64 offen offset:2048 lds
    v_and_b32 v140, v246, v106
    v_and_b32 v141, v247, v107
    v_and_b32 v142, v250, v104
    v_and_b32 v143, v251, v105
    v_and_b32 v144, v250, v106
    v_and_b32 v145, v251, v107
    v_mfma_f32_16x16x32_bf16 v[182:185], v[166:169], v[138:141], 0
    v_mfma_f32_16x16x32_bf16 v[186:189], v[172:175], v[138:141], 0
    v_xor_b32 v62, 128, v62
    buffer_load_dwordx4 v62, s[24:27], s64 offen offset:3072 lds
    v_mfma_f32_16x16x32_bf16 v[190:193], v[168:171], v[142:145], 0
    v_mfma_f32_16x16x32_bf16 v[194:197], v[174:177], v[142:145], 0
    s_add_u32 s83, s82, 16384
    s_nop 1
    v_cvt_pk_bf16_f32 v110, v182, v183
    v_cvt_pk_bf16_f32 v111, v184, v185
    s_add_u32 m0, s58, 147456
    s_add_u32 s64, s64, 524288
    s_cmp_eq_u32 s64, 3670016
    s_cselect_b32 s64, 0, s64
    buffer_load_dwordx4 v59, s[24:27], s64 offen lds
    v_cvt_pk_bf16_f32 v112, v186, v187
    v_cvt_pk_bf16_f32 v113, v188, v189
    v_cvt_pk_bf16_f32 v114, v190, v191
    v_cvt_pk_bf16_f32 v115, v192, v193
    v_cvt_pk_bf16_f32 v116, v194, v195
    v_cvt_pk_bf16_f32 v117, v196, v197
    buffer_store_dwordx4 v[110:113], v4, s[28:31], s82 offen sc1
    buffer_store_dwordx4 v[114:117], v4, s[28:31], s83 offen sc1
    s_cmp_lg_u32 s56, 0
    s_cbranch_scc0 L_nof
L_f:
    s_waitcnt vmcnt(17) lgkmcnt(8)
    v_mfma_f32_16x16x32_bf16 v[182:185], a[0:3], a[200:203], 0
    ds_read_b64_tr_b16 a[224:225], v32 offset:20480
    buffer_load_dwordx4 v60, s[24:27], s64 offen offset:1024 lds
    v_mfma_f32_16x16x32_bf16 v[186:189], a[4:7], a[200:203], 0
    ds_read_b64_tr_b16 a[226:227], v32 offset:22528
    v_lshlrev_b32 v93, 16, v93
    v_mfma_f32_16x16x32_bf16 v[238:241], a[0:3], a[204:207], 0
    ds_read_b64_tr_b16 a[228:229], v34 offset:20480
    buffer_load_dwordx4 v61, s[24:27], s64 offen offset:2048 lds
    v_mfma_f32_16x16x32_bf16 v[242:245], a[4:7], a[204:207], 0
    ds_read_b64_tr_b16 a[230:231], v34 offset:22528
    s_waitcnt lgkmcnt(8)
    v_mfma_f32_16x16x32_bf16 v[190:193], a[0:3], a[208:211], 0
    ds_read_b64_tr_b16 a[200:201], v35 offset:0
    v_lshlrev_b32 v222, 16, v96
    v_mfma_f32_16x16x32_bf16 v[194:197], a[4:7], a[208:211], 0
    ds_read_b64_tr_b16 a[202:203], v35 offset:2048
    buffer_load_dwordx4 v62, s[24:27], s64 offen offset:3072 lds
    v_and_b32 v223, 0xffff0000, v96
    v_mfma_f32_16x16x32_bf16 v[246:249], a[0:3], a[212:215], 0
    ds_read_b64_tr_b16 a[204:205], v37 offset:0
    s_add_u32 s65, s65, 8192
    v_mfma_f32_16x16x32_bf16 v[250:253], a[4:7], a[212:215], 0
    ds_read_b64_tr_b16 a[206:207], v37 offset:2048
    s_waitcnt vmcnt(18) lgkmcnt(8)
    v_mfma_f32_16x16x32_bf16 v[182:185], a[8:11], a[216:219], v[182:185]
    ds_read_b64_tr_b16 a[208:209], v36 offset:0
    s_cmp_eq_u32 s65, 57344
    v_mfma_f32_16x16x32_bf16 v[186:189], a[12:15], a[216:219], v[186:189]
    ds_read_b64_tr_b16 a[210:211], v36 offset:2048
    s_cselect_b32 s65, 0, s65
    buffer_load_dwordx4 a[48:51], v79, s[28:31], s65 offen offset:0 sc1
    v_add_f32 v222, v222, v93
    v_mfma_f32_16x16x32_bf16 v[238:241], a[8:11], a[220:223], v[238:241]
    ds_read_b64_tr_b16 a[212:213], v38 offset:0
    v_add_f32 v223, v223, v93
    v_mfma_f32_16x16x32_bf16 v[242:245], a[12:15], a[220:223], v[242:245]
    ds_read_b64_tr_b16 a[214:215], v38 offset:2048
    s_waitcnt lgkmcnt(8)
    v_mfma_f32_16x16x32_bf16 v[190:193], a[8:11], a[224:227], v[190:193]
    ds_read_b64_tr_b16 a[216:217], v35 offset:4096
    buffer_load_dwordx4 a[52:55], v79, s[28:31], s65 offen offset:1024 sc1
    v_mfma_f32_16x16x32_bf16 v[194:197], a[12:15], a[224:227], v[194:197]
    ds_read_b64_tr_b16 a[218:219], v35 offset:6144
    v_lshlrev_b32 v224, 16, v97
    v_mfma_f32_16x16x32_bf16 v[246:249], a[8:11], a[228:231], v[246:249]
    ds_read_b64_tr_b16 a[220:221], v37 offset:4096
    buffer_load_dwordx4 a[56:59], v79, s[28:31], s65 offen offset:2048 sc1
    v_mfma_f32_16x16x32_bf16 v[250:253], a[12:15], a[228:231], v[250:253]
    ds_read_b64_tr_b16 a[222:223], v37 offset:6144
    s_waitcnt vmcnt(19) lgkmcnt(8)
    v_mfma_f32_16x16x32_bf16 v[182:185], a[16:19], a[200:203], v[182:185]
    ds_read_b64_tr_b16 a[224:225], v36 offset:4096
    v_and_b32 v225, 0xffff0000, v97
    v_mfma_f32_16x16x32_bf16 v[186:189], a[20:23], a[200:203], v[186:189]
    ds_read_b64_tr_b16 a[226:227], v36 offset:6144
    buffer_load_dwordx4 a[60:63], v79, s[28:31], s65 offen offset:3072 sc1
    v_add_f32 v224, v224, v93
    v_mfma_f32_16x16x32_bf16 v[238:241], a[16:19], a[204:207], v[238:241]
    ds_read_b64_tr_b16 a[228:229], v38 offset:4096
    s_add_u32 s65, s65, 8192
    v_mfma_f32_16x16x32_bf16 v[242:245], a[20:23], a[204:207], v[242:245]
    ds_read_b64_tr_b16 a[230:231], v38 offset:6144
    s_waitcnt lgkmcnt(8)
    v_mfma_f32_16x16x32_bf16 v[190:193], a[16:19], a[208:211], v[190:193]
    ds_read_b64_tr_b16 a[200:201], v35 offset:16384
    s_cmp_eq_u32 s65, 57344
    v_mfma_f32_16x16x32_bf16 v[194:197], a[20:23], a[208:211], v[194:197]
    ds_read_b64_tr_b16 a[202:203], v35 offset:18432
    s_cselect_b32 s65, 0, s65
    v_add_f32 v225, v225, v93
    v_mfma_f32_16x16x32_bf16 v[246:249], a[16:19], a[212:215], v[246:249]
    ds_read_b64_tr_b16 a[204:205], v37 offset:16384
    buffer_load_dwordx4 a[64:67], v79, s[28:31], s65 offen offset:0 sc1
    v_mfma_f32_16x16x32_bf16 v[250:253], a[20:23], a[212:215], v[250:253]
    ds_read_b64_tr_b16 a[206:207], v37 offset:18432
    v_lshlrev_b32 v226, 16, v98
    s_waitcnt vmcnt(19) lgkmcnt(8)
    v_mfma_f32_16x16x32_bf16 v[182:185], a[24:27], a[216:219], v[182:185]
    ds_read_b64_tr_b16 a[208:209], v36 offset:16384
    buffer_load_dwordx4 a[68:71], v79, s[28:31], s65 offen offset:1024 sc1
    v_mfma_f32_16x16x32_bf16 v[186:189], a[28:31], a[216:219], v[186:189]
    ds_read_b64_tr_b16 a[210:211], v36 offset:18432
    v_and_b32 v227, 0xffff0000, v98
    v_mfma_f32_16x16x32_bf16 v[238:241], a[24:27], a[220:223], v[238:241]
    ds_read_b64_tr_b16 a[212:213], v38 offset:16384
    v_add_f32 v226, v226, v93
    v_mfma_f32_16x16x32_bf16 v[242:245], a[28:31], a[220:223], v[242:245]
    ds_read_b64_tr_b16 a[214:215], v38 offset:18432
    s_waitcnt lgkmcnt(8)
    v_mfma_f32_16x16x32_bf16 v[190:193], a[24:27], a[224:227], v[190:193]
    ds_read_b64_tr_b16 a[216:217], v35 offset:20480
    buffer_load_dwordx4 a[72:75], v79, s[28:31], s65 offen offset:2048 sc1
    v_mfma_f32_16x16x32_bf16 v[194:197], a[28:31], a[224:227], v[194:197]
    ds_read_b64_tr_b16 a[218:219], v35 offset:22528
    v_add_f32 v227, v227, v93
    v_mfma_f32_16x16x32_bf16 v[246:249], a[24:27], a[228:231], v[246:249]
    ds_read_b64_tr_b16 a[220:221], v37 offset:20480
    buffer_load_dwordx4 a[76:79], v79, s[28:31], s65 offen offset:3072 sc1
    v_mfma_f32_16x16x32_bf16 v[250:253], a[28:31], a[228:231], v[250:253]
    ds_read_b64_tr_b16 a[222:223], v37 offset:22528
    v_lshlrev_b32 v228, 16, v99
    s_waitcnt vmcnt(20) lgkmcnt(8)
    v_mfma_f32_16x16x32_bf16 v[182:185], a[32:35], a[200:203], v[182:185]
    ds_read_b64_tr_b16 a[224:225], v36 offset:20480
    s_add_u32 s65, s65, 8192
    v_mfma_f32_16x16x32_bf16 v[186:189], a[36:39], a[200:203], v[186:189]
    ds_read_b64_tr_b16 a[226:227], v36 offset:22528
    s_cmp_eq_u32 s65, 57344
    v_and_b32 v229, 0xffff0000, v99
    v_mfma_f32_16x16x32_bf16 v[238:241], a[32:35], a[204:207], v[238:241]
    ds_read_b64_tr_b16 a[228:229], v38 offset:20480
    s_cselect_b32 s65, 0, s65
    v_mfma_f32_16x16x32_bf16 v[242:245], a[36:39], a[204:207], v[242:245]
    ds_read_b64_tr_b16 a[230:231], v38 offset:22528
    buffer_load_dwordx4 a[80:83], v79, s[28:31], s65 offen offset:0 sc1
    v_add_f32 v228, v228, v93
    s_waitcnt lgkmcnt(8)
    v_mfma_f32_16x16x32_bf16 v[190:193], a[32:35], a[208:211], v[190:193]
    s_waitcnt vmcnt(12)
    s_barrier
    s_cmp_lg_u32 s48, 0
    s_cbranch_scc1 L_sig4
    s_atomic_add s36, s[28:29], s69
L_sig4:
    ds_read_b64_tr_b16 a[200:201], v31 offset:32768
    buffer_load_dwordx4 a[84:87], v79, s[28:31], s65 offen offset:1024 sc1
    v_mfma_f32_16x16x32_bf16 v[194:197], a[36:39], a[208:211], v[194:197]
    ds_read_b64_tr_b16 a[202:203], v31 offset:34816
    v_add_f32 v229, v229, v93
    v_mfma_f32_16x16x32_bf16 v[246:249], a[32:35], a[212:215], v[246:249]
    ds_read_b64_tr_b16 a[204:205], v33 offset:32768
    v_lshlrev_b32 v94, 16, v94
    v_mfma_f32_16x16x32_bf16 v[250:253], a[36:39], a[212:215], v[250:253]
    ds_read_b64_tr_b16 a[206:207], v33 offset:34816
    s_waitcnt lgkmcnt(8)
    v_mfma_f32_16x16x32_bf16 v[182:185], a[40:43], a[216:219], v[182:185]
    ds_read_b64_tr_b16 a[208:209], v32 offset:32768
    buffer_load_dwordx4 a[88:91], v79, s[28:31], s65 offen offset:2048 sc1
    v_mfma_f32_16x16x32_bf16 v[186:189], a[44:47], a[216:219], v[186:189]
    ds_read_b64_tr_b16 a[210:211], v32 offset:34816
    v_lshlrev_b32 v230, 16, v100
    v_mfma_f32_16x16x32_bf16 v[238:241], a[40:43], a[220:223], v[238:241]
    ds_read_b64_tr_b16 a[212:213], v34 offset:32768
    buffer_load_dwordx4 a[92:95], v79, s[28:31], s65 offen offset:3072 sc1
    v_mfma_f32_16x16x32_bf16 v[242:245], a[44:47], a[220:223], v[242:245]
    ds_read_b64_tr_b16 a[214:215], v34 offset:34816
    v_and_b32 v231, 0xffff0000, v100
    s_waitcnt lgkmcnt(8)
    v_mfma_f32_16x16x32_bf16 v[190:193], a[40:43], a[224:227], v[190:193]
    ds_read_b64_tr_b16 a[216:217], v31 offset:36864
    s_add_u32 s65, s65, 8192
    v_mfma_f32_16x16x32_bf16 v[194:197], a[44:47], a[224:227], v[194:197]
    ds_read_b64_tr_b16 a[218:219], v31 offset:38912
    s_cmp_eq_u32 s65, 57344
    v_add_f32 v230, v230, v94
    v_mfma_f32_16x16x32_bf16 v[246:249], a[40:43], a[228:231], v[246:249]
    ds_read_b64_tr_b16 a[220:221], v33 offset:36864
    s_cselect_b32 s65, 0, s65
    v_mfma_f32_16x16x32_bf16 v[250:253], a[44:47], a[228:231], v[250:253]
    ds_read_b64_tr_b16 a[222:223], v33 offset:38912
    buffer_load_dwordx4 a[96:99], v79, s[28:31], s65 offen offset:0 sc1
    v_add_f32 v231, v231, v94
    s_waitcnt vmcnt(11) lgkmcnt(8)
    v_mfma_f32_16x16x32_bf16 v[182:185], a[48:51], a[200:203], v[182:185]
    ds_read_b64_tr_b16 a[224:225], v32 offset:36864
    v_lshlrev_b32 v232, 16, v101
    v_mfma_f32_16x16x32_bf16 v[186:189], a[52:55], a[200:203], v[186:189]
    ds_read_b64_tr_b16 a[226:227], v32 offset:38912
    buffer_load_dwordx4 a[100:103], v79, s[28:31], s65 offen offset:1024 sc1
    v_and_b32 v233, 0xffff0000, v101
    v_mfma_f32_16x16x32_bf16 v[238:241], a[48:51], a[204:207], v[238:241]
    ds_read_b64_tr_b16 a[228:229], v34 offset:36864
    v_add_f32 v232, v232, v94
    v_mfma_f32_16x16x32_bf16 v[242:245], a[52:55], a[204:207], v[242:245]
    ds_read_b64_tr_b16 a[230:231], v34 offset:38912
    s_waitcnt lgkmcnt(8)
    v_mfma_f32_16x16x32_bf16 v[190:193], a[48:51], a[208:211], v[190:193]
    ds_read_b64_tr_b16 a[200:201], v31 offset:49152
    buffer_load_dwordx4 a[104:107], v79, s[28:31], s65 offen offset:2048 sc1
    v_mfma_f32_16x16x32_bf16 v[194:197], a[52:55], a[208:211], v[194:197]
    ds_read_b64_tr_b16 a[202:203], v31 offset:51200
    v_add_f32 v233, v233, v94
    v_mfma_f32_16x16x32_bf16 v[246:249], a[48:51], a[212:215], v[246:249]
    ds_read_b64_tr_b16 a[204:205], v33 offset:49152
    v_lshlrev_b32 v234, 16, v102
    v_mfma_f32_16x16x32_bf16 v[250:253], a[52:55], a[212:215], v[250:253]
    ds_read_b64_tr_b16 a[206:207], v33 offset:51200
    s_waitcnt vmcnt(11) lgkmcnt(8)
    v_mfma_f32_16x16x32_bf16 v[182:185], a[56:59], a[216:219], v[182:185]
    ds_read_b64_tr_b16 a[208:209], v32 offset:49152
    buffer_load_dwordx4 a[108:111], v79, s[28:31], s65 offen offset:3072 sc1
    v_mfma_f32_16x16x32_bf16 v[186:189], a[60:63], a[216:219], v[186:189]
    ds_read_b64_tr_b16 a[210:211], v32 offset:51200
    s_add_u32 m0, s58, 16384
    v_and_b32 v235, 0xffff0000, v102
    v_mfma_f32_16x16x32_bf16 v[238:241], a[56:59], a[220:223], v[238:241]
    ds_read_b64_tr_b16 a[212:213], v34 offset:49152
    s_add_u32 s64, s64, 524288
    v_mfma_f32_16x16x32_bf16 v[242:245], a[60:63], a[220:223], v[242:245]
    ds_read_b64_tr_b16 a[214:215], v34 offset:51200
    s_cmp_eq_u32 s64, 3670016
    s_cselect_b32 s64, 0, s64
    buffer_load_dwordx4 v59, s[24:27], s64 offen lds
    s_waitcnt lgkmcnt(8)
    v_mfma_f32_16x16x32_bf16 v[190:193], a[56:59], a[224:227], v[190:193]
    ds_read_b64_tr_b16 a[216:217], v31 offset:53248
    v_add_f32 v234, v234, v94
    v_mfma_f32_16x16x32_bf16 v[194:197], a[60:63], a[224:227], v[194:197]
    ds_read_b64_tr_b16 a[218:219], v31 offset:55296
    buffer_load_dwordx4 v60, s[24:27], s64 offen offset:1024 lds
    v_add_f32 v235, v235, v94
    v_mfma_f32_16x16x32_bf16 v[246:249], a[56:59], a[228:231], v[246:249]
    ds_read_b64_tr_b16 a[220:221], v33 offset:53248
    v_lshlrev_b32 v236, 16, v103
    v_mfma_f32_16x16x32_bf16 v[250:253], a[60:63], a[228:231], v[250:253]
    ds_read_b64_tr_b16 a[222:223], v33 offset:55296
    s_waitcnt vmcnt(12) lgkmcnt(8)
    v_mfma_f32_16x16x32_bf16 v[182:185], a[64:67], a[200:203], v[182:185]
    ds_read_b64_tr_b16 a[224:225], v32 offset:53248
    buffer_load_dwordx4 v61, s[24:27], s64 offen offset:2048 lds
    v_mfma_f32_16x16x32_bf16 v[186:189], a[68:71], a[200:203], v[186:189]
    ds_read_b64_tr_b16 a[226:227], v32 offset:55296
    v_and_b32 v237, 0xffff0000, v103
    v_mfma_f32_16x16x32_bf16 v[238:241], a[64:67], a[204:207], v[238:241]
    ds_read_b64_tr_b16 a[228:229], v34 offset:53248
    v_add_f32 v236, v236, v94
    v_mfma_f32_16x16x32_bf16 v[242:245], a[68:71], a[204:207], v[242:245]
    ds_read_b64_tr_b16 a[230:231], v34 offset:55296
    s_waitcnt lgkmcnt(8)
    v_mfma_f32_16x16x32_bf16 v[190:193], a[64:67], a[208:211], v[190:193]
    s_barrier
    ds_read_b64_tr_b16 a[200:201], v35 offset:32768
    buffer_load_dwordx4 v62, s[24:27], s64 offen offset:3072 lds
    v_mfma_f32_16x16x32_bf16 v[194:197], a[68:71], a[208:211], v[194:197]
    ds_read_b64_tr_b16 a[202:203], v35 offset:34816
    s_add_u32 m0, s58, 65536
    v_add_f32 v237, v237, v94
    v_mfma_f32_16x16x32_bf16 v[246:249], a[64:67], a[212:215], v[246:249]
    ds_read_b64_tr_b16 a[204:205], v37 offset:32768
    s_add_u32 s64, s64, 524288
    v_mfma_f32_16x16x32_bf16 v[250:253], a[68:71], a[212:215], v[250:253]
    ds_read_b64_tr_b16 a[206:207], v37 offset:34816
    s_waitcnt vmcnt(12) lgkmcnt(8)
    v_mfma_f32_16x16x32_bf16 v[182:185], a[72:75], a[216:219], v[182:185]
    ds_read_b64_tr_b16 a[208:209], v36 offset:32768
    s_cmp_eq_u32 s64, 3670016
    s_cselect_b32 s64, 0, s64
    buffer_load_dwordx4 v59, s[24:27], s64 offen lds
    v_mfma_f32_16x16x32_bf16 v[186:189], a[76:79], a[216:219], v[186:189]
    ds_read_b64_tr_b16 a[210:211], v36 offset:34816
    v_mfma_f32_16x16x32_bf16 v[238:241], a[72:75], a[220:223], v[238:241]
    ds_read_b64_tr_b16 a[212:213], v38 offset:32768
    buffer_load_dwordx4 v60, s[24:27], s64 offen offset:1024 lds
    v_mfma_f32_16x16x32_bf16 v[242:245], a[76:79], a[220:223], v[242:245]
    ds_read_b64_tr_b16 a[214:215], v38 offset:34816
    s_waitcnt lgkmcnt(8)
    v_mfma_f32_16x16x32_bf16 v[190:193], a[72:75], a[224:227], v[190:193]
    ds_read_b64_tr_b16 a[216:217], v35 offset:36864
    v_mfma_f32_16x16x32_bf16 v[194:197], a[76:79], a[224:227], v[194:197]
    ds_read_b64_tr_b16 a[218:219], v35 offset:38912
    v_mfma_f32_16x16x32_bf16 v[246:249], a[72:75], a[228:231], v[246:249]
    ds_read_b64_tr_b16 a[220:221], v37 offset:36864
    buffer_load_dwordx4 v61, s[24:27], s64 offen offset:2048 lds
    v_mfma_f32_16x16x32_bf16 v[250:253], a[76:79], a[228:231], v[250:253]
    ds_read_b64_tr_b16 a[222:223], v37 offset:38912
    s_waitcnt vmcnt(13) lgkmcnt(8)
    v_mfma_f32_16x16x32_bf16 v[182:185], a[80:83], a[200:203], v[182:185]
    ds_read_b64_tr_b16 a[224:225], v36 offset:36864
    v_mfma_f32_16x16x32_bf16 v[186:189], a[84:87], a[200:203], v[186:189]
    ds_read_b64_tr_b16 a[226:227], v36 offset:38912
    buffer_load_dwordx4 v62, s[24:27], s64 offen offset:3072 lds
    v_mfma_f32_16x16x32_bf16 v[238:241], a[80:83], a[204:207], v[238:241]
    ds_read_b64_tr_b16 a[228:229], v38 offset:36864
    s_add_u32 m0, s58, 81920
    v_mfma_f32_16x16x32_bf16 v[242:245], a[84:87], a[204:207], v[242:245]
    ds_read_b64_tr_b16 a[230:231], v38 offset:38912
    s_waitcnt lgkmcnt(8)
    v_mfma_f32_16x16x32_bf16 v[190:193], a[80:83], a[208:211], v[190:193]
    ds_read_b64_tr_b16 a[200:201], v35 offset:49152
    s_add_u32 s64, s64, 524288
    v_mfma_f32_16x16x32_bf16 v[194:197], a[84:87], a[208:211], v[194:197]
    ds_read_b64_tr_b16 a[202:203], v35 offset:51200
    s_cmp_eq_u32 s64, 3670016
    v_mfma_f32_16x16x32_bf16 v[246:249], a[80:83], a[212:215], v[246:249]
    ds_read_b64_tr_b16 a[204:205], v37 offset:49152
L_pad3:
    s_cbranch_execz L_warm
    s_cselect_b32 s64, 0, s64
    buffer_load_dwordx4 v59, s[24:27], s64 offen lds
    v_mfma_f32_16x16x32_bf16 v[250:253], a[84:87], a[212:215], v[250:253]
    ds_read_b64_tr_b16 a[206:207], v37 offset:51200
    s_waitcnt vmcnt(13) lgkmcnt(8)
    v_mfma_f32_16x16x32_bf16 v[182:185], a[88:91], a[216:219], v[182:185]
    ds_read_b64_tr_b16 a[208:209], v36 offset:49152
    buffer_load_dwordx4 v60, s[24:27], s64 offen offset:1024 lds
    v_mfma_f32_16x16x32_bf16 v[186:189], a[92:95], a[216:219], v[186:189]
    ds_read_b64_tr_b16 a[210:211], v36 offset:51200
    v_mfma_f32_16x16x32_bf16 v[238:241], a[88:91], a[220:223], v[238:241]
    ds_read_b64_tr_b16 a[212:213], v38 offset:49152
    v_mfma_f32_16x16x32_bf16 v[242:245], a[92:95], a[220:223], v[242:245]
    ds_read_b64_tr_b16 a[214:215], v38 offset:51200
    s_waitcnt lgkmcnt(8)
    v_mfma_f32_16x16x32_bf16 v[190:193], a[88:91], a[224:227], v[190:193]
    ds_read_b64_tr_b16 a[216:217], v35 offset:53248
    buffer_load_dwordx4 v61, s[24:27], s64 offen offset:2048 lds
    v_mfma_f32_16x16x32_bf16 v[194:197], a[92:95], a[224:227], v[194:197]
    ds_read_b64_tr_b16 a[218:219], v35 offset:55296
    v_mfma_f32_16x16x32_bf16 v[246:249], a[88:91], a[228:231], v[246:249]
    ds_read_b64_tr_b16 a[220:221], v37 offset:53248
    v_mfma_f32_16x16x32_bf16 v[250:253], a[92:95], a[228:231], v[250:253]
    ds_read_b64_tr_b16 a[222:223], v37 offset:55296
    s_waitcnt vmcnt(13) lgkmcnt(8)
    v_mfma_f32_16x16x32_bf16 v[182:185], a[96:99], a[200:203], v[182:185]
    ds_read_b64_tr_b16 a[224:225], v36 offset:53248
    buffer_load_dwordx4 v62, s[24:27], s64 offen offset:3072 lds
    v_mfma_f32_16x16x32_bf16 v[186:189], a[100:103], a[200:203], v[186:189]
    ds_read_b64_tr_b16 a[226:227], v36 offset:55296
    s_add_u32 m0, s58, 32768
    v_mfma_f32_16x16x32_bf16 v[238:241], a[96:99], a[204:207], v[238:241]
    ds_read_b64_tr_b16 a[228:229], v38 offset:53248
    s_add_u32 s64, s64, 524288
    v_mfma_f32_16x16x32_bf16 v[242:245], a[100:103], a[204:207], v[242:245]
    ds_read_b64_tr_b16 a[230:231], v38 offset:55296
    s_waitcnt lgkmcnt(8)
    v_mfma_f32_16x16x32_bf16 v[190:193], a[96:99], a[208:211], v[190:193]
    s_barrier
    ds_read_b64_tr_b16 a[200:201], v31 offset:0
    s_cmp_eq_u32 s64, 3670016
    s_cselect_b32 s64, 0, s64
    buffer_load_dwordx4 v59, s[24:27], s64 offen lds
    v_mfma_f32_16x16x32_bf16 v[194:197], a[100:103], a[208:211], v[194:197]
    ds_read_b64_tr_b16 a[202:203], v31 offset:2048
    v_mfma_f32_16x16x32_bf16 v[246:249], a[96:99], a[212:215], v[246:249]
    ds_read_b64_tr_b16 a[204:205], v33 offset:0
    buffer_load_dwordx4 v60, s[24:27], s64 offen offset:1024 lds
    v_mfma_f32_16x16x32_bf16 v[250:253], a[100:103], a[212:215], v[250:253]
    ds_read_b64_tr_b16 a[206:207], v33 offset:2048
    s_waitcnt vmcnt(14) lgkmcnt(8)
    v_mfma_f32_16x16x32_bf16 v[182:185], a[104:107], a[216:219], v[182:185]
    ds_read_b64_tr_b16 a[208:209], v32 offset:0
    v_mfma_f32_16x16x32_bf16 v[186:189], a[108:111], a[216:219], v[186:189]
    ds_read_b64_tr_b16 a[210:211], v32 offset:2048
    v_mfma_f32_16x16x32_bf16 v[238:241], a[104:107], a[220:223], v[238:241]
    ds_read_b64_tr_b16 a[212:213], v34 offset:0
    buffer_load_dwordx4 v61, s[24:27], s64 offen offset:2048 lds
    v_mfma_f32_16x16x32_bf16 v[242:245], a[108:111], a[220:223], v[242:245]
    ds_read_b64_tr_b16 a[214:215], v34 offset:2048
    s_waitcnt lgkmcnt(8)
    v_mfma_f32_16x16x32_bf16 v[190:193], a[104:107], a[224:227], v[190:193]
    ds_read_b64_tr_b16 a[216:217], v31 offset:4096
    v_mfma_f32_16x16x32_bf16 v[194:197], a[108:111], a[224:227], v[194:197]
    ds_read_b64_tr_b16 a[218:219], v31 offset:6144
    buffer_load_dwordx4 v62, s[24:27], s64 offen offset:3072 lds
    v_mfma_f32_16x16x32_bf16 v[246:249], a[104:107], a[228:231], v[246:249]
    ds_read_b64_tr_b16 a[220:221], v33 offset:4096
    s_add_u32 m0, s58, 49152
    v_mfma_f32_16x16x32_bf16 v[250:253], a[108:111], a[228:231], v[250:253]
    ds_read_b64_tr_b16 a[222:223], v33 offset:6144
    s_waitcnt lgkmcnt(8)
    v_mfma_f32_16x16x32_bf16 v[150:153], a[0:3], a[200:203], 0
    ds_read_b64_tr_b16 a[224:225], v32 offset:4096
    s_add_u32 s66, s66, 1
    v_mfma_f32_16x16x32_bf16 v[154:157], a[4:7], a[200:203], 0
    ds_read_b64_tr_b16 a[226:227], v32 offset:6144
    s_and_b32 s66, s66, 3
    v_mfma_f32_16x16x32_bf16 v[166:169], a[0:3], a[204:207], 0
    ds_read_b64_tr_b16 a[228:229], v34 offset:4096
    s_mul_i32 s61, s66, 100352
    buffer_load_dwordx4 v63, s[16:19], s61 offen lds
    v_mfma_f32_16x16x32_bf16 v[170:173], a[4:7], a[204:207], 0
    ds_read_b64_tr_b16 a[230:231], v34 offset:6144
    v_cvt_pk_bf16_f32 v182, v182, v183
    v_cvt_pk_bf16_f32 v183, v184, v185
    v_cvt_pk_bf16_f32 v184, v186, v187
    s_waitcnt lgkmcnt(8)
    v_mfma_f32_16x16x32_bf16 v[158:161], a[0:3], a[208:211], 0
    s_load_dword s14, s[28:29], s39
    ds_read_b64_tr_b16 a[200:201], v39 offset:0
    buffer_load_dwordx4 v64, s[16:19], s61 offen offset:1024 lds
    v_mfma_f32_16x16x32_bf16 v[162:165], a[4:7], a[208:211], 0
    ds_read_b64_tr_b16 a[202:203], v39 offset:2048
    s_add_u32 s61, s61, 48128
    v_cvt_pk_bf16_f32 v185, v188, v189
    buffer_store_dwordx4 v[182:185], v21, s[28:31], 0 offen offset:0 sc1
    v_cvt_pk_bf16_f32 v190, v190, v191
    v_cvt_pk_bf16_f32 v191, v192, v193
    v_cvt_pk_bf16_f32 v192, v194, v195
    v_mfma_f32_16x16x32_bf16 v[174:177], a[0:3], a[212:215], 0
    ds_read_b64_tr_b16 a[204:205], v41 offset:0
    v_cvt_pk_bf16_f32 v193, v196, v197
    v_mfma_f32_16x16x32_bf16 v[178:181], a[4:7], a[212:215], 0
    ds_read_b64_tr_b16 a[206:207], v41 offset:2048
    buffer_store_dwordx4 v[190:193], v21, s[28:31], 0 offen offset:1024 sc1
    v_cvt_pk_bf16_f32 v238, v238, v239
    v_cvt_pk_bf16_f32 v239, v240, v241
    v_cvt_pk_bf16_f32 v240, v242, v243
    s_waitcnt lgkmcnt(8)
    v_mfma_f32_16x16x32_bf16 v[150:153], a[8:11], a[216:219], v[150:153]
    ds_read_b64_tr_b16 a[208:209], v40 offset:0
    buffer_load_dwordx4 v63, s[16:19], s61 offen offset:2048 lds
    v_mfma_f32_16x16x32_bf16 v[154:157], a[12:15], a[216:219], v[154:157]
    ds_read_b64_tr_b16 a[210:211], v40 offset:2048
    v_cvt_pk_bf16_f32 v241, v244, v245
    buffer_store_dwordx4 v[238:241], v21, s[28:31], 0 offen offset:2048 sc1
    v_cvt_pk_bf16_f32 v246, v246, v247
    v_cvt_pk_bf16_f32 v247, v248, v249
    v_cvt_pk_bf16_f32 v248, v250, v251
    v_mfma_f32_16x16x32_bf16 v[166:169], a[8:11], a[220:223], v[166:169]
    ds_read_b64_tr_b16 a[212:213], v42 offset:0
    v_cvt_pk_bf16_f32 v249, v252, v253
    v_mfma_f32_16x16x32_bf16 v[170:173], a[12:15], a[220:223], v[170:173]
    ds_read_b64_tr_b16 a[214:215], v42 offset:2048
    s_waitcnt lgkmcnt(8)
    v_mfma_f32_16x16x32_bf16 v[158:161], a[8:11], a[224:227], v[158:161]
    ds_read_b64_tr_b16 a[216:217], v39 offset:4096
    buffer_load_dwordx4 v64, s[16:19], s61 offen offset:3072 lds
    v_mfma_f32_16x16x32_bf16 v[162:165], a[12:15], a[224:227], v[162:165]
    ds_read_b64_tr_b16 a[218:219], v39 offset:6144
    s_add_u32 m0, s58, 98304
    buffer_store_dwordx4 v[246:249], v21, s[28:31], 0 offen offset:3072 sc1
    v_mfma_f32_16x16x32_bf16 v[174:177], a[8:11], a[228:231], v[174:177]
    ds_read_b64_tr_b16 a[220:221], v41 offset:4096
    s_add_u32 s66, s66, 1
    v_mfma_f32_16x16x32_bf16 v[178:181], a[12:15], a[228:231], v[178:181]
    ds_read_b64_tr_b16 a[222:223], v41 offset:6144
    s_waitcnt lgkmcnt(8)
    v_mfma_f32_16x16x32_bf16 v[150:153], a[16:19], a[200:203], v[150:153]
    ds_read_b64_tr_b16 a[224:225], v40 offset:4096
    s_and_b32 s66, s66, 3
    v_mfma_f32_16x16x32_bf16 v[154:157], a[20:23], a[200:203], v[154:157]
    ds_read_b64_tr_b16 a[226:227], v40 offset:6144
    s_mul_i32 s61, s66, 100352
    buffer_load_dwordx4 v63, s[16:19], s61 offen lds
    v_mfma_f32_16x16x32_bf16 v[166:169], a[16:19], a[204:207], v[166:169]
    ds_read_b64_tr_b16 a[228:229], v42 offset:4096
    v_mfma_f32_16x16x32_bf16 v[170:173], a[20:23], a[204:207], v[170:173]
    ds_read_b64_tr_b16 a[230:231], v42 offset:6144
    s_waitcnt lgkmcnt(8)
    v_mfma_f32_16x16x32_bf16 v[158:161], a[16:19], a[208:211], v[158:161]
    s_waitcnt vmcnt(9)
    s_barrier
    ds_read_b64_tr_b16 a[200:201], v39 offset:16384
    buffer_load_dwordx4 v64, s[16:19], s61 offen offset:1024 lds
    v_mfma_f32_16x16x32_bf16 v[162:165], a[20:23], a[208:211], v[162:165]
    ds_read_b64_tr_b16 a[202:203], v39 offset:18432
    s_add_u32 s61, s61, 48128
    v_mfma_f32_16x16x32_bf16 v[174:177], a[16:19], a[212:215], v[174:177]
    ds_read_b64_tr_b16 a[204:205], v41 offset:16384
    buffer_load_dwordx4 v63, s[16:19], s61 offen offset:2048 lds
    v_mfma_f32_16x16x32_bf16 v[178:181], a[20:23], a[212:215], v[178:181]
    ds_read_b64_tr_b16 a[206:207], v41 offset:18432
    s_waitcnt lgkmcnt(8)
    v_mfma_f32_16x16x32_bf16 v[150:153], a[24:27], a[216:219], v[150:153]
    ds_read_b64_tr_b16 a[208:209], v40 offset:16384
    v_mfma_f32_16x16x32_bf16 v[154:157], a[28:31], a[216:219], v[154:157]
    ds_read_b64_tr_b16 a[210:211], v40 offset:18432
    v_mfma_f32_16x16x32_bf16 v[166:169], a[24:27], a[220:223], v[166:169]
    ds_read_b64_tr_b16 a[212:213], v42 offset:16384
    buffer_load_dwordx4 v64, s[16:19], s61 offen offset:3072 lds
    v_mfma_f32_16x16x32_bf16 v[170:173], a[28:31], a[220:223], v[170:173]
    ds_read_b64_tr_b16 a[214:215], v42 offset:18432
    s_waitcnt lgkmcnt(8)
    v_mfma_f32_16x16x32_bf16 v[158:161], a[24:27], a[224:227], v[158:161]
    ds_read_b64_tr_b16 a[216:217], v39 offset:20480
    s_add_u32 m0, s58, 114688
    v_mfma_f32_16x16x32_bf16 v[162:165], a[28:31], a[224:227], v[162:165]
    ds_read_b64_tr_b16 a[218:219], v39 offset:22528
    s_add_u32 s66, s66, 1
    v_mfma_f32_16x16x32_bf16 v[174:177], a[24:27], a[228:231], v[174:177]
    ds_read_b64_tr_b16 a[220:221], v41 offset:20480
    s_and_b32 s66, s66, 3
    v_mfma_f32_16x16x32_bf16 v[178:181], a[28:31], a[228:231], v[178:181]
    ds_read_b64_tr_b16 a[222:223], v41 offset:22528
    s_mul_i32 s61, s66, 100352
    buffer_load_dwordx4 v63, s[16:19], s61 offen lds
    s_waitcnt lgkmcnt(8)
    v_mfma_f32_16x16x32_bf16 v[150:153], a[32:35], a[200:203], v[150:153]
    ds_read_b64_tr_b16 a[224:225], v40 offset:20480
    v_mfma_f32_16x16x32_bf16 v[154:157], a[36:39], a[200:203], v[154:157]
    ds_read_b64_tr_b16 a[226:227], v40 offset:22528
    buffer_load_dwordx4 v64, s[16:19], s61 offen offset:1024 lds
    v_mfma_f32_16x16x32_bf16 v[166:169], a[32:35], a[204:207], v[166:169]
    ds_read_b64_tr_b16 a[228:229], v42 offset:20480
    s_add_u32 s61, s61, 48128
    v_mfma_f32_16x16x32_bf16 v[170:173], a[36:39], a[204:207], v[170:173]
    ds_read_b64_tr_b16 a[230:231], v42 offset:22528
    s_waitcnt lgkmcnt(8)
    v_mfma_f32_16x16x32_bf16 v[158:161], a[32:35], a[208:211], v[158:161]
    ds_read_b64_tr_b16 a[200:201], v31 offset:16384
    v_mfma_f32_16x16x32_bf16 v[162:165], a[36:39], a[208:211], v[162:165]
    ds_read_b64_tr_b16 a[202:203], v31 offset:18432
    buffer_load_dwordx4 v63, s[16:19], s61 offen offset:2048 lds
    v_mfma_f32_16x16x32_bf16 v[174:177], a[32:35], a[212:215], v[174:177]
    ds_read_b64_tr_b16 a[204:205], v33 offset:16384
    v_mfma_f32_16x16x32_bf16 v[178:181], a[36:39], a[212:215], v[178:181]
    ds_read_b64_tr_b16 a[206:207], v33 offset:18432
    s_waitcnt lgkmcnt(8)
    v_mfma_f32_16x16x32_bf16 v[150:153], a[40:43], a[216:219], v[150:153]
    ds_read_b64_tr_b16 a[208:209], v32 offset:16384
    buffer_load_dwordx4 v64, s[16:19], s61 offen offset:3072 lds
    v_mfma_f32_16x16x32_bf16 v[154:157], a[44:47], a[216:219], v[154:157]
    ds_read_b64_tr_b16 a[210:211], v32 offset:18432
    s_add_u32 m0, s58, 0
    v_mfma_f32_16x16x32_bf16 v[166:169], a[40:43], a[220:223], v[166:169]
    ds_read_b64_tr_b16 a[212:213], v34 offset:16384
    s_add_u32 s66, s66, 1
    v_mfma_f32_16x16x32_bf16 v[170:173], a[44:47], a[220:223], v[170:173]
    ds_read_b64_tr_b16 a[214:215], v34 offset:18432
    s_waitcnt lgkmcnt(8)
    v_mfma_f32_16x16x32_bf16 v[158:161], a[40:43], a[224:227], v[158:161]
    ds_read_b64_tr_b16 a[216:217], v31 offset:20480
    s_and_b32 s66, s66, 3
    v_mfma_f32_16x16x32_bf16 v[162:165], a[44:47], a[224:227], v[162:165]
    ds_read_b64_tr_b16 a[218:219], v31 offset:22528
    s_mul_i32 s61, s66, 100352
    buffer_load_dwordx4 v63, s[16:19], s61 offen lds
    v_mfma_f32_16x16x32_bf16 v[174:177], a[40:43], a[228:231], v[174:177]
    ds_read_b64_tr_b16 a[220:221], v33 offset:20480
    v_mfma_f32_16x16x32_bf16 v[178:181], a[44:47], a[228:231], v[178:181]
    ds_read_b64_tr_b16 a[222:223], v33 offset:22528
    s_waitcnt lgkmcnt(8)
    v_mfma_f32_16x16x32_bf16 v[150:153], a[48:51], a[200:203], v[150:153]
    s_waitcnt lgkmcnt(0)
    s_cmp_ge_u32 s14, 8
    s_cbranch_scc0 L_pollin6
L_pollok6:
    ds_read_b64_tr_b16 a[224:225], v32 offset:20480
    buffer_load_dwordx4 v64, s[16:19], s61 offen offset:1024 lds
    v_mfma_f32_16x16x32_bf16 v[154:157], a[52:55], a[200:203], v[154:157]
    ds_read_b64_tr_b16 a[226:227], v32 offset:22528
    s_add_u32 s61, s61, 48128
    v_mfma_f32_16x16x32_bf16 v[166:169], a[48:51], a[204:207], v[166:169]
    ds_read_b64_tr_b16 a[228:229], v34 offset:20480
    buffer_load_dwordx4 v63, s[16:19], s61 offen offset:2048 lds
    v_mfma_f32_16x16x32_bf16 v[170:173], a[52:55], a[204:207], v[170:173]
    ds_read_b64_tr_b16 a[230:231], v34 offset:22528
    v_mfma_f32_16x16x32_bf16 v[158:161], a[48:51], a[208:211], v[158:161]
    s_barrier
    s_waitcnt vmcnt(11)
    s_atomic_add s36, s[28:29], s55
    ds_read_b64_tr_b16 a[200:201], v35 offset:0
    v_mfma_f32_16x16x32_bf16 v[162:165], a[52:55], a[208:211], v[162:165]
    ds_read_b64_tr_b16 a[202:203], v35 offset:2048
    buffer_load_dwordx4 v64, s[16:19], s61 offen offset:3072 lds
    v_mfma_f32_16x16x32_bf16 v[174:177], a[48:51], a[212:215], v[174:177]
    ds_read_b64_tr_b16 a[204:205], v37 offset:0
    s_add_u32 m0, s58, 131072
    v_mfma_f32_16x16x32_bf16 v[178:181], a[52:55], a[212:215], v[178:181]
    ds_read_b64_tr_b16 a[206:207], v37 offset:2048
    v_mfma_f32_16x16x32_bf16 v[150:153], a[56:59], a[216:219], v[150:153]
    ds_read_b64_tr_b16 a[208:209], v36 offset:0
    s_add_u32 s66, s66, 1
    v_mfma_f32_16x16x32_bf16 v[154:157], a[60:63], a[216:219], v[154:157]
    ds_read_b64_tr_b16 a[210:211], v36 offset:2048
    s_and_b32 s66, s66, 3
    v_mfma_f32_16x16x32_bf16 v[166:169], a[56:59], a[220:223], v[166:169]
    ds_read_b64_tr_b16 a[212:213], v38 offset:0
    s_lshl_b32 s61, s66, 12
    buffer_load_dwordx4 v65, s[28:31], s61 offen sc1 lds
    v_mfma_f32_16x16x32_bf16 v[170:173], a[60:63], a[220:223], v[170:173]
    ds_read_b64_tr_b16 a[214:215], v38 offset:2048
    s_waitcnt lgkmcnt(8)
    v_mfma_f32_16x16x32_bf16 v[158:161], a[56:59], a[224:227], v[158:161]
    ds_read_b64_tr_b16 a[216:217], v35 offset:4096
    buffer_load_dwordx4 v66, s[28:31], s61 offen offset:1024 sc1 lds
    v_mfma_f32_16x16x32_bf16 v[162:165], a[60:63], a[224:227], v[162:165]
    ds_read_b64_tr_b16 a[218:219], v35 offset:6144
    v_mfma_f32_16x16x32_bf16 v[174:177], a[56:59], a[228:231], v[174:177]
    ds_read_b64_tr_b16 a[220:221], v37 offset:4096
    v_mfma_f32_16x16x32_bf16 v[178:181], a[60:63], a[228:231], v[178:181]
    ds_read_b64_tr_b16 a[222:223], v37 offset:6144
    s_waitcnt lgkmcnt(8)
    v_mfma_f32_16x16x32_bf16 v[150:153], a[64:67], a[200:203], v[150:153]
    ds_read_b64_tr_b16 a[224:225], v36 offset:4096
    buffer_load_dwordx4 v65, s[28:31], s61 offen offset:2048 sc1 lds
    v_mfma_f32_16x16x32_bf16 v[154:157], a[68:71], a[200:203], v[154:157]
    ds_read_b64_tr_b16 a[226:227], v36 offset:6144
    v_mfma_f32_16x16x32_bf16 v[166:169], a[64:67], a[204:207], v[166:169]
    ds_read_b64_tr_b16 a[228:229], v38 offset:4096
    buffer_load_dwordx4 v66, s[28:31], s61 offen offset:3072 sc1 lds
    v_mfma_f32_16x16x32_bf16 v[170:173], a[68:71], a[204:207], v[170:173]
    ds_read_b64_tr_b16 a[230:231], v38 offset:6144
    s_waitcnt lgkmcnt(8)
    v_mfma_f32_16x16x32_bf16 v[158:161], a[64:67], a[208:211], v[158:161]
    ds_read_b64_tr_b16 a[200:201], v35 offset:16384
    s_add_u32 m0, s58, 147456
    v_mfma_f32_16x16x32_bf16 v[162:165], a[68:71], a[208:211], v[162:165]
    ds_read_b64_tr_b16 a[202:203], v35 offset:18432
    s_add_u32 s66, s66, 1
    v_mfma_f32_16x16x32_bf16 v[174:177], a[64:67], a[212:215], v[174:177]
    ds_read_b64_tr_b16 a[204:205], v37 offset:16384
    s_and_b32 s66, s66, 3
    s_lshl_b32 s61, s66, 12
    buffer_load_dwordx4 v65, s[28:31], s61 offen sc1 lds
    v_mfma_f32_16x16x32_bf16 v[178:181], a[68:71], a[212:215], v[178:181]
    ds_read_b64_tr_b16 a[206:207], v37 offset:18432
    s_waitcnt lgkmcnt(8)
    v_mfma_f32_16x16x32_bf16 v[150:153], a[72:75], a[216:219], v[150:153]
    ds_read_b64_tr_b16 a[208:209], v36 offset:16384
    buffer_load_dwordx4 v66, s[28:31], s61 offen offset:1024 sc1 lds
    v_mfma_f32_16x16x32_bf16 v[154:157], a[76:79], a[216:219], v[154:157]
    ds_read_b64_tr_b16 a[210:211], v36 offset:18432
    v_mfma_f32_16x16x32_bf16 v[166:169], a[72:75], a[220:223], v[166:169]
    ds_read_b64_tr_b16 a[212:213], v38 offset:16384
    v_mfma_f32_16x16x32_bf16 v[170:173], a[76:79], a[220:223], v[170:173]
    ds_read_b64_tr_b16 a[214:215], v38 offset:18432
    s_waitcnt lgkmcnt(8)
    v_mfma_f32_16x16x32_bf16 v[158:161], a[72:75], a[224:227], v[158:161]
    ds_read_b64_tr_b16 a[216:217], v35 offset:20480
    buffer_load_dwordx4 v65, s[28:31], s61 offen offset:2048 sc1 lds
    v_mfma_f32_16x16x32_bf16 v[162:165], a[76:79], a[224:227], v[162:165]
    ds_read_b64_tr_b16 a[218:219], v35 offset:22528
    v_mfma_f32_16x16x32_bf16 v[174:177], a[72:75], a[228:231], v[174:177]
    ds_read_b64_tr_b16 a[220:221], v37 offset:20480
    buffer_load_dwordx4 v66, s[28:31], s61 offen offset:3072 sc1 lds
    v_mfma_f32_16x16x32_bf16 v[178:181], a[76:79], a[228:231], v[178:181]
    ds_read_b64_tr_b16 a[222:223], v37 offset:22528
    s_waitcnt lgkmcnt(8)
    v_mfma_f32_16x16x32_bf16 v[150:153], a[80:83], a[200:203], v[150:153]
    ds_read_b64_tr_b16 a[224:225], v36 offset:20480
    v_mfma_f32_16x16x32_bf16 v[154:157], a[84:87], a[200:203], v[154:157]
    ds_read_b64_tr_b16 a[226:227], v36 offset:22528
    v_mfma_f32_16x16x32_bf16 v[166:169], a[80:83], a[204:207], v[166:169]
    ds_read_b64_tr_b16 a[228:229], v38 offset:20480
    v_mfma_f32_16x16x32_bf16 v[170:173], a[84:87], a[204:207], v[170:173]
    ds_read_b64_tr_b16 a[230:231], v38 offset:22528
    s_waitcnt lgkmcnt(8)
    v_mfma_f32_16x16x32_bf16 v[158:161], a[80:83], a[208:211], v[158:161]
    s_barrier
    ds_read_b64_tr_b16 a[200:201], v31 offset:32768
    s_add_u32 m0, s58, 16384
    s_add_u32 s66, s66, 1
    s_and_b32 s66, s66, 3
    s_lshl_b32 s61, s66, 12
    buffer_load_dwordx4 v65, s[28:31], s61 offen sc1 lds
    v_mfma_f32_16x16x32_bf16 v[162:165], a[84:87], a[208:211], v[162:165]
    ds_read_b64_tr_b16 a[202:203], v31 offset:34816
    v_mfma_f32_16x16x32_bf16 v[174:177], a[80:83], a[212:215], v[174:177]
    ds_read_b64_tr_b16 a[204:205], v33 offset:32768
    buffer_load_dwordx4 v66, s[28:31], s61 offen offset:1024 sc1 lds
    v_mfma_f32_16x16x32_bf16 v[178:181], a[84:87], a[212:215], v[178:181]
    ds_read_b64_tr_b16 a[206:207], v33 offset:34816
    s_waitcnt lgkmcnt(8)
    v_mfma_f32_16x16x32_bf16 v[150:153], a[88:91], a[216:219], v[150:153]
    ds_read_b64_tr_b16 a[208:209], v32 offset:32768
    v_mfma_f32_16x16x32_bf16 v[154:157], a[92:95], a[216:219], v[154:157]
    ds_read_b64_tr_b16 a[210:211], v32 offset:34816
    buffer_load_dwordx4 v65, s[28:31], s61 offen offset:2048 sc1 lds
    v_mfma_f32_16x16x32_bf16 v[166:169], a[88:91], a[220:223], v[166:169]
    ds_read_b64_tr_b16 a[212:213], v34 offset:32768
    v_mfma_f32_16x16x32_bf16 v[170:173], a[92:95], a[220:223], v[170:173]
    ds_read_b64_tr_b16 a[214:215], v34 offset:34816
    s_waitcnt lgkmcnt(8)
    v_mfma_f32_16x16x32_bf16 v[158:161], a[88:91], a[224:227], v[158:161]
    ds_read_b64_tr_b16 a[216:217], v31 offset:36864
    buffer_load_dwordx4 v66, s[28:31], s61 offen offset:3072 sc1 lds
    v_mfma_f32_16x16x32_bf16 v[162:165], a[92:95], a[224:227], v[162:165]
    ds_read_b64_tr_b16 a[218:219], v31 offset:38912
    s_add_u32 m0, s58, 65536
    v_mfma_f32_16x16x32_bf16 v[174:177], a[88:91], a[228:231], v[174:177]
    ds_read_b64_tr_b16 a[220:221], v33 offset:36864
    s_add_u32 s66, s66, 1
    v_mfma_f32_16x16x32_bf16 v[178:181], a[92:95], a[228:231], v[178:181]
    ds_read_b64_tr_b16 a[222:223], v33 offset:38912
    s_waitcnt lgkmcnt(8)
    v_mfma_f32_16x16x32_bf16 v[150:153], a[96:99], a[200:203], v[150:153]
    ds_read_b64_tr_b16 a[224:225], v32 offset:36864
    s_and_b32 s66, s66, 3
    s_lshl_b32 s61, s66, 12
    buffer_load_dwordx4 v65, s[28:31], s61 offen sc1 lds
    v_mfma_f32_16x16x32_bf16 v[154:157], a[100:103], a[200:203], v[154:157]
    ds_read_b64_tr_b16 a[226:227], v32 offset:38912
    v_mfma_f32_16x16x32_bf16 v[166:169], a[96:99], a[204:207], v[166:169]
    ds_read_b64_tr_b16 a[228:229], v34 offset:36864
    buffer_load_dwordx4 v66, s[28:31], s61 offen offset:1024 sc1 lds
    v_mfma_f32_16x16x32_bf16 v[170:173], a[100:103], a[204:207], v[170:173]
    ds_read_b64_tr_b16 a[230:231], v34 offset:38912
    s_waitcnt lgkmcnt(8)
    v_mfma_f32_16x16x32_bf16 v[158:161], a[96:99], a[208:211], v[158:161]
    s_waitcnt vmcnt(10)
    s_barrier
    s_xor_b32 s55, s55, 1024
    s_load_dword s14, s[28:29], s55
    ds_read_b64_tr_b16 v[198:199], v43 offset:49152
    ds_read_b64_tr_b16 v[200:201], v43 offset:53248
    v_mfma_f32_16x16x32_bf16 v[162:165], a[100:103], a[208:211], v[162:165]
    ds_read_b64_tr_b16 v[202:203], v44 offset:49152
    buffer_load_dwordx4 v65, s[28:31], s61 offen offset:2048 sc1 lds
    v_mfma_f32_16x16x32_bf16 v[174:177], a[96:99], a[212:215], v[174:177]
    ds_read_b64_tr_b16 v[204:205], v44 offset:53248
    v_mfma_f32_16x16x32_bf16 v[178:181], a[100:103], a[212:215], v[178:181]
    ds_read_b128 a[200:203], v51 offset:0
    s_waitcnt lgkmcnt(9)
    v_mfma_f32_16x16x32_bf16 v[150:153], a[104:107], a[216:219], v[150:153]
    ds_read_b128 a[204:207], v52 offset:0
    buffer_load_dwordx4 v66, s[28:31], s61 offen offset:3072 sc1 lds
    v_mfma_f32_16x16x32_bf16 v[154:157], a[108:111], a[216:219], v[154:157]
    ds_read_b128 a[208:211], v51 offset:1024
    v_mfma_f32_16x16x32_bf16 v[166:169], a[104:107], a[220:223], v[166:169]
    ds_read_b128 a[212:215], v52 offset:1024
    v_mfma_f32_16x16x32_bf16 v[170:173], a[108:111], a[220:223], v[170:173]
    s_waitcnt lgkmcnt(8)
    v_mfma_f32_16x16x32_bf16 v[158:161], a[104:107], a[224:227], v[158:161]
    ds_read_b64_tr_b16 v[206:207], v43 offset:51200
    ds_read_b64_tr_b16 v[208:209], v43 offset:55296
    v_mfma_f32_16x16x32_bf16 v[162:165], a[108:111], a[224:227], v[162:165]
    ds_read_b64_tr_b16 v[210:211], v44 offset:51200
    v_mfma_f32_16x16x32_bf16 v[174:177], a[104:107], a[228:231], v[174:177]
    ds_read_b64_tr_b16 v[212:213], v44 offset:55296
    v_mfma_f32_16x16x32_bf16 v[178:181], a[108:111], a[228:231], v[178:181]
    ds_read_b128 a[216:219], v51 offset:2048
    s_waitcnt lgkmcnt(7)
    v_mfma_f32_16x16x32_bf16 v[150:153], v[198:201], a[200:203], v[150:153]
    ds_read_b128 a[220:223], v52 offset:2048
    v_mfma_f32_16x16x32_bf16 v[154:157], v[202:205], a[200:203], v[154:157]
    ds_read_b128 a[224:227], v51 offset:3072
    v_mfma_f32_16x16x32_bf16 v[166:169], v[198:201], a[204:207], v[166:169]
    ds_read_b128 a[228:231], v52 offset:3072
    v_mfma_f32_16x16x32_bf16 v[170:173], v[202:205], a[204:207], v[170:173]
    s_waitcnt lgkmcnt(8)
    v_mfma_f32_16x16x32_bf16 v[158:161], v[198:201], a[208:211], v[158:161]
    s_waitcnt vmcnt(8)
    s_barrier
    ds_read_b64_tr_b16 v[214:215], v45 offset:32768
    ds_read_b64_tr_b16 v[216:217], v45 offset:36864
    v_mfma_f32_16x16x32_bf16 v[162:165], v[202:205], a[208:211], v[162:165]
    ds_read_b64_tr_b16 v[218:219], v46 offset:32768
    v_mfma_f32_16x16x32_bf16 v[174:177], v[198:201], a[212:215], v[174:177]
    ds_read_b64_tr_b16 v[220:221], v46 offset:36864
    v_mfma_f32_16x16x32_bf16 v[178:181], v[202:205], a[212:215], v[178:181]
    ds_read_b128 a[200:203], v51 offset:16384
    s_waitcnt lgkmcnt(7)
    v_mfma_f32_16x16x32_bf16 v[150:153], v[206:209], a[216:219], v[150:153]
    ds_read_b128 a[204:207], v52 offset:16384
    v_mfma_f32_16x16x32_bf16 v[154:157], v[210:213], a[216:219], v[154:157]
    ds_read_b128 a[208:211], v51 offset:17408
    v_mfma_f32_16x16x32_bf16 v[166:169], v[206:209], a[220:223], v[166:169]
    ds_read_b128 a[212:215], v52 offset:17408
    v_mfma_f32_16x16x32_bf16 v[170:173], v[210:213], a[220:223], v[170:173]
    s_waitcnt lgkmcnt(8)
    v_mfma_f32_16x16x32_bf16 v[158:161], v[206:209], a[224:227], v[158:161]
    s_waitcnt lgkmcnt(0)
    s_cmp_ge_u32 s14, 1
    s_cbranch_scc0 L_pollin7
L_pollok7:
    v_xor_b32 v21, 131072, v21
    ds_read_b64_tr_b16 v[198:199], v45 offset:34816
    ds_read_b64_tr_b16 v[200:201], v45 offset:38912
    buffer_load_dwordx4 v[246:249], v21, s[28:31], 0 offen offset:2048 sc1
    v_mfma_f32_16x16x32_bf16 v[162:165], v[210:213], a[224:227], v[162:165]
    ds_read_b64_tr_b16 v[202:203], v46 offset:34816
    buffer_load_dwordx4 v[250:253], v21, s[28:31], 0 offen offset:3072 sc1
    v_mfma_f32_16x16x32_bf16 v[174:177], v[206:209], a[228:231], v[174:177]
    ds_read_b64_tr_b16 v[204:205], v46 offset:38912
    v_mfma_f32_16x16x32_bf16 v[178:181], v[210:213], a[228:231], v[178:181]
    ds_read_b128 a[216:219], v51 offset:18432
    v_mfma_f32_16x16x32_bf16 v[150:153], v[214:217], a[200:203], v[150:153]
    ds_read_b128 a[220:223], v52 offset:18432
    buffer_load_dwordx4 v[238:241], v21, s[28:31], 0 offen offset:0 sc1
    v_mfma_f32_16x16x32_bf16 v[154:157], v[218:221], a[200:203], v[154:157]
    ds_read_b128 a[224:227], v51 offset:19456
    buffer_load_dwordx4 v[242:245], v21, s[28:31], 0 offen offset:1024 sc1
    v_mfma_f32_16x16x32_bf16 v[166:169], v[214:217], a[204:207], v[166:169]
    ds_read_b128 a[228:231], v52 offset:19456
    v_mfma_f32_16x16x32_bf16 v[170:173], v[218:221], a[204:207], v[170:173]
    v_mfma_f32_16x16x32_bf16 v[158:161], v[214:217], a[208:211], v[158:161]
    s_waitcnt vmcnt(8)
    s_barrier
    ds_read_b64_tr_b16 v[206:207], v45 offset:49152
    ds_read_b64_tr_b16 v[208:209], v45 offset:53248
    v_mfma_f32_16x16x32_bf16 v[162:165], v[218:221], a[208:211], v[162:165]
    ds_read_b64_tr_b16 v[210:211], v46 offset:49152
    v_mfma_f32_16x16x32_bf16 v[174:177], v[214:217], a[212:215], v[174:177]
    ds_read_b64_tr_b16 v[212:213], v46 offset:53248
    v_mfma_f32_16x16x32_bf16 v[178:181], v[218:221], a[212:215], v[178:181]
    ds_read_b128 a[200:203], v47 offset:16384
    s_waitcnt lgkmcnt(7)
    v_mfma_f32_16x16x32_bf16 v[150:153], v[198:201], a[216:219], v[150:153]
    ds_read_b128 a[204:207], v48 offset:16384
    v_mfma_f32_16x16x32_bf16 v[154:157], v[202:205], a[216:219], v[154:157]
    ds_read_b128 a[208:211], v47 offset:17408
    v_mfma_f32_16x16x32_bf16 v[166:169], v[198:201], a[220:223], v[166:169]
    ds_read_b128 a[212:215], v48 offset:17408
    v_mfma_f32_16x16x32_bf16 v[170:173], v[202:205], a[220:223], v[170:173]
    s_waitcnt lgkmcnt(8)
    v_mfma_f32_16x16x32_bf16 v[158:161], v[198:201], a[224:227], v[158:161]
    ds_read_b64_tr_b16 v[214:215], v45 offset:51200
    ds_read_b64_tr_b16 v[216:217], v45 offset:55296
    v_mfma_f32_16x16x32_bf16 v[162:165], v[202:205], a[224:227], v[162:165]
    ds_read_b64_tr_b16 v[218:219], v46 offset:51200
    v_mfma_f32_16x16x32_bf16 v[174:177], v[198:201], a[228:231], v[174:177]
    ds_read_b64_tr_b16 v[220:221], v46 offset:55296
    v_mfma_f32_16x16x32_bf16 v[178:181], v[202:205], a[228:231], v[178:181]
    ds_read_b128 a[216:219], v47 offset:18432
    s_waitcnt lgkmcnt(7)
    v_mfma_f32_16x16x32_bf16 v[150:153], v[206:209], a[200:203], v[150:153]
    ds_read_b128 a[220:223], v48 offset:18432
    v_mfma_f32_16x16x32_bf16 v[154:157], v[210:213], a[200:203], v[154:157]
    ds_read_b128 a[224:227], v47 offset:19456
    v_mfma_f32_16x16x32_bf16 v[166:169], v[206:209], a[204:207], v[166:169]
    ds_read_b128 a[228:231], v48 offset:19456
    v_mfma_f32_16x16x32_bf16 v[170:173], v[210:213], a[204:207], v[170:173]
    s_waitcnt lgkmcnt(8)
    v_mfma_f32_16x16x32_bf16 v[158:161], v[206:209], a[208:211], v[158:161]
    s_waitcnt vmcnt(4)
    s_barrier
    ds_read_b64_tr_b16 v[198:199], v43 offset:0
    ds_read_b64_tr_b16 v[200:201], v43 offset:4096
    v_mfma_f32_16x16x32_bf16 v[162:165], v[210:213], a[208:211], v[162:165]
    ds_read_b64_tr_b16 v[202:203], v44 offset:0
    v_mfma_f32_16x16x32_bf16 v[174:177], v[206:209], a[212:215], v[174:177]
    ds_read_b64_tr_b16 v[204:205], v44 offset:4096
    v_mfma_f32_16x16x32_bf16 v[178:181], v[210:213], a[212:215], v[178:181]
    ds_read_b128 a[200:203], v50 offset:0
    s_waitcnt lgkmcnt(7)
    v_mfma_f32_16x16x32_bf16 v[150:153], v[214:217], a[216:219], v[150:153]
    ds_read_b128 a[204:207], v50 offset:1024
    ds_read_b64_tr_b16 v[206:207], v43 offset:2048
    v_mfma_f32_16x16x32_bf16 v[154:157], v[218:221], a[216:219], v[154:157]
    ds_read_b64_tr_b16 v[208:209], v43 offset:6144
    ds_read_b64_tr_b16 v[210:211], v44 offset:2048
    v_mfma_f32_16x16x32_bf16 v[166:169], v[214:217], a[220:223], v[166:169]
    ds_read_b64_tr_b16 v[212:213], v44 offset:6144
    v_mfma_f32_16x16x32_bf16 v[170:173], v[218:221], a[220:223], v[170:173]
    ds_read_b128 a[208:211], v50 offset:2048
    s_waitcnt lgkmcnt(11)
    v_mfma_f32_16x16x32_bf16 v[158:161], v[214:217], a[224:227], v[158:161]
    ds_read_b128 a[212:215], v50 offset:3072
    v_mfma_f32_16x16x32_bf16 v[162:165], v[218:221], a[224:227], v[162:165]
    v_mfma_f32_16x16x32_bf16 v[174:177], v[214:217], a[228:231], v[174:177]
    v_mfma_f32_16x16x32_bf16 v[178:181], v[218:221], a[228:231], v[178:181]
    s_waitcnt lgkmcnt(6)
    v_mfma_f32_16x16x32_bf16 v[166:169], v[198:201], a[200:203], v[166:169]
    ds_read_b128 a[224:227], v49 offset:0
    v_mfma_f32_16x16x32_bf16 v[170:173], v[202:205], a[200:203], v[170:173]
    v_mfma_f32_16x16x32_bf16 v[174:177], v[198:201], a[204:207], v[174:177]
    ds_read_b128 a[228:231], v49 offset:1024
    v_mfma_f32_16x16x32_bf16 v[178:181], v[202:205], a[204:207], v[178:181]
    s_waitcnt lgkmcnt(2)
    v_mfma_f32_16x16x32_bf16 v[166:169], v[206:209], a[208:211], v[166:169]
    ds_read_b128 a[200:203], v49 offset:2048
    v_mfma_f32_16x16x32_bf16 v[170:173], v[210:213], a[208:211], v[170:173]
    v_mfma_f32_16x16x32_bf16 v[174:177], v[206:209], a[212:215], v[174:177]
    ds_read_b128 a[204:207], v49 offset:3072
L_pad4:
    s_cbranch_execz L_warm
    v_mfma_f32_16x16x32_bf16 v[178:181], v[210:213], a[212:215], v[178:181]
    s_waitcnt vmcnt(3)
    v_mfma_f32_16x16x32_bf16 v[166:169], a[250:253], v[246:249], v[166:169]
    v_mfma_f32_16x16x32_bf16 v[170:173], a[248:251], v[246:249], v[170:173]
    s_waitcnt vmcnt(2)
    v_mfma_f32_16x16x32_bf16 v[174:177], a[250:253], v[250:253], v[174:177]
    v_mfma_f32_16x16x32_bf16 v[178:181], a[248:251], v[250:253], v[178:181]
    s_waitcnt lgkmcnt(2)
    v_mfma_f32_16x16x32_bf16 v[150:153], v[198:201], a[224:227], v[150:153]
    v_mfma_f32_16x16x32_bf16 v[154:157], v[202:205], a[224:227], v[154:157]
    v_mfma_f32_16x16x32_bf16 v[158:161], v[198:201], a[228:231], v[158:161]
    ds_write_b128 v87, v[166:169] offset:8192
    v_mfma_f32_16x16x32_bf16 v[162:165], v[202:205], a[228:231], v[162:165]
    s_waitcnt lgkmcnt(1)
    v_mfma_f32_16x16x32_bf16 v[150:153], v[206:209], a[200:203], v[150:153]
    ds_write_b128 v88, v[170:173] offset:8192
    v_mfma_f32_16x16x32_bf16 v[154:157], v[210:213], a[200:203], v[154:157]
    v_mfma_f32_16x16x32_bf16 v[158:161], v[206:209], a[204:207], v[158:161]
    ds_write_b128 v87, v[174:177] offset:12288
    v_mfma_f32_16x16x32_bf16 v[162:165], v[210:213], a[204:207], v[162:165]
    s_waitcnt vmcnt(1)
    v_mfma_f32_16x16x32_bf16 v[150:153], a[250:253], v[238:241], v[150:153]
    ds_write_b128 v88, v[178:181] offset:12288
    v_mfma_f32_16x16x32_bf16 v[154:157], a[248:251], v[238:241], v[154:157]
    s_waitcnt vmcnt(0)
    v_mfma_f32_16x16x32_bf16 v[158:161], a[250:253], v[242:245], v[158:161]
    v_mfma_f32_16x16x32_bf16 v[162:165], a[248:251], v[242:245], v[162:165]
    s_nop 2
    ds_write_b128 v87, v[150:153] offset:0
    s_nop 0
    ds_write_b128 v88, v[154:157] offset:0
    s_nop 0
    ds_write_b128 v87, v[158:161] offset:4096
    ds_write_b128 v88, v[162:165] offset:4096
    s_waitcnt lgkmcnt(0)
    s_barrier
    ds_read_b128 v[118:121], v89 offset:0
    ds_read_b128 v[122:125], v90 offset:0
    ds_read_b128 v[126:129], v91 offset:0
    ds_read_b128 v[130:133], v92 offset:0
    ds_read_b128 v[134:137], v89 offset:2048
    ds_read_b128 v[138:141], v90 offset:2048
    ds_read_b128 v[142:145], v91 offset:2048
    ds_read_b128 v[146:149], v92 offset:2048
    s_waitcnt lgkmcnt(7)
    v_pk_add_f32 v[222:223], v[222:223], v[118:119]
    v_pk_add_f32 v[224:225], v[224:225], v[120:121]
    s_waitcnt lgkmcnt(6)
    v_pk_add_f32 v[226:227], v[226:227], v[122:123]
    v_pk_add_f32 v[228:229], v[228:229], v[124:125]
    s_waitcnt lgkmcnt(5)
    v_pk_add_f32 v[222:223], v[222:223], v[126:127]
    v_pk_add_f32 v[224:225], v[224:225], v[128:129]
    s_waitcnt lgkmcnt(4)
    v_pk_add_f32 v[226:227], v[226:227], v[130:131]
    v_pk_add_f32 v[228:229], v[228:229], v[132:133]
    v_cvt_pk_bf16_f32 v110, v222, v223
    v_cvt_pk_bf16_f32 v111, v224, v225
    v_cvt_pk_bf16_f32 v112, v226, v227
    v_cvt_pk_bf16_f32 v113, v228, v229
    buffer_store_dwordx4 v[110:113], v85, s[32:35], 0 offen
    s_waitcnt lgkmcnt(3)
    v_pk_add_f32 v[230:231], v[230:231], v[134:135]
    v_pk_add_f32 v[232:233], v[232:233], v[136:137]
    s_waitcnt lgkmcnt(2)
    v_pk_add_f32 v[234:235], v[234:235], v[138:139]
    v_pk_add_f32 v[236:237], v[236:237], v[140:141]
    s_waitcnt lgkmcnt(1)
    v_pk_add_f32 v[230:231], v[230:231], v[142:143]
    v_pk_add_f32 v[232:233], v[232:233], v[144:145]
    s_waitcnt lgkmcnt(0)
    v_pk_add_f32 v[234:235], v[234:235], v[146:147]
    v_pk_add_f32 v[236:237], v[236:237], v[148:149]
    v_cvt_pk_bf16_f32 v114, v230, v231
    v_cvt_pk_bf16_f32 v115, v232, v233
    v_cvt_pk_bf16_f32 v116, v234, v235
    v_cvt_pk_bf16_f32 v117, v236, v237
    buffer_store_dwordx4 v[114:117], v86, s[32:35], 0 offen
L_fin:
L_end:
    s_endpgm
L_nonce:
    buffer_load_dword v12, v16, s[44:47], 0 offen sc1
    s_add_u32 s60, s60, 1
    s_waitcnt vmcnt(0)
    v_readfirstlane_b32 s57, v12
    s_cmp_ge_u32 s60, 20000
    s_cbranch_scc1 L_nonce_ok
    s_cmp_eq_u32 s57, 0
    s_cbranch_scc1 L_nonce
    s_branch L_nonce_ok
L_pollin0:
    s_mov_b32 s60, 0
L_poll0:
    s_sleep 4
    buffer_load_dword v18, v20, s[28:31], 0 offen sc1
    s_add_u32 s60, s60, 1
    s_waitcnt vmcnt(0)
    v_cmp_ne_u32 vcc, s57, v18
    s_cbranch_vccz L_pollok0
    s_cmp_lt_u32 s60, 20000
    s_cbranch_scc1 L_poll0
    s_branch L_pollok0
L_pollin1:
    s_mov_b32 s60, 0
L_poll1:
    s_sleep 8
    buffer_load_dword v18, off, s[44:47], s15 sc1
    s_add_u32 s60, s60, 1
    s_waitcnt vmcnt(0)
    v_readfirstlane_b32 s14, v18
    s_nop 0
    s_cmp_ge_u32 s14, 14
    s_cbranch_scc1 L_pollok1
    s_cmp_lt_u32 s60, 20000
    s_cbranch_scc1 L_poll1
    s_branch L_pollok1
L_pollin2:
    s_mov_b32 s60, 0
L_poll2:
    s_sleep 4
    buffer_load_dword v18, off, s[28:31], s37 sc1
    s_add_u32 s60, s60, 1
    s_waitcnt vmcnt(0)
    v_readfirstlane_b32 s14, v18
    s_nop 0
    s_cmp_ge_u32 s14, 2
    s_cbranch_scc1 L_pollok2
    s_cmp_lt_u32 s60, 20000
    s_cbranch_scc1 L_poll2
    s_branch L_pollok2
L_nonceh:
    buffer_load_dword v12, v16, s[44:47], 0 offen sc1
    s_add_u32 s60, s60, 1
    s_waitcnt vmcnt(0)
    v_readfirstlane_b32 s57, v12
    s_cmp_ge_u32 s60, 20000
    s_cbranch_scc1 L_nonce_okh
    s_cmp_eq_u32 s57, 0
    s_cbranch_scc1 L_nonceh
    s_branch L_nonce_okh
L_pollin3:
    s_mov_b32 s60, 0
L_poll3:
    s_sleep 8
    buffer_load_dword v18, v20, s[28:31], 0 offen sc1
    s_add_u32 s60, s60, 1
    s_waitcnt vmcnt(0)
    v_cmp_ne_u32 vcc, s57, v18
    s_cbranch_vccz L_pollok3
    s_cmp_lt_u32 s60, 20000
    s_cbranch_scc1 L_poll3
    s_branch L_pollok3
L_pollin4:
    s_mov_b32 s60, 0
L_poll4:
    s_sleep 16
    buffer_load_dword v18, off, s[44:47], s15 sc1
    s_add_u32 s60, s60, 1
    s_waitcnt vmcnt(0)
    v_readfirstlane_b32 s14, v18
    s_nop 0
    s_cmp_ge_u32 s14, 14
    s_cbranch_scc1 L_pollok4
    s_cmp_lt_u32 s60, 20000
    s_cbranch_scc1 L_poll4
    s_branch L_pollok4
L_nog1:
    s_nop 1
    s_mov_b32 s14, 1204224
    s_mov_b32 s15, 0x20000
    s_sub_u32 s3, s2, 200
    s_cmp_lt_u32 s3, 42
    s_cselect_b32 s81, 0, 268435456
    s_cselect_b32 s3, s3, 0
    s_mul_i32 s79, s3, 43
    s_lshr_b32 s79, s79, 7
    s_mul_i32 s80, s79, 3
    s_sub_u32 s80, s3, s80
    v_min_u32 v13, 55, v1
    s_lshl_b32 s3, s79, 2
    s_add_u32 s3, s3, s48
    s_mul_i32 s3, s3, 21504
    s_mul_i32 s60, s80, 896
    s_add_u32 s3, s3, s60
    s_add_u32 s3, s3, s81
    v_lshl_add_u32 v242, v13, 4, s3
    s_mul_i32 s60, s48, 8448
    s_add_u32 m0, s60, 0
    s_mov_b32 s3, 0
    buffer_load_dwordx4 v242, s[12:15], s3 offen lds
    s_add_u32 m0, s60, 1056
    s_mov_b32 s3, 2688
    buffer_load_dwordx4 v242, s[12:15], s3 offen lds
    s_add_u32 m0, s60, 2112
    s_mov_b32 s3, 5376
    buffer_load_dwordx4 v242, s[12:15], s3 offen lds
    s_add_u32 m0, s60, 3168
    s_mov_b32 s3, 8064
    buffer_load_dwordx4 v242, s[12:15], s3 offen lds
    s_add_u32 m0, s60, 4224
    s_mov_b32 s3, 10752
    buffer_load_dwordx4 v242, s[12:15], s3 offen lds
    s_add_u32 m0, s60, 5280
    s_mov_b32 s3, 13440
    buffer_load_dwordx4 v242, s[12:15], s3 offen lds
    s_add_u32 m0, s60, 6336
    s_mov_b32 s3, 16128
    buffer_load_dwordx4 v242, s[12:15], s3 offen lds
    s_add_u32 m0, s60, 7392
    s_mov_b32 s3, 18816
    buffer_load_dwordx4 v242, s[12:15], s3 offen lds
    s_mul_i32 s53, s101, 37
    s_lshr_b32 s53, s53, 8
    s_mul_i32 s54, s53, 7
    s_sub_u32 s54, s101, s54
    s_and_b32 s53, s53, 3
    s_lshl_b32 s3, s6, 2
    s_add_u32 s53, s53, s3
    s_lshl_b32 s53, s53, 1
    s_add_u32 s53, s53, s7
    s_mov_b32 s42, 4096
    s_mov_b32 s43, 0x20000
    s_lshl_b32 s3, s53, 2
    s_add_u32 s3, s3, s48
    s_lshl_b32 s60, s3, 5
    v_lshl_add_u32 v82, v5, 1, s60
    s_mul_i32 s3, s3, 14336
    s_lshl_b32 s60, s54, 7
    s_add_u32 s3, s3, s60
    v_mul_u32_u24 v14, 896, v5
    v_lshl_add_u32 v14, v6, 4, v14
    v_add_u32 v85, s3, v14
    v_add_u32 v86, 7168, v85
    s_cmp_lt_u32 s101, 28
    s_cselect_b32 s56, 1, 0
    s_lshl_b32 s50, s7, 3
    s_and_b32 s3, s101, 7
    s_add_u32 s50, s50, s3
    s_lshr_b32 s60, s101, 3
    s_lshl_b32 s49, s6, 2
    s_add_u32 s49, s49, s60
    s_lshl_b32 s49, s49, 2
    s_add_u32 s49, s49, s48
    s_mul_i32 s60, s60, 0
    s_add_u32 s3, s3, s60
    s_sub_u32 s60, s3, 7
    s_cmp_ge_u32 s3, 7
    s_cselect_b32 s3, s60, s3
    s_lshl_b32 s62, s3, 18
    s_mul_i32 s63, s3, 12288
    s_mov_b32 s30, 20971520
    s_mov_b32 s31, 0x20000
    s_mov_b32 s75, 0x3727c5ac
    s_mov_b32 s76, 0x3b124925
    s_mov_b32 s77, 0x3f803f80
    v_lshlrev_b32 v4, 4, v1
    v_bfe_u32 v7, v1, 2, 2
    v_and_b32 v8, 3, v1
    v_mul_u32_u24 v13, 960, v9
    v_lshl_add_u32 v13, v10, 4, v13
    s_mul_i32 s3, s48, 1920
    s_add_u32 s3, s3, 147456
    v_add_u32 v230, s3, v13
    v_mul_u32_u24 v13, 960, v7
    v_lshl_add_u32 v13, v3, 5, v13
    v_lshl_add_u32 v13, v8, 3, v13
    s_lshl_b32 s3, s48, 8
    s_add_u32 s3, s3, 147456
    v_add_u32 v231, s3, v13
    s_lshl_b32 s3, s48, 3
    s_add_u32 s3, s3, 155648
    v_lshl_add_u32 v232, v9, 2, s3
    v_lshlrev_b32 v237, 2, v6
    v_and_b32 v2, 15, v1
    v_lshlrev_b32 v238, 14, v3
    v_add_lshl_u32 v238, v238, v2, 2
    v_add_u32 v237, 155648, v237
    v_lshlrev_b32 v13, 17, v9
    v_lshl_add_u32 v233, v10, 4, v13
    s_cmp_eq_u32 s48, 3
    s_cselect_b32 s60, 268435456, 0
    s_lshl_b32 s70, s48, 10
    s_add_u32 s70, s70, s2
    s_lshl_b32 s70, s70, 9
    s_add_u32 s71, s70, 262144
    s_add_u32 s71, s71, s60
    s_xor_b32 s60, s60, 268435456
    s_lshl_b32 s72, s2, 7
    s_add_u32 s72, s72, s60
    s_add_u32 s72, s72, 6291456
    s_lshr_b32 s74, s2, 2
    s_lshl_b32 s74, s74, 5
    s_and_b32 s3, s2, 3
    s_add_u32 s74, s74, s3
    s_lshl_b32 s74, s74, 2
    s_add_u32 s74, s74, 10485760
    v_cmp_gt_u32 vcc, 8, v0
    v_lshlrev_b32 v236, 13, v0
    v_mov_b32 v13, 268435456
    s_and_b32 s3, s2, 7
    s_lshl_b32 s3, s3, 13
    s_add_u32 s3, s3, 10485760
    v_lshrrev_b32 v14, 2, v0
    v_lshl_add_u32 v14, v14, 7, s3
    v_lshl_add_u32 v20, v8, 2, v14
    v_cndmask_b32 v236, v13, v236, vcc
    v_mov_b32 v16, 0
    s_lshl_b32 s3, s48, 14
    s_add_u32 s74, s74, s3
    s_add_u32 s73, s74, 8192
    s_waitcnt vmcnt(10)
    v_dot2_f32_bf16 v226, v182, s77, 0
    v_dot2_f32_bf16 v227, v182, v182, 0
    v_dot2_f32_bf16 v226, v183, s77, v226
    v_dot2_f32_bf16 v227, v183, v183, v227
    v_dot2_f32_bf16 v226, v184, s77, v226
    v_dot2_f32_bf16 v227, v184, v184, v227
    v_dot2_f32_bf16 v226, v185, s77, v226
    v_dot2_f32_bf16 v227, v185, v185, v227
    s_waitcnt vmcnt(9)
    v_dot2_f32_bf16 v226, v186, s77, v226
    v_dot2_f32_bf16 v227, v186, v186, v227
    v_dot2_f32_bf16 v226, v187, s77, v226
    v_dot2_f32_bf16 v227, v187, v187, v227
    v_dot2_f32_bf16 v226, v188, s77, v226
    v_dot2_f32_bf16 v227, v188, v188, v227
    v_dot2_f32_bf16 v226, v189, s77, v226
    v_dot2_f32_bf16 v227, v189, v189, v227
    buffer_load_dword v12, v16, s[44:47], 0 offen sc1
    v_lshlrev_b32 v190, 16, v182
    v_and_b32 v191, 0xffff0000, v182
    v_add_f32_dpp v226, v226, v226 quad_perm:[1,0,3,2] row_mask:0xf bank_mask:0xf
    v_add_f32_dpp v227, v227, v227 quad_perm:[1,0,3,2] row_mask:0xf bank_mask:0xf
    v_lshlrev_b32 v192, 16, v183
    v_add_f32_dpp v226, v226, v226 quad_perm:[2,3,0,1] row_mask:0xf bank_mask:0xf
    v_add_f32_dpp v227, v227, v227 quad_perm:[2,3,0,1] row_mask:0xf bank_mask:0xf
    v_and_b32 v193, 0xffff0000, v183
    v_add_f32_dpp v226, v226, v226 row_half_mirror row_mask:0xf bank_mask:0xf
    v_add_f32_dpp v227, v227, v227 row_half_mirror row_mask:0xf bank_mask:0xf
    v_lshlrev_b32 v194, 16, v184
    v_add_f32_dpp v226, v226, v226 row_mirror row_mask:0xf bank_mask:0xf
    v_add_f32_dpp v227, v227, v227 row_mirror row_mask:0xf bank_mask:0xf
    v_and_b32 v195, 0xffff0000, v184
    v_mov_b32 v228, v226
    v_mov_b32 v229, v227
    v_lshlrev_b32 v196, 16, v185
    v_permlane16_swap_b32 v226, v228
    v_permlane16_swap_b32 v227, v229
    v_add_f32 v226, v226, v228
    v_add_f32 v227, v227, v229
    v_mul_f32_e64 v226, -v226, s76
    v_mul_f32 v228, v226, v226
    v_fma_f32 v227, v227, s76, -v228
    v_max_f32 v227, 0, v227
    v_add_f32 v228, s75, v227
    v_rsq_f32 v222, v228
    v_and_b32 v197, 0xffff0000, v185
    v_mul_f32 v228, v222, v222
    v_fma_f32 v229, v228, v227, s75
    v_rsq_f32 v228, v229
    v_mul_f32 v223, v226, v222
    v_mul_f32 v224, v222, v228
    v_mul_f32 v225, v223, v228
    v_mul_f32 v229, v229, v228
    ds_write_b32 v232, v229
    v_lshlrev_b32 v198, 16, v186
    v_and_b32 v199, 0xffff0000, v186
    v_lshlrev_b32 v200, 16, v187
    v_and_b32 v201, 0xffff0000, v187
    v_lshlrev_b32 v202, 16, v188
    v_and_b32 v203, 0xffff0000, v188
    v_lshlrev_b32 v204, 16, v189
    v_and_b32 v205, 0xffff0000, v189
    v_pk_fma_f32 v[206:207], v[190:191], v[224:225], v[224:225] op_sel:[0,0,1] op_sel_hi:[1,0,1]
    v_pk_fma_f32 v[208:209], v[192:193], v[224:225], v[224:225] op_sel:[0,0,1] op_sel_hi:[1,0,1]
    v_pk_fma_f32 v[210:211], v[194:195], v[224:225], v[224:225] op_sel:[0,0,1] op_sel_hi:[1,0,1]
    v_pk_fma_f32 v[212:213], v[196:197], v[224:225], v[224:225] op_sel:[0,0,1] op_sel_hi:[1,0,1]
    v_cvt_pk_bf16_f32 v182, v206, v207
    v_cvt_pk_bf16_f32 v183, v208, v209
    v_cvt_pk_bf16_f32 v184, v210, v211
    v_cvt_pk_bf16_f32 v185, v212, v213
    ds_write_b128 v230, v[182:185] offset:0
    v_pk_fma_f32 v[214:215], v[198:199], v[224:225], v[224:225] op_sel:[0,0,1] op_sel_hi:[1,0,1]
    v_pk_fma_f32 v[216:217], v[200:201], v[224:225], v[224:225] op_sel:[0,0,1] op_sel_hi:[1,0,1]
    v_pk_fma_f32 v[218:219], v[202:203], v[224:225], v[224:225] op_sel:[0,0,1] op_sel_hi:[1,0,1]
    v_pk_fma_f32 v[220:221], v[204:205], v[224:225], v[224:225] op_sel:[0,0,1] op_sel_hi:[1,0,1]
    v_cvt_pk_bf16_f32 v186, v214, v215
    v_cvt_pk_bf16_f32 v187, v216, v217
    v_cvt_pk_bf16_f32 v188, v218, v219
    v_cvt_pk_bf16_f32 v189, v220, v221
    ds_write_b128 v230, v[186:189] offset:448
    s_waitcnt lgkmcnt(0)
    s_barrier
    ds_read_b64_tr_b16 v[110:111], v231 offset:0
    ds_read_b64_tr_b16 v[112:113], v231 offset:3840
    ds_read_b64_tr_b16 v[114:115], v231 offset:128
    ds_read_b64_tr_b16 v[116:117], v231 offset:3968
    ds_read_b32 v229, v237
    s_waitcnt lgkmcnt(3)
    buffer_store_dwordx4 v[110:113], v233, s[28:31], s70 offen sc1
    s_waitcnt lgkmcnt(1)
    buffer_store_dwordx4 v[114:117], v233, s[28:31], s71 offen sc1
    v_cmp_gt_u32 vcc, 16, v1
    s_waitcnt lgkmcnt(0)
    s_nop 0
    v_cndmask_b32 v229, 0, v229, vcc
    buffer_store_dword v229, v238, s[28:31], s72 offen sc1
    v_lshrrev_b32 v13, 2, v1
    v_mul_u32_u24 v13, 1056, v13
    v_lshl_add_u32 v13, v8, 3, v13
    s_mul_i32 s3, s48, 224
    v_add_u32 v243, s3, v13
    s_mov_b32 s18, 401408
    s_mov_b32 s19, 0x20000
    s_mov_b32 s26, 7340032
    s_mov_b32 s27, 0x20000
    s_mov_b32 s34, 1835008
    s_mov_b32 s35, 0x20000
    s_mov_b32 s36, 1
    v_lshrrev_b32 v14, 2, v1
    v_lshlrev_b32 v14, 7, v14
    v_lshl_add_u32 v14, v8, 3, v14
    v_and_b32 v15, 3, v5
    v_lshl_add_u32 v14, v15, 5, v14
    s_mul_i32 s3, s4, 8256
    v_xor_b32 v31, s3, v14
    v_xor_b32 v32, 32, v31
    v_xor_b32 v33, 64, v31
    v_xor_b32 v34, 96, v31
    v_add_u32 v35, 65536, v31
    v_add_u32 v36, 65536, v32
    v_add_u32 v37, 65536, v33
    v_add_u32 v38, 65536, v34
    v_add_u32 v39, 131072, v31
    v_add_u32 v40, 131072, v32
    v_add_u32 v41, 131072, v33
    v_add_u32 v42, 131072, v34
    s_lshl_b32 s6, s52, 1
    s_add_u32 s6, s6, s5
    s_lshl_b32 s3, s6, 1
    s_add_u32 s3, s3, s59
    s_lshl_b32 s3, s3, 4
    s_add_u32 s3, s3, s4
    s_lshl_b32 s3, s3, 12
    v_lshl_add_u32 v78, v3, 8, v4
    v_add_u32 v78, s3, v78
    s_xor_b32 s37, s51, 1
    s_lshl_b32 s37, s37, 3
    s_add_u32 s37, s37, s52
    s_lshl_b32 s3, s37, 14
    s_add_u32 s3, s3, s58
    s_add_u32 s3, s3, 16777216
    v_add_u32 v23, s3, v4
    s_lshl_b32 s37, s37, 5
    s_add_u32 s37, s37, s5
    s_lshl_b32 s37, s37, 2
    s_add_u32 s37, s37, 6422528
    s_mul_i32 s67, s6, 56
    s_lshl_b32 s3, s51, 1
    s_add_u32 s3, s3, s4
    s_add_u32 s67, s67, s3
    s_lshl_b32 s67, s67, 11
    s_add_u32 s67, s67, 2097152
    v_add_u32 v81, s58, v4
    s_lshl_b32 s68, s52, 2
    s_and_b32 s3, s51, 1
    s_add_u32 s68, s68, s3
    s_cmp_ge_u32 s51, 14
    s_cselect_b32 s3, 2, 0
    s_add_u32 s68, s68, s3
    s_lshl_b32 s68, s68, 7
    s_add_u32 s68, s68, 6356992
    s_waitcnt vmcnt(3)
    v_readfirstlane_b32 s57, v12
    s_mov_b32 s60, 0
    s_cmp_lg_u32 s57, 0
    s_cbranch_scc0 L_nonceh
L_nonce_okh:
    s_waitcnt vmcnt(0)
    s_barrier
    s_atomic_swap s57, s[28:29], s74
    s_atomic_swap s57, s[28:29], s73
    buffer_load_dwordx4 v[96:99], v85, s[8:11], 0 offen
    buffer_load_ushort v93, v82, s[40:43], 0 offen offset:0
    buffer_load_dwordx4 v[100:103], v86, s[8:11], 0 offen
    buffer_load_ushort v94, v82, s[40:43], 0 offen offset:16
    v_cmp_gt_u32 vcc, 12, v2
    s_mul_i32 s3, s48, 56
    s_add_u32 s3, s3, s79
    s_mul_i32 s3, s3, 3
    s_add_u32 s3, s3, s80
    s_lshl_b32 s3, s3, 11
    s_add_u32 s3, s3, 8388608
    s_add_u32 s3, s3, s81
    ds_read_b64_tr_b16 v[182:183], v243 offset:0
    ds_read_b64_tr_b16 v[184:185], v243 offset:16896
    ds_read_b64_tr_b16 v[186:187], v243 offset:32
    ds_read_b64_tr_b16 v[188:189], v243 offset:16928
    ds_read_b64_tr_b16 v[190:191], v243 offset:56
    ds_read_b64_tr_b16 v[192:193], v243 offset:16952
    ds_read_b64_tr_b16 v[194:195], v243 offset:88
    ds_read_b64_tr_b16 v[196:197], v243 offset:16984
    ds_read_b64_tr_b16 v[198:199], v243 offset:112
    ds_read_b64_tr_b16 v[200:201], v243 offset:17008
    ds_read_b64_tr_b16 v[202:203], v243 offset:144
    ds_read_b64_tr_b16 v[204:205], v243 offset:17040
    ds_read_b64_tr_b16 v[206:207], v243 offset:168
    ds_read_b64_tr_b16 v[208:209], v243 offset:17064
    ds_read_b64_tr_b16 v[210:211], v243 offset:200
    ds_read_b64_tr_b16 v[212:213], v243 offset:17096
    s_waitcnt lgkmcnt(13)
    v_cndmask_b32 v186, 0, v186, vcc
    v_cndmask_b32 v187, 0, v187, vcc
    s_waitcnt lgkmcnt(12)
    v_cndmask_b32 v188, 0, v188, vcc
    v_cndmask_b32 v189, 0, v189, vcc
    buffer_store_dwordx4 v[182:185], v4, s[28:31], s3 offen offset:0 sc1
    buffer_store_dwordx4 v[186:189], v4, s[28:31], s3 offen offset:1024 sc1
    s_add_u32 s3, s3, 86016
    s_waitcnt lgkmcnt(9)
    v_cndmask_b32 v194, 0, v194, vcc
    v_cndmask_b32 v195, 0, v195, vcc
    s_waitcnt lgkmcnt(8)
    v_cndmask_b32 v196, 0, v196, vcc
    v_cndmask_b32 v197, 0, v197, vcc
    buffer_store_dwordx4 v[190:193], v4, s[28:31], s3 offen offset:0 sc1
    buffer_store_dwordx4 v[194:197], v4, s[28:31], s3 offen offset:1024 sc1
    s_add_u32 s3, s3, 86016
    s_waitcnt lgkmcnt(5)
    v_cndmask_b32 v202, 0, v202, vcc
    v_cndmask_b32 v203, 0, v203, vcc
    s_waitcnt lgkmcnt(4)
    v_cndmask_b32 v204, 0, v204, vcc
    v_cndmask_b32 v205, 0, v205, vcc
    buffer_store_dwordx4 v[198:201], v4, s[28:31], s3 offen offset:0 sc1
    buffer_store_dwordx4 v[202:205], v4, s[28:31], s3 offen offset:1024 sc1
    s_add_u32 s3, s3, 86016
    ds_read_b32 v24, v4
    s_waitcnt lgkmcnt(2)
    v_cndmask_b32 v210, 0, v210, vcc
    v_cndmask_b32 v211, 0, v211, vcc
    ds_read_b32 v24, v4
    s_waitcnt lgkmcnt(2)
    v_cndmask_b32 v212, 0, v212, vcc
    v_cndmask_b32 v213, 0, v213, vcc
    buffer_store_dwordx4 v[206:209], v4, s[28:31], s3 offen offset:0 sc1
    buffer_store_dwordx4 v[210:213], v4, s[28:31], s3 offen offset:1024 sc1
    s_add_u32 s3, s3, 86016
    s_lshl_b32 s67, s80, 6
    s_add_u32 s67, s67, 64
    s_cmp_eq_u32 s81, 0
    s_cselect_b32 s37, s48, 1
    s_mov_b32 s68, 6369792
    s_and_b32 s3, s2, 1
    s_mul_i32 s3, s3, 3
    s_bfe_u32 s6, s2, 0x10001
    s_mul_i32 s7, s6, 6
    s_add_u32 s3, s3, s7
    s_add_u32 s3, s3, 1
    v_add_u32 v14, s3, v8
    s_mul_i32 s6, s6, 64
    s_add_u32 s6, s6, 7
    v_cmp_ne_u32 vcc, s6, v14
    v_lshrrev_b32 v15, 2, v1
    v_mul_u32_u24 v15, 3584, v15
    v_cndmask_b32 v14, 0, v14, vcc
    v_lshl_add_u32 v14, v14, 8, v15
    s_lshl_b32 s3, s52, 2
    s_add_u32 s3, s3, s48
    s_mul_i32 s3, s3, 37
    s_min_u32 s3, s3, 976
    s_mul_i32 s3, s3, 3584
    s_mul_i32 s6, s59, 3670144
    s_add_u32 s3, s3, s6
    buffer_load_dword v226, v14, s[20:23], s3 offen
    s_add_u32 s3, s3, 57344
    buffer_load_dword v227, v14, s[20:23], s3 offen
    s_add_u32 s3, s3, 57344
    buffer_load_dword v228, v14, s[20:23], s3 offen
    s_add_u32 s3, s3, 57344
    v_add_u32 v53, 65536, v4
    v_add_u32 v54, 131072, v4
    s_mul_i32 s59, s48, 3072
    s_mul_i32 s3, s50, 86016
    s_add_u32 s3, s3, s59
    s_add_u32 s3, s3, 8388608
    v_add_u32 v80, s3, v4
    v_lshlrev_b32 v14, 7, v9
    v_xor_b32 v14, v14, v4
    s_lshl_b32 s3, s49, 11
    v_add_u32 v67, s3, v14
    v_add_u32 v68, 129024, v67
    s_lshr_b32 s3, s49, 2
    s_lshl_b32 s3, s3, 3
    s_max_u32 s3, s3, 1
    s_sub_u32 s3, s3, 1
    s_lshl_b32 s3, s3, 10
    s_lshl_b32 s6, s5, 17
    s_add_u32 s3, s3, s6
    s_lshl_b32 s6, s4, 28
    s_add_u32 s3, s3, s6
    v_add_u32 v69, s3, v14
    s_lshl_b32 s100, s5, 1
    s_add_u32 s100, s100, s4
    s_lshl_b32 s100, s100, 10
    v_and_b32 v14, 1, v1
    v_mul_u32_u24 v14, 640, v14
    v_lshrrev_b32 v15, 2, v1
    v_lshlrev_b32 v15, 4, v15
    v_xor_b32 v14, v14, v15
    v_bfe_u32 v15, v1, 1, 1
    v_lshl_add_u32 v14, v15, 3, v14
    s_add_u32 s3, s58, 12288
    v_add_u32 v70, s3, v14
    s_sub_u32 s3, s3, 3072
    s_cmp_eq_u32 s48, 0
    s_cselect_b32 s3, 28672, s3
    v_add_u32 v71, s3, v14
    v_add_u32 v72, 65536, v70
    v_add_u32 v73, 65536, v71
    v_add_u32 v74, 131072, v70
    v_add_u32 v75, 131072, v71
    s_lshl_b32 s3, s49, 1
    v_min_u32 v14, 2, v3
    v_add_u32 v14, s3, v14
    v_max_u32 v14, 1, v14
    v_lshlrev_b32 v14, 1, v14
    v_and_b32 v15, 1, v7
    v_add_lshl_u32 v14, v14, v15, 7
    v_lshrrev_b32 v15, 1, v7
    v_lshl_add_u32 v15, v15, 2, v8
    v_lshl_add_u32 v14, v15, 2, v14
    v_add_u32 v77, 6291200, v14
    s_min_u32 s15, s48, 2
    s_lshl_b32 s15, s15, 6
    s_add_u32 s15, s15, 64
    s_lshl_b32 s82, s49, 5
    s_add_u32 s82, s82, s50
    s_lshl_b32 s82, s82, 10
    s_add_u32 s82, s82, 4194304
    s_lshr_b32 s69, s49, 2
    s_lshl_b32 s69, s69, 1
    s_and_b32 s3, s50, 1
    s_add_u32 s69, s69, s3
    s_lshl_b32 s69, s69, 7
    s_add_u32 s69, s69, 6361088
    s_and_b32 s7, s53, 1
    s_mul_i32 s3, s7, 28
    s_add_u32 s3, s3, s48
    s_lshl_b32 s3, s3, 17
    s_xor_b32 s6, s53, 1
    s_lshl_b32 s55, s6, 3
    s_lshl_b32 s6, s53, 7
    s_add_u32 s3, s3, s6
    v_lshlrev_b32 v14, 12, v5
    v_add3_u32 v59, v14, v83, s3
    v_add_u32 v60, 31744, v59
    v_add_u32 v61, 63488, v59
    v_add_u32 v62, 95232, v59
    v_mul_u32_u24 v14, 896, v5
    s_mul_i32 s3, s4, 25088
    s_mul_i32 s6, s5, 14336
    s_add_u32 s3, s3, s6
    s_lshl_b32 s6, s54, 7
    s_add_u32 s3, s3, s6
    v_add3_u32 v63, v14, v83, s3
    v_add_u32 v64, 6144, v63
    s_lshl_b32 s6, s53, 1
    s_add_u32 s6, s6, s5
    s_and_b32 s3, s53, 30
    s_add_u32 s3, s3, s4
    s_lshl_b32 s3, s3, 7
    s_add_u32 s39, s3, 6361088
    s_lshl_b32 s3, s6, 5
    s_add_u32 s3, s3, s4
    s_lshl_b32 s3, s3, 10
    s_add_u32 s3, s3, 4194304
    v_add_u32 v65, s3, v4
    v_add_u32 v66, 15360, v65
    s_xor_b32 s3, s4, s5
    s_lshl_b32 s3, s3, 6
    v_xor_b32 v43, s3, v31
    v_xor_b32 v44, 32, v43
    v_add_u32 v45, 65536, v43
    v_add_u32 v46, 65536, v44
    s_mul_i32 s3, s4, 12288
    v_add_u32 v47, s3, v4
    v_xor_b32 v48, 4096, v47
    v_add_u32 v49, 65536, v47
    v_add_u32 v50, 65536, v48
    v_add_u32 v51, 131072, v47
    v_add_u32 v52, 131072, v48
    s_lshl_b32 s6, s54, 1
    s_add_u32 s6, s6, s5
    s_lshl_b32 s3, s6, 1
    s_add_u32 s3, s3, s7
    s_mul_i32 s3, s3, 14
    s_add_u32 s3, s3, s4
    s_lshl_b32 s3, s3, 12
    s_add_u32 s3, s3, 2097152
    v_add_u32 v79, s3, v4
    s_lshl_b32 s3, s54, 1
    s_add_u32 s3, s3, s7
    s_lshl_b32 s3, s3, 1
    s_add_u32 s3, s3, s4
    s_lshl_b32 s3, s3, 7
    s_add_u32 s38, s3, 6356992
    s_and_b32 s3, s2, 6
    s_add_u32 s3, s3, s54
    s_sub_u32 s6, s3, 7
    s_cmp_ge_u32 s3, 7
    s_cselect_b32 s3, s6, s3
    s_lshl_b32 s64, s3, 19
    s_lshl_b32 s65, s3, 13
    s_add_u32 s55, s55, s54
    s_lshl_b32 s3, s55, 14
    s_add_u32 s3, s3, s58
    s_add_u32 s3, s3, 12582912
    v_add_u32 v21, s3, v4
    s_lshl_b32 s55, s55, 5
    s_add_u32 s55, s55, s48
    s_lshl_b32 s55, s55, 2
    s_add_u32 s55, s55, 6488064
    s_lshl_b32 s3, s5, 3
    v_add_u32 v13, s3, v3
    v_xor_b32 v13, v13, v6
    v_lshlrev_b32 v13, 4, v13
    v_lshl_add_u32 v13, v2, 8, v13
    s_lshl_b32 s3, s4, 14
    s_add_u32 s3, s3, 131072
    v_add_u32 v87, s3, v13
    v_xor_b32 v88, 64, v87
    s_lshr_b32 s3, s53, 1
    s_add_u32 s66, s3, s54
    v_lshlrev_b32 v13, 1, v6
    v_xor_b32 v13, v13, v5
    v_lshlrev_b32 v13, 4, v13
    v_lshl_add_u32 v13, v5, 8, v13
    s_add_u32 s3, s58, 131072
    v_add_u32 v89, s3, v13
    v_xor_b32 v90, 16, v89
    v_xor_b32 v91, 24576, v89
    v_xor_b32 v92, 24592, v89
    s_mov_b32 s70, 0xaaaaaaaa
    s_mov_b32 s71, 0xaaaaaaaa
    s_mov_b32 s72, 0xfff0ffff
    s_mov_b32 s73, 0xf000ff00
    s_mov_b32 s74, 0xffc0fffc
    s_mov_b32 s75, 0xc000fc00
    s_cmp_eq_u32 s49, 0
    s_cselect_b64 s[76:77], 0, -1
    v_mov_b32 v13, 0xffff
    v_mov_b32 v14, 0xffff0000
    v_cndmask_b32 v13, v13, v14, s[70:71]
    v_cndmask_b32 v104, v13, 0, s[72:73]
    v_cndmask_b32 v106, 0, v13, s[72:73]
    v_cndmask_b32 v105, v13, 0, s[74:75]
    v_cndmask_b32 v107, 0, v13, s[74:75]
    v_mov_b32 v84, 0xf149f2ca
    s_mov_b32 s83, 0x3e8b97f6
    s_mov_b32 s78, 0xbdd2d3e8
    s_mov_b32 s79, 0xbdd2d3e8
    s_mov_b32 s80, 1.0
    s_mov_b32 s81, 1.0
    v_mov_b32 v108, 0xc0135761
    v_mov_b32 v109, 0xc0135761
    v_lshrrev_b32 v13, 1, v2
    v_lshlrev_b32 v14, 1, v3
    v_sub_u32 v13, v13, v14
    v_mov_b32 v14, 0x3f80
    v_cndmask_b32 v14, v14, 1.0, s[70:71]
    v_cmp_eq_i32 vcc, 0, v13
    v_accvgpr_write_b32 a248, 0
    v_accvgpr_write_b32 a252, 0
    v_cndmask_b32 v15, 0, v14, vcc
    v_accvgpr_write_b32 a250, v15
    v_cmp_eq_i32 vcc, 1, v13
    v_accvgpr_write_b32 a249, 0
    v_accvgpr_write_b32 a253, 0
    v_cndmask_b32 v15, 0, v14, vcc
    v_accvgpr_write_b32 a251, v15
    s_waitcnt vmcnt(3)
    s_barrier
    s_cmp_lg_u32 s37, 0
    s_cbranch_scc1 L_nowsig
    s_atomic_add s36, s[44:45], s67
L_nowsig:
    buffer_load_dword v18, v20, s[28:31], 0 offen sc1
    s_cmp_eq_u32 s56, 0
    s_cselect_b32 s26, 0, s26
    v_and_b32 v13, 0xfffff000, v78
    v_lshl_add_u32 v13, v10, 7, v13
    s_add_u32 s3, s1, 8192
    v_lshl_add_u32 v14, v9, 13, s3
    s_waitcnt vmcnt(0)
    v_cmp_ne_u32 vcc, s57, v18
    s_cbranch_vccnz L_pollin3
L_pollok3:
    s_barrier
    buffer_load_dword v76, v77, s[28:31], 0 offen sc1
    s_mov_b32 s26, 7340032
    s_and_b32 s3, s2, 1
    s_mul_i32 s3, s3, 7
    s_add_u32 s3, s3, s52
    s_lshl_b32 s3, s3, 2
    s_add_u32 s3, s3, s48
    s_lshl_b32 s3, s3, 17
    s_and_b32 s6, s2, 6
    s_lshl_b32 s6, s6, 9
    s_add_u32 s3, s3, s6
    v_lshlrev_b32 v13, 12, v10
    v_lshl_add_u32 v13, v9, 9, v13
    buffer_load_dword v232, v13, s[24:27], s3 offen offset:384
    buffer_load_dword v233, v13, s[24:27], s3 offen offset:256
    s_cmp_eq_u32 s56, 0
    s_cselect_b32 s26, 0, s26
    v_lshlrev_b32 v13, 2, v2
    v_and_b32 v14, 1, v1
    v_lshl_add_u32 v14, v3, 2, v14
    v_lshlrev_b32 v14, 2, v14
    v_add_u32 v15, 64, v14
    v_cndmask_b32 v16, v14, v15, s[72:73]
    v_cndmask_b32 v14, v14, v15, s[74:75]
    s_waitcnt vmcnt(2)
    ds_bpermute_b32 v25, v13, v76 offset:64
    ds_bpermute_b32 v27, v16, v76 offset:0
    ds_bpermute_b32 v28, v14, v76 offset:8
    ds_bpermute_b32 v26, v13, v76 offset:128
    ds_bpermute_b32 v29, v16, v76 offset:64
    ds_bpermute_b32 v30, v14, v76 offset:72
    s_waitcnt lgkmcnt(5)
    v_mul_f32 v25, s83, v25
    ds_read_b32 v24, v4
    s_waitcnt lgkmcnt(3)
    v_mul_f32 v26, s83, v26
    s_load_dword s14, s[44:45], s15
    s_waitcnt lgkmcnt(0)
    s_cmp_ge_u32 s14, 14
    s_cbranch_scc0 L_pollin4
L_pollok4:
    s_barrier
    s_cmp_eq_u32 s56, 0
    s_cselect_b32 s3, 268435456, 0
    v_add_u32 v79, s3, v79
    s_add_u32 m0, s59, 98304
    s_nop 0
    buffer_load_dwordx4 v80, s[28:31], s63 offen sc1 lds
    buffer_load_dwordx4 v80, s[28:31], s63 offen offset:1024 sc1 lds
    buffer_load_dwordx4 v80, s[28:31], s63 offen offset:2048 sc1 lds
    s_add_u32 m0, s100, 126976
    s_nop 0
    buffer_load_dwordx4 v69, s[28:31], s62 offen sc1 lds
    s_add_u32 m0, s58, 110592
    s_nop 0
    buffer_load_dwordx4 v67, s[28:31], s62 offen sc1 lds
    buffer_load_dwordx4 v67, s[28:31], s62 offen offset:1024 sc1 lds
    buffer_load_dwordx4 v68, s[28:31], s62 offen offset:2048 sc1 lds
    buffer_load_dwordx4 v68, s[28:31], s62 offen offset:3072 sc1 lds
    s_add_u32 m0, s59, 131072
    s_add_u32 s63, s63, 12288
    s_cmp_eq_u32 s63, 86016
    s_cselect_b32 s63, 0, s63
    buffer_load_dwordx4 v80, s[28:31], s63 offen sc1 lds
    buffer_load_dwordx4 v80, s[28:31], s63 offen offset:1024 sc1 lds
    buffer_load_dwordx4 v80, s[28:31], s63 offen offset:2048 sc1 lds
    s_add_u32 m0, s100, 159744
    s_add_u32 s62, s62, 262144
    s_cmp_eq_u32 s62, 1835008
    s_cselect_b32 s62, 0, s62
    buffer_load_dwordx4 v69, s[28:31], s62 offen sc1 lds
    s_add_u32 m0, s58, 143360
    s_nop 0
    buffer_load_dwordx4 v67, s[28:31], s62 offen sc1 lds
    buffer_load_dwordx4 v67, s[28:31], s62 offen offset:1024 sc1 lds
    buffer_load_dwordx4 v68, s[28:31], s62 offen offset:2048 sc1 lds
    buffer_load_dwordx4 v68, s[28:31], s62 offen offset:3072 sc1 lds
    s_add_u32 m0, s59, 0
    s_add_u32 s63, s63, 12288
    s_cmp_eq_u32 s63, 86016
    s_cselect_b32 s63, 0, s63
    buffer_load_dwordx4 v80, s[28:31], s63 offen sc1 lds
    buffer_load_dwordx4 v80, s[28:31], s63 offen offset:1024 sc1 lds
    buffer_load_dwordx4 v80, s[28:31], s63 offen offset:2048 sc1 lds
    s_add_u32 m0, s100, 28672
    s_add_u32 s62, s62, 262144
    s_cmp_eq_u32 s62, 1835008
    s_cselect_b32 s62, 0, s62
    buffer_load_dwordx4 v69, s[28:31], s62 offen sc1 lds
    s_add_u32 m0, s58, 12288
    s_nop 0
    buffer_load_dwordx4 v67, s[28:31], s62 offen sc1 lds
    buffer_load_dwordx4 v67, s[28:31], s62 offen offset:1024 sc1 lds
    buffer_load_dwordx4 v68, s[28:31], s62 offen offset:2048 sc1 lds
    buffer_load_dwordx4 v68, s[28:31], s62 offen offset:3072 sc1 lds
    s_add_u32 m0, s59, 65536
    s_add_u32 s63, s63, 12288
    s_cmp_eq_u32 s63, 86016
    s_cselect_b32 s63, 0, s63
    buffer_load_dwordx4 v80, s[28:31], s63 offen sc1 lds
    buffer_load_dwordx4 v80, s[28:31], s63 offen offset:1024 sc1 lds
    buffer_load_dwordx4 v80, s[28:31], s63 offen offset:2048 sc1 lds
    s_add_u32 m0, s100, 94208
    s_add_u32 s62, s62, 262144
    s_cmp_eq_u32 s62, 1835008
    s_cselect_b32 s62, 0, s62
    buffer_load_dwordx4 v69, s[28:31], s62 offen sc1 lds
    s_add_u32 m0, s58, 77824
    s_nop 0
    buffer_load_dwordx4 v67, s[28:31], s62 offen sc1 lds
    buffer_load_dwordx4 v67, s[28:31], s62 offen offset:1024 sc1 lds
    buffer_load_dwordx4 v68, s[28:31], s62 offen offset:2048 sc1 lds
    buffer_load_dwordx4 v68, s[28:31], s62 offen offset:3072 sc1 lds
    s_mov_b32 s3, 268435456
    buffer_store_dword v12, v11, s[28:31], s3 offen
    buffer_store_dword v12, v11, s[28:31], s3 offen
    s_waitcnt vmcnt(18)
    s_barrier
    ds_read_b64_tr_b16 a[180:181], v72 offset:32768
    ds_read_b64_tr_b16 a[182:183], v72 offset:33024
    ds_read_b128 a[128:131], v53 offset:32768
    ds_read_b64_tr_b16 a[184:185], v72 offset:33792
    ds_read_b64_tr_b16 a[186:187], v72 offset:34048
    ds_read_b128 a[132:135], v53 offset:33792
    ds_read_b128 a[136:139], v53 offset:34816
    ds_read_b64_tr_b16 a[176:177], v73 offset:32768
    ds_read_b64_tr_b16 a[178:179], v73 offset:33024
    ds_read_b128 a[140:143], v53 offset:35840
    ds_read_b128 a[144:147], v53 offset:36864
    ds_read_b128 a[148:151], v53 offset:37888
    s_waitcnt lgkmcnt(0)
    s_nop 3
    s_branch L_q
L_pollin5:
    s_cmp_eq_u32 s56, 0
    s_cbranch_scc1 L_pollok5
    s_mov_b32 s60, 0
L_poll5:
    s_sleep 8
    buffer_load_dword v18, off, s[28:31], s38 sc1
    s_add_u32 s60, s60, 1
    s_waitcnt vmcnt(0)
    v_readfirstlane_b32 s14, v18
    s_nop 0
    s_cmp_ge_u32 s14, 7
    s_cbranch_scc1 L_pollok5
    s_cmp_lt_u32 s60, 20000
    s_cbranch_scc1 L_poll5
    s_branch L_pollok5
L_nof:
    s_waitcnt vmcnt(0)
    s_barrier
    s_cmp_lg_u32 s48, 0
    s_cbranch_scc1 L_sig3
    s_atomic_add s36, s[28:29], s69
L_sig3:
    v_lshlrev_b32 v14, 7, v1
    s_lshl_b32 s3, s54, 2
    s_add_u32 s3, s3, s48
    s_mul_i32 s3, s3, 25088
    buffer_load_dword v182, v14, s[16:19], s3 offen
    s_add_u32 s3, s3, 5632
    buffer_load_dword v183, v14, s[16:19], s3 offen
    s_add_u32 s3, s3, 5632
    buffer_load_dword v184, v14, s[16:19], s3 offen
    s_add_u32 s3, s3, 5632
    buffer_load_dword v185, v14, s[16:19], s3 offen
    s_add_u32 s3, s3, 5632
    s_branch L_fin
L_pollin6:
    s_mov_b32 s60, 0
L_poll6:
    s_sleep 8
    buffer_load_dword v18, off, s[28:31], s39 sc1
    s_add_u32 s60, s60, 1
    s_waitcnt vmcnt(0)
    v_readfirstlane_b32 s14, v18
    s_nop 0
    s_cmp_ge_u32 s14, 8
    s_cbranch_scc1 L_pollok6
    s_cmp_lt_u32 s60, 20000
    s_cbranch_scc1 L_poll6
    s_branch L_pollok6
L_pollin7:
    s_mov_b32 s60, 0
L_poll7:
    s_sleep 4
    buffer_load_dword v18, off, s[28:31], s55 sc1
    s_add_u32 s60, s60, 1
    s_waitcnt vmcnt(0)
    v_readfirstlane_b32 s14, v18
    s_nop 0
    s_cmp_ge_u32 s14, 1
    s_cbranch_scc1 L_pollok7
    s_cmp_lt_u32 s60, 20000
    s_cbranch_scc1 L_poll7
    s_branch L_pollok7
L_last:
    s_endpgm
.section .rodata,"a"
.p2align 6
.amdhsa_kernel parallel_sum__sliding_local_dilated__mixer_token_mlp__prompt_kernel
  .amdhsa_next_free_vgpr 512
  .amdhsa_next_free_sgpr 102
  .amdhsa_accum_offset 256
  .amdhsa_group_segment_fixed_size 0
  .amdhsa_kernarg_size 88
  .amdhsa_user_sgpr_count 2
  .amdhsa_user_sgpr_kernarg_segment_ptr 1
  .amdhsa_system_sgpr_workgroup_id_x 1
.end_amdhsa_kernel
```

```asm
; @launch grid=(256,1,1) block=(256,1,1) lds=163840
.amdgcn_target "amdgcn-amd-amdhsa--gfx950"
.text
.globl parallel_sum__sliding_local_dilated__mixer_token_mlp__prompt_kernel
.p2align 8
.type parallel_sum__sliding_local_dilated__mixer_token_mlp__prompt_kernel,@function
parallel_sum__sliding_local_dilated__mixer_token_mlp__prompt_kernel:
    s_cmp_ge_u32 s2, 256
    s_cbranch_scc1 L_end
    s_load_dwordx2 s[8:9], s[0:1], 0
    s_load_dwordx2 s[20:21], s[0:1], 32
    s_load_dwordx2 s[28:29], s[0:1], 80
    s_load_dwordx2 s[44:45], s[0:1], 72
    s_load_dwordx2 s[12:13], s[0:1], 8
    s_load_dwordx2 s[16:17], s[0:1], 16
    s_load_dwordx2 s[24:25], s[0:1], 48
    s_load_dwordx2 s[32:33], s[0:1], 64
    s_load_dwordx2 s[36:37], s[0:1], 40
    s_load_dwordx2 s[40:41], s[0:1], 56
    s_memrealtime s[78:79]
    s_getpc_b64 s[6:7]
L_pc:
    s_and_b32 s3, s2, 0xf8
    v_lshrrev_b32 v13, 5, v0
    v_add_lshl_u32 v13, s3, v13, 7
    v_min_u32 v13, L_last-L_pc, v13
    global_load_dword v18, v13, s[6:7]
    v_lshrrev_b32 v13, 6, v0
    v_and_b32 v10, 31, v0
    v_readfirstlane_b32 s48, v13
    v_bfe_u32 v9, v0, 5, 1
    v_mul_u32_u24 v14, 896, v9
    v_lshl_add_u32 v14, v10, 4, v14
    v_cmp_gt_u32 vcc, 28, v10
    v_mov_b32 v15, 268435456
    s_mov_b32 s10, 1835008
    s_mov_b32 s11, 0x20000
    v_cndmask_b32 v14, v15, v14, vcc
    s_lshr_b32 s4, s48, 1
    s_and_b32 s5, s48, 1
    s_and_b32 s3, s2, 0xfe
    s_add_u32 s3, s3, s4
    s_lshl_b32 s3, s3, 1
    s_and_b32 s60, s2, 1
    s_add_u32 s3, s3, s60
    s_lshl_b32 s3, s3, 1
    s_add_u32 s3, s3, s5
    s_mul_i32 s3, s3, 1792
    s_waitcnt lgkmcnt(0)
    buffer_load_dwordx4 v[182:185], v14, s[8:11], s3 offen
    buffer_load_dwordx4 v[186:189], v14, s[8:11], s3 offen offset:448
    v_and_b32 v1, 63, v0
    s_mov_b32 s46, 256
    s_mov_b32 s47, 0x20000
    s_lshl_b32 s3, s48, 8
    s_add_u32 s3, s3, s2
    s_cmp_lt_u32 s3, 8
    s_cselect_b32 s3, 0, 268435456
    s_or_b32 s78, s78, 1
    v_mov_b32 v234, s78
    v_mov_b32 v235, 0
    v_lshlrev_b32 v11, 25, v1
    buffer_atomic_cmpswap v[234:235], v11, s[44:47], s3 offen sc1
    s_bfe_u32 s6, s2, 0x20001
    s_and_b32 s7, s2, 1
    s_and_b32 s61, s2, 7
    s_lshr_b32 s101, s2, 3
    s_mul_i32 s52, s7, 25
    s_add_u32 s52, s52, s101
    s_mul_i32 s51, s52, 37
    s_lshr_b32 s51, s51, 8
    s_mul_i32 s3, s51, 7
    s_sub_u32 s52, s52, s3
    s_and_b32 s3, s6, 1
    s_mul_i32 s3, s3, 6
    s_add_u32 s51, s51, s3
    s_add_u32 s51, s51, 1
    s_add_u32 s3, s3, s51
    s_cmp_eq_u32 s3, 7
    s_cselect_b32 s51, 0, s51
    s_lshr_b32 s59, s6, 1
    s_lshl_b32 s51, s51, 1
    s_add_u32 s51, s51, s59
    s_max_u32 s60, s101, 25
    s_sub_u32 s60, s60, 25
    s_add_u32 s3, s101, s7
    s_cmp_lt_u32 s3, 25
    s_cselect_b32 s55, 1, 0
    s_cselect_b32 s52, s52, s60
    s_mov_b32 s22, 7340032
    s_mov_b32 s23, 0x20000
    s_lshl_b32 s3, s52, 1
    s_sub_u32 s60, s3, 7
    s_cmp_ge_u32 s3, 7
    s_cselect_b32 s3, s60, s3
    s_and_b32 s3, s3, 7
    s_mul_i32 s60, s61, 2
    s_add_u32 s3, s3, s60
    s_and_b32 s3, s3, 7
    s_mul_i32 s0, s3, 458752
    s_lshl_b32 s1, s3, 13
    s_lshl_b32 s58, s48, 12
    v_lshrrev_b32 v3, 4, v1
    v_lshrrev_b32 v5, 3, v1
    v_and_b32 v6, 7, v1
    v_lshlrev_b32 v14, 1, v3
    v_xor_b32 v14, v14, v6
    v_lshlrev_b32 v83, 4, v14
    s_cmp_eq_u32 s55, 0
    s_cbranch_scc1 L_nog1
    v_mul_u32_u24 v14, 3584, v5
    s_lshl_b32 s3, s59, 5
    s_add_u32 s3, s3, s48
    s_mul_i32 s3, s3, 114688
    s_lshl_b32 s60, s51, 7
    s_add_u32 s3, s3, s60
    v_add3_u32 v55, v14, v83, s3
    v_add_u32 v56, 56320, v55
    v_add_u32 v57, 26624, v55
    v_add_u32 v58, 82944, v55
    s_mov_b32 s38, 3584
    s_mov_b32 s39, 0x20000
    v_lshlrev_b32 v13, 3, v3
    s_lshl_b32 s3, s51, 1
    s_add_u32 s3, s3, s4
    s_lshl_b32 s3, s3, 6
    buffer_load_dwordx2 v[246:247], v13, s[36:39], s3 offen offset:0
    buffer_load_dwordx2 v[248:249], v13, s[36:39], s3 offen offset:32
    s_add_u32 m0, s58, 0
    v_xor_b32 v55, 128, v55
    buffer_load_dwordx4 v55, s[20:23], s0 offen lds
    v_xor_b32 v56, 128, v56
    buffer_load_dwordx4 v56, s[20:23], s0 offen offset:1024 lds
    v_xor_b32 v57, 128, v57
    buffer_load_dwordx4 v57, s[20:23], s0 offen offset:2048 lds
    v_xor_b32 v58, 128, v58
    buffer_load_dwordx4 v58, s[20:23], s0 offen offset:3072 lds
    s_mul_i32 s53, s101, 37
    s_lshr_b32 s53, s53, 8
    s_mul_i32 s54, s53, 7
    s_sub_u32 s54, s101, s54
    s_and_b32 s53, s53, 3
    s_lshl_b32 s3, s6, 2
    s_add_u32 s53, s53, s3
    s_lshl_b32 s53, s53, 1
    s_add_u32 s53, s53, s7
    s_mov_b32 s42, 4096
    s_mov_b32 s43, 0x20000
    s_lshl_b32 s3, s53, 2
    s_add_u32 s3, s3, s48
    s_lshl_b32 s60, s3, 5
    v_lshl_add_u32 v82, v5, 1, s60
    s_mul_i32 s3, s3, 14336
    s_lshl_b32 s60, s54, 7
    s_add_u32 s3, s3, s60
    v_mul_u32_u24 v14, 896, v5
    v_lshl_add_u32 v14, v6, 4, v14
    v_add_u32 v85, s3, v14
    v_add_u32 v86, 7168, v85
    s_cmp_lt_u32 s101, 28
    s_cselect_b32 s56, 1, 0
    s_lshl_b32 s50, s7, 3
    s_and_b32 s3, s101, 7
    s_add_u32 s50, s50, s3
    s_lshr_b32 s60, s101, 3
    s_lshl_b32 s49, s6, 2
    s_add_u32 s49, s49, s60
    s_lshl_b32 s49, s49, 2
    s_add_u32 s49, s49, s48
    s_mul_i32 s60, s60, 0
    s_add_u32 s3, s3, s60
    s_sub_u32 s60, s3, 7
    s_cmp_ge_u32 s3, 7
    s_cselect_b32 s3, s60, s3
    s_lshl_b32 s62, s3, 18
    s_mul_i32 s63, s3, 12288
    s_mov_b32 s30, 20971520
    s_mov_b32 s31, 0x20000
    s_mov_b32 s75, 0x3727c5ac
    s_mov_b32 s76, 0x3b124925
    s_mov_b32 s77, 0x3f803f80
    v_lshlrev_b32 v4, 4, v1
    v_bfe_u32 v7, v1, 2, 2
    v_and_b32 v8, 3, v1
    v_mul_u32_u24 v13, 960, v9
    v_lshl_add_u32 v13, v10, 4, v13
    s_mul_i32 s3, s48, 1920
    s_add_u32 s3, s3, 147456
    v_add_u32 v230, s3, v13
    v_mul_u32_u24 v13, 960, v7
    v_lshl_add_u32 v13, v3, 5, v13
    v_lshl_add_u32 v13, v8, 3, v13
    s_lshl_b32 s3, s48, 8
    s_add_u32 s3, s3, 147456
    v_add_u32 v231, s3, v13
    s_lshl_b32 s3, s48, 3
    s_add_u32 s3, s3, 155648
    v_lshl_add_u32 v232, v9, 2, s3
    v_lshlrev_b32 v237, 2, v6
    v_and_b32 v2, 15, v1
    v_lshlrev_b32 v238, 14, v3
    v_add_lshl_u32 v238, v238, v2, 2
    v_add_u32 v237, 155648, v237
    v_lshlrev_b32 v13, 17, v9
    v_lshl_add_u32 v233, v10, 4, v13
    s_cmp_eq_u32 s48, 3
    s_cselect_b32 s60, 268435456, 0
    s_lshl_b32 s70, s48, 10
    s_add_u32 s70, s70, s2
    s_lshl_b32 s70, s70, 9
    s_add_u32 s71, s70, 262144
    s_add_u32 s71, s71, s60
    s_xor_b32 s60, s60, 268435456
    s_lshl_b32 s72, s2, 7
    s_add_u32 s72, s72, s60
    s_add_u32 s72, s72, 6291456
    s_lshr_b32 s74, s2, 2
    s_lshl_b32 s74, s74, 5
    s_and_b32 s3, s2, 3
    s_add_u32 s74, s74, s3
    s_lshl_b32 s74, s74, 2
    s_add_u32 s74, s74, 10485760
    v_cmp_gt_u32 vcc, 8, v0
    v_lshlrev_b32 v236, 13, v0
    v_mov_b32 v13, 268435456
    s_and_b32 s3, s2, 7
    s_lshl_b32 s3, s3, 13
    s_add_u32 s3, s3, 10485760
    v_lshrrev_b32 v14, 2, v0
    v_lshl_add_u32 v14, v14, 7, s3
    v_lshl_add_u32 v20, v8, 2, v14
    v_cndmask_b32 v236, v13, v236, vcc
    v_mov_b32 v16, 0
    s_lshl_b32 s3, s48, 14
    s_add_u32 s74, s74, s3
    s_add_u32 s73, s74, 8192
    s_waitcnt vmcnt(8)
    v_dot2_f32_bf16 v226, v182, s77, 0
    v_dot2_f32_bf16 v227, v182, v182, 0
    v_dot2_f32_bf16 v226, v183, s77, v226
    v_dot2_f32_bf16 v227, v183, v183, v227
    v_dot2_f32_bf16 v226, v184, s77, v226
    v_dot2_f32_bf16 v227, v184, v184, v227
    v_dot2_f32_bf16 v226, v185, s77, v226
    v_dot2_f32_bf16 v227, v185, v185, v227
    s_waitcnt vmcnt(7)
    v_dot2_f32_bf16 v226, v186, s77, v226
    v_dot2_f32_bf16 v227, v186, v186, v227
    v_dot2_f32_bf16 v226, v187, s77, v226
    v_dot2_f32_bf16 v227, v187, v187, v227
    v_dot2_f32_bf16 v226, v188, s77, v226
    v_dot2_f32_bf16 v227, v188, v188, v227
    v_dot2_f32_bf16 v226, v189, s77, v226
    v_dot2_f32_bf16 v227, v189, v189, v227
    buffer_load_dword v12, v16, s[44:47], 0 offen sc1
    v_lshlrev_b32 v190, 16, v182
    v_and_b32 v191, 0xffff0000, v182
    v_add_f32_dpp v226, v226, v226 quad_perm:[1,0,3,2] row_mask:0xf bank_mask:0xf
    v_add_f32_dpp v227, v227, v227 quad_perm:[1,0,3,2] row_mask:0xf bank_mask:0xf
    v_lshlrev_b32 v192, 16, v183
    v_add_f32_dpp v226, v226, v226 quad_perm:[2,3,0,1] row_mask:0xf bank_mask:0xf
    v_add_f32_dpp v227, v227, v227 quad_perm:[2,3,0,1] row_mask:0xf bank_mask:0xf
    v_and_b32 v193, 0xffff0000, v183
    v_add_f32_dpp v226, v226, v226 row_half_mirror row_mask:0xf bank_mask:0xf
    v_add_f32_dpp v227, v227, v227 row_half_mirror row_mask:0xf bank_mask:0xf
    v_lshlrev_b32 v194, 16, v184
    v_add_f32_dpp v226, v226, v226 row_mirror row_mask:0xf bank_mask:0xf
    v_add_f32_dpp v227, v227, v227 row_mirror row_mask:0xf bank_mask:0xf
    v_and_b32 v195, 0xffff0000, v184
    v_mov_b32 v228, v226
    v_mov_b32 v229, v227
    v_lshlrev_b32 v196, 16, v185
    v_permlane16_swap_b32 v226, v228
    v_permlane16_swap_b32 v227, v229
    v_add_f32 v226, v226, v228
    v_add_f32 v227, v227, v229
    v_mul_f32_e64 v226, -v226, s76
    v_mul_f32 v228, v226, v226
    v_fma_f32 v227, v227, s76, -v228
    v_max_f32 v227, 0, v227
    v_add_f32 v228, s75, v227
    v_rsq_f32 v222, v228
    v_and_b32 v197, 0xffff0000, v185
    v_mul_f32 v228, v222, v222
    v_fma_f32 v229, v228, v227, s75
    v_rsq_f32 v228, v229
    v_mul_f32 v223, v226, v222
    v_mul_f32 v224, v222, v228
    v_mul_f32 v225, v223, v228
    v_mul_f32 v229, v229, v228
    ds_write_b32 v232, v229
    v_lshlrev_b32 v198, 16, v186
    v_and_b32 v199, 0xffff0000, v186
    v_lshlrev_b32 v200, 16, v187
    v_and_b32 v201, 0xffff0000, v187
    v_lshlrev_b32 v202, 16, v188
    v_and_b32 v203, 0xffff0000, v188
    v_lshlrev_b32 v204, 16, v189
    v_and_b32 v205, 0xffff0000, v189
    v_pk_fma_f32 v[206:207], v[190:191], v[224:225], v[224:225] op_sel:[0,0,1] op_sel_hi:[1,0,1]
    v_pk_fma_f32 v[208:209], v[192:193], v[224:225], v[224:225] op_sel:[0,0,1] op_sel_hi:[1,0,1]
    v_pk_fma_f32 v[210:211], v[194:195], v[224:225], v[224:225] op_sel:[0,0,1] op_sel_hi:[1,0,1]
    v_pk_fma_f32 v[212:213], v[196:197], v[224:225], v[224:225] op_sel:[0,0,1] op_sel_hi:[1,0,1]
    v_cvt_pk_bf16_f32 v182, v206, v207
    v_cvt_pk_bf16_f32 v183, v208, v209
    v_cvt_pk_bf16_f32 v184, v210, v211
    v_cvt_pk_bf16_f32 v185, v212, v213
    ds_write_b128 v230, v[182:185] offset:0
    v_pk_fma_f32 v[214:215], v[198:199], v[224:225], v[224:225] op_sel:[0,0,1] op_sel_hi:[1,0,1]
    v_pk_fma_f32 v[216:217], v[200:201], v[224:225], v[224:225] op_sel:[0,0,1] op_sel_hi:[1,0,1]
    v_pk_fma_f32 v[218:219], v[202:203], v[224:225], v[224:225] op_sel:[0,0,1] op_sel_hi:[1,0,1]
    v_pk_fma_f32 v[220:221], v[204:205], v[224:225], v[224:225] op_sel:[0,0,1] op_sel_hi:[1,0,1]
    v_cvt_pk_bf16_f32 v186, v214, v215
    v_cvt_pk_bf16_f32 v187, v216, v217
    v_cvt_pk_bf16_f32 v188, v218, v219
    v_cvt_pk_bf16_f32 v189, v220, v221
    ds_write_b128 v230, v[186:189] offset:448
    s_waitcnt lgkmcnt(0)
    s_barrier
    ds_read_b64_tr_b16 v[110:111], v231 offset:0
    ds_read_b64_tr_b16 v[112:113], v231 offset:3840
    ds_read_b64_tr_b16 v[114:115], v231 offset:128
    ds_read_b64_tr_b16 v[116:117], v231 offset:3968
    ds_read_b32 v229, v237
    s_waitcnt lgkmcnt(3)
    buffer_store_dwordx4 v[110:113], v233, s[28:31], s70 offen sc1
    s_waitcnt lgkmcnt(1)
    buffer_store_dwordx4 v[114:117], v233, s[28:31], s71 offen sc1
    v_cmp_gt_u32 vcc, 16, v1
    s_waitcnt lgkmcnt(0)
    s_nop 0
    v_cndmask_b32 v229, 0, v229, vcc
    buffer_store_dword v229, v238, s[28:31], s72 offen sc1
    s_add_u32 m0, s58, 16384
    s_add_u32 s0, s0, 458752
    s_cmp_eq_u32 s0, 3670016
    s_cselect_b32 s0, 0, s0
    buffer_load_dwordx4 v55, s[20:23], s0 offen lds
    buffer_load_dwordx4 v56, s[20:23], s0 offen offset:1024 lds
    buffer_load_dwordx4 v57, s[20:23], s0 offen offset:2048 lds
    buffer_load_dwordx4 v58, s[20:23], s0 offen offset:3072 lds
    s_branch L_anchor
.p2align 12
L_anchor:
    s_mov_b32 s18, 401408
    s_mov_b32 s19, 0x20000
    s_mov_b32 s26, 7340032
    s_mov_b32 s27, 0x20000
    s_mov_b32 s34, 1835008
    s_mov_b32 s35, 0x20000
    s_mov_b32 s36, 1
    v_lshrrev_b32 v14, 2, v1
    v_lshlrev_b32 v14, 7, v14
    v_lshl_add_u32 v14, v8, 3, v14
    v_and_b32 v15, 3, v5
    v_lshl_add_u32 v14, v15, 5, v14
    s_mul_i32 s3, s4, 8256
    v_xor_b32 v31, s3, v14
    v_xor_b32 v32, 32, v31
    v_xor_b32 v33, 64, v31
    v_xor_b32 v34, 96, v31
    v_add_u32 v35, 65536, v31
    v_add_u32 v36, 65536, v32
    v_add_u32 v37, 65536, v33
    v_add_u32 v38, 65536, v34
    v_add_u32 v39, 131072, v31
    v_add_u32 v40, 131072, v32
    v_add_u32 v41, 131072, v33
    v_add_u32 v42, 131072, v34
    s_lshl_b32 s6, s52, 1
    s_add_u32 s6, s6, s5
    s_lshl_b32 s3, s6, 1
    s_add_u32 s3, s3, s59
    s_lshl_b32 s3, s3, 4
    s_add_u32 s3, s3, s4
    s_lshl_b32 s3, s3, 12
    v_lshl_add_u32 v78, v3, 8, v4
    v_add_u32 v78, s3, v78
    s_xor_b32 s37, s51, 1
    s_lshl_b32 s37, s37, 3
    s_add_u32 s37, s37, s52
    s_lshl_b32 s3, s37, 14
    s_add_u32 s3, s3, s58
    s_add_u32 s3, s3, 16777216
    v_add_u32 v23, s3, v4
    s_lshl_b32 s37, s37, 5
    s_add_u32 s37, s37, s5
    s_lshl_b32 s37, s37, 2
    s_add_u32 s37, s37, 6422528
    s_mul_i32 s67, s6, 56
    s_lshl_b32 s3, s51, 1
    s_add_u32 s3, s3, s4
    s_add_u32 s67, s67, s3
    s_lshl_b32 s67, s67, 11
    s_add_u32 s67, s67, 2097152
    v_add_u32 v81, s58, v4
    s_lshl_b32 s68, s52, 2
    s_and_b32 s3, s51, 1
    s_add_u32 s68, s68, s3
    s_cmp_ge_u32 s51, 14
    s_cselect_b32 s3, 2, 0
    s_add_u32 s68, s68, s3
    s_lshl_b32 s68, s68, 7
    s_add_u32 s68, s68, 6356992
    s_waitcnt vmcnt(7)
    v_readfirstlane_b32 s57, v12
    s_mov_b32 s60, 0
    s_cmp_lg_u32 s57, 0
    s_cbranch_scc0 L_nonce
L_nonce_ok:
    s_waitcnt vmcnt(4)
    s_barrier
    s_atomic_swap s57, s[28:29], s74
    s_atomic_swap s57, s[28:29], s73
    buffer_load_dwordx4 v[96:99], v85, s[8:11], 0 offen
    buffer_load_ushort v93, v82, s[40:43], 0 offen offset:0
    buffer_load_dwordx4 v[100:103], v86, s[8:11], 0 offen
    buffer_load_ushort v94, v82, s[40:43], 0 offen offset:16
    v_add_u32 v53, 65536, v4
    s_add_u32 m0, s58, 32768
    s_add_u32 s0, s0, 458752
    s_cmp_eq_u32 s0, 3670016
    s_cselect_b32 s0, 0, s0
    buffer_load_dwordx4 v55, s[20:23], s0 offen lds
    v_add_u32 v54, 131072, v4
    s_mul_i32 s59, s48, 3072
    s_mul_i32 s3, s50, 86016
    s_add_u32 s3, s3, s59
    s_add_u32 s3, s3, 8388608
    v_add_u32 v80, s3, v4
    v_lshlrev_b32 v14, 7, v9
    v_xor_b32 v14, v14, v4
    s_lshl_b32 s3, s49, 11
    v_add_u32 v67, s3, v14
    v_add_u32 v68, 129024, v67
    s_lshr_b32 s3, s49, 2
    s_lshl_b32 s3, s3, 3
    s_max_u32 s3, s3, 1
    s_sub_u32 s3, s3, 1
    s_lshl_b32 s3, s3, 10
    s_lshl_b32 s6, s5, 17
    s_add_u32 s3, s3, s6
    s_lshl_b32 s6, s4, 28
    s_add_u32 s3, s3, s6
    v_add_u32 v69, s3, v14
    buffer_load_dwordx4 v56, s[20:23], s0 offen offset:1024 lds
    s_lshl_b32 s100, s5, 1
    s_add_u32 s100, s100, s4
    s_lshl_b32 s100, s100, 10
    v_and_b32 v14, 1, v1
    v_mul_u32_u24 v14, 640, v14
    v_lshrrev_b32 v15, 2, v1
    v_lshlrev_b32 v15, 4, v15
    v_xor_b32 v14, v14, v15
    v_bfe_u32 v15, v1, 1, 1
    v_lshl_add_u32 v14, v15, 3, v14
    buffer_load_dwordx4 v57, s[20:23], s0 offen offset:2048 lds
    s_add_u32 s3, s58, 12288
    v_add_u32 v70, s3, v14
    s_sub_u32 s3, s3, 3072
    s_cmp_eq_u32 s48, 0
    s_cselect_b32 s3, 28672, s3
    v_add_u32 v71, s3, v14
    v_add_u32 v72, 65536, v70
    v_add_u32 v73, 65536, v71
    v_add_u32 v74, 131072, v70
    v_add_u32 v75, 131072, v71
    s_lshl_b32 s3, s49, 1
    v_min_u32 v14, 2, v3
    v_add_u32 v14, s3, v14
    v_max_u32 v14, 1, v14
    v_lshlrev_b32 v14, 1, v14
    v_and_b32 v15, 1, v7
    buffer_load_dwordx4 v58, s[20:23], s0 offen offset:3072 lds
    v_add_lshl_u32 v14, v14, v15, 7
    v_lshrrev_b32 v15, 1, v7
    v_lshl_add_u32 v15, v15, 2, v8
    v_lshl_add_u32 v14, v15, 2, v14
    v_add_u32 v77, 6291200, v14
    s_min_u32 s15, s48, 2
    s_lshl_b32 s15, s15, 6
    s_add_u32 s15, s15, 64
    s_lshl_b32 s82, s49, 5
    s_add_u32 s82, s82, s50
    s_lshl_b32 s82, s82, 10
    s_add_u32 s82, s82, 4194304
    s_lshr_b32 s69, s49, 2
    s_lshl_b32 s69, s69, 1
    s_and_b32 s3, s50, 1
    s_add_u32 s69, s69, s3
    s_lshl_b32 s69, s69, 7
    s_add_u32 s69, s69, 6361088
    s_and_b32 s7, s53, 1
    s_mul_i32 s3, s7, 28
    s_add_u32 s3, s3, s48
    s_lshl_b32 s3, s3, 17
    s_xor_b32 s6, s53, 1
    s_lshl_b32 s55, s6, 3
    s_lshl_b32 s6, s53, 7
    s_add_u32 s3, s3, s6
    v_lshlrev_b32 v14, 12, v5
    s_add_u32 m0, s58, 49152
    s_add_u32 s0, s0, 458752
    s_cmp_eq_u32 s0, 3670016
    s_cselect_b32 s0, 0, s0
    buffer_load_dwordx4 v55, s[20:23], s0 offen lds
    v_add3_u32 v59, v14, v83, s3
    v_add_u32 v60, 31744, v59
    v_add_u32 v61, 63488, v59
    v_add_u32 v62, 95232, v59
    v_mul_u32_u24 v14, 896, v5
    s_mul_i32 s3, s4, 25088
    s_mul_i32 s6, s5, 14336
    s_add_u32 s3, s3, s6
    s_lshl_b32 s6, s54, 7
    s_add_u32 s3, s3, s6
    v_add3_u32 v63, v14, v83, s3
    buffer_load_dwordx4 v56, s[20:23], s0 offen offset:1024 lds
    v_add_u32 v64, 6144, v63
    s_lshl_b32 s6, s53, 1
    s_add_u32 s6, s6, s5
    s_and_b32 s3, s53, 30
    s_add_u32 s3, s3, s4
    s_lshl_b32 s3, s3, 7
    s_add_u32 s39, s3, 6361088
    s_lshl_b32 s3, s6, 5
    s_add_u32 s3, s3, s4
    s_lshl_b32 s3, s3, 10
    s_add_u32 s3, s3, 4194304
    v_add_u32 v65, s3, v4
    v_add_u32 v66, 15360, v65
    s_xor_b32 s3, s4, s5
    s_lshl_b32 s3, s3, 6
    v_xor_b32 v43, s3, v31
    buffer_load_dwordx4 v57, s[20:23], s0 offen offset:2048 lds
    v_xor_b32 v44, 32, v43
    v_add_u32 v45, 65536, v43
    v_add_u32 v46, 65536, v44
    s_mul_i32 s3, s4, 12288
    v_add_u32 v47, s3, v4
    v_xor_b32 v48, 4096, v47
    v_add_u32 v49, 65536, v47
    v_add_u32 v50, 65536, v48
    v_add_u32 v51, 131072, v47
    v_add_u32 v52, 131072, v48
    s_lshl_b32 s6, s54, 1
    s_add_u32 s6, s6, s5
    s_lshl_b32 s3, s6, 1
    s_add_u32 s3, s3, s7
    s_mul_i32 s3, s3, 14
    s_add_u32 s3, s3, s4
    s_lshl_b32 s3, s3, 12
    s_add_u32 s3, s3, 2097152
    v_add_u32 v79, s3, v4
    buffer_load_dwordx4 v58, s[20:23], s0 offen offset:3072 lds
    s_lshl_b32 s3, s54, 1
    s_add_u32 s3, s3, s7
    s_lshl_b32 s3, s3, 1
    s_add_u32 s3, s3, s4
    s_lshl_b32 s3, s3, 7
    s_add_u32 s38, s3, 6356992
    s_and_b32 s3, s2, 6
    s_add_u32 s3, s3, s54
    s_sub_u32 s6, s3, 7
    s_cmp_ge_u32 s3, 7
    s_cselect_b32 s3, s6, s3
    s_lshl_b32 s64, s3, 19
    s_lshl_b32 s65, s3, 13
    s_add_u32 s55, s55, s54
    s_lshl_b32 s3, s55, 14
    s_add_u32 s3, s3, s58
    s_add_u32 s3, s3, 12582912
    v_add_u32 v21, s3, v4
    s_add_u32 m0, s58, 65536
    s_add_u32 s0, s0, 458752
    s_cmp_eq_u32 s0, 3670016
    s_cselect_b32 s0, 0, s0
    buffer_load_dwordx4 v55, s[20:23], s0 offen lds
    s_lshl_b32 s55, s55, 5
    s_add_u32 s55, s55, s48
    s_lshl_b32 s55, s55, 2
    s_add_u32 s55, s55, 6488064
    s_lshl_b32 s3, s5, 3
    v_add_u32 v13, s3, v3
    v_xor_b32 v13, v13, v6
    v_lshlrev_b32 v13, 4, v13
    v_lshl_add_u32 v13, v2, 8, v13
    buffer_load_dwordx4 v56, s[20:23], s0 offen offset:1024 lds
    s_lshl_b32 s3, s4, 14
    s_add_u32 s3, s3, 32768
    v_add_u32 v87, s3, v13
    v_xor_b32 v88, 64, v87
    s_lshr_b32 s3, s53, 1
    s_add_u32 s66, s3, s54
    s_mov_b32 s51, s66
    v_lshlrev_b32 v13, 1, v6
    v_xor_b32 v13, v13, v5
    v_lshlrev_b32 v13, 4, v13
    v_lshl_add_u32 v13, v5, 8, v13
    s_add_u32 s3, s58, 32768
    v_add_u32 v89, s3, v13
    v_xor_b32 v90, 16, v89
    v_xor_b32 v91, 24576, v89
    v_xor_b32 v92, 24592, v89
    buffer_load_dwordx4 v57, s[20:23], s0 offen offset:2048 lds
    v_lshlrev_b32 v150, 16, v246
    v_and_b32 v151, 0xffff0000, v246
    v_lshlrev_b32 v152, 16, v247
    v_and_b32 v153, 0xffff0000, v247
    v_lshlrev_b32 v154, 16, v248
    v_and_b32 v155, 0xffff0000, v248
    v_lshlrev_b32 v156, 16, v249
    v_and_b32 v157, 0xffff0000, v249
    v_lshlrev_b32 v158, 16, v246
    v_and_b32 v159, 0xffff0000, v246
    v_lshlrev_b32 v160, 16, v247
    v_and_b32 v161, 0xffff0000, v247
    v_lshlrev_b32 v162, 16, v248
    v_and_b32 v163, 0xffff0000, v248
    v_lshlrev_b32 v164, 16, v249
    v_and_b32 v165, 0xffff0000, v249
    buffer_load_dwordx4 v58, s[20:23], s0 offen offset:3072 lds
    s_add_u32 m0, s58, 81920
    s_add_u32 s0, s0, 458752
    s_cmp_eq_u32 s0, 3670016
    s_cselect_b32 s0, 0, s0
    buffer_load_dwordx4 v55, s[20:23], s0 offen lds
    buffer_load_dwordx4 v56, s[20:23], s0 offen offset:1024 lds
    buffer_load_dwordx4 v57, s[20:23], s0 offen offset:2048 lds
    buffer_load_dwordx4 v58, s[20:23], s0 offen offset:3072 lds
    buffer_load_dword v18, v20, s[28:31], 0 offen sc1
    s_add_u32 m0, s58, 98304
    s_add_u32 s0, s0, 458752
    s_cmp_eq_u32 s0, 3670016
    s_cselect_b32 s0, 0, s0
    buffer_load_dwordx4 v55, s[20:23], s0 offen lds
    buffer_load_dwordx4 v56, s[20:23], s0 offen offset:1024 lds
    buffer_load_dwordx4 v57, s[20:23], s0 offen offset:2048 lds
    buffer_load_dwordx4 v58, s[20:23], s0 offen offset:3072 lds
    s_add_u32 m0, s58, 114688
    s_add_u32 s0, s0, 458752
    s_cmp_eq_u32 s0, 3670016
    s_cselect_b32 s0, 0, s0
    buffer_load_dwordx4 v55, s[20:23], s0 offen lds
    buffer_load_dwordx4 v56, s[20:23], s0 offen offset:1024 lds
    buffer_load_dwordx4 v57, s[20:23], s0 offen offset:2048 lds
    buffer_load_dwordx4 v58, s[20:23], s0 offen offset:3072 lds
    s_mov_b32 s3, s48
    s_mov_b64 exec, 0
L_warm:
    s_add_u32 s3, s3, 4
    s_cmp_eq_u32 s3, 4
    s_cbranch_scc1 L_pad0
    s_cmp_eq_u32 s3, 5
    s_cbranch_scc1 L_pad1
    s_cmp_eq_u32 s3, 6
    s_cbranch_scc1 L_pad2
    s_cmp_eq_u32 s3, 7
    s_cbranch_scc1 L_pad3
    s_cmp_eq_u32 s3, 8
    s_cbranch_scc1 L_pad4
    s_cmp_eq_u32 s3, 9
    s_nop 0
    s_mov_b64 exec, -1
    s_waitcnt vmcnt(8)
    v_cmp_ne_u32 vcc, s57, v18
    s_cbranch_vccnz L_pollin0
L_pollok0:
    s_barrier
    buffer_load_dwordx4 a[0:3], v78, s[28:31], s1 offen offset:0 sc1
    buffer_load_dwordx4 a[4:7], v78, s[28:31], s1 offen offset:256 sc1
    buffer_load_dwordx4 a[8:11], v78, s[28:31], s1 offen offset:2048 sc1
    buffer_load_dwordx4 a[12:15], v78, s[28:31], s1 offen offset:2304 sc1
    buffer_load_dword v76, v77, s[28:31], 0 offen sc1
    s_add_u32 s1, s1, 8192
    s_and_b32 s1, s1, 0xffff
    buffer_load_dwordx4 a[16:19], v78, s[28:31], s1 offen offset:0 sc1
    buffer_load_dwordx4 a[20:23], v78, s[28:31], s1 offen offset:256 sc1
    buffer_load_dwordx4 a[24:27], v78, s[28:31], s1 offen offset:2048 sc1
    buffer_load_dwordx4 a[28:31], v78, s[28:31], s1 offen offset:2304 sc1
    s_add_u32 s1, s1, 8192
    s_and_b32 s1, s1, 0xffff
    buffer_load_dwordx4 a[32:35], v78, s[28:31], s1 offen offset:0 sc1
    buffer_load_dwordx4 a[36:39], v78, s[28:31], s1 offen offset:256 sc1
    buffer_load_dwordx4 a[40:43], v78, s[28:31], s1 offen offset:2048 sc1
    buffer_load_dwordx4 a[44:47], v78, s[28:31], s1 offen offset:2304 sc1
    ds_read_b64_tr_b16 a[200:201], v31 offset:0
    ds_read_b64_tr_b16 a[202:203], v31 offset:2048
    ds_read_b64_tr_b16 a[204:205], v33 offset:0
    ds_read_b64_tr_b16 a[206:207], v33 offset:2048
    ds_read_b64_tr_b16 a[208:209], v32 offset:0
    ds_read_b64_tr_b16 a[210:211], v32 offset:2048
    ds_read_b64_tr_b16 a[212:213], v34 offset:0
    ds_read_b64_tr_b16 a[214:215], v34 offset:2048
    ds_read_b64_tr_b16 a[216:217], v31 offset:4096
    ds_read_b64_tr_b16 a[218:219], v31 offset:6144
    ds_read_b64_tr_b16 a[220:221], v33 offset:4096
    ds_read_b64_tr_b16 a[222:223], v33 offset:6144
    s_waitcnt vmcnt(11) lgkmcnt(8)
    v_mfma_f32_16x16x32_bf16 v[182:185], a[200:203], a[0:3], 0
    ds_read_b64_tr_b16 a[224:225], v32 offset:4096
    s_add_u32 s1, s1, 8192
    v_mfma_f32_16x16x32_bf16 v[190:193], a[200:203], a[4:7], 0
    ds_read_b64_tr_b16 a[226:227], v32 offset:6144
    s_and_b32 s1, s1, 0xffff
    s_mov_b32 s70, 0xaaaaaaaa
    s_mov_b32 s71, 0xaaaaaaaa
    s_mov_b32 s72, 0xfff0ffff
    s_mov_b32 s73, 0xf000ff00
    s_mov_b32 s74, 0xffc0fffc
    v_mfma_f32_16x16x32_bf16 v[198:201], a[204:207], a[0:3], 0
    ds_read_b64_tr_b16 a[228:229], v34 offset:4096
    buffer_load_dwordx4 a[48:51], v78, s[28:31], s1 offen offset:0 sc1
    v_mfma_f32_16x16x32_bf16 v[206:209], a[204:207], a[4:7], 0
    ds_read_b64_tr_b16 a[230:231], v34 offset:6144
    s_mov_b32 s75, 0xc000fc00
    s_waitcnt lgkmcnt(8)
    v_mfma_f32_16x16x32_bf16 v[186:189], a[208:211], a[0:3], 0
    ds_read_b64_tr_b16 a[200:201], v31 offset:16384
    s_mov_b32 s83, 0x3e8b97f6
    v_mfma_f32_16x16x32_bf16 v[194:197], a[208:211], a[4:7], 0
    ds_read_b64_tr_b16 a[202:203], v31 offset:18432
    buffer_load_dwordx4 a[52:55], v78, s[28:31], s1 offen offset:256 sc1
    v_lshlrev_b32 v13, 2, v2
    v_mfma_f32_16x16x32_bf16 v[202:205], a[212:215], a[0:3], 0
    ds_read_b64_tr_b16 a[204:205], v33 offset:16384
    v_and_b32 v14, 1, v1
    v_mfma_f32_16x16x32_bf16 v[210:213], a[212:215], a[4:7], 0
    ds_read_b64_tr_b16 a[206:207], v33 offset:18432
    s_waitcnt vmcnt(11) lgkmcnt(8)
    v_mfma_f32_16x16x32_bf16 v[182:185], a[216:219], a[8:11], v[182:185]
    ds_read_b64_tr_b16 a[208:209], v32 offset:16384
    buffer_load_dwordx4 a[56:59], v78, s[28:31], s1 offen offset:2048 sc1
    v_mfma_f32_16x16x32_bf16 v[190:193], a[216:219], a[12:15], v[190:193]
    ds_read_b64_tr_b16 a[210:211], v32 offset:18432
    v_lshl_add_u32 v14, v3, 2, v14
    v_mfma_f32_16x16x32_bf16 v[198:201], a[220:223], a[8:11], v[198:201]
    ds_read_b64_tr_b16 a[212:213], v34 offset:16384
    v_lshlrev_b32 v14, 2, v14
    v_mfma_f32_16x16x32_bf16 v[206:209], a[220:223], a[12:15], v[206:209]
    ds_read_b64_tr_b16 a[214:215], v34 offset:18432
    s_waitcnt lgkmcnt(8)
    v_mfma_f32_16x16x32_bf16 v[186:189], a[224:227], a[8:11], v[186:189]
    ds_read_b64_tr_b16 a[216:217], v31 offset:20480
    buffer_load_dwordx4 a[60:63], v78, s[28:31], s1 offen offset:2304 sc1
    v_mfma_f32_16x16x32_bf16 v[194:197], a[224:227], a[12:15], v[194:197]
    ds_read_b64_tr_b16 a[218:219], v31 offset:22528
    s_add_u32 s1, s1, 8192
    v_add_u32 v15, 64, v14
    v_mfma_f32_16x16x32_bf16 v[202:205], a[228:231], a[8:11], v[202:205]
    ds_read_b64_tr_b16 a[220:221], v33 offset:20480
    s_and_b32 s1, s1, 0xffff
    v_mfma_f32_16x16x32_bf16 v[210:213], a[228:231], a[12:15], v[210:213]
    ds_read_b64_tr_b16 a[222:223], v33 offset:22528
    s_waitcnt vmcnt(10) lgkmcnt(8)
    v_mfma_f32_16x16x32_bf16 v[182:185], a[200:203], a[16:19], v[182:185]
    ds_read_b64_tr_b16 a[224:225], v32 offset:20480
    buffer_load_dwordx4 a[64:67], v78, s[28:31], s1 offen offset:0 sc1
    v_mfma_f32_16x16x32_bf16 v[190:193], a[200:203], a[20:23], v[190:193]
    ds_read_b64_tr_b16 a[226:227], v32 offset:22528
    v_cndmask_b32 v16, v14, v15, s[72:73]
    v_mfma_f32_16x16x32_bf16 v[198:201], a[204:207], a[16:19], v[198:201]
    ds_read_b64_tr_b16 a[228:229], v34 offset:20480
    buffer_load_dwordx4 a[68:71], v78, s[28:31], s1 offen offset:256 sc1
    v_mfma_f32_16x16x32_bf16 v[206:209], a[204:207], a[20:23], v[206:209]
    ds_read_b64_tr_b16 a[230:231], v34 offset:22528
    v_cndmask_b32 v14, v14, v15, s[74:75]
    s_waitcnt lgkmcnt(8)
    v_mfma_f32_16x16x32_bf16 v[186:189], a[208:211], a[16:19], v[186:189]
    ds_read_b64_tr_b16 a[200:201], v31 offset:32768
    ds_bpermute_b32 v25, v13, v76 offset:64
    v_mfma_f32_16x16x32_bf16 v[194:197], a[208:211], a[20:23], v[194:197]
    ds_read_b64_tr_b16 a[202:203], v31 offset:34816
    buffer_load_dwordx4 a[72:75], v78, s[28:31], s1 offen offset:2048 sc1
    ds_bpermute_b32 v27, v16, v76 offset:0
    v_mfma_f32_16x16x32_bf16 v[202:205], a[212:215], a[16:19], v[202:205]
    ds_read_b64_tr_b16 a[204:205], v33 offset:32768
    ds_bpermute_b32 v28, v14, v76 offset:8
    v_mfma_f32_16x16x32_bf16 v[210:213], a[212:215], a[20:23], v[210:213]
    ds_read_b64_tr_b16 a[206:207], v33 offset:34816
    s_waitcnt vmcnt(11) lgkmcnt(11)
    v_mfma_f32_16x16x32_bf16 v[182:185], a[216:219], a[24:27], v[182:185]
    ds_read_b64_tr_b16 a[208:209], v32 offset:32768
    ds_bpermute_b32 v26, v13, v76 offset:128
    v_mfma_f32_16x16x32_bf16 v[190:193], a[216:219], a[28:31], v[190:193]
    ds_read_b64_tr_b16 a[210:211], v32 offset:34816
    buffer_load_dwordx4 a[76:79], v78, s[28:31], s1 offen offset:2304 sc1
    ds_bpermute_b32 v29, v16, v76 offset:64
    v_mfma_f32_16x16x32_bf16 v[198:201], a[220:223], a[24:27], v[198:201]
    ds_read_b64_tr_b16 a[212:213], v34 offset:32768
    s_add_u32 s1, s1, 8192
    v_mfma_f32_16x16x32_bf16 v[206:209], a[220:223], a[28:31], v[206:209]
    ds_read_b64_tr_b16 a[214:215], v34 offset:34816
    s_waitcnt lgkmcnt(13)
    v_mfma_f32_16x16x32_bf16 v[186:189], a[224:227], a[24:27], v[186:189]
    ds_read_b64_tr_b16 a[216:217], v31 offset:36864
    s_and_b32 s1, s1, 0xffff
    v_mfma_f32_16x16x32_bf16 v[194:197], a[224:227], a[28:31], v[194:197]
    ds_read_b64_tr_b16 a[218:219], v31 offset:38912
    buffer_load_dwordx4 a[80:83], v78, s[28:31], s1 offen offset:0 sc1
    ds_bpermute_b32 v30, v14, v76 offset:72
    v_mfma_f32_16x16x32_bf16 v[202:205], a[228:231], a[24:27], v[202:205]
    ds_read_b64_tr_b16 a[220:221], v33 offset:36864
    v_mfma_f32_16x16x32_bf16 v[210:213], a[228:231], a[28:31], v[210:213]
    ds_read_b64_tr_b16 a[222:223], v33 offset:38912
    s_waitcnt vmcnt(11) lgkmcnt(11)
    v_mfma_f32_16x16x32_bf16 v[182:185], a[200:203], a[32:35], v[182:185]
    ds_read_b64_tr_b16 a[224:225], v32 offset:36864
    buffer_load_dwordx4 a[84:87], v78, s[28:31], s1 offen offset:256 sc1
    v_mfma_f32_16x16x32_bf16 v[190:193], a[200:203], a[36:39], v[190:193]
    ds_read_b64_tr_b16 a[226:227], v32 offset:38912
    v_mfma_f32_16x16x32_bf16 v[198:201], a[204:207], a[32:35], v[198:201]
    ds_read_b64_tr_b16 a[228:229], v34 offset:36864
    v_mfma_f32_16x16x32_bf16 v[206:209], a[204:207], a[36:39], v[206:209]
    ds_read_b64_tr_b16 a[230:231], v34 offset:38912
    s_waitcnt lgkmcnt(9)
    v_mfma_f32_16x16x32_bf16 v[186:189], a[208:211], a[32:35], v[186:189]
    s_barrier
    ds_read_b64_tr_b16 a[200:201], v31 offset:49152
    buffer_load_dwordx4 a[88:91], v78, s[28:31], s1 offen offset:2048 sc1
    v_mfma_f32_16x16x32_bf16 v[194:197], a[208:211], a[36:39], v[194:197]
    ds_read_b64_tr_b16 a[202:203], v31 offset:51200
    v_mfma_f32_16x16x32_bf16 v[202:205], a[212:215], a[32:35], v[202:205]
    ds_read_b64_tr_b16 a[204:205], v33 offset:49152
    buffer_load_dwordx4 a[92:95], v78, s[28:31], s1 offen offset:2304 sc1
    v_mfma_f32_16x16x32_bf16 v[210:213], a[212:215], a[36:39], v[210:213]
    ds_read_b64_tr_b16 a[206:207], v33 offset:51200
    s_waitcnt vmcnt(12) lgkmcnt(8)
    v_mfma_f32_16x16x32_bf16 v[182:185], a[216:219], a[40:43], v[182:185]
    ds_read_b64_tr_b16 a[208:209], v32 offset:49152
    s_add_u32 m0, s58, 131072
    v_mfma_f32_16x16x32_bf16 v[190:193], a[216:219], a[44:47], v[190:193]
    ds_read_b64_tr_b16 a[210:211], v32 offset:51200
    s_add_u32 s0, s0, 458752
    v_mul_f32 v25, s83, v25
    v_mfma_f32_16x16x32_bf16 v[198:201], a[220:223], a[40:43], v[198:201]
    ds_read_b64_tr_b16 a[212:213], v34 offset:49152
    s_cmp_eq_u32 s0, 3670016
    v_mfma_f32_16x16x32_bf16 v[206:209], a[220:223], a[44:47], v[206:209]
    ds_read_b64_tr_b16 a[214:215], v34 offset:51200
    s_cselect_b32 s0, 0, s0
    v_xor_b32 v55, 128, v55
    buffer_load_dwordx4 v55, s[20:23], s0 offen lds
    s_waitcnt lgkmcnt(8)
    v_mfma_f32_16x16x32_bf16 v[186:189], a[224:227], a[40:43], v[186:189]
    ds_read_b64_tr_b16 a[216:217], v31 offset:53248
    v_xor_b32 v56, 128, v56
    v_mfma_f32_16x16x32_bf16 v[194:197], a[224:227], a[44:47], v[194:197]
    ds_read_b64_tr_b16 a[218:219], v31 offset:55296
    buffer_load_dwordx4 v56, s[20:23], s0 offen offset:1024 lds
    v_mul_f32 v26, s83, v26
    v_mfma_f32_16x16x32_bf16 v[202:205], a[228:231], a[40:43], v[202:205]
    ds_read_b64_tr_b16 a[220:221], v33 offset:53248
    v_xor_b32 v57, 128, v57
    v_mfma_f32_16x16x32_bf16 v[210:213], a[228:231], a[44:47], v[210:213]
    ds_read_b64_tr_b16 a[222:223], v33 offset:55296
    s_waitcnt vmcnt(12) lgkmcnt(8)
    v_mfma_f32_16x16x32_bf16 v[182:185], a[200:203], a[48:51], v[182:185]
    ds_read_b64_tr_b16 a[224:225], v32 offset:53248
    buffer_load_dwordx4 v57, s[20:23], s0 offen offset:2048 lds
    v_mfma_f32_16x16x32_bf16 v[190:193], a[200:203], a[52:55], v[190:193]
    ds_read_b64_tr_b16 a[226:227], v32 offset:55296
    v_xor_b32 v58, 128, v58
    s_cmp_eq_u32 s49, 0
    s_cselect_b64 s[76:77], 0, -1
    v_mfma_f32_16x16x32_bf16 v[198:201], a[204:207], a[48:51], v[198:201]
    ds_read_b64_tr_b16 a[228:229], v34 offset:53248
    v_mov_b32 v13, 0xffff
    v_mfma_f32_16x16x32_bf16 v[206:209], a[204:207], a[52:55], v[206:209]
    ds_read_b64_tr_b16 a[230:231], v34 offset:55296
    s_waitcnt lgkmcnt(8)
    v_mfma_f32_16x16x32_bf16 v[186:189], a[208:211], a[48:51], v[186:189]
    ds_read_b64_tr_b16 a[200:201], v35 offset:0
    buffer_load_dwordx4 v58, s[20:23], s0 offen offset:3072 lds
    v_mfma_f32_16x16x32_bf16 v[194:197], a[208:211], a[52:55], v[194:197]
    ds_read_b64_tr_b16 a[202:203], v35 offset:2048
    s_add_u32 s1, s1, 8192
    v_mov_b32 v14, 0xffff0000
    v_mfma_f32_16x16x32_bf16 v[202:205], a[212:215], a[48:51], v[202:205]
    ds_read_b64_tr_b16 a[204:205], v37 offset:0
    s_and_b32 s1, s1, 0xffff
    v_mfma_f32_16x16x32_bf16 v[210:213], a[212:215], a[52:55], v[210:213]
    ds_read_b64_tr_b16 a[206:207], v37 offset:2048
    v_cndmask_b32 v13, v13, v14, s[70:71]
    s_waitcnt vmcnt(12) lgkmcnt(8)
    v_mfma_f32_16x16x32_bf16 v[182:185], a[216:219], a[56:59], v[182:185]
    ds_read_b64_tr_b16 a[208:209], v36 offset:0
    buffer_load_dwordx4 a[96:99], v78, s[28:31], s1 offen offset:0 sc1
    v_mfma_f32_16x16x32_bf16 v[190:193], a[216:219], a[60:63], v[190:193]
    ds_read_b64_tr_b16 a[210:211], v36 offset:2048
    v_cndmask_b32 v104, v13, 0, s[72:73]
    v_mfma_f32_16x16x32_bf16 v[198:201], a[220:223], a[56:59], v[198:201]
    ds_read_b64_tr_b16 a[212:213], v38 offset:0
    buffer_load_dwordx4 a[100:103], v78, s[28:31], s1 offen offset:256 sc1
    v_mfma_f32_16x16x32_bf16 v[206:209], a[220:223], a[60:63], v[206:209]
    ds_read_b64_tr_b16 a[214:215], v38 offset:2048
    v_cndmask_b32 v106, 0, v13, s[72:73]
    s_waitcnt lgkmcnt(8)
    v_mfma_f32_16x16x32_bf16 v[186:189], a[224:227], a[56:59], v[186:189]
    ds_read_b64_tr_b16 a[216:217], v35 offset:4096
    v_cndmask_b32 v105, v13, 0, s[74:75]
    v_mfma_f32_16x16x32_bf16 v[194:197], a[224:227], a[60:63], v[194:197]
    ds_read_b64_tr_b16 a[218:219], v35 offset:6144
    buffer_load_dwordx4 a[104:107], v78, s[28:31], s1 offen offset:2048 sc1
    v_cndmask_b32 v107, 0, v13, s[74:75]
    v_mfma_f32_16x16x32_bf16 v[202:205], a[228:231], a[56:59], v[202:205]
    ds_read_b64_tr_b16 a[220:221], v37 offset:4096
    v_mov_b32 v84, 0xf149f2ca
    v_mfma_f32_16x16x32_bf16 v[210:213], a[228:231], a[60:63], v[210:213]
    ds_read_b64_tr_b16 a[222:223], v37 offset:6144
    s_waitcnt vmcnt(13) lgkmcnt(8)
    v_mfma_f32_16x16x32_bf16 v[182:185], a[200:203], a[64:67], v[182:185]
    ds_read_b64_tr_b16 a[224:225], v36 offset:4096
    buffer_load_dwordx4 a[108:111], v78, s[28:31], s1 offen offset:2304 sc1
    v_mfma_f32_16x16x32_bf16 v[190:193], a[200:203], a[68:71], v[190:193]
    ds_read_b64_tr_b16 a[226:227], v36 offset:6144
    s_add_u32 m0, s58, 147456
    s_mov_b32 s83, 0x3e8b97f6
    v_mfma_f32_16x16x32_bf16 v[198:201], a[204:207], a[64:67], v[198:201]
    ds_read_b64_tr_b16 a[228:229], v38 offset:4096
    s_add_u32 s0, s0, 458752
    v_mfma_f32_16x16x32_bf16 v[206:209], a[204:207], a[68:71], v[206:209]
    ds_read_b64_tr_b16 a[230:231], v38 offset:6144
    s_mov_b32 s78, 0xbdd2d3e8
    s_mov_b32 s79, 0xbdd2d3e8
    s_waitcnt lgkmcnt(8)
    v_mfma_f32_16x16x32_bf16 v[186:189], a[208:211], a[64:67], v[186:189]
    s_barrier
    s_load_dword s14, s[44:45], s15
    ds_read_b64_tr_b16 a[200:201], v35 offset:16384
    s_cmp_eq_u32 s0, 3670016
    s_cselect_b32 s0, 0, s0
    buffer_load_dwordx4 v55, s[20:23], s0 offen lds
    v_mfma_f32_16x16x32_bf16 v[194:197], a[208:211], a[68:71], v[194:197]
    ds_read_b64_tr_b16 a[202:203], v35 offset:18432
    s_mov_b32 s80, 1.0
    v_mfma_f32_16x16x32_bf16 v[202:205], a[212:215], a[64:67], v[202:205]
    ds_read_b64_tr_b16 a[204:205], v37 offset:16384
    buffer_load_dwordx4 v56, s[20:23], s0 offen offset:1024 lds
    v_mfma_f32_16x16x32_bf16 v[210:213], a[212:215], a[68:71], v[210:213]
    ds_read_b64_tr_b16 a[206:207], v37 offset:18432
    s_mov_b32 s81, 1.0
    s_waitcnt vmcnt(14) lgkmcnt(8)
    v_mfma_f32_16x16x32_bf16 v[182:185], a[216:219], a[72:75], v[182:185]
    ds_read_b64_tr_b16 a[208:209], v36 offset:16384
    v_mov_b32 v108, 0xc0135761
    v_mfma_f32_16x16x32_bf16 v[190:193], a[216:219], a[76:79], v[190:193]
    ds_read_b64_tr_b16 a[210:211], v36 offset:18432
    buffer_load_dwordx4 v57, s[20:23], s0 offen offset:2048 lds
    v_mov_b32 v109, 0xc0135761
    v_mfma_f32_16x16x32_bf16 v[198:201], a[220:223], a[72:75], v[198:201]
    ds_read_b64_tr_b16 a[212:213], v38 offset:16384
    v_lshrrev_b32 v13, 1, v2
    v_mfma_f32_16x16x32_bf16 v[206:209], a[220:223], a[76:79], v[206:209]
    ds_read_b64_tr_b16 a[214:215], v38 offset:18432
    s_waitcnt lgkmcnt(8)
    v_mfma_f32_16x16x32_bf16 v[186:189], a[224:227], a[72:75], v[186:189]
    ds_read_b64_tr_b16 a[216:217], v35 offset:20480
    buffer_load_dwordx4 v58, s[20:23], s0 offen offset:3072 lds
    v_mfma_f32_16x16x32_bf16 v[194:197], a[224:227], a[76:79], v[194:197]
    ds_read_b64_tr_b16 a[218:219], v35 offset:22528
    s_add_u32 s1, s1, 8192
    v_lshlrev_b32 v14, 1, v3
    v_mfma_f32_16x16x32_bf16 v[202:205], a[228:231], a[72:75], v[202:205]
    ds_read_b64_tr_b16 a[220:221], v37 offset:20480
    s_and_b32 s1, s1, 0xffff
    v_mfma_f32_16x16x32_bf16 v[210:213], a[228:231], a[76:79], v[210:213]
    ds_read_b64_tr_b16 a[222:223], v37 offset:22528
    s_waitcnt vmcnt(14) lgkmcnt(8)
    v_mfma_f32_16x16x32_bf16 v[182:185], a[200:203], a[80:83], v[182:185]
    ds_read_b64_tr_b16 a[224:225], v36 offset:20480
    buffer_load_dwordx4 a[112:115], v78, s[28:31], s1 offen offset:0 sc1
    v_mfma_f32_16x16x32_bf16 v[190:193], a[200:203], a[84:87], v[190:193]
L_pad0:
    s_cbranch_execz L_warm
    ds_read_b64_tr_b16 a[226:227], v36 offset:22528
    v_sub_u32 v13, v13, v14
    v_mfma_f32_16x16x32_bf16 v[198:201], a[204:207], a[80:83], v[198:201]
    ds_read_b64_tr_b16 a[228:229], v38 offset:20480
    buffer_load_dwordx4 a[116:119], v78, s[28:31], s1 offen offset:256 sc1
    v_mfma_f32_16x16x32_bf16 v[206:209], a[204:207], a[84:87], v[206:209]
    ds_read_b64_tr_b16 a[230:231], v38 offset:22528
    v_mov_b32 v14, 0x3f80
    s_waitcnt lgkmcnt(8)
    v_mfma_f32_16x16x32_bf16 v[186:189], a[208:211], a[80:83], v[186:189]
    ds_read_b64_tr_b16 a[200:201], v35 offset:32768
    v_cndmask_b32 v14, v14, 1.0, s[70:71]
    v_mfma_f32_16x16x32_bf16 v[194:197], a[208:211], a[84:87], v[194:197]
    ds_read_b64_tr_b16 a[202:203], v35 offset:34816
    buffer_load_dwordx4 a[120:123], v78, s[28:31], s1 offen offset:2048 sc1
    v_cmp_eq_i32 vcc, 0, v13
    v_mfma_f32_16x16x32_bf16 v[202:205], a[212:215], a[80:83], v[202:205]
    ds_read_b64_tr_b16 a[204:205], v37 offset:32768
    v_accvgpr_write_b32 a248, 0
    v_mfma_f32_16x16x32_bf16 v[210:213], a[212:215], a[84:87], v[210:213]
    ds_read_b64_tr_b16 a[206:207], v37 offset:34816
    s_waitcnt vmcnt(15) lgkmcnt(8)
    v_mfma_f32_16x16x32_bf16 v[182:185], a[216:219], a[88:91], v[182:185]
    ds_read_b64_tr_b16 a[208:209], v36 offset:32768
    buffer_load_dwordx4 a[124:127], v78, s[28:31], s1 offen offset:2304 sc1
    v_mfma_f32_16x16x32_bf16 v[190:193], a[216:219], a[92:95], v[190:193]
    ds_read_b64_tr_b16 a[210:211], v36 offset:34816
    s_add_u32 m0, s58, 0
    v_accvgpr_write_b32 a252, 0
    v_mfma_f32_16x16x32_bf16 v[198:201], a[220:223], a[88:91], v[198:201]
    ds_read_b64_tr_b16 a[212:213], v38 offset:32768
    s_add_u32 s0, s0, 458752
    v_mfma_f32_16x16x32_bf16 v[206:209], a[220:223], a[92:95], v[206:209]
    ds_read_b64_tr_b16 a[214:215], v38 offset:34816
    s_waitcnt lgkmcnt(8)
    v_mfma_f32_16x16x32_bf16 v[186:189], a[224:227], a[88:91], v[186:189]
    ds_read_b64_tr_b16 a[216:217], v35 offset:36864
    s_cmp_eq_u32 s0, 3670016
    v_mfma_f32_16x16x32_bf16 v[194:197], a[224:227], a[92:95], v[194:197]
    ds_read_b64_tr_b16 a[218:219], v35 offset:38912
    s_cselect_b32 s0, 0, s0
    buffer_load_dwordx4 v55, s[20:23], s0 offen lds
    v_cndmask_b32 v15, 0, v14, vcc
    v_mfma_f32_16x16x32_bf16 v[202:205], a[228:231], a[88:91], v[202:205]
    ds_read_b64_tr_b16 a[220:221], v37 offset:36864
    v_accvgpr_write_b32 a250, v15
    v_mfma_f32_16x16x32_bf16 v[210:213], a[228:231], a[92:95], v[210:213]
    ds_read_b64_tr_b16 a[222:223], v37 offset:38912
    s_waitcnt vmcnt(11) lgkmcnt(8)
    v_mfma_f32_16x16x32_bf16 v[182:185], a[200:203], a[96:99], v[182:185]
    ds_read_b64_tr_b16 a[224:225], v36 offset:36864
    buffer_load_dwordx4 v56, s[20:23], s0 offen offset:1024 lds
    v_mfma_f32_16x16x32_bf16 v[190:193], a[200:203], a[100:103], v[190:193]
    ds_read_b64_tr_b16 a[226:227], v36 offset:38912
    v_cmp_eq_i32 vcc, 1, v13
    v_mfma_f32_16x16x32_bf16 v[198:201], a[204:207], a[96:99], v[198:201]
    ds_read_b64_tr_b16 a[228:229], v38 offset:36864
    buffer_load_dwordx4 v57, s[20:23], s0 offen offset:2048 lds
    v_mfma_f32_16x16x32_bf16 v[206:209], a[204:207], a[100:103], v[206:209]
    ds_read_b64_tr_b16 a[230:231], v38 offset:38912
    v_accvgpr_write_b32 a249, 0
    s_waitcnt lgkmcnt(8)
    v_mfma_f32_16x16x32_bf16 v[186:189], a[208:211], a[96:99], v[186:189]
    s_waitcnt vmcnt(7)
    s_barrier
    ds_read_b64_tr_b16 a[200:201], v35 offset:49152
    buffer_load_dwordx4 v58, s[20:23], s0 offen offset:3072 lds
    v_mfma_f32_16x16x32_bf16 v[194:197], a[208:211], a[100:103], v[194:197]
    ds_read_b64_tr_b16 a[202:203], v35 offset:51200
    s_add_u32 m0, s58, 16384
    v_accvgpr_write_b32 a253, 0
    v_mfma_f32_16x16x32_bf16 v[202:205], a[212:215], a[96:99], v[202:205]
    ds_read_b64_tr_b16 a[204:205], v37 offset:49152
    s_add_u32 s0, s0, 458752
    v_mfma_f32_16x16x32_bf16 v[210:213], a[212:215], a[100:103], v[210:213]
    ds_read_b64_tr_b16 a[206:207], v37 offset:51200
    s_waitcnt lgkmcnt(8)
    v_mfma_f32_16x16x32_bf16 v[182:185], a[216:219], a[104:107], v[182:185]
    ds_read_b64_tr_b16 a[208:209], v36 offset:49152
    s_cmp_eq_u32 s0, 3670016
    v_mfma_f32_16x16x32_bf16 v[190:193], a[216:219], a[108:111], v[190:193]
    ds_read_b64_tr_b16 a[210:211], v36 offset:51200
    s_cselect_b32 s0, 0, s0
    buffer_load_dwordx4 v55, s[20:23], s0 offen lds
    v_cndmask_b32 v15, 0, v14, vcc
    v_mfma_f32_16x16x32_bf16 v[198:201], a[220:223], a[104:107], v[198:201]
    ds_read_b64_tr_b16 a[212:213], v38 offset:49152
    v_accvgpr_write_b32 a251, v15
    v_mfma_f32_16x16x32_bf16 v[206:209], a[220:223], a[108:111], v[206:209]
    ds_read_b64_tr_b16 a[214:215], v38 offset:51200
    s_waitcnt lgkmcnt(8)
    v_mfma_f32_16x16x32_bf16 v[186:189], a[224:227], a[104:107], v[186:189]
    ds_read_b64_tr_b16 a[216:217], v35 offset:53248
    buffer_load_dwordx4 v56, s[20:23], s0 offen offset:1024 lds
    v_mfma_f32_16x16x32_bf16 v[194:197], a[224:227], a[108:111], v[194:197]
    ds_read_b64_tr_b16 a[218:219], v35 offset:55296
    v_mfma_f32_16x16x32_bf16 v[202:205], a[228:231], a[104:107], v[202:205]
    ds_read_b64_tr_b16 a[220:221], v37 offset:53248
    buffer_load_dwordx4 v57, s[20:23], s0 offen offset:2048 lds
    v_mfma_f32_16x16x32_bf16 v[210:213], a[228:231], a[108:111], v[210:213]
    ds_read_b64_tr_b16 a[222:223], v37 offset:55296
    s_waitcnt vmcnt(9) lgkmcnt(8)
    v_mfma_f32_16x16x32_bf16 v[182:185], a[200:203], a[112:115], v[182:185]
    ds_read_b64_tr_b16 a[224:225], v36 offset:53248
    v_mfma_f32_16x16x32_bf16 v[190:193], a[200:203], a[116:119], v[190:193]
    ds_read_b64_tr_b16 a[226:227], v36 offset:55296
    buffer_load_dwordx4 v58, s[20:23], s0 offen offset:3072 lds
    v_mfma_f32_16x16x32_bf16 v[198:201], a[204:207], a[112:115], v[198:201]
    ds_read_b64_tr_b16 a[228:229], v38 offset:53248
    s_add_u32 m0, s58, 32768
    v_mfma_f32_16x16x32_bf16 v[206:209], a[204:207], a[116:119], v[206:209]
    ds_read_b64_tr_b16 a[230:231], v38 offset:55296
    s_waitcnt lgkmcnt(8)
    v_mfma_f32_16x16x32_bf16 v[186:189], a[208:211], a[112:115], v[186:189]
    s_waitcnt lgkmcnt(0)
    s_cmp_ge_u32 s14, 14
    s_cbranch_scc0 L_pollin1
L_pollok1:
    ds_read_b64_tr_b16 a[200:201], v39 offset:0
    s_add_u32 s0, s0, 458752
    v_mfma_f32_16x16x32_bf16 v[194:197], a[208:211], a[116:119], v[194:197]
    ds_read_b64_tr_b16 a[202:203], v39 offset:2048
    s_cmp_eq_u32 s0, 3670016
    s_cselect_b32 s0, 0, s0
    buffer_load_dwordx4 v55, s[20:23], s0 offen lds
    v_mfma_f32_16x16x32_bf16 v[202:205], a[212:215], a[112:115], v[202:205]
    ds_read_b64_tr_b16 a[204:205], v41 offset:0
    v_mfma_f32_16x16x32_bf16 v[210:213], a[212:215], a[116:119], v[210:213]
    ds_read_b64_tr_b16 a[206:207], v41 offset:2048
    s_waitcnt vmcnt(9)
    v_mfma_f32_16x16x32_bf16 v[182:185], a[216:219], a[120:123], v[182:185]
    ds_read_b64_tr_b16 a[208:209], v40 offset:0
    buffer_load_dwordx4 v56, s[20:23], s0 offen offset:1024 lds
    v_mfma_f32_16x16x32_bf16 v[190:193], a[216:219], a[124:127], v[190:193]
    ds_read_b64_tr_b16 a[210:211], v40 offset:2048
    v_mfma_f32_16x16x32_bf16 v[198:201], a[220:223], a[120:123], v[198:201]
    ds_read_b64_tr_b16 a[212:213], v42 offset:0
    buffer_load_dwordx4 v57, s[20:23], s0 offen offset:2048 lds
    v_mfma_f32_16x16x32_bf16 v[206:209], a[220:223], a[124:127], v[206:209]
    ds_read_b64_tr_b16 a[214:215], v42 offset:2048
    v_mfma_f32_16x16x32_bf16 v[186:189], a[224:227], a[120:123], v[186:189]
    ds_read_b64_tr_b16 a[216:217], v39 offset:4096
    v_mfma_f32_16x16x32_bf16 v[194:197], a[224:227], a[124:127], v[194:197]
    ds_read_b64_tr_b16 a[218:219], v39 offset:6144
    v_mfma_f32_16x16x32_bf16 v[202:205], a[228:231], a[120:123], v[202:205]
    ds_read_b64_tr_b16 a[220:221], v41 offset:4096
    buffer_load_dwordx4 v58, s[20:23], s0 offen offset:3072 lds
    v_mfma_f32_16x16x32_bf16 v[210:213], a[228:231], a[124:127], v[210:213]
    ds_read_b64_tr_b16 a[222:223], v41 offset:6144
    s_waitcnt lgkmcnt(8)
    v_mfma_f32_16x16x32_bf16 v[150:153], a[200:203], a[0:3], v[150:153]
    ds_read_b64_tr_b16 a[224:225], v40 offset:4096
    s_add_u32 m0, s58, 49152
    v_mfma_f32_16x16x32_bf16 v[158:161], a[200:203], a[4:7], v[158:161]
    ds_read_b64_tr_b16 a[226:227], v40 offset:6144
    s_add_u32 s0, s0, 458752
    v_mfma_f32_16x16x32_bf16 v[166:169], a[204:207], a[0:3], 0
    ds_read_b64_tr_b16 a[228:229], v42 offset:4096
    s_cmp_eq_u32 s0, 3670016
    s_cselect_b32 s0, 0, s0
    buffer_load_dwordx4 v55, s[20:23], s0 offen lds
    v_mfma_f32_16x16x32_bf16 v[174:177], a[204:207], a[4:7], 0
    ds_read_b64_tr_b16 a[230:231], v42 offset:6144
    v_cvt_pk_bf16_f32 v182, v182, v183
    v_cvt_pk_bf16_f32 v183, v184, v185
    v_cvt_pk_bf16_f32 v184, v186, v187
    s_waitcnt lgkmcnt(8)
    v_mfma_f32_16x16x32_bf16 v[154:157], a[208:211], a[0:3], v[154:157]
    s_waitcnt vmcnt(5)
    s_barrier
    ds_read_b64_tr_b16 a[200:201], v39 offset:16384
    buffer_load_dwordx4 v56, s[20:23], s0 offen offset:1024 lds
    v_mfma_f32_16x16x32_bf16 v[162:165], a[208:211], a[4:7], v[162:165]
    ds_read_b64_tr_b16 a[202:203], v39 offset:18432
    v_cvt_pk_bf16_f32 v185, v188, v189
    buffer_store_dwordx4 v[182:185], v23, s[28:31], 0 offen offset:0 sc1
    v_cvt_pk_bf16_f32 v190, v190, v191
    v_cvt_pk_bf16_f32 v191, v192, v193
    v_cvt_pk_bf16_f32 v192, v194, v195
    v_mfma_f32_16x16x32_bf16 v[170:173], a[212:215], a[0:3], 0
    ds_read_b64_tr_b16 a[204:205], v41 offset:16384
    v_cvt_pk_bf16_f32 v193, v196, v197
    v_mfma_f32_16x16x32_bf16 v[178:181], a[212:215], a[4:7], 0
    ds_read_b64_tr_b16 a[206:207], v41 offset:18432
    buffer_store_dwordx4 v[190:193], v23, s[28:31], 0 offen offset:1024 sc1
    v_cvt_pk_bf16_f32 v198, v198, v199
    v_cvt_pk_bf16_f32 v199, v200, v201
    v_cvt_pk_bf16_f32 v200, v202, v203
    s_waitcnt lgkmcnt(8)
    v_mfma_f32_16x16x32_bf16 v[150:153], a[216:219], a[8:11], v[150:153]
    ds_read_b64_tr_b16 a[208:209], v40 offset:16384
    buffer_load_dwordx4 v57, s[20:23], s0 offen offset:2048 lds
    v_mfma_f32_16x16x32_bf16 v[158:161], a[216:219], a[12:15], v[158:161]
    ds_read_b64_tr_b16 a[210:211], v40 offset:18432
    v_cvt_pk_bf16_f32 v201, v204, v205
    buffer_store_dwordx4 v[198:201], v23, s[28:31], 0 offen offset:2048 sc1
    v_cvt_pk_bf16_f32 v206, v206, v207
    v_cvt_pk_bf16_f32 v207, v208, v209
    v_cvt_pk_bf16_f32 v208, v210, v211
    v_mfma_f32_16x16x32_bf16 v[166:169], a[220:223], a[8:11], v[166:169]
    ds_read_b64_tr_b16 a[212:213], v42 offset:16384
    v_cvt_pk_bf16_f32 v209, v212, v213
    v_mfma_f32_16x16x32_bf16 v[174:177], a[220:223], a[12:15], v[174:177]
    ds_read_b64_tr_b16 a[214:215], v42 offset:18432
    s_waitcnt lgkmcnt(8)
    v_mfma_f32_16x16x32_bf16 v[154:157], a[224:227], a[8:11], v[154:157]
    ds_read_b64_tr_b16 a[216:217], v39 offset:20480
    buffer_load_dwordx4 v58, s[20:23], s0 offen offset:3072 lds
    v_mfma_f32_16x16x32_bf16 v[162:165], a[224:227], a[12:15], v[162:165]
    ds_read_b64_tr_b16 a[218:219], v39 offset:22528
    s_add_u32 m0, s58, 65536
    buffer_store_dwordx4 v[206:209], v23, s[28:31], 0 offen offset:3072 sc1
    v_mfma_f32_16x16x32_bf16 v[170:173], a[228:231], a[8:11], v[170:173]
    ds_read_b64_tr_b16 a[220:221], v41 offset:20480
    s_add_u32 s0, s0, 458752
    v_mfma_f32_16x16x32_bf16 v[178:181], a[228:231], a[12:15], v[178:181]
    ds_read_b64_tr_b16 a[222:223], v41 offset:22528
    s_waitcnt lgkmcnt(8)
    v_mfma_f32_16x16x32_bf16 v[150:153], a[200:203], a[16:19], v[150:153]
    ds_read_b64_tr_b16 a[224:225], v40 offset:20480
    s_cmp_eq_u32 s0, 3670016
    v_mfma_f32_16x16x32_bf16 v[158:161], a[200:203], a[20:23], v[158:161]
    ds_read_b64_tr_b16 a[226:227], v40 offset:22528
    s_cselect_b32 s0, 0, s0
    buffer_load_dwordx4 v55, s[20:23], s0 offen lds
    v_mfma_f32_16x16x32_bf16 v[166:169], a[204:207], a[16:19], v[166:169]
    ds_read_b64_tr_b16 a[228:229], v42 offset:20480
    v_mfma_f32_16x16x32_bf16 v[174:177], a[204:207], a[20:23], v[174:177]
    ds_read_b64_tr_b16 a[230:231], v42 offset:22528
    s_waitcnt lgkmcnt(8)
    v_mfma_f32_16x16x32_bf16 v[154:157], a[208:211], a[16:19], v[154:157]
    ds_read_b64_tr_b16 a[200:201], v31 offset:0
    buffer_load_dwordx4 v56, s[20:23], s0 offen offset:1024 lds
    v_mfma_f32_16x16x32_bf16 v[162:165], a[208:211], a[20:23], v[162:165]
    ds_read_b64_tr_b16 a[202:203], v31 offset:2048
    v_mfma_f32_16x16x32_bf16 v[170:173], a[212:215], a[16:19], v[170:173]
    ds_read_b64_tr_b16 a[204:205], v33 offset:0
    buffer_load_dwordx4 v57, s[20:23], s0 offen offset:2048 lds
    v_mfma_f32_16x16x32_bf16 v[178:181], a[212:215], a[20:23], v[178:181]
    ds_read_b64_tr_b16 a[206:207], v33 offset:2048
    s_waitcnt lgkmcnt(8)
    v_mfma_f32_16x16x32_bf16 v[150:153], a[216:219], a[24:27], v[150:153]
    ds_read_b64_tr_b16 a[208:209], v32 offset:0
    v_mfma_f32_16x16x32_bf16 v[158:161], a[216:219], a[28:31], v[158:161]
    ds_read_b64_tr_b16 a[210:211], v32 offset:2048
    buffer_load_dwordx4 v58, s[20:23], s0 offen offset:3072 lds
    v_mfma_f32_16x16x32_bf16 v[166:169], a[220:223], a[24:27], v[166:169]
    ds_read_b64_tr_b16 a[212:213], v34 offset:0
    s_add_u32 m0, s58, 81920
    v_mfma_f32_16x16x32_bf16 v[174:177], a[220:223], a[28:31], v[174:177]
    ds_read_b64_tr_b16 a[214:215], v34 offset:2048
    s_waitcnt lgkmcnt(8)
    v_mfma_f32_16x16x32_bf16 v[154:157], a[224:227], a[24:27], v[154:157]
    ds_read_b64_tr_b16 a[216:217], v31 offset:4096
    s_add_u32 s0, s0, 458752
    v_mfma_f32_16x16x32_bf16 v[162:165], a[224:227], a[28:31], v[162:165]
    ds_read_b64_tr_b16 a[218:219], v31 offset:6144
    s_cmp_eq_u32 s0, 3670016
    v_mfma_f32_16x16x32_bf16 v[170:173], a[228:231], a[24:27], v[170:173]
    ds_read_b64_tr_b16 a[220:221], v33 offset:4096
    s_cselect_b32 s0, 0, s0
    buffer_load_dwordx4 v55, s[20:23], s0 offen lds
    v_mfma_f32_16x16x32_bf16 v[178:181], a[228:231], a[28:31], v[178:181]
    ds_read_b64_tr_b16 a[222:223], v33 offset:6144
    s_waitcnt lgkmcnt(8)
    v_mfma_f32_16x16x32_bf16 v[150:153], a[200:203], a[32:35], v[150:153]
    ds_read_b64_tr_b16 a[224:225], v32 offset:4096
    buffer_load_dwordx4 v56, s[20:23], s0 offen offset:1024 lds
    v_mfma_f32_16x16x32_bf16 v[158:161], a[200:203], a[36:39], v[158:161]
    ds_read_b64_tr_b16 a[226:227], v32 offset:6144
    v_mfma_f32_16x16x32_bf16 v[166:169], a[204:207], a[32:35], v[166:169]
    ds_read_b64_tr_b16 a[228:229], v34 offset:4096
    v_mfma_f32_16x16x32_bf16 v[174:177], a[204:207], a[36:39], v[174:177]
    ds_read_b64_tr_b16 a[230:231], v34 offset:6144
    s_waitcnt lgkmcnt(8)
    v_mfma_f32_16x16x32_bf16 v[154:157], a[208:211], a[32:35], v[154:157]
    s_waitcnt vmcnt(7)
    s_barrier
    s_waitcnt vmcnt(6)
    s_atomic_add s36, s[28:29], s37
    ds_read_b64_tr_b16 a[200:201], v31 offset:16384
    buffer_load_dwordx4 v57, s[20:23], s0 offen offset:2048 lds
    v_mfma_f32_16x16x32_bf16 v[162:165], a[208:211], a[36:39], v[162:165]
    ds_read_b64_tr_b16 a[202:203], v31 offset:18432
    v_mfma_f32_16x16x32_bf16 v[170:173], a[212:215], a[32:35], v[170:173]
    ds_read_b64_tr_b16 a[204:205], v33 offset:16384
    buffer_load_dwordx4 v58, s[20:23], s0 offen offset:3072 lds
    v_mfma_f32_16x16x32_bf16 v[178:181], a[212:215], a[36:39], v[178:181]
    ds_read_b64_tr_b16 a[206:207], v33 offset:18432
    s_waitcnt lgkmcnt(8)
    v_mfma_f32_16x16x32_bf16 v[150:153], a[216:219], a[40:43], v[150:153]
    ds_read_b64_tr_b16 a[208:209], v32 offset:16384
    s_add_u32 m0, s59, 98304
    v_mfma_f32_16x16x32_bf16 v[158:161], a[216:219], a[44:47], v[158:161]
    ds_read_b64_tr_b16 a[210:211], v32 offset:18432
    buffer_load_dwordx4 v80, s[28:31], s63 offen sc1 lds
    v_mfma_f32_16x16x32_bf16 v[166:169], a[220:223], a[40:43], v[166:169]
    ds_read_b64_tr_b16 a[212:213], v34 offset:16384
    v_mfma_f32_16x16x32_bf16 v[174:177], a[220:223], a[44:47], v[174:177]
    ds_read_b64_tr_b16 a[214:215], v34 offset:18432
    s_waitcnt lgkmcnt(8)
    v_mfma_f32_16x16x32_bf16 v[154:157], a[224:227], a[40:43], v[154:157]
    ds_read_b64_tr_b16 a[216:217], v31 offset:20480
    v_mfma_f32_16x16x32_bf16 v[162:165], a[224:227], a[44:47], v[162:165]
    ds_read_b64_tr_b16 a[218:219], v31 offset:22528
    buffer_load_dwordx4 v80, s[28:31], s63 offen offset:1024 sc1 lds
    v_mfma_f32_16x16x32_bf16 v[170:173], a[228:231], a[40:43], v[170:173]
    ds_read_b64_tr_b16 a[220:221], v33 offset:20480
    v_mfma_f32_16x16x32_bf16 v[178:181], a[228:231], a[44:47], v[178:181]
    ds_read_b64_tr_b16 a[222:223], v33 offset:22528
    s_waitcnt lgkmcnt(8)
    v_mfma_f32_16x16x32_bf16 v[150:153], a[200:203], a[48:51], v[150:153]
    ds_read_b64_tr_b16 a[224:225], v32 offset:20480
    buffer_load_dwordx4 v80, s[28:31], s63 offen offset:2048 sc1 lds
    v_mfma_f32_16x16x32_bf16 v[158:161], a[200:203], a[52:55], v[158:161]
    ds_read_b64_tr_b16 a[226:227], v32 offset:22528
    s_add_u32 m0, s100, 126976
    v_mfma_f32_16x16x32_bf16 v[166:169], a[204:207], a[48:51], v[166:169]
    ds_read_b64_tr_b16 a[228:229], v34 offset:20480
    v_mfma_f32_16x16x32_bf16 v[174:177], a[204:207], a[52:55], v[174:177]
    ds_read_b64_tr_b16 a[230:231], v34 offset:22528
    s_waitcnt lgkmcnt(8)
    v_mfma_f32_16x16x32_bf16 v[154:157], a[208:211], a[48:51], v[154:157]
    ds_read_b64_tr_b16 a[200:201], v31 offset:32768
    buffer_load_dwordx4 v69, s[28:31], s62 offen sc1 lds
    v_mfma_f32_16x16x32_bf16 v[162:165], a[208:211], a[52:55], v[162:165]
    ds_read_b64_tr_b16 a[202:203], v31 offset:34816
    s_add_u32 m0, s58, 110592
    v_mfma_f32_16x16x32_bf16 v[170:173], a[212:215], a[48:51], v[170:173]
    ds_read_b64_tr_b16 a[204:205], v33 offset:32768
    v_mfma_f32_16x16x32_bf16 v[178:181], a[212:215], a[52:55], v[178:181]
    ds_read_b64_tr_b16 a[206:207], v33 offset:34816
    s_waitcnt lgkmcnt(8)
    v_mfma_f32_16x16x32_bf16 v[150:153], a[216:219], a[56:59], v[150:153]
    ds_read_b64_tr_b16 a[208:209], v32 offset:32768
    buffer_load_dwordx4 v67, s[28:31], s62 offen sc1 lds
    v_mfma_f32_16x16x32_bf16 v[158:161], a[216:219], a[60:63], v[158:161]
    ds_read_b64_tr_b16 a[210:211], v32 offset:34816
    v_mfma_f32_16x16x32_bf16 v[166:169], a[220:223], a[56:59], v[166:169]
    ds_read_b64_tr_b16 a[212:213], v34 offset:32768
    v_mfma_f32_16x16x32_bf16 v[174:177], a[220:223], a[60:63], v[174:177]
    ds_read_b64_tr_b16 a[214:215], v34 offset:34816
    s_waitcnt lgkmcnt(8)
    v_mfma_f32_16x16x32_bf16 v[154:157], a[224:227], a[56:59], v[154:157]
    ds_read_b64_tr_b16 a[216:217], v31 offset:36864
    buffer_load_dwordx4 v67, s[28:31], s62 offen offset:1024 sc1 lds
    v_mfma_f32_16x16x32_bf16 v[162:165], a[224:227], a[60:63], v[162:165]
    ds_read_b64_tr_b16 a[218:219], v31 offset:38912
    v_mfma_f32_16x16x32_bf16 v[170:173], a[228:231], a[56:59], v[170:173]
    ds_read_b64_tr_b16 a[220:221], v33 offset:36864
    buffer_load_dwordx4 v68, s[28:31], s62 offen offset:2048 sc1 lds
    v_mfma_f32_16x16x32_bf16 v[178:181], a[228:231], a[60:63], v[178:181]
    ds_read_b64_tr_b16 a[222:223], v33 offset:38912
    s_waitcnt lgkmcnt(8)
    v_mfma_f32_16x16x32_bf16 v[150:153], a[200:203], a[64:67], v[150:153]
    ds_read_b64_tr_b16 a[224:225], v32 offset:36864
    v_mfma_f32_16x16x32_bf16 v[158:161], a[200:203], a[68:71], v[158:161]
    ds_read_b64_tr_b16 a[226:227], v32 offset:38912
    v_mfma_f32_16x16x32_bf16 v[166:169], a[204:207], a[64:67], v[166:169]
    ds_read_b64_tr_b16 a[228:229], v34 offset:36864
    buffer_load_dwordx4 v68, s[28:31], s62 offen offset:3072 sc1 lds
    v_mfma_f32_16x16x32_bf16 v[174:177], a[204:207], a[68:71], v[174:177]
    ds_read_b64_tr_b16 a[230:231], v34 offset:38912
    s_waitcnt lgkmcnt(8)
    v_mfma_f32_16x16x32_bf16 v[154:157], a[208:211], a[64:67], v[154:157]
    s_waitcnt vmcnt(8)
    s_barrier
    s_xor_b32 s37, s37, 1024
    s_load_dword s14, s[28:29], s37
    ds_read_b64_tr_b16 a[200:201], v31 offset:49152
    s_add_u32 m0, s59, 131072
    v_mfma_f32_16x16x32_bf16 v[162:165], a[208:211], a[68:71], v[162:165]
    ds_read_b64_tr_b16 a[202:203], v31 offset:51200
    s_add_u32 s63, s63, 12288
    v_mfma_f32_16x16x32_bf16 v[170:173], a[212:215], a[64:67], v[170:173]
    ds_read_b64_tr_b16 a[204:205], v33 offset:49152
    s_cmp_eq_u32 s63, 86016
    s_cselect_b32 s63, 0, s63
    buffer_load_dwordx4 v80, s[28:31], s63 offen sc1 lds
    v_mfma_f32_16x16x32_bf16 v[178:181], a[212:215], a[68:71], v[178:181]
    ds_read_b64_tr_b16 a[206:207], v33 offset:51200
    s_waitcnt lgkmcnt(8)
    v_mfma_f32_16x16x32_bf16 v[150:153], a[216:219], a[72:75], v[150:153]
    ds_read_b64_tr_b16 a[208:209], v32 offset:49152
    buffer_load_dwordx4 v80, s[28:31], s63 offen offset:1024 sc1 lds
    v_mfma_f32_16x16x32_bf16 v[158:161], a[216:219], a[76:79], v[158:161]
    ds_read_b64_tr_b16 a[210:211], v32 offset:51200
    v_mfma_f32_16x16x32_bf16 v[166:169], a[220:223], a[72:75], v[166:169]
    ds_read_b64_tr_b16 a[212:213], v34 offset:49152
    v_mfma_f32_16x16x32_bf16 v[174:177], a[220:223], a[76:79], v[174:177]
    ds_read_b64_tr_b16 a[214:215], v34 offset:51200
    s_waitcnt lgkmcnt(8)
    v_mfma_f32_16x16x32_bf16 v[154:157], a[224:227], a[72:75], v[154:157]
    ds_read_b64_tr_b16 a[216:217], v31 offset:53248
    buffer_load_dwordx4 v80, s[28:31], s63 offen offset:2048 sc1 lds
    v_mfma_f32_16x16x32_bf16 v[162:165], a[224:227], a[76:79], v[162:165]
    ds_read_b64_tr_b16 a[218:219], v31 offset:55296
    s_add_u32 m0, s100, 159744
    v_mfma_f32_16x16x32_bf16 v[170:173], a[228:231], a[72:75], v[170:173]
    ds_read_b64_tr_b16 a[220:221], v33 offset:53248
    s_add_u32 s62, s62, 262144
    v_mfma_f32_16x16x32_bf16 v[178:181], a[228:231], a[76:79], v[178:181]
    ds_read_b64_tr_b16 a[222:223], v33 offset:55296
    s_waitcnt lgkmcnt(8)
    v_mfma_f32_16x16x32_bf16 v[150:153], a[200:203], a[80:83], v[150:153]
    ds_read_b64_tr_b16 a[224:225], v32 offset:53248
    s_cmp_eq_u32 s62, 1835008
    v_mfma_f32_16x16x32_bf16 v[158:161], a[200:203], a[84:87], v[158:161]
    ds_read_b64_tr_b16 a[226:227], v32 offset:55296
    s_cselect_b32 s62, 0, s62
    buffer_load_dwordx4 v69, s[28:31], s62 offen sc1 lds
    v_mfma_f32_16x16x32_bf16 v[166:169], a[204:207], a[80:83], v[166:169]
    ds_read_b64_tr_b16 a[228:229], v34 offset:53248
    s_add_u32 m0, s58, 143360
    v_mfma_f32_16x16x32_bf16 v[174:177], a[204:207], a[84:87], v[174:177]
    ds_read_b64_tr_b16 a[230:231], v34 offset:55296
    s_waitcnt lgkmcnt(8)
    v_mfma_f32_16x16x32_bf16 v[154:157], a[208:211], a[80:83], v[154:157]
    s_barrier
    ds_read_b64_tr_b16 a[200:201], v37 offset:0
    buffer_load_dwordx4 v67, s[28:31], s62 offen sc1 lds
    v_mfma_f32_16x16x32_bf16 v[162:165], a[208:211], a[84:87], v[162:165]
    ds_read_b64_tr_b16 a[202:203], v37 offset:2048
    v_mfma_f32_16x16x32_bf16 v[170:173], a[212:215], a[80:83], v[170:173]
    ds_read_b64_tr_b16 a[204:205], v38 offset:0
    buffer_load_dwordx4 v67, s[28:31], s62 offen offset:1024 sc1 lds
    v_mfma_f32_16x16x32_bf16 v[178:181], a[212:215], a[84:87], v[178:181]
    ds_read_b64_tr_b16 a[206:207], v38 offset:2048
    s_waitcnt lgkmcnt(8)
    v_mfma_f32_16x16x32_bf16 v[150:153], a[216:219], a[88:91], v[150:153]
    ds_read_b64_tr_b16 a[208:209], v37 offset:4096
    v_mfma_f32_16x16x32_bf16 v[158:161], a[216:219], a[92:95], v[158:161]
    ds_read_b64_tr_b16 a[210:211], v37 offset:6144
    v_mfma_f32_16x16x32_bf16 v[166:169], a[220:223], a[88:91], v[166:169]
    ds_read_b64_tr_b16 a[212:213], v38 offset:4096
    buffer_load_dwordx4 v68, s[28:31], s62 offen offset:2048 sc1 lds
    v_mfma_f32_16x16x32_bf16 v[174:177], a[220:223], a[92:95], v[174:177]
    ds_read_b64_tr_b16 a[214:215], v38 offset:6144
    s_waitcnt lgkmcnt(8)
    v_mfma_f32_16x16x32_bf16 v[154:157], a[224:227], a[88:91], v[154:157]
    ds_read_b64_tr_b16 a[216:217], v37 offset:16384
    v_mfma_f32_16x16x32_bf16 v[162:165], a[224:227], a[92:95], v[162:165]
    ds_read_b64_tr_b16 a[218:219], v37 offset:18432
    buffer_load_dwordx4 v68, s[28:31], s62 offen offset:3072 sc1 lds
    v_mfma_f32_16x16x32_bf16 v[170:173], a[228:231], a[88:91], v[170:173]
    ds_read_b64_tr_b16 a[220:221], v38 offset:16384
    s_add_u32 m0, s59, 0
    v_mfma_f32_16x16x32_bf16 v[178:181], a[228:231], a[92:95], v[178:181]
    ds_read_b64_tr_b16 a[222:223], v38 offset:18432
    s_waitcnt lgkmcnt(8)
    v_mfma_f32_16x16x32_bf16 v[166:169], a[200:203], a[96:99], v[166:169]
    s_waitcnt lgkmcnt(0)
    s_cmp_ge_u32 s14, 2
    s_cbranch_scc0 L_pollin2
L_pollok2:
    v_xor_b32 v23, 131072, v23
    v_xor_b32 v22, 8192, v23
    ds_read_b64_tr_b16 a[224:225], v37 offset:20480
    buffer_load_dwordx4 v[214:217], v23, s[28:31], 0 offen offset:0 sc1
    v_mfma_f32_16x16x32_bf16 v[174:177], a[200:203], a[100:103], v[174:177]
    ds_read_b64_tr_b16 a[226:227], v37 offset:22528
    v_mfma_f32_16x16x32_bf16 v[170:173], a[204:207], a[96:99], v[170:173]
    ds_read_b64_tr_b16 a[228:229], v38 offset:20480
    buffer_load_dwordx4 v[218:221], v23, s[28:31], 0 offen offset:1024 sc1
    v_mfma_f32_16x16x32_bf16 v[178:181], a[204:207], a[100:103], v[178:181]
    ds_read_b64_tr_b16 a[230:231], v38 offset:22528
    v_mfma_f32_16x16x32_bf16 v[166:169], a[208:211], a[104:107], v[166:169]
    ds_read_b64_tr_b16 a[200:201], v35 offset:0
    buffer_load_dwordx4 v[222:225], v22, s[28:31], 0 offen offset:2048 sc1
    v_mfma_f32_16x16x32_bf16 v[174:177], a[208:211], a[108:111], v[174:177]
    ds_read_b64_tr_b16 a[202:203], v35 offset:2048
    v_mfma_f32_16x16x32_bf16 v[170:173], a[212:215], a[104:107], v[170:173]
    ds_read_b64_tr_b16 a[204:205], v36 offset:0
    buffer_load_dwordx4 v[226:229], v22, s[28:31], 0 offen offset:3072 sc1
    v_mfma_f32_16x16x32_bf16 v[178:181], a[212:215], a[108:111], v[178:181]
    ds_read_b64_tr_b16 a[206:207], v36 offset:2048
    v_mfma_f32_16x16x32_bf16 v[166:169], a[216:219], a[112:115], v[166:169]
    ds_read_b64_tr_b16 a[208:209], v35 offset:4096
    s_add_u32 s63, s63, 12288
    v_mfma_f32_16x16x32_bf16 v[174:177], a[216:219], a[116:119], v[174:177]
    ds_read_b64_tr_b16 a[210:211], v35 offset:6144
    s_cmp_eq_u32 s63, 86016
    s_cselect_b32 s63, 0, s63
    buffer_load_dwordx4 v80, s[28:31], s63 offen sc1 lds
    v_mfma_f32_16x16x32_bf16 v[170:173], a[220:223], a[112:115], v[170:173]
    ds_read_b64_tr_b16 a[212:213], v36 offset:4096
    v_mfma_f32_16x16x32_bf16 v[178:181], a[220:223], a[116:119], v[178:181]
    ds_read_b64_tr_b16 a[214:215], v36 offset:6144
    s_waitcnt lgkmcnt(8)
    v_mfma_f32_16x16x32_bf16 v[166:169], a[224:227], a[120:123], v[166:169]
    ds_read_b64_tr_b16 a[216:217], v35 offset:16384
    buffer_load_dwordx4 v80, s[28:31], s63 offen offset:1024 sc1 lds
    v_mfma_f32_16x16x32_bf16 v[174:177], a[224:227], a[124:127], v[174:177]
    ds_read_b64_tr_b16 a[218:219], v35 offset:18432
    v_mfma_f32_16x16x32_bf16 v[170:173], a[228:231], a[120:123], v[170:173]
    ds_read_b64_tr_b16 a[220:221], v36 offset:16384
    v_mfma_f32_16x16x32_bf16 v[178:181], a[228:231], a[124:127], v[178:181]
    ds_read_b64_tr_b16 a[222:223], v36 offset:18432
    s_waitcnt lgkmcnt(8)
    v_mfma_f32_16x16x32_bf16 v[150:153], a[200:203], a[96:99], v[150:153]
    ds_read_b64_tr_b16 a[224:225], v35 offset:20480
    buffer_load_dwordx4 v80, s[28:31], s63 offen offset:2048 sc1 lds
    v_mfma_f32_16x16x32_bf16 v[158:161], a[200:203], a[100:103], v[158:161]
    ds_read_b64_tr_b16 a[226:227], v35 offset:22528
    s_add_u32 m0, s100, 28672
    v_mfma_f32_16x16x32_bf16 v[154:157], a[204:207], a[96:99], v[154:157]
    ds_read_b64_tr_b16 a[228:229], v36 offset:20480
    s_add_u32 s62, s62, 262144
    v_mfma_f32_16x16x32_bf16 v[162:165], a[204:207], a[100:103], v[162:165]
    ds_read_b64_tr_b16 a[230:231], v36 offset:22528
    ds_write_b128 v81, v[166:169] offset:32768
    s_waitcnt lgkmcnt(9)
    v_mfma_f32_16x16x32_bf16 v[150:153], a[208:211], a[104:107], v[150:153]
    s_cmp_eq_u32 s62, 1835008
    s_cselect_b32 s62, 0, s62
    buffer_load_dwordx4 v69, s[28:31], s62 offen sc1 lds
    v_mfma_f32_16x16x32_bf16 v[158:161], a[208:211], a[108:111], v[158:161]
    s_add_u32 m0, s58, 12288
    ds_write_b128 v81, v[170:173] offset:33792
    v_mfma_f32_16x16x32_bf16 v[154:157], a[212:215], a[104:107], v[154:157]
    buffer_load_dwordx4 v67, s[28:31], s62 offen sc1 lds
    ds_write_b128 v81, v[174:177] offset:34816
    v_mfma_f32_16x16x32_bf16 v[162:165], a[212:215], a[108:111], v[162:165]
    s_waitcnt lgkmcnt(7)
    v_mfma_f32_16x16x32_bf16 v[150:153], a[216:219], a[112:115], v[150:153]
    ds_write_b128 v81, v[178:181] offset:35840
    v_mfma_f32_16x16x32_bf16 v[158:161], a[216:219], a[116:119], v[158:161]
    v_mfma_f32_16x16x32_bf16 v[154:157], a[220:223], a[112:115], v[154:157]
    buffer_load_dwordx4 v67, s[28:31], s62 offen offset:1024 sc1 lds
    v_mfma_f32_16x16x32_bf16 v[162:165], a[220:223], a[116:119], v[162:165]
    s_waitcnt lgkmcnt(4)
    v_mfma_f32_16x16x32_bf16 v[150:153], a[224:227], a[120:123], v[150:153]
    v_mfma_f32_16x16x32_bf16 v[158:161], a[224:227], a[124:127], v[158:161]
    buffer_load_dwordx4 v68, s[28:31], s62 offen offset:2048 sc1 lds
    v_mfma_f32_16x16x32_bf16 v[154:157], a[228:231], a[120:123], v[154:157]
    v_mfma_f32_16x16x32_bf16 v[162:165], a[228:231], a[124:127], v[162:165]
    s_waitcnt vmcnt(10)
    v_mfma_f32_16x16x32_bf16 v[150:153], a[250:253], v[214:217], v[150:153]
    v_xor_b32 v81, 8192, v81
    s_waitcnt lgkmcnt(0)
    s_barrier
    ds_read_b128 v[182:185], v81 offset:32768
    ds_read_b128 v[186:189], v81 offset:33792
    ds_read_b128 v[190:193], v81 offset:34816
    ds_read_b128 v[194:197], v81 offset:35840
    v_mfma_f32_16x16x32_bf16 v[154:157], a[248:251], v[214:217], v[154:157]
    buffer_load_dwordx4 v68, s[28:31], s62 offen offset:3072 sc1 lds
    s_add_u32 m0, s59, 65536
    s_waitcnt vmcnt(10)
    v_mfma_f32_16x16x32_bf16 v[158:161], a[250:253], v[218:221], v[158:161]
    s_add_u32 s63, s63, 12288
    s_cmp_eq_u32 s63, 86016
L_pad1:
    s_cbranch_execz L_warm
    v_mfma_f32_16x16x32_bf16 v[162:165], a[248:251], v[218:221], v[162:165]
    s_cselect_b32 s63, 0, s63
    s_waitcnt vmcnt(9)
    v_mfma_f32_16x16x32_bf16 v[150:153], a[250:253], v[222:225], v[150:153]
    buffer_load_dwordx4 v80, s[28:31], s63 offen sc1 lds
    v_mfma_f32_16x16x32_bf16 v[154:157], a[248:251], v[222:225], v[154:157]
    s_waitcnt vmcnt(9)
    v_mfma_f32_16x16x32_bf16 v[158:161], a[250:253], v[226:229], v[158:161]
    v_mfma_f32_16x16x32_bf16 v[162:165], a[248:251], v[226:229], v[162:165]
    buffer_load_dwordx4 v80, s[28:31], s63 offen offset:1024 sc1 lds
    s_waitcnt lgkmcnt(3)
    s_nop 0
    v_pk_add_f32 v[150:151], v[150:151], v[182:183]
    v_pk_add_f32 v[152:153], v[152:153], v[184:185]
    s_waitcnt lgkmcnt(2)
    v_pk_add_f32 v[154:155], v[154:155], v[186:187]
    v_pk_add_f32 v[156:157], v[156:157], v[188:189]
    v_pk_mul_f32 v[182:183], v[150:151], v[150:151]
    v_pk_mul_f32 v[184:185], v[152:153], v[152:153]
    v_pk_mul_f32 v[186:187], v[154:155], v[154:155]
    v_pk_mul_f32 v[188:189], v[156:157], v[156:157]
    v_pk_fma_f32 v[182:183], v[182:183], s[78:79], v[108:109]
    v_pk_fma_f32 v[184:185], v[184:185], s[78:79], v[108:109]
    v_pk_fma_f32 v[186:187], v[186:187], s[78:79], v[108:109]
    v_pk_fma_f32 v[188:189], v[188:189], s[78:79], v[108:109]
    v_pk_mul_f32 v[182:183], v[182:183], v[150:151]
    buffer_load_dwordx4 v80, s[28:31], s63 offen offset:2048 sc1 lds
    v_pk_mul_f32 v[184:185], v[184:185], v[152:153]
    v_pk_mul_f32 v[186:187], v[186:187], v[154:155]
    v_pk_mul_f32 v[188:189], v[188:189], v[156:157]
    v_exp_f32 v182, v182
    v_exp_f32 v183, v183
    v_exp_f32 v184, v184
    v_exp_f32 v185, v185
    v_exp_f32 v186, v186
    v_exp_f32 v187, v187
    s_add_u32 m0, s100, 94208
    s_add_u32 s62, s62, 262144
    s_cmp_eq_u32 s62, 1835008
    s_cselect_b32 s62, 0, s62
    buffer_load_dwordx4 v69, s[28:31], s62 offen sc1 lds
    v_exp_f32 v188, v188
    v_exp_f32 v189, v189
    v_pk_add_f32 v[182:183], v[182:183], s[80:81]
    v_pk_add_f32 v[184:185], v[184:185], s[80:81]
    v_pk_add_f32 v[186:187], v[186:187], s[80:81]
    v_pk_add_f32 v[188:189], v[188:189], s[80:81]
    v_rcp_f32 v182, v182
    v_rcp_f32 v183, v183
    v_rcp_f32 v184, v184
    s_add_u32 m0, s58, 77824
    s_nop 0
    buffer_load_dwordx4 v67, s[28:31], s62 offen sc1 lds
    v_rcp_f32 v185, v185
    v_rcp_f32 v186, v186
    v_rcp_f32 v187, v187
    v_rcp_f32 v188, v188
    v_rcp_f32 v189, v189
    v_pk_mul_f32 v[182:183], v[182:183], v[150:151]
    v_pk_mul_f32 v[184:185], v[184:185], v[152:153]
    v_pk_mul_f32 v[186:187], v[186:187], v[154:155]
    buffer_load_dwordx4 v67, s[28:31], s62 offen offset:1024 sc1 lds
    v_pk_mul_f32 v[188:189], v[188:189], v[156:157]
    v_cvt_pk_bf16_f32 v110, v182, v183
    v_cvt_pk_bf16_f32 v111, v184, v185
    v_cvt_pk_bf16_f32 v112, v186, v187
    v_cvt_pk_bf16_f32 v113, v188, v189
    s_waitcnt lgkmcnt(1)
    v_pk_add_f32 v[158:159], v[158:159], v[190:191]
    v_pk_add_f32 v[160:161], v[160:161], v[192:193]
    s_waitcnt lgkmcnt(0)
    v_pk_add_f32 v[162:163], v[162:163], v[194:195]
    v_pk_add_f32 v[164:165], v[164:165], v[196:197]
    v_pk_mul_f32 v[190:191], v[158:159], v[158:159]
    v_pk_mul_f32 v[192:193], v[160:161], v[160:161]
    v_pk_mul_f32 v[194:195], v[162:163], v[162:163]
    v_pk_mul_f32 v[196:197], v[164:165], v[164:165]
    v_pk_fma_f32 v[190:191], v[190:191], s[78:79], v[108:109]
    buffer_load_dwordx4 v68, s[28:31], s62 offen offset:2048 sc1 lds
    v_pk_fma_f32 v[192:193], v[192:193], s[78:79], v[108:109]
    v_pk_fma_f32 v[194:195], v[194:195], s[78:79], v[108:109]
    v_pk_fma_f32 v[196:197], v[196:197], s[78:79], v[108:109]
    v_pk_mul_f32 v[190:191], v[190:191], v[158:159]
    v_pk_mul_f32 v[192:193], v[192:193], v[160:161]
    v_pk_mul_f32 v[194:195], v[194:195], v[162:163]
    v_pk_mul_f32 v[196:197], v[196:197], v[164:165]
    v_exp_f32 v190, v190
    v_exp_f32 v191, v191
    v_exp_f32 v192, v192
    v_exp_f32 v193, v193
    buffer_load_dwordx4 v68, s[28:31], s62 offen offset:3072 sc1 lds
    v_exp_f32 v194, v194
    v_exp_f32 v195, v195
    v_exp_f32 v196, v196
    v_exp_f32 v197, v197
    v_pk_add_f32 v[190:191], v[190:191], s[80:81]
    v_pk_add_f32 v[192:193], v[192:193], s[80:81]
    v_pk_add_f32 v[194:195], v[194:195], s[80:81]
    v_pk_add_f32 v[196:197], v[196:197], s[80:81]
    v_rcp_f32 v190, v190
    v_rcp_f32 v191, v191
    v_rcp_f32 v192, v192
    v_rcp_f32 v193, v193
    v_rcp_f32 v194, v194
    v_rcp_f32 v195, v195
    v_rcp_f32 v196, v196
    v_rcp_f32 v197, v197
    v_pk_mul_f32 v[190:191], v[190:191], v[158:159]
    v_pk_mul_f32 v[192:193], v[192:193], v[160:161]
    v_pk_mul_f32 v[194:195], v[194:195], v[162:163]
    v_pk_mul_f32 v[196:197], v[196:197], v[164:165]
    v_cvt_pk_bf16_f32 v114, v190, v191
    v_cvt_pk_bf16_f32 v115, v192, v193
    v_cvt_pk_bf16_f32 v116, v194, v195
    v_cvt_pk_bf16_f32 v117, v196, v197
    ds_read_b64_tr_b16 a[180:181], v72 offset:32768
    ds_read_b64_tr_b16 a[182:183], v72 offset:33024
    ds_read_b128 a[128:131], v53 offset:32768
    ds_read_b64_tr_b16 a[184:185], v72 offset:33792
    ds_read_b64_tr_b16 a[186:187], v72 offset:34048
    ds_read_b128 a[132:135], v53 offset:33792
    ds_read_b128 a[136:139], v53 offset:34816
    ds_read_b64_tr_b16 a[176:177], v73 offset:32768
    ds_read_b64_tr_b16 a[178:179], v73 offset:33024
    ds_read_b128 a[140:143], v53 offset:35840
    ds_read_b128 a[144:147], v53 offset:36864
    ds_read_b128 a[148:151], v53 offset:37888
    buffer_store_dwordx4 v[110:113], v4, s[28:31], s67 offen offset:0 sc1
    buffer_store_dwordx4 v[114:117], v4, s[28:31], s67 offen offset:1024 sc1
L_q:
    s_waitcnt lgkmcnt(6)
    v_mfma_f32_16x16x32_bf16 v[182:185], a[128:131], a[180:183], 0
    ds_read_b64_tr_b16 a[192:193], v72 offset:34816
    v_mfma_f32_16x16x32_bf16 v[190:193], a[128:131], a[184:187], 0
    ds_read_b64_tr_b16 a[194:195], v72 offset:35072
    v_mfma_f32_16x16x32_bf16 v[186:189], a[132:135], a[180:183], 0
    ds_read_b128 a[152:155], v53 offset:38912
    v_mfma_f32_16x16x32_bf16 v[194:197], a[132:135], a[184:187], 0
    ds_read_b64_tr_b16 a[196:197], v72 offset:35840
    s_waitcnt lgkmcnt(4)
    v_mfma_f32_16x16x32_bf16 v[206:209], a[136:139], a[180:183], 0
    ds_read_b64_tr_b16 a[198:199], v72 offset:36096
    v_mfma_f32_16x16x32_bf16 v[214:217], a[136:139], a[184:187], 0
    ds_read_b128 a[156:159], v53 offset:39936
    v_mfma_f32_16x16x32_bf16 v[198:201], a[136:139], a[176:179], 0
    ds_read_b128 a[160:163], v53 offset:40960
    v_mfma_f32_16x16x32_bf16 v[210:213], a[140:143], a[180:183], 0
    ds_read_b64_tr_b16 a[188:189], v73 offset:34816
    v_mfma_f32_16x16x32_bf16 v[218:221], a[140:143], a[184:187], 0
    ds_read_b64_tr_b16 a[190:191], v73 offset:35072
    v_mfma_f32_16x16x32_bf16 v[202:205], a[140:143], a[176:179], 0
    ds_read_b128 a[164:167], v53 offset:41984
    v_mfma_f32_16x16x32_bf16 v[230:233], a[180:183], a[144:147], 0
    ds_read_b128 a[168:171], v53 offset:43008
    v_mfma_f32_16x16x32_bf16 v[238:241], a[184:187], a[144:147], 0
    ds_read_b128 a[172:175], v53 offset:44032
    v_mfma_f32_16x16x32_bf16 v[222:225], a[176:179], a[144:147], 0
    v_mfma_f32_16x16x32_bf16 v[234:237], a[180:183], a[148:151], 0
    v_mfma_f32_16x16x32_bf16 v[242:245], a[184:187], a[148:151], 0
    v_mfma_f32_16x16x32_bf16 v[226:229], a[176:179], a[148:151], 0
    s_waitcnt lgkmcnt(0)
    s_barrier
    v_mfma_f32_16x16x32_bf16 v[182:185], a[152:155], a[192:195], v[182:185]
    ds_read_b64_tr_b16 a[180:181], v74 offset:0
    s_add_u32 m0, s59, 32768
    v_mfma_f32_16x16x32_bf16 v[190:193], a[152:155], a[196:199], v[190:193]
    ds_read_b64_tr_b16 a[182:183], v74 offset:256
    s_add_u32 s63, s63, 12288
    v_mfma_f32_16x16x32_bf16 v[186:189], a[156:159], a[192:195], v[186:189]
    ds_read_b128 a[128:131], v54 offset:0
    s_cmp_eq_u32 s63, 86016
    v_mfma_f32_16x16x32_bf16 v[194:197], a[156:159], a[196:199], v[194:197]
    ds_read_b64_tr_b16 a[184:185], v74 offset:1024
    v_mfma_f32_16x16x32_bf16 v[206:209], a[160:163], a[192:195], v[206:209]
    ds_read_b64_tr_b16 a[186:187], v74 offset:1280
    s_cselect_b32 s63, 0, s63
    v_mfma_f32_16x16x32_bf16 v[214:217], a[160:163], a[196:199], v[214:217]
    ds_read_b128 a[132:135], v54 offset:1024
    buffer_load_dwordx4 v80, s[28:31], s63 offen sc1 lds
    v_mfma_f32_16x16x32_bf16 v[198:201], a[160:163], a[188:191], v[198:201]
    ds_read_b128 a[136:139], v54 offset:2048
    v_mfma_f32_16x16x32_bf16 v[210:213], a[164:167], a[192:195], v[210:213]
    ds_read_b64_tr_b16 a[176:177], v75 offset:0
    buffer_load_dwordx4 v80, s[28:31], s63 offen offset:1024 sc1 lds
    v_mfma_f32_16x16x32_bf16 v[218:221], a[164:167], a[196:199], v[218:221]
    ds_read_b64_tr_b16 a[178:179], v75 offset:256
    v_mfma_f32_16x16x32_bf16 v[202:205], a[164:167], a[188:191], v[202:205]
    ds_read_b128 a[140:143], v54 offset:3072
    v_mfma_f32_16x16x32_bf16 v[230:233], a[192:195], a[168:171], v[230:233]
    ds_read_b128 a[144:147], v54 offset:4096
    buffer_load_dwordx4 v80, s[28:31], s63 offen offset:2048 sc1 lds
    v_mfma_f32_16x16x32_bf16 v[238:241], a[196:199], a[168:171], v[238:241]
    ds_read_b128 a[148:151], v54 offset:5120
    s_add_u32 m0, s100, 61440
    v_mfma_f32_16x16x32_bf16 v[222:225], a[188:191], a[168:171], v[222:225]
    s_add_u32 s62, s62, 262144
    s_cmp_eq_u32 s62, 1835008
    v_mfma_f32_16x16x32_bf16 v[234:237], a[192:195], a[172:175], v[234:237]
    s_cselect_b32 s62, 0, s62
    buffer_load_dwordx4 v69, s[28:31], s62 offen sc1 lds
    v_mfma_f32_16x16x32_bf16 v[242:245], a[196:199], a[172:175], v[242:245]
    s_add_u32 m0, s58, 45056
    v_mfma_f32_16x16x32_bf16 v[226:229], a[188:191], a[172:175], v[226:229]
    s_waitcnt lgkmcnt(6)
    v_mfma_f32_16x16x32_bf16 v[182:185], a[128:131], a[180:183], v[182:185]
    ds_read_b64_tr_b16 a[192:193], v74 offset:2048
    buffer_load_dwordx4 v67, s[28:31], s62 offen sc1 lds
    v_mfma_f32_16x16x32_bf16 v[190:193], a[128:131], a[184:187], v[190:193]
    ds_read_b64_tr_b16 a[194:195], v74 offset:2304
    v_mfma_f32_16x16x32_bf16 v[186:189], a[132:135], a[180:183], v[186:189]
    ds_read_b128 a[152:155], v54 offset:6144
    v_mfma_f32_16x16x32_bf16 v[194:197], a[132:135], a[184:187], v[194:197]
    ds_read_b64_tr_b16 a[196:197], v74 offset:3072
    s_waitcnt lgkmcnt(4)
    v_mfma_f32_16x16x32_bf16 v[206:209], a[136:139], a[180:183], v[206:209]
    ds_read_b64_tr_b16 a[198:199], v74 offset:3328
    buffer_load_dwordx4 v67, s[28:31], s62 offen offset:1024 sc1 lds
    v_mfma_f32_16x16x32_bf16 v[214:217], a[136:139], a[184:187], v[214:217]
    ds_read_b128 a[156:159], v54 offset:7168
    v_mfma_f32_16x16x32_bf16 v[198:201], a[136:139], a[176:179], v[198:201]
    ds_read_b128 a[160:163], v54 offset:8192
    buffer_load_dwordx4 v68, s[28:31], s62 offen offset:2048 sc1 lds
    v_mfma_f32_16x16x32_bf16 v[210:213], a[140:143], a[180:183], v[210:213]
    ds_read_b64_tr_b16 a[188:189], v75 offset:2048
    v_mfma_f32_16x16x32_bf16 v[218:221], a[140:143], a[184:187], v[218:221]
    ds_read_b64_tr_b16 a[190:191], v75 offset:2304
    v_mfma_f32_16x16x32_bf16 v[202:205], a[140:143], a[176:179], v[202:205]
    ds_read_b128 a[164:167], v54 offset:9216
    buffer_load_dwordx4 v68, s[28:31], s62 offen offset:3072 sc1 lds
    v_mfma_f32_16x16x32_bf16 v[230:233], a[180:183], a[144:147], v[230:233]
    ds_read_b128 a[168:171], v54 offset:10240
    s_add_u32 m0, s59, 98304
    v_mfma_f32_16x16x32_bf16 v[238:241], a[184:187], a[144:147], v[238:241]
    ds_read_b128 a[172:175], v54 offset:11264
    s_add_u32 s63, s63, 12288
    v_mfma_f32_16x16x32_bf16 v[222:225], a[176:179], a[144:147], v[222:225]
    s_cmp_eq_u32 s63, 86016
    s_cselect_b32 s63, 0, s63
    v_mfma_f32_16x16x32_bf16 v[234:237], a[180:183], a[148:151], v[234:237]
    buffer_load_dwordx4 v80, s[28:31], s63 offen sc1 lds
    v_mfma_f32_16x16x32_bf16 v[242:245], a[184:187], a[148:151], v[242:245]
    v_mfma_f32_16x16x32_bf16 v[226:229], a[176:179], a[148:151], v[226:229]
    s_waitcnt vmcnt(9) lgkmcnt(0)
    s_barrier
    s_cmp_lg_u32 s48, 0
    s_cbranch_scc1 L_sig2
    s_atomic_add s36, s[28:29], s68
L_sig2:
    v_mfma_f32_16x16x32_bf16 v[182:185], a[152:155], a[192:195], v[182:185]
    ds_read_b64_tr_b16 a[180:181], v70 offset:0
    buffer_load_dwordx4 v80, s[28:31], s63 offen offset:1024 sc1 lds
    v_mfma_f32_16x16x32_bf16 v[190:193], a[152:155], a[196:199], v[190:193]
    ds_read_b64_tr_b16 a[182:183], v70 offset:256
    v_mfma_f32_16x16x32_bf16 v[186:189], a[156:159], a[192:195], v[186:189]
    ds_read_b128 a[128:131], v4 offset:0
    buffer_load_dwordx4 v80, s[28:31], s63 offen offset:2048 sc1 lds
    v_mfma_f32_16x16x32_bf16 v[194:197], a[156:159], a[196:199], v[194:197]
    ds_read_b64_tr_b16 a[184:185], v70 offset:1024
    v_mfma_f32_16x16x32_bf16 v[206:209], a[160:163], a[192:195], v[206:209]
    ds_read_b64_tr_b16 a[186:187], v70 offset:1280
    s_add_u32 m0, s100, 126976
    v_mfma_f32_16x16x32_bf16 v[214:217], a[160:163], a[196:199], v[214:217]
    ds_read_b128 a[132:135], v4 offset:1024
    s_add_u32 s62, s62, 262144
    v_mfma_f32_16x16x32_bf16 v[198:201], a[160:163], a[188:191], v[198:201]
    ds_read_b128 a[136:139], v4 offset:2048
    s_cmp_eq_u32 s62, 1835008
    v_mfma_f32_16x16x32_bf16 v[210:213], a[164:167], a[192:195], v[210:213]
    ds_read_b64_tr_b16 a[176:177], v71 offset:0
    s_cselect_b32 s62, 0, s62
    v_mfma_f32_16x16x32_bf16 v[218:221], a[164:167], a[196:199], v[218:221]
    ds_read_b64_tr_b16 a[178:179], v71 offset:256
    buffer_load_dwordx4 v69, s[28:31], s62 offen sc1 lds
    v_mfma_f32_16x16x32_bf16 v[202:205], a[164:167], a[188:191], v[202:205]
    ds_read_b128 a[140:143], v4 offset:3072
    s_add_u32 m0, s58, 110592
    v_mfma_f32_16x16x32_bf16 v[230:233], a[192:195], a[168:171], v[230:233]
    ds_read_b128 a[144:147], v4 offset:4096
    buffer_load_dwordx4 v67, s[28:31], s62 offen sc1 lds
    v_mfma_f32_16x16x32_bf16 v[238:241], a[196:199], a[168:171], v[238:241]
    ds_read_b128 a[148:151], v4 offset:5120
    v_mfma_f32_16x16x32_bf16 v[222:225], a[188:191], a[168:171], v[222:225]
    v_mfma_f32_16x16x32_bf16 v[234:237], a[192:195], a[172:175], v[234:237]
    buffer_load_dwordx4 v67, s[28:31], s62 offen offset:1024 sc1 lds
    v_mfma_f32_16x16x32_bf16 v[242:245], a[196:199], a[172:175], v[242:245]
    v_mfma_f32_16x16x32_bf16 v[226:229], a[188:191], a[172:175], v[226:229]
    s_waitcnt lgkmcnt(6)
    v_mfma_f32_16x16x32_bf16 v[182:185], a[128:131], a[180:183], v[182:185]
    ds_read_b64_tr_b16 a[192:193], v70 offset:2048
    buffer_load_dwordx4 v68, s[28:31], s62 offen offset:2048 sc1 lds
    v_mfma_f32_16x16x32_bf16 v[190:193], a[128:131], a[184:187], v[190:193]
    ds_read_b64_tr_b16 a[194:195], v70 offset:2304
    v_mfma_f32_16x16x32_bf16 v[186:189], a[132:135], a[180:183], v[186:189]
    ds_read_b128 a[152:155], v4 offset:6144
    v_mfma_f32_16x16x32_bf16 v[194:197], a[132:135], a[184:187], v[194:197]
    ds_read_b64_tr_b16 a[196:197], v70 offset:3072
    s_waitcnt lgkmcnt(4)
    v_mfma_f32_16x16x32_bf16 v[206:209], a[136:139], a[180:183], v[206:209]
    ds_read_b64_tr_b16 a[198:199], v70 offset:3328
    buffer_load_dwordx4 v68, s[28:31], s62 offen offset:3072 sc1 lds
    v_mfma_f32_16x16x32_bf16 v[214:217], a[136:139], a[184:187], v[214:217]
    ds_read_b128 a[156:159], v4 offset:7168
    s_add_u32 m0, s59, 131072
    v_mfma_f32_16x16x32_bf16 v[198:201], a[136:139], a[176:179], v[198:201]
    ds_read_b128 a[160:163], v4 offset:8192
    s_add_u32 s63, s63, 12288
    v_mfma_f32_16x16x32_bf16 v[210:213], a[140:143], a[180:183], v[210:213]
    ds_read_b64_tr_b16 a[188:189], v71 offset:2048
    s_cmp_eq_u32 s63, 86016
    v_mfma_f32_16x16x32_bf16 v[218:221], a[140:143], a[184:187], v[218:221]
    ds_read_b64_tr_b16 a[190:191], v71 offset:2304
    s_cselect_b32 s63, 0, s63
    v_mfma_f32_16x16x32_bf16 v[202:205], a[140:143], a[176:179], v[202:205]
    ds_read_b128 a[164:167], v4 offset:9216
    buffer_load_dwordx4 v80, s[28:31], s63 offen sc1 lds
    v_mfma_f32_16x16x32_bf16 v[230:233], a[180:183], a[144:147], v[230:233]
    ds_read_b128 a[168:171], v4 offset:10240
    v_mfma_f32_16x16x32_bf16 v[238:241], a[184:187], a[144:147], v[238:241]
    ds_read_b128 a[172:175], v4 offset:11264
    buffer_load_dwordx4 v80, s[28:31], s63 offen offset:1024 sc1 lds
    v_mfma_f32_16x16x32_bf16 v[222:225], a[176:179], a[144:147], v[222:225]
    v_mfma_f32_16x16x32_bf16 v[234:237], a[180:183], a[148:151], v[234:237]
    v_mfma_f32_16x16x32_bf16 v[242:245], a[184:187], a[148:151], v[242:245]
    buffer_load_dwordx4 v80, s[28:31], s63 offen offset:2048 sc1 lds
    s_add_u32 m0, s100, 159744
    v_mfma_f32_16x16x32_bf16 v[226:229], a[176:179], a[148:151], v[226:229]
    s_add_u32 s62, s62, 262144
    ds_read_b32 v24, v4
    s_waitcnt lgkmcnt(1)
    s_barrier
    v_mfma_f32_16x16x32_bf16 v[182:185], a[152:155], a[192:195], v[182:185]
    ds_read_b64_tr_b16 a[180:181], v72 offset:0
    s_cmp_eq_u32 s62, 1835008
    v_mfma_f32_16x16x32_bf16 v[190:193], a[152:155], a[196:199], v[190:193]
    ds_read_b64_tr_b16 a[182:183], v72 offset:256
    s_cselect_b32 s62, 0, s62
    v_mfma_f32_16x16x32_bf16 v[186:189], a[156:159], a[192:195], v[186:189]
    ds_read_b128 a[128:131], v53 offset:0
    buffer_load_dwordx4 v69, s[28:31], s62 offen sc1 lds
    v_mfma_f32_16x16x32_bf16 v[194:197], a[156:159], a[196:199], v[194:197]
    ds_read_b64_tr_b16 a[184:185], v72 offset:1024
    v_mfma_f32_16x16x32_bf16 v[206:209], a[160:163], a[192:195], v[206:209]
    ds_read_b64_tr_b16 a[186:187], v72 offset:1280
    s_add_u32 m0, s58, 143360
    v_mfma_f32_16x16x32_bf16 v[214:217], a[160:163], a[196:199], v[214:217]
    ds_read_b128 a[132:135], v53 offset:1024
    buffer_load_dwordx4 v67, s[28:31], s62 offen sc1 lds
    v_mfma_f32_16x16x32_bf16 v[198:201], a[160:163], a[188:191], v[198:201]
    ds_read_b128 a[136:139], v53 offset:2048
    v_mfma_f32_16x16x32_bf16 v[210:213], a[164:167], a[192:195], v[210:213]
    ds_read_b64_tr_b16 a[176:177], v73 offset:0
    buffer_load_dwordx4 v67, s[28:31], s62 offen offset:1024 sc1 lds
    v_mfma_f32_16x16x32_bf16 v[218:221], a[164:167], a[196:199], v[218:221]
    ds_read_b64_tr_b16 a[178:179], v73 offset:256
    v_mfma_f32_16x16x32_bf16 v[202:205], a[164:167], a[188:191], v[202:205]
    ds_read_b128 a[140:143], v53 offset:3072
    v_mfma_f32_16x16x32_bf16 v[230:233], a[192:195], a[168:171], v[230:233]
    ds_read_b128 a[144:147], v53 offset:4096
    buffer_load_dwordx4 v68, s[28:31], s62 offen offset:2048 sc1 lds
    v_mfma_f32_16x16x32_bf16 v[238:241], a[196:199], a[168:171], v[238:241]
    ds_read_b128 a[148:151], v53 offset:5120
    v_mfma_f32_16x16x32_bf16 v[222:225], a[188:191], a[168:171], v[222:225]
    v_mfma_f32_16x16x32_bf16 v[234:237], a[192:195], a[172:175], v[234:237]
    buffer_load_dwordx4 v68, s[28:31], s62 offen offset:3072 sc1 lds
    s_add_u32 m0, s58, 0
    v_mfma_f32_16x16x32_bf16 v[242:245], a[196:199], a[172:175], v[242:245]
    v_mfma_f32_16x16x32_bf16 v[226:229], a[188:191], a[172:175], v[226:229]
    s_waitcnt lgkmcnt(6)
    v_mfma_f32_16x16x32_bf16 v[182:185], a[128:131], a[180:183], v[182:185]
    ds_read_b64_tr_b16 a[192:193], v72 offset:2048
    buffer_load_dwordx4 v59, s[24:27], s64 offen lds
    v_mfma_f32_16x16x32_bf16 v[190:193], a[128:131], a[184:187], v[190:193]
    ds_read_b64_tr_b16 a[194:195], v72 offset:2304
    v_mfma_f32_16x16x32_bf16 v[186:189], a[132:135], a[180:183], v[186:189]
    ds_read_b128 a[152:155], v53 offset:6144
    v_mfma_f32_16x16x32_bf16 v[194:197], a[132:135], a[184:187], v[194:197]
    ds_read_b64_tr_b16 a[196:197], v72 offset:3072
    s_waitcnt lgkmcnt(4)
    v_mfma_f32_16x16x32_bf16 v[206:209], a[136:139], a[180:183], v[206:209]
    ds_read_b64_tr_b16 a[198:199], v72 offset:3328
    buffer_load_dwordx4 v60, s[24:27], s64 offen offset:1024 lds
    v_mfma_f32_16x16x32_bf16 v[214:217], a[136:139], a[184:187], v[214:217]
    ds_read_b128 a[156:159], v53 offset:7168
    v_mfma_f32_16x16x32_bf16 v[198:201], a[136:139], a[176:179], v[198:201]
    ds_read_b128 a[160:163], v53 offset:8192
    v_mfma_f32_16x16x32_bf16 v[210:213], a[140:143], a[180:183], v[210:213]
    ds_read_b64_tr_b16 a[188:189], v73 offset:2048
    buffer_load_dwordx4 v61, s[24:27], s64 offen offset:2048 lds
    v_mfma_f32_16x16x32_bf16 v[218:221], a[140:143], a[184:187], v[218:221]
    ds_read_b64_tr_b16 a[190:191], v73 offset:2304
    v_mfma_f32_16x16x32_bf16 v[202:205], a[140:143], a[176:179], v[202:205]
    ds_read_b128 a[164:167], v53 offset:9216
    v_mfma_f32_16x16x32_bf16 v[230:233], a[180:183], a[144:147], v[230:233]
    ds_read_b128 a[168:171], v53 offset:10240
    buffer_load_dwordx4 v62, s[24:27], s64 offen offset:3072 lds
    v_mfma_f32_16x16x32_bf16 v[238:241], a[184:187], a[144:147], v[238:241]
    ds_read_b128 a[172:175], v53 offset:11264
    s_add_u32 m0, s58, 16384
    v_mfma_f32_16x16x32_bf16 v[222:225], a[176:179], a[144:147], v[222:225]
    v_xor_b32 v59, 128, v59
    v_mfma_f32_16x16x32_bf16 v[234:237], a[180:183], a[148:151], v[234:237]
    buffer_load_dwordx4 v59, s[24:27], s64 offen lds
    v_xor_b32 v60, 128, v60
    v_mfma_f32_16x16x32_bf16 v[242:245], a[184:187], a[148:151], v[242:245]
    v_mfma_f32_16x16x32_bf16 v[226:229], a[176:179], a[148:151], v[226:229]
    ds_read_b32 v24, v4
    s_waitcnt vmcnt(21) lgkmcnt(1)
    s_barrier
    v_mfma_f32_16x16x32_bf16 v[182:185], a[152:155], a[192:195], v[182:185]
    ds_read_b64_tr_b16 a[180:181], v70 offset:32768
    buffer_load_dwordx4 v60, s[24:27], s64 offen offset:1024 lds
    v_mfma_f32_16x16x32_bf16 v[190:193], a[152:155], a[196:199], v[190:193]
    ds_read_b64_tr_b16 a[182:183], v70 offset:33024
    v_xor_b32 v61, 128, v61
    v_mfma_f32_16x16x32_bf16 v[186:189], a[156:159], a[192:195], v[186:189]
    ds_read_b128 a[128:131], v4 offset:32768
    v_mfma_f32_16x16x32_bf16 v[194:197], a[156:159], a[196:199], v[194:197]
    ds_read_b64_tr_b16 a[184:185], v70 offset:33792
    v_mfma_f32_16x16x32_bf16 v[206:209], a[160:163], a[192:195], v[206:209]
    ds_read_b64_tr_b16 a[186:187], v70 offset:34048
    buffer_load_dwordx4 v61, s[24:27], s64 offen offset:2048 lds
    v_mfma_f32_16x16x32_bf16 v[214:217], a[160:163], a[196:199], v[214:217]
    ds_read_b128 a[132:135], v4 offset:33792
    v_xor_b32 v62, 128, v62
    v_mfma_f32_16x16x32_bf16 v[198:201], a[160:163], a[188:191], v[198:201]
    ds_read_b128 a[136:139], v4 offset:34816
    buffer_load_dwordx4 v62, s[24:27], s64 offen offset:3072 lds
    v_mfma_f32_16x16x32_bf16 v[210:213], a[164:167], a[192:195], v[210:213]
    ds_read_b64_tr_b16 a[176:177], v71 offset:32768
    s_add_u32 m0, s58, 65536
    v_mfma_f32_16x16x32_bf16 v[218:221], a[164:167], a[196:199], v[218:221]
    ds_read_b64_tr_b16 a[178:179], v71 offset:33024
    s_add_u32 s64, s64, 524288
    v_mfma_f32_16x16x32_bf16 v[202:205], a[164:167], a[188:191], v[202:205]
    ds_read_b128 a[140:143], v4 offset:35840
    s_cmp_eq_u32 s64, 3670016
    v_mfma_f32_16x16x32_bf16 v[230:233], a[192:195], a[168:171], v[230:233]
    ds_read_b128 a[144:147], v4 offset:36864
    s_cselect_b32 s64, 0, s64
    v_mfma_f32_16x16x32_bf16 v[238:241], a[196:199], a[168:171], v[238:241]
    ds_read_b128 a[148:151], v4 offset:37888
    buffer_load_dwordx4 v59, s[24:27], s64 offen lds
    v_mfma_f32_16x16x32_bf16 v[222:225], a[188:191], a[168:171], v[222:225]
    v_mfma_f32_16x16x32_bf16 v[234:237], a[192:195], a[172:175], v[234:237]
    buffer_load_dwordx4 v60, s[24:27], s64 offen offset:1024 lds
    v_mfma_f32_16x16x32_bf16 v[242:245], a[196:199], a[172:175], v[242:245]
    v_mfma_f32_16x16x32_bf16 v[226:229], a[188:191], a[172:175], v[226:229]
    s_waitcnt lgkmcnt(6)
    v_mfma_f32_16x16x32_bf16 v[182:185], a[128:131], a[180:183], v[182:185]
    ds_read_b64_tr_b16 a[192:193], v70 offset:34816
    buffer_load_dwordx4 v61, s[24:27], s64 offen offset:2048 lds
    v_mfma_f32_16x16x32_bf16 v[190:193], a[128:131], a[184:187], v[190:193]
    ds_read_b64_tr_b16 a[194:195], v70 offset:35072
    v_mfma_f32_16x16x32_bf16 v[186:189], a[132:135], a[180:183], v[186:189]
    ds_read_b128 a[152:155], v4 offset:38912
    v_mfma_f32_16x16x32_bf16 v[194:197], a[132:135], a[184:187], v[194:197]
    ds_read_b64_tr_b16 a[196:197], v70 offset:35840
    s_waitcnt lgkmcnt(4)
    v_mfma_f32_16x16x32_bf16 v[206:209], a[136:139], a[180:183], v[206:209]
    ds_read_b64_tr_b16 a[198:199], v70 offset:36096
    buffer_load_dwordx4 v62, s[24:27], s64 offen offset:3072 lds
    v_mfma_f32_16x16x32_bf16 v[214:217], a[136:139], a[184:187], v[214:217]
    ds_read_b128 a[156:159], v4 offset:39936
    s_add_u32 m0, s58, 81920
    v_mfma_f32_16x16x32_bf16 v[198:201], a[136:139], a[176:179], v[198:201]
    ds_read_b128 a[160:163], v4 offset:40960
    s_add_u32 s64, s64, 524288
    v_mfma_f32_16x16x32_bf16 v[210:213], a[140:143], a[180:183], v[210:213]
    ds_read_b64_tr_b16 a[188:189], v71 offset:34816
    s_cmp_eq_u32 s64, 3670016
    v_mfma_f32_16x16x32_bf16 v[218:221], a[140:143], a[184:187], v[218:221]
    ds_read_b64_tr_b16 a[190:191], v71 offset:35072
    s_cselect_b32 s64, 0, s64
    v_mfma_f32_16x16x32_bf16 v[202:205], a[140:143], a[176:179], v[202:205]
    ds_read_b128 a[164:167], v4 offset:41984
    buffer_load_dwordx4 v59, s[24:27], s64 offen lds
    v_mfma_f32_16x16x32_bf16 v[230:233], a[180:183], a[144:147], v[230:233]
    ds_read_b128 a[168:171], v4 offset:43008
    v_mfma_f32_16x16x32_bf16 v[238:241], a[184:187], a[144:147], v[238:241]
    ds_read_b128 a[172:175], v4 offset:44032
    buffer_load_dwordx4 v60, s[24:27], s64 offen offset:1024 lds
    v_mfma_f32_16x16x32_bf16 v[222:225], a[176:179], a[144:147], v[222:225]
    v_mfma_f32_16x16x32_bf16 v[234:237], a[180:183], a[148:151], v[234:237]
    v_mfma_f32_16x16x32_bf16 v[242:245], a[184:187], a[148:151], v[242:245]
    buffer_load_dwordx4 v61, s[24:27], s64 offen offset:2048 lds
    v_mfma_f32_16x16x32_bf16 v[226:229], a[176:179], a[148:151], v[226:229]
    ds_read_b32 v24, v4
    s_waitcnt vmcnt(23) lgkmcnt(1)
    s_barrier
    v_mfma_f32_16x16x32_bf16 v[182:185], a[152:155], a[192:195], v[182:185]
    ds_read_b64_tr_b16 a[180:181], v72 offset:32768
    v_mfma_f32_16x16x32_bf16 v[190:193], a[152:155], a[196:199], v[190:193]
    ds_read_b64_tr_b16 a[182:183], v72 offset:33024
    buffer_load_dwordx4 v62, s[24:27], s64 offen offset:3072 lds
    v_mfma_f32_16x16x32_bf16 v[186:189], a[156:159], a[192:195], v[186:189]
    ds_read_b128 a[128:131], v53 offset:32768
    s_add_u32 m0, s58, 32768
    v_mfma_f32_16x16x32_bf16 v[194:197], a[156:159], a[196:199], v[194:197]
    ds_read_b64_tr_b16 a[184:185], v72 offset:33792
    v_mfma_f32_16x16x32_bf16 v[206:209], a[160:163], a[192:195], v[206:209]
    ds_read_b64_tr_b16 a[186:187], v72 offset:34048
    s_add_u32 s64, s64, 524288
    v_mfma_f32_16x16x32_bf16 v[214:217], a[160:163], a[196:199], v[214:217]
    ds_read_b128 a[132:135], v53 offset:33792
    s_cmp_eq_u32 s64, 3670016
    v_mfma_f32_16x16x32_bf16 v[198:201], a[160:163], a[188:191], v[198:201]
    ds_read_b128 a[136:139], v53 offset:34816
    s_cselect_b32 s64, 0, s64
    v_mfma_f32_16x16x32_bf16 v[210:213], a[164:167], a[192:195], v[210:213]
    ds_read_b64_tr_b16 a[176:177], v73 offset:32768
    buffer_load_dwordx4 v59, s[24:27], s64 offen lds
    v_mfma_f32_16x16x32_bf16 v[218:221], a[164:167], a[196:199], v[218:221]
    ds_read_b64_tr_b16 a[178:179], v73 offset:33024
    v_mfma_f32_16x16x32_bf16 v[202:205], a[164:167], a[188:191], v[202:205]
    ds_read_b128 a[140:143], v53 offset:35840
    buffer_load_dwordx4 v60, s[24:27], s64 offen offset:1024 lds
    v_mfma_f32_16x16x32_bf16 v[230:233], a[192:195], a[168:171], v[230:233]
    ds_read_b128 a[144:147], v53 offset:36864
    v_mfma_f32_16x16x32_bf16 v[238:241], a[196:199], a[168:171], v[238:241]
    ds_read_b128 a[148:151], v53 offset:37888
    v_mfma_f32_16x16x32_bf16 v[222:225], a[188:191], a[168:171], v[222:225]
    buffer_load_dwordx4 v61, s[24:27], s64 offen offset:2048 lds
    v_mfma_f32_16x16x32_bf16 v[234:237], a[192:195], a[172:175], v[234:237]
    v_mfma_f32_16x16x32_bf16 v[242:245], a[196:199], a[172:175], v[242:245]
    v_mfma_f32_16x16x32_bf16 v[226:229], a[188:191], a[172:175], v[226:229]
    buffer_load_dwordx4 v62, s[24:27], s64 offen offset:3072 lds
    s_load_dword s14, s[28:29], s38
    s_waitcnt lgkmcnt(6)
    v_mfma_f32_16x16x32_bf16 v[182:185], a[128:131], a[180:183], v[182:185]
    ds_read_b64_tr_b16 a[192:193], v72 offset:34816
    s_add_u32 m0, s58, 49152
    v_mfma_f32_16x16x32_bf16 v[190:193], a[128:131], a[184:187], v[190:193]
    ds_read_b64_tr_b16 a[194:195], v72 offset:35072
    s_add_u32 s64, s64, 524288
    v_mfma_f32_16x16x32_bf16 v[186:189], a[132:135], a[180:183], v[186:189]
    ds_read_b128 a[152:155], v53 offset:38912
    s_cmp_eq_u32 s64, 3670016
    v_mfma_f32_16x16x32_bf16 v[194:197], a[132:135], a[184:187], v[194:197]
    ds_read_b64_tr_b16 a[196:197], v72 offset:35840
    s_waitcnt lgkmcnt(4)
    v_mfma_f32_16x16x32_bf16 v[206:209], a[136:139], a[180:183], v[206:209]
    ds_read_b64_tr_b16 a[198:199], v72 offset:36096
    s_cselect_b32 s64, 0, s64
    v_mfma_f32_16x16x32_bf16 v[214:217], a[136:139], a[184:187], v[214:217]
    ds_read_b128 a[156:159], v53 offset:39936
    buffer_load_dwordx4 v59, s[24:27], s64 offen lds
    v_mfma_f32_16x16x32_bf16 v[198:201], a[136:139], a[176:179], v[198:201]
    ds_read_b128 a[160:163], v53 offset:40960
    v_mfma_f32_16x16x32_bf16 v[210:213], a[140:143], a[180:183], v[210:213]
    ds_read_b64_tr_b16 a[188:189], v73 offset:34816
    buffer_load_dwordx4 v60, s[24:27], s64 offen offset:1024 lds
    v_mfma_f32_16x16x32_bf16 v[218:221], a[140:143], a[184:187], v[218:221]
L_pad2:
    s_cbranch_execz L_warm
    ds_read_b64_tr_b16 a[190:191], v73 offset:35072
    v_mfma_f32_16x16x32_bf16 v[202:205], a[140:143], a[176:179], v[202:205]
    ds_read_b128 a[164:167], v53 offset:41984
    v_mfma_f32_16x16x32_bf16 v[230:233], a[180:183], a[144:147], v[230:233]
    ds_read_b128 a[168:171], v53 offset:43008
    buffer_load_dwordx4 v61, s[24:27], s64 offen offset:2048 lds
    v_mfma_f32_16x16x32_bf16 v[238:241], a[184:187], a[144:147], v[238:241]
    ds_read_b128 a[172:175], v53 offset:44032
    v_mfma_f32_16x16x32_bf16 v[222:225], a[176:179], a[144:147], v[222:225]
    v_mfma_f32_16x16x32_bf16 v[234:237], a[180:183], a[148:151], v[234:237]
    buffer_load_dwordx4 v62, s[24:27], s64 offen offset:3072 lds
    v_mfma_f32_16x16x32_bf16 v[242:245], a[184:187], a[148:151], v[242:245]
    v_mfma_f32_16x16x32_bf16 v[226:229], a[176:179], a[148:151], v[226:229]
    ds_read_b32 v24, v4
    s_waitcnt vmcnt(24) lgkmcnt(1)
    s_barrier
    v_mfma_f32_16x16x32_bf16 v[182:185], a[152:155], a[192:195], v[182:185]
    ds_read_b64_tr_b16 a[180:181], v74 offset:0
    s_add_u32 m0, s58, 98304
    v_mfma_f32_16x16x32_bf16 v[190:193], a[152:155], a[196:199], v[190:193]
    ds_read_b64_tr_b16 a[182:183], v74 offset:256
    s_add_u32 s64, s64, 524288
    v_mfma_f32_16x16x32_bf16 v[186:189], a[156:159], a[192:195], v[186:189]
    ds_read_b128 a[128:131], v54 offset:0
    s_cmp_eq_u32 s64, 3670016
    v_mfma_f32_16x16x32_bf16 v[194:197], a[156:159], a[196:199], v[194:197]
    ds_read_b64_tr_b16 a[184:185], v74 offset:1024
    v_mfma_f32_16x16x32_bf16 v[206:209], a[160:163], a[192:195], v[206:209]
    ds_read_b64_tr_b16 a[186:187], v74 offset:1280
    s_cselect_b32 s64, 0, s64
    v_mfma_f32_16x16x32_bf16 v[214:217], a[160:163], a[196:199], v[214:217]
    ds_read_b128 a[132:135], v54 offset:1024
    buffer_load_dwordx4 v59, s[24:27], s64 offen lds
    v_mfma_f32_16x16x32_bf16 v[198:201], a[160:163], a[188:191], v[198:201]
    ds_read_b128 a[136:139], v54 offset:2048
    v_mfma_f32_16x16x32_bf16 v[210:213], a[164:167], a[192:195], v[210:213]
    ds_read_b64_tr_b16 a[176:177], v75 offset:0
    buffer_load_dwordx4 v60, s[24:27], s64 offen offset:1024 lds
    v_mfma_f32_16x16x32_bf16 v[218:221], a[164:167], a[196:199], v[218:221]
    ds_read_b64_tr_b16 a[178:179], v75 offset:256
    v_mfma_f32_16x16x32_bf16 v[202:205], a[164:167], a[188:191], v[202:205]
    ds_read_b128 a[140:143], v54 offset:3072
    v_mfma_f32_16x16x32_bf16 v[230:233], a[192:195], a[168:171], v[230:233]
    ds_read_b128 a[144:147], v54 offset:4096
    buffer_load_dwordx4 v61, s[24:27], s64 offen offset:2048 lds
    v_mfma_f32_16x16x32_bf16 v[238:241], a[196:199], a[168:171], v[238:241]
    ds_read_b128 a[148:151], v54 offset:5120
    v_mfma_f32_16x16x32_bf16 v[222:225], a[188:191], a[168:171], v[222:225]
    v_mfma_f32_16x16x32_bf16 v[234:237], a[192:195], a[172:175], v[234:237]
    buffer_load_dwordx4 v62, s[24:27], s64 offen offset:3072 lds
    s_add_u32 m0, s58, 114688
    v_mfma_f32_16x16x32_bf16 v[242:245], a[196:199], a[172:175], v[242:245]
    s_add_u32 s64, s64, 524288
    s_cmp_eq_u32 s64, 3670016
    v_mfma_f32_16x16x32_bf16 v[226:229], a[188:191], a[172:175], v[226:229]
    s_cselect_b32 s64, 0, s64
    s_waitcnt lgkmcnt(6)
    v_mfma_f32_16x16x32_bf16 v[182:185], a[128:131], a[180:183], v[182:185]
    ds_read_b64_tr_b16 a[192:193], v74 offset:2048
    buffer_load_dwordx4 v59, s[24:27], s64 offen lds
    v_mfma_f32_16x16x32_bf16 v[190:193], a[128:131], a[184:187], v[190:193]
    ds_read_b64_tr_b16 a[194:195], v74 offset:2304
    v_mfma_f32_16x16x32_bf16 v[186:189], a[132:135], a[180:183], v[186:189]
    ds_read_b128 a[152:155], v54 offset:6144
    v_mfma_f32_16x16x32_bf16 v[194:197], a[132:135], a[184:187], v[194:197]
    ds_read_b64_tr_b16 a[196:197], v74 offset:3072
    s_waitcnt lgkmcnt(4)
    v_mfma_f32_16x16x32_bf16 v[206:209], a[136:139], a[180:183], v[206:209]
    ds_read_b64_tr_b16 a[198:199], v74 offset:3328
    buffer_load_dwordx4 v60, s[24:27], s64 offen offset:1024 lds
    v_mfma_f32_16x16x32_bf16 v[214:217], a[136:139], a[184:187], v[214:217]
    ds_read_b128 a[156:159], v54 offset:7168
    v_mfma_f32_16x16x32_bf16 v[198:201], a[136:139], a[176:179], v[198:201]
    ds_read_b128 a[160:163], v54 offset:8192
    buffer_load_dwordx4 v61, s[24:27], s64 offen offset:2048 lds
    v_mfma_f32_16x16x32_bf16 v[210:213], a[140:143], a[180:183], v[210:213]
    ds_read_b64_tr_b16 a[188:189], v75 offset:2048
    v_mfma_f32_16x16x32_bf16 v[218:221], a[140:143], a[184:187], v[218:221]
    ds_read_b64_tr_b16 a[190:191], v75 offset:2304
    v_mfma_f32_16x16x32_bf16 v[202:205], a[140:143], a[176:179], v[202:205]
    ds_read_b128 a[164:167], v54 offset:9216
    buffer_load_dwordx4 v62, s[24:27], s64 offen offset:3072 lds
    v_mfma_f32_16x16x32_bf16 v[230:233], a[180:183], a[144:147], v[230:233]
    ds_read_b128 a[168:171], v54 offset:10240
    v_mfma_f32_16x16x32_bf16 v[238:241], a[184:187], a[144:147], v[238:241]
    ds_read_b128 a[172:175], v54 offset:11264
    v_mfma_f32_16x16x32_bf16 v[222:225], a[176:179], a[144:147], v[222:225]
    v_mfma_f32_16x16x32_bf16 v[234:237], a[180:183], a[148:151], v[234:237]
    v_mfma_f32_16x16x32_bf16 v[242:245], a[184:187], a[148:151], v[242:245]
    v_mfma_f32_16x16x32_bf16 v[226:229], a[176:179], a[148:151], v[226:229]
    s_waitcnt lgkmcnt(0)
    s_cmp_ge_u32 s14, 7
    s_cbranch_scc0 L_pollin5
L_pollok5:
    s_waitcnt vmcnt(16)
    s_barrier
    v_mfma_f32_16x16x32_bf16 v[182:185], a[152:155], a[192:195], v[182:185]
    ds_read_b64_tr_b16 a[200:201], v31 offset:16384
    buffer_load_dwordx4 a[0:3], v79, s[28:31], s65 offen offset:0 sc1
    v_mfma_f32_16x16x32_bf16 v[190:193], a[152:155], a[196:199], v[190:193]
    ds_read_b64_tr_b16 a[202:203], v31 offset:18432
    v_mfma_f32_16x16x32_bf16 v[186:189], a[156:159], a[192:195], v[186:189]
    ds_read_b64_tr_b16 a[204:205], v33 offset:16384
    buffer_load_dwordx4 a[4:7], v79, s[28:31], s65 offen offset:1024 sc1
    v_mfma_f32_16x16x32_bf16 v[194:197], a[156:159], a[196:199], v[194:197]
    ds_read_b64_tr_b16 a[206:207], v33 offset:18432
    v_mfma_f32_16x16x32_bf16 v[206:209], a[160:163], a[192:195], v[206:209]
    ds_read_b64_tr_b16 a[208:209], v32 offset:16384
    v_mfma_f32_16x16x32_bf16 v[214:217], a[160:163], a[196:199], v[214:217]
    ds_read_b64_tr_b16 a[210:211], v32 offset:18432
    v_mfma_f32_16x16x32_bf16 v[198:201], a[160:163], a[188:191], v[198:201]
    ds_read_b64_tr_b16 a[212:213], v34 offset:16384
    buffer_load_dwordx4 a[8:11], v79, s[28:31], s65 offen offset:2048 sc1
    v_mfma_f32_16x16x32_bf16 v[210:213], a[164:167], a[192:195], v[210:213]
    ds_read_b64_tr_b16 a[214:215], v34 offset:18432
    v_mfma_f32_16x16x32_bf16 v[218:221], a[164:167], a[196:199], v[218:221]
    ds_read_b64_tr_b16 a[216:217], v31 offset:20480
    v_mfma_f32_16x16x32_bf16 v[202:205], a[164:167], a[188:191], v[202:205]
    ds_read_b64_tr_b16 a[218:219], v31 offset:22528
    buffer_load_dwordx4 a[12:15], v79, s[28:31], s65 offen offset:3072 sc1
    v_mfma_f32_16x16x32_bf16 v[230:233], a[192:195], a[168:171], v[230:233]
    ds_read_b64_tr_b16 a[220:221], v33 offset:20480
    s_add_u32 s65, s65, 8192
    v_mfma_f32_16x16x32_bf16 v[238:241], a[196:199], a[168:171], v[238:241]
    ds_read_b64_tr_b16 a[222:223], v33 offset:22528
    s_cmp_eq_u32 s65, 57344
    v_mfma_f32_16x16x32_bf16 v[222:225], a[188:191], a[168:171], v[222:225]
    s_cselect_b32 s65, 0, s65
    v_mfma_f32_16x16x32_bf16 v[234:237], a[192:195], a[172:175], v[234:237]
    buffer_load_dwordx4 a[16:19], v79, s[28:31], s65 offen offset:0 sc1
    v_mfma_f32_16x16x32_bf16 v[242:245], a[196:199], a[172:175], v[242:245]
    v_mfma_f32_16x16x32_bf16 v[226:229], a[188:191], a[172:175], v[226:229]
    v_cvt_pk_bf16_f32 v118, v182, v183
    v_cvt_pk_bf16_f32 v119, v184, v185
    v_cvt_pk_bf16_f32 v120, v186, v187
    buffer_load_dwordx4 a[20:23], v79, s[28:31], s65 offen offset:1024 sc1
    v_cvt_pk_bf16_f32 v121, v188, v189
    v_cvt_pk_bf16_f32 v122, v190, v191
    v_cvt_pk_bf16_f32 v123, v192, v193
    v_cvt_pk_bf16_f32 v124, v194, v195
    v_cvt_pk_bf16_f32 v125, v196, v197
    v_cvt_pk_bf16_f32 v130, v206, v207
    v_cvt_pk_bf16_f32 v131, v208, v209
    v_cvt_pk_bf16_f32 v132, v210, v211
    v_cvt_pk_bf16_f32 v133, v212, v213
    v_cvt_pk_bf16_f32 v134, v214, v215
    v_cvt_pk_bf16_f32 v135, v216, v217
    v_cvt_pk_bf16_f32 v136, v218, v219
    v_cvt_pk_bf16_f32 v137, v220, v221
    v_cvt_pk_bf16_f32 v126, v198, v199
    buffer_load_dwordx4 a[24:27], v79, s[28:31], s65 offen offset:2048 sc1
    v_cvt_pk_bf16_f32 v127, v200, v201
    v_cvt_pk_bf16_f32 v128, v202, v203
    v_cvt_pk_bf16_f32 v129, v204, v205
    v_mfma_f32_16x16x32_bf16 v[154:157], v[130:133], v[118:121], 0
    v_mfma_f32_16x16x32_bf16 v[158:161], v[130:133], v[122:125], 0
    v_mfma_f32_16x16x32_bf16 v[162:165], v[134:137], v[122:125], 0
    buffer_load_dwordx4 a[28:31], v79, s[28:31], s65 offen offset:3072 sc1
    v_mfma_f32_16x16x32_bf16 v[150:153], v[126:129], v[118:121], 0
    v_cvt_pk_bf16_f32 v166, v222, v223
    v_cvt_pk_bf16_f32 v167, v224, v225
    v_cvt_pk_bf16_f32 v168, v230, v231
    v_cvt_pk_bf16_f32 v169, v232, v233
    v_cvt_pk_bf16_f32 v170, v238, v239
    v_cvt_pk_bf16_f32 v171, v240, v241
    v_cndmask_b32 v250, v158, v159, s[70:71]
    v_cndmask_b32 v253, v162, v163, s[70:71]
    v_cndmask_b32 v250, v250, v253, s[72:73]
    s_add_u32 s65, s65, 8192
    s_cmp_eq_u32 s65, 57344
    s_cselect_b32 s65, 0, s65
    buffer_load_dwordx4 a[32:35], v79, s[28:31], s65 offen offset:0 sc1
    v_mul_f32 v250, v250, v29
    v_cndmask_b32 v251, v160, v161, s[70:71]
    v_cndmask_b32 v253, v164, v165, s[70:71]
    v_cndmask_b32 v251, v251, v253, s[74:75]
    v_mul_f32 v251, v251, v30
    v_cndmask_b32 v246, v150, v151, s[70:71]
    v_cndmask_b32 v246, v84, v246, s[76:77]
    v_cndmask_b32 v249, v154, v155, s[70:71]
    v_cndmask_b32 v246, v246, v249, s[72:73]
    v_mul_f32 v246, v246, v27
    v_cndmask_b32 v247, v152, v153, s[70:71]
    v_cndmask_b32 v247, v84, v247, s[76:77]
    v_cndmask_b32 v249, v156, v157, s[70:71]
    v_cndmask_b32 v247, v247, v249, s[74:75]
    buffer_load_dwordx4 a[36:39], v79, s[28:31], s65 offen offset:1024 sc1
    v_mul_f32 v247, v247, v28
    v_max_f32 v248, v246, v247
    v_max_f32 v252, v250, v251
    v_mov_b32 v249, v248
    v_mov_b32 v253, v252
    v_cvt_pk_bf16_f32 v172, v226, v227
    v_permlane16_swap_b32 v248, v249
    v_permlane16_swap_b32 v252, v253
    v_max_f32 v248, v248, v249
    v_max_f32 v252, v252, v253
    v_mov_b32 v249, v248
    v_mov_b32 v253, v252
    v_cvt_pk_bf16_f32 v173, v228, v229
    v_permlane32_swap_b32 v248, v249
    buffer_load_dwordx4 a[40:43], v79, s[28:31], s65 offen offset:2048 sc1
    v_permlane32_swap_b32 v252, v253
    v_max_f32 v248, v248, v249
    v_max_f32 v252, v252, v253
    v_mul_f32 v248, v25, v248
    v_mul_f32 v252, v26, v252
    v_fma_f32 v246, v246, v25, -v248
    v_fma_f32 v247, v247, v25, -v248
    v_fma_f32 v250, v250, v26, -v252
    v_fma_f32 v251, v251, v26, -v252
    v_exp_f32 v246, v246
    v_exp_f32 v247, v247
    v_exp_f32 v250, v250
    buffer_load_dwordx4 a[44:47], v79, s[28:31], s65 offen offset:3072 sc1
    v_exp_f32 v251, v251
    v_add_f32 v248, v246, v247
    v_add_f32 v252, v250, v251
    v_mov_b32 v249, v248
    v_mov_b32 v253, v252
    v_cvt_pk_bf16_f32 v174, v234, v235
    v_permlane16_swap_b32 v248, v249
    v_permlane16_swap_b32 v252, v253
    v_add_f32 v248, v248, v249
    v_add_f32 v252, v252, v253
    v_mov_b32 v249, v248
    v_mov_b32 v253, v252
    s_add_u32 m0, s58, 131072
    s_add_u32 s64, s64, 524288
    s_cmp_eq_u32 s64, 3670016
    s_cselect_b32 s64, 0, s64
    s_add_u32 s64, s64, 524288
    s_cmp_eq_u32 s64, 3670016
    s_cselect_b32 s64, 0, s64
    v_xor_b32 v59, 128, v59
    buffer_load_dwordx4 v59, s[24:27], s64 offen lds
    v_cvt_pk_bf16_f32 v175, v236, v237
    v_permlane32_swap_b32 v248, v249
    v_permlane32_swap_b32 v252, v253
    v_add_f32 v248, v248, v249
    v_add_f32 v252, v252, v253
    v_rcp_f32 v248, v248
    v_rcp_f32 v252, v252
    v_cvt_pk_bf16_f32 v176, v242, v243
    v_cvt_pk_bf16_f32 v177, v244, v245
    v_mul_f32 v246, v246, v27
    v_xor_b32 v60, 128, v60
    buffer_load_dwordx4 v60, s[24:27], s64 offen offset:1024 lds
    v_mul_f32 v247, v247, v28
    v_mul_f32 v250, v250, v29
    v_mul_f32 v251, v251, v30
    v_mul_f32 v246, v246, v248
    v_mul_f32 v247, v247, v248
    v_mul_f32 v250, v250, v252
    v_mul_f32 v251, v251, v252
    v_cvt_pk_bf16_f32 v246, v246, v246
    v_cvt_pk_bf16_f32 v247, v247, v247
    v_cvt_pk_bf16_f32 v250, v250, v250
    v_cvt_pk_bf16_f32 v251, v251, v251
    v_and_b32 v138, v246, v104
    v_and_b32 v139, v247, v105
    v_xor_b32 v61, 128, v61
    buffer_load_dwordx4 v61, s[24:27], s64 offen offset:2048 lds
    v_and_b32 v140, v246, v106
    v_and_b32 v141, v247, v107
    v_and_b32 v142, v250, v104
    v_and_b32 v143, v251, v105
    v_and_b32 v144, v250, v106
    v_and_b32 v145, v251, v107
    v_mfma_f32_16x16x32_bf16 v[182:185], v[166:169], v[138:141], 0
    v_mfma_f32_16x16x32_bf16 v[186:189], v[172:175], v[138:141], 0
    v_xor_b32 v62, 128, v62
    buffer_load_dwordx4 v62, s[24:27], s64 offen offset:3072 lds
    v_mfma_f32_16x16x32_bf16 v[190:193], v[168:171], v[142:145], 0
    v_mfma_f32_16x16x32_bf16 v[194:197], v[174:177], v[142:145], 0
    s_add_u32 s83, s82, 16384
    s_nop 1
    v_cvt_pk_bf16_f32 v110, v182, v183
    v_cvt_pk_bf16_f32 v111, v184, v185
    s_add_u32 m0, s58, 147456
    s_add_u32 s64, s64, 524288
    s_cmp_eq_u32 s64, 3670016
    s_cselect_b32 s64, 0, s64
    buffer_load_dwordx4 v59, s[24:27], s64 offen lds
    v_cvt_pk_bf16_f32 v112, v186, v187
    v_cvt_pk_bf16_f32 v113, v188, v189
    v_cvt_pk_bf16_f32 v114, v190, v191
    v_cvt_pk_bf16_f32 v115, v192, v193
    v_cvt_pk_bf16_f32 v116, v194, v195
    v_cvt_pk_bf16_f32 v117, v196, v197
    buffer_store_dwordx4 v[110:113], v4, s[28:31], s82 offen sc1
    buffer_store_dwordx4 v[114:117], v4, s[28:31], s83 offen sc1
    s_cmp_lg_u32 s56, 0
    s_cbranch_scc0 L_nof
L_f:
    s_waitcnt vmcnt(17) lgkmcnt(8)
    v_mfma_f32_16x16x32_bf16 v[182:185], a[0:3], a[200:203], 0
    ds_read_b64_tr_b16 a[224:225], v32 offset:20480
    s_add_u32 s65, s65, 8192
    s_cmp_eq_u32 s65, 57344
    s_cselect_b32 s65, 0, s65
    buffer_load_dwordx4 a[48:51], v79, s[28:31], s65 offen offset:0 sc1
    v_mfma_f32_16x16x32_bf16 v[186:189], a[4:7], a[200:203], 0
    ds_read_b64_tr_b16 a[226:227], v32 offset:22528
    v_lshlrev_b32 v93, 16, v93
    v_mfma_f32_16x16x32_bf16 v[238:241], a[0:3], a[204:207], 0
    ds_read_b64_tr_b16 a[228:229], v34 offset:20480
    buffer_load_dwordx4 a[52:55], v79, s[28:31], s65 offen offset:1024 sc1
    v_mfma_f32_16x16x32_bf16 v[242:245], a[4:7], a[204:207], 0
    ds_read_b64_tr_b16 a[230:231], v34 offset:22528
    s_waitcnt lgkmcnt(8)
    v_mfma_f32_16x16x32_bf16 v[190:193], a[0:3], a[208:211], 0
    ds_read_b64_tr_b16 a[200:201], v35 offset:0
    v_lshlrev_b32 v222, 16, v96
    v_mfma_f32_16x16x32_bf16 v[194:197], a[4:7], a[208:211], 0
    ds_read_b64_tr_b16 a[202:203], v35 offset:2048
    v_and_b32 v223, 0xffff0000, v96
    v_mfma_f32_16x16x32_bf16 v[246:249], a[0:3], a[212:215], 0
    ds_read_b64_tr_b16 a[204:205], v37 offset:0
    buffer_load_dwordx4 a[56:59], v79, s[28:31], s65 offen offset:2048 sc1
    v_mfma_f32_16x16x32_bf16 v[250:253], a[4:7], a[212:215], 0
    ds_read_b64_tr_b16 a[206:207], v37 offset:2048
    s_waitcnt vmcnt(18) lgkmcnt(8)
    v_mfma_f32_16x16x32_bf16 v[182:185], a[8:11], a[216:219], v[182:185]
    ds_read_b64_tr_b16 a[208:209], v36 offset:0
    v_add_f32 v222, v222, v93
    v_mfma_f32_16x16x32_bf16 v[186:189], a[12:15], a[216:219], v[186:189]
    ds_read_b64_tr_b16 a[210:211], v36 offset:2048
    buffer_load_dwordx4 a[60:63], v79, s[28:31], s65 offen offset:3072 sc1
    v_add_f32 v223, v223, v93
    v_mfma_f32_16x16x32_bf16 v[238:241], a[8:11], a[220:223], v[238:241]
    ds_read_b64_tr_b16 a[212:213], v38 offset:0
    s_add_u32 s65, s65, 8192
    v_mfma_f32_16x16x32_bf16 v[242:245], a[12:15], a[220:223], v[242:245]
    ds_read_b64_tr_b16 a[214:215], v38 offset:2048
    s_waitcnt lgkmcnt(8)
    v_mfma_f32_16x16x32_bf16 v[190:193], a[8:11], a[224:227], v[190:193]
    ds_read_b64_tr_b16 a[216:217], v35 offset:4096
    s_cmp_eq_u32 s65, 57344
    v_mfma_f32_16x16x32_bf16 v[194:197], a[12:15], a[224:227], v[194:197]
    ds_read_b64_tr_b16 a[218:219], v35 offset:6144
    s_cselect_b32 s65, 0, s65
    v_lshlrev_b32 v224, 16, v97
    v_mfma_f32_16x16x32_bf16 v[246:249], a[8:11], a[228:231], v[246:249]
    ds_read_b64_tr_b16 a[220:221], v37 offset:4096
    buffer_load_dwordx4 a[64:67], v79, s[28:31], s65 offen offset:0 sc1
    v_mfma_f32_16x16x32_bf16 v[250:253], a[12:15], a[228:231], v[250:253]
    ds_read_b64_tr_b16 a[222:223], v37 offset:6144
    s_waitcnt vmcnt(18) lgkmcnt(8)
    v_mfma_f32_16x16x32_bf16 v[182:185], a[16:19], a[200:203], v[182:185]
    ds_read_b64_tr_b16 a[224:225], v36 offset:4096
    buffer_load_dwordx4 a[68:71], v79, s[28:31], s65 offen offset:1024 sc1
    v_mfma_f32_16x16x32_bf16 v[186:189], a[20:23], a[200:203], v[186:189]
    ds_read_b64_tr_b16 a[226:227], v36 offset:6144
    v_and_b32 v225, 0xffff0000, v97
    v_mfma_f32_16x16x32_bf16 v[238:241], a[16:19], a[204:207], v[238:241]
    ds_read_b64_tr_b16 a[228:229], v38 offset:4096
    v_add_f32 v224, v224, v93
    v_mfma_f32_16x16x32_bf16 v[242:245], a[20:23], a[204:207], v[242:245]
    ds_read_b64_tr_b16 a[230:231], v38 offset:6144
    s_waitcnt lgkmcnt(8)
    v_mfma_f32_16x16x32_bf16 v[190:193], a[16:19], a[208:211], v[190:193]
    ds_read_b64_tr_b16 a[200:201], v35 offset:16384
    buffer_load_dwordx4 a[72:75], v79, s[28:31], s65 offen offset:2048 sc1
    v_mfma_f32_16x16x32_bf16 v[194:197], a[20:23], a[208:211], v[194:197]
    ds_read_b64_tr_b16 a[202:203], v35 offset:18432
    v_add_f32 v225, v225, v93
    v_mfma_f32_16x16x32_bf16 v[246:249], a[16:19], a[212:215], v[246:249]
    ds_read_b64_tr_b16 a[204:205], v37 offset:16384
    v_lshlrev_b32 v226, 16, v98
    v_mfma_f32_16x16x32_bf16 v[250:253], a[20:23], a[212:215], v[250:253]
    ds_read_b64_tr_b16 a[206:207], v37 offset:18432
    s_waitcnt vmcnt(18) lgkmcnt(8)
    v_mfma_f32_16x16x32_bf16 v[182:185], a[24:27], a[216:219], v[182:185]
    ds_read_b64_tr_b16 a[208:209], v36 offset:16384
    buffer_load_dwordx4 a[76:79], v79, s[28:31], s65 offen offset:3072 sc1
    v_mfma_f32_16x16x32_bf16 v[186:189], a[28:31], a[216:219], v[186:189]
    ds_read_b64_tr_b16 a[210:211], v36 offset:18432
    s_add_u32 s65, s65, 8192
    v_and_b32 v227, 0xffff0000, v98
    v_mfma_f32_16x16x32_bf16 v[238:241], a[24:27], a[220:223], v[238:241]
    ds_read_b64_tr_b16 a[212:213], v38 offset:16384
    s_cmp_eq_u32 s65, 57344
    v_mfma_f32_16x16x32_bf16 v[242:245], a[28:31], a[220:223], v[242:245]
    ds_read_b64_tr_b16 a[214:215], v38 offset:18432
    v_add_f32 v226, v226, v93
    s_waitcnt lgkmcnt(8)
    v_mfma_f32_16x16x32_bf16 v[190:193], a[24:27], a[224:227], v[190:193]
    ds_read_b64_tr_b16 a[216:217], v35 offset:20480
    s_cselect_b32 s65, 0, s65
    buffer_load_dwordx4 a[80:83], v79, s[28:31], s65 offen offset:0 sc1
    v_mfma_f32_16x16x32_bf16 v[194:197], a[28:31], a[224:227], v[194:197]
    ds_read_b64_tr_b16 a[218:219], v35 offset:22528
    v_add_f32 v227, v227, v93
    v_mfma_f32_16x16x32_bf16 v[246:249], a[24:27], a[228:231], v[246:249]
    ds_read_b64_tr_b16 a[220:221], v37 offset:20480
    buffer_load_dwordx4 a[84:87], v79, s[28:31], s65 offen offset:1024 sc1
    v_mfma_f32_16x16x32_bf16 v[250:253], a[28:31], a[228:231], v[250:253]
    ds_read_b64_tr_b16 a[222:223], v37 offset:22528
    v_lshlrev_b32 v228, 16, v99
    s_waitcnt vmcnt(19) lgkmcnt(8)
    v_mfma_f32_16x16x32_bf16 v[182:185], a[32:35], a[200:203], v[182:185]
    ds_read_b64_tr_b16 a[224:225], v36 offset:20480
    v_and_b32 v229, 0xffff0000, v99
    v_mfma_f32_16x16x32_bf16 v[186:189], a[36:39], a[200:203], v[186:189]
    ds_read_b64_tr_b16 a[226:227], v36 offset:22528
    buffer_load_dwordx4 a[88:91], v79, s[28:31], s65 offen offset:2048 sc1
    v_add_f32 v228, v228, v93
    v_mfma_f32_16x16x32_bf16 v[238:241], a[32:35], a[204:207], v[238:241]
    ds_read_b64_tr_b16 a[228:229], v38 offset:20480
    v_add_f32 v229, v229, v93
    v_mfma_f32_16x16x32_bf16 v[242:245], a[36:39], a[204:207], v[242:245]
    ds_read_b64_tr_b16 a[230:231], v38 offset:22528
    s_waitcnt lgkmcnt(8)
    v_mfma_f32_16x16x32_bf16 v[190:193], a[32:35], a[208:211], v[190:193]
    s_waitcnt vmcnt(11)
    s_barrier
    s_cmp_lg_u32 s48, 0
    s_cbranch_scc1 L_sig4
    s_atomic_add s36, s[28:29], s69
L_sig4:
    ds_read_b64_tr_b16 a[200:201], v31 offset:32768
    buffer_load_dwordx4 a[92:95], v79, s[28:31], s65 offen offset:3072 sc1
    v_mfma_f32_16x16x32_bf16 v[194:197], a[36:39], a[208:211], v[194:197]
    ds_read_b64_tr_b16 a[202:203], v31 offset:34816
    s_add_u32 s65, s65, 8192
    v_lshlrev_b32 v94, 16, v94
    v_mfma_f32_16x16x32_bf16 v[246:249], a[32:35], a[212:215], v[246:249]
    ds_read_b64_tr_b16 a[204:205], v33 offset:32768
    s_cmp_eq_u32 s65, 57344
    v_mfma_f32_16x16x32_bf16 v[250:253], a[36:39], a[212:215], v[250:253]
    ds_read_b64_tr_b16 a[206:207], v33 offset:34816
    s_waitcnt lgkmcnt(8)
    v_mfma_f32_16x16x32_bf16 v[182:185], a[40:43], a[216:219], v[182:185]
    ds_read_b64_tr_b16 a[208:209], v32 offset:32768
    s_cselect_b32 s65, 0, s65
    v_mfma_f32_16x16x32_bf16 v[186:189], a[44:47], a[216:219], v[186:189]
    ds_read_b64_tr_b16 a[210:211], v32 offset:34816
    buffer_load_dwordx4 a[96:99], v79, s[28:31], s65 offen offset:0 sc1
    v_lshlrev_b32 v230, 16, v100
    v_mfma_f32_16x16x32_bf16 v[238:241], a[40:43], a[220:223], v[238:241]
    ds_read_b64_tr_b16 a[212:213], v34 offset:32768
    v_and_b32 v231, 0xffff0000, v100
    v_mfma_f32_16x16x32_bf16 v[242:245], a[44:47], a[220:223], v[242:245]
    ds_read_b64_tr_b16 a[214:215], v34 offset:34816
    s_waitcnt lgkmcnt(8)
    v_mfma_f32_16x16x32_bf16 v[190:193], a[40:43], a[224:227], v[190:193]
    ds_read_b64_tr_b16 a[216:217], v31 offset:36864
    buffer_load_dwordx4 a[100:103], v79, s[28:31], s65 offen offset:1024 sc1
    v_mfma_f32_16x16x32_bf16 v[194:197], a[44:47], a[224:227], v[194:197]
    ds_read_b64_tr_b16 a[218:219], v31 offset:38912
    v_add_f32 v230, v230, v94
    v_mfma_f32_16x16x32_bf16 v[246:249], a[40:43], a[228:231], v[246:249]
    ds_read_b64_tr_b16 a[220:221], v33 offset:36864
    buffer_load_dwordx4 a[104:107], v79, s[28:31], s65 offen offset:2048 sc1
    v_mfma_f32_16x16x32_bf16 v[250:253], a[44:47], a[228:231], v[250:253]
    ds_read_b64_tr_b16 a[222:223], v33 offset:38912
    v_add_f32 v231, v231, v94
    s_waitcnt vmcnt(13) lgkmcnt(8)
    v_mfma_f32_16x16x32_bf16 v[182:185], a[48:51], a[200:203], v[182:185]
    ds_read_b64_tr_b16 a[224:225], v32 offset:36864
    v_lshlrev_b32 v232, 16, v101
    v_mfma_f32_16x16x32_bf16 v[186:189], a[52:55], a[200:203], v[186:189]
    ds_read_b64_tr_b16 a[226:227], v32 offset:38912
    v_and_b32 v233, 0xffff0000, v101
    v_mfma_f32_16x16x32_bf16 v[238:241], a[48:51], a[204:207], v[238:241]
    ds_read_b64_tr_b16 a[228:229], v34 offset:36864
    buffer_load_dwordx4 a[108:111], v79, s[28:31], s65 offen offset:3072 sc1
    v_mfma_f32_16x16x32_bf16 v[242:245], a[52:55], a[204:207], v[242:245]
    ds_read_b64_tr_b16 a[230:231], v34 offset:38912
    s_waitcnt lgkmcnt(8)
    v_mfma_f32_16x16x32_bf16 v[190:193], a[48:51], a[208:211], v[190:193]
    ds_read_b64_tr_b16 a[200:201], v31 offset:49152
    v_add_f32 v232, v232, v94
    v_mfma_f32_16x16x32_bf16 v[194:197], a[52:55], a[208:211], v[194:197]
    ds_read_b64_tr_b16 a[202:203], v31 offset:51200
    buffer_load_dwordx4 v60, s[24:27], s64 offen offset:1024 lds
    v_add_f32 v233, v233, v94
    v_mfma_f32_16x16x32_bf16 v[246:249], a[48:51], a[212:215], v[246:249]
    ds_read_b64_tr_b16 a[204:205], v33 offset:49152
    v_lshlrev_b32 v234, 16, v102
    v_mfma_f32_16x16x32_bf16 v[250:253], a[52:55], a[212:215], v[250:253]
    ds_read_b64_tr_b16 a[206:207], v33 offset:51200
    s_waitcnt vmcnt(13) lgkmcnt(8)
    v_mfma_f32_16x16x32_bf16 v[182:185], a[56:59], a[216:219], v[182:185]
    ds_read_b64_tr_b16 a[208:209], v32 offset:49152
    buffer_load_dwordx4 v61, s[24:27], s64 offen offset:2048 lds
    v_mfma_f32_16x16x32_bf16 v[186:189], a[60:63], a[216:219], v[186:189]
    ds_read_b64_tr_b16 a[210:211], v32 offset:51200
    v_and_b32 v235, 0xffff0000, v102
    v_mfma_f32_16x16x32_bf16 v[238:241], a[56:59], a[220:223], v[238:241]
    ds_read_b64_tr_b16 a[212:213], v34 offset:49152
    buffer_load_dwordx4 v62, s[24:27], s64 offen offset:3072 lds
    v_mfma_f32_16x16x32_bf16 v[242:245], a[60:63], a[220:223], v[242:245]
    ds_read_b64_tr_b16 a[214:215], v34 offset:51200
    s_waitcnt lgkmcnt(8)
    v_mfma_f32_16x16x32_bf16 v[190:193], a[56:59], a[224:227], v[190:193]
    ds_read_b64_tr_b16 a[216:217], v31 offset:53248
    s_add_u32 m0, s58, 16384
    v_mfma_f32_16x16x32_bf16 v[194:197], a[60:63], a[224:227], v[194:197]
    ds_read_b64_tr_b16 a[218:219], v31 offset:55296
    s_add_u32 s64, s64, 524288
    v_add_f32 v234, v234, v94
    v_mfma_f32_16x16x32_bf16 v[246:249], a[56:59], a[228:231], v[246:249]
    ds_read_b64_tr_b16 a[220:221], v33 offset:53248
    s_cmp_eq_u32 s64, 3670016
    v_mfma_f32_16x16x32_bf16 v[250:253], a[60:63], a[228:231], v[250:253]
    ds_read_b64_tr_b16 a[222:223], v33 offset:55296
    s_cselect_b32 s64, 0, s64
    buffer_load_dwordx4 v59, s[24:27], s64 offen lds
    v_add_f32 v235, v235, v94
    s_waitcnt vmcnt(14) lgkmcnt(8)
    v_mfma_f32_16x16x32_bf16 v[182:185], a[64:67], a[200:203], v[182:185]
    ds_read_b64_tr_b16 a[224:225], v32 offset:53248
    v_lshlrev_b32 v236, 16, v103
    v_mfma_f32_16x16x32_bf16 v[186:189], a[68:71], a[200:203], v[186:189]
    ds_read_b64_tr_b16 a[226:227], v32 offset:55296
    buffer_load_dwordx4 v60, s[24:27], s64 offen offset:1024 lds
    v_and_b32 v237, 0xffff0000, v103
    v_mfma_f32_16x16x32_bf16 v[238:241], a[64:67], a[204:207], v[238:241]
    ds_read_b64_tr_b16 a[228:229], v34 offset:53248
    v_add_f32 v236, v236, v94
    v_mfma_f32_16x16x32_bf16 v[242:245], a[68:71], a[204:207], v[242:245]
    ds_read_b64_tr_b16 a[230:231], v34 offset:55296
    s_waitcnt lgkmcnt(8)
    v_mfma_f32_16x16x32_bf16 v[190:193], a[64:67], a[208:211], v[190:193]
    s_barrier
    ds_read_b64_tr_b16 a[200:201], v35 offset:32768
    buffer_load_dwordx4 v61, s[24:27], s64 offen offset:2048 lds
    v_mfma_f32_16x16x32_bf16 v[194:197], a[68:71], a[208:211], v[194:197]
    ds_read_b64_tr_b16 a[202:203], v35 offset:34816
    v_add_f32 v237, v237, v94
    v_mfma_f32_16x16x32_bf16 v[246:249], a[64:67], a[212:215], v[246:249]
    ds_read_b64_tr_b16 a[204:205], v37 offset:32768
    v_mfma_f32_16x16x32_bf16 v[250:253], a[68:71], a[212:215], v[250:253]
    ds_read_b64_tr_b16 a[206:207], v37 offset:34816
    s_waitcnt vmcnt(14) lgkmcnt(8)
    v_mfma_f32_16x16x32_bf16 v[182:185], a[72:75], a[216:219], v[182:185]
    ds_read_b64_tr_b16 a[208:209], v36 offset:32768
    buffer_load_dwordx4 v62, s[24:27], s64 offen offset:3072 lds
    v_mfma_f32_16x16x32_bf16 v[186:189], a[76:79], a[216:219], v[186:189]
    ds_read_b64_tr_b16 a[210:211], v36 offset:34816
    s_add_u32 m0, s58, 65536
    v_mfma_f32_16x16x32_bf16 v[238:241], a[72:75], a[220:223], v[238:241]
    ds_read_b64_tr_b16 a[212:213], v38 offset:32768
    s_add_u32 s64, s64, 524288
    v_mfma_f32_16x16x32_bf16 v[242:245], a[76:79], a[220:223], v[242:245]
    ds_read_b64_tr_b16 a[214:215], v38 offset:34816
    s_waitcnt lgkmcnt(8)
    v_mfma_f32_16x16x32_bf16 v[190:193], a[72:75], a[224:227], v[190:193]
    ds_read_b64_tr_b16 a[216:217], v35 offset:36864
    s_cmp_eq_u32 s64, 3670016
    v_mfma_f32_16x16x32_bf16 v[194:197], a[76:79], a[224:227], v[194:197]
    ds_read_b64_tr_b16 a[218:219], v35 offset:38912
    s_cselect_b32 s64, 0, s64
    buffer_load_dwordx4 v59, s[24:27], s64 offen lds
    v_mfma_f32_16x16x32_bf16 v[246:249], a[72:75], a[228:231], v[246:249]
    ds_read_b64_tr_b16 a[220:221], v37 offset:36864
    v_mfma_f32_16x16x32_bf16 v[250:253], a[76:79], a[228:231], v[250:253]
    ds_read_b64_tr_b16 a[222:223], v37 offset:38912
    s_waitcnt vmcnt(14) lgkmcnt(8)
    v_mfma_f32_16x16x32_bf16 v[182:185], a[80:83], a[200:203], v[182:185]
    ds_read_b64_tr_b16 a[224:225], v36 offset:36864
    buffer_load_dwordx4 v60, s[24:27], s64 offen offset:1024 lds
    v_mfma_f32_16x16x32_bf16 v[186:189], a[84:87], a[200:203], v[186:189]
    ds_read_b64_tr_b16 a[226:227], v36 offset:38912
    v_mfma_f32_16x16x32_bf16 v[238:241], a[80:83], a[204:207], v[238:241]
    ds_read_b64_tr_b16 a[228:229], v38 offset:36864
    v_mfma_f32_16x16x32_bf16 v[242:245], a[84:87], a[204:207], v[242:245]
    ds_read_b64_tr_b16 a[230:231], v38 offset:38912
    s_waitcnt lgkmcnt(8)
    v_mfma_f32_16x16x32_bf16 v[190:193], a[80:83], a[208:211], v[190:193]
    ds_read_b64_tr_b16 a[200:201], v35 offset:49152
    buffer_load_dwordx4 v61, s[24:27], s64 offen offset:2048 lds
    v_mfma_f32_16x16x32_bf16 v[194:197], a[84:87], a[208:211], v[194:197]
    ds_read_b64_tr_b16 a[202:203], v35 offset:51200
    v_mfma_f32_16x16x32_bf16 v[246:249], a[80:83], a[212:215], v[246:249]
    ds_read_b64_tr_b16 a[204:205], v37 offset:49152
    v_mfma_f32_16x16x32_bf16 v[250:253], a[84:87], a[212:215], v[250:253]
    ds_read_b64_tr_b16 a[206:207], v37 offset:51200
    s_waitcnt vmcnt(14) lgkmcnt(8)
    v_mfma_f32_16x16x32_bf16 v[182:185], a[88:91], a[216:219], v[182:185]
L_pad3:
    s_cbranch_execz L_warm
    ds_read_b64_tr_b16 a[208:209], v36 offset:49152
    buffer_load_dwordx4 v62, s[24:27], s64 offen offset:3072 lds
    v_mfma_f32_16x16x32_bf16 v[186:189], a[92:95], a[216:219], v[186:189]
    ds_read_b64_tr_b16 a[210:211], v36 offset:51200
    s_add_u32 m0, s58, 81920
    v_mfma_f32_16x16x32_bf16 v[238:241], a[88:91], a[220:223], v[238:241]
    ds_read_b64_tr_b16 a[212:213], v38 offset:49152
    s_add_u32 s64, s64, 524288
    v_mfma_f32_16x16x32_bf16 v[242:245], a[92:95], a[220:223], v[242:245]
    ds_read_b64_tr_b16 a[214:215], v38 offset:51200
    s_waitcnt lgkmcnt(8)
    v_mfma_f32_16x16x32_bf16 v[190:193], a[88:91], a[224:227], v[190:193]
    ds_read_b64_tr_b16 a[216:217], v35 offset:53248
    s_cmp_eq_u32 s64, 3670016
    s_cselect_b32 s64, 0, s64
    buffer_load_dwordx4 v59, s[24:27], s64 offen lds
    v_mfma_f32_16x16x32_bf16 v[194:197], a[92:95], a[224:227], v[194:197]
    ds_read_b64_tr_b16 a[218:219], v35 offset:55296
    v_mfma_f32_16x16x32_bf16 v[246:249], a[88:91], a[228:231], v[246:249]
    ds_read_b64_tr_b16 a[220:221], v37 offset:53248
    buffer_load_dwordx4 v60, s[24:27], s64 offen offset:1024 lds
    v_mfma_f32_16x16x32_bf16 v[250:253], a[92:95], a[228:231], v[250:253]
    ds_read_b64_tr_b16 a[222:223], v37 offset:55296
    s_waitcnt vmcnt(15) lgkmcnt(8)
    v_mfma_f32_16x16x32_bf16 v[182:185], a[96:99], a[200:203], v[182:185]
    ds_read_b64_tr_b16 a[224:225], v36 offset:53248
    v_mfma_f32_16x16x32_bf16 v[186:189], a[100:103], a[200:203], v[186:189]
    ds_read_b64_tr_b16 a[226:227], v36 offset:55296
    v_mfma_f32_16x16x32_bf16 v[238:241], a[96:99], a[204:207], v[238:241]
    ds_read_b64_tr_b16 a[228:229], v38 offset:53248
    buffer_load_dwordx4 v61, s[24:27], s64 offen offset:2048 lds
    v_mfma_f32_16x16x32_bf16 v[242:245], a[100:103], a[204:207], v[242:245]
    ds_read_b64_tr_b16 a[230:231], v38 offset:55296
    s_waitcnt lgkmcnt(8)
    v_mfma_f32_16x16x32_bf16 v[190:193], a[96:99], a[208:211], v[190:193]
    ds_read_b64_tr_b16 a[200:201], v31 offset:0
    v_mfma_f32_16x16x32_bf16 v[194:197], a[100:103], a[208:211], v[194:197]
    ds_read_b64_tr_b16 a[202:203], v31 offset:2048
    v_mfma_f32_16x16x32_bf16 v[246:249], a[96:99], a[212:215], v[246:249]
    ds_read_b64_tr_b16 a[204:205], v33 offset:0
    buffer_load_dwordx4 v62, s[24:27], s64 offen offset:3072 lds
    v_mfma_f32_16x16x32_bf16 v[250:253], a[100:103], a[212:215], v[250:253]
    ds_read_b64_tr_b16 a[206:207], v33 offset:2048
    s_waitcnt vmcnt(15) lgkmcnt(8)
    v_mfma_f32_16x16x32_bf16 v[182:185], a[104:107], a[216:219], v[182:185]
    ds_read_b64_tr_b16 a[208:209], v32 offset:0
    s_add_u32 m0, s58, 32768
    v_mfma_f32_16x16x32_bf16 v[186:189], a[108:111], a[216:219], v[186:189]
    ds_read_b64_tr_b16 a[210:211], v32 offset:2048
    s_add_u32 s64, s64, 524288
    v_mfma_f32_16x16x32_bf16 v[238:241], a[104:107], a[220:223], v[238:241]
    ds_read_b64_tr_b16 a[212:213], v34 offset:0
    s_cmp_eq_u32 s64, 3670016
    v_mfma_f32_16x16x32_bf16 v[242:245], a[108:111], a[220:223], v[242:245]
    ds_read_b64_tr_b16 a[214:215], v34 offset:2048
    s_cselect_b32 s64, 0, s64
    buffer_load_dwordx4 v59, s[24:27], s64 offen lds
    s_waitcnt lgkmcnt(8)
    v_mfma_f32_16x16x32_bf16 v[190:193], a[104:107], a[224:227], v[190:193]
    ds_read_b64_tr_b16 a[216:217], v31 offset:4096
    v_mfma_f32_16x16x32_bf16 v[194:197], a[108:111], a[224:227], v[194:197]
    ds_read_b64_tr_b16 a[218:219], v31 offset:6144
    buffer_load_dwordx4 v60, s[24:27], s64 offen offset:1024 lds
    v_mfma_f32_16x16x32_bf16 v[246:249], a[104:107], a[228:231], v[246:249]
    ds_read_b64_tr_b16 a[220:221], v33 offset:4096
    v_mfma_f32_16x16x32_bf16 v[250:253], a[108:111], a[228:231], v[250:253]
    ds_read_b64_tr_b16 a[222:223], v33 offset:6144
    s_waitcnt lgkmcnt(8)
    v_mfma_f32_16x16x32_bf16 v[150:153], a[0:3], a[200:203], 0
    ds_read_b64_tr_b16 a[224:225], v32 offset:4096
    v_mfma_f32_16x16x32_bf16 v[154:157], a[4:7], a[200:203], 0
    ds_read_b64_tr_b16 a[226:227], v32 offset:6144
    buffer_load_dwordx4 v61, s[24:27], s64 offen offset:2048 lds
    v_mfma_f32_16x16x32_bf16 v[166:169], a[0:3], a[204:207], 0
    ds_read_b64_tr_b16 a[228:229], v34 offset:4096
    v_cvt_pk_bf16_f32 v182, v182, v183
    v_mfma_f32_16x16x32_bf16 v[170:173], a[4:7], a[204:207], 0
    ds_read_b64_tr_b16 a[230:231], v34 offset:6144
    v_cvt_pk_bf16_f32 v183, v184, v185
    v_cvt_pk_bf16_f32 v184, v186, v187
    s_waitcnt lgkmcnt(8)
    v_mfma_f32_16x16x32_bf16 v[158:161], a[0:3], a[208:211], 0
    s_waitcnt vmcnt(15)
    s_barrier
    s_load_dword s14, s[28:29], s39
    ds_read_b64_tr_b16 a[200:201], v39 offset:0
    buffer_load_dwordx4 v62, s[24:27], s64 offen offset:3072 lds
    v_mfma_f32_16x16x32_bf16 v[162:165], a[4:7], a[208:211], 0
    ds_read_b64_tr_b16 a[202:203], v39 offset:2048
    s_add_u32 m0, s58, 49152
    v_cvt_pk_bf16_f32 v185, v188, v189
    buffer_store_dwordx4 v[182:185], v21, s[28:31], 0 offen offset:0 sc1
    v_cvt_pk_bf16_f32 v190, v190, v191
    v_cvt_pk_bf16_f32 v191, v192, v193
    v_cvt_pk_bf16_f32 v192, v194, v195
    v_mfma_f32_16x16x32_bf16 v[174:177], a[0:3], a[212:215], 0
    ds_read_b64_tr_b16 a[204:205], v41 offset:0
    s_add_u32 s66, s66, 1
    v_mfma_f32_16x16x32_bf16 v[178:181], a[4:7], a[212:215], 0
    ds_read_b64_tr_b16 a[206:207], v41 offset:2048
    v_cvt_pk_bf16_f32 v193, v196, v197
    buffer_store_dwordx4 v[190:193], v21, s[28:31], 0 offen offset:1024 sc1
    v_cvt_pk_bf16_f32 v238, v238, v239
    v_cvt_pk_bf16_f32 v239, v240, v241
    v_cvt_pk_bf16_f32 v240, v242, v243
    s_waitcnt lgkmcnt(8)
    v_mfma_f32_16x16x32_bf16 v[150:153], a[8:11], a[216:219], v[150:153]
    ds_read_b64_tr_b16 a[208:209], v40 offset:0
    s_and_b32 s66, s66, 3
    v_mfma_f32_16x16x32_bf16 v[154:157], a[12:15], a[216:219], v[154:157]
    ds_read_b64_tr_b16 a[210:211], v40 offset:2048
    s_mul_i32 s61, s66, 100352
    buffer_load_dwordx4 v63, s[16:19], s61 offen lds
    v_cvt_pk_bf16_f32 v241, v244, v245
    buffer_store_dwordx4 v[238:241], v21, s[28:31], 0 offen offset:2048 sc1
    v_cvt_pk_bf16_f32 v246, v246, v247
    v_cvt_pk_bf16_f32 v247, v248, v249
    v_cvt_pk_bf16_f32 v248, v250, v251
    v_mfma_f32_16x16x32_bf16 v[166:169], a[8:11], a[220:223], v[166:169]
    ds_read_b64_tr_b16 a[212:213], v42 offset:0
    v_cvt_pk_bf16_f32 v249, v252, v253
    v_mfma_f32_16x16x32_bf16 v[170:173], a[12:15], a[220:223], v[170:173]
    ds_read_b64_tr_b16 a[214:215], v42 offset:2048
    s_waitcnt lgkmcnt(8)
    v_mfma_f32_16x16x32_bf16 v[158:161], a[8:11], a[224:227], v[158:161]
    ds_read_b64_tr_b16 a[216:217], v39 offset:4096
    buffer_load_dwordx4 v64, s[16:19], s61 offen offset:1024 lds
    v_mfma_f32_16x16x32_bf16 v[162:165], a[12:15], a[224:227], v[162:165]
    ds_read_b64_tr_b16 a[218:219], v39 offset:6144
    s_add_u32 s61, s61, 48128
    buffer_store_dwordx4 v[246:249], v21, s[28:31], 0 offen offset:3072 sc1
    v_mfma_f32_16x16x32_bf16 v[174:177], a[8:11], a[228:231], v[174:177]
    ds_read_b64_tr_b16 a[220:221], v41 offset:4096
    v_mfma_f32_16x16x32_bf16 v[178:181], a[12:15], a[228:231], v[178:181]
    ds_read_b64_tr_b16 a[222:223], v41 offset:6144
    s_waitcnt lgkmcnt(8)
    v_mfma_f32_16x16x32_bf16 v[150:153], a[16:19], a[200:203], v[150:153]
    ds_read_b64_tr_b16 a[224:225], v40 offset:4096
    buffer_load_dwordx4 v63, s[16:19], s61 offen offset:2048 lds
    v_mfma_f32_16x16x32_bf16 v[154:157], a[20:23], a[200:203], v[154:157]
    ds_read_b64_tr_b16 a[226:227], v40 offset:6144
    v_mfma_f32_16x16x32_bf16 v[166:169], a[16:19], a[204:207], v[166:169]
    ds_read_b64_tr_b16 a[228:229], v42 offset:4096
    v_mfma_f32_16x16x32_bf16 v[170:173], a[20:23], a[204:207], v[170:173]
    ds_read_b64_tr_b16 a[230:231], v42 offset:6144
    s_waitcnt lgkmcnt(8)
    v_mfma_f32_16x16x32_bf16 v[158:161], a[16:19], a[208:211], v[158:161]
    ds_read_b64_tr_b16 a[200:201], v39 offset:16384
    buffer_load_dwordx4 v64, s[16:19], s61 offen offset:3072 lds
    v_mfma_f32_16x16x32_bf16 v[162:165], a[20:23], a[208:211], v[162:165]
    ds_read_b64_tr_b16 a[202:203], v39 offset:18432
    s_add_u32 m0, s58, 98304
    v_mfma_f32_16x16x32_bf16 v[174:177], a[16:19], a[212:215], v[174:177]
    ds_read_b64_tr_b16 a[204:205], v41 offset:16384
    s_add_u32 s66, s66, 1
    v_mfma_f32_16x16x32_bf16 v[178:181], a[20:23], a[212:215], v[178:181]
    ds_read_b64_tr_b16 a[206:207], v41 offset:18432
    s_waitcnt lgkmcnt(8)
    v_mfma_f32_16x16x32_bf16 v[150:153], a[24:27], a[216:219], v[150:153]
    ds_read_b64_tr_b16 a[208:209], v40 offset:16384
    s_and_b32 s66, s66, 3
    v_mfma_f32_16x16x32_bf16 v[154:157], a[28:31], a[216:219], v[154:157]
    ds_read_b64_tr_b16 a[210:211], v40 offset:18432
    s_mul_i32 s61, s66, 100352
    buffer_load_dwordx4 v63, s[16:19], s61 offen lds
    v_mfma_f32_16x16x32_bf16 v[166:169], a[24:27], a[220:223], v[166:169]
    ds_read_b64_tr_b16 a[212:213], v42 offset:16384
    v_mfma_f32_16x16x32_bf16 v[170:173], a[28:31], a[220:223], v[170:173]
    ds_read_b64_tr_b16 a[214:215], v42 offset:18432
    s_waitcnt lgkmcnt(8)
    v_mfma_f32_16x16x32_bf16 v[158:161], a[24:27], a[224:227], v[158:161]
    ds_read_b64_tr_b16 a[216:217], v39 offset:20480
    buffer_load_dwordx4 v64, s[16:19], s61 offen offset:1024 lds
    v_mfma_f32_16x16x32_bf16 v[162:165], a[28:31], a[224:227], v[162:165]
    ds_read_b64_tr_b16 a[218:219], v39 offset:22528
    s_add_u32 s61, s61, 48128
    v_mfma_f32_16x16x32_bf16 v[174:177], a[24:27], a[228:231], v[174:177]
    ds_read_b64_tr_b16 a[220:221], v41 offset:20480
    v_mfma_f32_16x16x32_bf16 v[178:181], a[28:31], a[228:231], v[178:181]
    ds_read_b64_tr_b16 a[222:223], v41 offset:22528
    s_waitcnt lgkmcnt(8)
    v_mfma_f32_16x16x32_bf16 v[150:153], a[32:35], a[200:203], v[150:153]
    ds_read_b64_tr_b16 a[224:225], v40 offset:20480
    buffer_load_dwordx4 v63, s[16:19], s61 offen offset:2048 lds
    v_mfma_f32_16x16x32_bf16 v[154:157], a[36:39], a[200:203], v[154:157]
    ds_read_b64_tr_b16 a[226:227], v40 offset:22528
    v_mfma_f32_16x16x32_bf16 v[166:169], a[32:35], a[204:207], v[166:169]
    ds_read_b64_tr_b16 a[228:229], v42 offset:20480
    v_mfma_f32_16x16x32_bf16 v[170:173], a[36:39], a[204:207], v[170:173]
    ds_read_b64_tr_b16 a[230:231], v42 offset:22528
    s_waitcnt lgkmcnt(8)
    v_mfma_f32_16x16x32_bf16 v[158:161], a[32:35], a[208:211], v[158:161]
    s_waitcnt vmcnt(19)
    s_barrier
    ds_read_b64_tr_b16 a[200:201], v31 offset:16384
    buffer_load_dwordx4 v64, s[16:19], s61 offen offset:3072 lds
    v_mfma_f32_16x16x32_bf16 v[162:165], a[36:39], a[208:211], v[162:165]
    ds_read_b64_tr_b16 a[202:203], v31 offset:18432
    s_add_u32 m0, s58, 114688
    v_mfma_f32_16x16x32_bf16 v[174:177], a[32:35], a[212:215], v[174:177]
    ds_read_b64_tr_b16 a[204:205], v33 offset:16384
    s_add_u32 s66, s66, 1
    v_mfma_f32_16x16x32_bf16 v[178:181], a[36:39], a[212:215], v[178:181]
    ds_read_b64_tr_b16 a[206:207], v33 offset:18432
    s_waitcnt lgkmcnt(8)
    v_mfma_f32_16x16x32_bf16 v[150:153], a[40:43], a[216:219], v[150:153]
    ds_read_b64_tr_b16 a[208:209], v32 offset:16384
    s_and_b32 s66, s66, 3
    s_mul_i32 s61, s66, 100352
    buffer_load_dwordx4 v63, s[16:19], s61 offen lds
    v_mfma_f32_16x16x32_bf16 v[154:157], a[44:47], a[216:219], v[154:157]
    ds_read_b64_tr_b16 a[210:211], v32 offset:18432
    v_mfma_f32_16x16x32_bf16 v[166:169], a[40:43], a[220:223], v[166:169]
    ds_read_b64_tr_b16 a[212:213], v34 offset:16384
    buffer_load_dwordx4 v64, s[16:19], s61 offen offset:1024 lds
    v_mfma_f32_16x16x32_bf16 v[170:173], a[44:47], a[220:223], v[170:173]
    ds_read_b64_tr_b16 a[214:215], v34 offset:18432
    s_waitcnt lgkmcnt(8)
    v_mfma_f32_16x16x32_bf16 v[158:161], a[40:43], a[224:227], v[158:161]
    ds_read_b64_tr_b16 a[216:217], v31 offset:20480
    s_add_u32 s61, s61, 48128
    v_mfma_f32_16x16x32_bf16 v[162:165], a[44:47], a[224:227], v[162:165]
    ds_read_b64_tr_b16 a[218:219], v31 offset:22528
    v_mfma_f32_16x16x32_bf16 v[174:177], a[40:43], a[228:231], v[174:177]
    ds_read_b64_tr_b16 a[220:221], v33 offset:20480
    buffer_load_dwordx4 v63, s[16:19], s61 offen offset:2048 lds
    v_mfma_f32_16x16x32_bf16 v[178:181], a[44:47], a[228:231], v[178:181]
    ds_read_b64_tr_b16 a[222:223], v33 offset:22528
    s_waitcnt lgkmcnt(8)
    v_mfma_f32_16x16x32_bf16 v[150:153], a[48:51], a[200:203], v[150:153]
    s_waitcnt lgkmcnt(0)
    s_cmp_ge_u32 s14, 8
    s_cbranch_scc0 L_pollin6
L_pollok6:
    ds_read_b64_tr_b16 a[224:225], v32 offset:20480
    v_mfma_f32_16x16x32_bf16 v[154:157], a[52:55], a[200:203], v[154:157]
    ds_read_b64_tr_b16 a[226:227], v32 offset:22528
    buffer_load_dwordx4 v64, s[16:19], s61 offen offset:3072 lds
    v_mfma_f32_16x16x32_bf16 v[166:169], a[48:51], a[204:207], v[166:169]
    ds_read_b64_tr_b16 a[228:229], v34 offset:20480
    s_add_u32 m0, s58, 0
    v_mfma_f32_16x16x32_bf16 v[170:173], a[52:55], a[204:207], v[170:173]
    ds_read_b64_tr_b16 a[230:231], v34 offset:22528
    v_mfma_f32_16x16x32_bf16 v[158:161], a[48:51], a[208:211], v[158:161]
    s_waitcnt vmcnt(10)
    s_atomic_add s36, s[28:29], s55
    ds_read_b64_tr_b16 a[200:201], v35 offset:0
    s_add_u32 s51, s51, 1
    v_mfma_f32_16x16x32_bf16 v[162:165], a[52:55], a[208:211], v[162:165]
    ds_read_b64_tr_b16 a[202:203], v35 offset:2048
    s_and_b32 s51, s51, 3
    v_mfma_f32_16x16x32_bf16 v[174:177], a[48:51], a[212:215], v[174:177]
    ds_read_b64_tr_b16 a[204:205], v37 offset:0
    s_lshl_b32 s61, s51, 12
    buffer_load_dwordx4 v65, s[28:31], s61 offen sc1 lds
    v_mfma_f32_16x16x32_bf16 v[178:181], a[52:55], a[212:215], v[178:181]
    ds_read_b64_tr_b16 a[206:207], v37 offset:2048
    v_mfma_f32_16x16x32_bf16 v[150:153], a[56:59], a[216:219], v[150:153]
    ds_read_b64_tr_b16 a[208:209], v36 offset:0
    buffer_load_dwordx4 v66, s[28:31], s61 offen offset:1024 sc1 lds
    v_mfma_f32_16x16x32_bf16 v[154:157], a[60:63], a[216:219], v[154:157]
    ds_read_b64_tr_b16 a[210:211], v36 offset:2048
    v_mfma_f32_16x16x32_bf16 v[166:169], a[56:59], a[220:223], v[166:169]
    ds_read_b64_tr_b16 a[212:213], v38 offset:0
    v_mfma_f32_16x16x32_bf16 v[170:173], a[60:63], a[220:223], v[170:173]
    ds_read_b64_tr_b16 a[214:215], v38 offset:2048
    s_waitcnt lgkmcnt(8)
    v_mfma_f32_16x16x32_bf16 v[158:161], a[56:59], a[224:227], v[158:161]
    ds_read_b64_tr_b16 a[216:217], v35 offset:4096
    buffer_load_dwordx4 v65, s[28:31], s61 offen offset:2048 sc1 lds
    v_mfma_f32_16x16x32_bf16 v[162:165], a[60:63], a[224:227], v[162:165]
    ds_read_b64_tr_b16 a[218:219], v35 offset:6144
    v_mfma_f32_16x16x32_bf16 v[174:177], a[56:59], a[228:231], v[174:177]
    ds_read_b64_tr_b16 a[220:221], v37 offset:4096
    buffer_load_dwordx4 v66, s[28:31], s61 offen offset:3072 sc1 lds
    v_mfma_f32_16x16x32_bf16 v[178:181], a[60:63], a[228:231], v[178:181]
    ds_read_b64_tr_b16 a[222:223], v37 offset:6144
    s_waitcnt lgkmcnt(8)
    v_mfma_f32_16x16x32_bf16 v[150:153], a[64:67], a[200:203], v[150:153]
    ds_read_b64_tr_b16 a[224:225], v36 offset:4096
    s_add_u32 m0, s58, 131072
    v_mfma_f32_16x16x32_bf16 v[154:157], a[68:71], a[200:203], v[154:157]
    ds_read_b64_tr_b16 a[226:227], v36 offset:6144
    s_add_u32 s51, s51, 1
    v_mfma_f32_16x16x32_bf16 v[166:169], a[64:67], a[204:207], v[166:169]
    ds_read_b64_tr_b16 a[228:229], v38 offset:4096
    s_and_b32 s51, s51, 3
    s_lshl_b32 s61, s51, 12
    buffer_load_dwordx4 v65, s[28:31], s61 offen sc1 lds
    v_mfma_f32_16x16x32_bf16 v[170:173], a[68:71], a[204:207], v[170:173]
    ds_read_b64_tr_b16 a[230:231], v38 offset:6144
    s_waitcnt lgkmcnt(8)
    v_mfma_f32_16x16x32_bf16 v[158:161], a[64:67], a[208:211], v[158:161]
    s_barrier
    ds_read_b64_tr_b16 a[200:201], v35 offset:16384
    buffer_load_dwordx4 v66, s[28:31], s61 offen offset:1024 sc1 lds
    v_mfma_f32_16x16x32_bf16 v[162:165], a[68:71], a[208:211], v[162:165]
    ds_read_b64_tr_b16 a[202:203], v35 offset:18432
    v_mfma_f32_16x16x32_bf16 v[174:177], a[64:67], a[212:215], v[174:177]
    ds_read_b64_tr_b16 a[204:205], v37 offset:16384
    buffer_load_dwordx4 v65, s[28:31], s61 offen offset:2048 sc1 lds
    v_mfma_f32_16x16x32_bf16 v[178:181], a[68:71], a[212:215], v[178:181]
    ds_read_b64_tr_b16 a[206:207], v37 offset:18432
    s_waitcnt lgkmcnt(8)
    v_mfma_f32_16x16x32_bf16 v[150:153], a[72:75], a[216:219], v[150:153]
    ds_read_b64_tr_b16 a[208:209], v36 offset:16384
    v_mfma_f32_16x16x32_bf16 v[154:157], a[76:79], a[216:219], v[154:157]
    ds_read_b64_tr_b16 a[210:211], v36 offset:18432
    buffer_load_dwordx4 v66, s[28:31], s61 offen offset:3072 sc1 lds
    v_mfma_f32_16x16x32_bf16 v[166:169], a[72:75], a[220:223], v[166:169]
    ds_read_b64_tr_b16 a[212:213], v38 offset:16384
    s_add_u32 m0, s58, 147456
    v_mfma_f32_16x16x32_bf16 v[170:173], a[76:79], a[220:223], v[170:173]
    ds_read_b64_tr_b16 a[214:215], v38 offset:18432
    s_waitcnt lgkmcnt(8)
    v_mfma_f32_16x16x32_bf16 v[158:161], a[72:75], a[224:227], v[158:161]
    ds_read_b64_tr_b16 a[216:217], v35 offset:20480
    s_add_u32 s51, s51, 1
    v_mfma_f32_16x16x32_bf16 v[162:165], a[76:79], a[224:227], v[162:165]
    ds_read_b64_tr_b16 a[218:219], v35 offset:22528
    s_and_b32 s51, s51, 3
    v_mfma_f32_16x16x32_bf16 v[174:177], a[72:75], a[228:231], v[174:177]
    ds_read_b64_tr_b16 a[220:221], v37 offset:20480
    s_lshl_b32 s61, s51, 12
    buffer_load_dwordx4 v65, s[28:31], s61 offen sc1 lds
    v_mfma_f32_16x16x32_bf16 v[178:181], a[76:79], a[228:231], v[178:181]
    ds_read_b64_tr_b16 a[222:223], v37 offset:22528
    s_waitcnt lgkmcnt(8)
    v_mfma_f32_16x16x32_bf16 v[150:153], a[80:83], a[200:203], v[150:153]
    ds_read_b64_tr_b16 a[224:225], v36 offset:20480
    buffer_load_dwordx4 v66, s[28:31], s61 offen offset:1024 sc1 lds
    v_mfma_f32_16x16x32_bf16 v[154:157], a[84:87], a[200:203], v[154:157]
    ds_read_b64_tr_b16 a[226:227], v36 offset:22528
    v_mfma_f32_16x16x32_bf16 v[166:169], a[80:83], a[204:207], v[166:169]
    ds_read_b64_tr_b16 a[228:229], v38 offset:20480
    v_mfma_f32_16x16x32_bf16 v[170:173], a[84:87], a[204:207], v[170:173]
    ds_read_b64_tr_b16 a[230:231], v38 offset:22528
    s_waitcnt lgkmcnt(8)
    v_mfma_f32_16x16x32_bf16 v[158:161], a[80:83], a[208:211], v[158:161]
    s_barrier
    ds_read_b64_tr_b16 a[200:201], v31 offset:32768
    buffer_load_dwordx4 v65, s[28:31], s61 offen offset:2048 sc1 lds
    v_mfma_f32_16x16x32_bf16 v[162:165], a[84:87], a[208:211], v[162:165]
    ds_read_b64_tr_b16 a[202:203], v31 offset:34816
    v_mfma_f32_16x16x32_bf16 v[174:177], a[80:83], a[212:215], v[174:177]
    ds_read_b64_tr_b16 a[204:205], v33 offset:32768
    buffer_load_dwordx4 v66, s[28:31], s61 offen offset:3072 sc1 lds
    v_mfma_f32_16x16x32_bf16 v[178:181], a[84:87], a[212:215], v[178:181]
    ds_read_b64_tr_b16 a[206:207], v33 offset:34816
    s_waitcnt lgkmcnt(8)
    v_mfma_f32_16x16x32_bf16 v[150:153], a[88:91], a[216:219], v[150:153]
    ds_read_b64_tr_b16 a[208:209], v32 offset:32768
    s_add_u32 m0, s58, 16384
    v_mfma_f32_16x16x32_bf16 v[154:157], a[92:95], a[216:219], v[154:157]
    ds_read_b64_tr_b16 a[210:211], v32 offset:34816
    s_add_u32 s66, s66, 1
    v_mfma_f32_16x16x32_bf16 v[166:169], a[88:91], a[220:223], v[166:169]
    ds_read_b64_tr_b16 a[212:213], v34 offset:32768
    s_and_b32 s66, s66, 3
    s_mul_i32 s61, s66, 100352
    buffer_load_dwordx4 v63, s[16:19], s61 offen lds
    v_mfma_f32_16x16x32_bf16 v[170:173], a[92:95], a[220:223], v[170:173]
    ds_read_b64_tr_b16 a[214:215], v34 offset:34816
    s_waitcnt lgkmcnt(8)
    v_mfma_f32_16x16x32_bf16 v[158:161], a[88:91], a[224:227], v[158:161]
    ds_read_b64_tr_b16 a[216:217], v31 offset:36864
    buffer_load_dwordx4 v64, s[16:19], s61 offen offset:1024 lds
    v_mfma_f32_16x16x32_bf16 v[162:165], a[92:95], a[224:227], v[162:165]
    ds_read_b64_tr_b16 a[218:219], v31 offset:38912
    s_add_u32 s61, s61, 48128
    v_mfma_f32_16x16x32_bf16 v[174:177], a[88:91], a[228:231], v[174:177]
    ds_read_b64_tr_b16 a[220:221], v33 offset:36864
    v_mfma_f32_16x16x32_bf16 v[178:181], a[92:95], a[228:231], v[178:181]
    ds_read_b64_tr_b16 a[222:223], v33 offset:38912
    s_waitcnt lgkmcnt(8)
    v_mfma_f32_16x16x32_bf16 v[150:153], a[96:99], a[200:203], v[150:153]
    ds_read_b64_tr_b16 a[224:225], v32 offset:36864
    buffer_load_dwordx4 v63, s[16:19], s61 offen offset:2048 lds
    v_mfma_f32_16x16x32_bf16 v[154:157], a[100:103], a[200:203], v[154:157]
    ds_read_b64_tr_b16 a[226:227], v32 offset:38912
    v_mfma_f32_16x16x32_bf16 v[166:169], a[96:99], a[204:207], v[166:169]
    ds_read_b64_tr_b16 a[228:229], v34 offset:36864
    buffer_load_dwordx4 v64, s[16:19], s61 offen offset:3072 lds
    v_mfma_f32_16x16x32_bf16 v[170:173], a[100:103], a[204:207], v[170:173]
    ds_read_b64_tr_b16 a[230:231], v34 offset:38912
    s_waitcnt lgkmcnt(8)
    v_mfma_f32_16x16x32_bf16 v[158:161], a[96:99], a[208:211], v[158:161]
    s_waitcnt vmcnt(12)
    s_barrier
    s_xor_b32 s55, s55, 1024
    s_load_dword s14, s[28:29], s55
    ds_read_b64_tr_b16 v[198:199], v43 offset:49152
    ds_read_b64_tr_b16 v[200:201], v43 offset:53248
    v_mfma_f32_16x16x32_bf16 v[162:165], a[100:103], a[208:211], v[162:165]
    ds_read_b64_tr_b16 v[202:203], v44 offset:49152
    s_add_u32 m0, s58, 65536
    s_add_u32 s51, s51, 1
    s_and_b32 s51, s51, 3
    s_lshl_b32 s61, s51, 12
    buffer_load_dwordx4 v65, s[28:31], s61 offen sc1 lds
    v_mfma_f32_16x16x32_bf16 v[174:177], a[96:99], a[212:215], v[174:177]
    ds_read_b64_tr_b16 v[204:205], v44 offset:53248
    v_mfma_f32_16x16x32_bf16 v[178:181], a[100:103], a[212:215], v[178:181]
    ds_read_b128 a[200:203], v47 offset:0
    s_waitcnt lgkmcnt(9)
    v_mfma_f32_16x16x32_bf16 v[150:153], a[104:107], a[216:219], v[150:153]
    ds_read_b128 a[204:207], v48 offset:0
    buffer_load_dwordx4 v66, s[28:31], s61 offen offset:1024 sc1 lds
    v_mfma_f32_16x16x32_bf16 v[154:157], a[108:111], a[216:219], v[154:157]
    ds_read_b128 a[208:211], v47 offset:1024
    v_mfma_f32_16x16x32_bf16 v[166:169], a[104:107], a[220:223], v[166:169]
    ds_read_b128 a[212:215], v48 offset:1024
    buffer_load_dwordx4 v65, s[28:31], s61 offen offset:2048 sc1 lds
    v_mfma_f32_16x16x32_bf16 v[170:173], a[108:111], a[220:223], v[170:173]
    s_waitcnt lgkmcnt(8)
    v_mfma_f32_16x16x32_bf16 v[158:161], a[104:107], a[224:227], v[158:161]
    ds_read_b64_tr_b16 v[206:207], v43 offset:51200
    ds_read_b64_tr_b16 v[208:209], v43 offset:55296
    v_mfma_f32_16x16x32_bf16 v[162:165], a[108:111], a[224:227], v[162:165]
    ds_read_b64_tr_b16 v[210:211], v44 offset:51200
    buffer_load_dwordx4 v66, s[28:31], s61 offen offset:3072 sc1 lds
    v_mfma_f32_16x16x32_bf16 v[174:177], a[104:107], a[228:231], v[174:177]
    ds_read_b64_tr_b16 v[212:213], v44 offset:55296
    v_mfma_f32_16x16x32_bf16 v[178:181], a[108:111], a[228:231], v[178:181]
    ds_read_b128 a[216:219], v47 offset:2048
    s_waitcnt lgkmcnt(7)
    v_mfma_f32_16x16x32_bf16 v[150:153], v[198:201], a[200:203], v[150:153]
    ds_read_b128 a[220:223], v48 offset:2048
    v_mfma_f32_16x16x32_bf16 v[154:157], v[202:205], a[200:203], v[154:157]
    ds_read_b128 a[224:227], v47 offset:3072
    v_mfma_f32_16x16x32_bf16 v[166:169], v[198:201], a[204:207], v[166:169]
    ds_read_b128 a[228:231], v48 offset:3072
    v_mfma_f32_16x16x32_bf16 v[170:173], v[202:205], a[204:207], v[170:173]
    s_waitcnt lgkmcnt(8)
    v_mfma_f32_16x16x32_bf16 v[158:161], v[198:201], a[208:211], v[158:161]
    s_waitcnt vmcnt(12)
    s_barrier
    ds_read_b64_tr_b16 v[214:215], v45 offset:32768
    ds_read_b64_tr_b16 v[216:217], v45 offset:36864
    v_mfma_f32_16x16x32_bf16 v[162:165], v[202:205], a[208:211], v[162:165]
    ds_read_b64_tr_b16 v[218:219], v46 offset:32768
    v_mfma_f32_16x16x32_bf16 v[174:177], v[198:201], a[212:215], v[174:177]
    ds_read_b64_tr_b16 v[220:221], v46 offset:36864
    v_mfma_f32_16x16x32_bf16 v[178:181], v[202:205], a[212:215], v[178:181]
    ds_read_b128 a[200:203], v51 offset:0
    s_waitcnt lgkmcnt(7)
    v_mfma_f32_16x16x32_bf16 v[150:153], v[206:209], a[216:219], v[150:153]
    ds_read_b128 a[204:207], v52 offset:0
    v_mfma_f32_16x16x32_bf16 v[154:157], v[210:213], a[216:219], v[154:157]
    ds_read_b128 a[208:211], v51 offset:1024
    v_mfma_f32_16x16x32_bf16 v[166:169], v[206:209], a[220:223], v[166:169]
    ds_read_b128 a[212:215], v52 offset:1024
    v_mfma_f32_16x16x32_bf16 v[170:173], v[210:213], a[220:223], v[170:173]
    s_waitcnt lgkmcnt(8)
    v_mfma_f32_16x16x32_bf16 v[158:161], v[206:209], a[224:227], v[158:161]
    s_waitcnt lgkmcnt(0)
    s_cmp_ge_u32 s14, 1
    s_cbranch_scc0 L_pollin7
L_pollok7:
    v_xor_b32 v21, 131072, v21
    ds_read_b64_tr_b16 v[198:199], v45 offset:34816
    ds_read_b64_tr_b16 v[200:201], v45 offset:38912
    buffer_load_dwordx4 v[246:249], v21, s[28:31], 0 offen offset:2048 sc1
    v_mfma_f32_16x16x32_bf16 v[162:165], v[210:213], a[224:227], v[162:165]
    ds_read_b64_tr_b16 v[202:203], v46 offset:34816
    buffer_load_dwordx4 v[250:253], v21, s[28:31], 0 offen offset:3072 sc1
    v_mfma_f32_16x16x32_bf16 v[174:177], v[206:209], a[228:231], v[174:177]
    ds_read_b64_tr_b16 v[204:205], v46 offset:38912
    v_mfma_f32_16x16x32_bf16 v[178:181], v[210:213], a[228:231], v[178:181]
    ds_read_b128 a[216:219], v51 offset:2048
    v_mfma_f32_16x16x32_bf16 v[150:153], v[214:217], a[200:203], v[150:153]
    ds_read_b128 a[220:223], v52 offset:2048
    buffer_load_dwordx4 v[238:241], v21, s[28:31], 0 offen offset:0 sc1
    v_mfma_f32_16x16x32_bf16 v[154:157], v[218:221], a[200:203], v[154:157]
    ds_read_b128 a[224:227], v51 offset:3072
    buffer_load_dwordx4 v[242:245], v21, s[28:31], 0 offen offset:1024 sc1
    v_mfma_f32_16x16x32_bf16 v[166:169], v[214:217], a[204:207], v[166:169]
    ds_read_b128 a[228:231], v52 offset:3072
    v_mfma_f32_16x16x32_bf16 v[170:173], v[218:221], a[204:207], v[170:173]
    v_mfma_f32_16x16x32_bf16 v[158:161], v[214:217], a[208:211], v[158:161]
    s_waitcnt vmcnt(12)
    s_barrier
    ds_read_b64_tr_b16 v[206:207], v45 offset:49152
    ds_read_b64_tr_b16 v[208:209], v45 offset:53248
    v_mfma_f32_16x16x32_bf16 v[162:165], v[218:221], a[208:211], v[162:165]
    ds_read_b64_tr_b16 v[210:211], v46 offset:49152
    v_mfma_f32_16x16x32_bf16 v[174:177], v[214:217], a[212:215], v[174:177]
    ds_read_b64_tr_b16 v[212:213], v46 offset:53248
    v_mfma_f32_16x16x32_bf16 v[178:181], v[218:221], a[212:215], v[178:181]
    ds_read_b128 a[200:203], v51 offset:16384
    s_waitcnt lgkmcnt(7)
    v_mfma_f32_16x16x32_bf16 v[150:153], v[198:201], a[216:219], v[150:153]
    ds_read_b128 a[204:207], v52 offset:16384
    v_mfma_f32_16x16x32_bf16 v[154:157], v[202:205], a[216:219], v[154:157]
    ds_read_b128 a[208:211], v51 offset:17408
    v_mfma_f32_16x16x32_bf16 v[166:169], v[198:201], a[220:223], v[166:169]
    ds_read_b128 a[212:215], v52 offset:17408
    v_mfma_f32_16x16x32_bf16 v[170:173], v[202:205], a[220:223], v[170:173]
    s_waitcnt lgkmcnt(8)
    v_mfma_f32_16x16x32_bf16 v[158:161], v[198:201], a[224:227], v[158:161]
    ds_read_b64_tr_b16 v[214:215], v45 offset:51200
    ds_read_b64_tr_b16 v[216:217], v45 offset:55296
    v_mfma_f32_16x16x32_bf16 v[162:165], v[202:205], a[224:227], v[162:165]
    ds_read_b64_tr_b16 v[218:219], v46 offset:51200
    v_mfma_f32_16x16x32_bf16 v[174:177], v[198:201], a[228:231], v[174:177]
    ds_read_b64_tr_b16 v[220:221], v46 offset:55296
    v_mfma_f32_16x16x32_bf16 v[178:181], v[202:205], a[228:231], v[178:181]
    ds_read_b128 a[216:219], v51 offset:18432
    s_waitcnt lgkmcnt(7)
    v_mfma_f32_16x16x32_bf16 v[150:153], v[206:209], a[200:203], v[150:153]
    ds_read_b128 a[220:223], v52 offset:18432
    v_mfma_f32_16x16x32_bf16 v[154:157], v[210:213], a[200:203], v[154:157]
    ds_read_b128 a[224:227], v51 offset:19456
    v_mfma_f32_16x16x32_bf16 v[166:169], v[206:209], a[204:207], v[166:169]
    ds_read_b128 a[228:231], v52 offset:19456
    v_mfma_f32_16x16x32_bf16 v[170:173], v[210:213], a[204:207], v[170:173]
    s_waitcnt lgkmcnt(8)
    v_mfma_f32_16x16x32_bf16 v[158:161], v[206:209], a[208:211], v[158:161]
    s_waitcnt vmcnt(4)
    s_barrier
    ds_read_b64_tr_b16 v[198:199], v43 offset:16384
    ds_read_b64_tr_b16 v[200:201], v43 offset:20480
    v_mfma_f32_16x16x32_bf16 v[162:165], v[210:213], a[208:211], v[162:165]
    ds_read_b64_tr_b16 v[202:203], v44 offset:16384
    v_mfma_f32_16x16x32_bf16 v[174:177], v[206:209], a[212:215], v[174:177]
    ds_read_b64_tr_b16 v[204:205], v44 offset:20480
    v_mfma_f32_16x16x32_bf16 v[178:181], v[210:213], a[212:215], v[178:181]
    ds_read_b128 a[200:203], v50 offset:0
    s_waitcnt lgkmcnt(7)
    v_mfma_f32_16x16x32_bf16 v[150:153], v[214:217], a[216:219], v[150:153]
    ds_read_b128 a[204:207], v50 offset:1024
    ds_read_b64_tr_b16 v[206:207], v43 offset:18432
    v_mfma_f32_16x16x32_bf16 v[154:157], v[218:221], a[216:219], v[154:157]
    ds_read_b64_tr_b16 v[208:209], v43 offset:22528
    ds_read_b64_tr_b16 v[210:211], v44 offset:18432
    v_mfma_f32_16x16x32_bf16 v[166:169], v[214:217], a[220:223], v[166:169]
    ds_read_b64_tr_b16 v[212:213], v44 offset:22528
    v_mfma_f32_16x16x32_bf16 v[170:173], v[218:221], a[220:223], v[170:173]
    ds_read_b128 a[208:211], v50 offset:2048
    s_waitcnt lgkmcnt(11)
    v_mfma_f32_16x16x32_bf16 v[158:161], v[214:217], a[224:227], v[158:161]
    ds_read_b128 a[212:215], v50 offset:3072
    v_mfma_f32_16x16x32_bf16 v[162:165], v[218:221], a[224:227], v[162:165]
    v_mfma_f32_16x16x32_bf16 v[174:177], v[214:217], a[228:231], v[174:177]
    v_mfma_f32_16x16x32_bf16 v[178:181], v[218:221], a[228:231], v[178:181]
    s_waitcnt lgkmcnt(6)
    v_mfma_f32_16x16x32_bf16 v[166:169], v[198:201], a[200:203], v[166:169]
    ds_read_b128 a[224:227], v49 offset:0
    v_mfma_f32_16x16x32_bf16 v[170:173], v[202:205], a[200:203], v[170:173]
    v_mfma_f32_16x16x32_bf16 v[174:177], v[198:201], a[204:207], v[174:177]
    ds_read_b128 a[228:231], v49 offset:1024
    v_mfma_f32_16x16x32_bf16 v[178:181], v[202:205], a[204:207], v[178:181]
    s_waitcnt lgkmcnt(2)
    v_mfma_f32_16x16x32_bf16 v[166:169], v[206:209], a[208:211], v[166:169]
    ds_read_b128 a[200:203], v49 offset:2048
    v_mfma_f32_16x16x32_bf16 v[170:173], v[210:213], a[208:211], v[170:173]
    v_mfma_f32_16x16x32_bf16 v[174:177], v[206:209], a[212:215], v[174:177]
L_pad4:
    s_cbranch_execz L_warm
    ds_read_b128 a[204:207], v49 offset:3072
    v_mfma_f32_16x16x32_bf16 v[178:181], v[210:213], a[212:215], v[178:181]
    s_waitcnt vmcnt(3)
    v_mfma_f32_16x16x32_bf16 v[166:169], a[250:253], v[246:249], v[166:169]
    v_mfma_f32_16x16x32_bf16 v[170:173], a[248:251], v[246:249], v[170:173]
    s_waitcnt vmcnt(2)
    v_mfma_f32_16x16x32_bf16 v[174:177], a[250:253], v[250:253], v[174:177]
    v_mfma_f32_16x16x32_bf16 v[178:181], a[248:251], v[250:253], v[178:181]
    s_waitcnt lgkmcnt(2)
    v_mfma_f32_16x16x32_bf16 v[150:153], v[198:201], a[224:227], v[150:153]
    v_mfma_f32_16x16x32_bf16 v[154:157], v[202:205], a[224:227], v[154:157]
    v_mfma_f32_16x16x32_bf16 v[158:161], v[198:201], a[228:231], v[158:161]
    ds_write_b128 v87, v[166:169] offset:8192
    v_mfma_f32_16x16x32_bf16 v[162:165], v[202:205], a[228:231], v[162:165]
    s_waitcnt lgkmcnt(1)
    v_mfma_f32_16x16x32_bf16 v[150:153], v[206:209], a[200:203], v[150:153]
    ds_write_b128 v88, v[170:173] offset:8192
    v_mfma_f32_16x16x32_bf16 v[154:157], v[210:213], a[200:203], v[154:157]
    v_mfma_f32_16x16x32_bf16 v[158:161], v[206:209], a[204:207], v[158:161]
    ds_write_b128 v87, v[174:177] offset:12288
    v_mfma_f32_16x16x32_bf16 v[162:165], v[210:213], a[204:207], v[162:165]
    s_waitcnt vmcnt(1)
    v_mfma_f32_16x16x32_bf16 v[150:153], a[250:253], v[238:241], v[150:153]
    ds_write_b128 v88, v[178:181] offset:12288
    v_mfma_f32_16x16x32_bf16 v[154:157], a[248:251], v[238:241], v[154:157]
    s_waitcnt vmcnt(0)
    v_mfma_f32_16x16x32_bf16 v[158:161], a[250:253], v[242:245], v[158:161]
    v_mfma_f32_16x16x32_bf16 v[162:165], a[248:251], v[242:245], v[162:165]
    s_nop 2
    ds_write_b128 v87, v[150:153] offset:0
    s_nop 0
    ds_write_b128 v88, v[154:157] offset:0
    s_nop 0
    ds_write_b128 v87, v[158:161] offset:4096
    ds_write_b128 v88, v[162:165] offset:4096
    s_waitcnt lgkmcnt(0)
    s_barrier
    ds_read_b128 v[118:121], v89 offset:0
    ds_read_b128 v[122:125], v90 offset:0
    ds_read_b128 v[126:129], v91 offset:0
    ds_read_b128 v[130:133], v92 offset:0
    ds_read_b128 v[134:137], v89 offset:2048
    ds_read_b128 v[138:141], v90 offset:2048
    ds_read_b128 v[142:145], v91 offset:2048
    ds_read_b128 v[146:149], v92 offset:2048
    s_waitcnt lgkmcnt(7)
    v_pk_add_f32 v[222:223], v[222:223], v[118:119]
    v_pk_add_f32 v[224:225], v[224:225], v[120:121]
    s_waitcnt lgkmcnt(6)
    v_pk_add_f32 v[226:227], v[226:227], v[122:123]
    v_pk_add_f32 v[228:229], v[228:229], v[124:125]
    s_waitcnt lgkmcnt(5)
    v_pk_add_f32 v[222:223], v[222:223], v[126:127]
    v_pk_add_f32 v[224:225], v[224:225], v[128:129]
    s_waitcnt lgkmcnt(4)
    v_pk_add_f32 v[226:227], v[226:227], v[130:131]
    v_pk_add_f32 v[228:229], v[228:229], v[132:133]
    v_cvt_pk_bf16_f32 v110, v222, v223
    v_cvt_pk_bf16_f32 v111, v224, v225
    v_cvt_pk_bf16_f32 v112, v226, v227
    v_cvt_pk_bf16_f32 v113, v228, v229
    buffer_store_dwordx4 v[110:113], v85, s[32:35], 0 offen
    s_waitcnt lgkmcnt(3)
    v_pk_add_f32 v[230:231], v[230:231], v[134:135]
    v_pk_add_f32 v[232:233], v[232:233], v[136:137]
    s_waitcnt lgkmcnt(2)
    v_pk_add_f32 v[234:235], v[234:235], v[138:139]
    v_pk_add_f32 v[236:237], v[236:237], v[140:141]
    s_waitcnt lgkmcnt(1)
    v_pk_add_f32 v[230:231], v[230:231], v[142:143]
    v_pk_add_f32 v[232:233], v[232:233], v[144:145]
    s_waitcnt lgkmcnt(0)
    v_pk_add_f32 v[234:235], v[234:235], v[146:147]
    v_pk_add_f32 v[236:237], v[236:237], v[148:149]
    v_cvt_pk_bf16_f32 v114, v230, v231
    v_cvt_pk_bf16_f32 v115, v232, v233
    v_cvt_pk_bf16_f32 v116, v234, v235
    v_cvt_pk_bf16_f32 v117, v236, v237
    buffer_store_dwordx4 v[114:117], v86, s[32:35], 0 offen
L_fin:
L_end:
    s_endpgm
L_nonce:
    buffer_load_dword v12, v16, s[44:47], 0 offen sc1
    s_add_u32 s60, s60, 1
    s_waitcnt vmcnt(0)
    v_readfirstlane_b32 s57, v12
    s_cmp_ge_u32 s60, 20000
    s_cbranch_scc1 L_nonce_ok
    s_cmp_eq_u32 s57, 0
    s_cbranch_scc1 L_nonce
    s_branch L_nonce_ok
L_pollin0:
    s_mov_b32 s60, 0
L_poll0:
    s_sleep 4
    buffer_load_dword v18, v20, s[28:31], 0 offen sc1
    s_add_u32 s60, s60, 1
    s_waitcnt vmcnt(0)
    v_cmp_ne_u32 vcc, s57, v18
    s_cbranch_vccz L_pollok0
    s_cmp_lt_u32 s60, 20000
    s_cbranch_scc1 L_poll0
    s_branch L_pollok0
L_pollin1:
    s_mov_b32 s60, 0
L_poll1:
    s_sleep 8
    buffer_load_dword v18, off, s[44:47], s15 sc1
    s_add_u32 s60, s60, 1
    s_waitcnt vmcnt(0)
    v_readfirstlane_b32 s14, v18
    s_nop 0
    s_cmp_ge_u32 s14, 14
    s_cbranch_scc1 L_pollok1
    s_cmp_lt_u32 s60, 20000
    s_cbranch_scc1 L_poll1
    s_branch L_pollok1
L_pollin2:
    s_mov_b32 s60, 0
L_poll2:
    s_sleep 4
    buffer_load_dword v18, off, s[28:31], s37 sc1
    s_add_u32 s60, s60, 1
    s_waitcnt vmcnt(0)
    v_readfirstlane_b32 s14, v18
    s_nop 0
    s_cmp_ge_u32 s14, 2
    s_cbranch_scc1 L_pollok2
    s_cmp_lt_u32 s60, 20000
    s_cbranch_scc1 L_poll2
    s_branch L_pollok2
L_nonceh:
    buffer_load_dword v12, v16, s[44:47], 0 offen sc1
    s_add_u32 s60, s60, 1
    s_waitcnt vmcnt(0)
    v_readfirstlane_b32 s57, v12
    s_cmp_ge_u32 s60, 20000
    s_cbranch_scc1 L_nonce_okh
    s_cmp_eq_u32 s57, 0
    s_cbranch_scc1 L_nonceh
    s_branch L_nonce_okh
L_pollin3:
    s_mov_b32 s60, 0
L_poll3:
    s_sleep 8
    buffer_load_dword v18, v20, s[28:31], 0 offen sc1
    s_add_u32 s60, s60, 1
    s_waitcnt vmcnt(0)
    v_cmp_ne_u32 vcc, s57, v18
    s_cbranch_vccz L_pollok3
    s_cmp_lt_u32 s60, 20000
    s_cbranch_scc1 L_poll3
    s_branch L_pollok3
L_pollin4:
    s_mov_b32 s60, 0
L_poll4:
    s_sleep 16
    buffer_load_dword v18, off, s[44:47], s15 sc1
    s_add_u32 s60, s60, 1
    s_waitcnt vmcnt(0)
    v_readfirstlane_b32 s14, v18
    s_nop 0
    s_cmp_ge_u32 s14, 14
    s_cbranch_scc1 L_pollok4
    s_cmp_lt_u32 s60, 20000
    s_cbranch_scc1 L_poll4
    s_branch L_pollok4
L_nog1:
    s_nop 1
    s_mov_b32 s14, 1204224
    s_mov_b32 s15, 0x20000
    s_sub_u32 s3, s2, 200
    s_cmp_lt_u32 s3, 42
    s_cselect_b32 s81, 0, 268435456
    s_cselect_b32 s3, s3, 0
    s_mul_i32 s79, s3, 43
    s_lshr_b32 s79, s79, 7
    s_mul_i32 s80, s79, 3
    s_sub_u32 s80, s3, s80
    v_min_u32 v13, 55, v1
    s_lshl_b32 s3, s79, 2
    s_add_u32 s3, s3, s48
    s_mul_i32 s3, s3, 21504
    s_mul_i32 s60, s80, 896
    s_add_u32 s3, s3, s60
    s_add_u32 s3, s3, s81
    v_lshl_add_u32 v242, v13, 4, s3
    s_mul_i32 s60, s48, 8448
    s_add_u32 m0, s60, 0
    s_mov_b32 s3, 0
    buffer_load_dwordx4 v242, s[12:15], s3 offen lds
    s_add_u32 m0, s60, 1056
    s_mov_b32 s3, 2688
    buffer_load_dwordx4 v242, s[12:15], s3 offen lds
    s_add_u32 m0, s60, 2112
    s_mov_b32 s3, 5376
    buffer_load_dwordx4 v242, s[12:15], s3 offen lds
    s_add_u32 m0, s60, 3168
    s_mov_b32 s3, 8064
    buffer_load_dwordx4 v242, s[12:15], s3 offen lds
    s_add_u32 m0, s60, 4224
    s_mov_b32 s3, 10752
    buffer_load_dwordx4 v242, s[12:15], s3 offen lds
    s_add_u32 m0, s60, 5280
    s_mov_b32 s3, 13440
    buffer_load_dwordx4 v242, s[12:15], s3 offen lds
    s_add_u32 m0, s60, 6336
    s_mov_b32 s3, 16128
    buffer_load_dwordx4 v242, s[12:15], s3 offen lds
    s_add_u32 m0, s60, 7392
    s_mov_b32 s3, 18816
    buffer_load_dwordx4 v242, s[12:15], s3 offen lds
    s_mul_i32 s53, s101, 37
    s_lshr_b32 s53, s53, 8
    s_mul_i32 s54, s53, 7
    s_sub_u32 s54, s101, s54
    s_and_b32 s53, s53, 3
    s_lshl_b32 s3, s6, 2
    s_add_u32 s53, s53, s3
    s_lshl_b32 s53, s53, 1
    s_add_u32 s53, s53, s7
    s_mov_b32 s42, 4096
    s_mov_b32 s43, 0x20000
    s_lshl_b32 s3, s53, 2
    s_add_u32 s3, s3, s48
    s_lshl_b32 s60, s3, 5
    v_lshl_add_u32 v82, v5, 1, s60
    s_mul_i32 s3, s3, 14336
    s_lshl_b32 s60, s54, 7
    s_add_u32 s3, s3, s60
    v_mul_u32_u24 v14, 896, v5
    v_lshl_add_u32 v14, v6, 4, v14
    v_add_u32 v85, s3, v14
    v_add_u32 v86, 7168, v85
    s_cmp_lt_u32 s101, 28
    s_cselect_b32 s56, 1, 0
    s_lshl_b32 s50, s7, 3
    s_and_b32 s3, s101, 7
    s_add_u32 s50, s50, s3
    s_lshr_b32 s60, s101, 3
    s_lshl_b32 s49, s6, 2
    s_add_u32 s49, s49, s60
    s_lshl_b32 s49, s49, 2
    s_add_u32 s49, s49, s48
    s_mul_i32 s60, s60, 0
    s_add_u32 s3, s3, s60
    s_sub_u32 s60, s3, 7
    s_cmp_ge_u32 s3, 7
    s_cselect_b32 s3, s60, s3
    s_lshl_b32 s62, s3, 18
    s_mul_i32 s63, s3, 12288
    s_mov_b32 s30, 20971520
    s_mov_b32 s31, 0x20000
    s_mov_b32 s75, 0x3727c5ac
    s_mov_b32 s76, 0x3b124925
    s_mov_b32 s77, 0x3f803f80
    v_lshlrev_b32 v4, 4, v1
    v_bfe_u32 v7, v1, 2, 2
    v_and_b32 v8, 3, v1
    v_mul_u32_u24 v13, 960, v9
    v_lshl_add_u32 v13, v10, 4, v13
    s_mul_i32 s3, s48, 1920
    s_add_u32 s3, s3, 147456
    v_add_u32 v230, s3, v13
    v_mul_u32_u24 v13, 960, v7
    v_lshl_add_u32 v13, v3, 5, v13
    v_lshl_add_u32 v13, v8, 3, v13
    s_lshl_b32 s3, s48, 8
    s_add_u32 s3, s3, 147456
    v_add_u32 v231, s3, v13
    s_lshl_b32 s3, s48, 3
    s_add_u32 s3, s3, 155648
    v_lshl_add_u32 v232, v9, 2, s3
    v_lshlrev_b32 v237, 2, v6
    v_and_b32 v2, 15, v1
    v_lshlrev_b32 v238, 14, v3
    v_add_lshl_u32 v238, v238, v2, 2
    v_add_u32 v237, 155648, v237
    v_lshlrev_b32 v13, 17, v9
    v_lshl_add_u32 v233, v10, 4, v13
    s_cmp_eq_u32 s48, 3
    s_cselect_b32 s60, 268435456, 0
    s_lshl_b32 s70, s48, 10
    s_add_u32 s70, s70, s2
    s_lshl_b32 s70, s70, 9
    s_add_u32 s71, s70, 262144
    s_add_u32 s71, s71, s60
    s_xor_b32 s60, s60, 268435456
    s_lshl_b32 s72, s2, 7
    s_add_u32 s72, s72, s60
    s_add_u32 s72, s72, 6291456
    s_lshr_b32 s74, s2, 2
    s_lshl_b32 s74, s74, 5
    s_and_b32 s3, s2, 3
    s_add_u32 s74, s74, s3
    s_lshl_b32 s74, s74, 2
    s_add_u32 s74, s74, 10485760
    v_cmp_gt_u32 vcc, 8, v0
    v_lshlrev_b32 v236, 13, v0
    v_mov_b32 v13, 268435456
    s_and_b32 s3, s2, 7
    s_lshl_b32 s3, s3, 13
    s_add_u32 s3, s3, 10485760
    v_lshrrev_b32 v14, 2, v0
    v_lshl_add_u32 v14, v14, 7, s3
    v_lshl_add_u32 v20, v8, 2, v14
    v_cndmask_b32 v236, v13, v236, vcc
    v_mov_b32 v16, 0
    s_lshl_b32 s3, s48, 14
    s_add_u32 s74, s74, s3
    s_add_u32 s73, s74, 8192
    s_waitcnt vmcnt(10)
    v_dot2_f32_bf16 v226, v182, s77, 0
    v_dot2_f32_bf16 v227, v182, v182, 0
    v_dot2_f32_bf16 v226, v183, s77, v226
    v_dot2_f32_bf16 v227, v183, v183, v227
    v_dot2_f32_bf16 v226, v184, s77, v226
    v_dot2_f32_bf16 v227, v184, v184, v227
    v_dot2_f32_bf16 v226, v185, s77, v226
    v_dot2_f32_bf16 v227, v185, v185, v227
    s_waitcnt vmcnt(9)
    v_dot2_f32_bf16 v226, v186, s77, v226
    v_dot2_f32_bf16 v227, v186, v186, v227
    v_dot2_f32_bf16 v226, v187, s77, v226
    v_dot2_f32_bf16 v227, v187, v187, v227
    v_dot2_f32_bf16 v226, v188, s77, v226
    v_dot2_f32_bf16 v227, v188, v188, v227
    v_dot2_f32_bf16 v226, v189, s77, v226
    v_dot2_f32_bf16 v227, v189, v189, v227
    buffer_load_dword v12, v16, s[44:47], 0 offen sc1
    v_lshlrev_b32 v190, 16, v182
    v_and_b32 v191, 0xffff0000, v182
    v_add_f32_dpp v226, v226, v226 quad_perm:[1,0,3,2] row_mask:0xf bank_mask:0xf
    v_add_f32_dpp v227, v227, v227 quad_perm:[1,0,3,2] row_mask:0xf bank_mask:0xf
    v_lshlrev_b32 v192, 16, v183
    v_add_f32_dpp v226, v226, v226 quad_perm:[2,3,0,1] row_mask:0xf bank_mask:0xf
    v_add_f32_dpp v227, v227, v227 quad_perm:[2,3,0,1] row_mask:0xf bank_mask:0xf
    v_and_b32 v193, 0xffff0000, v183
    v_add_f32_dpp v226, v226, v226 row_half_mirror row_mask:0xf bank_mask:0xf
    v_add_f32_dpp v227, v227, v227 row_half_mirror row_mask:0xf bank_mask:0xf
    v_lshlrev_b32 v194, 16, v184
    v_add_f32_dpp v226, v226, v226 row_mirror row_mask:0xf bank_mask:0xf
    v_add_f32_dpp v227, v227, v227 row_mirror row_mask:0xf bank_mask:0xf
    v_and_b32 v195, 0xffff0000, v184
    v_mov_b32 v228, v226
    v_mov_b32 v229, v227
    v_lshlrev_b32 v196, 16, v185
    v_permlane16_swap_b32 v226, v228
    v_permlane16_swap_b32 v227, v229
    v_add_f32 v226, v226, v228
    v_add_f32 v227, v227, v229
    v_mul_f32_e64 v226, -v226, s76
    v_mul_f32 v228, v226, v226
    v_fma_f32 v227, v227, s76, -v228
    v_max_f32 v227, 0, v227
    v_add_f32 v228, s75, v227
    v_rsq_f32 v222, v228
    v_and_b32 v197, 0xffff0000, v185
    v_mul_f32 v228, v222, v222
    v_fma_f32 v229, v228, v227, s75
    v_rsq_f32 v228, v229
    v_mul_f32 v223, v226, v222
    v_mul_f32 v224, v222, v228
    v_mul_f32 v225, v223, v228
    v_mul_f32 v229, v229, v228
    ds_write_b32 v232, v229
    v_lshlrev_b32 v198, 16, v186
    v_and_b32 v199, 0xffff0000, v186
    v_lshlrev_b32 v200, 16, v187
    v_and_b32 v201, 0xffff0000, v187
    v_lshlrev_b32 v202, 16, v188
    v_and_b32 v203, 0xffff0000, v188
    v_lshlrev_b32 v204, 16, v189
    v_and_b32 v205, 0xffff0000, v189
    v_pk_fma_f32 v[206:207], v[190:191], v[224:225], v[224:225] op_sel:[0,0,1] op_sel_hi:[1,0,1]
    v_pk_fma_f32 v[208:209], v[192:193], v[224:225], v[224:225] op_sel:[0,0,1] op_sel_hi:[1,0,1]
    v_pk_fma_f32 v[210:211], v[194:195], v[224:225], v[224:225] op_sel:[0,0,1] op_sel_hi:[1,0,1]
    v_pk_fma_f32 v[212:213], v[196:197], v[224:225], v[224:225] op_sel:[0,0,1] op_sel_hi:[1,0,1]
    v_cvt_pk_bf16_f32 v182, v206, v207
    v_cvt_pk_bf16_f32 v183, v208, v209
    v_cvt_pk_bf16_f32 v184, v210, v211
    v_cvt_pk_bf16_f32 v185, v212, v213
    ds_write_b128 v230, v[182:185] offset:0
    v_pk_fma_f32 v[214:215], v[198:199], v[224:225], v[224:225] op_sel:[0,0,1] op_sel_hi:[1,0,1]
    v_pk_fma_f32 v[216:217], v[200:201], v[224:225], v[224:225] op_sel:[0,0,1] op_sel_hi:[1,0,1]
    v_pk_fma_f32 v[218:219], v[202:203], v[224:225], v[224:225] op_sel:[0,0,1] op_sel_hi:[1,0,1]
    v_pk_fma_f32 v[220:221], v[204:205], v[224:225], v[224:225] op_sel:[0,0,1] op_sel_hi:[1,0,1]
    v_cvt_pk_bf16_f32 v186, v214, v215
    v_cvt_pk_bf16_f32 v187, v216, v217
    v_cvt_pk_bf16_f32 v188, v218, v219
    v_cvt_pk_bf16_f32 v189, v220, v221
    ds_write_b128 v230, v[186:189] offset:448
    s_waitcnt lgkmcnt(0)
    s_barrier
    ds_read_b64_tr_b16 v[110:111], v231 offset:0
    ds_read_b64_tr_b16 v[112:113], v231 offset:3840
    ds_read_b64_tr_b16 v[114:115], v231 offset:128
    ds_read_b64_tr_b16 v[116:117], v231 offset:3968
    ds_read_b32 v229, v237
    s_waitcnt lgkmcnt(3)
    buffer_store_dwordx4 v[110:113], v233, s[28:31], s70 offen sc1
    s_waitcnt lgkmcnt(1)
    buffer_store_dwordx4 v[114:117], v233, s[28:31], s71 offen sc1
    v_cmp_gt_u32 vcc, 16, v1
    s_waitcnt lgkmcnt(0)
    s_nop 0
    v_cndmask_b32 v229, 0, v229, vcc
    buffer_store_dword v229, v238, s[28:31], s72 offen sc1
    v_lshrrev_b32 v13, 2, v1
    v_mul_u32_u24 v13, 1056, v13
    v_lshl_add_u32 v13, v8, 3, v13
    s_mul_i32 s3, s48, 224
    v_add_u32 v243, s3, v13
    s_mov_b32 s18, 401408
    s_mov_b32 s19, 0x20000
    s_mov_b32 s26, 7340032
    s_mov_b32 s27, 0x20000
    s_mov_b32 s34, 1835008
    s_mov_b32 s35, 0x20000
    s_mov_b32 s36, 1
    v_lshrrev_b32 v14, 2, v1
    v_lshlrev_b32 v14, 7, v14
    v_lshl_add_u32 v14, v8, 3, v14
    v_and_b32 v15, 3, v5
    v_lshl_add_u32 v14, v15, 5, v14
    s_mul_i32 s3, s4, 8256
    v_xor_b32 v31, s3, v14
    v_xor_b32 v32, 32, v31
    v_xor_b32 v33, 64, v31
    v_xor_b32 v34, 96, v31
    v_add_u32 v35, 65536, v31
    v_add_u32 v36, 65536, v32
    v_add_u32 v37, 65536, v33
    v_add_u32 v38, 65536, v34
    v_add_u32 v39, 131072, v31
    v_add_u32 v40, 131072, v32
    v_add_u32 v41, 131072, v33
    v_add_u32 v42, 131072, v34
    s_lshl_b32 s6, s52, 1
    s_add_u32 s6, s6, s5
    s_lshl_b32 s3, s6, 1
    s_add_u32 s3, s3, s59
    s_lshl_b32 s3, s3, 4
    s_add_u32 s3, s3, s4
    s_lshl_b32 s3, s3, 12
    v_lshl_add_u32 v78, v3, 8, v4
    v_add_u32 v78, s3, v78
    s_xor_b32 s37, s51, 1
    s_lshl_b32 s37, s37, 3
    s_add_u32 s37, s37, s52
    s_lshl_b32 s3, s37, 14
    s_add_u32 s3, s3, s58
    s_add_u32 s3, s3, 16777216
    v_add_u32 v23, s3, v4
    s_lshl_b32 s37, s37, 5
    s_add_u32 s37, s37, s5
    s_lshl_b32 s37, s37, 2
    s_add_u32 s37, s37, 6422528
    s_mul_i32 s67, s6, 56
    s_lshl_b32 s3, s51, 1
    s_add_u32 s3, s3, s4
    s_add_u32 s67, s67, s3
    s_lshl_b32 s67, s67, 11
    s_add_u32 s67, s67, 2097152
    v_add_u32 v81, s58, v4
    s_lshl_b32 s68, s52, 2
    s_and_b32 s3, s51, 1
    s_add_u32 s68, s68, s3
    s_cmp_ge_u32 s51, 14
    s_cselect_b32 s3, 2, 0
    s_add_u32 s68, s68, s3
    s_lshl_b32 s68, s68, 7
    s_add_u32 s68, s68, 6356992
    s_waitcnt vmcnt(3)
    v_readfirstlane_b32 s57, v12
    s_mov_b32 s60, 0
    s_cmp_lg_u32 s57, 0
    s_cbranch_scc0 L_nonceh
L_nonce_okh:
    s_waitcnt vmcnt(0)
    s_barrier
    s_atomic_swap s57, s[28:29], s74
    s_atomic_swap s57, s[28:29], s73
    buffer_load_dwordx4 v[96:99], v85, s[8:11], 0 offen
    buffer_load_ushort v93, v82, s[40:43], 0 offen offset:0
    buffer_load_dwordx4 v[100:103], v86, s[8:11], 0 offen
    buffer_load_ushort v94, v82, s[40:43], 0 offen offset:16
    v_cmp_gt_u32 vcc, 12, v2
    s_mul_i32 s3, s48, 56
    s_add_u32 s3, s3, s79
    s_mul_i32 s3, s3, 3
    s_add_u32 s3, s3, s80
    s_lshl_b32 s3, s3, 11
    s_add_u32 s3, s3, 8388608
    s_add_u32 s3, s3, s81
    ds_read_b64_tr_b16 v[182:183], v243 offset:0
    ds_read_b64_tr_b16 v[184:185], v243 offset:16896
    ds_read_b64_tr_b16 v[186:187], v243 offset:32
    ds_read_b64_tr_b16 v[188:189], v243 offset:16928
    ds_read_b64_tr_b16 v[190:191], v243 offset:56
    ds_read_b64_tr_b16 v[192:193], v243 offset:16952
    ds_read_b64_tr_b16 v[194:195], v243 offset:88
    ds_read_b64_tr_b16 v[196:197], v243 offset:16984
    ds_read_b64_tr_b16 v[198:199], v243 offset:112
    ds_read_b64_tr_b16 v[200:201], v243 offset:17008
    ds_read_b64_tr_b16 v[202:203], v243 offset:144
    ds_read_b64_tr_b16 v[204:205], v243 offset:17040
    ds_read_b64_tr_b16 v[206:207], v243 offset:168
    ds_read_b64_tr_b16 v[208:209], v243 offset:17064
    ds_read_b64_tr_b16 v[210:211], v243 offset:200
    ds_read_b64_tr_b16 v[212:213], v243 offset:17096
    s_waitcnt lgkmcnt(13)
    v_cndmask_b32 v186, 0, v186, vcc
    v_cndmask_b32 v187, 0, v187, vcc
    s_waitcnt lgkmcnt(12)
    v_cndmask_b32 v188, 0, v188, vcc
    v_cndmask_b32 v189, 0, v189, vcc
    buffer_store_dwordx4 v[182:185], v4, s[28:31], s3 offen offset:0 sc1
    buffer_store_dwordx4 v[186:189], v4, s[28:31], s3 offen offset:1024 sc1
    s_add_u32 s3, s3, 86016
    s_waitcnt lgkmcnt(9)
    v_cndmask_b32 v194, 0, v194, vcc
    v_cndmask_b32 v195, 0, v195, vcc
    s_waitcnt lgkmcnt(8)
    v_cndmask_b32 v196, 0, v196, vcc
    v_cndmask_b32 v197, 0, v197, vcc
    buffer_store_dwordx4 v[190:193], v4, s[28:31], s3 offen offset:0 sc1
    buffer_store_dwordx4 v[194:197], v4, s[28:31], s3 offen offset:1024 sc1
    s_add_u32 s3, s3, 86016
    s_waitcnt lgkmcnt(5)
    v_cndmask_b32 v202, 0, v202, vcc
    v_cndmask_b32 v203, 0, v203, vcc
    s_waitcnt lgkmcnt(4)
    v_cndmask_b32 v204, 0, v204, vcc
    v_cndmask_b32 v205, 0, v205, vcc
    buffer_store_dwordx4 v[198:201], v4, s[28:31], s3 offen offset:0 sc1
    buffer_store_dwordx4 v[202:205], v4, s[28:31], s3 offen offset:1024 sc1
    s_add_u32 s3, s3, 86016
    ds_read_b32 v24, v4
    s_waitcnt lgkmcnt(2)
    v_cndmask_b32 v210, 0, v210, vcc
    v_cndmask_b32 v211, 0, v211, vcc
    ds_read_b32 v24, v4
    s_waitcnt lgkmcnt(2)
    v_cndmask_b32 v212, 0, v212, vcc
    v_cndmask_b32 v213, 0, v213, vcc
    buffer_store_dwordx4 v[206:209], v4, s[28:31], s3 offen offset:0 sc1
    buffer_store_dwordx4 v[210:213], v4, s[28:31], s3 offen offset:1024 sc1
    s_add_u32 s3, s3, 86016
    s_lshl_b32 s67, s80, 6
    s_add_u32 s67, s67, 64
    s_cmp_eq_u32 s81, 0
    s_cselect_b32 s37, s48, 1
    s_mov_b32 s68, 6369792
    s_and_b32 s3, s2, 1
    s_mul_i32 s3, s3, 3
    s_bfe_u32 s6, s2, 0x10001
    s_mul_i32 s7, s6, 6
    s_add_u32 s3, s3, s7
    s_add_u32 s3, s3, 1
    v_add_u32 v14, s3, v8
    s_mul_i32 s6, s6, 64
    s_add_u32 s6, s6, 7
    v_cmp_ne_u32 vcc, s6, v14
    v_lshrrev_b32 v15, 2, v1
    v_mul_u32_u24 v15, 3584, v15
    v_cndmask_b32 v14, 0, v14, vcc
    v_lshl_add_u32 v14, v14, 8, v15
    s_lshl_b32 s3, s52, 2
    s_add_u32 s3, s3, s48
    s_mul_i32 s3, s3, 37
    s_min_u32 s3, s3, 976
    s_mul_i32 s3, s3, 3584
    s_mul_i32 s6, s59, 3670144
    s_add_u32 s3, s3, s6
    buffer_load_dword v226, v14, s[20:23], s3 offen
    s_add_u32 s3, s3, 57344
    buffer_load_dword v227, v14, s[20:23], s3 offen
    s_add_u32 s3, s3, 57344
    buffer_load_dword v228, v14, s[20:23], s3 offen
    s_add_u32 s3, s3, 57344
    v_add_u32 v53, 65536, v4
    v_add_u32 v54, 131072, v4
    s_mul_i32 s59, s48, 3072
    s_mul_i32 s3, s50, 86016
    s_add_u32 s3, s3, s59
    s_add_u32 s3, s3, 8388608
    v_add_u32 v80, s3, v4
    v_lshlrev_b32 v14, 7, v9
    v_xor_b32 v14, v14, v4
    s_lshl_b32 s3, s49, 11
    v_add_u32 v67, s3, v14
    v_add_u32 v68, 129024, v67
    s_lshr_b32 s3, s49, 2
    s_lshl_b32 s3, s3, 3
    s_max_u32 s3, s3, 1
    s_sub_u32 s3, s3, 1
    s_lshl_b32 s3, s3, 10
    s_lshl_b32 s6, s5, 17
    s_add_u32 s3, s3, s6
    s_lshl_b32 s6, s4, 28
    s_add_u32 s3, s3, s6
    v_add_u32 v69, s3, v14
    s_lshl_b32 s100, s5, 1
    s_add_u32 s100, s100, s4
    s_lshl_b32 s100, s100, 10
    v_and_b32 v14, 1, v1
    v_mul_u32_u24 v14, 640, v14
    v_lshrrev_b32 v15, 2, v1
    v_lshlrev_b32 v15, 4, v15
    v_xor_b32 v14, v14, v15
    v_bfe_u32 v15, v1, 1, 1
    v_lshl_add_u32 v14, v15, 3, v14
    s_add_u32 s3, s58, 12288
    v_add_u32 v70, s3, v14
    s_sub_u32 s3, s3, 3072
    s_cmp_eq_u32 s48, 0
    s_cselect_b32 s3, 28672, s3
    v_add_u32 v71, s3, v14
    v_add_u32 v72, 65536, v70
    v_add_u32 v73, 65536, v71
    v_add_u32 v74, 131072, v70
    v_add_u32 v75, 131072, v71
    s_lshl_b32 s3, s49, 1
    v_min_u32 v14, 2, v3
    v_add_u32 v14, s3, v14
    v_max_u32 v14, 1, v14
    v_lshlrev_b32 v14, 1, v14
    v_and_b32 v15, 1, v7
    v_add_lshl_u32 v14, v14, v15, 7
    v_lshrrev_b32 v15, 1, v7
    v_lshl_add_u32 v15, v15, 2, v8
    v_lshl_add_u32 v14, v15, 2, v14
    v_add_u32 v77, 6291200, v14
    s_min_u32 s15, s48, 2
    s_lshl_b32 s15, s15, 6
    s_add_u32 s15, s15, 64
    s_lshl_b32 s82, s49, 5
    s_add_u32 s82, s82, s50
    s_lshl_b32 s82, s82, 10
    s_add_u32 s82, s82, 4194304
    s_lshr_b32 s69, s49, 2
    s_lshl_b32 s69, s69, 1
    s_and_b32 s3, s50, 1
    s_add_u32 s69, s69, s3
    s_lshl_b32 s69, s69, 7
    s_add_u32 s69, s69, 6361088
    s_and_b32 s7, s53, 1
    s_mul_i32 s3, s7, 28
    s_add_u32 s3, s3, s48
    s_lshl_b32 s3, s3, 17
    s_xor_b32 s6, s53, 1
    s_lshl_b32 s55, s6, 3
    s_lshl_b32 s6, s53, 7
    s_add_u32 s3, s3, s6
    v_lshlrev_b32 v14, 12, v5
    v_add3_u32 v59, v14, v83, s3
    v_add_u32 v60, 31744, v59
    v_add_u32 v61, 63488, v59
    v_add_u32 v62, 95232, v59
    v_mul_u32_u24 v14, 896, v5
    s_mul_i32 s3, s4, 25088
    s_mul_i32 s6, s5, 14336
    s_add_u32 s3, s3, s6
    s_lshl_b32 s6, s54, 7
    s_add_u32 s3, s3, s6
    v_add3_u32 v63, v14, v83, s3
    v_add_u32 v64, 6144, v63
    s_lshl_b32 s6, s53, 1
    s_add_u32 s6, s6, s5
    s_and_b32 s3, s53, 30
    s_add_u32 s3, s3, s4
    s_lshl_b32 s3, s3, 7
    s_add_u32 s39, s3, 6361088
    s_lshl_b32 s3, s6, 5
    s_add_u32 s3, s3, s4
    s_lshl_b32 s3, s3, 10
    s_add_u32 s3, s3, 4194304
    v_add_u32 v65, s3, v4
    v_add_u32 v66, 15360, v65
    s_xor_b32 s3, s4, s5
    s_lshl_b32 s3, s3, 6
    v_xor_b32 v43, s3, v31
    v_xor_b32 v44, 32, v43
    v_add_u32 v45, 65536, v43
    v_add_u32 v46, 65536, v44
    s_mul_i32 s3, s4, 12288
    v_add_u32 v47, s3, v4
    v_xor_b32 v48, 4096, v47
    v_add_u32 v49, 65536, v47
    v_add_u32 v50, 65536, v48
    v_add_u32 v51, 131072, v47
    v_add_u32 v52, 131072, v48
    s_lshl_b32 s6, s54, 1
    s_add_u32 s6, s6, s5
    s_lshl_b32 s3, s6, 1
    s_add_u32 s3, s3, s7
    s_mul_i32 s3, s3, 14
    s_add_u32 s3, s3, s4
    s_lshl_b32 s3, s3, 12
    s_add_u32 s3, s3, 2097152
    v_add_u32 v79, s3, v4
    s_lshl_b32 s3, s54, 1
    s_add_u32 s3, s3, s7
    s_lshl_b32 s3, s3, 1
    s_add_u32 s3, s3, s4
    s_lshl_b32 s3, s3, 7
    s_add_u32 s38, s3, 6356992
    s_and_b32 s3, s2, 6
    s_add_u32 s3, s3, s54
    s_sub_u32 s6, s3, 7
    s_cmp_ge_u32 s3, 7
    s_cselect_b32 s3, s6, s3
    s_lshl_b32 s64, s3, 19
    s_lshl_b32 s65, s3, 13
    s_add_u32 s55, s55, s54
    s_lshl_b32 s3, s55, 14
    s_add_u32 s3, s3, s58
    s_add_u32 s3, s3, 12582912
    v_add_u32 v21, s3, v4
    s_lshl_b32 s55, s55, 5
    s_add_u32 s55, s55, s48
    s_lshl_b32 s55, s55, 2
    s_add_u32 s55, s55, 6488064
    s_lshl_b32 s3, s5, 3
    v_add_u32 v13, s3, v3
    v_xor_b32 v13, v13, v6
    v_lshlrev_b32 v13, 4, v13
    v_lshl_add_u32 v13, v2, 8, v13
    s_lshl_b32 s3, s4, 14
    s_add_u32 s3, s3, 32768
    v_add_u32 v87, s3, v13
    v_xor_b32 v88, 64, v87
    s_lshr_b32 s3, s53, 1
    s_add_u32 s66, s3, s54
    s_mov_b32 s51, s66
    v_lshlrev_b32 v13, 1, v6
    v_xor_b32 v13, v13, v5
    v_lshlrev_b32 v13, 4, v13
    v_lshl_add_u32 v13, v5, 8, v13
    s_add_u32 s3, s58, 32768
    v_add_u32 v89, s3, v13
    v_xor_b32 v90, 16, v89
    v_xor_b32 v91, 24576, v89
    v_xor_b32 v92, 24592, v89
    s_mov_b32 s70, 0xaaaaaaaa
    s_mov_b32 s71, 0xaaaaaaaa
    s_mov_b32 s72, 0xfff0ffff
    s_mov_b32 s73, 0xf000ff00
    s_mov_b32 s74, 0xffc0fffc
    s_mov_b32 s75, 0xc000fc00
    s_cmp_eq_u32 s49, 0
    s_cselect_b64 s[76:77], 0, -1
    v_mov_b32 v13, 0xffff
    v_mov_b32 v14, 0xffff0000
    v_cndmask_b32 v13, v13, v14, s[70:71]
    v_cndmask_b32 v104, v13, 0, s[72:73]
    v_cndmask_b32 v106, 0, v13, s[72:73]
    v_cndmask_b32 v105, v13, 0, s[74:75]
    v_cndmask_b32 v107, 0, v13, s[74:75]
    v_mov_b32 v84, 0xf149f2ca
    s_mov_b32 s83, 0x3e8b97f6
    s_mov_b32 s78, 0xbdd2d3e8
    s_mov_b32 s79, 0xbdd2d3e8
    s_mov_b32 s80, 1.0
    s_mov_b32 s81, 1.0
    v_mov_b32 v108, 0xc0135761
    v_mov_b32 v109, 0xc0135761
    v_lshrrev_b32 v13, 1, v2
    v_lshlrev_b32 v14, 1, v3
    v_sub_u32 v13, v13, v14
    v_mov_b32 v14, 0x3f80
    v_cndmask_b32 v14, v14, 1.0, s[70:71]
    v_cmp_eq_i32 vcc, 0, v13
    v_accvgpr_write_b32 a248, 0
    v_accvgpr_write_b32 a252, 0
    v_cndmask_b32 v15, 0, v14, vcc
    v_accvgpr_write_b32 a250, v15
    v_cmp_eq_i32 vcc, 1, v13
    v_accvgpr_write_b32 a249, 0
    v_accvgpr_write_b32 a253, 0
    v_cndmask_b32 v15, 0, v14, vcc
    v_accvgpr_write_b32 a251, v15
    s_waitcnt vmcnt(3)
    s_barrier
    s_cmp_lg_u32 s37, 0
    s_cbranch_scc1 L_nowsig
    s_atomic_add s36, s[44:45], s67
L_nowsig:
    buffer_load_dword v18, v20, s[28:31], 0 offen sc1
    s_cmp_eq_u32 s56, 0
    s_cselect_b32 s26, 0, s26
    v_and_b32 v13, 0xfffff000, v78
    v_lshl_add_u32 v13, v10, 7, v13
    s_add_u32 s3, s1, 8192
    v_lshl_add_u32 v14, v9, 13, s3
    s_waitcnt vmcnt(0)
    v_cmp_ne_u32 vcc, s57, v18
    s_cbranch_vccnz L_pollin3
L_pollok3:
    s_barrier
    buffer_load_dword v76, v77, s[28:31], 0 offen sc1
    s_mov_b32 s26, 7340032
    s_and_b32 s3, s2, 1
    s_mul_i32 s3, s3, 7
    s_add_u32 s3, s3, s52
    s_lshl_b32 s3, s3, 2
    s_add_u32 s3, s3, s48
    s_lshl_b32 s3, s3, 17
    s_and_b32 s6, s2, 6
    s_lshl_b32 s6, s6, 9
    s_add_u32 s3, s3, s6
    v_lshlrev_b32 v13, 12, v10
    v_lshl_add_u32 v13, v9, 9, v13
    buffer_load_dword v232, v13, s[24:27], s3 offen offset:384
    buffer_load_dword v233, v13, s[24:27], s3 offen offset:256
    s_cmp_eq_u32 s56, 0
    s_cselect_b32 s26, 0, s26
    v_lshlrev_b32 v13, 2, v2
    v_and_b32 v14, 1, v1
    v_lshl_add_u32 v14, v3, 2, v14
    v_lshlrev_b32 v14, 2, v14
    v_add_u32 v15, 64, v14
    v_cndmask_b32 v16, v14, v15, s[72:73]
    v_cndmask_b32 v14, v14, v15, s[74:75]
    s_waitcnt vmcnt(2)
    ds_bpermute_b32 v25, v13, v76 offset:64
    ds_bpermute_b32 v27, v16, v76 offset:0
    ds_bpermute_b32 v28, v14, v76 offset:8
    ds_bpermute_b32 v26, v13, v76 offset:128
    ds_bpermute_b32 v29, v16, v76 offset:64
    ds_bpermute_b32 v30, v14, v76 offset:72
    s_waitcnt lgkmcnt(5)
    v_mul_f32 v25, s83, v25
    ds_read_b32 v24, v4
    s_waitcnt lgkmcnt(3)
    v_mul_f32 v26, s83, v26
    s_load_dword s14, s[44:45], s15
    s_waitcnt lgkmcnt(0)
    s_cmp_ge_u32 s14, 14
    s_cbranch_scc0 L_pollin4
L_pollok4:
    s_barrier
    s_cmp_eq_u32 s56, 0
    s_cselect_b32 s3, 268435456, 0
    v_add_u32 v79, s3, v79
    s_add_u32 m0, s59, 98304
    s_nop 0
    buffer_load_dwordx4 v80, s[28:31], s63 offen sc1 lds
    buffer_load_dwordx4 v80, s[28:31], s63 offen offset:1024 sc1 lds
    buffer_load_dwordx4 v80, s[28:31], s63 offen offset:2048 sc1 lds
    s_add_u32 m0, s100, 126976
    s_nop 0
    buffer_load_dwordx4 v69, s[28:31], s62 offen sc1 lds
    s_add_u32 m0, s58, 110592
    s_nop 0
    buffer_load_dwordx4 v67, s[28:31], s62 offen sc1 lds
    buffer_load_dwordx4 v67, s[28:31], s62 offen offset:1024 sc1 lds
    buffer_load_dwordx4 v68, s[28:31], s62 offen offset:2048 sc1 lds
    buffer_load_dwordx4 v68, s[28:31], s62 offen offset:3072 sc1 lds
    s_add_u32 m0, s59, 131072
    s_add_u32 s63, s63, 12288
    s_cmp_eq_u32 s63, 86016
    s_cselect_b32 s63, 0, s63
    buffer_load_dwordx4 v80, s[28:31], s63 offen sc1 lds
    buffer_load_dwordx4 v80, s[28:31], s63 offen offset:1024 sc1 lds
    buffer_load_dwordx4 v80, s[28:31], s63 offen offset:2048 sc1 lds
    s_add_u32 m0, s100, 159744
    s_add_u32 s62, s62, 262144
    s_cmp_eq_u32 s62, 1835008
    s_cselect_b32 s62, 0, s62
    buffer_load_dwordx4 v69, s[28:31], s62 offen sc1 lds
    s_add_u32 m0, s58, 143360
    s_nop 0
    buffer_load_dwordx4 v67, s[28:31], s62 offen sc1 lds
    buffer_load_dwordx4 v67, s[28:31], s62 offen offset:1024 sc1 lds
    buffer_load_dwordx4 v68, s[28:31], s62 offen offset:2048 sc1 lds
    buffer_load_dwordx4 v68, s[28:31], s62 offen offset:3072 sc1 lds
    s_add_u32 m0, s59, 0
    s_add_u32 s63, s63, 12288
    s_cmp_eq_u32 s63, 86016
    s_cselect_b32 s63, 0, s63
    buffer_load_dwordx4 v80, s[28:31], s63 offen sc1 lds
    buffer_load_dwordx4 v80, s[28:31], s63 offen offset:1024 sc1 lds
    buffer_load_dwordx4 v80, s[28:31], s63 offen offset:2048 sc1 lds
    s_add_u32 m0, s100, 28672
    s_add_u32 s62, s62, 262144
    s_cmp_eq_u32 s62, 1835008
    s_cselect_b32 s62, 0, s62
    buffer_load_dwordx4 v69, s[28:31], s62 offen sc1 lds
    s_add_u32 m0, s58, 12288
    s_nop 0
    buffer_load_dwordx4 v67, s[28:31], s62 offen sc1 lds
    buffer_load_dwordx4 v67, s[28:31], s62 offen offset:1024 sc1 lds
    buffer_load_dwordx4 v68, s[28:31], s62 offen offset:2048 sc1 lds
    buffer_load_dwordx4 v68, s[28:31], s62 offen offset:3072 sc1 lds
    s_add_u32 m0, s59, 65536
    s_add_u32 s63, s63, 12288
    s_cmp_eq_u32 s63, 86016
    s_cselect_b32 s63, 0, s63
    buffer_load_dwordx4 v80, s[28:31], s63 offen sc1 lds
    buffer_load_dwordx4 v80, s[28:31], s63 offen offset:1024 sc1 lds
    buffer_load_dwordx4 v80, s[28:31], s63 offen offset:2048 sc1 lds
    s_add_u32 m0, s100, 94208
    s_add_u32 s62, s62, 262144
    s_cmp_eq_u32 s62, 1835008
    s_cselect_b32 s62, 0, s62
    buffer_load_dwordx4 v69, s[28:31], s62 offen sc1 lds
    s_add_u32 m0, s58, 77824
    s_nop 0
    buffer_load_dwordx4 v67, s[28:31], s62 offen sc1 lds
    buffer_load_dwordx4 v67, s[28:31], s62 offen offset:1024 sc1 lds
    buffer_load_dwordx4 v68, s[28:31], s62 offen offset:2048 sc1 lds
    buffer_load_dwordx4 v68, s[28:31], s62 offen offset:3072 sc1 lds
    s_mov_b32 s3, 268435456
    buffer_store_dword v12, v11, s[28:31], s3 offen
    buffer_store_dword v12, v11, s[28:31], s3 offen
    s_waitcnt vmcnt(18)
    s_barrier
    ds_read_b64_tr_b16 a[180:181], v72 offset:32768
    ds_read_b64_tr_b16 a[182:183], v72 offset:33024
    ds_read_b128 a[128:131], v53 offset:32768
    ds_read_b64_tr_b16 a[184:185], v72 offset:33792
    ds_read_b64_tr_b16 a[186:187], v72 offset:34048
    ds_read_b128 a[132:135], v53 offset:33792
    ds_read_b128 a[136:139], v53 offset:34816
    ds_read_b64_tr_b16 a[176:177], v73 offset:32768
    ds_read_b64_tr_b16 a[178:179], v73 offset:33024
    ds_read_b128 a[140:143], v53 offset:35840
    ds_read_b128 a[144:147], v53 offset:36864
    ds_read_b128 a[148:151], v53 offset:37888
    s_waitcnt lgkmcnt(0)
    s_nop 3
    s_branch L_q
L_pollin5:
    s_cmp_eq_u32 s56, 0
    s_cbranch_scc1 L_pollok5
    s_mov_b32 s60, 0
L_poll5:
    s_sleep 8
    buffer_load_dword v18, off, s[28:31], s38 sc1
    s_add_u32 s60, s60, 1
    s_waitcnt vmcnt(0)
    v_readfirstlane_b32 s14, v18
    s_nop 0
    s_cmp_ge_u32 s14, 7
    s_cbranch_scc1 L_pollok5
    s_cmp_lt_u32 s60, 20000
    s_cbranch_scc1 L_poll5
    s_branch L_pollok5
L_nof:
    s_waitcnt vmcnt(0)
    s_barrier
    s_cmp_lg_u32 s48, 0
    s_cbranch_scc1 L_sig3
    s_atomic_add s36, s[28:29], s69
L_sig3:
    v_lshlrev_b32 v14, 7, v1
    s_lshl_b32 s3, s54, 2
    s_add_u32 s3, s3, s48
    s_mul_i32 s3, s3, 25088
    buffer_load_dword v182, v14, s[16:19], s3 offen
    s_add_u32 s3, s3, 5632
    buffer_load_dword v183, v14, s[16:19], s3 offen
    s_add_u32 s3, s3, 5632
    buffer_load_dword v184, v14, s[16:19], s3 offen
    s_add_u32 s3, s3, 5632
    buffer_load_dword v185, v14, s[16:19], s3 offen
    s_add_u32 s3, s3, 5632
    s_branch L_fin
L_pollin6:
    s_mov_b32 s60, 0
L_poll6:
    s_sleep 8
    buffer_load_dword v18, off, s[28:31], s39 sc1
    s_add_u32 s60, s60, 1
    s_waitcnt vmcnt(0)
    v_readfirstlane_b32 s14, v18
    s_nop 0
    s_cmp_ge_u32 s14, 8
    s_cbranch_scc1 L_pollok6
    s_cmp_lt_u32 s60, 20000
    s_cbranch_scc1 L_poll6
    s_branch L_pollok6
L_pollin7:
    s_mov_b32 s60, 0
L_poll7:
    s_sleep 4
    buffer_load_dword v18, off, s[28:31], s55 sc1
    s_add_u32 s60, s60, 1
    s_waitcnt vmcnt(0)
    v_readfirstlane_b32 s14, v18
    s_nop 0
    s_cmp_ge_u32 s14, 1
    s_cbranch_scc1 L_pollok7
    s_cmp_lt_u32 s60, 20000
    s_cbranch_scc1 L_poll7
    s_branch L_pollok7
L_last:
    s_endpgm
.section .rodata,"a"
.p2align 6
.amdhsa_kernel parallel_sum__sliding_local_dilated__mixer_token_mlp__prompt_kernel
  .amdhsa_next_free_vgpr 512
  .amdhsa_next_free_sgpr 102
  .amdhsa_accum_offset 256
  .amdhsa_group_segment_fixed_size 0
  .amdhsa_kernarg_size 88
  .amdhsa_user_sgpr_count 2
  .amdhsa_user_sgpr_kernarg_segment_ptr 1
  .amdhsa_system_sgpr_workgroup_id_x 1
.end_amdhsa_kernel
```

```asm
; @launch grid=(256,1,1) block=(256,1,1) lds=163840
.amdgcn_target "amdgcn-amd-amdhsa--gfx950"
.text
.globl parallel_sum__sliding_local_dilated__mixer_token_mlp__prompt_kernel
.p2align 8
.type parallel_sum__sliding_local_dilated__mixer_token_mlp__prompt_kernel,@function
parallel_sum__sliding_local_dilated__mixer_token_mlp__prompt_kernel:
    s_cmp_ge_u32 s2, 256
    s_cbranch_scc1 L_end
    s_load_dwordx2 s[8:9], s[0:1], 0
    s_load_dwordx2 s[20:21], s[0:1], 32
    s_load_dwordx2 s[28:29], s[0:1], 80
    s_load_dwordx2 s[44:45], s[0:1], 72
    s_load_dwordx2 s[12:13], s[0:1], 8
    s_load_dwordx2 s[16:17], s[0:1], 16
    s_load_dwordx2 s[24:25], s[0:1], 48
    s_load_dwordx2 s[32:33], s[0:1], 64
    s_load_dwordx2 s[36:37], s[0:1], 40
    s_load_dwordx2 s[40:41], s[0:1], 56
    s_memrealtime s[78:79]
    s_getpc_b64 s[6:7]
L_pc:
    s_and_b32 s3, s2, 0xf8
    v_lshrrev_b32 v13, 5, v0
    v_add_lshl_u32 v13, s3, v13, 7
    v_min_u32 v13, L_last-L_pc, v13
    global_load_dword v18, v13, s[6:7]
    v_lshrrev_b32 v13, 6, v0
    v_and_b32 v10, 31, v0
    v_readfirstlane_b32 s48, v13
    v_bfe_u32 v9, v0, 5, 1
    v_mul_u32_u24 v14, 896, v9
    v_lshl_add_u32 v14, v10, 4, v14
    v_cmp_gt_u32 vcc, 28, v10
    v_mov_b32 v15, 268435456
    s_mov_b32 s10, 1835008
    s_mov_b32 s11, 0x20000
    v_cndmask_b32 v14, v15, v14, vcc
    s_lshr_b32 s4, s48, 1
    s_and_b32 s5, s48, 1
    s_and_b32 s3, s2, 0xfe
    s_add_u32 s3, s3, s4
    s_lshl_b32 s3, s3, 1
    s_and_b32 s60, s2, 1
    s_add_u32 s3, s3, s60
    s_lshl_b32 s3, s3, 1
    s_add_u32 s3, s3, s5
    s_mul_i32 s3, s3, 1792
    s_waitcnt lgkmcnt(0)
    buffer_load_dwordx4 v[182:185], v14, s[8:11], s3 offen
    buffer_load_dwordx4 v[186:189], v14, s[8:11], s3 offen offset:448
    v_and_b32 v1, 63, v0
    s_mov_b32 s46, 256
    s_mov_b32 s47, 0x20000
    s_lshl_b32 s3, s48, 8
    s_add_u32 s3, s3, s2
    s_cmp_lt_u32 s3, 8
    s_cselect_b32 s3, 0, 268435456
    s_or_b32 s78, s78, 1
    v_mov_b32 v234, s78
    v_mov_b32 v235, 0
    v_lshlrev_b32 v11, 25, v1
    buffer_atomic_cmpswap v[234:235], v11, s[44:47], s3 offen sc1
    s_bfe_u32 s6, s2, 0x20001
    s_and_b32 s7, s2, 1
    s_and_b32 s61, s2, 7
    s_lshr_b32 s101, s2, 3
    s_mul_i32 s52, s7, 25
    s_add_u32 s52, s52, s101
    s_mul_i32 s51, s52, 37
    s_lshr_b32 s51, s51, 8
    s_mul_i32 s3, s51, 7
    s_sub_u32 s52, s52, s3
    s_and_b32 s3, s6, 1
    s_mul_i32 s3, s3, 6
    s_add_u32 s51, s51, s3
    s_add_u32 s51, s51, 1
    s_add_u32 s3, s3, s51
    s_cmp_eq_u32 s3, 7
    s_cselect_b32 s51, 0, s51
    s_lshr_b32 s59, s6, 1
    s_lshl_b32 s51, s51, 1
    s_add_u32 s51, s51, s59
    s_max_u32 s60, s101, 25
    s_sub_u32 s60, s60, 25
    s_add_u32 s3, s101, s7
    s_cmp_lt_u32 s3, 25
    s_cselect_b32 s55, 1, 0
    s_cselect_b32 s52, s52, s60
    s_mov_b32 s22, 7340032
    s_mov_b32 s23, 0x20000
    s_lshl_b32 s3, s52, 1
    s_sub_u32 s60, s3, 7
    s_cmp_ge_u32 s3, 7
    s_cselect_b32 s3, s60, s3
    s_and_b32 s3, s3, 7
    s_mul_i32 s60, s61, 2
    s_add_u32 s3, s3, s60
    s_and_b32 s3, s3, 7
    s_mul_i32 s0, s3, 458752
    s_lshl_b32 s1, s3, 13
    s_lshl_b32 s58, s48, 12
    v_lshrrev_b32 v3, 4, v1
    v_lshrrev_b32 v5, 3, v1
    v_and_b32 v6, 7, v1
    v_lshlrev_b32 v14, 1, v3
    v_xor_b32 v14, v14, v6
    v_lshlrev_b32 v83, 4, v14
    s_cmp_eq_u32 s55, 0
    s_cbranch_scc1 L_nog1
    v_mul_u32_u24 v14, 3584, v5
    s_lshl_b32 s3, s59, 5
    s_add_u32 s3, s3, s48
    s_mul_i32 s3, s3, 114688
    s_lshl_b32 s60, s51, 7
    s_add_u32 s3, s3, s60
    v_add3_u32 v55, v14, v83, s3
    v_add_u32 v56, 56320, v55
    v_add_u32 v57, 26624, v55
    v_add_u32 v58, 82944, v55
    s_mov_b32 s38, 3584
    s_mov_b32 s39, 0x20000
    v_lshlrev_b32 v13, 3, v3
    s_lshl_b32 s3, s51, 1
    s_add_u32 s3, s3, s4
    s_lshl_b32 s3, s3, 6
    buffer_load_dwordx2 v[246:247], v13, s[36:39], s3 offen offset:0
    buffer_load_dwordx2 v[248:249], v13, s[36:39], s3 offen offset:32
    s_add_u32 m0, s58, 0
    v_xor_b32 v55, 128, v55
    buffer_load_dwordx4 v55, s[20:23], s0 offen lds
    v_xor_b32 v56, 128, v56
    buffer_load_dwordx4 v56, s[20:23], s0 offen offset:1024 lds
    v_xor_b32 v57, 128, v57
    buffer_load_dwordx4 v57, s[20:23], s0 offen offset:2048 lds
    v_xor_b32 v58, 128, v58
    buffer_load_dwordx4 v58, s[20:23], s0 offen offset:3072 lds
    s_mul_i32 s53, s101, 37
    s_lshr_b32 s53, s53, 8
    s_mul_i32 s54, s53, 7
    s_sub_u32 s54, s101, s54
    s_and_b32 s53, s53, 3
    s_lshl_b32 s3, s6, 2
    s_add_u32 s53, s53, s3
    s_lshl_b32 s53, s53, 1
    s_add_u32 s53, s53, s7
    s_mov_b32 s42, 4096
    s_mov_b32 s43, 0x20000
    s_lshl_b32 s3, s53, 2
    s_add_u32 s3, s3, s48
    s_lshl_b32 s60, s3, 5
    v_lshl_add_u32 v82, v5, 1, s60
    s_mul_i32 s3, s3, 14336
    s_lshl_b32 s60, s54, 7
    s_add_u32 s3, s3, s60
    v_mul_u32_u24 v14, 896, v5
    v_lshl_add_u32 v14, v6, 4, v14
    v_add_u32 v85, s3, v14
    v_add_u32 v86, 7168, v85
    s_cmp_lt_u32 s101, 28
    s_cselect_b32 s56, 1, 0
    s_lshl_b32 s50, s7, 3
    s_and_b32 s3, s101, 7
    s_add_u32 s50, s50, s3
    s_lshr_b32 s60, s101, 3
    s_lshl_b32 s49, s6, 2
    s_add_u32 s49, s49, s60
    s_lshl_b32 s49, s49, 2
    s_add_u32 s49, s49, s48
    s_mul_i32 s60, s60, 0
    s_add_u32 s3, s3, s60
    s_sub_u32 s60, s3, 7
    s_cmp_ge_u32 s3, 7
    s_cselect_b32 s3, s60, s3
    s_lshl_b32 s62, s3, 18
    s_mul_i32 s63, s3, 12288
    s_mov_b32 s30, 20971520
    s_mov_b32 s31, 0x20000
    s_mov_b32 s75, 0x3727c5ac
    s_mov_b32 s76, 0x3b124925
    s_mov_b32 s77, 0x3f803f80
    v_lshlrev_b32 v4, 4, v1
    v_bfe_u32 v7, v1, 2, 2
    v_and_b32 v8, 3, v1
    v_mul_u32_u24 v13, 960, v9
    v_lshl_add_u32 v13, v10, 4, v13
    s_mul_i32 s3, s48, 1920
    s_add_u32 s3, s3, 147456
    v_add_u32 v230, s3, v13
    v_mul_u32_u24 v13, 960, v7
    v_lshl_add_u32 v13, v3, 5, v13
    v_lshl_add_u32 v13, v8, 3, v13
    s_lshl_b32 s3, s48, 8
    s_add_u32 s3, s3, 147456
    v_add_u32 v231, s3, v13
    s_lshl_b32 s3, s48, 3
    s_add_u32 s3, s3, 155648
    v_lshl_add_u32 v232, v9, 2, s3
    v_lshlrev_b32 v237, 2, v6
    v_and_b32 v2, 15, v1
    v_lshlrev_b32 v238, 14, v3
    v_add_lshl_u32 v238, v238, v2, 2
    v_add_u32 v237, 155648, v237
    v_lshlrev_b32 v13, 17, v9
    v_lshl_add_u32 v233, v10, 4, v13
    s_cmp_eq_u32 s48, 3
    s_cselect_b32 s60, 268435456, 0
    s_lshl_b32 s70, s48, 10
    s_add_u32 s70, s70, s2
    s_lshl_b32 s70, s70, 9
    s_add_u32 s71, s70, 262144
    s_add_u32 s71, s71, s60
    s_xor_b32 s60, s60, 268435456
    s_lshl_b32 s72, s2, 7
    s_add_u32 s72, s72, s60
    s_add_u32 s72, s72, 6291456
    s_lshr_b32 s74, s2, 2
    s_lshl_b32 s74, s74, 5
    s_and_b32 s3, s2, 3
    s_add_u32 s74, s74, s3
    s_lshl_b32 s74, s74, 2
    s_add_u32 s74, s74, 10485760
    v_cmp_gt_u32 vcc, 8, v0
    v_lshlrev_b32 v236, 13, v0
    v_mov_b32 v13, 268435456
    s_and_b32 s3, s2, 7
    s_lshl_b32 s3, s3, 13
    s_add_u32 s3, s3, 10485760
    v_lshrrev_b32 v14, 2, v0
    v_lshl_add_u32 v14, v14, 7, s3
    v_lshl_add_u32 v20, v8, 2, v14
    v_cndmask_b32 v236, v13, v236, vcc
    v_mov_b32 v16, 0
    s_lshl_b32 s3, s48, 14
    s_add_u32 s74, s74, s3
    s_add_u32 s73, s74, 8192
    s_waitcnt vmcnt(8)
    v_dot2_f32_bf16 v226, v182, s77, 0
    v_dot2_f32_bf16 v227, v182, v182, 0
    v_dot2_f32_bf16 v226, v183, s77, v226
    v_dot2_f32_bf16 v227, v183, v183, v227
    v_dot2_f32_bf16 v226, v184, s77, v226
    v_dot2_f32_bf16 v227, v184, v184, v227
    v_dot2_f32_bf16 v226, v185, s77, v226
    v_dot2_f32_bf16 v227, v185, v185, v227
    s_waitcnt vmcnt(7)
    v_dot2_f32_bf16 v226, v186, s77, v226
    v_dot2_f32_bf16 v227, v186, v186, v227
    v_dot2_f32_bf16 v226, v187, s77, v226
    v_dot2_f32_bf16 v227, v187, v187, v227
    v_dot2_f32_bf16 v226, v188, s77, v226
    v_dot2_f32_bf16 v227, v188, v188, v227
    v_dot2_f32_bf16 v226, v189, s77, v226
    v_dot2_f32_bf16 v227, v189, v189, v227
    buffer_load_dword v12, v16, s[44:47], 0 offen sc1
    v_lshlrev_b32 v190, 16, v182
    v_and_b32 v191, 0xffff0000, v182
    v_add_f32_dpp v226, v226, v226 quad_perm:[1,0,3,2] row_mask:0xf bank_mask:0xf
    v_add_f32_dpp v227, v227, v227 quad_perm:[1,0,3,2] row_mask:0xf bank_mask:0xf
    v_lshlrev_b32 v192, 16, v183
    v_add_f32_dpp v226, v226, v226 quad_perm:[2,3,0,1] row_mask:0xf bank_mask:0xf
    v_add_f32_dpp v227, v227, v227 quad_perm:[2,3,0,1] row_mask:0xf bank_mask:0xf
    v_and_b32 v193, 0xffff0000, v183
    v_add_f32_dpp v226, v226, v226 row_half_mirror row_mask:0xf bank_mask:0xf
    v_add_f32_dpp v227, v227, v227 row_half_mirror row_mask:0xf bank_mask:0xf
    v_lshlrev_b32 v194, 16, v184
    v_add_f32_dpp v226, v226, v226 row_mirror row_mask:0xf bank_mask:0xf
    v_add_f32_dpp v227, v227, v227 row_mirror row_mask:0xf bank_mask:0xf
    v_and_b32 v195, 0xffff0000, v184
    v_mov_b32 v228, v226
    v_mov_b32 v229, v227
    v_lshlrev_b32 v196, 16, v185
    v_permlane16_swap_b32 v226, v228
    v_permlane16_swap_b32 v227, v229
    v_add_f32 v226, v226, v228
    v_add_f32 v227, v227, v229
    v_mul_f32_e64 v226, -v226, s76
    v_mul_f32 v228, v226, v226
    v_fma_f32 v227, v227, s76, -v228
    v_max_f32 v227, 0, v227
    v_add_f32 v228, s75, v227
    v_rsq_f32 v222, v228
    v_and_b32 v197, 0xffff0000, v185
    v_mul_f32 v228, v222, v222
    v_fma_f32 v229, v228, v227, s75
    v_rsq_f32 v228, v229
    v_mul_f32 v223, v226, v222
    v_mul_f32 v224, v222, v228
    v_mul_f32 v225, v223, v228
    v_mul_f32 v229, v229, v228
    ds_write_b32 v232, v229
    v_lshlrev_b32 v198, 16, v186
    v_and_b32 v199, 0xffff0000, v186
    v_lshlrev_b32 v200, 16, v187
    v_and_b32 v201, 0xffff0000, v187
    v_lshlrev_b32 v202, 16, v188
    v_and_b32 v203, 0xffff0000, v188
    v_lshlrev_b32 v204, 16, v189
    v_and_b32 v205, 0xffff0000, v189
    v_pk_fma_f32 v[206:207], v[190:191], v[224:225], v[224:225] op_sel:[0,0,1] op_sel_hi:[1,0,1]
    v_pk_fma_f32 v[208:209], v[192:193], v[224:225], v[224:225] op_sel:[0,0,1] op_sel_hi:[1,0,1]
    v_pk_fma_f32 v[210:211], v[194:195], v[224:225], v[224:225] op_sel:[0,0,1] op_sel_hi:[1,0,1]
    v_pk_fma_f32 v[212:213], v[196:197], v[224:225], v[224:225] op_sel:[0,0,1] op_sel_hi:[1,0,1]
    v_cvt_pk_bf16_f32 v182, v206, v207
    v_cvt_pk_bf16_f32 v183, v208, v209
    v_cvt_pk_bf16_f32 v184, v210, v211
    v_cvt_pk_bf16_f32 v185, v212, v213
    ds_write_b128 v230, v[182:185] offset:0
    v_pk_fma_f32 v[214:215], v[198:199], v[224:225], v[224:225] op_sel:[0,0,1] op_sel_hi:[1,0,1]
    v_pk_fma_f32 v[216:217], v[200:201], v[224:225], v[224:225] op_sel:[0,0,1] op_sel_hi:[1,0,1]
    v_pk_fma_f32 v[218:219], v[202:203], v[224:225], v[224:225] op_sel:[0,0,1] op_sel_hi:[1,0,1]
    v_pk_fma_f32 v[220:221], v[204:205], v[224:225], v[224:225] op_sel:[0,0,1] op_sel_hi:[1,0,1]
    v_cvt_pk_bf16_f32 v186, v214, v215
    v_cvt_pk_bf16_f32 v187, v216, v217
    v_cvt_pk_bf16_f32 v188, v218, v219
    v_cvt_pk_bf16_f32 v189, v220, v221
    ds_write_b128 v230, v[186:189] offset:448
    s_waitcnt lgkmcnt(0)
    s_barrier
    ds_read_b64_tr_b16 v[110:111], v231 offset:0
    ds_read_b64_tr_b16 v[112:113], v231 offset:3840
    ds_read_b64_tr_b16 v[114:115], v231 offset:128
    ds_read_b64_tr_b16 v[116:117], v231 offset:3968
    ds_read_b32 v229, v237
    s_waitcnt lgkmcnt(3)
    buffer_store_dwordx4 v[110:113], v233, s[28:31], s70 offen sc1
    s_waitcnt lgkmcnt(1)
    buffer_store_dwordx4 v[114:117], v233, s[28:31], s71 offen sc1
    v_cmp_gt_u32 vcc, 16, v1
    s_waitcnt lgkmcnt(0)
    s_nop 0
    v_cndmask_b32 v229, 0, v229, vcc
    buffer_store_dword v229, v238, s[28:31], s72 offen sc1
    s_add_u32 m0, s58, 16384
    s_add_u32 s0, s0, 458752
    s_cmp_eq_u32 s0, 3670016
    s_cselect_b32 s0, 0, s0
    buffer_load_dwordx4 v55, s[20:23], s0 offen lds
    buffer_load_dwordx4 v56, s[20:23], s0 offen offset:1024 lds
    buffer_load_dwordx4 v57, s[20:23], s0 offen offset:2048 lds
    buffer_load_dwordx4 v58, s[20:23], s0 offen offset:3072 lds
    s_branch L_anchor
.p2align 12
L_anchor:
    s_mov_b32 s18, 401408
    s_mov_b32 s19, 0x20000
    s_mov_b32 s26, 7340032
    s_mov_b32 s27, 0x20000
    s_mov_b32 s34, 1835008
    s_mov_b32 s35, 0x20000
    s_mov_b32 s36, 1
    v_lshrrev_b32 v14, 2, v1
    v_lshlrev_b32 v14, 7, v14
    v_lshl_add_u32 v14, v8, 3, v14
    v_and_b32 v15, 3, v5
    v_lshl_add_u32 v14, v15, 5, v14
    s_mul_i32 s3, s4, 8256
    v_xor_b32 v31, s3, v14
    v_xor_b32 v32, 32, v31
    v_xor_b32 v33, 64, v31
    v_xor_b32 v34, 96, v31
    v_add_u32 v35, 65536, v31
    v_add_u32 v36, 65536, v32
    v_add_u32 v37, 65536, v33
    v_add_u32 v38, 65536, v34
    v_add_u32 v39, 131072, v31
    v_add_u32 v40, 131072, v32
    v_add_u32 v41, 131072, v33
    v_add_u32 v42, 131072, v34
    s_lshl_b32 s6, s52, 1
    s_add_u32 s6, s6, s5
    s_lshl_b32 s3, s6, 1
    s_add_u32 s3, s3, s59
    s_lshl_b32 s3, s3, 4
    s_add_u32 s3, s3, s4
    s_lshl_b32 s3, s3, 12
    v_lshl_add_u32 v78, v3, 8, v4
    v_add_u32 v78, s3, v78
    s_xor_b32 s37, s51, 1
    s_lshl_b32 s37, s37, 3
    s_add_u32 s37, s37, s52
    s_lshl_b32 s3, s37, 14
    s_add_u32 s3, s3, s58
    s_add_u32 s3, s3, 16777216
    v_add_u32 v23, s3, v4
    s_lshl_b32 s37, s37, 5
    s_add_u32 s37, s37, s5
    s_lshl_b32 s37, s37, 2
    s_add_u32 s37, s37, 6422528
    s_mul_i32 s67, s6, 56
    s_lshl_b32 s3, s51, 1
    s_add_u32 s3, s3, s4
    s_add_u32 s67, s67, s3
    s_lshl_b32 s67, s67, 11
    s_add_u32 s67, s67, 2097152
    v_add_u32 v81, s58, v4
    s_lshl_b32 s68, s52, 2
    s_and_b32 s3, s51, 1
    s_add_u32 s68, s68, s3
    s_cmp_ge_u32 s51, 14
    s_cselect_b32 s3, 2, 0
    s_add_u32 s68, s68, s3
    s_lshl_b32 s68, s68, 7
    s_add_u32 s68, s68, 6356992
    s_waitcnt vmcnt(7)
    v_readfirstlane_b32 s57, v12
    s_mov_b32 s60, 0
    s_cmp_lg_u32 s57, 0
    s_cbranch_scc0 L_nonce
L_nonce_ok:
    s_waitcnt vmcnt(4)
    s_barrier
    s_atomic_swap s57, s[28:29], s74
    s_atomic_swap s57, s[28:29], s73
    buffer_load_dwordx4 v[96:99], v85, s[8:11], 0 offen
    buffer_load_ushort v93, v82, s[40:43], 0 offen offset:0
    buffer_load_dwordx4 v[100:103], v86, s[8:11], 0 offen
    buffer_load_ushort v94, v82, s[40:43], 0 offen offset:16
    v_add_u32 v53, 65536, v4
    s_add_u32 m0, s58, 32768
    s_add_u32 s0, s0, 458752
    s_cmp_eq_u32 s0, 3670016
    s_cselect_b32 s0, 0, s0
    buffer_load_dwordx4 v55, s[20:23], s0 offen lds
    v_add_u32 v54, 131072, v4
    s_mul_i32 s59, s48, 3072
    s_mul_i32 s3, s50, 86016
    s_add_u32 s3, s3, s59
    s_add_u32 s3, s3, 8388608
    v_add_u32 v80, s3, v4
    v_lshlrev_b32 v14, 7, v9
    v_xor_b32 v14, v14, v4
    s_lshl_b32 s3, s49, 11
    v_add_u32 v67, s3, v14
    v_add_u32 v68, 129024, v67
    s_lshr_b32 s3, s49, 2
    s_lshl_b32 s3, s3, 3
    s_max_u32 s3, s3, 1
    s_sub_u32 s3, s3, 1
    s_lshl_b32 s3, s3, 10
    s_lshl_b32 s6, s5, 17
    s_add_u32 s3, s3, s6
    s_lshl_b32 s6, s4, 28
    s_add_u32 s3, s3, s6
    v_add_u32 v69, s3, v14
    buffer_load_dwordx4 v56, s[20:23], s0 offen offset:1024 lds
    s_lshl_b32 s100, s5, 1
    s_add_u32 s100, s100, s4
    s_lshl_b32 s100, s100, 10
    v_and_b32 v14, 1, v1
    v_mul_u32_u24 v14, 640, v14
    v_lshrrev_b32 v15, 2, v1
    v_lshlrev_b32 v15, 4, v15
    v_xor_b32 v14, v14, v15
    v_bfe_u32 v15, v1, 1, 1
    v_lshl_add_u32 v14, v15, 3, v14
    buffer_load_dwordx4 v57, s[20:23], s0 offen offset:2048 lds
    s_add_u32 s3, s58, 12288
    v_add_u32 v70, s3, v14
    s_sub_u32 s3, s3, 3072
    s_cmp_eq_u32 s48, 0
    s_cselect_b32 s3, 28672, s3
    v_add_u32 v71, s3, v14
    v_add_u32 v72, 65536, v70
    v_add_u32 v73, 65536, v71
    v_add_u32 v74, 131072, v70
    v_add_u32 v75, 131072, v71
    s_lshl_b32 s3, s49, 1
    v_min_u32 v14, 2, v3
    v_add_u32 v14, s3, v14
    v_max_u32 v14, 1, v14
    v_lshlrev_b32 v14, 1, v14
    v_and_b32 v15, 1, v7
    buffer_load_dwordx4 v58, s[20:23], s0 offen offset:3072 lds
    v_add_lshl_u32 v14, v14, v15, 7
    v_lshrrev_b32 v15, 1, v7
    v_lshl_add_u32 v15, v15, 2, v8
    v_lshl_add_u32 v14, v15, 2, v14
    v_add_u32 v77, 6291200, v14
    s_min_u32 s15, s48, 2
    s_lshl_b32 s15, s15, 6
    s_add_u32 s15, s15, 64
    s_lshl_b32 s82, s49, 5
    s_add_u32 s82, s82, s50
    s_lshl_b32 s82, s82, 10
    s_add_u32 s82, s82, 4194304
    s_lshr_b32 s69, s49, 2
    s_lshl_b32 s69, s69, 1
    s_and_b32 s3, s50, 1
    s_add_u32 s69, s69, s3
    s_lshl_b32 s69, s69, 7
    s_add_u32 s69, s69, 6361088
    s_and_b32 s7, s53, 1
    s_mul_i32 s3, s7, 28
    s_add_u32 s3, s3, s48
    s_lshl_b32 s3, s3, 17
    s_xor_b32 s6, s53, 1
    s_lshl_b32 s55, s6, 3
    s_lshl_b32 s6, s53, 7
    s_add_u32 s3, s3, s6
    v_lshlrev_b32 v14, 12, v5
    s_add_u32 m0, s58, 49152
    s_add_u32 s0, s0, 458752
    s_cmp_eq_u32 s0, 3670016
    s_cselect_b32 s0, 0, s0
    buffer_load_dwordx4 v55, s[20:23], s0 offen lds
    v_add3_u32 v59, v14, v83, s3
    v_add_u32 v60, 31744, v59
    v_add_u32 v61, 63488, v59
    v_add_u32 v62, 95232, v59
    v_mul_u32_u24 v14, 896, v5
    s_mul_i32 s3, s4, 25088
    s_mul_i32 s6, s5, 14336
    s_add_u32 s3, s3, s6
    s_lshl_b32 s6, s54, 7
    s_add_u32 s3, s3, s6
    v_add3_u32 v63, v14, v83, s3
    buffer_load_dwordx4 v56, s[20:23], s0 offen offset:1024 lds
    v_add_u32 v64, 6144, v63
    s_lshl_b32 s6, s53, 1
    s_add_u32 s6, s6, s5
    s_and_b32 s3, s53, 30
    s_add_u32 s3, s3, s4
    s_lshl_b32 s3, s3, 7
    s_add_u32 s39, s3, 6361088
    s_lshl_b32 s3, s6, 5
    s_add_u32 s3, s3, s4
    s_lshl_b32 s3, s3, 10
    s_add_u32 s3, s3, 4194304
    v_add_u32 v65, s3, v4
    v_add_u32 v66, 15360, v65
    s_xor_b32 s3, s4, s5
    s_lshl_b32 s3, s3, 6
    v_xor_b32 v43, s3, v31
    buffer_load_dwordx4 v57, s[20:23], s0 offen offset:2048 lds
    v_xor_b32 v44, 32, v43
    v_add_u32 v45, 65536, v43
    v_add_u32 v46, 65536, v44
    s_mul_i32 s3, s4, 12288
    v_add_u32 v47, s3, v4
    v_xor_b32 v48, 4096, v47
    v_add_u32 v49, 65536, v47
    v_add_u32 v50, 65536, v48
    v_add_u32 v51, 131072, v47
    v_add_u32 v52, 131072, v48
    s_lshl_b32 s6, s54, 1
    s_add_u32 s6, s6, s5
    s_lshl_b32 s3, s6, 1
    s_add_u32 s3, s3, s7
    s_mul_i32 s3, s3, 14
    s_add_u32 s3, s3, s4
    s_lshl_b32 s3, s3, 12
    s_add_u32 s3, s3, 2097152
    v_add_u32 v79, s3, v4
    buffer_load_dwordx4 v58, s[20:23], s0 offen offset:3072 lds
    s_lshl_b32 s3, s54, 1
    s_add_u32 s3, s3, s7
    s_lshl_b32 s3, s3, 1
    s_add_u32 s3, s3, s4
    s_lshl_b32 s3, s3, 7
    s_add_u32 s38, s3, 6356992
    s_and_b32 s3, s2, 6
    s_add_u32 s3, s3, s54
    s_sub_u32 s6, s3, 7
    s_cmp_ge_u32 s3, 7
    s_cselect_b32 s3, s6, s3
    s_lshl_b32 s64, s3, 19
    s_lshl_b32 s65, s3, 13
    s_add_u32 s55, s55, s54
    s_lshl_b32 s3, s55, 14
    s_add_u32 s3, s3, s58
    s_add_u32 s3, s3, 12582912
    v_add_u32 v21, s3, v4
    s_add_u32 m0, s58, 65536
    s_add_u32 s0, s0, 458752
    s_cmp_eq_u32 s0, 3670016
    s_cselect_b32 s0, 0, s0
    buffer_load_dwordx4 v55, s[20:23], s0 offen lds
    s_lshl_b32 s55, s55, 5
    s_add_u32 s55, s55, s48
    s_lshl_b32 s55, s55, 2
    s_add_u32 s55, s55, 6488064
    s_lshl_b32 s3, s5, 3
    v_add_u32 v13, s3, v3
    v_xor_b32 v13, v13, v6
    v_lshlrev_b32 v13, 4, v13
    v_lshl_add_u32 v13, v2, 8, v13
    buffer_load_dwordx4 v56, s[20:23], s0 offen offset:1024 lds
    s_lshl_b32 s3, s4, 14
    s_add_u32 s3, s3, 32768
    v_add_u32 v87, s3, v13
    v_xor_b32 v88, 64, v87
    s_lshr_b32 s3, s53, 1
    s_add_u32 s66, s3, s54
    s_mov_b32 s51, s66
    v_lshlrev_b32 v13, 1, v6
    v_xor_b32 v13, v13, v5
    v_lshlrev_b32 v13, 4, v13
    v_lshl_add_u32 v13, v5, 8, v13
    s_add_u32 s3, s58, 32768
    v_add_u32 v89, s3, v13
    v_xor_b32 v90, 16, v89
    v_xor_b32 v91, 24576, v89
    v_xor_b32 v92, 24592, v89
    buffer_load_dwordx4 v57, s[20:23], s0 offen offset:2048 lds
    v_lshlrev_b32 v150, 16, v246
    v_and_b32 v151, 0xffff0000, v246
    v_lshlrev_b32 v152, 16, v247
    v_and_b32 v153, 0xffff0000, v247
    v_lshlrev_b32 v154, 16, v248
    v_and_b32 v155, 0xffff0000, v248
    v_lshlrev_b32 v156, 16, v249
    v_and_b32 v157, 0xffff0000, v249
    v_lshlrev_b32 v158, 16, v246
    v_and_b32 v159, 0xffff0000, v246
    v_lshlrev_b32 v160, 16, v247
    v_and_b32 v161, 0xffff0000, v247
    v_lshlrev_b32 v162, 16, v248
    v_and_b32 v163, 0xffff0000, v248
    v_lshlrev_b32 v164, 16, v249
    v_and_b32 v165, 0xffff0000, v249
    buffer_load_dwordx4 v58, s[20:23], s0 offen offset:3072 lds
    s_add_u32 m0, s58, 81920
    s_add_u32 s0, s0, 458752
    s_cmp_eq_u32 s0, 3670016
    s_cselect_b32 s0, 0, s0
    buffer_load_dwordx4 v55, s[20:23], s0 offen lds
    buffer_load_dwordx4 v56, s[20:23], s0 offen offset:1024 lds
    buffer_load_dwordx4 v57, s[20:23], s0 offen offset:2048 lds
    buffer_load_dwordx4 v58, s[20:23], s0 offen offset:3072 lds
    buffer_load_dword v18, v20, s[28:31], 0 offen sc1
    s_add_u32 m0, s58, 98304
    s_add_u32 s0, s0, 458752
    s_cmp_eq_u32 s0, 3670016
    s_cselect_b32 s0, 0, s0
    buffer_load_dwordx4 v55, s[20:23], s0 offen lds
    buffer_load_dwordx4 v56, s[20:23], s0 offen offset:1024 lds
    buffer_load_dwordx4 v57, s[20:23], s0 offen offset:2048 lds
    buffer_load_dwordx4 v58, s[20:23], s0 offen offset:3072 lds
    s_add_u32 m0, s58, 114688
    s_add_u32 s0, s0, 458752
    s_cmp_eq_u32 s0, 3670016
    s_cselect_b32 s0, 0, s0
    buffer_load_dwordx4 v55, s[20:23], s0 offen lds
    buffer_load_dwordx4 v56, s[20:23], s0 offen offset:1024 lds
    buffer_load_dwordx4 v57, s[20:23], s0 offen offset:2048 lds
    buffer_load_dwordx4 v58, s[20:23], s0 offen offset:3072 lds
    s_mov_b32 s3, s48
    s_mov_b64 exec, 0
L_warm:
    s_add_u32 s3, s3, 4
    s_cmp_eq_u32 s3, 4
    s_cbranch_scc1 L_pad0
    s_cmp_eq_u32 s3, 5
    s_cbranch_scc1 L_pad1
    s_cmp_eq_u32 s3, 6
    s_cbranch_scc1 L_pad2
    s_cmp_eq_u32 s3, 7
    s_cbranch_scc1 L_pad3
    s_cmp_eq_u32 s3, 8
    s_cbranch_scc1 L_pad4
    s_mov_b64 exec, -1
    s_waitcnt vmcnt(8)
    v_cmp_ne_u32 vcc, s57, v18
    s_cbranch_vccnz L_pollin0
L_pollok0:
    s_barrier
    buffer_load_dwordx4 a[0:3], v78, s[28:31], s1 offen offset:0 sc1
    buffer_load_dwordx4 a[4:7], v78, s[28:31], s1 offen offset:256 sc1
    buffer_load_dwordx4 a[8:11], v78, s[28:31], s1 offen offset:2048 sc1
    buffer_load_dwordx4 a[12:15], v78, s[28:31], s1 offen offset:2304 sc1
    buffer_load_dword v76, v77, s[28:31], 0 offen sc1
    s_add_u32 s1, s1, 8192
    s_and_b32 s1, s1, 0xffff
    buffer_load_dwordx4 a[16:19], v78, s[28:31], s1 offen offset:0 sc1
    buffer_load_dwordx4 a[20:23], v78, s[28:31], s1 offen offset:256 sc1
    buffer_load_dwordx4 a[24:27], v78, s[28:31], s1 offen offset:2048 sc1
    buffer_load_dwordx4 a[28:31], v78, s[28:31], s1 offen offset:2304 sc1
    s_add_u32 s1, s1, 8192
    s_and_b32 s1, s1, 0xffff
    buffer_load_dwordx4 a[32:35], v78, s[28:31], s1 offen offset:0 sc1
    buffer_load_dwordx4 a[36:39], v78, s[28:31], s1 offen offset:256 sc1
    buffer_load_dwordx4 a[40:43], v78, s[28:31], s1 offen offset:2048 sc1
    buffer_load_dwordx4 a[44:47], v78, s[28:31], s1 offen offset:2304 sc1
    ds_read_b64_tr_b16 a[200:201], v31 offset:0
    ds_read_b64_tr_b16 a[202:203], v31 offset:2048
    ds_read_b64_tr_b16 a[204:205], v33 offset:0
    ds_read_b64_tr_b16 a[206:207], v33 offset:2048
    ds_read_b64_tr_b16 a[208:209], v32 offset:0
    ds_read_b64_tr_b16 a[210:211], v32 offset:2048
    ds_read_b64_tr_b16 a[212:213], v34 offset:0
    ds_read_b64_tr_b16 a[214:215], v34 offset:2048
    ds_read_b64_tr_b16 a[216:217], v31 offset:4096
    ds_read_b64_tr_b16 a[218:219], v31 offset:6144
    ds_read_b64_tr_b16 a[220:221], v33 offset:4096
    ds_read_b64_tr_b16 a[222:223], v33 offset:6144
    s_waitcnt vmcnt(11) lgkmcnt(8)
    v_mfma_f32_16x16x32_bf16 v[182:185], a[200:203], a[0:3], 0
    ds_read_b64_tr_b16 a[224:225], v32 offset:4096
    s_add_u32 s1, s1, 8192
    v_mfma_f32_16x16x32_bf16 v[190:193], a[200:203], a[4:7], 0
    ds_read_b64_tr_b16 a[226:227], v32 offset:6144
    s_and_b32 s1, s1, 0xffff
    s_mov_b32 s70, 0xaaaaaaaa
    s_mov_b32 s71, 0xaaaaaaaa
    s_mov_b32 s72, 0xfff0ffff
    s_mov_b32 s73, 0xf000ff00
    s_mov_b32 s74, 0xffc0fffc
    v_mfma_f32_16x16x32_bf16 v[198:201], a[204:207], a[0:3], 0
    ds_read_b64_tr_b16 a[228:229], v34 offset:4096
    buffer_load_dwordx4 a[48:51], v78, s[28:31], s1 offen offset:0 sc1
    v_mfma_f32_16x16x32_bf16 v[206:209], a[204:207], a[4:7], 0
    ds_read_b64_tr_b16 a[230:231], v34 offset:6144
    s_mov_b32 s75, 0xc000fc00
    s_waitcnt lgkmcnt(8)
    v_mfma_f32_16x16x32_bf16 v[186:189], a[208:211], a[0:3], 0
    ds_read_b64_tr_b16 a[200:201], v31 offset:16384
    s_mov_b32 s83, 0x3e8b97f6
    v_mfma_f32_16x16x32_bf16 v[194:197], a[208:211], a[4:7], 0
    ds_read_b64_tr_b16 a[202:203], v31 offset:18432
    buffer_load_dwordx4 a[52:55], v78, s[28:31], s1 offen offset:256 sc1
    v_lshlrev_b32 v13, 2, v2
    v_mfma_f32_16x16x32_bf16 v[202:205], a[212:215], a[0:3], 0
    ds_read_b64_tr_b16 a[204:205], v33 offset:16384
    v_and_b32 v14, 1, v1
    v_mfma_f32_16x16x32_bf16 v[210:213], a[212:215], a[4:7], 0
    ds_read_b64_tr_b16 a[206:207], v33 offset:18432
    s_waitcnt vmcnt(11) lgkmcnt(8)
    v_mfma_f32_16x16x32_bf16 v[182:185], a[216:219], a[8:11], v[182:185]
    ds_read_b64_tr_b16 a[208:209], v32 offset:16384
    buffer_load_dwordx4 a[56:59], v78, s[28:31], s1 offen offset:2048 sc1
    v_mfma_f32_16x16x32_bf16 v[190:193], a[216:219], a[12:15], v[190:193]
    ds_read_b64_tr_b16 a[210:211], v32 offset:18432
    v_lshl_add_u32 v14, v3, 2, v14
    v_mfma_f32_16x16x32_bf16 v[198:201], a[220:223], a[8:11], v[198:201]
    ds_read_b64_tr_b16 a[212:213], v34 offset:16384
    v_lshlrev_b32 v14, 2, v14
    v_mfma_f32_16x16x32_bf16 v[206:209], a[220:223], a[12:15], v[206:209]
    ds_read_b64_tr_b16 a[214:215], v34 offset:18432
    s_waitcnt lgkmcnt(8)
    v_mfma_f32_16x16x32_bf16 v[186:189], a[224:227], a[8:11], v[186:189]
    ds_read_b64_tr_b16 a[216:217], v31 offset:20480
    buffer_load_dwordx4 a[60:63], v78, s[28:31], s1 offen offset:2304 sc1
    v_mfma_f32_16x16x32_bf16 v[194:197], a[224:227], a[12:15], v[194:197]
    ds_read_b64_tr_b16 a[218:219], v31 offset:22528
    s_add_u32 s1, s1, 8192
    v_add_u32 v15, 64, v14
    v_mfma_f32_16x16x32_bf16 v[202:205], a[228:231], a[8:11], v[202:205]
    ds_read_b64_tr_b16 a[220:221], v33 offset:20480
    s_and_b32 s1, s1, 0xffff
    v_mfma_f32_16x16x32_bf16 v[210:213], a[228:231], a[12:15], v[210:213]
    ds_read_b64_tr_b16 a[222:223], v33 offset:22528
    s_waitcnt vmcnt(10) lgkmcnt(8)
    v_mfma_f32_16x16x32_bf16 v[182:185], a[200:203], a[16:19], v[182:185]
    ds_read_b64_tr_b16 a[224:225], v32 offset:20480
    buffer_load_dwordx4 a[64:67], v78, s[28:31], s1 offen offset:0 sc1
    v_mfma_f32_16x16x32_bf16 v[190:193], a[200:203], a[20:23], v[190:193]
    ds_read_b64_tr_b16 a[226:227], v32 offset:22528
    v_cndmask_b32 v16, v14, v15, s[72:73]
    v_mfma_f32_16x16x32_bf16 v[198:201], a[204:207], a[16:19], v[198:201]
    ds_read_b64_tr_b16 a[228:229], v34 offset:20480
    buffer_load_dwordx4 a[68:71], v78, s[28:31], s1 offen offset:256 sc1
    v_mfma_f32_16x16x32_bf16 v[206:209], a[204:207], a[20:23], v[206:209]
    ds_read_b64_tr_b16 a[230:231], v34 offset:22528
    v_cndmask_b32 v14, v14, v15, s[74:75]
    s_waitcnt lgkmcnt(8)
    v_mfma_f32_16x16x32_bf16 v[186:189], a[208:211], a[16:19], v[186:189]
    ds_read_b64_tr_b16 a[200:201], v31 offset:32768
    ds_bpermute_b32 v25, v13, v76 offset:64
    v_mfma_f32_16x16x32_bf16 v[194:197], a[208:211], a[20:23], v[194:197]
    ds_read_b64_tr_b16 a[202:203], v31 offset:34816
    buffer_load_dwordx4 a[72:75], v78, s[28:31], s1 offen offset:2048 sc1
    ds_bpermute_b32 v27, v16, v76 offset:0
    v_mfma_f32_16x16x32_bf16 v[202:205], a[212:215], a[16:19], v[202:205]
    ds_read_b64_tr_b16 a[204:205], v33 offset:32768
    ds_bpermute_b32 v28, v14, v76 offset:8
    v_mfma_f32_16x16x32_bf16 v[210:213], a[212:215], a[20:23], v[210:213]
    ds_read_b64_tr_b16 a[206:207], v33 offset:34816
    s_waitcnt vmcnt(11) lgkmcnt(11)
    v_mfma_f32_16x16x32_bf16 v[182:185], a[216:219], a[24:27], v[182:185]
    ds_read_b64_tr_b16 a[208:209], v32 offset:32768
    ds_bpermute_b32 v26, v13, v76 offset:128
    v_mfma_f32_16x16x32_bf16 v[190:193], a[216:219], a[28:31], v[190:193]
    ds_read_b64_tr_b16 a[210:211], v32 offset:34816
    buffer_load_dwordx4 a[76:79], v78, s[28:31], s1 offen offset:2304 sc1
    ds_bpermute_b32 v29, v16, v76 offset:64
    v_mfma_f32_16x16x32_bf16 v[198:201], a[220:223], a[24:27], v[198:201]
    ds_read_b64_tr_b16 a[212:213], v34 offset:32768
    s_add_u32 s1, s1, 8192
    v_mfma_f32_16x16x32_bf16 v[206:209], a[220:223], a[28:31], v[206:209]
    ds_read_b64_tr_b16 a[214:215], v34 offset:34816
    s_waitcnt lgkmcnt(13)
    v_mfma_f32_16x16x32_bf16 v[186:189], a[224:227], a[24:27], v[186:189]
    ds_read_b64_tr_b16 a[216:217], v31 offset:36864
    s_and_b32 s1, s1, 0xffff
    v_mfma_f32_16x16x32_bf16 v[194:197], a[224:227], a[28:31], v[194:197]
    ds_read_b64_tr_b16 a[218:219], v31 offset:38912
    buffer_load_dwordx4 a[80:83], v78, s[28:31], s1 offen offset:0 sc1
    ds_bpermute_b32 v30, v14, v76 offset:72
    v_mfma_f32_16x16x32_bf16 v[202:205], a[228:231], a[24:27], v[202:205]
    ds_read_b64_tr_b16 a[220:221], v33 offset:36864
    v_mfma_f32_16x16x32_bf16 v[210:213], a[228:231], a[28:31], v[210:213]
    ds_read_b64_tr_b16 a[222:223], v33 offset:38912
    s_waitcnt vmcnt(11) lgkmcnt(11)
    v_mfma_f32_16x16x32_bf16 v[182:185], a[200:203], a[32:35], v[182:185]
    ds_read_b64_tr_b16 a[224:225], v32 offset:36864
    buffer_load_dwordx4 a[84:87], v78, s[28:31], s1 offen offset:256 sc1
    v_mfma_f32_16x16x32_bf16 v[190:193], a[200:203], a[36:39], v[190:193]
    ds_read_b64_tr_b16 a[226:227], v32 offset:38912
    v_mfma_f32_16x16x32_bf16 v[198:201], a[204:207], a[32:35], v[198:201]
    ds_read_b64_tr_b16 a[228:229], v34 offset:36864
    v_mfma_f32_16x16x32_bf16 v[206:209], a[204:207], a[36:39], v[206:209]
    ds_read_b64_tr_b16 a[230:231], v34 offset:38912
    s_waitcnt lgkmcnt(9)
    v_mfma_f32_16x16x32_bf16 v[186:189], a[208:211], a[32:35], v[186:189]
    s_barrier
    ds_read_b64_tr_b16 a[200:201], v31 offset:49152
    buffer_load_dwordx4 a[88:91], v78, s[28:31], s1 offen offset:2048 sc1
    v_mfma_f32_16x16x32_bf16 v[194:197], a[208:211], a[36:39], v[194:197]
    ds_read_b64_tr_b16 a[202:203], v31 offset:51200
    v_mfma_f32_16x16x32_bf16 v[202:205], a[212:215], a[32:35], v[202:205]
    ds_read_b64_tr_b16 a[204:205], v33 offset:49152
    buffer_load_dwordx4 a[92:95], v78, s[28:31], s1 offen offset:2304 sc1
    v_mfma_f32_16x16x32_bf16 v[210:213], a[212:215], a[36:39], v[210:213]
    ds_read_b64_tr_b16 a[206:207], v33 offset:51200
    s_waitcnt vmcnt(12) lgkmcnt(8)
    v_mfma_f32_16x16x32_bf16 v[182:185], a[216:219], a[40:43], v[182:185]
    ds_read_b64_tr_b16 a[208:209], v32 offset:49152
    s_add_u32 m0, s58, 131072
    v_mfma_f32_16x16x32_bf16 v[190:193], a[216:219], a[44:47], v[190:193]
    ds_read_b64_tr_b16 a[210:211], v32 offset:51200
    s_add_u32 s0, s0, 458752
    v_mul_f32 v25, s83, v25
    v_mfma_f32_16x16x32_bf16 v[198:201], a[220:223], a[40:43], v[198:201]
    ds_read_b64_tr_b16 a[212:213], v34 offset:49152
    s_cmp_eq_u32 s0, 3670016
    v_mfma_f32_16x16x32_bf16 v[206:209], a[220:223], a[44:47], v[206:209]
    ds_read_b64_tr_b16 a[214:215], v34 offset:51200
    s_cselect_b32 s0, 0, s0
    v_xor_b32 v55, 128, v55
    buffer_load_dwordx4 v55, s[20:23], s0 offen lds
    s_waitcnt lgkmcnt(8)
    v_mfma_f32_16x16x32_bf16 v[186:189], a[224:227], a[40:43], v[186:189]
    ds_read_b64_tr_b16 a[216:217], v31 offset:53248
    v_xor_b32 v56, 128, v56
    v_mfma_f32_16x16x32_bf16 v[194:197], a[224:227], a[44:47], v[194:197]
    ds_read_b64_tr_b16 a[218:219], v31 offset:55296
    buffer_load_dwordx4 v56, s[20:23], s0 offen offset:1024 lds
    v_mul_f32 v26, s83, v26
    v_mfma_f32_16x16x32_bf16 v[202:205], a[228:231], a[40:43], v[202:205]
    ds_read_b64_tr_b16 a[220:221], v33 offset:53248
    v_xor_b32 v57, 128, v57
    v_mfma_f32_16x16x32_bf16 v[210:213], a[228:231], a[44:47], v[210:213]
    ds_read_b64_tr_b16 a[222:223], v33 offset:55296
    s_waitcnt vmcnt(12) lgkmcnt(8)
    v_mfma_f32_16x16x32_bf16 v[182:185], a[200:203], a[48:51], v[182:185]
    ds_read_b64_tr_b16 a[224:225], v32 offset:53248
    buffer_load_dwordx4 v57, s[20:23], s0 offen offset:2048 lds
    v_mfma_f32_16x16x32_bf16 v[190:193], a[200:203], a[52:55], v[190:193]
    ds_read_b64_tr_b16 a[226:227], v32 offset:55296
    v_xor_b32 v58, 128, v58
    s_cmp_eq_u32 s49, 0
    s_cselect_b64 s[76:77], 0, -1
    v_mfma_f32_16x16x32_bf16 v[198:201], a[204:207], a[48:51], v[198:201]
    ds_read_b64_tr_b16 a[228:229], v34 offset:53248
    v_mov_b32 v13, 0xffff
    v_mfma_f32_16x16x32_bf16 v[206:209], a[204:207], a[52:55], v[206:209]
    ds_read_b64_tr_b16 a[230:231], v34 offset:55296
    s_waitcnt lgkmcnt(8)
    v_mfma_f32_16x16x32_bf16 v[186:189], a[208:211], a[48:51], v[186:189]
    ds_read_b64_tr_b16 a[200:201], v35 offset:0
    buffer_load_dwordx4 v58, s[20:23], s0 offen offset:3072 lds
    v_mfma_f32_16x16x32_bf16 v[194:197], a[208:211], a[52:55], v[194:197]
    ds_read_b64_tr_b16 a[202:203], v35 offset:2048
    s_add_u32 s1, s1, 8192
    v_mov_b32 v14, 0xffff0000
    v_mfma_f32_16x16x32_bf16 v[202:205], a[212:215], a[48:51], v[202:205]
    ds_read_b64_tr_b16 a[204:205], v37 offset:0
    s_and_b32 s1, s1, 0xffff
    v_mfma_f32_16x16x32_bf16 v[210:213], a[212:215], a[52:55], v[210:213]
    ds_read_b64_tr_b16 a[206:207], v37 offset:2048
    v_cndmask_b32 v13, v13, v14, s[70:71]
    s_waitcnt vmcnt(12) lgkmcnt(8)
    v_mfma_f32_16x16x32_bf16 v[182:185], a[216:219], a[56:59], v[182:185]
    ds_read_b64_tr_b16 a[208:209], v36 offset:0
    buffer_load_dwordx4 a[96:99], v78, s[28:31], s1 offen offset:0 sc1
    v_mfma_f32_16x16x32_bf16 v[190:193], a[216:219], a[60:63], v[190:193]
    ds_read_b64_tr_b16 a[210:211], v36 offset:2048
    v_cndmask_b32 v104, v13, 0, s[72:73]
    v_mfma_f32_16x16x32_bf16 v[198:201], a[220:223], a[56:59], v[198:201]
    ds_read_b64_tr_b16 a[212:213], v38 offset:0
    buffer_load_dwordx4 a[100:103], v78, s[28:31], s1 offen offset:256 sc1
    v_mfma_f32_16x16x32_bf16 v[206:209], a[220:223], a[60:63], v[206:209]
    ds_read_b64_tr_b16 a[214:215], v38 offset:2048
    v_cndmask_b32 v106, 0, v13, s[72:73]
    s_waitcnt lgkmcnt(8)
    v_mfma_f32_16x16x32_bf16 v[186:189], a[224:227], a[56:59], v[186:189]
    ds_read_b64_tr_b16 a[216:217], v35 offset:4096
    v_cndmask_b32 v105, v13, 0, s[74:75]
    v_mfma_f32_16x16x32_bf16 v[194:197], a[224:227], a[60:63], v[194:197]
    ds_read_b64_tr_b16 a[218:219], v35 offset:6144
    buffer_load_dwordx4 a[104:107], v78, s[28:31], s1 offen offset:2048 sc1
    v_cndmask_b32 v107, 0, v13, s[74:75]
    v_mfma_f32_16x16x32_bf16 v[202:205], a[228:231], a[56:59], v[202:205]
    ds_read_b64_tr_b16 a[220:221], v37 offset:4096
    v_mov_b32 v84, 0xf149f2ca
    v_mfma_f32_16x16x32_bf16 v[210:213], a[228:231], a[60:63], v[210:213]
    ds_read_b64_tr_b16 a[222:223], v37 offset:6144
    s_waitcnt vmcnt(13) lgkmcnt(8)
    v_mfma_f32_16x16x32_bf16 v[182:185], a[200:203], a[64:67], v[182:185]
    ds_read_b64_tr_b16 a[224:225], v36 offset:4096
    buffer_load_dwordx4 a[108:111], v78, s[28:31], s1 offen offset:2304 sc1
    v_mfma_f32_16x16x32_bf16 v[190:193], a[200:203], a[68:71], v[190:193]
    ds_read_b64_tr_b16 a[226:227], v36 offset:6144
    s_add_u32 m0, s58, 147456
    s_mov_b32 s83, 0x3e8b97f6
    v_mfma_f32_16x16x32_bf16 v[198:201], a[204:207], a[64:67], v[198:201]
    ds_read_b64_tr_b16 a[228:229], v38 offset:4096
    s_add_u32 s0, s0, 458752
    v_mfma_f32_16x16x32_bf16 v[206:209], a[204:207], a[68:71], v[206:209]
    ds_read_b64_tr_b16 a[230:231], v38 offset:6144
    s_mov_b32 s78, 0xbdd2d3e8
    s_mov_b32 s79, 0xbdd2d3e8
    s_waitcnt lgkmcnt(8)
    v_mfma_f32_16x16x32_bf16 v[186:189], a[208:211], a[64:67], v[186:189]
    s_barrier
    s_load_dword s14, s[44:45], s15
    ds_read_b64_tr_b16 a[200:201], v35 offset:16384
    s_cmp_eq_u32 s0, 3670016
    s_cselect_b32 s0, 0, s0
    buffer_load_dwordx4 v55, s[20:23], s0 offen lds
    v_mfma_f32_16x16x32_bf16 v[194:197], a[208:211], a[68:71], v[194:197]
    ds_read_b64_tr_b16 a[202:203], v35 offset:18432
    s_mov_b32 s80, 1.0
    v_mfma_f32_16x16x32_bf16 v[202:205], a[212:215], a[64:67], v[202:205]
    ds_read_b64_tr_b16 a[204:205], v37 offset:16384
    buffer_load_dwordx4 v56, s[20:23], s0 offen offset:1024 lds
    v_mfma_f32_16x16x32_bf16 v[210:213], a[212:215], a[68:71], v[210:213]
    ds_read_b64_tr_b16 a[206:207], v37 offset:18432
    s_mov_b32 s81, 1.0
    s_waitcnt vmcnt(14) lgkmcnt(8)
    v_mfma_f32_16x16x32_bf16 v[182:185], a[216:219], a[72:75], v[182:185]
    ds_read_b64_tr_b16 a[208:209], v36 offset:16384
    v_mov_b32 v108, 0xc0135761
    v_mfma_f32_16x16x32_bf16 v[190:193], a[216:219], a[76:79], v[190:193]
    ds_read_b64_tr_b16 a[210:211], v36 offset:18432
    buffer_load_dwordx4 v57, s[20:23], s0 offen offset:2048 lds
    v_mov_b32 v109, 0xc0135761
    v_mfma_f32_16x16x32_bf16 v[198:201], a[220:223], a[72:75], v[198:201]
    ds_read_b64_tr_b16 a[212:213], v38 offset:16384
    v_lshrrev_b32 v13, 1, v2
    v_mfma_f32_16x16x32_bf16 v[206:209], a[220:223], a[76:79], v[206:209]
    ds_read_b64_tr_b16 a[214:215], v38 offset:18432
    s_waitcnt lgkmcnt(8)
    v_mfma_f32_16x16x32_bf16 v[186:189], a[224:227], a[72:75], v[186:189]
    ds_read_b64_tr_b16 a[216:217], v35 offset:20480
    buffer_load_dwordx4 v58, s[20:23], s0 offen offset:3072 lds
    v_mfma_f32_16x16x32_bf16 v[194:197], a[224:227], a[76:79], v[194:197]
    ds_read_b64_tr_b16 a[218:219], v35 offset:22528
    s_add_u32 s1, s1, 8192
    v_lshlrev_b32 v14, 1, v3
    v_mfma_f32_16x16x32_bf16 v[202:205], a[228:231], a[72:75], v[202:205]
    ds_read_b64_tr_b16 a[220:221], v37 offset:20480
    s_and_b32 s1, s1, 0xffff
    v_mfma_f32_16x16x32_bf16 v[210:213], a[228:231], a[76:79], v[210:213]
    ds_read_b64_tr_b16 a[222:223], v37 offset:22528
    s_waitcnt vmcnt(14) lgkmcnt(8)
    v_mfma_f32_16x16x32_bf16 v[182:185], a[200:203], a[80:83], v[182:185]
    ds_read_b64_tr_b16 a[224:225], v36 offset:20480
    buffer_load_dwordx4 a[112:115], v78, s[28:31], s1 offen offset:0 sc1
    v_mfma_f32_16x16x32_bf16 v[190:193], a[200:203], a[84:87], v[190:193]
    ds_read_b64_tr_b16 a[226:227], v36 offset:22528
L_pad0:
    s_cbranch_execz L_warm
    v_sub_u32 v13, v13, v14
    v_mfma_f32_16x16x32_bf16 v[198:201], a[204:207], a[80:83], v[198:201]
    ds_read_b64_tr_b16 a[228:229], v38 offset:20480
    buffer_load_dwordx4 a[116:119], v78, s[28:31], s1 offen offset:256 sc1
    v_mfma_f32_16x16x32_bf16 v[206:209], a[204:207], a[84:87], v[206:209]
    ds_read_b64_tr_b16 a[230:231], v38 offset:22528
    v_mov_b32 v14, 0x3f80
    s_waitcnt lgkmcnt(8)
    v_mfma_f32_16x16x32_bf16 v[186:189], a[208:211], a[80:83], v[186:189]
    ds_read_b64_tr_b16 a[200:201], v35 offset:32768
    v_cndmask_b32 v14, v14, 1.0, s[70:71]
    v_mfma_f32_16x16x32_bf16 v[194:197], a[208:211], a[84:87], v[194:197]
    ds_read_b64_tr_b16 a[202:203], v35 offset:34816
    buffer_load_dwordx4 a[120:123], v78, s[28:31], s1 offen offset:2048 sc1
    v_cmp_eq_i32 vcc, 0, v13
    v_mfma_f32_16x16x32_bf16 v[202:205], a[212:215], a[80:83], v[202:205]
    ds_read_b64_tr_b16 a[204:205], v37 offset:32768
    v_accvgpr_write_b32 a248, 0
    v_mfma_f32_16x16x32_bf16 v[210:213], a[212:215], a[84:87], v[210:213]
    ds_read_b64_tr_b16 a[206:207], v37 offset:34816
    s_waitcnt vmcnt(15) lgkmcnt(8)
    v_mfma_f32_16x16x32_bf16 v[182:185], a[216:219], a[88:91], v[182:185]
    ds_read_b64_tr_b16 a[208:209], v36 offset:32768
    buffer_load_dwordx4 a[124:127], v78, s[28:31], s1 offen offset:2304 sc1
    v_mfma_f32_16x16x32_bf16 v[190:193], a[216:219], a[92:95], v[190:193]
    ds_read_b64_tr_b16 a[210:211], v36 offset:34816
    s_add_u32 m0, s58, 0
    v_accvgpr_write_b32 a252, 0
    v_mfma_f32_16x16x32_bf16 v[198:201], a[220:223], a[88:91], v[198:201]
    ds_read_b64_tr_b16 a[212:213], v38 offset:32768
    s_add_u32 s0, s0, 458752
    v_mfma_f32_16x16x32_bf16 v[206:209], a[220:223], a[92:95], v[206:209]
    ds_read_b64_tr_b16 a[214:215], v38 offset:34816
    s_waitcnt lgkmcnt(8)
    v_mfma_f32_16x16x32_bf16 v[186:189], a[224:227], a[88:91], v[186:189]
    ds_read_b64_tr_b16 a[216:217], v35 offset:36864
    s_cmp_eq_u32 s0, 3670016
    v_mfma_f32_16x16x32_bf16 v[194:197], a[224:227], a[92:95], v[194:197]
    ds_read_b64_tr_b16 a[218:219], v35 offset:38912
    s_cselect_b32 s0, 0, s0
    buffer_load_dwordx4 v55, s[20:23], s0 offen lds
    v_cndmask_b32 v15, 0, v14, vcc
    v_mfma_f32_16x16x32_bf16 v[202:205], a[228:231], a[88:91], v[202:205]
    ds_read_b64_tr_b16 a[220:221], v37 offset:36864
    v_accvgpr_write_b32 a250, v15
    v_mfma_f32_16x16x32_bf16 v[210:213], a[228:231], a[92:95], v[210:213]
    ds_read_b64_tr_b16 a[222:223], v37 offset:38912
    s_waitcnt vmcnt(11) lgkmcnt(8)
    v_mfma_f32_16x16x32_bf16 v[182:185], a[200:203], a[96:99], v[182:185]
    ds_read_b64_tr_b16 a[224:225], v36 offset:36864
    buffer_load_dwordx4 v56, s[20:23], s0 offen offset:1024 lds
    v_mfma_f32_16x16x32_bf16 v[190:193], a[200:203], a[100:103], v[190:193]
    ds_read_b64_tr_b16 a[226:227], v36 offset:38912
    v_cmp_eq_i32 vcc, 1, v13
    v_mfma_f32_16x16x32_bf16 v[198:201], a[204:207], a[96:99], v[198:201]
    ds_read_b64_tr_b16 a[228:229], v38 offset:36864
    buffer_load_dwordx4 v57, s[20:23], s0 offen offset:2048 lds
    v_mfma_f32_16x16x32_bf16 v[206:209], a[204:207], a[100:103], v[206:209]
    ds_read_b64_tr_b16 a[230:231], v38 offset:38912
    v_accvgpr_write_b32 a249, 0
    s_waitcnt lgkmcnt(8)
    v_mfma_f32_16x16x32_bf16 v[186:189], a[208:211], a[96:99], v[186:189]
    s_waitcnt vmcnt(7)
    s_barrier
    ds_read_b64_tr_b16 a[200:201], v35 offset:49152
    buffer_load_dwordx4 v58, s[20:23], s0 offen offset:3072 lds
    v_mfma_f32_16x16x32_bf16 v[194:197], a[208:211], a[100:103], v[194:197]
    ds_read_b64_tr_b16 a[202:203], v35 offset:51200
    s_add_u32 m0, s58, 16384
    v_accvgpr_write_b32 a253, 0
    v_mfma_f32_16x16x32_bf16 v[202:205], a[212:215], a[96:99], v[202:205]
    ds_read_b64_tr_b16 a[204:205], v37 offset:49152
    s_add_u32 s0, s0, 458752
    v_mfma_f32_16x16x32_bf16 v[210:213], a[212:215], a[100:103], v[210:213]
    ds_read_b64_tr_b16 a[206:207], v37 offset:51200
    s_waitcnt lgkmcnt(8)
    v_mfma_f32_16x16x32_bf16 v[182:185], a[216:219], a[104:107], v[182:185]
    ds_read_b64_tr_b16 a[208:209], v36 offset:49152
    s_cmp_eq_u32 s0, 3670016
    v_mfma_f32_16x16x32_bf16 v[190:193], a[216:219], a[108:111], v[190:193]
    ds_read_b64_tr_b16 a[210:211], v36 offset:51200
    s_cselect_b32 s0, 0, s0
    buffer_load_dwordx4 v55, s[20:23], s0 offen lds
    v_cndmask_b32 v15, 0, v14, vcc
    v_mfma_f32_16x16x32_bf16 v[198:201], a[220:223], a[104:107], v[198:201]
    ds_read_b64_tr_b16 a[212:213], v38 offset:49152
    v_accvgpr_write_b32 a251, v15
    v_mfma_f32_16x16x32_bf16 v[206:209], a[220:223], a[108:111], v[206:209]
    ds_read_b64_tr_b16 a[214:215], v38 offset:51200
    s_waitcnt lgkmcnt(8)
    v_mfma_f32_16x16x32_bf16 v[186:189], a[224:227], a[104:107], v[186:189]
    ds_read_b64_tr_b16 a[216:217], v35 offset:53248
    buffer_load_dwordx4 v56, s[20:23], s0 offen offset:1024 lds
    v_mfma_f32_16x16x32_bf16 v[194:197], a[224:227], a[108:111], v[194:197]
    ds_read_b64_tr_b16 a[218:219], v35 offset:55296
    v_mfma_f32_16x16x32_bf16 v[202:205], a[228:231], a[104:107], v[202:205]
    ds_read_b64_tr_b16 a[220:221], v37 offset:53248
    buffer_load_dwordx4 v57, s[20:23], s0 offen offset:2048 lds
    v_mfma_f32_16x16x32_bf16 v[210:213], a[228:231], a[108:111], v[210:213]
    ds_read_b64_tr_b16 a[222:223], v37 offset:55296
    s_waitcnt vmcnt(9) lgkmcnt(8)
    v_mfma_f32_16x16x32_bf16 v[182:185], a[200:203], a[112:115], v[182:185]
    ds_read_b64_tr_b16 a[224:225], v36 offset:53248
    v_mfma_f32_16x16x32_bf16 v[190:193], a[200:203], a[116:119], v[190:193]
    ds_read_b64_tr_b16 a[226:227], v36 offset:55296
    buffer_load_dwordx4 v58, s[20:23], s0 offen offset:3072 lds
    v_mfma_f32_16x16x32_bf16 v[198:201], a[204:207], a[112:115], v[198:201]
    ds_read_b64_tr_b16 a[228:229], v38 offset:53248
    s_add_u32 m0, s58, 32768
    v_mfma_f32_16x16x32_bf16 v[206:209], a[204:207], a[116:119], v[206:209]
    ds_read_b64_tr_b16 a[230:231], v38 offset:55296
    s_waitcnt lgkmcnt(8)
    v_mfma_f32_16x16x32_bf16 v[186:189], a[208:211], a[112:115], v[186:189]
    s_waitcnt lgkmcnt(0)
    s_cmp_ge_u32 s14, 14
    s_cbranch_scc0 L_pollin1
L_pollok1:
    ds_read_b64_tr_b16 a[200:201], v39 offset:0
    s_add_u32 s0, s0, 458752
    v_mfma_f32_16x16x32_bf16 v[194:197], a[208:211], a[116:119], v[194:197]
    ds_read_b64_tr_b16 a[202:203], v39 offset:2048
    s_cmp_eq_u32 s0, 3670016
    s_cselect_b32 s0, 0, s0
    buffer_load_dwordx4 v55, s[20:23], s0 offen lds
    v_mfma_f32_16x16x32_bf16 v[202:205], a[212:215], a[112:115], v[202:205]
    ds_read_b64_tr_b16 a[204:205], v41 offset:0
    v_mfma_f32_16x16x32_bf16 v[210:213], a[212:215], a[116:119], v[210:213]
    ds_read_b64_tr_b16 a[206:207], v41 offset:2048
    s_waitcnt vmcnt(9)
    v_mfma_f32_16x16x32_bf16 v[182:185], a[216:219], a[120:123], v[182:185]
    ds_read_b64_tr_b16 a[208:209], v40 offset:0
    buffer_load_dwordx4 v56, s[20:23], s0 offen offset:1024 lds
    v_mfma_f32_16x16x32_bf16 v[190:193], a[216:219], a[124:127], v[190:193]
    ds_read_b64_tr_b16 a[210:211], v40 offset:2048
    v_mfma_f32_16x16x32_bf16 v[198:201], a[220:223], a[120:123], v[198:201]
    ds_read_b64_tr_b16 a[212:213], v42 offset:0
    buffer_load_dwordx4 v57, s[20:23], s0 offen offset:2048 lds
    v_mfma_f32_16x16x32_bf16 v[206:209], a[220:223], a[124:127], v[206:209]
    ds_read_b64_tr_b16 a[214:215], v42 offset:2048
    v_mfma_f32_16x16x32_bf16 v[186:189], a[224:227], a[120:123], v[186:189]
    ds_read_b64_tr_b16 a[216:217], v39 offset:4096
    v_mfma_f32_16x16x32_bf16 v[194:197], a[224:227], a[124:127], v[194:197]
    ds_read_b64_tr_b16 a[218:219], v39 offset:6144
    v_mfma_f32_16x16x32_bf16 v[202:205], a[228:231], a[120:123], v[202:205]
    ds_read_b64_tr_b16 a[220:221], v41 offset:4096
    buffer_load_dwordx4 v58, s[20:23], s0 offen offset:3072 lds
    v_mfma_f32_16x16x32_bf16 v[210:213], a[228:231], a[124:127], v[210:213]
    ds_read_b64_tr_b16 a[222:223], v41 offset:6144
    s_waitcnt lgkmcnt(8)
    v_mfma_f32_16x16x32_bf16 v[150:153], a[200:203], a[0:3], v[150:153]
    ds_read_b64_tr_b16 a[224:225], v40 offset:4096
    s_add_u32 m0, s58, 49152
    v_mfma_f32_16x16x32_bf16 v[158:161], a[200:203], a[4:7], v[158:161]
    ds_read_b64_tr_b16 a[226:227], v40 offset:6144
    s_add_u32 s0, s0, 458752
    v_mfma_f32_16x16x32_bf16 v[166:169], a[204:207], a[0:3], 0
    ds_read_b64_tr_b16 a[228:229], v42 offset:4096
    s_cmp_eq_u32 s0, 3670016
    s_cselect_b32 s0, 0, s0
    buffer_load_dwordx4 v55, s[20:23], s0 offen lds
    v_mfma_f32_16x16x32_bf16 v[174:177], a[204:207], a[4:7], 0
    ds_read_b64_tr_b16 a[230:231], v42 offset:6144
    v_cvt_pk_bf16_f32 v182, v182, v183
    v_cvt_pk_bf16_f32 v183, v184, v185
    v_cvt_pk_bf16_f32 v184, v186, v187
    s_waitcnt lgkmcnt(8)
    v_mfma_f32_16x16x32_bf16 v[154:157], a[208:211], a[0:3], v[154:157]
    s_waitcnt vmcnt(5)
    s_barrier
    ds_read_b64_tr_b16 a[200:201], v39 offset:16384
    buffer_load_dwordx4 v56, s[20:23], s0 offen offset:1024 lds
    v_mfma_f32_16x16x32_bf16 v[162:165], a[208:211], a[4:7], v[162:165]
    ds_read_b64_tr_b16 a[202:203], v39 offset:18432
    v_cvt_pk_bf16_f32 v185, v188, v189
    buffer_store_dwordx4 v[182:185], v23, s[28:31], 0 offen offset:0 sc1
    v_cvt_pk_bf16_f32 v190, v190, v191
    v_cvt_pk_bf16_f32 v191, v192, v193
    v_cvt_pk_bf16_f32 v192, v194, v195
    v_mfma_f32_16x16x32_bf16 v[170:173], a[212:215], a[0:3], 0
    ds_read_b64_tr_b16 a[204:205], v41 offset:16384
    v_cvt_pk_bf16_f32 v193, v196, v197
    v_mfma_f32_16x16x32_bf16 v[178:181], a[212:215], a[4:7], 0
    ds_read_b64_tr_b16 a[206:207], v41 offset:18432
    buffer_store_dwordx4 v[190:193], v23, s[28:31], 0 offen offset:1024 sc1
    v_cvt_pk_bf16_f32 v198, v198, v199
    v_cvt_pk_bf16_f32 v199, v200, v201
    v_cvt_pk_bf16_f32 v200, v202, v203
    s_waitcnt lgkmcnt(8)
    v_mfma_f32_16x16x32_bf16 v[150:153], a[216:219], a[8:11], v[150:153]
    ds_read_b64_tr_b16 a[208:209], v40 offset:16384
    buffer_load_dwordx4 v57, s[20:23], s0 offen offset:2048 lds
    v_mfma_f32_16x16x32_bf16 v[158:161], a[216:219], a[12:15], v[158:161]
    ds_read_b64_tr_b16 a[210:211], v40 offset:18432
    v_cvt_pk_bf16_f32 v201, v204, v205
    buffer_store_dwordx4 v[198:201], v23, s[28:31], 0 offen offset:2048 sc1
    v_cvt_pk_bf16_f32 v206, v206, v207
    v_cvt_pk_bf16_f32 v207, v208, v209
    v_cvt_pk_bf16_f32 v208, v210, v211
    v_mfma_f32_16x16x32_bf16 v[166:169], a[220:223], a[8:11], v[166:169]
    ds_read_b64_tr_b16 a[212:213], v42 offset:16384
    v_cvt_pk_bf16_f32 v209, v212, v213
    v_mfma_f32_16x16x32_bf16 v[174:177], a[220:223], a[12:15], v[174:177]
    ds_read_b64_tr_b16 a[214:215], v42 offset:18432
    s_waitcnt lgkmcnt(8)
    v_mfma_f32_16x16x32_bf16 v[154:157], a[224:227], a[8:11], v[154:157]
    ds_read_b64_tr_b16 a[216:217], v39 offset:20480
    buffer_load_dwordx4 v58, s[20:23], s0 offen offset:3072 lds
    v_mfma_f32_16x16x32_bf16 v[162:165], a[224:227], a[12:15], v[162:165]
    ds_read_b64_tr_b16 a[218:219], v39 offset:22528
    s_add_u32 m0, s58, 65536
    buffer_store_dwordx4 v[206:209], v23, s[28:31], 0 offen offset:3072 sc1
    v_mfma_f32_16x16x32_bf16 v[170:173], a[228:231], a[8:11], v[170:173]
    ds_read_b64_tr_b16 a[220:221], v41 offset:20480
    s_add_u32 s0, s0, 458752
    v_mfma_f32_16x16x32_bf16 v[178:181], a[228:231], a[12:15], v[178:181]
    ds_read_b64_tr_b16 a[222:223], v41 offset:22528
    s_waitcnt lgkmcnt(8)
    v_mfma_f32_16x16x32_bf16 v[150:153], a[200:203], a[16:19], v[150:153]
    ds_read_b64_tr_b16 a[224:225], v40 offset:20480
    s_cmp_eq_u32 s0, 3670016
    v_mfma_f32_16x16x32_bf16 v[158:161], a[200:203], a[20:23], v[158:161]
    ds_read_b64_tr_b16 a[226:227], v40 offset:22528
    s_cselect_b32 s0, 0, s0
    buffer_load_dwordx4 v55, s[20:23], s0 offen lds
    v_mfma_f32_16x16x32_bf16 v[166:169], a[204:207], a[16:19], v[166:169]
    ds_read_b64_tr_b16 a[228:229], v42 offset:20480
    v_mfma_f32_16x16x32_bf16 v[174:177], a[204:207], a[20:23], v[174:177]
    ds_read_b64_tr_b16 a[230:231], v42 offset:22528
    s_waitcnt lgkmcnt(8)
    v_mfma_f32_16x16x32_bf16 v[154:157], a[208:211], a[16:19], v[154:157]
    ds_read_b64_tr_b16 a[200:201], v31 offset:0
    buffer_load_dwordx4 v56, s[20:23], s0 offen offset:1024 lds
    v_mfma_f32_16x16x32_bf16 v[162:165], a[208:211], a[20:23], v[162:165]
    ds_read_b64_tr_b16 a[202:203], v31 offset:2048
    v_mfma_f32_16x16x32_bf16 v[170:173], a[212:215], a[16:19], v[170:173]
    ds_read_b64_tr_b16 a[204:205], v33 offset:0
    buffer_load_dwordx4 v57, s[20:23], s0 offen offset:2048 lds
    v_mfma_f32_16x16x32_bf16 v[178:181], a[212:215], a[20:23], v[178:181]
    ds_read_b64_tr_b16 a[206:207], v33 offset:2048
    s_waitcnt lgkmcnt(8)
    v_mfma_f32_16x16x32_bf16 v[150:153], a[216:219], a[24:27], v[150:153]
    ds_read_b64_tr_b16 a[208:209], v32 offset:0
    v_mfma_f32_16x16x32_bf16 v[158:161], a[216:219], a[28:31], v[158:161]
    ds_read_b64_tr_b16 a[210:211], v32 offset:2048
    buffer_load_dwordx4 v58, s[20:23], s0 offen offset:3072 lds
    v_mfma_f32_16x16x32_bf16 v[166:169], a[220:223], a[24:27], v[166:169]
    ds_read_b64_tr_b16 a[212:213], v34 offset:0
    s_add_u32 m0, s58, 81920
    v_mfma_f32_16x16x32_bf16 v[174:177], a[220:223], a[28:31], v[174:177]
    ds_read_b64_tr_b16 a[214:215], v34 offset:2048
    s_waitcnt lgkmcnt(8)
    v_mfma_f32_16x16x32_bf16 v[154:157], a[224:227], a[24:27], v[154:157]
    ds_read_b64_tr_b16 a[216:217], v31 offset:4096
    s_add_u32 s0, s0, 458752
    v_mfma_f32_16x16x32_bf16 v[162:165], a[224:227], a[28:31], v[162:165]
    ds_read_b64_tr_b16 a[218:219], v31 offset:6144
    s_cmp_eq_u32 s0, 3670016
    v_mfma_f32_16x16x32_bf16 v[170:173], a[228:231], a[24:27], v[170:173]
    ds_read_b64_tr_b16 a[220:221], v33 offset:4096
    s_cselect_b32 s0, 0, s0
    buffer_load_dwordx4 v55, s[20:23], s0 offen lds
    v_mfma_f32_16x16x32_bf16 v[178:181], a[228:231], a[28:31], v[178:181]
    ds_read_b64_tr_b16 a[222:223], v33 offset:6144
    s_waitcnt lgkmcnt(8)
    v_mfma_f32_16x16x32_bf16 v[150:153], a[200:203], a[32:35], v[150:153]
    ds_read_b64_tr_b16 a[224:225], v32 offset:4096
    buffer_load_dwordx4 v56, s[20:23], s0 offen offset:1024 lds
    v_mfma_f32_16x16x32_bf16 v[158:161], a[200:203], a[36:39], v[158:161]
    ds_read_b64_tr_b16 a[226:227], v32 offset:6144
    v_mfma_f32_16x16x32_bf16 v[166:169], a[204:207], a[32:35], v[166:169]
    ds_read_b64_tr_b16 a[228:229], v34 offset:4096
    v_mfma_f32_16x16x32_bf16 v[174:177], a[204:207], a[36:39], v[174:177]
    ds_read_b64_tr_b16 a[230:231], v34 offset:6144
    s_waitcnt lgkmcnt(8)
    v_mfma_f32_16x16x32_bf16 v[154:157], a[208:211], a[32:35], v[154:157]
    s_waitcnt vmcnt(7)
    s_barrier
    s_waitcnt vmcnt(6)
    s_atomic_add s36, s[28:29], s37
    ds_read_b64_tr_b16 a[200:201], v31 offset:16384
    buffer_load_dwordx4 v57, s[20:23], s0 offen offset:2048 lds
    v_mfma_f32_16x16x32_bf16 v[162:165], a[208:211], a[36:39], v[162:165]
    ds_read_b64_tr_b16 a[202:203], v31 offset:18432
    v_mfma_f32_16x16x32_bf16 v[170:173], a[212:215], a[32:35], v[170:173]
    ds_read_b64_tr_b16 a[204:205], v33 offset:16384
    buffer_load_dwordx4 v58, s[20:23], s0 offen offset:3072 lds
    v_mfma_f32_16x16x32_bf16 v[178:181], a[212:215], a[36:39], v[178:181]
    ds_read_b64_tr_b16 a[206:207], v33 offset:18432
    s_waitcnt lgkmcnt(8)
    v_mfma_f32_16x16x32_bf16 v[150:153], a[216:219], a[40:43], v[150:153]
    ds_read_b64_tr_b16 a[208:209], v32 offset:16384
    s_add_u32 m0, s59, 98304
    v_mfma_f32_16x16x32_bf16 v[158:161], a[216:219], a[44:47], v[158:161]
    ds_read_b64_tr_b16 a[210:211], v32 offset:18432
    buffer_load_dwordx4 v80, s[28:31], s63 offen sc1 lds
    v_mfma_f32_16x16x32_bf16 v[166:169], a[220:223], a[40:43], v[166:169]
    ds_read_b64_tr_b16 a[212:213], v34 offset:16384
    v_mfma_f32_16x16x32_bf16 v[174:177], a[220:223], a[44:47], v[174:177]
    ds_read_b64_tr_b16 a[214:215], v34 offset:18432
    s_waitcnt lgkmcnt(8)
    v_mfma_f32_16x16x32_bf16 v[154:157], a[224:227], a[40:43], v[154:157]
    ds_read_b64_tr_b16 a[216:217], v31 offset:20480
    v_mfma_f32_16x16x32_bf16 v[162:165], a[224:227], a[44:47], v[162:165]
    ds_read_b64_tr_b16 a[218:219], v31 offset:22528
    buffer_load_dwordx4 v80, s[28:31], s63 offen offset:1024 sc1 lds
    v_mfma_f32_16x16x32_bf16 v[170:173], a[228:231], a[40:43], v[170:173]
    ds_read_b64_tr_b16 a[220:221], v33 offset:20480
    v_mfma_f32_16x16x32_bf16 v[178:181], a[228:231], a[44:47], v[178:181]
    ds_read_b64_tr_b16 a[222:223], v33 offset:22528
    s_waitcnt lgkmcnt(8)
    v_mfma_f32_16x16x32_bf16 v[150:153], a[200:203], a[48:51], v[150:153]
    ds_read_b64_tr_b16 a[224:225], v32 offset:20480
    buffer_load_dwordx4 v80, s[28:31], s63 offen offset:2048 sc1 lds
    v_mfma_f32_16x16x32_bf16 v[158:161], a[200:203], a[52:55], v[158:161]
    ds_read_b64_tr_b16 a[226:227], v32 offset:22528
    s_add_u32 m0, s100, 126976
    v_mfma_f32_16x16x32_bf16 v[166:169], a[204:207], a[48:51], v[166:169]
    ds_read_b64_tr_b16 a[228:229], v34 offset:20480
    v_mfma_f32_16x16x32_bf16 v[174:177], a[204:207], a[52:55], v[174:177]
    ds_read_b64_tr_b16 a[230:231], v34 offset:22528
    s_waitcnt lgkmcnt(8)
    v_mfma_f32_16x16x32_bf16 v[154:157], a[208:211], a[48:51], v[154:157]
    ds_read_b64_tr_b16 a[200:201], v31 offset:32768
    buffer_load_dwordx4 v69, s[28:31], s62 offen sc1 lds
    v_mfma_f32_16x16x32_bf16 v[162:165], a[208:211], a[52:55], v[162:165]
    ds_read_b64_tr_b16 a[202:203], v31 offset:34816
    s_add_u32 m0, s58, 110592
    v_mfma_f32_16x16x32_bf16 v[170:173], a[212:215], a[48:51], v[170:173]
    ds_read_b64_tr_b16 a[204:205], v33 offset:32768
    v_mfma_f32_16x16x32_bf16 v[178:181], a[212:215], a[52:55], v[178:181]
    ds_read_b64_tr_b16 a[206:207], v33 offset:34816
    s_waitcnt lgkmcnt(8)
    v_mfma_f32_16x16x32_bf16 v[150:153], a[216:219], a[56:59], v[150:153]
    ds_read_b64_tr_b16 a[208:209], v32 offset:32768
    buffer_load_dwordx4 v67, s[28:31], s62 offen sc1 lds
    v_mfma_f32_16x16x32_bf16 v[158:161], a[216:219], a[60:63], v[158:161]
    ds_read_b64_tr_b16 a[210:211], v32 offset:34816
    v_mfma_f32_16x16x32_bf16 v[166:169], a[220:223], a[56:59], v[166:169]
    ds_read_b64_tr_b16 a[212:213], v34 offset:32768
    v_mfma_f32_16x16x32_bf16 v[174:177], a[220:223], a[60:63], v[174:177]
    ds_read_b64_tr_b16 a[214:215], v34 offset:34816
    s_waitcnt lgkmcnt(8)
    v_mfma_f32_16x16x32_bf16 v[154:157], a[224:227], a[56:59], v[154:157]
    ds_read_b64_tr_b16 a[216:217], v31 offset:36864
    buffer_load_dwordx4 v67, s[28:31], s62 offen offset:1024 sc1 lds
    v_mfma_f32_16x16x32_bf16 v[162:165], a[224:227], a[60:63], v[162:165]
    ds_read_b64_tr_b16 a[218:219], v31 offset:38912
    v_mfma_f32_16x16x32_bf16 v[170:173], a[228:231], a[56:59], v[170:173]
    ds_read_b64_tr_b16 a[220:221], v33 offset:36864
    buffer_load_dwordx4 v68, s[28:31], s62 offen offset:2048 sc1 lds
    v_mfma_f32_16x16x32_bf16 v[178:181], a[228:231], a[60:63], v[178:181]
    ds_read_b64_tr_b16 a[222:223], v33 offset:38912
    s_waitcnt lgkmcnt(8)
    v_mfma_f32_16x16x32_bf16 v[150:153], a[200:203], a[64:67], v[150:153]
    ds_read_b64_tr_b16 a[224:225], v32 offset:36864
    v_mfma_f32_16x16x32_bf16 v[158:161], a[200:203], a[68:71], v[158:161]
    ds_read_b64_tr_b16 a[226:227], v32 offset:38912
    v_mfma_f32_16x16x32_bf16 v[166:169], a[204:207], a[64:67], v[166:169]
    ds_read_b64_tr_b16 a[228:229], v34 offset:36864
    buffer_load_dwordx4 v68, s[28:31], s62 offen offset:3072 sc1 lds
    v_mfma_f32_16x16x32_bf16 v[174:177], a[204:207], a[68:71], v[174:177]
    ds_read_b64_tr_b16 a[230:231], v34 offset:38912
    s_waitcnt lgkmcnt(8)
    v_mfma_f32_16x16x32_bf16 v[154:157], a[208:211], a[64:67], v[154:157]
    s_waitcnt vmcnt(8)
    s_barrier
    s_xor_b32 s37, s37, 1024
    s_load_dword s14, s[28:29], s37
    ds_read_b64_tr_b16 a[200:201], v31 offset:49152
    s_add_u32 m0, s59, 131072
    v_mfma_f32_16x16x32_bf16 v[162:165], a[208:211], a[68:71], v[162:165]
    ds_read_b64_tr_b16 a[202:203], v31 offset:51200
    s_add_u32 s63, s63, 12288
    v_mfma_f32_16x16x32_bf16 v[170:173], a[212:215], a[64:67], v[170:173]
    ds_read_b64_tr_b16 a[204:205], v33 offset:49152
    s_cmp_eq_u32 s63, 86016
    s_cselect_b32 s63, 0, s63
    buffer_load_dwordx4 v80, s[28:31], s63 offen sc1 lds
    v_mfma_f32_16x16x32_bf16 v[178:181], a[212:215], a[68:71], v[178:181]
    ds_read_b64_tr_b16 a[206:207], v33 offset:51200
    s_waitcnt lgkmcnt(8)
    v_mfma_f32_16x16x32_bf16 v[150:153], a[216:219], a[72:75], v[150:153]
    ds_read_b64_tr_b16 a[208:209], v32 offset:49152
    buffer_load_dwordx4 v80, s[28:31], s63 offen offset:1024 sc1 lds
    v_mfma_f32_16x16x32_bf16 v[158:161], a[216:219], a[76:79], v[158:161]
    ds_read_b64_tr_b16 a[210:211], v32 offset:51200
    v_mfma_f32_16x16x32_bf16 v[166:169], a[220:223], a[72:75], v[166:169]
    ds_read_b64_tr_b16 a[212:213], v34 offset:49152
    v_mfma_f32_16x16x32_bf16 v[174:177], a[220:223], a[76:79], v[174:177]
    ds_read_b64_tr_b16 a[214:215], v34 offset:51200
    s_waitcnt lgkmcnt(8)
    v_mfma_f32_16x16x32_bf16 v[154:157], a[224:227], a[72:75], v[154:157]
    ds_read_b64_tr_b16 a[216:217], v31 offset:53248
    buffer_load_dwordx4 v80, s[28:31], s63 offen offset:2048 sc1 lds
    v_mfma_f32_16x16x32_bf16 v[162:165], a[224:227], a[76:79], v[162:165]
    ds_read_b64_tr_b16 a[218:219], v31 offset:55296
    s_add_u32 m0, s100, 159744
    v_mfma_f32_16x16x32_bf16 v[170:173], a[228:231], a[72:75], v[170:173]
    ds_read_b64_tr_b16 a[220:221], v33 offset:53248
    s_add_u32 s62, s62, 262144
    v_mfma_f32_16x16x32_bf16 v[178:181], a[228:231], a[76:79], v[178:181]
    ds_read_b64_tr_b16 a[222:223], v33 offset:55296
    s_waitcnt lgkmcnt(8)
    v_mfma_f32_16x16x32_bf16 v[150:153], a[200:203], a[80:83], v[150:153]
    ds_read_b64_tr_b16 a[224:225], v32 offset:53248
    s_cmp_eq_u32 s62, 1835008
    v_mfma_f32_16x16x32_bf16 v[158:161], a[200:203], a[84:87], v[158:161]
    ds_read_b64_tr_b16 a[226:227], v32 offset:55296
    s_cselect_b32 s62, 0, s62
    buffer_load_dwordx4 v69, s[28:31], s62 offen sc1 lds
    v_mfma_f32_16x16x32_bf16 v[166:169], a[204:207], a[80:83], v[166:169]
    ds_read_b64_tr_b16 a[228:229], v34 offset:53248
    s_add_u32 m0, s58, 143360
    v_mfma_f32_16x16x32_bf16 v[174:177], a[204:207], a[84:87], v[174:177]
    ds_read_b64_tr_b16 a[230:231], v34 offset:55296
    s_waitcnt lgkmcnt(8)
    v_mfma_f32_16x16x32_bf16 v[154:157], a[208:211], a[80:83], v[154:157]
    s_barrier
    ds_read_b64_tr_b16 a[200:201], v37 offset:0
    buffer_load_dwordx4 v67, s[28:31], s62 offen sc1 lds
    v_mfma_f32_16x16x32_bf16 v[162:165], a[208:211], a[84:87], v[162:165]
    ds_read_b64_tr_b16 a[202:203], v37 offset:2048
    v_mfma_f32_16x16x32_bf16 v[170:173], a[212:215], a[80:83], v[170:173]
    ds_read_b64_tr_b16 a[204:205], v38 offset:0
    buffer_load_dwordx4 v67, s[28:31], s62 offen offset:1024 sc1 lds
    v_mfma_f32_16x16x32_bf16 v[178:181], a[212:215], a[84:87], v[178:181]
    ds_read_b64_tr_b16 a[206:207], v38 offset:2048
    s_waitcnt lgkmcnt(8)
    v_mfma_f32_16x16x32_bf16 v[150:153], a[216:219], a[88:91], v[150:153]
    ds_read_b64_tr_b16 a[208:209], v37 offset:4096
    v_mfma_f32_16x16x32_bf16 v[158:161], a[216:219], a[92:95], v[158:161]
    ds_read_b64_tr_b16 a[210:211], v37 offset:6144
    v_mfma_f32_16x16x32_bf16 v[166:169], a[220:223], a[88:91], v[166:169]
    ds_read_b64_tr_b16 a[212:213], v38 offset:4096
    buffer_load_dwordx4 v68, s[28:31], s62 offen offset:2048 sc1 lds
    v_mfma_f32_16x16x32_bf16 v[174:177], a[220:223], a[92:95], v[174:177]
    ds_read_b64_tr_b16 a[214:215], v38 offset:6144
    s_waitcnt lgkmcnt(8)
    v_mfma_f32_16x16x32_bf16 v[154:157], a[224:227], a[88:91], v[154:157]
    ds_read_b64_tr_b16 a[216:217], v37 offset:16384
    v_mfma_f32_16x16x32_bf16 v[162:165], a[224:227], a[92:95], v[162:165]
    ds_read_b64_tr_b16 a[218:219], v37 offset:18432
    buffer_load_dwordx4 v68, s[28:31], s62 offen offset:3072 sc1 lds
    v_mfma_f32_16x16x32_bf16 v[170:173], a[228:231], a[88:91], v[170:173]
    ds_read_b64_tr_b16 a[220:221], v38 offset:16384
    s_add_u32 m0, s59, 0
    v_mfma_f32_16x16x32_bf16 v[178:181], a[228:231], a[92:95], v[178:181]
    ds_read_b64_tr_b16 a[222:223], v38 offset:18432
    s_waitcnt lgkmcnt(8)
    v_mfma_f32_16x16x32_bf16 v[166:169], a[200:203], a[96:99], v[166:169]
    s_waitcnt lgkmcnt(0)
    s_cmp_ge_u32 s14, 2
    s_cbranch_scc0 L_pollin2
L_pollok2:
    v_xor_b32 v23, 131072, v23
    v_xor_b32 v22, 8192, v23
    ds_read_b64_tr_b16 a[224:225], v37 offset:20480
    buffer_load_dwordx4 v[214:217], v23, s[28:31], 0 offen offset:0 sc1
    v_mfma_f32_16x16x32_bf16 v[174:177], a[200:203], a[100:103], v[174:177]
    ds_read_b64_tr_b16 a[226:227], v37 offset:22528
    v_mfma_f32_16x16x32_bf16 v[170:173], a[204:207], a[96:99], v[170:173]
    ds_read_b64_tr_b16 a[228:229], v38 offset:20480
    buffer_load_dwordx4 v[218:221], v23, s[28:31], 0 offen offset:1024 sc1
    v_mfma_f32_16x16x32_bf16 v[178:181], a[204:207], a[100:103], v[178:181]
    ds_read_b64_tr_b16 a[230:231], v38 offset:22528
    v_mfma_f32_16x16x32_bf16 v[166:169], a[208:211], a[104:107], v[166:169]
    ds_read_b64_tr_b16 a[200:201], v35 offset:0
    buffer_load_dwordx4 v[222:225], v22, s[28:31], 0 offen offset:2048 sc1
    v_mfma_f32_16x16x32_bf16 v[174:177], a[208:211], a[108:111], v[174:177]
    ds_read_b64_tr_b16 a[202:203], v35 offset:2048
    v_mfma_f32_16x16x32_bf16 v[170:173], a[212:215], a[104:107], v[170:173]
    ds_read_b64_tr_b16 a[204:205], v36 offset:0
    buffer_load_dwordx4 v[226:229], v22, s[28:31], 0 offen offset:3072 sc1
    v_mfma_f32_16x16x32_bf16 v[178:181], a[212:215], a[108:111], v[178:181]
    ds_read_b64_tr_b16 a[206:207], v36 offset:2048
    v_mfma_f32_16x16x32_bf16 v[166:169], a[216:219], a[112:115], v[166:169]
    ds_read_b64_tr_b16 a[208:209], v35 offset:4096
    s_add_u32 s63, s63, 12288
    v_mfma_f32_16x16x32_bf16 v[174:177], a[216:219], a[116:119], v[174:177]
    ds_read_b64_tr_b16 a[210:211], v35 offset:6144
    s_cmp_eq_u32 s63, 86016
    s_cselect_b32 s63, 0, s63
    buffer_load_dwordx4 v80, s[28:31], s63 offen sc1 lds
    v_mfma_f32_16x16x32_bf16 v[170:173], a[220:223], a[112:115], v[170:173]
    ds_read_b64_tr_b16 a[212:213], v36 offset:4096
    v_mfma_f32_16x16x32_bf16 v[178:181], a[220:223], a[116:119], v[178:181]
    ds_read_b64_tr_b16 a[214:215], v36 offset:6144
    s_waitcnt lgkmcnt(8)
    v_mfma_f32_16x16x32_bf16 v[166:169], a[224:227], a[120:123], v[166:169]
    ds_read_b64_tr_b16 a[216:217], v35 offset:16384
    buffer_load_dwordx4 v80, s[28:31], s63 offen offset:1024 sc1 lds
    v_mfma_f32_16x16x32_bf16 v[174:177], a[224:227], a[124:127], v[174:177]
    ds_read_b64_tr_b16 a[218:219], v35 offset:18432
    v_mfma_f32_16x16x32_bf16 v[170:173], a[228:231], a[120:123], v[170:173]
    ds_read_b64_tr_b16 a[220:221], v36 offset:16384
    v_mfma_f32_16x16x32_bf16 v[178:181], a[228:231], a[124:127], v[178:181]
    ds_read_b64_tr_b16 a[222:223], v36 offset:18432
    s_waitcnt lgkmcnt(8)
    v_mfma_f32_16x16x32_bf16 v[150:153], a[200:203], a[96:99], v[150:153]
    ds_read_b64_tr_b16 a[224:225], v35 offset:20480
    buffer_load_dwordx4 v80, s[28:31], s63 offen offset:2048 sc1 lds
    v_mfma_f32_16x16x32_bf16 v[158:161], a[200:203], a[100:103], v[158:161]
    ds_read_b64_tr_b16 a[226:227], v35 offset:22528
    s_add_u32 m0, s100, 28672
    v_mfma_f32_16x16x32_bf16 v[154:157], a[204:207], a[96:99], v[154:157]
    ds_read_b64_tr_b16 a[228:229], v36 offset:20480
    s_add_u32 s62, s62, 262144
    v_mfma_f32_16x16x32_bf16 v[162:165], a[204:207], a[100:103], v[162:165]
    ds_read_b64_tr_b16 a[230:231], v36 offset:22528
    ds_write_b128 v81, v[166:169] offset:32768
    s_waitcnt lgkmcnt(9)
    v_mfma_f32_16x16x32_bf16 v[150:153], a[208:211], a[104:107], v[150:153]
    s_cmp_eq_u32 s62, 1835008
    s_cselect_b32 s62, 0, s62
    buffer_load_dwordx4 v69, s[28:31], s62 offen sc1 lds
    v_mfma_f32_16x16x32_bf16 v[158:161], a[208:211], a[108:111], v[158:161]
    s_add_u32 m0, s58, 12288
    ds_write_b128 v81, v[170:173] offset:33792
    v_mfma_f32_16x16x32_bf16 v[154:157], a[212:215], a[104:107], v[154:157]
    buffer_load_dwordx4 v67, s[28:31], s62 offen sc1 lds
    ds_write_b128 v81, v[174:177] offset:34816
    v_mfma_f32_16x16x32_bf16 v[162:165], a[212:215], a[108:111], v[162:165]
    s_waitcnt lgkmcnt(7)
    v_mfma_f32_16x16x32_bf16 v[150:153], a[216:219], a[112:115], v[150:153]
    ds_write_b128 v81, v[178:181] offset:35840
    v_mfma_f32_16x16x32_bf16 v[158:161], a[216:219], a[116:119], v[158:161]
    v_mfma_f32_16x16x32_bf16 v[154:157], a[220:223], a[112:115], v[154:157]
    buffer_load_dwordx4 v67, s[28:31], s62 offen offset:1024 sc1 lds
    v_mfma_f32_16x16x32_bf16 v[162:165], a[220:223], a[116:119], v[162:165]
    s_waitcnt lgkmcnt(4)
    v_mfma_f32_16x16x32_bf16 v[150:153], a[224:227], a[120:123], v[150:153]
    v_mfma_f32_16x16x32_bf16 v[158:161], a[224:227], a[124:127], v[158:161]
    buffer_load_dwordx4 v68, s[28:31], s62 offen offset:2048 sc1 lds
    v_mfma_f32_16x16x32_bf16 v[154:157], a[228:231], a[120:123], v[154:157]
    v_mfma_f32_16x16x32_bf16 v[162:165], a[228:231], a[124:127], v[162:165]
    s_waitcnt vmcnt(10)
    v_mfma_f32_16x16x32_bf16 v[150:153], a[250:253], v[214:217], v[150:153]
    v_xor_b32 v81, 8192, v81
    s_waitcnt lgkmcnt(0)
    s_barrier
    ds_read_b128 v[182:185], v81 offset:32768
    ds_read_b128 v[186:189], v81 offset:33792
    ds_read_b128 v[190:193], v81 offset:34816
    ds_read_b128 v[194:197], v81 offset:35840
    v_mfma_f32_16x16x32_bf16 v[154:157], a[248:251], v[214:217], v[154:157]
    buffer_load_dwordx4 v68, s[28:31], s62 offen offset:3072 sc1 lds
    s_add_u32 m0, s59, 65536
    s_waitcnt vmcnt(10)
    v_mfma_f32_16x16x32_bf16 v[158:161], a[250:253], v[218:221], v[158:161]
    s_add_u32 s63, s63, 12288
    s_cmp_eq_u32 s63, 86016
    v_mfma_f32_16x16x32_bf16 v[162:165], a[248:251], v[218:221], v[162:165]
L_pad1:
    s_cbranch_execz L_warm
    s_cselect_b32 s63, 0, s63
    s_waitcnt vmcnt(9)
    v_mfma_f32_16x16x32_bf16 v[150:153], a[250:253], v[222:225], v[150:153]
    buffer_load_dwordx4 v80, s[28:31], s63 offen sc1 lds
    v_mfma_f32_16x16x32_bf16 v[154:157], a[248:251], v[222:225], v[154:157]
    s_waitcnt vmcnt(9)
    v_mfma_f32_16x16x32_bf16 v[158:161], a[250:253], v[226:229], v[158:161]
    v_mfma_f32_16x16x32_bf16 v[162:165], a[248:251], v[226:229], v[162:165]
    buffer_load_dwordx4 v80, s[28:31], s63 offen offset:1024 sc1 lds
    s_waitcnt lgkmcnt(3)
    s_nop 0
    v_pk_add_f32 v[150:151], v[150:151], v[182:183]
    v_pk_add_f32 v[152:153], v[152:153], v[184:185]
    s_waitcnt lgkmcnt(2)
    v_pk_add_f32 v[154:155], v[154:155], v[186:187]
    v_pk_add_f32 v[156:157], v[156:157], v[188:189]
    v_pk_mul_f32 v[182:183], v[150:151], v[150:151]
    v_pk_mul_f32 v[184:185], v[152:153], v[152:153]
    v_pk_mul_f32 v[186:187], v[154:155], v[154:155]
    v_pk_mul_f32 v[188:189], v[156:157], v[156:157]
    v_pk_fma_f32 v[182:183], v[182:183], s[78:79], v[108:109]
    v_pk_fma_f32 v[184:185], v[184:185], s[78:79], v[108:109]
    v_pk_fma_f32 v[186:187], v[186:187], s[78:79], v[108:109]
    v_pk_fma_f32 v[188:189], v[188:189], s[78:79], v[108:109]
    v_pk_mul_f32 v[182:183], v[182:183], v[150:151]
    buffer_load_dwordx4 v80, s[28:31], s63 offen offset:2048 sc1 lds
    v_pk_mul_f32 v[184:185], v[184:185], v[152:153]
    v_pk_mul_f32 v[186:187], v[186:187], v[154:155]
    v_pk_mul_f32 v[188:189], v[188:189], v[156:157]
    v_exp_f32 v182, v182
    v_exp_f32 v183, v183
    v_exp_f32 v184, v184
    v_exp_f32 v185, v185
    v_exp_f32 v186, v186
    v_exp_f32 v187, v187
    s_add_u32 m0, s100, 94208
    s_add_u32 s62, s62, 262144
    s_cmp_eq_u32 s62, 1835008
    s_cselect_b32 s62, 0, s62
    buffer_load_dwordx4 v69, s[28:31], s62 offen sc1 lds
    v_exp_f32 v188, v188
    v_exp_f32 v189, v189
    v_pk_add_f32 v[182:183], v[182:183], s[80:81]
    v_pk_add_f32 v[184:185], v[184:185], s[80:81]
    v_pk_add_f32 v[186:187], v[186:187], s[80:81]
    v_pk_add_f32 v[188:189], v[188:189], s[80:81]
    v_rcp_f32 v182, v182
    v_rcp_f32 v183, v183
    v_rcp_f32 v184, v184
    s_add_u32 m0, s58, 77824
    s_nop 0
    buffer_load_dwordx4 v67, s[28:31], s62 offen sc1 lds
    v_rcp_f32 v185, v185
    v_rcp_f32 v186, v186
    v_rcp_f32 v187, v187
    v_rcp_f32 v188, v188
    v_rcp_f32 v189, v189
    v_pk_mul_f32 v[182:183], v[182:183], v[150:151]
    v_pk_mul_f32 v[184:185], v[184:185], v[152:153]
    v_pk_mul_f32 v[186:187], v[186:187], v[154:155]
    buffer_load_dwordx4 v67, s[28:31], s62 offen offset:1024 sc1 lds
    v_pk_mul_f32 v[188:189], v[188:189], v[156:157]
    v_cvt_pk_bf16_f32 v110, v182, v183
    v_cvt_pk_bf16_f32 v111, v184, v185
    v_cvt_pk_bf16_f32 v112, v186, v187
    v_cvt_pk_bf16_f32 v113, v188, v189
    s_waitcnt lgkmcnt(1)
    v_pk_add_f32 v[158:159], v[158:159], v[190:191]
    v_pk_add_f32 v[160:161], v[160:161], v[192:193]
    s_waitcnt lgkmcnt(0)
    v_pk_add_f32 v[162:163], v[162:163], v[194:195]
    v_pk_add_f32 v[164:165], v[164:165], v[196:197]
    v_pk_mul_f32 v[190:191], v[158:159], v[158:159]
    v_pk_mul_f32 v[192:193], v[160:161], v[160:161]
    v_pk_mul_f32 v[194:195], v[162:163], v[162:163]
    v_pk_mul_f32 v[196:197], v[164:165], v[164:165]
    v_pk_fma_f32 v[190:191], v[190:191], s[78:79], v[108:109]
    buffer_load_dwordx4 v68, s[28:31], s62 offen offset:2048 sc1 lds
    v_pk_fma_f32 v[192:193], v[192:193], s[78:79], v[108:109]
    v_pk_fma_f32 v[194:195], v[194:195], s[78:79], v[108:109]
    v_pk_fma_f32 v[196:197], v[196:197], s[78:79], v[108:109]
    v_pk_mul_f32 v[190:191], v[190:191], v[158:159]
    v_pk_mul_f32 v[192:193], v[192:193], v[160:161]
    v_pk_mul_f32 v[194:195], v[194:195], v[162:163]
    v_pk_mul_f32 v[196:197], v[196:197], v[164:165]
    v_exp_f32 v190, v190
    v_exp_f32 v191, v191
    v_exp_f32 v192, v192
    v_exp_f32 v193, v193
    buffer_load_dwordx4 v68, s[28:31], s62 offen offset:3072 sc1 lds
    v_exp_f32 v194, v194
    v_exp_f32 v195, v195
    v_exp_f32 v196, v196
    v_exp_f32 v197, v197
    v_pk_add_f32 v[190:191], v[190:191], s[80:81]
    v_pk_add_f32 v[192:193], v[192:193], s[80:81]
    v_pk_add_f32 v[194:195], v[194:195], s[80:81]
    v_pk_add_f32 v[196:197], v[196:197], s[80:81]
    v_rcp_f32 v190, v190
    v_rcp_f32 v191, v191
    v_rcp_f32 v192, v192
    v_rcp_f32 v193, v193
    v_rcp_f32 v194, v194
    v_rcp_f32 v195, v195
    v_rcp_f32 v196, v196
    v_rcp_f32 v197, v197
    v_pk_mul_f32 v[190:191], v[190:191], v[158:159]
    v_pk_mul_f32 v[192:193], v[192:193], v[160:161]
    v_pk_mul_f32 v[194:195], v[194:195], v[162:163]
    v_pk_mul_f32 v[196:197], v[196:197], v[164:165]
    v_cvt_pk_bf16_f32 v114, v190, v191
    v_cvt_pk_bf16_f32 v115, v192, v193
    v_cvt_pk_bf16_f32 v116, v194, v195
    v_cvt_pk_bf16_f32 v117, v196, v197
    ds_read_b64_tr_b16 a[180:181], v72 offset:32768
    ds_read_b64_tr_b16 a[182:183], v72 offset:33024
    ds_read_b128 a[128:131], v53 offset:32768
    ds_read_b64_tr_b16 a[184:185], v72 offset:33792
    ds_read_b64_tr_b16 a[186:187], v72 offset:34048
    ds_read_b128 a[132:135], v53 offset:33792
    ds_read_b128 a[136:139], v53 offset:34816
    ds_read_b64_tr_b16 a[176:177], v73 offset:32768
    ds_read_b64_tr_b16 a[178:179], v73 offset:33024
    ds_read_b128 a[140:143], v53 offset:35840
    ds_read_b128 a[144:147], v53 offset:36864
    ds_read_b128 a[148:151], v53 offset:37888
    buffer_store_dwordx4 v[110:113], v4, s[28:31], s67 offen offset:0 sc1
    buffer_store_dwordx4 v[114:117], v4, s[28:31], s67 offen offset:1024 sc1
L_q:
    s_waitcnt lgkmcnt(6)
    v_mfma_f32_16x16x32_bf16 v[182:185], a[128:131], a[180:183], 0
    ds_read_b64_tr_b16 a[192:193], v72 offset:34816
    v_mfma_f32_16x16x32_bf16 v[190:193], a[128:131], a[184:187], 0
    ds_read_b64_tr_b16 a[194:195], v72 offset:35072
    v_mfma_f32_16x16x32_bf16 v[186:189], a[132:135], a[180:183], 0
    ds_read_b128 a[152:155], v53 offset:38912
    v_mfma_f32_16x16x32_bf16 v[194:197], a[132:135], a[184:187], 0
    ds_read_b64_tr_b16 a[196:197], v72 offset:35840
    s_waitcnt lgkmcnt(4)
    v_mfma_f32_16x16x32_bf16 v[206:209], a[136:139], a[180:183], 0
    ds_read_b64_tr_b16 a[198:199], v72 offset:36096
    v_mfma_f32_16x16x32_bf16 v[214:217], a[136:139], a[184:187], 0
    ds_read_b128 a[156:159], v53 offset:39936
    v_mfma_f32_16x16x32_bf16 v[198:201], a[136:139], a[176:179], 0
    ds_read_b128 a[160:163], v53 offset:40960
    v_mfma_f32_16x16x32_bf16 v[210:213], a[140:143], a[180:183], 0
    ds_read_b64_tr_b16 a[188:189], v73 offset:34816
    v_mfma_f32_16x16x32_bf16 v[218:221], a[140:143], a[184:187], 0
    ds_read_b64_tr_b16 a[190:191], v73 offset:35072
    v_mfma_f32_16x16x32_bf16 v[202:205], a[140:143], a[176:179], 0
    ds_read_b128 a[164:167], v53 offset:41984
    v_mfma_f32_16x16x32_bf16 v[230:233], a[180:183], a[144:147], 0
    ds_read_b128 a[168:171], v53 offset:43008
    v_mfma_f32_16x16x32_bf16 v[238:241], a[184:187], a[144:147], 0
    ds_read_b128 a[172:175], v53 offset:44032
    v_mfma_f32_16x16x32_bf16 v[222:225], a[176:179], a[144:147], 0
    v_mfma_f32_16x16x32_bf16 v[234:237], a[180:183], a[148:151], 0
    v_mfma_f32_16x16x32_bf16 v[242:245], a[184:187], a[148:151], 0
    v_mfma_f32_16x16x32_bf16 v[226:229], a[176:179], a[148:151], 0
    s_waitcnt lgkmcnt(0)
    s_barrier
    v_mfma_f32_16x16x32_bf16 v[182:185], a[152:155], a[192:195], v[182:185]
    ds_read_b64_tr_b16 a[180:181], v74 offset:0
    s_add_u32 m0, s59, 32768
    v_mfma_f32_16x16x32_bf16 v[190:193], a[152:155], a[196:199], v[190:193]
    ds_read_b64_tr_b16 a[182:183], v74 offset:256
    s_add_u32 s63, s63, 12288
    v_mfma_f32_16x16x32_bf16 v[186:189], a[156:159], a[192:195], v[186:189]
    ds_read_b128 a[128:131], v54 offset:0
    s_cmp_eq_u32 s63, 86016
    v_mfma_f32_16x16x32_bf16 v[194:197], a[156:159], a[196:199], v[194:197]
    ds_read_b64_tr_b16 a[184:185], v74 offset:1024
    v_mfma_f32_16x16x32_bf16 v[206:209], a[160:163], a[192:195], v[206:209]
    ds_read_b64_tr_b16 a[186:187], v74 offset:1280
    s_cselect_b32 s63, 0, s63
    v_mfma_f32_16x16x32_bf16 v[214:217], a[160:163], a[196:199], v[214:217]
    ds_read_b128 a[132:135], v54 offset:1024
    buffer_load_dwordx4 v80, s[28:31], s63 offen sc1 lds
    v_mfma_f32_16x16x32_bf16 v[198:201], a[160:163], a[188:191], v[198:201]
    ds_read_b128 a[136:139], v54 offset:2048
    v_mfma_f32_16x16x32_bf16 v[210:213], a[164:167], a[192:195], v[210:213]
    ds_read_b64_tr_b16 a[176:177], v75 offset:0
    buffer_load_dwordx4 v80, s[28:31], s63 offen offset:1024 sc1 lds
    v_mfma_f32_16x16x32_bf16 v[218:221], a[164:167], a[196:199], v[218:221]
    ds_read_b64_tr_b16 a[178:179], v75 offset:256
    v_mfma_f32_16x16x32_bf16 v[202:205], a[164:167], a[188:191], v[202:205]
    ds_read_b128 a[140:143], v54 offset:3072
    v_mfma_f32_16x16x32_bf16 v[230:233], a[192:195], a[168:171], v[230:233]
    ds_read_b128 a[144:147], v54 offset:4096
    buffer_load_dwordx4 v80, s[28:31], s63 offen offset:2048 sc1 lds
    v_mfma_f32_16x16x32_bf16 v[238:241], a[196:199], a[168:171], v[238:241]
    ds_read_b128 a[148:151], v54 offset:5120
    s_add_u32 m0, s100, 61440
    v_mfma_f32_16x16x32_bf16 v[222:225], a[188:191], a[168:171], v[222:225]
    s_add_u32 s62, s62, 262144
    s_cmp_eq_u32 s62, 1835008
    v_mfma_f32_16x16x32_bf16 v[234:237], a[192:195], a[172:175], v[234:237]
    s_cselect_b32 s62, 0, s62
    buffer_load_dwordx4 v69, s[28:31], s62 offen sc1 lds
    v_mfma_f32_16x16x32_bf16 v[242:245], a[196:199], a[172:175], v[242:245]
    s_add_u32 m0, s58, 45056
    v_mfma_f32_16x16x32_bf16 v[226:229], a[188:191], a[172:175], v[226:229]
    s_waitcnt lgkmcnt(6)
    v_mfma_f32_16x16x32_bf16 v[182:185], a[128:131], a[180:183], v[182:185]
    ds_read_b64_tr_b16 a[192:193], v74 offset:2048
    buffer_load_dwordx4 v67, s[28:31], s62 offen sc1 lds
    v_mfma_f32_16x16x32_bf16 v[190:193], a[128:131], a[184:187], v[190:193]
    ds_read_b64_tr_b16 a[194:195], v74 offset:2304
    v_mfma_f32_16x16x32_bf16 v[186:189], a[132:135], a[180:183], v[186:189]
    ds_read_b128 a[152:155], v54 offset:6144
    v_mfma_f32_16x16x32_bf16 v[194:197], a[132:135], a[184:187], v[194:197]
    ds_read_b64_tr_b16 a[196:197], v74 offset:3072
    s_waitcnt lgkmcnt(4)
    v_mfma_f32_16x16x32_bf16 v[206:209], a[136:139], a[180:183], v[206:209]
    ds_read_b64_tr_b16 a[198:199], v74 offset:3328
    buffer_load_dwordx4 v67, s[28:31], s62 offen offset:1024 sc1 lds
    v_mfma_f32_16x16x32_bf16 v[214:217], a[136:139], a[184:187], v[214:217]
    ds_read_b128 a[156:159], v54 offset:7168
    v_mfma_f32_16x16x32_bf16 v[198:201], a[136:139], a[176:179], v[198:201]
    ds_read_b128 a[160:163], v54 offset:8192
    buffer_load_dwordx4 v68, s[28:31], s62 offen offset:2048 sc1 lds
    v_mfma_f32_16x16x32_bf16 v[210:213], a[140:143], a[180:183], v[210:213]
    ds_read_b64_tr_b16 a[188:189], v75 offset:2048
    v_mfma_f32_16x16x32_bf16 v[218:221], a[140:143], a[184:187], v[218:221]
    ds_read_b64_tr_b16 a[190:191], v75 offset:2304
    v_mfma_f32_16x16x32_bf16 v[202:205], a[140:143], a[176:179], v[202:205]
    ds_read_b128 a[164:167], v54 offset:9216
    buffer_load_dwordx4 v68, s[28:31], s62 offen offset:3072 sc1 lds
    v_mfma_f32_16x16x32_bf16 v[230:233], a[180:183], a[144:147], v[230:233]
    ds_read_b128 a[168:171], v54 offset:10240
    s_add_u32 m0, s59, 98304
    v_mfma_f32_16x16x32_bf16 v[238:241], a[184:187], a[144:147], v[238:241]
    ds_read_b128 a[172:175], v54 offset:11264
    s_add_u32 s63, s63, 12288
    v_mfma_f32_16x16x32_bf16 v[222:225], a[176:179], a[144:147], v[222:225]
    s_cmp_eq_u32 s63, 86016
    s_cselect_b32 s63, 0, s63
    v_mfma_f32_16x16x32_bf16 v[234:237], a[180:183], a[148:151], v[234:237]
    buffer_load_dwordx4 v80, s[28:31], s63 offen sc1 lds
    v_mfma_f32_16x16x32_bf16 v[242:245], a[184:187], a[148:151], v[242:245]
    v_mfma_f32_16x16x32_bf16 v[226:229], a[176:179], a[148:151], v[226:229]
    s_waitcnt vmcnt(9) lgkmcnt(0)
    s_barrier
    s_cmp_lg_u32 s48, 0
    s_cbranch_scc1 L_sig2
    s_atomic_add s36, s[28:29], s68
L_sig2:
    v_mfma_f32_16x16x32_bf16 v[182:185], a[152:155], a[192:195], v[182:185]
    ds_read_b64_tr_b16 a[180:181], v70 offset:0
    buffer_load_dwordx4 v80, s[28:31], s63 offen offset:1024 sc1 lds
    v_mfma_f32_16x16x32_bf16 v[190:193], a[152:155], a[196:199], v[190:193]
    ds_read_b64_tr_b16 a[182:183], v70 offset:256
    v_mfma_f32_16x16x32_bf16 v[186:189], a[156:159], a[192:195], v[186:189]
    ds_read_b128 a[128:131], v4 offset:0
    buffer_load_dwordx4 v80, s[28:31], s63 offen offset:2048 sc1 lds
    v_mfma_f32_16x16x32_bf16 v[194:197], a[156:159], a[196:199], v[194:197]
    ds_read_b64_tr_b16 a[184:185], v70 offset:1024
    v_mfma_f32_16x16x32_bf16 v[206:209], a[160:163], a[192:195], v[206:209]
    ds_read_b64_tr_b16 a[186:187], v70 offset:1280
    s_add_u32 m0, s100, 126976
    v_mfma_f32_16x16x32_bf16 v[214:217], a[160:163], a[196:199], v[214:217]
    ds_read_b128 a[132:135], v4 offset:1024
    s_add_u32 s62, s62, 262144
    v_mfma_f32_16x16x32_bf16 v[198:201], a[160:163], a[188:191], v[198:201]
    ds_read_b128 a[136:139], v4 offset:2048
    s_cmp_eq_u32 s62, 1835008
    v_mfma_f32_16x16x32_bf16 v[210:213], a[164:167], a[192:195], v[210:213]
    ds_read_b64_tr_b16 a[176:177], v71 offset:0
    s_cselect_b32 s62, 0, s62
    v_mfma_f32_16x16x32_bf16 v[218:221], a[164:167], a[196:199], v[218:221]
    ds_read_b64_tr_b16 a[178:179], v71 offset:256
    buffer_load_dwordx4 v69, s[28:31], s62 offen sc1 lds
    v_mfma_f32_16x16x32_bf16 v[202:205], a[164:167], a[188:191], v[202:205]
    ds_read_b128 a[140:143], v4 offset:3072
    s_add_u32 m0, s58, 110592
    v_mfma_f32_16x16x32_bf16 v[230:233], a[192:195], a[168:171], v[230:233]
    ds_read_b128 a[144:147], v4 offset:4096
    buffer_load_dwordx4 v67, s[28:31], s62 offen sc1 lds
    v_mfma_f32_16x16x32_bf16 v[238:241], a[196:199], a[168:171], v[238:241]
    ds_read_b128 a[148:151], v4 offset:5120
    v_mfma_f32_16x16x32_bf16 v[222:225], a[188:191], a[168:171], v[222:225]
    v_mfma_f32_16x16x32_bf16 v[234:237], a[192:195], a[172:175], v[234:237]
    buffer_load_dwordx4 v67, s[28:31], s62 offen offset:1024 sc1 lds
    v_mfma_f32_16x16x32_bf16 v[242:245], a[196:199], a[172:175], v[242:245]
    v_mfma_f32_16x16x32_bf16 v[226:229], a[188:191], a[172:175], v[226:229]
    s_waitcnt lgkmcnt(6)
    v_mfma_f32_16x16x32_bf16 v[182:185], a[128:131], a[180:183], v[182:185]
    ds_read_b64_tr_b16 a[192:193], v70 offset:2048
    buffer_load_dwordx4 v68, s[28:31], s62 offen offset:2048 sc1 lds
    v_mfma_f32_16x16x32_bf16 v[190:193], a[128:131], a[184:187], v[190:193]
    ds_read_b64_tr_b16 a[194:195], v70 offset:2304
    v_mfma_f32_16x16x32_bf16 v[186:189], a[132:135], a[180:183], v[186:189]
    ds_read_b128 a[152:155], v4 offset:6144
    v_mfma_f32_16x16x32_bf16 v[194:197], a[132:135], a[184:187], v[194:197]
    ds_read_b64_tr_b16 a[196:197], v70 offset:3072
    s_waitcnt lgkmcnt(4)
    v_mfma_f32_16x16x32_bf16 v[206:209], a[136:139], a[180:183], v[206:209]
    ds_read_b64_tr_b16 a[198:199], v70 offset:3328
    buffer_load_dwordx4 v68, s[28:31], s62 offen offset:3072 sc1 lds
    v_mfma_f32_16x16x32_bf16 v[214:217], a[136:139], a[184:187], v[214:217]
    ds_read_b128 a[156:159], v4 offset:7168
    s_add_u32 m0, s59, 131072
    v_mfma_f32_16x16x32_bf16 v[198:201], a[136:139], a[176:179], v[198:201]
    ds_read_b128 a[160:163], v4 offset:8192
    s_add_u32 s63, s63, 12288
    v_mfma_f32_16x16x32_bf16 v[210:213], a[140:143], a[180:183], v[210:213]
    ds_read_b64_tr_b16 a[188:189], v71 offset:2048
    s_cmp_eq_u32 s63, 86016
    v_mfma_f32_16x16x32_bf16 v[218:221], a[140:143], a[184:187], v[218:221]
    ds_read_b64_tr_b16 a[190:191], v71 offset:2304
    s_cselect_b32 s63, 0, s63
    v_mfma_f32_16x16x32_bf16 v[202:205], a[140:143], a[176:179], v[202:205]
    ds_read_b128 a[164:167], v4 offset:9216
    buffer_load_dwordx4 v80, s[28:31], s63 offen sc1 lds
    v_mfma_f32_16x16x32_bf16 v[230:233], a[180:183], a[144:147], v[230:233]
    ds_read_b128 a[168:171], v4 offset:10240
    v_mfma_f32_16x16x32_bf16 v[238:241], a[184:187], a[144:147], v[238:241]
    ds_read_b128 a[172:175], v4 offset:11264
    buffer_load_dwordx4 v80, s[28:31], s63 offen offset:1024 sc1 lds
    v_mfma_f32_16x16x32_bf16 v[222:225], a[176:179], a[144:147], v[222:225]
    v_mfma_f32_16x16x32_bf16 v[234:237], a[180:183], a[148:151], v[234:237]
    v_mfma_f32_16x16x32_bf16 v[242:245], a[184:187], a[148:151], v[242:245]
    buffer_load_dwordx4 v80, s[28:31], s63 offen offset:2048 sc1 lds
    s_add_u32 m0, s100, 159744
    v_mfma_f32_16x16x32_bf16 v[226:229], a[176:179], a[148:151], v[226:229]
    s_add_u32 s62, s62, 262144
    ds_read_b32 v24, v4
    s_waitcnt lgkmcnt(1)
    s_barrier
    v_mfma_f32_16x16x32_bf16 v[182:185], a[152:155], a[192:195], v[182:185]
    ds_read_b64_tr_b16 a[180:181], v72 offset:0
    s_cmp_eq_u32 s62, 1835008
    v_mfma_f32_16x16x32_bf16 v[190:193], a[152:155], a[196:199], v[190:193]
    ds_read_b64_tr_b16 a[182:183], v72 offset:256
    s_cselect_b32 s62, 0, s62
    v_mfma_f32_16x16x32_bf16 v[186:189], a[156:159], a[192:195], v[186:189]
    ds_read_b128 a[128:131], v53 offset:0
    buffer_load_dwordx4 v69, s[28:31], s62 offen sc1 lds
    v_mfma_f32_16x16x32_bf16 v[194:197], a[156:159], a[196:199], v[194:197]
    ds_read_b64_tr_b16 a[184:185], v72 offset:1024
    v_mfma_f32_16x16x32_bf16 v[206:209], a[160:163], a[192:195], v[206:209]
    ds_read_b64_tr_b16 a[186:187], v72 offset:1280
    s_add_u32 m0, s58, 143360
    v_mfma_f32_16x16x32_bf16 v[214:217], a[160:163], a[196:199], v[214:217]
    ds_read_b128 a[132:135], v53 offset:1024
    buffer_load_dwordx4 v67, s[28:31], s62 offen sc1 lds
    v_mfma_f32_16x16x32_bf16 v[198:201], a[160:163], a[188:191], v[198:201]
    ds_read_b128 a[136:139], v53 offset:2048
    v_mfma_f32_16x16x32_bf16 v[210:213], a[164:167], a[192:195], v[210:213]
    ds_read_b64_tr_b16 a[176:177], v73 offset:0
    buffer_load_dwordx4 v67, s[28:31], s62 offen offset:1024 sc1 lds
    v_mfma_f32_16x16x32_bf16 v[218:221], a[164:167], a[196:199], v[218:221]
    ds_read_b64_tr_b16 a[178:179], v73 offset:256
    v_mfma_f32_16x16x32_bf16 v[202:205], a[164:167], a[188:191], v[202:205]
    ds_read_b128 a[140:143], v53 offset:3072
    v_mfma_f32_16x16x32_bf16 v[230:233], a[192:195], a[168:171], v[230:233]
    ds_read_b128 a[144:147], v53 offset:4096
    buffer_load_dwordx4 v68, s[28:31], s62 offen offset:2048 sc1 lds
    v_mfma_f32_16x16x32_bf16 v[238:241], a[196:199], a[168:171], v[238:241]
    ds_read_b128 a[148:151], v53 offset:5120
    v_mfma_f32_16x16x32_bf16 v[222:225], a[188:191], a[168:171], v[222:225]
    v_mfma_f32_16x16x32_bf16 v[234:237], a[192:195], a[172:175], v[234:237]
    buffer_load_dwordx4 v68, s[28:31], s62 offen offset:3072 sc1 lds
    s_add_u32 m0, s58, 0
    v_mfma_f32_16x16x32_bf16 v[242:245], a[196:199], a[172:175], v[242:245]
    v_mfma_f32_16x16x32_bf16 v[226:229], a[188:191], a[172:175], v[226:229]
    s_waitcnt lgkmcnt(6)
    v_mfma_f32_16x16x32_bf16 v[182:185], a[128:131], a[180:183], v[182:185]
    ds_read_b64_tr_b16 a[192:193], v72 offset:2048
    buffer_load_dwordx4 v59, s[24:27], s64 offen lds
    v_mfma_f32_16x16x32_bf16 v[190:193], a[128:131], a[184:187], v[190:193]
    ds_read_b64_tr_b16 a[194:195], v72 offset:2304
    v_mfma_f32_16x16x32_bf16 v[186:189], a[132:135], a[180:183], v[186:189]
    ds_read_b128 a[152:155], v53 offset:6144
    v_mfma_f32_16x16x32_bf16 v[194:197], a[132:135], a[184:187], v[194:197]
    ds_read_b64_tr_b16 a[196:197], v72 offset:3072
    s_waitcnt lgkmcnt(4)
    v_mfma_f32_16x16x32_bf16 v[206:209], a[136:139], a[180:183], v[206:209]
    ds_read_b64_tr_b16 a[198:199], v72 offset:3328
    buffer_load_dwordx4 v60, s[24:27], s64 offen offset:1024 lds
    v_mfma_f32_16x16x32_bf16 v[214:217], a[136:139], a[184:187], v[214:217]
    ds_read_b128 a[156:159], v53 offset:7168
    v_mfma_f32_16x16x32_bf16 v[198:201], a[136:139], a[176:179], v[198:201]
    ds_read_b128 a[160:163], v53 offset:8192
    v_mfma_f32_16x16x32_bf16 v[210:213], a[140:143], a[180:183], v[210:213]
    ds_read_b64_tr_b16 a[188:189], v73 offset:2048
    buffer_load_dwordx4 v61, s[24:27], s64 offen offset:2048 lds
    v_mfma_f32_16x16x32_bf16 v[218:221], a[140:143], a[184:187], v[218:221]
    ds_read_b64_tr_b16 a[190:191], v73 offset:2304
    v_mfma_f32_16x16x32_bf16 v[202:205], a[140:143], a[176:179], v[202:205]
    ds_read_b128 a[164:167], v53 offset:9216
    v_mfma_f32_16x16x32_bf16 v[230:233], a[180:183], a[144:147], v[230:233]
    ds_read_b128 a[168:171], v53 offset:10240
    buffer_load_dwordx4 v62, s[24:27], s64 offen offset:3072 lds
    v_mfma_f32_16x16x32_bf16 v[238:241], a[184:187], a[144:147], v[238:241]
    ds_read_b128 a[172:175], v53 offset:11264
    s_add_u32 m0, s58, 16384
    v_mfma_f32_16x16x32_bf16 v[222:225], a[176:179], a[144:147], v[222:225]
    v_xor_b32 v59, 128, v59
    v_mfma_f32_16x16x32_bf16 v[234:237], a[180:183], a[148:151], v[234:237]
    buffer_load_dwordx4 v59, s[24:27], s64 offen lds
    v_xor_b32 v60, 128, v60
    v_mfma_f32_16x16x32_bf16 v[242:245], a[184:187], a[148:151], v[242:245]
    v_mfma_f32_16x16x32_bf16 v[226:229], a[176:179], a[148:151], v[226:229]
    ds_read_b32 v24, v4
    s_waitcnt vmcnt(21) lgkmcnt(1)
    s_barrier
    v_mfma_f32_16x16x32_bf16 v[182:185], a[152:155], a[192:195], v[182:185]
    ds_read_b64_tr_b16 a[180:181], v70 offset:32768
    buffer_load_dwordx4 v60, s[24:27], s64 offen offset:1024 lds
    v_mfma_f32_16x16x32_bf16 v[190:193], a[152:155], a[196:199], v[190:193]
    ds_read_b64_tr_b16 a[182:183], v70 offset:33024
    v_xor_b32 v61, 128, v61
    v_mfma_f32_16x16x32_bf16 v[186:189], a[156:159], a[192:195], v[186:189]
    ds_read_b128 a[128:131], v4 offset:32768
    v_mfma_f32_16x16x32_bf16 v[194:197], a[156:159], a[196:199], v[194:197]
    ds_read_b64_tr_b16 a[184:185], v70 offset:33792
    v_mfma_f32_16x16x32_bf16 v[206:209], a[160:163], a[192:195], v[206:209]
    ds_read_b64_tr_b16 a[186:187], v70 offset:34048
    buffer_load_dwordx4 v61, s[24:27], s64 offen offset:2048 lds
    v_mfma_f32_16x16x32_bf16 v[214:217], a[160:163], a[196:199], v[214:217]
    ds_read_b128 a[132:135], v4 offset:33792
    v_xor_b32 v62, 128, v62
    v_mfma_f32_16x16x32_bf16 v[198:201], a[160:163], a[188:191], v[198:201]
    ds_read_b128 a[136:139], v4 offset:34816
    buffer_load_dwordx4 v62, s[24:27], s64 offen offset:3072 lds
    v_mfma_f32_16x16x32_bf16 v[210:213], a[164:167], a[192:195], v[210:213]
    ds_read_b64_tr_b16 a[176:177], v71 offset:32768
    s_add_u32 m0, s58, 65536
    v_mfma_f32_16x16x32_bf16 v[218:221], a[164:167], a[196:199], v[218:221]
    ds_read_b64_tr_b16 a[178:179], v71 offset:33024
    s_add_u32 s64, s64, 524288
    v_mfma_f32_16x16x32_bf16 v[202:205], a[164:167], a[188:191], v[202:205]
    ds_read_b128 a[140:143], v4 offset:35840
    s_cmp_eq_u32 s64, 3670016
    v_mfma_f32_16x16x32_bf16 v[230:233], a[192:195], a[168:171], v[230:233]
    ds_read_b128 a[144:147], v4 offset:36864
    s_cselect_b32 s64, 0, s64
    v_mfma_f32_16x16x32_bf16 v[238:241], a[196:199], a[168:171], v[238:241]
    ds_read_b128 a[148:151], v4 offset:37888
    buffer_load_dwordx4 v59, s[24:27], s64 offen lds
    v_mfma_f32_16x16x32_bf16 v[222:225], a[188:191], a[168:171], v[222:225]
    v_mfma_f32_16x16x32_bf16 v[234:237], a[192:195], a[172:175], v[234:237]
    buffer_load_dwordx4 v60, s[24:27], s64 offen offset:1024 lds
    v_mfma_f32_16x16x32_bf16 v[242:245], a[196:199], a[172:175], v[242:245]
    v_mfma_f32_16x16x32_bf16 v[226:229], a[188:191], a[172:175], v[226:229]
    s_waitcnt lgkmcnt(6)
    v_mfma_f32_16x16x32_bf16 v[182:185], a[128:131], a[180:183], v[182:185]
    ds_read_b64_tr_b16 a[192:193], v70 offset:34816
    buffer_load_dwordx4 v61, s[24:27], s64 offen offset:2048 lds
    v_mfma_f32_16x16x32_bf16 v[190:193], a[128:131], a[184:187], v[190:193]
    ds_read_b64_tr_b16 a[194:195], v70 offset:35072
    v_mfma_f32_16x16x32_bf16 v[186:189], a[132:135], a[180:183], v[186:189]
    ds_read_b128 a[152:155], v4 offset:38912
    v_mfma_f32_16x16x32_bf16 v[194:197], a[132:135], a[184:187], v[194:197]
    ds_read_b64_tr_b16 a[196:197], v70 offset:35840
    s_waitcnt lgkmcnt(4)
    v_mfma_f32_16x16x32_bf16 v[206:209], a[136:139], a[180:183], v[206:209]
    ds_read_b64_tr_b16 a[198:199], v70 offset:36096
    buffer_load_dwordx4 v62, s[24:27], s64 offen offset:3072 lds
    v_mfma_f32_16x16x32_bf16 v[214:217], a[136:139], a[184:187], v[214:217]
    ds_read_b128 a[156:159], v4 offset:39936
    s_add_u32 m0, s58, 81920
    v_mfma_f32_16x16x32_bf16 v[198:201], a[136:139], a[176:179], v[198:201]
    ds_read_b128 a[160:163], v4 offset:40960
    s_add_u32 s64, s64, 524288
    v_mfma_f32_16x16x32_bf16 v[210:213], a[140:143], a[180:183], v[210:213]
    ds_read_b64_tr_b16 a[188:189], v71 offset:34816
    s_cmp_eq_u32 s64, 3670016
    v_mfma_f32_16x16x32_bf16 v[218:221], a[140:143], a[184:187], v[218:221]
    ds_read_b64_tr_b16 a[190:191], v71 offset:35072
    s_cselect_b32 s64, 0, s64
    v_mfma_f32_16x16x32_bf16 v[202:205], a[140:143], a[176:179], v[202:205]
    ds_read_b128 a[164:167], v4 offset:41984
    buffer_load_dwordx4 v59, s[24:27], s64 offen lds
    v_mfma_f32_16x16x32_bf16 v[230:233], a[180:183], a[144:147], v[230:233]
    ds_read_b128 a[168:171], v4 offset:43008
    v_mfma_f32_16x16x32_bf16 v[238:241], a[184:187], a[144:147], v[238:241]
    ds_read_b128 a[172:175], v4 offset:44032
    buffer_load_dwordx4 v60, s[24:27], s64 offen offset:1024 lds
    v_mfma_f32_16x16x32_bf16 v[222:225], a[176:179], a[144:147], v[222:225]
    v_mfma_f32_16x16x32_bf16 v[234:237], a[180:183], a[148:151], v[234:237]
    v_mfma_f32_16x16x32_bf16 v[242:245], a[184:187], a[148:151], v[242:245]
    buffer_load_dwordx4 v61, s[24:27], s64 offen offset:2048 lds
    v_mfma_f32_16x16x32_bf16 v[226:229], a[176:179], a[148:151], v[226:229]
    ds_read_b32 v24, v4
    s_waitcnt vmcnt(23) lgkmcnt(1)
    s_barrier
    v_mfma_f32_16x16x32_bf16 v[182:185], a[152:155], a[192:195], v[182:185]
    ds_read_b64_tr_b16 a[180:181], v72 offset:32768
    v_mfma_f32_16x16x32_bf16 v[190:193], a[152:155], a[196:199], v[190:193]
    ds_read_b64_tr_b16 a[182:183], v72 offset:33024
    buffer_load_dwordx4 v62, s[24:27], s64 offen offset:3072 lds
    v_mfma_f32_16x16x32_bf16 v[186:189], a[156:159], a[192:195], v[186:189]
    ds_read_b128 a[128:131], v53 offset:32768
    s_add_u32 m0, s58, 32768
    v_mfma_f32_16x16x32_bf16 v[194:197], a[156:159], a[196:199], v[194:197]
    ds_read_b64_tr_b16 a[184:185], v72 offset:33792
    v_mfma_f32_16x16x32_bf16 v[206:209], a[160:163], a[192:195], v[206:209]
    ds_read_b64_tr_b16 a[186:187], v72 offset:34048
    s_add_u32 s64, s64, 524288
    v_mfma_f32_16x16x32_bf16 v[214:217], a[160:163], a[196:199], v[214:217]
    ds_read_b128 a[132:135], v53 offset:33792
    s_cmp_eq_u32 s64, 3670016
    v_mfma_f32_16x16x32_bf16 v[198:201], a[160:163], a[188:191], v[198:201]
    ds_read_b128 a[136:139], v53 offset:34816
    s_cselect_b32 s64, 0, s64
    v_mfma_f32_16x16x32_bf16 v[210:213], a[164:167], a[192:195], v[210:213]
    ds_read_b64_tr_b16 a[176:177], v73 offset:32768
    buffer_load_dwordx4 v59, s[24:27], s64 offen lds
    v_mfma_f32_16x16x32_bf16 v[218:221], a[164:167], a[196:199], v[218:221]
    ds_read_b64_tr_b16 a[178:179], v73 offset:33024
    v_mfma_f32_16x16x32_bf16 v[202:205], a[164:167], a[188:191], v[202:205]
    ds_read_b128 a[140:143], v53 offset:35840
    buffer_load_dwordx4 v60, s[24:27], s64 offen offset:1024 lds
    v_mfma_f32_16x16x32_bf16 v[230:233], a[192:195], a[168:171], v[230:233]
    ds_read_b128 a[144:147], v53 offset:36864
    v_mfma_f32_16x16x32_bf16 v[238:241], a[196:199], a[168:171], v[238:241]
    ds_read_b128 a[148:151], v53 offset:37888
    v_mfma_f32_16x16x32_bf16 v[222:225], a[188:191], a[168:171], v[222:225]
    buffer_load_dwordx4 v61, s[24:27], s64 offen offset:2048 lds
    v_mfma_f32_16x16x32_bf16 v[234:237], a[192:195], a[172:175], v[234:237]
    v_mfma_f32_16x16x32_bf16 v[242:245], a[196:199], a[172:175], v[242:245]
    v_mfma_f32_16x16x32_bf16 v[226:229], a[188:191], a[172:175], v[226:229]
    buffer_load_dwordx4 v62, s[24:27], s64 offen offset:3072 lds
    s_load_dword s14, s[28:29], s38
    s_waitcnt lgkmcnt(6)
    v_mfma_f32_16x16x32_bf16 v[182:185], a[128:131], a[180:183], v[182:185]
    ds_read_b64_tr_b16 a[192:193], v72 offset:34816
    s_add_u32 m0, s58, 49152
    v_mfma_f32_16x16x32_bf16 v[190:193], a[128:131], a[184:187], v[190:193]
    ds_read_b64_tr_b16 a[194:195], v72 offset:35072
    s_add_u32 s64, s64, 524288
    v_mfma_f32_16x16x32_bf16 v[186:189], a[132:135], a[180:183], v[186:189]
    ds_read_b128 a[152:155], v53 offset:38912
    s_cmp_eq_u32 s64, 3670016
    v_mfma_f32_16x16x32_bf16 v[194:197], a[132:135], a[184:187], v[194:197]
    ds_read_b64_tr_b16 a[196:197], v72 offset:35840
    s_waitcnt lgkmcnt(4)
    v_mfma_f32_16x16x32_bf16 v[206:209], a[136:139], a[180:183], v[206:209]
    ds_read_b64_tr_b16 a[198:199], v72 offset:36096
    s_cselect_b32 s64, 0, s64
    v_mfma_f32_16x16x32_bf16 v[214:217], a[136:139], a[184:187], v[214:217]
    ds_read_b128 a[156:159], v53 offset:39936
    buffer_load_dwordx4 v59, s[24:27], s64 offen lds
    v_mfma_f32_16x16x32_bf16 v[198:201], a[136:139], a[176:179], v[198:201]
    ds_read_b128 a[160:163], v53 offset:40960
    v_mfma_f32_16x16x32_bf16 v[210:213], a[140:143], a[180:183], v[210:213]
    ds_read_b64_tr_b16 a[188:189], v73 offset:34816
    buffer_load_dwordx4 v60, s[24:27], s64 offen offset:1024 lds
    v_mfma_f32_16x16x32_bf16 v[218:221], a[140:143], a[184:187], v[218:221]
    ds_read_b64_tr_b16 a[190:191], v73 offset:35072
L_pad2:
    s_cbranch_execz L_warm
    v_mfma_f32_16x16x32_bf16 v[202:205], a[140:143], a[176:179], v[202:205]
    ds_read_b128 a[164:167], v53 offset:41984
    v_mfma_f32_16x16x32_bf16 v[230:233], a[180:183], a[144:147], v[230:233]
    ds_read_b128 a[168:171], v53 offset:43008
    buffer_load_dwordx4 v61, s[24:27], s64 offen offset:2048 lds
    v_mfma_f32_16x16x32_bf16 v[238:241], a[184:187], a[144:147], v[238:241]
    ds_read_b128 a[172:175], v53 offset:44032
    v_mfma_f32_16x16x32_bf16 v[222:225], a[176:179], a[144:147], v[222:225]
    v_mfma_f32_16x16x32_bf16 v[234:237], a[180:183], a[148:151], v[234:237]
    buffer_load_dwordx4 v62, s[24:27], s64 offen offset:3072 lds
    v_mfma_f32_16x16x32_bf16 v[242:245], a[184:187], a[148:151], v[242:245]
    v_mfma_f32_16x16x32_bf16 v[226:229], a[176:179], a[148:151], v[226:229]
    ds_read_b32 v24, v4
    s_waitcnt vmcnt(24) lgkmcnt(1)
    s_barrier
    v_mfma_f32_16x16x32_bf16 v[182:185], a[152:155], a[192:195], v[182:185]
    ds_read_b64_tr_b16 a[180:181], v74 offset:0
    s_add_u32 m0, s58, 98304
    v_mfma_f32_16x16x32_bf16 v[190:193], a[152:155], a[196:199], v[190:193]
    ds_read_b64_tr_b16 a[182:183], v74 offset:256
    s_add_u32 s64, s64, 524288
    v_mfma_f32_16x16x32_bf16 v[186:189], a[156:159], a[192:195], v[186:189]
    ds_read_b128 a[128:131], v54 offset:0
    s_cmp_eq_u32 s64, 3670016
    v_mfma_f32_16x16x32_bf16 v[194:197], a[156:159], a[196:199], v[194:197]
    ds_read_b64_tr_b16 a[184:185], v74 offset:1024
    v_mfma_f32_16x16x32_bf16 v[206:209], a[160:163], a[192:195], v[206:209]
    ds_read_b64_tr_b16 a[186:187], v74 offset:1280
    s_cselect_b32 s64, 0, s64
    v_mfma_f32_16x16x32_bf16 v[214:217], a[160:163], a[196:199], v[214:217]
    ds_read_b128 a[132:135], v54 offset:1024
    buffer_load_dwordx4 v59, s[24:27], s64 offen lds
    v_mfma_f32_16x16x32_bf16 v[198:201], a[160:163], a[188:191], v[198:201]
    ds_read_b128 a[136:139], v54 offset:2048
    v_mfma_f32_16x16x32_bf16 v[210:213], a[164:167], a[192:195], v[210:213]
    ds_read_b64_tr_b16 a[176:177], v75 offset:0
    buffer_load_dwordx4 v60, s[24:27], s64 offen offset:1024 lds
    v_mfma_f32_16x16x32_bf16 v[218:221], a[164:167], a[196:199], v[218:221]
    ds_read_b64_tr_b16 a[178:179], v75 offset:256
    v_mfma_f32_16x16x32_bf16 v[202:205], a[164:167], a[188:191], v[202:205]
    ds_read_b128 a[140:143], v54 offset:3072
    v_mfma_f32_16x16x32_bf16 v[230:233], a[192:195], a[168:171], v[230:233]
    ds_read_b128 a[144:147], v54 offset:4096
    buffer_load_dwordx4 v61, s[24:27], s64 offen offset:2048 lds
    v_mfma_f32_16x16x32_bf16 v[238:241], a[196:199], a[168:171], v[238:241]
    ds_read_b128 a[148:151], v54 offset:5120
    v_mfma_f32_16x16x32_bf16 v[222:225], a[188:191], a[168:171], v[222:225]
    v_mfma_f32_16x16x32_bf16 v[234:237], a[192:195], a[172:175], v[234:237]
    buffer_load_dwordx4 v62, s[24:27], s64 offen offset:3072 lds
    s_add_u32 m0, s58, 114688
    v_mfma_f32_16x16x32_bf16 v[242:245], a[196:199], a[172:175], v[242:245]
    s_add_u32 s64, s64, 524288
    s_cmp_eq_u32 s64, 3670016
    v_mfma_f32_16x16x32_bf16 v[226:229], a[188:191], a[172:175], v[226:229]
    s_cselect_b32 s64, 0, s64
    s_waitcnt lgkmcnt(6)
    v_mfma_f32_16x16x32_bf16 v[182:185], a[128:131], a[180:183], v[182:185]
    ds_read_b64_tr_b16 a[192:193], v74 offset:2048
    buffer_load_dwordx4 v59, s[24:27], s64 offen lds
    v_mfma_f32_16x16x32_bf16 v[190:193], a[128:131], a[184:187], v[190:193]
    ds_read_b64_tr_b16 a[194:195], v74 offset:2304
    v_mfma_f32_16x16x32_bf16 v[186:189], a[132:135], a[180:183], v[186:189]
    ds_read_b128 a[152:155], v54 offset:6144
    v_mfma_f32_16x16x32_bf16 v[194:197], a[132:135], a[184:187], v[194:197]
    ds_read_b64_tr_b16 a[196:197], v74 offset:3072
    s_waitcnt lgkmcnt(4)
    v_mfma_f32_16x16x32_bf16 v[206:209], a[136:139], a[180:183], v[206:209]
    ds_read_b64_tr_b16 a[198:199], v74 offset:3328
    buffer_load_dwordx4 v60, s[24:27], s64 offen offset:1024 lds
    v_mfma_f32_16x16x32_bf16 v[214:217], a[136:139], a[184:187], v[214:217]
    ds_read_b128 a[156:159], v54 offset:7168
    v_mfma_f32_16x16x32_bf16 v[198:201], a[136:139], a[176:179], v[198:201]
    ds_read_b128 a[160:163], v54 offset:8192
    buffer_load_dwordx4 v61, s[24:27], s64 offen offset:2048 lds
    v_mfma_f32_16x16x32_bf16 v[210:213], a[140:143], a[180:183], v[210:213]
    ds_read_b64_tr_b16 a[188:189], v75 offset:2048
    v_mfma_f32_16x16x32_bf16 v[218:221], a[140:143], a[184:187], v[218:221]
    ds_read_b64_tr_b16 a[190:191], v75 offset:2304
    v_mfma_f32_16x16x32_bf16 v[202:205], a[140:143], a[176:179], v[202:205]
    ds_read_b128 a[164:167], v54 offset:9216
    buffer_load_dwordx4 v62, s[24:27], s64 offen offset:3072 lds
    v_mfma_f32_16x16x32_bf16 v[230:233], a[180:183], a[144:147], v[230:233]
    ds_read_b128 a[168:171], v54 offset:10240
    v_mfma_f32_16x16x32_bf16 v[238:241], a[184:187], a[144:147], v[238:241]
    ds_read_b128 a[172:175], v54 offset:11264
    v_mfma_f32_16x16x32_bf16 v[222:225], a[176:179], a[144:147], v[222:225]
    v_mfma_f32_16x16x32_bf16 v[234:237], a[180:183], a[148:151], v[234:237]
    v_mfma_f32_16x16x32_bf16 v[242:245], a[184:187], a[148:151], v[242:245]
    v_mfma_f32_16x16x32_bf16 v[226:229], a[176:179], a[148:151], v[226:229]
    s_waitcnt lgkmcnt(0)
    s_cmp_ge_u32 s14, 7
    s_cbranch_scc0 L_pollin5
L_pollok5:
    s_waitcnt vmcnt(16)
    s_barrier
    v_mfma_f32_16x16x32_bf16 v[182:185], a[152:155], a[192:195], v[182:185]
    ds_read_b64_tr_b16 a[200:201], v31 offset:16384
    buffer_load_dwordx4 a[0:3], v79, s[28:31], s65 offen offset:0 sc1
    v_mfma_f32_16x16x32_bf16 v[190:193], a[152:155], a[196:199], v[190:193]
    ds_read_b64_tr_b16 a[202:203], v31 offset:18432
    v_mfma_f32_16x16x32_bf16 v[186:189], a[156:159], a[192:195], v[186:189]
    ds_read_b64_tr_b16 a[204:205], v33 offset:16384
    buffer_load_dwordx4 a[4:7], v79, s[28:31], s65 offen offset:1024 sc1
    v_mfma_f32_16x16x32_bf16 v[194:197], a[156:159], a[196:199], v[194:197]
    ds_read_b64_tr_b16 a[206:207], v33 offset:18432
    v_mfma_f32_16x16x32_bf16 v[206:209], a[160:163], a[192:195], v[206:209]
    ds_read_b64_tr_b16 a[208:209], v32 offset:16384
    v_mfma_f32_16x16x32_bf16 v[214:217], a[160:163], a[196:199], v[214:217]
    ds_read_b64_tr_b16 a[210:211], v32 offset:18432
    v_mfma_f32_16x16x32_bf16 v[198:201], a[160:163], a[188:191], v[198:201]
    ds_read_b64_tr_b16 a[212:213], v34 offset:16384
    buffer_load_dwordx4 a[8:11], v79, s[28:31], s65 offen offset:2048 sc1
    v_mfma_f32_16x16x32_bf16 v[210:213], a[164:167], a[192:195], v[210:213]
    ds_read_b64_tr_b16 a[214:215], v34 offset:18432
    v_mfma_f32_16x16x32_bf16 v[218:221], a[164:167], a[196:199], v[218:221]
    ds_read_b64_tr_b16 a[216:217], v31 offset:20480
    v_mfma_f32_16x16x32_bf16 v[202:205], a[164:167], a[188:191], v[202:205]
    ds_read_b64_tr_b16 a[218:219], v31 offset:22528
    buffer_load_dwordx4 a[12:15], v79, s[28:31], s65 offen offset:3072 sc1
    v_mfma_f32_16x16x32_bf16 v[230:233], a[192:195], a[168:171], v[230:233]
    ds_read_b64_tr_b16 a[220:221], v33 offset:20480
    s_add_u32 s65, s65, 8192
    v_mfma_f32_16x16x32_bf16 v[238:241], a[196:199], a[168:171], v[238:241]
    ds_read_b64_tr_b16 a[222:223], v33 offset:22528
    s_cmp_eq_u32 s65, 57344
    v_mfma_f32_16x16x32_bf16 v[222:225], a[188:191], a[168:171], v[222:225]
    s_cselect_b32 s65, 0, s65
    v_mfma_f32_16x16x32_bf16 v[234:237], a[192:195], a[172:175], v[234:237]
    buffer_load_dwordx4 a[16:19], v79, s[28:31], s65 offen offset:0 sc1
    v_mfma_f32_16x16x32_bf16 v[242:245], a[196:199], a[172:175], v[242:245]
    v_mfma_f32_16x16x32_bf16 v[226:229], a[188:191], a[172:175], v[226:229]
    v_cvt_pk_bf16_f32 v118, v182, v183
    v_cvt_pk_bf16_f32 v119, v184, v185
    v_cvt_pk_bf16_f32 v120, v186, v187
    buffer_load_dwordx4 a[20:23], v79, s[28:31], s65 offen offset:1024 sc1
    v_cvt_pk_bf16_f32 v121, v188, v189
    v_cvt_pk_bf16_f32 v122, v190, v191
    v_cvt_pk_bf16_f32 v123, v192, v193
    v_cvt_pk_bf16_f32 v124, v194, v195
    v_cvt_pk_bf16_f32 v125, v196, v197
    v_cvt_pk_bf16_f32 v130, v206, v207
    v_cvt_pk_bf16_f32 v131, v208, v209
    v_cvt_pk_bf16_f32 v132, v210, v211
    v_cvt_pk_bf16_f32 v133, v212, v213
    v_cvt_pk_bf16_f32 v134, v214, v215
    v_cvt_pk_bf16_f32 v135, v216, v217
    v_cvt_pk_bf16_f32 v136, v218, v219
    v_cvt_pk_bf16_f32 v137, v220, v221
    v_cvt_pk_bf16_f32 v126, v198, v199
    buffer_load_dwordx4 a[24:27], v79, s[28:31], s65 offen offset:2048 sc1
    v_cvt_pk_bf16_f32 v127, v200, v201
    v_cvt_pk_bf16_f32 v128, v202, v203
    v_cvt_pk_bf16_f32 v129, v204, v205
    v_mfma_f32_16x16x32_bf16 v[154:157], v[130:133], v[118:121], 0
    v_mfma_f32_16x16x32_bf16 v[158:161], v[130:133], v[122:125], 0
    v_mfma_f32_16x16x32_bf16 v[162:165], v[134:137], v[122:125], 0
    buffer_load_dwordx4 a[28:31], v79, s[28:31], s65 offen offset:3072 sc1
    v_mfma_f32_16x16x32_bf16 v[150:153], v[126:129], v[118:121], 0
    v_cvt_pk_bf16_f32 v166, v222, v223
    v_cvt_pk_bf16_f32 v167, v224, v225
    v_cvt_pk_bf16_f32 v168, v230, v231
    v_cvt_pk_bf16_f32 v169, v232, v233
    v_cvt_pk_bf16_f32 v170, v238, v239
    v_cvt_pk_bf16_f32 v171, v240, v241
    v_cndmask_b32 v250, v158, v159, s[70:71]
    v_cndmask_b32 v253, v162, v163, s[70:71]
    v_cndmask_b32 v250, v250, v253, s[72:73]
    s_add_u32 s65, s65, 8192
    s_cmp_eq_u32 s65, 57344
    s_cselect_b32 s65, 0, s65
    buffer_load_dwordx4 a[32:35], v79, s[28:31], s65 offen offset:0 sc1
    v_mul_f32 v250, v250, v29
    v_cndmask_b32 v251, v160, v161, s[70:71]
    v_cndmask_b32 v253, v164, v165, s[70:71]
    v_cndmask_b32 v251, v251, v253, s[74:75]
    v_mul_f32 v251, v251, v30
    v_cndmask_b32 v246, v150, v151, s[70:71]
    v_cndmask_b32 v246, v84, v246, s[76:77]
    v_cndmask_b32 v249, v154, v155, s[70:71]
    v_cndmask_b32 v246, v246, v249, s[72:73]
    v_mul_f32 v246, v246, v27
    v_cndmask_b32 v247, v152, v153, s[70:71]
    v_cndmask_b32 v247, v84, v247, s[76:77]
    v_cndmask_b32 v249, v156, v157, s[70:71]
    v_cndmask_b32 v247, v247, v249, s[74:75]
    buffer_load_dwordx4 a[36:39], v79, s[28:31], s65 offen offset:1024 sc1
    v_mul_f32 v247, v247, v28
    v_max_f32 v248, v246, v247
    v_max_f32 v252, v250, v251
    v_mov_b32 v249, v248
    v_mov_b32 v253, v252
    v_cvt_pk_bf16_f32 v172, v226, v227
    v_permlane16_swap_b32 v248, v249
    v_permlane16_swap_b32 v252, v253
    v_max_f32 v248, v248, v249
    v_max_f32 v252, v252, v253
    v_mov_b32 v249, v248
    v_mov_b32 v253, v252
    v_cvt_pk_bf16_f32 v173, v228, v229
    v_permlane32_swap_b32 v248, v249
    buffer_load_dwordx4 a[40:43], v79, s[28:31], s65 offen offset:2048 sc1
    v_permlane32_swap_b32 v252, v253
    v_max_f32 v248, v248, v249
    v_max_f32 v252, v252, v253
    v_mul_f32 v248, v25, v248
    v_mul_f32 v252, v26, v252
    v_fma_f32 v246, v246, v25, -v248
    v_fma_f32 v247, v247, v25, -v248
    v_fma_f32 v250, v250, v26, -v252
    v_fma_f32 v251, v251, v26, -v252
    v_exp_f32 v246, v246
    v_exp_f32 v247, v247
    v_exp_f32 v250, v250
    buffer_load_dwordx4 a[44:47], v79, s[28:31], s65 offen offset:3072 sc1
    v_exp_f32 v251, v251
    v_add_f32 v248, v246, v247
    v_add_f32 v252, v250, v251
    v_mov_b32 v249, v248
    v_mov_b32 v253, v252
    v_cvt_pk_bf16_f32 v174, v234, v235
    v_permlane16_swap_b32 v248, v249
    v_permlane16_swap_b32 v252, v253
    v_add_f32 v248, v248, v249
    v_add_f32 v252, v252, v253
    v_mov_b32 v249, v248
    v_mov_b32 v253, v252
    s_add_u32 m0, s58, 131072
    s_add_u32 s64, s64, 524288
    s_cmp_eq_u32 s64, 3670016
    s_cselect_b32 s64, 0, s64
    s_add_u32 s64, s64, 524288
    s_cmp_eq_u32 s64, 3670016
    s_cselect_b32 s64, 0, s64
    v_xor_b32 v59, 128, v59
    buffer_load_dwordx4 v59, s[24:27], s64 offen lds
    v_cvt_pk_bf16_f32 v175, v236, v237
    v_permlane32_swap_b32 v248, v249
    v_permlane32_swap_b32 v252, v253
    v_add_f32 v248, v248, v249
    v_add_f32 v252, v252, v253
    v_rcp_f32 v248, v248
    v_rcp_f32 v252, v252
    v_cvt_pk_bf16_f32 v176, v242, v243
    v_cvt_pk_bf16_f32 v177, v244, v245
    v_mul_f32 v246, v246, v27
    v_xor_b32 v60, 128, v60
    buffer_load_dwordx4 v60, s[24:27], s64 offen offset:1024 lds
    v_mul_f32 v247, v247, v28
    v_mul_f32 v250, v250, v29
    v_mul_f32 v251, v251, v30
    v_mul_f32 v246, v246, v248
    v_mul_f32 v247, v247, v248
    v_mul_f32 v250, v250, v252
    v_mul_f32 v251, v251, v252
    v_cvt_pk_bf16_f32 v246, v246, v246
    v_cvt_pk_bf16_f32 v247, v247, v247
    v_cvt_pk_bf16_f32 v250, v250, v250
    v_cvt_pk_bf16_f32 v251, v251, v251
    v_and_b32 v138, v246, v104
    v_and_b32 v139, v247, v105
    v_xor_b32 v61, 128, v61
    buffer_load_dwordx4 v61, s[24:27], s64 offen offset:2048 lds
    v_and_b32 v140, v246, v106
    v_and_b32 v141, v247, v107
    v_and_b32 v142, v250, v104
    v_and_b32 v143, v251, v105
    v_and_b32 v144, v250, v106
    v_and_b32 v145, v251, v107
    v_mfma_f32_16x16x32_bf16 v[182:185], v[166:169], v[138:141], 0
    v_mfma_f32_16x16x32_bf16 v[186:189], v[172:175], v[138:141], 0
    v_xor_b32 v62, 128, v62
    buffer_load_dwordx4 v62, s[24:27], s64 offen offset:3072 lds
    v_mfma_f32_16x16x32_bf16 v[190:193], v[168:171], v[142:145], 0
    v_mfma_f32_16x16x32_bf16 v[194:197], v[174:177], v[142:145], 0
    s_add_u32 s83, s82, 16384
    s_nop 1
    v_cvt_pk_bf16_f32 v110, v182, v183
    v_cvt_pk_bf16_f32 v111, v184, v185
    s_add_u32 m0, s58, 147456
    s_add_u32 s64, s64, 524288
    s_cmp_eq_u32 s64, 3670016
    s_cselect_b32 s64, 0, s64
    buffer_load_dwordx4 v59, s[24:27], s64 offen lds
    v_cvt_pk_bf16_f32 v112, v186, v187
    v_cvt_pk_bf16_f32 v113, v188, v189
    v_cvt_pk_bf16_f32 v114, v190, v191
    v_cvt_pk_bf16_f32 v115, v192, v193
    v_cvt_pk_bf16_f32 v116, v194, v195
    v_cvt_pk_bf16_f32 v117, v196, v197
    buffer_store_dwordx4 v[110:113], v4, s[28:31], s82 offen sc1
    buffer_store_dwordx4 v[114:117], v4, s[28:31], s83 offen sc1
    s_cmp_lg_u32 s56, 0
    s_cbranch_scc0 L_nof
L_f:
    s_waitcnt vmcnt(17) lgkmcnt(8)
    v_mfma_f32_16x16x32_bf16 v[182:185], a[0:3], a[200:203], 0
    ds_read_b64_tr_b16 a[224:225], v32 offset:20480
    s_add_u32 s65, s65, 8192
    s_cmp_eq_u32 s65, 57344
    s_cselect_b32 s65, 0, s65
    buffer_load_dwordx4 a[48:51], v79, s[28:31], s65 offen offset:0 sc1
    v_mfma_f32_16x16x32_bf16 v[186:189], a[4:7], a[200:203], 0
    ds_read_b64_tr_b16 a[226:227], v32 offset:22528
    v_lshlrev_b32 v93, 16, v93
    v_mfma_f32_16x16x32_bf16 v[238:241], a[0:3], a[204:207], 0
    ds_read_b64_tr_b16 a[228:229], v34 offset:20480
    buffer_load_dwordx4 a[52:55], v79, s[28:31], s65 offen offset:1024 sc1
    v_mfma_f32_16x16x32_bf16 v[242:245], a[4:7], a[204:207], 0
    ds_read_b64_tr_b16 a[230:231], v34 offset:22528
    s_waitcnt lgkmcnt(8)
    v_mfma_f32_16x16x32_bf16 v[190:193], a[0:3], a[208:211], 0
    ds_read_b64_tr_b16 a[200:201], v35 offset:0
    v_lshlrev_b32 v222, 16, v96
    v_mfma_f32_16x16x32_bf16 v[194:197], a[4:7], a[208:211], 0
    ds_read_b64_tr_b16 a[202:203], v35 offset:2048
    v_and_b32 v223, 0xffff0000, v96
    v_mfma_f32_16x16x32_bf16 v[246:249], a[0:3], a[212:215], 0
    ds_read_b64_tr_b16 a[204:205], v37 offset:0
    buffer_load_dwordx4 a[56:59], v79, s[28:31], s65 offen offset:2048 sc1
    v_mfma_f32_16x16x32_bf16 v[250:253], a[4:7], a[212:215], 0
    ds_read_b64_tr_b16 a[206:207], v37 offset:2048
    s_waitcnt vmcnt(18) lgkmcnt(8)
    v_mfma_f32_16x16x32_bf16 v[182:185], a[8:11], a[216:219], v[182:185]
    ds_read_b64_tr_b16 a[208:209], v36 offset:0
    v_add_f32 v222, v222, v93
    v_mfma_f32_16x16x32_bf16 v[186:189], a[12:15], a[216:219], v[186:189]
    ds_read_b64_tr_b16 a[210:211], v36 offset:2048
    buffer_load_dwordx4 a[60:63], v79, s[28:31], s65 offen offset:3072 sc1
    v_add_f32 v223, v223, v93
    v_mfma_f32_16x16x32_bf16 v[238:241], a[8:11], a[220:223], v[238:241]
    ds_read_b64_tr_b16 a[212:213], v38 offset:0
    s_add_u32 s65, s65, 8192
    v_mfma_f32_16x16x32_bf16 v[242:245], a[12:15], a[220:223], v[242:245]
    ds_read_b64_tr_b16 a[214:215], v38 offset:2048
    s_waitcnt lgkmcnt(8)
    v_mfma_f32_16x16x32_bf16 v[190:193], a[8:11], a[224:227], v[190:193]
    ds_read_b64_tr_b16 a[216:217], v35 offset:4096
    s_cmp_eq_u32 s65, 57344
    v_mfma_f32_16x16x32_bf16 v[194:197], a[12:15], a[224:227], v[194:197]
    ds_read_b64_tr_b16 a[218:219], v35 offset:6144
    s_cselect_b32 s65, 0, s65
    v_lshlrev_b32 v224, 16, v97
    v_mfma_f32_16x16x32_bf16 v[246:249], a[8:11], a[228:231], v[246:249]
    ds_read_b64_tr_b16 a[220:221], v37 offset:4096
    buffer_load_dwordx4 a[64:67], v79, s[28:31], s65 offen offset:0 sc1
    v_mfma_f32_16x16x32_bf16 v[250:253], a[12:15], a[228:231], v[250:253]
    ds_read_b64_tr_b16 a[222:223], v37 offset:6144
    s_waitcnt vmcnt(18) lgkmcnt(8)
    v_mfma_f32_16x16x32_bf16 v[182:185], a[16:19], a[200:203], v[182:185]
    ds_read_b64_tr_b16 a[224:225], v36 offset:4096
    buffer_load_dwordx4 a[68:71], v79, s[28:31], s65 offen offset:1024 sc1
    v_mfma_f32_16x16x32_bf16 v[186:189], a[20:23], a[200:203], v[186:189]
    ds_read_b64_tr_b16 a[226:227], v36 offset:6144
    v_and_b32 v225, 0xffff0000, v97
    v_mfma_f32_16x16x32_bf16 v[238:241], a[16:19], a[204:207], v[238:241]
    ds_read_b64_tr_b16 a[228:229], v38 offset:4096
    v_add_f32 v224, v224, v93
    v_mfma_f32_16x16x32_bf16 v[242:245], a[20:23], a[204:207], v[242:245]
    ds_read_b64_tr_b16 a[230:231], v38 offset:6144
    s_waitcnt lgkmcnt(8)
    v_mfma_f32_16x16x32_bf16 v[190:193], a[16:19], a[208:211], v[190:193]
    ds_read_b64_tr_b16 a[200:201], v35 offset:16384
    buffer_load_dwordx4 a[72:75], v79, s[28:31], s65 offen offset:2048 sc1
    v_mfma_f32_16x16x32_bf16 v[194:197], a[20:23], a[208:211], v[194:197]
    ds_read_b64_tr_b16 a[202:203], v35 offset:18432
    v_add_f32 v225, v225, v93
    v_mfma_f32_16x16x32_bf16 v[246:249], a[16:19], a[212:215], v[246:249]
    ds_read_b64_tr_b16 a[204:205], v37 offset:16384
    v_lshlrev_b32 v226, 16, v98
    v_mfma_f32_16x16x32_bf16 v[250:253], a[20:23], a[212:215], v[250:253]
    ds_read_b64_tr_b16 a[206:207], v37 offset:18432
    s_waitcnt vmcnt(18) lgkmcnt(8)
    v_mfma_f32_16x16x32_bf16 v[182:185], a[24:27], a[216:219], v[182:185]
    ds_read_b64_tr_b16 a[208:209], v36 offset:16384
    buffer_load_dwordx4 a[76:79], v79, s[28:31], s65 offen offset:3072 sc1
    v_mfma_f32_16x16x32_bf16 v[186:189], a[28:31], a[216:219], v[186:189]
    ds_read_b64_tr_b16 a[210:211], v36 offset:18432
    s_add_u32 s65, s65, 8192
    v_and_b32 v227, 0xffff0000, v98
    v_mfma_f32_16x16x32_bf16 v[238:241], a[24:27], a[220:223], v[238:241]
    ds_read_b64_tr_b16 a[212:213], v38 offset:16384
    s_cmp_eq_u32 s65, 57344
    v_mfma_f32_16x16x32_bf16 v[242:245], a[28:31], a[220:223], v[242:245]
    ds_read_b64_tr_b16 a[214:215], v38 offset:18432
    v_add_f32 v226, v226, v93
    s_waitcnt lgkmcnt(8)
    v_mfma_f32_16x16x32_bf16 v[190:193], a[24:27], a[224:227], v[190:193]
    ds_read_b64_tr_b16 a[216:217], v35 offset:20480
    s_cselect_b32 s65, 0, s65
    buffer_load_dwordx4 a[80:83], v79, s[28:31], s65 offen offset:0 sc1
    v_mfma_f32_16x16x32_bf16 v[194:197], a[28:31], a[224:227], v[194:197]
    ds_read_b64_tr_b16 a[218:219], v35 offset:22528
    v_add_f32 v227, v227, v93
    v_mfma_f32_16x16x32_bf16 v[246:249], a[24:27], a[228:231], v[246:249]
    ds_read_b64_tr_b16 a[220:221], v37 offset:20480
    buffer_load_dwordx4 a[84:87], v79, s[28:31], s65 offen offset:1024 sc1
    v_mfma_f32_16x16x32_bf16 v[250:253], a[28:31], a[228:231], v[250:253]
    ds_read_b64_tr_b16 a[222:223], v37 offset:22528
    v_lshlrev_b32 v228, 16, v99
    s_waitcnt vmcnt(19) lgkmcnt(8)
    v_mfma_f32_16x16x32_bf16 v[182:185], a[32:35], a[200:203], v[182:185]
    ds_read_b64_tr_b16 a[224:225], v36 offset:20480
    v_and_b32 v229, 0xffff0000, v99
    v_mfma_f32_16x16x32_bf16 v[186:189], a[36:39], a[200:203], v[186:189]
    ds_read_b64_tr_b16 a[226:227], v36 offset:22528
    buffer_load_dwordx4 a[88:91], v79, s[28:31], s65 offen offset:2048 sc1
    v_add_f32 v228, v228, v93
    v_mfma_f32_16x16x32_bf16 v[238:241], a[32:35], a[204:207], v[238:241]
    ds_read_b64_tr_b16 a[228:229], v38 offset:20480
    v_add_f32 v229, v229, v93
    v_mfma_f32_16x16x32_bf16 v[242:245], a[36:39], a[204:207], v[242:245]
    ds_read_b64_tr_b16 a[230:231], v38 offset:22528
    s_waitcnt lgkmcnt(8)
    v_mfma_f32_16x16x32_bf16 v[190:193], a[32:35], a[208:211], v[190:193]
    s_waitcnt vmcnt(11)
    s_barrier
    s_cmp_lg_u32 s48, 0
    s_cbranch_scc1 L_sig4
    s_atomic_add s36, s[28:29], s69
L_sig4:
    ds_read_b64_tr_b16 a[200:201], v31 offset:32768
    buffer_load_dwordx4 a[92:95], v79, s[28:31], s65 offen offset:3072 sc1
    v_mfma_f32_16x16x32_bf16 v[194:197], a[36:39], a[208:211], v[194:197]
    ds_read_b64_tr_b16 a[202:203], v31 offset:34816
    s_add_u32 s65, s65, 8192
    v_lshlrev_b32 v94, 16, v94
    v_mfma_f32_16x16x32_bf16 v[246:249], a[32:35], a[212:215], v[246:249]
    ds_read_b64_tr_b16 a[204:205], v33 offset:32768
    s_cmp_eq_u32 s65, 57344
    v_mfma_f32_16x16x32_bf16 v[250:253], a[36:39], a[212:215], v[250:253]
    ds_read_b64_tr_b16 a[206:207], v33 offset:34816
    s_waitcnt lgkmcnt(8)
    v_mfma_f32_16x16x32_bf16 v[182:185], a[40:43], a[216:219], v[182:185]
    ds_read_b64_tr_b16 a[208:209], v32 offset:32768
    s_cselect_b32 s65, 0, s65
    v_mfma_f32_16x16x32_bf16 v[186:189], a[44:47], a[216:219], v[186:189]
    ds_read_b64_tr_b16 a[210:211], v32 offset:34816
    buffer_load_dwordx4 a[96:99], v79, s[28:31], s65 offen offset:0 sc1
    v_lshlrev_b32 v230, 16, v100
    v_mfma_f32_16x16x32_bf16 v[238:241], a[40:43], a[220:223], v[238:241]
    ds_read_b64_tr_b16 a[212:213], v34 offset:32768
    v_and_b32 v231, 0xffff0000, v100
    v_mfma_f32_16x16x32_bf16 v[242:245], a[44:47], a[220:223], v[242:245]
    ds_read_b64_tr_b16 a[214:215], v34 offset:34816
    s_waitcnt lgkmcnt(8)
    v_mfma_f32_16x16x32_bf16 v[190:193], a[40:43], a[224:227], v[190:193]
    ds_read_b64_tr_b16 a[216:217], v31 offset:36864
    buffer_load_dwordx4 a[100:103], v79, s[28:31], s65 offen offset:1024 sc1
    v_mfma_f32_16x16x32_bf16 v[194:197], a[44:47], a[224:227], v[194:197]
    ds_read_b64_tr_b16 a[218:219], v31 offset:38912
    v_add_f32 v230, v230, v94
    v_mfma_f32_16x16x32_bf16 v[246:249], a[40:43], a[228:231], v[246:249]
    ds_read_b64_tr_b16 a[220:221], v33 offset:36864
    buffer_load_dwordx4 a[104:107], v79, s[28:31], s65 offen offset:2048 sc1
    v_mfma_f32_16x16x32_bf16 v[250:253], a[44:47], a[228:231], v[250:253]
    ds_read_b64_tr_b16 a[222:223], v33 offset:38912
    v_add_f32 v231, v231, v94
    s_waitcnt vmcnt(13) lgkmcnt(8)
    v_mfma_f32_16x16x32_bf16 v[182:185], a[48:51], a[200:203], v[182:185]
    ds_read_b64_tr_b16 a[224:225], v32 offset:36864
    v_lshlrev_b32 v232, 16, v101
    v_mfma_f32_16x16x32_bf16 v[186:189], a[52:55], a[200:203], v[186:189]
    ds_read_b64_tr_b16 a[226:227], v32 offset:38912
    v_and_b32 v233, 0xffff0000, v101
    v_mfma_f32_16x16x32_bf16 v[238:241], a[48:51], a[204:207], v[238:241]
    ds_read_b64_tr_b16 a[228:229], v34 offset:36864
    buffer_load_dwordx4 a[108:111], v79, s[28:31], s65 offen offset:3072 sc1
    v_mfma_f32_16x16x32_bf16 v[242:245], a[52:55], a[204:207], v[242:245]
    ds_read_b64_tr_b16 a[230:231], v34 offset:38912
    s_waitcnt lgkmcnt(8)
    v_mfma_f32_16x16x32_bf16 v[190:193], a[48:51], a[208:211], v[190:193]
    ds_read_b64_tr_b16 a[200:201], v31 offset:49152
    v_add_f32 v232, v232, v94
    v_mfma_f32_16x16x32_bf16 v[194:197], a[52:55], a[208:211], v[194:197]
    ds_read_b64_tr_b16 a[202:203], v31 offset:51200
    buffer_load_dwordx4 v60, s[24:27], s64 offen offset:1024 lds
    v_add_f32 v233, v233, v94
    v_mfma_f32_16x16x32_bf16 v[246:249], a[48:51], a[212:215], v[246:249]
    ds_read_b64_tr_b16 a[204:205], v33 offset:49152
    v_lshlrev_b32 v234, 16, v102
    v_mfma_f32_16x16x32_bf16 v[250:253], a[52:55], a[212:215], v[250:253]
    ds_read_b64_tr_b16 a[206:207], v33 offset:51200
    s_waitcnt vmcnt(13) lgkmcnt(8)
    v_mfma_f32_16x16x32_bf16 v[182:185], a[56:59], a[216:219], v[182:185]
    ds_read_b64_tr_b16 a[208:209], v32 offset:49152
    buffer_load_dwordx4 v61, s[24:27], s64 offen offset:2048 lds
    v_mfma_f32_16x16x32_bf16 v[186:189], a[60:63], a[216:219], v[186:189]
    ds_read_b64_tr_b16 a[210:211], v32 offset:51200
    v_and_b32 v235, 0xffff0000, v102
    v_mfma_f32_16x16x32_bf16 v[238:241], a[56:59], a[220:223], v[238:241]
    ds_read_b64_tr_b16 a[212:213], v34 offset:49152
    buffer_load_dwordx4 v62, s[24:27], s64 offen offset:3072 lds
    v_mfma_f32_16x16x32_bf16 v[242:245], a[60:63], a[220:223], v[242:245]
    ds_read_b64_tr_b16 a[214:215], v34 offset:51200
    s_waitcnt lgkmcnt(8)
    v_mfma_f32_16x16x32_bf16 v[190:193], a[56:59], a[224:227], v[190:193]
    ds_read_b64_tr_b16 a[216:217], v31 offset:53248
    s_add_u32 m0, s58, 16384
    v_mfma_f32_16x16x32_bf16 v[194:197], a[60:63], a[224:227], v[194:197]
    ds_read_b64_tr_b16 a[218:219], v31 offset:55296
    s_add_u32 s64, s64, 524288
    v_add_f32 v234, v234, v94
    v_mfma_f32_16x16x32_bf16 v[246:249], a[56:59], a[228:231], v[246:249]
    ds_read_b64_tr_b16 a[220:221], v33 offset:53248
    s_cmp_eq_u32 s64, 3670016
    v_mfma_f32_16x16x32_bf16 v[250:253], a[60:63], a[228:231], v[250:253]
    ds_read_b64_tr_b16 a[222:223], v33 offset:55296
    s_cselect_b32 s64, 0, s64
    buffer_load_dwordx4 v59, s[24:27], s64 offen lds
    v_add_f32 v235, v235, v94
    s_waitcnt vmcnt(14) lgkmcnt(8)
    v_mfma_f32_16x16x32_bf16 v[182:185], a[64:67], a[200:203], v[182:185]
    ds_read_b64_tr_b16 a[224:225], v32 offset:53248
    v_lshlrev_b32 v236, 16, v103
    v_mfma_f32_16x16x32_bf16 v[186:189], a[68:71], a[200:203], v[186:189]
    ds_read_b64_tr_b16 a[226:227], v32 offset:55296
    buffer_load_dwordx4 v60, s[24:27], s64 offen offset:1024 lds
    v_and_b32 v237, 0xffff0000, v103
    v_mfma_f32_16x16x32_bf16 v[238:241], a[64:67], a[204:207], v[238:241]
    ds_read_b64_tr_b16 a[228:229], v34 offset:53248
    v_add_f32 v236, v236, v94
    v_mfma_f32_16x16x32_bf16 v[242:245], a[68:71], a[204:207], v[242:245]
    ds_read_b64_tr_b16 a[230:231], v34 offset:55296
    s_waitcnt lgkmcnt(8)
    v_mfma_f32_16x16x32_bf16 v[190:193], a[64:67], a[208:211], v[190:193]
    s_barrier
    ds_read_b64_tr_b16 a[200:201], v35 offset:32768
    buffer_load_dwordx4 v61, s[24:27], s64 offen offset:2048 lds
    v_mfma_f32_16x16x32_bf16 v[194:197], a[68:71], a[208:211], v[194:197]
    ds_read_b64_tr_b16 a[202:203], v35 offset:34816
    v_add_f32 v237, v237, v94
    v_mfma_f32_16x16x32_bf16 v[246:249], a[64:67], a[212:215], v[246:249]
    ds_read_b64_tr_b16 a[204:205], v37 offset:32768
    v_mfma_f32_16x16x32_bf16 v[250:253], a[68:71], a[212:215], v[250:253]
    ds_read_b64_tr_b16 a[206:207], v37 offset:34816
    s_waitcnt vmcnt(14) lgkmcnt(8)
    v_mfma_f32_16x16x32_bf16 v[182:185], a[72:75], a[216:219], v[182:185]
    ds_read_b64_tr_b16 a[208:209], v36 offset:32768
    buffer_load_dwordx4 v62, s[24:27], s64 offen offset:3072 lds
    v_mfma_f32_16x16x32_bf16 v[186:189], a[76:79], a[216:219], v[186:189]
    ds_read_b64_tr_b16 a[210:211], v36 offset:34816
    s_add_u32 m0, s58, 65536
    v_mfma_f32_16x16x32_bf16 v[238:241], a[72:75], a[220:223], v[238:241]
    ds_read_b64_tr_b16 a[212:213], v38 offset:32768
    s_add_u32 s64, s64, 524288
    v_mfma_f32_16x16x32_bf16 v[242:245], a[76:79], a[220:223], v[242:245]
    ds_read_b64_tr_b16 a[214:215], v38 offset:34816
    s_waitcnt lgkmcnt(8)
    v_mfma_f32_16x16x32_bf16 v[190:193], a[72:75], a[224:227], v[190:193]
    ds_read_b64_tr_b16 a[216:217], v35 offset:36864
    s_cmp_eq_u32 s64, 3670016
    v_mfma_f32_16x16x32_bf16 v[194:197], a[76:79], a[224:227], v[194:197]
    ds_read_b64_tr_b16 a[218:219], v35 offset:38912
    s_cselect_b32 s64, 0, s64
    buffer_load_dwordx4 v59, s[24:27], s64 offen lds
    v_mfma_f32_16x16x32_bf16 v[246:249], a[72:75], a[228:231], v[246:249]
    ds_read_b64_tr_b16 a[220:221], v37 offset:36864
    v_mfma_f32_16x16x32_bf16 v[250:253], a[76:79], a[228:231], v[250:253]
    ds_read_b64_tr_b16 a[222:223], v37 offset:38912
    s_waitcnt vmcnt(14) lgkmcnt(8)
    v_mfma_f32_16x16x32_bf16 v[182:185], a[80:83], a[200:203], v[182:185]
    ds_read_b64_tr_b16 a[224:225], v36 offset:36864
    buffer_load_dwordx4 v60, s[24:27], s64 offen offset:1024 lds
    v_mfma_f32_16x16x32_bf16 v[186:189], a[84:87], a[200:203], v[186:189]
    ds_read_b64_tr_b16 a[226:227], v36 offset:38912
    v_mfma_f32_16x16x32_bf16 v[238:241], a[80:83], a[204:207], v[238:241]
    ds_read_b64_tr_b16 a[228:229], v38 offset:36864
    v_mfma_f32_16x16x32_bf16 v[242:245], a[84:87], a[204:207], v[242:245]
    ds_read_b64_tr_b16 a[230:231], v38 offset:38912
    s_waitcnt lgkmcnt(8)
    v_mfma_f32_16x16x32_bf16 v[190:193], a[80:83], a[208:211], v[190:193]
    ds_read_b64_tr_b16 a[200:201], v35 offset:49152
    buffer_load_dwordx4 v61, s[24:27], s64 offen offset:2048 lds
    v_mfma_f32_16x16x32_bf16 v[194:197], a[84:87], a[208:211], v[194:197]
    ds_read_b64_tr_b16 a[202:203], v35 offset:51200
    v_mfma_f32_16x16x32_bf16 v[246:249], a[80:83], a[212:215], v[246:249]
    ds_read_b64_tr_b16 a[204:205], v37 offset:49152
    v_mfma_f32_16x16x32_bf16 v[250:253], a[84:87], a[212:215], v[250:253]
    ds_read_b64_tr_b16 a[206:207], v37 offset:51200
    s_waitcnt vmcnt(14) lgkmcnt(8)
    v_mfma_f32_16x16x32_bf16 v[182:185], a[88:91], a[216:219], v[182:185]
    ds_read_b64_tr_b16 a[208:209], v36 offset:49152
L_pad3:
    s_cbranch_execz L_warm
    buffer_load_dwordx4 v62, s[24:27], s64 offen offset:3072 lds
    v_mfma_f32_16x16x32_bf16 v[186:189], a[92:95], a[216:219], v[186:189]
    ds_read_b64_tr_b16 a[210:211], v36 offset:51200
    s_add_u32 m0, s58, 81920
    v_mfma_f32_16x16x32_bf16 v[238:241], a[88:91], a[220:223], v[238:241]
    ds_read_b64_tr_b16 a[212:213], v38 offset:49152
    s_add_u32 s64, s64, 524288
    v_mfma_f32_16x16x32_bf16 v[242:245], a[92:95], a[220:223], v[242:245]
    ds_read_b64_tr_b16 a[214:215], v38 offset:51200
    s_waitcnt lgkmcnt(8)
    v_mfma_f32_16x16x32_bf16 v[190:193], a[88:91], a[224:227], v[190:193]
    ds_read_b64_tr_b16 a[216:217], v35 offset:53248
    s_cmp_eq_u32 s64, 3670016
    s_cselect_b32 s64, 0, s64
    buffer_load_dwordx4 v59, s[24:27], s64 offen lds
    v_mfma_f32_16x16x32_bf16 v[194:197], a[92:95], a[224:227], v[194:197]
    ds_read_b64_tr_b16 a[218:219], v35 offset:55296
    v_mfma_f32_16x16x32_bf16 v[246:249], a[88:91], a[228:231], v[246:249]
    ds_read_b64_tr_b16 a[220:221], v37 offset:53248
    buffer_load_dwordx4 v60, s[24:27], s64 offen offset:1024 lds
    v_mfma_f32_16x16x32_bf16 v[250:253], a[92:95], a[228:231], v[250:253]
    ds_read_b64_tr_b16 a[222:223], v37 offset:55296
    s_waitcnt vmcnt(15) lgkmcnt(8)
    v_mfma_f32_16x16x32_bf16 v[182:185], a[96:99], a[200:203], v[182:185]
    ds_read_b64_tr_b16 a[224:225], v36 offset:53248
    v_mfma_f32_16x16x32_bf16 v[186:189], a[100:103], a[200:203], v[186:189]
    ds_read_b64_tr_b16 a[226:227], v36 offset:55296
    v_mfma_f32_16x16x32_bf16 v[238:241], a[96:99], a[204:207], v[238:241]
    ds_read_b64_tr_b16 a[228:229], v38 offset:53248
    buffer_load_dwordx4 v61, s[24:27], s64 offen offset:2048 lds
    v_mfma_f32_16x16x32_bf16 v[242:245], a[100:103], a[204:207], v[242:245]
    ds_read_b64_tr_b16 a[230:231], v38 offset:55296
    s_waitcnt lgkmcnt(8)
    v_mfma_f32_16x16x32_bf16 v[190:193], a[96:99], a[208:211], v[190:193]
    ds_read_b64_tr_b16 a[200:201], v31 offset:0
    v_mfma_f32_16x16x32_bf16 v[194:197], a[100:103], a[208:211], v[194:197]
    ds_read_b64_tr_b16 a[202:203], v31 offset:2048
    v_mfma_f32_16x16x32_bf16 v[246:249], a[96:99], a[212:215], v[246:249]
    ds_read_b64_tr_b16 a[204:205], v33 offset:0
    buffer_load_dwordx4 v62, s[24:27], s64 offen offset:3072 lds
    v_mfma_f32_16x16x32_bf16 v[250:253], a[100:103], a[212:215], v[250:253]
    ds_read_b64_tr_b16 a[206:207], v33 offset:2048
    s_waitcnt vmcnt(15) lgkmcnt(8)
    v_mfma_f32_16x16x32_bf16 v[182:185], a[104:107], a[216:219], v[182:185]
    ds_read_b64_tr_b16 a[208:209], v32 offset:0
    s_add_u32 m0, s58, 32768
    v_mfma_f32_16x16x32_bf16 v[186:189], a[108:111], a[216:219], v[186:189]
    ds_read_b64_tr_b16 a[210:211], v32 offset:2048
    s_add_u32 s64, s64, 524288
    v_mfma_f32_16x16x32_bf16 v[238:241], a[104:107], a[220:223], v[238:241]
    ds_read_b64_tr_b16 a[212:213], v34 offset:0
    s_cmp_eq_u32 s64, 3670016
    v_mfma_f32_16x16x32_bf16 v[242:245], a[108:111], a[220:223], v[242:245]
    ds_read_b64_tr_b16 a[214:215], v34 offset:2048
    s_cselect_b32 s64, 0, s64
    buffer_load_dwordx4 v59, s[24:27], s64 offen lds
    s_waitcnt lgkmcnt(8)
    v_mfma_f32_16x16x32_bf16 v[190:193], a[104:107], a[224:227], v[190:193]
    ds_read_b64_tr_b16 a[216:217], v31 offset:4096
    v_mfma_f32_16x16x32_bf16 v[194:197], a[108:111], a[224:227], v[194:197]
    ds_read_b64_tr_b16 a[218:219], v31 offset:6144
    buffer_load_dwordx4 v60, s[24:27], s64 offen offset:1024 lds
    v_mfma_f32_16x16x32_bf16 v[246:249], a[104:107], a[228:231], v[246:249]
    ds_read_b64_tr_b16 a[220:221], v33 offset:4096
    v_mfma_f32_16x16x32_bf16 v[250:253], a[108:111], a[228:231], v[250:253]
    ds_read_b64_tr_b16 a[222:223], v33 offset:6144
    s_waitcnt lgkmcnt(8)
    v_mfma_f32_16x16x32_bf16 v[150:153], a[0:3], a[200:203], 0
    ds_read_b64_tr_b16 a[224:225], v32 offset:4096
    v_mfma_f32_16x16x32_bf16 v[154:157], a[4:7], a[200:203], 0
    ds_read_b64_tr_b16 a[226:227], v32 offset:6144
    buffer_load_dwordx4 v61, s[24:27], s64 offen offset:2048 lds
    v_mfma_f32_16x16x32_bf16 v[166:169], a[0:3], a[204:207], 0
    ds_read_b64_tr_b16 a[228:229], v34 offset:4096
    v_cvt_pk_bf16_f32 v182, v182, v183
    v_mfma_f32_16x16x32_bf16 v[170:173], a[4:7], a[204:207], 0
    ds_read_b64_tr_b16 a[230:231], v34 offset:6144
    v_cvt_pk_bf16_f32 v183, v184, v185
    v_cvt_pk_bf16_f32 v184, v186, v187
    s_waitcnt lgkmcnt(8)
    v_mfma_f32_16x16x32_bf16 v[158:161], a[0:3], a[208:211], 0
    s_waitcnt vmcnt(15)
    s_barrier
    s_load_dword s14, s[28:29], s39
    ds_read_b64_tr_b16 a[200:201], v39 offset:0
    buffer_load_dwordx4 v62, s[24:27], s64 offen offset:3072 lds
    v_mfma_f32_16x16x32_bf16 v[162:165], a[4:7], a[208:211], 0
    ds_read_b64_tr_b16 a[202:203], v39 offset:2048
    s_add_u32 m0, s58, 49152
    v_cvt_pk_bf16_f32 v185, v188, v189
    buffer_store_dwordx4 v[182:185], v21, s[28:31], 0 offen offset:0 sc1
    v_cvt_pk_bf16_f32 v190, v190, v191
    v_cvt_pk_bf16_f32 v191, v192, v193
    v_cvt_pk_bf16_f32 v192, v194, v195
    v_mfma_f32_16x16x32_bf16 v[174:177], a[0:3], a[212:215], 0
    ds_read_b64_tr_b16 a[204:205], v41 offset:0
    s_add_u32 s66, s66, 1
    v_mfma_f32_16x16x32_bf16 v[178:181], a[4:7], a[212:215], 0
    ds_read_b64_tr_b16 a[206:207], v41 offset:2048
    v_cvt_pk_bf16_f32 v193, v196, v197
    buffer_store_dwordx4 v[190:193], v21, s[28:31], 0 offen offset:1024 sc1
    v_cvt_pk_bf16_f32 v238, v238, v239
    v_cvt_pk_bf16_f32 v239, v240, v241
    v_cvt_pk_bf16_f32 v240, v242, v243
    s_waitcnt lgkmcnt(8)
    v_mfma_f32_16x16x32_bf16 v[150:153], a[8:11], a[216:219], v[150:153]
    ds_read_b64_tr_b16 a[208:209], v40 offset:0
    s_and_b32 s66, s66, 3
    v_mfma_f32_16x16x32_bf16 v[154:157], a[12:15], a[216:219], v[154:157]
    ds_read_b64_tr_b16 a[210:211], v40 offset:2048
    s_mul_i32 s61, s66, 100352
    buffer_load_dwordx4 v63, s[16:19], s61 offen lds
    v_cvt_pk_bf16_f32 v241, v244, v245
    buffer_store_dwordx4 v[238:241], v21, s[28:31], 0 offen offset:2048 sc1
    v_cvt_pk_bf16_f32 v246, v246, v247
    v_cvt_pk_bf16_f32 v247, v248, v249
    v_cvt_pk_bf16_f32 v248, v250, v251
    v_mfma_f32_16x16x32_bf16 v[166:169], a[8:11], a[220:223], v[166:169]
    ds_read_b64_tr_b16 a[212:213], v42 offset:0
    v_cvt_pk_bf16_f32 v249, v252, v253
    v_mfma_f32_16x16x32_bf16 v[170:173], a[12:15], a[220:223], v[170:173]
    ds_read_b64_tr_b16 a[214:215], v42 offset:2048
    s_waitcnt lgkmcnt(8)
    v_mfma_f32_16x16x32_bf16 v[158:161], a[8:11], a[224:227], v[158:161]
    ds_read_b64_tr_b16 a[216:217], v39 offset:4096
    buffer_load_dwordx4 v64, s[16:19], s61 offen offset:1024 lds
    v_mfma_f32_16x16x32_bf16 v[162:165], a[12:15], a[224:227], v[162:165]
    ds_read_b64_tr_b16 a[218:219], v39 offset:6144
    s_add_u32 s61, s61, 48128
    buffer_store_dwordx4 v[246:249], v21, s[28:31], 0 offen offset:3072 sc1
    v_mfma_f32_16x16x32_bf16 v[174:177], a[8:11], a[228:231], v[174:177]
    ds_read_b64_tr_b16 a[220:221], v41 offset:4096
    v_mfma_f32_16x16x32_bf16 v[178:181], a[12:15], a[228:231], v[178:181]
    ds_read_b64_tr_b16 a[222:223], v41 offset:6144
    s_waitcnt lgkmcnt(8)
    v_mfma_f32_16x16x32_bf16 v[150:153], a[16:19], a[200:203], v[150:153]
    ds_read_b64_tr_b16 a[224:225], v40 offset:4096
    buffer_load_dwordx4 v63, s[16:19], s61 offen offset:2048 lds
    v_mfma_f32_16x16x32_bf16 v[154:157], a[20:23], a[200:203], v[154:157]
    ds_read_b64_tr_b16 a[226:227], v40 offset:6144
    v_mfma_f32_16x16x32_bf16 v[166:169], a[16:19], a[204:207], v[166:169]
    ds_read_b64_tr_b16 a[228:229], v42 offset:4096
    v_mfma_f32_16x16x32_bf16 v[170:173], a[20:23], a[204:207], v[170:173]
    ds_read_b64_tr_b16 a[230:231], v42 offset:6144
    s_waitcnt lgkmcnt(8)
    v_mfma_f32_16x16x32_bf16 v[158:161], a[16:19], a[208:211], v[158:161]
    ds_read_b64_tr_b16 a[200:201], v39 offset:16384
    buffer_load_dwordx4 v64, s[16:19], s61 offen offset:3072 lds
    v_mfma_f32_16x16x32_bf16 v[162:165], a[20:23], a[208:211], v[162:165]
    ds_read_b64_tr_b16 a[202:203], v39 offset:18432
    s_add_u32 m0, s58, 98304
    v_mfma_f32_16x16x32_bf16 v[174:177], a[16:19], a[212:215], v[174:177]
    ds_read_b64_tr_b16 a[204:205], v41 offset:16384
    s_add_u32 s66, s66, 1
    v_mfma_f32_16x16x32_bf16 v[178:181], a[20:23], a[212:215], v[178:181]
    ds_read_b64_tr_b16 a[206:207], v41 offset:18432
    s_waitcnt lgkmcnt(8)
    v_mfma_f32_16x16x32_bf16 v[150:153], a[24:27], a[216:219], v[150:153]
    ds_read_b64_tr_b16 a[208:209], v40 offset:16384
    s_and_b32 s66, s66, 3
    v_mfma_f32_16x16x32_bf16 v[154:157], a[28:31], a[216:219], v[154:157]
    ds_read_b64_tr_b16 a[210:211], v40 offset:18432
    s_mul_i32 s61, s66, 100352
    buffer_load_dwordx4 v63, s[16:19], s61 offen lds
    v_mfma_f32_16x16x32_bf16 v[166:169], a[24:27], a[220:223], v[166:169]
    ds_read_b64_tr_b16 a[212:213], v42 offset:16384
    v_mfma_f32_16x16x32_bf16 v[170:173], a[28:31], a[220:223], v[170:173]
    ds_read_b64_tr_b16 a[214:215], v42 offset:18432
    s_waitcnt lgkmcnt(8)
    v_mfma_f32_16x16x32_bf16 v[158:161], a[24:27], a[224:227], v[158:161]
    ds_read_b64_tr_b16 a[216:217], v39 offset:20480
    buffer_load_dwordx4 v64, s[16:19], s61 offen offset:1024 lds
    v_mfma_f32_16x16x32_bf16 v[162:165], a[28:31], a[224:227], v[162:165]
    ds_read_b64_tr_b16 a[218:219], v39 offset:22528
    s_add_u32 s61, s61, 48128
    v_mfma_f32_16x16x32_bf16 v[174:177], a[24:27], a[228:231], v[174:177]
    ds_read_b64_tr_b16 a[220:221], v41 offset:20480
    v_mfma_f32_16x16x32_bf16 v[178:181], a[28:31], a[228:231], v[178:181]
    ds_read_b64_tr_b16 a[222:223], v41 offset:22528
    s_waitcnt lgkmcnt(8)
    v_mfma_f32_16x16x32_bf16 v[150:153], a[32:35], a[200:203], v[150:153]
    ds_read_b64_tr_b16 a[224:225], v40 offset:20480
    buffer_load_dwordx4 v63, s[16:19], s61 offen offset:2048 lds
    v_mfma_f32_16x16x32_bf16 v[154:157], a[36:39], a[200:203], v[154:157]
    ds_read_b64_tr_b16 a[226:227], v40 offset:22528
    v_mfma_f32_16x16x32_bf16 v[166:169], a[32:35], a[204:207], v[166:169]
    ds_read_b64_tr_b16 a[228:229], v42 offset:20480
    v_mfma_f32_16x16x32_bf16 v[170:173], a[36:39], a[204:207], v[170:173]
    ds_read_b64_tr_b16 a[230:231], v42 offset:22528
    s_waitcnt lgkmcnt(8)
    v_mfma_f32_16x16x32_bf16 v[158:161], a[32:35], a[208:211], v[158:161]
    s_waitcnt vmcnt(19)
    s_barrier
    ds_read_b64_tr_b16 a[200:201], v31 offset:16384
    buffer_load_dwordx4 v64, s[16:19], s61 offen offset:3072 lds
    v_mfma_f32_16x16x32_bf16 v[162:165], a[36:39], a[208:211], v[162:165]
    ds_read_b64_tr_b16 a[202:203], v31 offset:18432
    s_add_u32 m0, s58, 114688
    v_mfma_f32_16x16x32_bf16 v[174:177], a[32:35], a[212:215], v[174:177]
    ds_read_b64_tr_b16 a[204:205], v33 offset:16384
    s_add_u32 s66, s66, 1
    v_mfma_f32_16x16x32_bf16 v[178:181], a[36:39], a[212:215], v[178:181]
    ds_read_b64_tr_b16 a[206:207], v33 offset:18432
    s_waitcnt lgkmcnt(8)
    v_mfma_f32_16x16x32_bf16 v[150:153], a[40:43], a[216:219], v[150:153]
    ds_read_b64_tr_b16 a[208:209], v32 offset:16384
    s_and_b32 s66, s66, 3
    s_mul_i32 s61, s66, 100352
    buffer_load_dwordx4 v63, s[16:19], s61 offen lds
    v_mfma_f32_16x16x32_bf16 v[154:157], a[44:47], a[216:219], v[154:157]
    ds_read_b64_tr_b16 a[210:211], v32 offset:18432
    v_mfma_f32_16x16x32_bf16 v[166:169], a[40:43], a[220:223], v[166:169]
    ds_read_b64_tr_b16 a[212:213], v34 offset:16384
    buffer_load_dwordx4 v64, s[16:19], s61 offen offset:1024 lds
    v_mfma_f32_16x16x32_bf16 v[170:173], a[44:47], a[220:223], v[170:173]
    ds_read_b64_tr_b16 a[214:215], v34 offset:18432
    s_waitcnt lgkmcnt(8)
    v_mfma_f32_16x16x32_bf16 v[158:161], a[40:43], a[224:227], v[158:161]
    ds_read_b64_tr_b16 a[216:217], v31 offset:20480
    s_add_u32 s61, s61, 48128
    v_mfma_f32_16x16x32_bf16 v[162:165], a[44:47], a[224:227], v[162:165]
    ds_read_b64_tr_b16 a[218:219], v31 offset:22528
    v_mfma_f32_16x16x32_bf16 v[174:177], a[40:43], a[228:231], v[174:177]
    ds_read_b64_tr_b16 a[220:221], v33 offset:20480
    buffer_load_dwordx4 v63, s[16:19], s61 offen offset:2048 lds
    v_mfma_f32_16x16x32_bf16 v[178:181], a[44:47], a[228:231], v[178:181]
    ds_read_b64_tr_b16 a[222:223], v33 offset:22528
    s_waitcnt lgkmcnt(8)
    v_mfma_f32_16x16x32_bf16 v[150:153], a[48:51], a[200:203], v[150:153]
    s_waitcnt lgkmcnt(0)
    s_cmp_ge_u32 s14, 8
    s_cbranch_scc0 L_pollin6
L_pollok6:
    ds_read_b64_tr_b16 a[224:225], v32 offset:20480
    v_mfma_f32_16x16x32_bf16 v[154:157], a[52:55], a[200:203], v[154:157]
    ds_read_b64_tr_b16 a[226:227], v32 offset:22528
    buffer_load_dwordx4 v64, s[16:19], s61 offen offset:3072 lds
    v_mfma_f32_16x16x32_bf16 v[166:169], a[48:51], a[204:207], v[166:169]
    ds_read_b64_tr_b16 a[228:229], v34 offset:20480
    s_add_u32 m0, s58, 0
    v_mfma_f32_16x16x32_bf16 v[170:173], a[52:55], a[204:207], v[170:173]
    ds_read_b64_tr_b16 a[230:231], v34 offset:22528
    v_mfma_f32_16x16x32_bf16 v[158:161], a[48:51], a[208:211], v[158:161]
    s_waitcnt vmcnt(10)
    s_atomic_add s36, s[28:29], s55
    ds_read_b64_tr_b16 a[200:201], v35 offset:0
    s_add_u32 s51, s51, 1
    v_mfma_f32_16x16x32_bf16 v[162:165], a[52:55], a[208:211], v[162:165]
    ds_read_b64_tr_b16 a[202:203], v35 offset:2048
    s_and_b32 s51, s51, 3
    v_mfma_f32_16x16x32_bf16 v[174:177], a[48:51], a[212:215], v[174:177]
    ds_read_b64_tr_b16 a[204:205], v37 offset:0
    s_lshl_b32 s61, s51, 12
    buffer_load_dwordx4 v65, s[28:31], s61 offen sc1 lds
    v_mfma_f32_16x16x32_bf16 v[178:181], a[52:55], a[212:215], v[178:181]
    ds_read_b64_tr_b16 a[206:207], v37 offset:2048
    v_mfma_f32_16x16x32_bf16 v[150:153], a[56:59], a[216:219], v[150:153]
    ds_read_b64_tr_b16 a[208:209], v36 offset:0
    buffer_load_dwordx4 v66, s[28:31], s61 offen offset:1024 sc1 lds
    v_mfma_f32_16x16x32_bf16 v[154:157], a[60:63], a[216:219], v[154:157]
    ds_read_b64_tr_b16 a[210:211], v36 offset:2048
    v_mfma_f32_16x16x32_bf16 v[166:169], a[56:59], a[220:223], v[166:169]
    ds_read_b64_tr_b16 a[212:213], v38 offset:0
    v_mfma_f32_16x16x32_bf16 v[170:173], a[60:63], a[220:223], v[170:173]
    ds_read_b64_tr_b16 a[214:215], v38 offset:2048
    s_waitcnt lgkmcnt(8)
    v_mfma_f32_16x16x32_bf16 v[158:161], a[56:59], a[224:227], v[158:161]
    ds_read_b64_tr_b16 a[216:217], v35 offset:4096
    buffer_load_dwordx4 v65, s[28:31], s61 offen offset:2048 sc1 lds
    v_mfma_f32_16x16x32_bf16 v[162:165], a[60:63], a[224:227], v[162:165]
    ds_read_b64_tr_b16 a[218:219], v35 offset:6144
    v_mfma_f32_16x16x32_bf16 v[174:177], a[56:59], a[228:231], v[174:177]
    ds_read_b64_tr_b16 a[220:221], v37 offset:4096
    buffer_load_dwordx4 v66, s[28:31], s61 offen offset:3072 sc1 lds
    v_mfma_f32_16x16x32_bf16 v[178:181], a[60:63], a[228:231], v[178:181]
    ds_read_b64_tr_b16 a[222:223], v37 offset:6144
    s_waitcnt lgkmcnt(8)
    v_mfma_f32_16x16x32_bf16 v[150:153], a[64:67], a[200:203], v[150:153]
    ds_read_b64_tr_b16 a[224:225], v36 offset:4096
    s_add_u32 m0, s58, 131072
    v_mfma_f32_16x16x32_bf16 v[154:157], a[68:71], a[200:203], v[154:157]
    ds_read_b64_tr_b16 a[226:227], v36 offset:6144
    s_add_u32 s51, s51, 1
    v_mfma_f32_16x16x32_bf16 v[166:169], a[64:67], a[204:207], v[166:169]
    ds_read_b64_tr_b16 a[228:229], v38 offset:4096
    s_and_b32 s51, s51, 3
    s_lshl_b32 s61, s51, 12
    buffer_load_dwordx4 v65, s[28:31], s61 offen sc1 lds
    v_mfma_f32_16x16x32_bf16 v[170:173], a[68:71], a[204:207], v[170:173]
    ds_read_b64_tr_b16 a[230:231], v38 offset:6144
    s_waitcnt lgkmcnt(8)
    v_mfma_f32_16x16x32_bf16 v[158:161], a[64:67], a[208:211], v[158:161]
    s_barrier
    ds_read_b64_tr_b16 a[200:201], v35 offset:16384
    buffer_load_dwordx4 v66, s[28:31], s61 offen offset:1024 sc1 lds
    v_mfma_f32_16x16x32_bf16 v[162:165], a[68:71], a[208:211], v[162:165]
    ds_read_b64_tr_b16 a[202:203], v35 offset:18432
    v_mfma_f32_16x16x32_bf16 v[174:177], a[64:67], a[212:215], v[174:177]
    ds_read_b64_tr_b16 a[204:205], v37 offset:16384
    buffer_load_dwordx4 v65, s[28:31], s61 offen offset:2048 sc1 lds
    v_mfma_f32_16x16x32_bf16 v[178:181], a[68:71], a[212:215], v[178:181]
    ds_read_b64_tr_b16 a[206:207], v37 offset:18432
    s_waitcnt lgkmcnt(8)
    v_mfma_f32_16x16x32_bf16 v[150:153], a[72:75], a[216:219], v[150:153]
    ds_read_b64_tr_b16 a[208:209], v36 offset:16384
    v_mfma_f32_16x16x32_bf16 v[154:157], a[76:79], a[216:219], v[154:157]
    ds_read_b64_tr_b16 a[210:211], v36 offset:18432
    buffer_load_dwordx4 v66, s[28:31], s61 offen offset:3072 sc1 lds
    v_mfma_f32_16x16x32_bf16 v[166:169], a[72:75], a[220:223], v[166:169]
    ds_read_b64_tr_b16 a[212:213], v38 offset:16384
    s_add_u32 m0, s58, 147456
    v_mfma_f32_16x16x32_bf16 v[170:173], a[76:79], a[220:223], v[170:173]
    ds_read_b64_tr_b16 a[214:215], v38 offset:18432
    s_waitcnt lgkmcnt(8)
    v_mfma_f32_16x16x32_bf16 v[158:161], a[72:75], a[224:227], v[158:161]
    ds_read_b64_tr_b16 a[216:217], v35 offset:20480
    s_add_u32 s51, s51, 1
    v_mfma_f32_16x16x32_bf16 v[162:165], a[76:79], a[224:227], v[162:165]
    ds_read_b64_tr_b16 a[218:219], v35 offset:22528
    s_and_b32 s51, s51, 3
    v_mfma_f32_16x16x32_bf16 v[174:177], a[72:75], a[228:231], v[174:177]
    ds_read_b64_tr_b16 a[220:221], v37 offset:20480
    s_lshl_b32 s61, s51, 12
    buffer_load_dwordx4 v65, s[28:31], s61 offen sc1 lds
    v_mfma_f32_16x16x32_bf16 v[178:181], a[76:79], a[228:231], v[178:181]
    ds_read_b64_tr_b16 a[222:223], v37 offset:22528
    s_waitcnt lgkmcnt(8)
    v_mfma_f32_16x16x32_bf16 v[150:153], a[80:83], a[200:203], v[150:153]
    ds_read_b64_tr_b16 a[224:225], v36 offset:20480
    buffer_load_dwordx4 v66, s[28:31], s61 offen offset:1024 sc1 lds
    v_mfma_f32_16x16x32_bf16 v[154:157], a[84:87], a[200:203], v[154:157]
    ds_read_b64_tr_b16 a[226:227], v36 offset:22528
    v_mfma_f32_16x16x32_bf16 v[166:169], a[80:83], a[204:207], v[166:169]
    ds_read_b64_tr_b16 a[228:229], v38 offset:20480
    v_mfma_f32_16x16x32_bf16 v[170:173], a[84:87], a[204:207], v[170:173]
    ds_read_b64_tr_b16 a[230:231], v38 offset:22528
    s_waitcnt lgkmcnt(8)
    v_mfma_f32_16x16x32_bf16 v[158:161], a[80:83], a[208:211], v[158:161]
    s_barrier
    ds_read_b64_tr_b16 a[200:201], v31 offset:32768
    buffer_load_dwordx4 v65, s[28:31], s61 offen offset:2048 sc1 lds
    v_mfma_f32_16x16x32_bf16 v[162:165], a[84:87], a[208:211], v[162:165]
    ds_read_b64_tr_b16 a[202:203], v31 offset:34816
    v_mfma_f32_16x16x32_bf16 v[174:177], a[80:83], a[212:215], v[174:177]
    ds_read_b64_tr_b16 a[204:205], v33 offset:32768
    buffer_load_dwordx4 v66, s[28:31], s61 offen offset:3072 sc1 lds
    v_mfma_f32_16x16x32_bf16 v[178:181], a[84:87], a[212:215], v[178:181]
    ds_read_b64_tr_b16 a[206:207], v33 offset:34816
    s_waitcnt lgkmcnt(8)
    v_mfma_f32_16x16x32_bf16 v[150:153], a[88:91], a[216:219], v[150:153]
    ds_read_b64_tr_b16 a[208:209], v32 offset:32768
    s_add_u32 m0, s58, 16384
    v_mfma_f32_16x16x32_bf16 v[154:157], a[92:95], a[216:219], v[154:157]
    ds_read_b64_tr_b16 a[210:211], v32 offset:34816
    s_add_u32 s66, s66, 1
    v_mfma_f32_16x16x32_bf16 v[166:169], a[88:91], a[220:223], v[166:169]
    ds_read_b64_tr_b16 a[212:213], v34 offset:32768
    s_and_b32 s66, s66, 3
    s_mul_i32 s61, s66, 100352
    buffer_load_dwordx4 v63, s[16:19], s61 offen lds
    v_mfma_f32_16x16x32_bf16 v[170:173], a[92:95], a[220:223], v[170:173]
    ds_read_b64_tr_b16 a[214:215], v34 offset:34816
    s_waitcnt lgkmcnt(8)
    v_mfma_f32_16x16x32_bf16 v[158:161], a[88:91], a[224:227], v[158:161]
    ds_read_b64_tr_b16 a[216:217], v31 offset:36864
    buffer_load_dwordx4 v64, s[16:19], s61 offen offset:1024 lds
    v_mfma_f32_16x16x32_bf16 v[162:165], a[92:95], a[224:227], v[162:165]
    ds_read_b64_tr_b16 a[218:219], v31 offset:38912
    s_add_u32 s61, s61, 48128
    v_mfma_f32_16x16x32_bf16 v[174:177], a[88:91], a[228:231], v[174:177]
    ds_read_b64_tr_b16 a[220:221], v33 offset:36864
    v_mfma_f32_16x16x32_bf16 v[178:181], a[92:95], a[228:231], v[178:181]
    ds_read_b64_tr_b16 a[222:223], v33 offset:38912
    s_waitcnt lgkmcnt(8)
    v_mfma_f32_16x16x32_bf16 v[150:153], a[96:99], a[200:203], v[150:153]
    ds_read_b64_tr_b16 a[224:225], v32 offset:36864
    buffer_load_dwordx4 v63, s[16:19], s61 offen offset:2048 lds
    v_mfma_f32_16x16x32_bf16 v[154:157], a[100:103], a[200:203], v[154:157]
    ds_read_b64_tr_b16 a[226:227], v32 offset:38912
    v_mfma_f32_16x16x32_bf16 v[166:169], a[96:99], a[204:207], v[166:169]
    ds_read_b64_tr_b16 a[228:229], v34 offset:36864
    buffer_load_dwordx4 v64, s[16:19], s61 offen offset:3072 lds
    v_mfma_f32_16x16x32_bf16 v[170:173], a[100:103], a[204:207], v[170:173]
    ds_read_b64_tr_b16 a[230:231], v34 offset:38912
    s_waitcnt lgkmcnt(8)
    v_mfma_f32_16x16x32_bf16 v[158:161], a[96:99], a[208:211], v[158:161]
    s_waitcnt vmcnt(12)
    s_barrier
    s_xor_b32 s55, s55, 1024
    s_load_dword s14, s[28:29], s55
    ds_read_b64_tr_b16 v[198:199], v43 offset:49152
    ds_read_b64_tr_b16 v[200:201], v43 offset:53248
    v_mfma_f32_16x16x32_bf16 v[162:165], a[100:103], a[208:211], v[162:165]
    ds_read_b64_tr_b16 v[202:203], v44 offset:49152
    s_add_u32 m0, s58, 65536
    s_add_u32 s51, s51, 1
    s_and_b32 s51, s51, 3
    s_lshl_b32 s61, s51, 12
    buffer_load_dwordx4 v65, s[28:31], s61 offen sc1 lds
    v_mfma_f32_16x16x32_bf16 v[174:177], a[96:99], a[212:215], v[174:177]
    ds_read_b64_tr_b16 v[204:205], v44 offset:53248
    v_mfma_f32_16x16x32_bf16 v[178:181], a[100:103], a[212:215], v[178:181]
    ds_read_b128 a[200:203], v47 offset:0
    s_waitcnt lgkmcnt(9)
    v_mfma_f32_16x16x32_bf16 v[150:153], a[104:107], a[216:219], v[150:153]
    ds_read_b128 a[204:207], v48 offset:0
    buffer_load_dwordx4 v66, s[28:31], s61 offen offset:1024 sc1 lds
    v_mfma_f32_16x16x32_bf16 v[154:157], a[108:111], a[216:219], v[154:157]
    ds_read_b128 a[208:211], v47 offset:1024
    v_mfma_f32_16x16x32_bf16 v[166:169], a[104:107], a[220:223], v[166:169]
    ds_read_b128 a[212:215], v48 offset:1024
    buffer_load_dwordx4 v65, s[28:31], s61 offen offset:2048 sc1 lds
    v_mfma_f32_16x16x32_bf16 v[170:173], a[108:111], a[220:223], v[170:173]
    s_waitcnt lgkmcnt(8)
    v_mfma_f32_16x16x32_bf16 v[158:161], a[104:107], a[224:227], v[158:161]
    ds_read_b64_tr_b16 v[206:207], v43 offset:51200
    ds_read_b64_tr_b16 v[208:209], v43 offset:55296
    v_mfma_f32_16x16x32_bf16 v[162:165], a[108:111], a[224:227], v[162:165]
    ds_read_b64_tr_b16 v[210:211], v44 offset:51200
    buffer_load_dwordx4 v66, s[28:31], s61 offen offset:3072 sc1 lds
    v_mfma_f32_16x16x32_bf16 v[174:177], a[104:107], a[228:231], v[174:177]
    ds_read_b64_tr_b16 v[212:213], v44 offset:55296
    v_mfma_f32_16x16x32_bf16 v[178:181], a[108:111], a[228:231], v[178:181]
    ds_read_b128 a[216:219], v47 offset:2048
    s_waitcnt lgkmcnt(7)
    v_mfma_f32_16x16x32_bf16 v[150:153], v[198:201], a[200:203], v[150:153]
    ds_read_b128 a[220:223], v48 offset:2048
    v_mfma_f32_16x16x32_bf16 v[154:157], v[202:205], a[200:203], v[154:157]
    ds_read_b128 a[224:227], v47 offset:3072
    v_mfma_f32_16x16x32_bf16 v[166:169], v[198:201], a[204:207], v[166:169]
    ds_read_b128 a[228:231], v48 offset:3072
    v_mfma_f32_16x16x32_bf16 v[170:173], v[202:205], a[204:207], v[170:173]
    s_waitcnt lgkmcnt(8)
    v_mfma_f32_16x16x32_bf16 v[158:161], v[198:201], a[208:211], v[158:161]
    s_waitcnt vmcnt(12)
    s_barrier
    ds_read_b64_tr_b16 v[214:215], v45 offset:32768
    ds_read_b64_tr_b16 v[216:217], v45 offset:36864
    v_mfma_f32_16x16x32_bf16 v[162:165], v[202:205], a[208:211], v[162:165]
    ds_read_b64_tr_b16 v[218:219], v46 offset:32768
    v_mfma_f32_16x16x32_bf16 v[174:177], v[198:201], a[212:215], v[174:177]
    ds_read_b64_tr_b16 v[220:221], v46 offset:36864
    v_mfma_f32_16x16x32_bf16 v[178:181], v[202:205], a[212:215], v[178:181]
    ds_read_b128 a[200:203], v51 offset:0
    s_waitcnt lgkmcnt(7)
    v_mfma_f32_16x16x32_bf16 v[150:153], v[206:209], a[216:219], v[150:153]
    ds_read_b128 a[204:207], v52 offset:0
    v_mfma_f32_16x16x32_bf16 v[154:157], v[210:213], a[216:219], v[154:157]
    ds_read_b128 a[208:211], v51 offset:1024
    v_mfma_f32_16x16x32_bf16 v[166:169], v[206:209], a[220:223], v[166:169]
    ds_read_b128 a[212:215], v52 offset:1024
    v_mfma_f32_16x16x32_bf16 v[170:173], v[210:213], a[220:223], v[170:173]
    s_waitcnt lgkmcnt(8)
    v_mfma_f32_16x16x32_bf16 v[158:161], v[206:209], a[224:227], v[158:161]
    s_waitcnt lgkmcnt(0)
    s_cmp_ge_u32 s14, 1
    s_cbranch_scc0 L_pollin7
L_pollok7:
    v_xor_b32 v21, 131072, v21
    ds_read_b64_tr_b16 v[198:199], v45 offset:34816
    ds_read_b64_tr_b16 v[200:201], v45 offset:38912
    buffer_load_dwordx4 v[246:249], v21, s[28:31], 0 offen offset:2048 sc1
    v_mfma_f32_16x16x32_bf16 v[162:165], v[210:213], a[224:227], v[162:165]
    ds_read_b64_tr_b16 v[202:203], v46 offset:34816
    buffer_load_dwordx4 v[250:253], v21, s[28:31], 0 offen offset:3072 sc1
    v_mfma_f32_16x16x32_bf16 v[174:177], v[206:209], a[228:231], v[174:177]
    ds_read_b64_tr_b16 v[204:205], v46 offset:38912
    v_mfma_f32_16x16x32_bf16 v[178:181], v[210:213], a[228:231], v[178:181]
    ds_read_b128 a[216:219], v51 offset:2048
    v_mfma_f32_16x16x32_bf16 v[150:153], v[214:217], a[200:203], v[150:153]
    ds_read_b128 a[220:223], v52 offset:2048
    buffer_load_dwordx4 v[238:241], v21, s[28:31], 0 offen offset:0 sc1
    v_mfma_f32_16x16x32_bf16 v[154:157], v[218:221], a[200:203], v[154:157]
    ds_read_b128 a[224:227], v51 offset:3072
    buffer_load_dwordx4 v[242:245], v21, s[28:31], 0 offen offset:1024 sc1
    v_mfma_f32_16x16x32_bf16 v[166:169], v[214:217], a[204:207], v[166:169]
    ds_read_b128 a[228:231], v52 offset:3072
    v_mfma_f32_16x16x32_bf16 v[170:173], v[218:221], a[204:207], v[170:173]
    v_mfma_f32_16x16x32_bf16 v[158:161], v[214:217], a[208:211], v[158:161]
    s_waitcnt vmcnt(12)
    s_barrier
    ds_read_b64_tr_b16 v[206:207], v45 offset:49152
    ds_read_b64_tr_b16 v[208:209], v45 offset:53248
    v_mfma_f32_16x16x32_bf16 v[162:165], v[218:221], a[208:211], v[162:165]
    ds_read_b64_tr_b16 v[210:211], v46 offset:49152
    v_mfma_f32_16x16x32_bf16 v[174:177], v[214:217], a[212:215], v[174:177]
    ds_read_b64_tr_b16 v[212:213], v46 offset:53248
    v_mfma_f32_16x16x32_bf16 v[178:181], v[218:221], a[212:215], v[178:181]
    ds_read_b128 a[200:203], v51 offset:16384
    s_waitcnt lgkmcnt(7)
    v_mfma_f32_16x16x32_bf16 v[150:153], v[198:201], a[216:219], v[150:153]
    ds_read_b128 a[204:207], v52 offset:16384
    v_mfma_f32_16x16x32_bf16 v[154:157], v[202:205], a[216:219], v[154:157]
    ds_read_b128 a[208:211], v51 offset:17408
    v_mfma_f32_16x16x32_bf16 v[166:169], v[198:201], a[220:223], v[166:169]
    ds_read_b128 a[212:215], v52 offset:17408
    v_mfma_f32_16x16x32_bf16 v[170:173], v[202:205], a[220:223], v[170:173]
    s_waitcnt lgkmcnt(8)
    v_mfma_f32_16x16x32_bf16 v[158:161], v[198:201], a[224:227], v[158:161]
    ds_read_b64_tr_b16 v[214:215], v45 offset:51200
    ds_read_b64_tr_b16 v[216:217], v45 offset:55296
    v_mfma_f32_16x16x32_bf16 v[162:165], v[202:205], a[224:227], v[162:165]
    ds_read_b64_tr_b16 v[218:219], v46 offset:51200
    v_mfma_f32_16x16x32_bf16 v[174:177], v[198:201], a[228:231], v[174:177]
    ds_read_b64_tr_b16 v[220:221], v46 offset:55296
    v_mfma_f32_16x16x32_bf16 v[178:181], v[202:205], a[228:231], v[178:181]
    ds_read_b128 a[216:219], v51 offset:18432
    s_waitcnt lgkmcnt(7)
    v_mfma_f32_16x16x32_bf16 v[150:153], v[206:209], a[200:203], v[150:153]
    ds_read_b128 a[220:223], v52 offset:18432
    v_mfma_f32_16x16x32_bf16 v[154:157], v[210:213], a[200:203], v[154:157]
    ds_read_b128 a[224:227], v51 offset:19456
    v_mfma_f32_16x16x32_bf16 v[166:169], v[206:209], a[204:207], v[166:169]
    ds_read_b128 a[228:231], v52 offset:19456
    v_mfma_f32_16x16x32_bf16 v[170:173], v[210:213], a[204:207], v[170:173]
    s_waitcnt lgkmcnt(8)
    v_mfma_f32_16x16x32_bf16 v[158:161], v[206:209], a[208:211], v[158:161]
    s_waitcnt vmcnt(4)
    s_barrier
    ds_read_b64_tr_b16 v[198:199], v43 offset:16384
    ds_read_b64_tr_b16 v[200:201], v43 offset:20480
    v_mfma_f32_16x16x32_bf16 v[162:165], v[210:213], a[208:211], v[162:165]
    ds_read_b64_tr_b16 v[202:203], v44 offset:16384
    v_mfma_f32_16x16x32_bf16 v[174:177], v[206:209], a[212:215], v[174:177]
    ds_read_b64_tr_b16 v[204:205], v44 offset:20480
    v_mfma_f32_16x16x32_bf16 v[178:181], v[210:213], a[212:215], v[178:181]
    ds_read_b128 a[200:203], v50 offset:0
    s_waitcnt lgkmcnt(7)
    v_mfma_f32_16x16x32_bf16 v[150:153], v[214:217], a[216:219], v[150:153]
    ds_read_b128 a[204:207], v50 offset:1024
    ds_read_b64_tr_b16 v[206:207], v43 offset:18432
    v_mfma_f32_16x16x32_bf16 v[154:157], v[218:221], a[216:219], v[154:157]
    ds_read_b64_tr_b16 v[208:209], v43 offset:22528
    ds_read_b64_tr_b16 v[210:211], v44 offset:18432
    v_mfma_f32_16x16x32_bf16 v[166:169], v[214:217], a[220:223], v[166:169]
    ds_read_b64_tr_b16 v[212:213], v44 offset:22528
    v_mfma_f32_16x16x32_bf16 v[170:173], v[218:221], a[220:223], v[170:173]
    ds_read_b128 a[208:211], v50 offset:2048
    s_waitcnt lgkmcnt(11)
    v_mfma_f32_16x16x32_bf16 v[158:161], v[214:217], a[224:227], v[158:161]
    ds_read_b128 a[212:215], v50 offset:3072
    v_mfma_f32_16x16x32_bf16 v[162:165], v[218:221], a[224:227], v[162:165]
    v_mfma_f32_16x16x32_bf16 v[174:177], v[214:217], a[228:231], v[174:177]
    v_mfma_f32_16x16x32_bf16 v[178:181], v[218:221], a[228:231], v[178:181]
    s_waitcnt lgkmcnt(6)
    v_mfma_f32_16x16x32_bf16 v[166:169], v[198:201], a[200:203], v[166:169]
    ds_read_b128 a[224:227], v49 offset:0
    v_mfma_f32_16x16x32_bf16 v[170:173], v[202:205], a[200:203], v[170:173]
    v_mfma_f32_16x16x32_bf16 v[174:177], v[198:201], a[204:207], v[174:177]
    ds_read_b128 a[228:231], v49 offset:1024
    v_mfma_f32_16x16x32_bf16 v[178:181], v[202:205], a[204:207], v[178:181]
    s_waitcnt lgkmcnt(2)
    v_mfma_f32_16x16x32_bf16 v[166:169], v[206:209], a[208:211], v[166:169]
    ds_read_b128 a[200:203], v49 offset:2048
    v_mfma_f32_16x16x32_bf16 v[170:173], v[210:213], a[208:211], v[170:173]
    v_mfma_f32_16x16x32_bf16 v[174:177], v[206:209], a[212:215], v[174:177]
    ds_read_b128 a[204:207], v49 offset:3072
L_pad4:
    s_cbranch_execz L_warm
    v_mfma_f32_16x16x32_bf16 v[178:181], v[210:213], a[212:215], v[178:181]
    s_waitcnt vmcnt(3)
    v_mfma_f32_16x16x32_bf16 v[166:169], a[250:253], v[246:249], v[166:169]
    v_mfma_f32_16x16x32_bf16 v[170:173], a[248:251], v[246:249], v[170:173]
    s_waitcnt vmcnt(2)
    v_mfma_f32_16x16x32_bf16 v[174:177], a[250:253], v[250:253], v[174:177]
    v_mfma_f32_16x16x32_bf16 v[178:181], a[248:251], v[250:253], v[178:181]
    s_waitcnt lgkmcnt(2)
    v_mfma_f32_16x16x32_bf16 v[150:153], v[198:201], a[224:227], v[150:153]
    v_mfma_f32_16x16x32_bf16 v[154:157], v[202:205], a[224:227], v[154:157]
    v_mfma_f32_16x16x32_bf16 v[158:161], v[198:201], a[228:231], v[158:161]
    ds_write_b128 v87, v[166:169] offset:8192
    v_mfma_f32_16x16x32_bf16 v[162:165], v[202:205], a[228:231], v[162:165]
    s_waitcnt lgkmcnt(1)
    v_mfma_f32_16x16x32_bf16 v[150:153], v[206:209], a[200:203], v[150:153]
    ds_write_b128 v88, v[170:173] offset:8192
    v_mfma_f32_16x16x32_bf16 v[154:157], v[210:213], a[200:203], v[154:157]
    v_mfma_f32_16x16x32_bf16 v[158:161], v[206:209], a[204:207], v[158:161]
    ds_write_b128 v87, v[174:177] offset:12288
    v_mfma_f32_16x16x32_bf16 v[162:165], v[210:213], a[204:207], v[162:165]
    s_waitcnt vmcnt(1)
    v_mfma_f32_16x16x32_bf16 v[150:153], a[250:253], v[238:241], v[150:153]
    ds_write_b128 v88, v[178:181] offset:12288
    v_mfma_f32_16x16x32_bf16 v[154:157], a[248:251], v[238:241], v[154:157]
    s_waitcnt vmcnt(0)
    v_mfma_f32_16x16x32_bf16 v[158:161], a[250:253], v[242:245], v[158:161]
    v_mfma_f32_16x16x32_bf16 v[162:165], a[248:251], v[242:245], v[162:165]
    s_nop 2
    ds_write_b128 v87, v[150:153] offset:0
    s_nop 0
    ds_write_b128 v88, v[154:157] offset:0
    s_nop 0
    ds_write_b128 v87, v[158:161] offset:4096
    ds_write_b128 v88, v[162:165] offset:4096
    s_waitcnt lgkmcnt(0)
    s_barrier
    ds_read_b128 v[118:121], v89 offset:0
    ds_read_b128 v[122:125], v90 offset:0
    ds_read_b128 v[126:129], v91 offset:0
    ds_read_b128 v[130:133], v92 offset:0
    ds_read_b128 v[134:137], v89 offset:2048
    ds_read_b128 v[138:141], v90 offset:2048
    ds_read_b128 v[142:145], v91 offset:2048
    ds_read_b128 v[146:149], v92 offset:2048
    s_waitcnt lgkmcnt(7)
    v_pk_add_f32 v[222:223], v[222:223], v[118:119]
    v_pk_add_f32 v[224:225], v[224:225], v[120:121]
    s_waitcnt lgkmcnt(6)
    v_pk_add_f32 v[226:227], v[226:227], v[122:123]
    v_pk_add_f32 v[228:229], v[228:229], v[124:125]
    s_waitcnt lgkmcnt(5)
    v_pk_add_f32 v[222:223], v[222:223], v[126:127]
    v_pk_add_f32 v[224:225], v[224:225], v[128:129]
    s_waitcnt lgkmcnt(4)
    v_pk_add_f32 v[226:227], v[226:227], v[130:131]
    v_pk_add_f32 v[228:229], v[228:229], v[132:133]
    v_cvt_pk_bf16_f32 v110, v222, v223
    v_cvt_pk_bf16_f32 v111, v224, v225
    v_cvt_pk_bf16_f32 v112, v226, v227
    v_cvt_pk_bf16_f32 v113, v228, v229
    buffer_store_dwordx4 v[110:113], v85, s[32:35], 0 offen
    s_waitcnt lgkmcnt(3)
    v_pk_add_f32 v[230:231], v[230:231], v[134:135]
    v_pk_add_f32 v[232:233], v[232:233], v[136:137]
    s_waitcnt lgkmcnt(2)
    v_pk_add_f32 v[234:235], v[234:235], v[138:139]
    v_pk_add_f32 v[236:237], v[236:237], v[140:141]
    s_waitcnt lgkmcnt(1)
    v_pk_add_f32 v[230:231], v[230:231], v[142:143]
    v_pk_add_f32 v[232:233], v[232:233], v[144:145]
    s_waitcnt lgkmcnt(0)
    v_pk_add_f32 v[234:235], v[234:235], v[146:147]
    v_pk_add_f32 v[236:237], v[236:237], v[148:149]
    v_cvt_pk_bf16_f32 v114, v230, v231
    v_cvt_pk_bf16_f32 v115, v232, v233
    v_cvt_pk_bf16_f32 v116, v234, v235
    v_cvt_pk_bf16_f32 v117, v236, v237
    buffer_store_dwordx4 v[114:117], v86, s[32:35], 0 offen
L_fin:
L_end:
    s_endpgm
L_nonce:
    buffer_load_dword v12, v16, s[44:47], 0 offen sc1
    s_add_u32 s60, s60, 1
    s_waitcnt vmcnt(0)
    v_readfirstlane_b32 s57, v12
    s_cmp_ge_u32 s60, 20000
    s_cbranch_scc1 L_nonce_ok
    s_cmp_eq_u32 s57, 0
    s_cbranch_scc1 L_nonce
    s_branch L_nonce_ok
L_pollin0:
    s_mov_b32 s60, 0
L_poll0:
    s_sleep 4
    buffer_load_dword v18, v20, s[28:31], 0 offen sc1
    s_add_u32 s60, s60, 1
    s_waitcnt vmcnt(0)
    v_cmp_ne_u32 vcc, s57, v18
    s_cbranch_vccz L_pollok0
    s_cmp_lt_u32 s60, 20000
    s_cbranch_scc1 L_poll0
    s_branch L_pollok0
L_pollin1:
    s_mov_b32 s60, 0
L_poll1:
    s_sleep 8
    buffer_load_dword v18, off, s[44:47], s15 sc1
    s_add_u32 s60, s60, 1
    s_waitcnt vmcnt(0)
    v_readfirstlane_b32 s14, v18
    s_nop 0
    s_cmp_ge_u32 s14, 14
    s_cbranch_scc1 L_pollok1
    s_cmp_lt_u32 s60, 20000
    s_cbranch_scc1 L_poll1
    s_branch L_pollok1
L_pollin2:
    s_mov_b32 s60, 0
L_poll2:
    s_sleep 4
    buffer_load_dword v18, off, s[28:31], s37 sc1
    s_add_u32 s60, s60, 1
    s_waitcnt vmcnt(0)
    v_readfirstlane_b32 s14, v18
    s_nop 0
    s_cmp_ge_u32 s14, 2
    s_cbranch_scc1 L_pollok2
    s_cmp_lt_u32 s60, 20000
    s_cbranch_scc1 L_poll2
    s_branch L_pollok2
L_nonceh:
    buffer_load_dword v12, v16, s[44:47], 0 offen sc1
    s_add_u32 s60, s60, 1
    s_waitcnt vmcnt(0)
    v_readfirstlane_b32 s57, v12
    s_cmp_ge_u32 s60, 20000
    s_cbranch_scc1 L_nonce_okh
    s_cmp_eq_u32 s57, 0
    s_cbranch_scc1 L_nonceh
    s_branch L_nonce_okh
L_pollin3:
    s_mov_b32 s60, 0
L_poll3:
    s_sleep 8
    buffer_load_dword v18, v20, s[28:31], 0 offen sc1
    s_add_u32 s60, s60, 1
    s_waitcnt vmcnt(0)
    v_cmp_ne_u32 vcc, s57, v18
    s_cbranch_vccz L_pollok3
    s_cmp_lt_u32 s60, 20000
    s_cbranch_scc1 L_poll3
    s_branch L_pollok3
L_pollin4:
    s_mov_b32 s60, 0
L_poll4:
    s_sleep 16
    buffer_load_dword v18, off, s[44:47], s15 sc1
    s_add_u32 s60, s60, 1
    s_waitcnt vmcnt(0)
    v_readfirstlane_b32 s14, v18
    s_nop 0
    s_cmp_ge_u32 s14, 14
    s_cbranch_scc1 L_pollok4
    s_cmp_lt_u32 s60, 20000
    s_cbranch_scc1 L_poll4
    s_branch L_pollok4
L_nog1:
    s_nop 1
    s_mov_b32 s14, 1204224
    s_mov_b32 s15, 0x20000
    s_sub_u32 s3, s2, 200
    s_cmp_lt_u32 s3, 42
    s_cselect_b32 s81, 0, 268435456
    s_cselect_b32 s3, s3, 0
    s_mul_i32 s79, s3, 43
    s_lshr_b32 s79, s79, 7
    s_mul_i32 s80, s79, 3
    s_sub_u32 s80, s3, s80
    v_min_u32 v13, 55, v1
    s_lshl_b32 s3, s79, 2
    s_add_u32 s3, s3, s48
    s_mul_i32 s3, s3, 21504
    s_mul_i32 s60, s80, 896
    s_add_u32 s3, s3, s60
    s_add_u32 s3, s3, s81
    v_lshl_add_u32 v242, v13, 4, s3
    s_mul_i32 s60, s48, 8448
    s_add_u32 m0, s60, 0
    s_mov_b32 s3, 0
    buffer_load_dwordx4 v242, s[12:15], s3 offen lds
    s_add_u32 m0, s60, 1056
    s_mov_b32 s3, 2688
    buffer_load_dwordx4 v242, s[12:15], s3 offen lds
    s_add_u32 m0, s60, 2112
    s_mov_b32 s3, 5376
    buffer_load_dwordx4 v242, s[12:15], s3 offen lds
    s_add_u32 m0, s60, 3168
    s_mov_b32 s3, 8064
    buffer_load_dwordx4 v242, s[12:15], s3 offen lds
    s_add_u32 m0, s60, 4224
    s_mov_b32 s3, 10752
    buffer_load_dwordx4 v242, s[12:15], s3 offen lds
    s_add_u32 m0, s60, 5280
    s_mov_b32 s3, 13440
    buffer_load_dwordx4 v242, s[12:15], s3 offen lds
    s_add_u32 m0, s60, 6336
    s_mov_b32 s3, 16128
    buffer_load_dwordx4 v242, s[12:15], s3 offen lds
    s_add_u32 m0, s60, 7392
    s_mov_b32 s3, 18816
    buffer_load_dwordx4 v242, s[12:15], s3 offen lds
    s_mul_i32 s53, s101, 37
    s_lshr_b32 s53, s53, 8
    s_mul_i32 s54, s53, 7
    s_sub_u32 s54, s101, s54
    s_and_b32 s53, s53, 3
    s_lshl_b32 s3, s6, 2
    s_add_u32 s53, s53, s3
    s_lshl_b32 s53, s53, 1
    s_add_u32 s53, s53, s7
    s_mov_b32 s42, 4096
    s_mov_b32 s43, 0x20000
    s_lshl_b32 s3, s53, 2
    s_add_u32 s3, s3, s48
    s_lshl_b32 s60, s3, 5
    v_lshl_add_u32 v82, v5, 1, s60
    s_mul_i32 s3, s3, 14336
    s_lshl_b32 s60, s54, 7
    s_add_u32 s3, s3, s60
    v_mul_u32_u24 v14, 896, v5
    v_lshl_add_u32 v14, v6, 4, v14
    v_add_u32 v85, s3, v14
    v_add_u32 v86, 7168, v85
    s_cmp_lt_u32 s101, 28
    s_cselect_b32 s56, 1, 0
    s_lshl_b32 s50, s7, 3
    s_and_b32 s3, s101, 7
    s_add_u32 s50, s50, s3
    s_lshr_b32 s60, s101, 3
    s_lshl_b32 s49, s6, 2
    s_add_u32 s49, s49, s60
    s_lshl_b32 s49, s49, 2
    s_add_u32 s49, s49, s48
    s_mul_i32 s60, s60, 0
    s_add_u32 s3, s3, s60
    s_sub_u32 s60, s3, 7
    s_cmp_ge_u32 s3, 7
    s_cselect_b32 s3, s60, s3
    s_lshl_b32 s62, s3, 18
    s_mul_i32 s63, s3, 12288
    s_mov_b32 s30, 20971520
    s_mov_b32 s31, 0x20000
    s_mov_b32 s75, 0x3727c5ac
    s_mov_b32 s76, 0x3b124925
    s_mov_b32 s77, 0x3f803f80
    v_lshlrev_b32 v4, 4, v1
    v_bfe_u32 v7, v1, 2, 2
    v_and_b32 v8, 3, v1
    v_mul_u32_u24 v13, 960, v9
    v_lshl_add_u32 v13, v10, 4, v13
    s_mul_i32 s3, s48, 1920
    s_add_u32 s3, s3, 147456
    v_add_u32 v230, s3, v13
    v_mul_u32_u24 v13, 960, v7
    v_lshl_add_u32 v13, v3, 5, v13
    v_lshl_add_u32 v13, v8, 3, v13
    s_lshl_b32 s3, s48, 8
    s_add_u32 s3, s3, 147456
    v_add_u32 v231, s3, v13
    s_lshl_b32 s3, s48, 3
    s_add_u32 s3, s3, 155648
    v_lshl_add_u32 v232, v9, 2, s3
    v_lshlrev_b32 v237, 2, v6
    v_and_b32 v2, 15, v1
    v_lshlrev_b32 v238, 14, v3
    v_add_lshl_u32 v238, v238, v2, 2
    v_add_u32 v237, 155648, v237
    v_lshlrev_b32 v13, 17, v9
    v_lshl_add_u32 v233, v10, 4, v13
    s_cmp_eq_u32 s48, 3
    s_cselect_b32 s60, 268435456, 0
    s_lshl_b32 s70, s48, 10
    s_add_u32 s70, s70, s2
    s_lshl_b32 s70, s70, 9
    s_add_u32 s71, s70, 262144
    s_add_u32 s71, s71, s60
    s_xor_b32 s60, s60, 268435456
    s_lshl_b32 s72, s2, 7
    s_add_u32 s72, s72, s60
    s_add_u32 s72, s72, 6291456
    s_lshr_b32 s74, s2, 2
    s_lshl_b32 s74, s74, 5
    s_and_b32 s3, s2, 3
    s_add_u32 s74, s74, s3
    s_lshl_b32 s74, s74, 2
    s_add_u32 s74, s74, 10485760
    v_cmp_gt_u32 vcc, 8, v0
    v_lshlrev_b32 v236, 13, v0
    v_mov_b32 v13, 268435456
    s_and_b32 s3, s2, 7
    s_lshl_b32 s3, s3, 13
    s_add_u32 s3, s3, 10485760
    v_lshrrev_b32 v14, 2, v0
    v_lshl_add_u32 v14, v14, 7, s3
    v_lshl_add_u32 v20, v8, 2, v14
    v_cndmask_b32 v236, v13, v236, vcc
    v_mov_b32 v16, 0
    s_lshl_b32 s3, s48, 14
    s_add_u32 s74, s74, s3
    s_add_u32 s73, s74, 8192
    s_waitcnt vmcnt(10)
    v_dot2_f32_bf16 v226, v182, s77, 0
    v_dot2_f32_bf16 v227, v182, v182, 0
    v_dot2_f32_bf16 v226, v183, s77, v226
    v_dot2_f32_bf16 v227, v183, v183, v227
    v_dot2_f32_bf16 v226, v184, s77, v226
    v_dot2_f32_bf16 v227, v184, v184, v227
    v_dot2_f32_bf16 v226, v185, s77, v226
    v_dot2_f32_bf16 v227, v185, v185, v227
    s_waitcnt vmcnt(9)
    v_dot2_f32_bf16 v226, v186, s77, v226
    v_dot2_f32_bf16 v227, v186, v186, v227
    v_dot2_f32_bf16 v226, v187, s77, v226
    v_dot2_f32_bf16 v227, v187, v187, v227
    v_dot2_f32_bf16 v226, v188, s77, v226
    v_dot2_f32_bf16 v227, v188, v188, v227
    v_dot2_f32_bf16 v226, v189, s77, v226
    v_dot2_f32_bf16 v227, v189, v189, v227
    buffer_load_dword v12, v16, s[44:47], 0 offen sc1
    v_lshlrev_b32 v190, 16, v182
    v_and_b32 v191, 0xffff0000, v182
    v_add_f32_dpp v226, v226, v226 quad_perm:[1,0,3,2] row_mask:0xf bank_mask:0xf
    v_add_f32_dpp v227, v227, v227 quad_perm:[1,0,3,2] row_mask:0xf bank_mask:0xf
    v_lshlrev_b32 v192, 16, v183
    v_add_f32_dpp v226, v226, v226 quad_perm:[2,3,0,1] row_mask:0xf bank_mask:0xf
    v_add_f32_dpp v227, v227, v227 quad_perm:[2,3,0,1] row_mask:0xf bank_mask:0xf
    v_and_b32 v193, 0xffff0000, v183
    v_add_f32_dpp v226, v226, v226 row_half_mirror row_mask:0xf bank_mask:0xf
    v_add_f32_dpp v227, v227, v227 row_half_mirror row_mask:0xf bank_mask:0xf
    v_lshlrev_b32 v194, 16, v184
    v_add_f32_dpp v226, v226, v226 row_mirror row_mask:0xf bank_mask:0xf
    v_add_f32_dpp v227, v227, v227 row_mirror row_mask:0xf bank_mask:0xf
    v_and_b32 v195, 0xffff0000, v184
    v_mov_b32 v228, v226
    v_mov_b32 v229, v227
    v_lshlrev_b32 v196, 16, v185
    v_permlane16_swap_b32 v226, v228
    v_permlane16_swap_b32 v227, v229
    v_add_f32 v226, v226, v228
    v_add_f32 v227, v227, v229
    v_mul_f32_e64 v226, -v226, s76
    v_mul_f32 v228, v226, v226
    v_fma_f32 v227, v227, s76, -v228
    v_max_f32 v227, 0, v227
    v_add_f32 v228, s75, v227
    v_rsq_f32 v222, v228
    v_and_b32 v197, 0xffff0000, v185
    v_mul_f32 v228, v222, v222
    v_fma_f32 v229, v228, v227, s75
    v_rsq_f32 v228, v229
    v_mul_f32 v223, v226, v222
    v_mul_f32 v224, v222, v228
    v_mul_f32 v225, v223, v228
    v_mul_f32 v229, v229, v228
    ds_write_b32 v232, v229
    v_lshlrev_b32 v198, 16, v186
    v_and_b32 v199, 0xffff0000, v186
    v_lshlrev_b32 v200, 16, v187
    v_and_b32 v201, 0xffff0000, v187
    v_lshlrev_b32 v202, 16, v188
    v_and_b32 v203, 0xffff0000, v188
    v_lshlrev_b32 v204, 16, v189
    v_and_b32 v205, 0xffff0000, v189
    v_pk_fma_f32 v[206:207], v[190:191], v[224:225], v[224:225] op_sel:[0,0,1] op_sel_hi:[1,0,1]
    v_pk_fma_f32 v[208:209], v[192:193], v[224:225], v[224:225] op_sel:[0,0,1] op_sel_hi:[1,0,1]
    v_pk_fma_f32 v[210:211], v[194:195], v[224:225], v[224:225] op_sel:[0,0,1] op_sel_hi:[1,0,1]
    v_pk_fma_f32 v[212:213], v[196:197], v[224:225], v[224:225] op_sel:[0,0,1] op_sel_hi:[1,0,1]
    v_cvt_pk_bf16_f32 v182, v206, v207
    v_cvt_pk_bf16_f32 v183, v208, v209
    v_cvt_pk_bf16_f32 v184, v210, v211
    v_cvt_pk_bf16_f32 v185, v212, v213
    ds_write_b128 v230, v[182:185] offset:0
    v_pk_fma_f32 v[214:215], v[198:199], v[224:225], v[224:225] op_sel:[0,0,1] op_sel_hi:[1,0,1]
    v_pk_fma_f32 v[216:217], v[200:201], v[224:225], v[224:225] op_sel:[0,0,1] op_sel_hi:[1,0,1]
    v_pk_fma_f32 v[218:219], v[202:203], v[224:225], v[224:225] op_sel:[0,0,1] op_sel_hi:[1,0,1]
    v_pk_fma_f32 v[220:221], v[204:205], v[224:225], v[224:225] op_sel:[0,0,1] op_sel_hi:[1,0,1]
    v_cvt_pk_bf16_f32 v186, v214, v215
    v_cvt_pk_bf16_f32 v187, v216, v217
    v_cvt_pk_bf16_f32 v188, v218, v219
    v_cvt_pk_bf16_f32 v189, v220, v221
    ds_write_b128 v230, v[186:189] offset:448
    s_waitcnt lgkmcnt(0)
    s_barrier
    ds_read_b64_tr_b16 v[110:111], v231 offset:0
    ds_read_b64_tr_b16 v[112:113], v231 offset:3840
    ds_read_b64_tr_b16 v[114:115], v231 offset:128
    ds_read_b64_tr_b16 v[116:117], v231 offset:3968
    ds_read_b32 v229, v237
    s_waitcnt lgkmcnt(3)
    buffer_store_dwordx4 v[110:113], v233, s[28:31], s70 offen sc1
    s_waitcnt lgkmcnt(1)
    buffer_store_dwordx4 v[114:117], v233, s[28:31], s71 offen sc1
    v_cmp_gt_u32 vcc, 16, v1
    s_waitcnt lgkmcnt(0)
    s_nop 0
    v_cndmask_b32 v229, 0, v229, vcc
    buffer_store_dword v229, v238, s[28:31], s72 offen sc1
    v_lshrrev_b32 v13, 2, v1
    v_mul_u32_u24 v13, 1056, v13
    v_lshl_add_u32 v13, v8, 3, v13
    s_mul_i32 s3, s48, 224
    v_add_u32 v243, s3, v13
    s_mov_b32 s18, 401408
    s_mov_b32 s19, 0x20000
    s_mov_b32 s26, 7340032
    s_mov_b32 s27, 0x20000
    s_mov_b32 s34, 1835008
    s_mov_b32 s35, 0x20000
    s_mov_b32 s36, 1
    v_lshrrev_b32 v14, 2, v1
    v_lshlrev_b32 v14, 7, v14
    v_lshl_add_u32 v14, v8, 3, v14
    v_and_b32 v15, 3, v5
    v_lshl_add_u32 v14, v15, 5, v14
    s_mul_i32 s3, s4, 8256
    v_xor_b32 v31, s3, v14
    v_xor_b32 v32, 32, v31
    v_xor_b32 v33, 64, v31
    v_xor_b32 v34, 96, v31
    v_add_u32 v35, 65536, v31
    v_add_u32 v36, 65536, v32
    v_add_u32 v37, 65536, v33
    v_add_u32 v38, 65536, v34
    v_add_u32 v39, 131072, v31
    v_add_u32 v40, 131072, v32
    v_add_u32 v41, 131072, v33
    v_add_u32 v42, 131072, v34
    s_lshl_b32 s6, s52, 1
    s_add_u32 s6, s6, s5
    s_lshl_b32 s3, s6, 1
    s_add_u32 s3, s3, s59
    s_lshl_b32 s3, s3, 4
    s_add_u32 s3, s3, s4
    s_lshl_b32 s3, s3, 12
    v_lshl_add_u32 v78, v3, 8, v4
    v_add_u32 v78, s3, v78
    s_xor_b32 s37, s51, 1
    s_lshl_b32 s37, s37, 3
    s_add_u32 s37, s37, s52
    s_lshl_b32 s3, s37, 14
    s_add_u32 s3, s3, s58
    s_add_u32 s3, s3, 16777216
    v_add_u32 v23, s3, v4
    s_lshl_b32 s37, s37, 5
    s_add_u32 s37, s37, s5
    s_lshl_b32 s37, s37, 2
    s_add_u32 s37, s37, 6422528
    s_mul_i32 s67, s6, 56
    s_lshl_b32 s3, s51, 1
    s_add_u32 s3, s3, s4
    s_add_u32 s67, s67, s3
    s_lshl_b32 s67, s67, 11
    s_add_u32 s67, s67, 2097152
    v_add_u32 v81, s58, v4
    s_lshl_b32 s68, s52, 2
    s_and_b32 s3, s51, 1
    s_add_u32 s68, s68, s3
    s_cmp_ge_u32 s51, 14
    s_cselect_b32 s3, 2, 0
    s_add_u32 s68, s68, s3
    s_lshl_b32 s68, s68, 7
    s_add_u32 s68, s68, 6356992
    s_waitcnt vmcnt(3)
    v_readfirstlane_b32 s57, v12
    s_mov_b32 s60, 0
    s_cmp_lg_u32 s57, 0
    s_cbranch_scc0 L_nonceh
L_nonce_okh:
    s_waitcnt vmcnt(0)
    s_barrier
    s_atomic_swap s57, s[28:29], s74
    s_atomic_swap s57, s[28:29], s73
    buffer_load_dwordx4 v[96:99], v85, s[8:11], 0 offen
    buffer_load_ushort v93, v82, s[40:43], 0 offen offset:0
    buffer_load_dwordx4 v[100:103], v86, s[8:11], 0 offen
    buffer_load_ushort v94, v82, s[40:43], 0 offen offset:16
    v_cmp_gt_u32 vcc, 12, v2
    s_mul_i32 s3, s48, 56
    s_add_u32 s3, s3, s79
    s_mul_i32 s3, s3, 3
    s_add_u32 s3, s3, s80
    s_lshl_b32 s3, s3, 11
    s_add_u32 s3, s3, 8388608
    s_add_u32 s3, s3, s81
    ds_read_b64_tr_b16 v[182:183], v243 offset:0
    ds_read_b64_tr_b16 v[184:185], v243 offset:16896
    ds_read_b64_tr_b16 v[186:187], v243 offset:32
    ds_read_b64_tr_b16 v[188:189], v243 offset:16928
    ds_read_b64_tr_b16 v[190:191], v243 offset:56
    ds_read_b64_tr_b16 v[192:193], v243 offset:16952
    ds_read_b64_tr_b16 v[194:195], v243 offset:88
    ds_read_b64_tr_b16 v[196:197], v243 offset:16984
    ds_read_b64_tr_b16 v[198:199], v243 offset:112
    ds_read_b64_tr_b16 v[200:201], v243 offset:17008
    ds_read_b64_tr_b16 v[202:203], v243 offset:144
    ds_read_b64_tr_b16 v[204:205], v243 offset:17040
    ds_read_b64_tr_b16 v[206:207], v243 offset:168
    ds_read_b64_tr_b16 v[208:209], v243 offset:17064
    ds_read_b64_tr_b16 v[210:211], v243 offset:200
    ds_read_b64_tr_b16 v[212:213], v243 offset:17096
    s_waitcnt lgkmcnt(13)
    v_cndmask_b32 v186, 0, v186, vcc
    v_cndmask_b32 v187, 0, v187, vcc
    s_waitcnt lgkmcnt(12)
    v_cndmask_b32 v188, 0, v188, vcc
    v_cndmask_b32 v189, 0, v189, vcc
    buffer_store_dwordx4 v[182:185], v4, s[28:31], s3 offen offset:0 sc1
    buffer_store_dwordx4 v[186:189], v4, s[28:31], s3 offen offset:1024 sc1
    s_add_u32 s3, s3, 86016
    s_waitcnt lgkmcnt(9)
    v_cndmask_b32 v194, 0, v194, vcc
    v_cndmask_b32 v195, 0, v195, vcc
    s_waitcnt lgkmcnt(8)
    v_cndmask_b32 v196, 0, v196, vcc
    v_cndmask_b32 v197, 0, v197, vcc
    buffer_store_dwordx4 v[190:193], v4, s[28:31], s3 offen offset:0 sc1
    buffer_store_dwordx4 v[194:197], v4, s[28:31], s3 offen offset:1024 sc1
    s_add_u32 s3, s3, 86016
    s_waitcnt lgkmcnt(5)
    v_cndmask_b32 v202, 0, v202, vcc
    v_cndmask_b32 v203, 0, v203, vcc
    s_waitcnt lgkmcnt(4)
    v_cndmask_b32 v204, 0, v204, vcc
    v_cndmask_b32 v205, 0, v205, vcc
    buffer_store_dwordx4 v[198:201], v4, s[28:31], s3 offen offset:0 sc1
    buffer_store_dwordx4 v[202:205], v4, s[28:31], s3 offen offset:1024 sc1
    s_add_u32 s3, s3, 86016
    ds_read_b32 v24, v4
    s_waitcnt lgkmcnt(2)
    v_cndmask_b32 v210, 0, v210, vcc
    v_cndmask_b32 v211, 0, v211, vcc
    ds_read_b32 v24, v4
    s_waitcnt lgkmcnt(2)
    v_cndmask_b32 v212, 0, v212, vcc
    v_cndmask_b32 v213, 0, v213, vcc
    buffer_store_dwordx4 v[206:209], v4, s[28:31], s3 offen offset:0 sc1
    buffer_store_dwordx4 v[210:213], v4, s[28:31], s3 offen offset:1024 sc1
    s_add_u32 s3, s3, 86016
    s_lshl_b32 s67, s80, 6
    s_add_u32 s67, s67, 64
    s_cmp_eq_u32 s81, 0
    s_cselect_b32 s37, s48, 1
    s_mov_b32 s68, 6369792
    s_and_b32 s3, s2, 1
    s_mul_i32 s3, s3, 3
    s_bfe_u32 s6, s2, 0x10001
    s_mul_i32 s7, s6, 6
    s_add_u32 s3, s3, s7
    s_add_u32 s3, s3, 1
    v_add_u32 v14, s3, v8
    s_mul_i32 s6, s6, 64
    s_add_u32 s6, s6, 7
    v_cmp_ne_u32 vcc, s6, v14
    v_lshrrev_b32 v15, 2, v1
    v_mul_u32_u24 v15, 3584, v15
    v_cndmask_b32 v14, 0, v14, vcc
    v_lshl_add_u32 v14, v14, 8, v15
    s_lshl_b32 s3, s52, 2
    s_add_u32 s3, s3, s48
    s_mul_i32 s3, s3, 37
    s_min_u32 s3, s3, 976
    s_mul_i32 s3, s3, 3584
    s_mul_i32 s6, s59, 3670144
    s_add_u32 s3, s3, s6
    buffer_load_dword v226, v14, s[20:23], s3 offen
    s_add_u32 s3, s3, 57344
    buffer_load_dword v227, v14, s[20:23], s3 offen
    s_add_u32 s3, s3, 57344
    buffer_load_dword v228, v14, s[20:23], s3 offen
    s_add_u32 s3, s3, 57344
    v_add_u32 v53, 65536, v4
    v_add_u32 v54, 131072, v4
    s_mul_i32 s59, s48, 3072
    s_mul_i32 s3, s50, 86016
    s_add_u32 s3, s3, s59
    s_add_u32 s3, s3, 8388608
    v_add_u32 v80, s3, v4
    v_lshlrev_b32 v14, 7, v9
    v_xor_b32 v14, v14, v4
    s_lshl_b32 s3, s49, 11
    v_add_u32 v67, s3, v14
    v_add_u32 v68, 129024, v67
    s_lshr_b32 s3, s49, 2
    s_lshl_b32 s3, s3, 3
    s_max_u32 s3, s3, 1
    s_sub_u32 s3, s3, 1
    s_lshl_b32 s3, s3, 10
    s_lshl_b32 s6, s5, 17
    s_add_u32 s3, s3, s6
    s_lshl_b32 s6, s4, 28
    s_add_u32 s3, s3, s6
    v_add_u32 v69, s3, v14
    s_lshl_b32 s100, s5, 1
    s_add_u32 s100, s100, s4
    s_lshl_b32 s100, s100, 10
    v_and_b32 v14, 1, v1
    v_mul_u32_u24 v14, 640, v14
    v_lshrrev_b32 v15, 2, v1
    v_lshlrev_b32 v15, 4, v15
    v_xor_b32 v14, v14, v15
    v_bfe_u32 v15, v1, 1, 1
    v_lshl_add_u32 v14, v15, 3, v14
    s_add_u32 s3, s58, 12288
    v_add_u32 v70, s3, v14
    s_sub_u32 s3, s3, 3072
    s_cmp_eq_u32 s48, 0
    s_cselect_b32 s3, 28672, s3
    v_add_u32 v71, s3, v14
    v_add_u32 v72, 65536, v70
    v_add_u32 v73, 65536, v71
    v_add_u32 v74, 131072, v70
    v_add_u32 v75, 131072, v71
    s_lshl_b32 s3, s49, 1
    v_min_u32 v14, 2, v3
    v_add_u32 v14, s3, v14
    v_max_u32 v14, 1, v14
    v_lshlrev_b32 v14, 1, v14
    v_and_b32 v15, 1, v7
    v_add_lshl_u32 v14, v14, v15, 7
    v_lshrrev_b32 v15, 1, v7
    v_lshl_add_u32 v15, v15, 2, v8
    v_lshl_add_u32 v14, v15, 2, v14
    v_add_u32 v77, 6291200, v14
    s_min_u32 s15, s48, 2
    s_lshl_b32 s15, s15, 6
    s_add_u32 s15, s15, 64
    s_lshl_b32 s82, s49, 5
    s_add_u32 s82, s82, s50
    s_lshl_b32 s82, s82, 10
    s_add_u32 s82, s82, 4194304
    s_lshr_b32 s69, s49, 2
    s_lshl_b32 s69, s69, 1
    s_and_b32 s3, s50, 1
    s_add_u32 s69, s69, s3
    s_lshl_b32 s69, s69, 7
    s_add_u32 s69, s69, 6361088
    s_and_b32 s7, s53, 1
    s_mul_i32 s3, s7, 28
    s_add_u32 s3, s3, s48
    s_lshl_b32 s3, s3, 17
    s_xor_b32 s6, s53, 1
    s_lshl_b32 s55, s6, 3
    s_lshl_b32 s6, s53, 7
    s_add_u32 s3, s3, s6
    v_lshlrev_b32 v14, 12, v5
    v_add3_u32 v59, v14, v83, s3
    v_add_u32 v60, 31744, v59
    v_add_u32 v61, 63488, v59
    v_add_u32 v62, 95232, v59
    v_mul_u32_u24 v14, 896, v5
    s_mul_i32 s3, s4, 25088
    s_mul_i32 s6, s5, 14336
    s_add_u32 s3, s3, s6
    s_lshl_b32 s6, s54, 7
    s_add_u32 s3, s3, s6
    v_add3_u32 v63, v14, v83, s3
    v_add_u32 v64, 6144, v63
    s_lshl_b32 s6, s53, 1
    s_add_u32 s6, s6, s5
    s_and_b32 s3, s53, 30
    s_add_u32 s3, s3, s4
    s_lshl_b32 s3, s3, 7
    s_add_u32 s39, s3, 6361088
    s_lshl_b32 s3, s6, 5
    s_add_u32 s3, s3, s4
    s_lshl_b32 s3, s3, 10
    s_add_u32 s3, s3, 4194304
    v_add_u32 v65, s3, v4
    v_add_u32 v66, 15360, v65
    s_xor_b32 s3, s4, s5
    s_lshl_b32 s3, s3, 6
    v_xor_b32 v43, s3, v31
    v_xor_b32 v44, 32, v43
    v_add_u32 v45, 65536, v43
    v_add_u32 v46, 65536, v44
    s_mul_i32 s3, s4, 12288
    v_add_u32 v47, s3, v4
    v_xor_b32 v48, 4096, v47
    v_add_u32 v49, 65536, v47
    v_add_u32 v50, 65536, v48
    v_add_u32 v51, 131072, v47
    v_add_u32 v52, 131072, v48
    s_lshl_b32 s6, s54, 1
    s_add_u32 s6, s6, s5
    s_lshl_b32 s3, s6, 1
    s_add_u32 s3, s3, s7
    s_mul_i32 s3, s3, 14
    s_add_u32 s3, s3, s4
    s_lshl_b32 s3, s3, 12
    s_add_u32 s3, s3, 2097152
    v_add_u32 v79, s3, v4
    s_lshl_b32 s3, s54, 1
    s_add_u32 s3, s3, s7
    s_lshl_b32 s3, s3, 1
    s_add_u32 s3, s3, s4
    s_lshl_b32 s3, s3, 7
    s_add_u32 s38, s3, 6356992
    s_and_b32 s3, s2, 6
    s_add_u32 s3, s3, s54
    s_sub_u32 s6, s3, 7
    s_cmp_ge_u32 s3, 7
    s_cselect_b32 s3, s6, s3
    s_lshl_b32 s64, s3, 19
    s_lshl_b32 s65, s3, 13
    s_add_u32 s55, s55, s54
    s_lshl_b32 s3, s55, 14
    s_add_u32 s3, s3, s58
    s_add_u32 s3, s3, 12582912
    v_add_u32 v21, s3, v4
    s_lshl_b32 s55, s55, 5
    s_add_u32 s55, s55, s48
    s_lshl_b32 s55, s55, 2
    s_add_u32 s55, s55, 6488064
    s_lshl_b32 s3, s5, 3
    v_add_u32 v13, s3, v3
    v_xor_b32 v13, v13, v6
    v_lshlrev_b32 v13, 4, v13
    v_lshl_add_u32 v13, v2, 8, v13
    s_lshl_b32 s3, s4, 14
    s_add_u32 s3, s3, 32768
    v_add_u32 v87, s3, v13
    v_xor_b32 v88, 64, v87
    s_lshr_b32 s3, s53, 1
    s_add_u32 s66, s3, s54
    s_mov_b32 s51, s66
    v_lshlrev_b32 v13, 1, v6
    v_xor_b32 v13, v13, v5
    v_lshlrev_b32 v13, 4, v13
    v_lshl_add_u32 v13, v5, 8, v13
    s_add_u32 s3, s58, 32768
    v_add_u32 v89, s3, v13
    v_xor_b32 v90, 16, v89
    v_xor_b32 v91, 24576, v89
    v_xor_b32 v92, 24592, v89
    s_mov_b32 s70, 0xaaaaaaaa
    s_mov_b32 s71, 0xaaaaaaaa
    s_mov_b32 s72, 0xfff0ffff
    s_mov_b32 s73, 0xf000ff00
    s_mov_b32 s74, 0xffc0fffc
    s_mov_b32 s75, 0xc000fc00
    s_cmp_eq_u32 s49, 0
    s_cselect_b64 s[76:77], 0, -1
    v_mov_b32 v13, 0xffff
    v_mov_b32 v14, 0xffff0000
    v_cndmask_b32 v13, v13, v14, s[70:71]
    v_cndmask_b32 v104, v13, 0, s[72:73]
    v_cndmask_b32 v106, 0, v13, s[72:73]
    v_cndmask_b32 v105, v13, 0, s[74:75]
    v_cndmask_b32 v107, 0, v13, s[74:75]
    v_mov_b32 v84, 0xf149f2ca
    s_mov_b32 s83, 0x3e8b97f6
    s_mov_b32 s78, 0xbdd2d3e8
    s_mov_b32 s79, 0xbdd2d3e8
    s_mov_b32 s80, 1.0
    s_mov_b32 s81, 1.0
    v_mov_b32 v108, 0xc0135761
    v_mov_b32 v109, 0xc0135761
    v_lshrrev_b32 v13, 1, v2
    v_lshlrev_b32 v14, 1, v3
    v_sub_u32 v13, v13, v14
    v_mov_b32 v14, 0x3f80
    v_cndmask_b32 v14, v14, 1.0, s[70:71]
    v_cmp_eq_i32 vcc, 0, v13
    v_accvgpr_write_b32 a248, 0
    v_accvgpr_write_b32 a252, 0
    v_cndmask_b32 v15, 0, v14, vcc
    v_accvgpr_write_b32 a250, v15
    v_cmp_eq_i32 vcc, 1, v13
    v_accvgpr_write_b32 a249, 0
    v_accvgpr_write_b32 a253, 0
    v_cndmask_b32 v15, 0, v14, vcc
    v_accvgpr_write_b32 a251, v15
    s_waitcnt vmcnt(3)
    s_barrier
    s_cmp_lg_u32 s37, 0
    s_cbranch_scc1 L_nowsig
    s_atomic_add s36, s[44:45], s67
L_nowsig:
    buffer_load_dword v18, v20, s[28:31], 0 offen sc1
    s_cmp_eq_u32 s56, 0
    s_cselect_b32 s26, 0, s26
    v_and_b32 v13, 0xfffff000, v78
    v_lshl_add_u32 v13, v10, 7, v13
    s_add_u32 s3, s1, 8192
    v_lshl_add_u32 v14, v9, 13, s3
    s_waitcnt vmcnt(0)
    v_cmp_ne_u32 vcc, s57, v18
    s_cbranch_vccnz L_pollin3
L_pollok3:
    s_barrier
    buffer_load_dword v76, v77, s[28:31], 0 offen sc1
    s_mov_b32 s26, 7340032
    s_and_b32 s3, s2, 1
    s_mul_i32 s3, s3, 7
    s_add_u32 s3, s3, s52
    s_lshl_b32 s3, s3, 2
    s_add_u32 s3, s3, s48
    s_lshl_b32 s3, s3, 17
    s_and_b32 s6, s2, 6
    s_lshl_b32 s6, s6, 9
    s_add_u32 s3, s3, s6
    v_lshlrev_b32 v13, 12, v10
    v_lshl_add_u32 v13, v9, 9, v13
    buffer_load_dword v232, v13, s[24:27], s3 offen offset:384
    buffer_load_dword v233, v13, s[24:27], s3 offen offset:256
    s_cmp_eq_u32 s56, 0
    s_cselect_b32 s26, 0, s26
    v_lshlrev_b32 v13, 2, v2
    v_and_b32 v14, 1, v1
    v_lshl_add_u32 v14, v3, 2, v14
    v_lshlrev_b32 v14, 2, v14
    v_add_u32 v15, 64, v14
    v_cndmask_b32 v16, v14, v15, s[72:73]
    v_cndmask_b32 v14, v14, v15, s[74:75]
    s_waitcnt vmcnt(2)
    ds_bpermute_b32 v25, v13, v76 offset:64
    ds_bpermute_b32 v27, v16, v76 offset:0
    ds_bpermute_b32 v28, v14, v76 offset:8
    ds_bpermute_b32 v26, v13, v76 offset:128
    ds_bpermute_b32 v29, v16, v76 offset:64
    ds_bpermute_b32 v30, v14, v76 offset:72
    s_waitcnt lgkmcnt(5)
    v_mul_f32 v25, s83, v25
    ds_read_b32 v24, v4
    s_waitcnt lgkmcnt(3)
    v_mul_f32 v26, s83, v26
    s_load_dword s14, s[44:45], s15
    s_waitcnt lgkmcnt(0)
    s_cmp_ge_u32 s14, 14
    s_cbranch_scc0 L_pollin4
L_pollok4:
    s_barrier
    s_cmp_eq_u32 s56, 0
    s_cselect_b32 s3, 268435456, 0
    v_add_u32 v79, s3, v79
    s_add_u32 m0, s59, 98304
    s_nop 0
    buffer_load_dwordx4 v80, s[28:31], s63 offen sc1 lds
    buffer_load_dwordx4 v80, s[28:31], s63 offen offset:1024 sc1 lds
    buffer_load_dwordx4 v80, s[28:31], s63 offen offset:2048 sc1 lds
    s_add_u32 m0, s100, 126976
    s_nop 0
    buffer_load_dwordx4 v69, s[28:31], s62 offen sc1 lds
    s_add_u32 m0, s58, 110592
    s_nop 0
    buffer_load_dwordx4 v67, s[28:31], s62 offen sc1 lds
    buffer_load_dwordx4 v67, s[28:31], s62 offen offset:1024 sc1 lds
    buffer_load_dwordx4 v68, s[28:31], s62 offen offset:2048 sc1 lds
    buffer_load_dwordx4 v68, s[28:31], s62 offen offset:3072 sc1 lds
    s_add_u32 m0, s59, 131072
    s_add_u32 s63, s63, 12288
    s_cmp_eq_u32 s63, 86016
    s_cselect_b32 s63, 0, s63
    buffer_load_dwordx4 v80, s[28:31], s63 offen sc1 lds
    buffer_load_dwordx4 v80, s[28:31], s63 offen offset:1024 sc1 lds
    buffer_load_dwordx4 v80, s[28:31], s63 offen offset:2048 sc1 lds
    s_add_u32 m0, s100, 159744
    s_add_u32 s62, s62, 262144
    s_cmp_eq_u32 s62, 1835008
    s_cselect_b32 s62, 0, s62
    buffer_load_dwordx4 v69, s[28:31], s62 offen sc1 lds
    s_add_u32 m0, s58, 143360
    s_nop 0
    buffer_load_dwordx4 v67, s[28:31], s62 offen sc1 lds
    buffer_load_dwordx4 v67, s[28:31], s62 offen offset:1024 sc1 lds
    buffer_load_dwordx4 v68, s[28:31], s62 offen offset:2048 sc1 lds
    buffer_load_dwordx4 v68, s[28:31], s62 offen offset:3072 sc1 lds
    s_add_u32 m0, s59, 0
    s_add_u32 s63, s63, 12288
    s_cmp_eq_u32 s63, 86016
    s_cselect_b32 s63, 0, s63
    buffer_load_dwordx4 v80, s[28:31], s63 offen sc1 lds
    buffer_load_dwordx4 v80, s[28:31], s63 offen offset:1024 sc1 lds
    buffer_load_dwordx4 v80, s[28:31], s63 offen offset:2048 sc1 lds
    s_add_u32 m0, s100, 28672
    s_add_u32 s62, s62, 262144
    s_cmp_eq_u32 s62, 1835008
    s_cselect_b32 s62, 0, s62
    buffer_load_dwordx4 v69, s[28:31], s62 offen sc1 lds
    s_add_u32 m0, s58, 12288
    s_nop 0
    buffer_load_dwordx4 v67, s[28:31], s62 offen sc1 lds
    buffer_load_dwordx4 v67, s[28:31], s62 offen offset:1024 sc1 lds
    buffer_load_dwordx4 v68, s[28:31], s62 offen offset:2048 sc1 lds
    buffer_load_dwordx4 v68, s[28:31], s62 offen offset:3072 sc1 lds
    s_add_u32 m0, s59, 65536
    s_add_u32 s63, s63, 12288
    s_cmp_eq_u32 s63, 86016
    s_cselect_b32 s63, 0, s63
    buffer_load_dwordx4 v80, s[28:31], s63 offen sc1 lds
    buffer_load_dwordx4 v80, s[28:31], s63 offen offset:1024 sc1 lds
    buffer_load_dwordx4 v80, s[28:31], s63 offen offset:2048 sc1 lds
    s_add_u32 m0, s100, 94208
    s_add_u32 s62, s62, 262144
    s_cmp_eq_u32 s62, 1835008
    s_cselect_b32 s62, 0, s62
    buffer_load_dwordx4 v69, s[28:31], s62 offen sc1 lds
    s_add_u32 m0, s58, 77824
    s_nop 0
    buffer_load_dwordx4 v67, s[28:31], s62 offen sc1 lds
    buffer_load_dwordx4 v67, s[28:31], s62 offen offset:1024 sc1 lds
    buffer_load_dwordx4 v68, s[28:31], s62 offen offset:2048 sc1 lds
    buffer_load_dwordx4 v68, s[28:31], s62 offen offset:3072 sc1 lds
    s_mov_b32 s3, 268435456
    buffer_store_dword v12, v11, s[28:31], s3 offen
    buffer_store_dword v12, v11, s[28:31], s3 offen
    s_waitcnt vmcnt(18)
    s_barrier
    ds_read_b64_tr_b16 a[180:181], v72 offset:32768
    ds_read_b64_tr_b16 a[182:183], v72 offset:33024
    ds_read_b128 a[128:131], v53 offset:32768
    ds_read_b64_tr_b16 a[184:185], v72 offset:33792
    ds_read_b64_tr_b16 a[186:187], v72 offset:34048
    ds_read_b128 a[132:135], v53 offset:33792
    ds_read_b128 a[136:139], v53 offset:34816
    ds_read_b64_tr_b16 a[176:177], v73 offset:32768
    ds_read_b64_tr_b16 a[178:179], v73 offset:33024
    ds_read_b128 a[140:143], v53 offset:35840
    ds_read_b128 a[144:147], v53 offset:36864
    ds_read_b128 a[148:151], v53 offset:37888
    s_waitcnt lgkmcnt(0)
    s_nop 3
    s_branch L_q
L_pollin5:
    s_cmp_eq_u32 s56, 0
    s_cbranch_scc1 L_pollok5
    s_mov_b32 s60, 0
L_poll5:
    s_sleep 8
    buffer_load_dword v18, off, s[28:31], s38 sc1
    s_add_u32 s60, s60, 1
    s_waitcnt vmcnt(0)
    v_readfirstlane_b32 s14, v18
    s_nop 0
    s_cmp_ge_u32 s14, 7
    s_cbranch_scc1 L_pollok5
    s_cmp_lt_u32 s60, 20000
    s_cbranch_scc1 L_poll5
    s_branch L_pollok5
L_nof:
    s_waitcnt vmcnt(0)
    s_barrier
    s_cmp_lg_u32 s48, 0
    s_cbranch_scc1 L_sig3
    s_atomic_add s36, s[28:29], s69
L_sig3:
    v_lshlrev_b32 v14, 7, v1
    s_lshl_b32 s3, s54, 2
    s_add_u32 s3, s3, s48
    s_mul_i32 s3, s3, 25088
    buffer_load_dword v182, v14, s[16:19], s3 offen
    s_add_u32 s3, s3, 5632
    buffer_load_dword v183, v14, s[16:19], s3 offen
    s_add_u32 s3, s3, 5632
    buffer_load_dword v184, v14, s[16:19], s3 offen
    s_add_u32 s3, s3, 5632
    buffer_load_dword v185, v14, s[16:19], s3 offen
    s_add_u32 s3, s3, 5632
    s_branch L_fin
L_pollin6:
    s_mov_b32 s60, 0
L_poll6:
    s_sleep 8
    buffer_load_dword v18, off, s[28:31], s39 sc1
    s_add_u32 s60, s60, 1
    s_waitcnt vmcnt(0)
    v_readfirstlane_b32 s14, v18
    s_nop 0
    s_cmp_ge_u32 s14, 8
    s_cbranch_scc1 L_pollok6
    s_cmp_lt_u32 s60, 20000
    s_cbranch_scc1 L_poll6
    s_branch L_pollok6
L_pollin7:
    s_mov_b32 s60, 0
L_poll7:
    s_sleep 4
    buffer_load_dword v18, off, s[28:31], s55 sc1
    s_add_u32 s60, s60, 1
    s_waitcnt vmcnt(0)
    v_readfirstlane_b32 s14, v18
    s_nop 0
    s_cmp_ge_u32 s14, 1
    s_cbranch_scc1 L_pollok7
    s_cmp_lt_u32 s60, 20000
    s_cbranch_scc1 L_poll7
    s_branch L_pollok7
L_last:
    s_endpgm
.section .rodata,"a"
.p2align 6
.amdhsa_kernel parallel_sum__sliding_local_dilated__mixer_token_mlp__prompt_kernel
  .amdhsa_next_free_vgpr 512
  .amdhsa_next_free_sgpr 102
  .amdhsa_accum_offset 256
  .amdhsa_group_segment_fixed_size 0
  .amdhsa_kernarg_size 88
  .amdhsa_user_sgpr_count 2
  .amdhsa_user_sgpr_kernarg_segment_ptr 1
  .amdhsa_system_sgpr_workgroup_id_x 1
.end_amdhsa_kernel
```

```asm
; @launch grid=(256,1,1) block=(256,1,1) lds=163840
.amdgcn_target "amdgcn-amd-amdhsa--gfx950"
.text
.globl parallel_sum__sliding_local_dilated__mixer_token_mlp__prompt_kernel
.p2align 8
.type parallel_sum__sliding_local_dilated__mixer_token_mlp__prompt_kernel,@function
parallel_sum__sliding_local_dilated__mixer_token_mlp__prompt_kernel:
    s_cmp_ge_u32 s2, 256
    s_cbranch_scc1 L_end
    s_load_dwordx2 s[8:9], s[0:1], 0
    s_load_dwordx2 s[20:21], s[0:1], 32
    s_load_dwordx2 s[28:29], s[0:1], 80
    s_load_dwordx2 s[44:45], s[0:1], 72
    s_load_dwordx2 s[12:13], s[0:1], 8
    s_load_dwordx2 s[16:17], s[0:1], 16
    s_load_dwordx2 s[24:25], s[0:1], 48
    s_load_dwordx2 s[32:33], s[0:1], 64
    s_load_dwordx2 s[36:37], s[0:1], 40
    s_load_dwordx2 s[40:41], s[0:1], 56
    s_memrealtime s[78:79]
    s_getpc_b64 s[6:7]
L_pc:
    s_and_b32 s3, s2, 0xf8
    v_lshrrev_b32 v13, 5, v0
    v_add_lshl_u32 v13, s3, v13, 7
    v_min_u32 v13, L_last-L_pc, v13
    global_load_dword v18, v13, s[6:7]
    v_lshrrev_b32 v13, 6, v0
    v_and_b32 v10, 31, v0
    v_readfirstlane_b32 s48, v13
    v_bfe_u32 v9, v0, 5, 1
    v_mul_u32_u24 v14, 896, v9
    v_lshl_add_u32 v14, v10, 4, v14
    v_cmp_gt_u32 vcc, 28, v10
    v_mov_b32 v15, 268435456
    s_mov_b32 s10, 1835008
    s_mov_b32 s11, 0x20000
    v_cndmask_b32 v14, v15, v14, vcc
    s_lshr_b32 s4, s48, 1
    s_and_b32 s5, s48, 1
    s_and_b32 s3, s2, 0xfe
    s_add_u32 s3, s3, s4
    s_lshl_b32 s3, s3, 1
    s_and_b32 s60, s2, 1
    s_add_u32 s3, s3, s60
    s_lshl_b32 s3, s3, 1
    s_add_u32 s3, s3, s5
    s_mul_i32 s3, s3, 1792
    s_waitcnt lgkmcnt(0)
    buffer_load_dwordx4 v[182:185], v14, s[8:11], s3 offen
    buffer_load_dwordx4 v[186:189], v14, s[8:11], s3 offen offset:448
    v_and_b32 v1, 63, v0
    s_mov_b32 s46, 256
    s_mov_b32 s47, 0x20000
    s_lshl_b32 s3, s48, 8
    s_add_u32 s3, s3, s2
    s_cmp_lt_u32 s3, 8
    s_cselect_b32 s3, 0, 268435456
    s_or_b32 s78, s78, 1
    v_mov_b32 v234, s78
    v_mov_b32 v235, 0
    v_lshlrev_b32 v11, 25, v1
    buffer_atomic_cmpswap v[234:235], v11, s[44:47], s3 offen sc1
    s_bfe_u32 s6, s2, 0x20001
    s_and_b32 s7, s2, 1
    s_and_b32 s61, s2, 7
    s_lshr_b32 s101, s2, 3
    s_mul_i32 s52, s7, 25
    s_add_u32 s52, s52, s101
    s_mul_i32 s51, s52, 37
    s_lshr_b32 s51, s51, 8
    s_mul_i32 s3, s51, 7
    s_sub_u32 s52, s52, s3
    s_and_b32 s3, s6, 1
    s_mul_i32 s3, s3, 6
    s_add_u32 s51, s51, s3
    s_add_u32 s51, s51, 1
    s_add_u32 s3, s3, s51
    s_cmp_eq_u32 s3, 7
    s_cselect_b32 s51, 0, s51
    s_lshr_b32 s59, s6, 1
    s_lshl_b32 s51, s51, 1
    s_add_u32 s51, s51, s59
    s_max_u32 s60, s101, 25
    s_sub_u32 s60, s60, 25
    s_add_u32 s3, s101, s7
    s_cmp_lt_u32 s3, 25
    s_cselect_b32 s55, 1, 0
    s_cselect_b32 s52, s52, s60
    s_mov_b32 s22, 7340032
    s_mov_b32 s23, 0x20000
    s_lshl_b32 s3, s52, 1
    s_sub_u32 s60, s3, 7
    s_cmp_ge_u32 s3, 7
    s_cselect_b32 s3, s60, s3
    s_and_b32 s3, s3, 7
    s_mul_i32 s60, s61, 2
    s_add_u32 s3, s3, s60
    s_and_b32 s3, s3, 7
    s_mul_i32 s0, s3, 458752
    s_lshl_b32 s1, s3, 13
    s_lshl_b32 s58, s48, 12
    v_lshrrev_b32 v3, 4, v1
    v_lshrrev_b32 v5, 3, v1
    v_and_b32 v6, 7, v1
    v_lshlrev_b32 v14, 1, v3
    v_xor_b32 v14, v14, v6
    v_lshlrev_b32 v83, 4, v14
    s_cmp_eq_u32 s55, 0
    s_cbranch_scc1 L_nog1
    v_mul_u32_u24 v14, 3584, v5
    s_lshl_b32 s3, s59, 5
    s_add_u32 s3, s3, s48
    s_mul_i32 s3, s3, 114688
    s_lshl_b32 s60, s51, 7
    s_add_u32 s3, s3, s60
    v_add3_u32 v55, v14, v83, s3
    v_add_u32 v56, 56320, v55
    v_add_u32 v57, 26624, v55
    v_add_u32 v58, 82944, v55
    s_mov_b32 s38, 3584
    s_mov_b32 s39, 0x20000
    v_lshlrev_b32 v13, 3, v3
    s_lshl_b32 s3, s51, 1
    s_add_u32 s3, s3, s4
    s_lshl_b32 s3, s3, 6
    buffer_load_dwordx2 v[246:247], v13, s[36:39], s3 offen offset:0
    buffer_load_dwordx2 v[248:249], v13, s[36:39], s3 offen offset:32
    s_add_u32 m0, s58, 0
    v_xor_b32 v55, 128, v55
    buffer_load_dwordx4 v55, s[20:23], s0 offen lds
    v_xor_b32 v56, 128, v56
    buffer_load_dwordx4 v56, s[20:23], s0 offen offset:1024 lds
    v_xor_b32 v57, 128, v57
    buffer_load_dwordx4 v57, s[20:23], s0 offen offset:2048 lds
    v_xor_b32 v58, 128, v58
    buffer_load_dwordx4 v58, s[20:23], s0 offen offset:3072 lds
    s_mul_i32 s53, s101, 37
    s_lshr_b32 s53, s53, 8
    s_mul_i32 s54, s53, 7
    s_sub_u32 s54, s101, s54
    s_and_b32 s53, s53, 3
    s_lshl_b32 s3, s6, 2
    s_add_u32 s53, s53, s3
    s_lshl_b32 s53, s53, 1
    s_add_u32 s53, s53, s7
    s_mov_b32 s42, 4096
    s_mov_b32 s43, 0x20000
    s_lshl_b32 s3, s53, 2
    s_add_u32 s3, s3, s48
    s_lshl_b32 s60, s3, 5
    v_lshl_add_u32 v82, v5, 1, s60
    s_mul_i32 s3, s3, 14336
    s_lshl_b32 s60, s54, 7
    s_add_u32 s3, s3, s60
    v_mul_u32_u24 v14, 896, v5
    v_lshl_add_u32 v14, v6, 4, v14
    v_add_u32 v85, s3, v14
    v_add_u32 v86, 7168, v85
    s_cmp_lt_u32 s101, 28
    s_cselect_b32 s56, 1, 0
    s_lshl_b32 s50, s7, 3
    s_and_b32 s3, s101, 7
    s_add_u32 s50, s50, s3
    s_lshr_b32 s60, s101, 3
    s_lshl_b32 s49, s6, 2
    s_add_u32 s49, s49, s60
    s_lshl_b32 s49, s49, 2
    s_add_u32 s49, s49, s48
    s_mul_i32 s60, s60, 0
    s_add_u32 s3, s3, s60
    s_sub_u32 s60, s3, 7
    s_cmp_ge_u32 s3, 7
    s_cselect_b32 s3, s60, s3
    s_lshl_b32 s62, s3, 18
    s_mul_i32 s63, s3, 12288
    s_mov_b32 s30, 20971520
    s_mov_b32 s31, 0x20000
    s_mov_b32 s75, 0x3727c5ac
    s_mov_b32 s76, 0x3b124925
    s_mov_b32 s77, 0x3f803f80
    v_lshlrev_b32 v4, 4, v1
    v_bfe_u32 v7, v1, 2, 2
    v_and_b32 v8, 3, v1
    v_mul_u32_u24 v13, 960, v9
    v_lshl_add_u32 v13, v10, 4, v13
    s_mul_i32 s3, s48, 1920
    s_add_u32 s3, s3, 147456
    v_add_u32 v230, s3, v13
    v_mul_u32_u24 v13, 960, v7
    v_lshl_add_u32 v13, v3, 5, v13
    v_lshl_add_u32 v13, v8, 3, v13
    s_lshl_b32 s3, s48, 8
    s_add_u32 s3, s3, 147456
    v_add_u32 v231, s3, v13
    s_lshl_b32 s3, s48, 3
    s_add_u32 s3, s3, 155648
    v_lshl_add_u32 v232, v9, 2, s3
    v_lshlrev_b32 v237, 2, v6
    v_and_b32 v2, 15, v1
    v_lshlrev_b32 v238, 14, v3
    v_add_lshl_u32 v238, v238, v2, 2
    v_add_u32 v237, 155648, v237
    v_lshlrev_b32 v13, 17, v9
    v_lshl_add_u32 v233, v10, 4, v13
    s_cmp_eq_u32 s48, 3
    s_cselect_b32 s60, 268435456, 0
    s_lshl_b32 s70, s48, 10
    s_add_u32 s70, s70, s2
    s_lshl_b32 s70, s70, 9
    s_add_u32 s71, s70, 262144
    s_add_u32 s71, s71, s60
    s_xor_b32 s60, s60, 268435456
    s_lshl_b32 s72, s2, 7
    s_add_u32 s72, s72, s60
    s_add_u32 s72, s72, 6291456
    s_lshr_b32 s74, s2, 2
    s_lshl_b32 s74, s74, 5
    s_and_b32 s3, s2, 3
    s_add_u32 s74, s74, s3
    s_lshl_b32 s74, s74, 2
    s_add_u32 s74, s74, 10485760
    v_cmp_gt_u32 vcc, 8, v0
    v_lshlrev_b32 v236, 13, v0
    v_mov_b32 v13, 268435456
    s_and_b32 s3, s2, 7
    s_lshl_b32 s3, s3, 13
    s_add_u32 s3, s3, 10485760
    v_lshrrev_b32 v14, 2, v0
    v_lshl_add_u32 v14, v14, 7, s3
    v_lshl_add_u32 v20, v8, 2, v14
    v_cndmask_b32 v236, v13, v236, vcc
    v_mov_b32 v16, 0
    s_lshl_b32 s3, s48, 14
    s_add_u32 s74, s74, s3
    s_add_u32 s73, s74, 8192
    s_waitcnt vmcnt(8)
    v_dot2_f32_bf16 v226, v182, s77, 0
    v_dot2_f32_bf16 v227, v182, v182, 0
    v_dot2_f32_bf16 v226, v183, s77, v226
    v_dot2_f32_bf16 v227, v183, v183, v227
    v_dot2_f32_bf16 v226, v184, s77, v226
    v_dot2_f32_bf16 v227, v184, v184, v227
    v_dot2_f32_bf16 v226, v185, s77, v226
    v_dot2_f32_bf16 v227, v185, v185, v227
    s_waitcnt vmcnt(7)
    v_dot2_f32_bf16 v226, v186, s77, v226
    v_dot2_f32_bf16 v227, v186, v186, v227
    v_dot2_f32_bf16 v226, v187, s77, v226
    v_dot2_f32_bf16 v227, v187, v187, v227
    v_dot2_f32_bf16 v226, v188, s77, v226
    v_dot2_f32_bf16 v227, v188, v188, v227
    v_dot2_f32_bf16 v226, v189, s77, v226
    v_dot2_f32_bf16 v227, v189, v189, v227
    buffer_load_dword v12, v16, s[44:47], 0 offen sc1
    v_lshlrev_b32 v190, 16, v182
    v_and_b32 v191, 0xffff0000, v182
    v_add_f32_dpp v226, v226, v226 quad_perm:[1,0,3,2] row_mask:0xf bank_mask:0xf
    v_add_f32_dpp v227, v227, v227 quad_perm:[1,0,3,2] row_mask:0xf bank_mask:0xf
    v_lshlrev_b32 v192, 16, v183
    v_add_f32_dpp v226, v226, v226 quad_perm:[2,3,0,1] row_mask:0xf bank_mask:0xf
    v_add_f32_dpp v227, v227, v227 quad_perm:[2,3,0,1] row_mask:0xf bank_mask:0xf
    v_and_b32 v193, 0xffff0000, v183
    v_add_f32_dpp v226, v226, v226 row_half_mirror row_mask:0xf bank_mask:0xf
    v_add_f32_dpp v227, v227, v227 row_half_mirror row_mask:0xf bank_mask:0xf
    v_lshlrev_b32 v194, 16, v184
    v_add_f32_dpp v226, v226, v226 row_mirror row_mask:0xf bank_mask:0xf
    v_add_f32_dpp v227, v227, v227 row_mirror row_mask:0xf bank_mask:0xf
    v_and_b32 v195, 0xffff0000, v184
    v_mov_b32 v228, v226
    v_mov_b32 v229, v227
    v_lshlrev_b32 v196, 16, v185
    v_permlane16_swap_b32 v226, v228
    v_permlane16_swap_b32 v227, v229
    v_add_f32 v226, v226, v228
    v_add_f32 v227, v227, v229
    v_mul_f32_e64 v226, -v226, s76
    v_mul_f32 v228, v226, v226
    v_fma_f32 v227, v227, s76, -v228
    v_max_f32 v227, 0, v227
    v_add_f32 v228, s75, v227
    v_rsq_f32 v222, v228
    v_and_b32 v197, 0xffff0000, v185
    v_mul_f32 v228, v222, v222
    v_fma_f32 v229, v228, v227, s75
    v_rsq_f32 v228, v229
    v_mul_f32 v223, v226, v222
    v_mul_f32 v224, v222, v228
    v_mul_f32 v225, v223, v228
    v_mul_f32 v229, v229, v228
    ds_write_b32 v232, v229
    v_lshlrev_b32 v198, 16, v186
    v_and_b32 v199, 0xffff0000, v186
    v_lshlrev_b32 v200, 16, v187
    v_and_b32 v201, 0xffff0000, v187
    v_lshlrev_b32 v202, 16, v188
    v_and_b32 v203, 0xffff0000, v188
    v_lshlrev_b32 v204, 16, v189
    v_and_b32 v205, 0xffff0000, v189
    v_pk_fma_f32 v[206:207], v[190:191], v[224:225], v[224:225] op_sel:[0,0,1] op_sel_hi:[1,0,1]
    v_pk_fma_f32 v[208:209], v[192:193], v[224:225], v[224:225] op_sel:[0,0,1] op_sel_hi:[1,0,1]
    v_pk_fma_f32 v[210:211], v[194:195], v[224:225], v[224:225] op_sel:[0,0,1] op_sel_hi:[1,0,1]
    v_pk_fma_f32 v[212:213], v[196:197], v[224:225], v[224:225] op_sel:[0,0,1] op_sel_hi:[1,0,1]
    v_cvt_pk_bf16_f32 v182, v206, v207
    v_cvt_pk_bf16_f32 v183, v208, v209
    v_cvt_pk_bf16_f32 v184, v210, v211
    v_cvt_pk_bf16_f32 v185, v212, v213
    ds_write_b128 v230, v[182:185] offset:0
    v_pk_fma_f32 v[214:215], v[198:199], v[224:225], v[224:225] op_sel:[0,0,1] op_sel_hi:[1,0,1]
    v_pk_fma_f32 v[216:217], v[200:201], v[224:225], v[224:225] op_sel:[0,0,1] op_sel_hi:[1,0,1]
    v_pk_fma_f32 v[218:219], v[202:203], v[224:225], v[224:225] op_sel:[0,0,1] op_sel_hi:[1,0,1]
    v_pk_fma_f32 v[220:221], v[204:205], v[224:225], v[224:225] op_sel:[0,0,1] op_sel_hi:[1,0,1]
    v_cvt_pk_bf16_f32 v186, v214, v215
    v_cvt_pk_bf16_f32 v187, v216, v217
    v_cvt_pk_bf16_f32 v188, v218, v219
    v_cvt_pk_bf16_f32 v189, v220, v221
    ds_write_b128 v230, v[186:189] offset:448
    s_waitcnt lgkmcnt(0)
    s_barrier
    ds_read_b64_tr_b16 v[110:111], v231 offset:0
    ds_read_b64_tr_b16 v[112:113], v231 offset:3840
    ds_read_b64_tr_b16 v[114:115], v231 offset:128
    ds_read_b64_tr_b16 v[116:117], v231 offset:3968
    ds_read_b32 v229, v237
    s_waitcnt lgkmcnt(3)
    buffer_store_dwordx4 v[110:113], v233, s[28:31], s70 offen sc1
    s_waitcnt lgkmcnt(1)
    buffer_store_dwordx4 v[114:117], v233, s[28:31], s71 offen sc1
    v_cmp_gt_u32 vcc, 16, v1
    s_waitcnt lgkmcnt(0)
    s_nop 0
    v_cndmask_b32 v229, 0, v229, vcc
    buffer_store_dword v229, v238, s[28:31], s72 offen sc1
    s_add_u32 m0, s58, 16384
    s_add_u32 s0, s0, 458752
    s_cmp_eq_u32 s0, 3670016
    s_cselect_b32 s0, 0, s0
    buffer_load_dwordx4 v55, s[20:23], s0 offen lds
    buffer_load_dwordx4 v56, s[20:23], s0 offen offset:1024 lds
    buffer_load_dwordx4 v57, s[20:23], s0 offen offset:2048 lds
    buffer_load_dwordx4 v58, s[20:23], s0 offen offset:3072 lds
    s_branch L_anchor
.p2align 12
L_anchor:
    s_mov_b32 s18, 401408
    s_mov_b32 s19, 0x20000
    s_mov_b32 s26, 7340032
    s_mov_b32 s27, 0x20000
    s_mov_b32 s34, 1835008
    s_mov_b32 s35, 0x20000
    s_mov_b32 s36, 1
    v_lshrrev_b32 v14, 2, v1
    v_lshlrev_b32 v14, 7, v14
    v_lshl_add_u32 v14, v8, 3, v14
    v_and_b32 v15, 3, v5
    v_lshl_add_u32 v14, v15, 5, v14
    s_mul_i32 s3, s4, 8256
    v_xor_b32 v31, s3, v14
    v_xor_b32 v32, 32, v31
    v_xor_b32 v33, 64, v31
    v_xor_b32 v34, 96, v31
    v_add_u32 v35, 65536, v31
    v_add_u32 v36, 65536, v32
    v_add_u32 v37, 65536, v33
    v_add_u32 v38, 65536, v34
    v_add_u32 v39, 131072, v31
    v_add_u32 v40, 131072, v32
    v_add_u32 v41, 131072, v33
    v_add_u32 v42, 131072, v34
    s_lshl_b32 s6, s52, 1
    s_add_u32 s6, s6, s5
    s_lshl_b32 s3, s6, 1
    s_add_u32 s3, s3, s59
    s_lshl_b32 s3, s3, 4
    s_add_u32 s3, s3, s4
    s_lshl_b32 s3, s3, 12
    v_lshl_add_u32 v78, v3, 8, v4
    v_add_u32 v78, s3, v78
    s_xor_b32 s37, s51, 1
    s_lshl_b32 s37, s37, 3
    s_add_u32 s37, s37, s52
    s_lshl_b32 s3, s37, 14
    s_add_u32 s3, s3, s58
    s_add_u32 s3, s3, 16777216
    v_add_u32 v23, s3, v4
    s_lshl_b32 s37, s37, 5
    s_add_u32 s37, s37, s5
    s_lshl_b32 s37, s37, 2
    s_add_u32 s37, s37, 6422528
    s_mul_i32 s67, s6, 56
    s_lshl_b32 s3, s51, 1
    s_add_u32 s3, s3, s4
    s_add_u32 s67, s67, s3
    s_lshl_b32 s67, s67, 11
    s_add_u32 s67, s67, 2097152
    v_add_u32 v81, s58, v4
    s_lshl_b32 s68, s52, 2
    s_and_b32 s3, s51, 1
    s_add_u32 s68, s68, s3
    s_cmp_ge_u32 s51, 14
    s_cselect_b32 s3, 2, 0
    s_add_u32 s68, s68, s3
    s_lshl_b32 s68, s68, 7
    s_add_u32 s68, s68, 6356992
    s_waitcnt vmcnt(7)
    v_readfirstlane_b32 s57, v12
    s_mov_b32 s60, 0
    s_cmp_lg_u32 s57, 0
    s_cbranch_scc0 L_nonce
L_nonce_ok:
    s_waitcnt vmcnt(4)
    s_barrier
    s_atomic_swap s57, s[28:29], s74
    s_atomic_swap s57, s[28:29], s73
    buffer_load_dwordx4 v[96:99], v85, s[8:11], 0 offen
    buffer_load_ushort v93, v82, s[40:43], 0 offen offset:0
    buffer_load_dwordx4 v[100:103], v86, s[8:11], 0 offen
    buffer_load_ushort v94, v82, s[40:43], 0 offen offset:16
    v_add_u32 v53, 65536, v4
    s_add_u32 m0, s58, 32768
    s_add_u32 s0, s0, 458752
    s_cmp_eq_u32 s0, 3670016
    s_cselect_b32 s0, 0, s0
    buffer_load_dwordx4 v55, s[20:23], s0 offen lds
    v_add_u32 v54, 131072, v4
    s_mul_i32 s59, s48, 3072
    s_mul_i32 s3, s50, 86016
    s_add_u32 s3, s3, s59
    s_add_u32 s3, s3, 8388608
    v_add_u32 v80, s3, v4
    v_lshlrev_b32 v14, 7, v9
    v_xor_b32 v14, v14, v4
    s_lshl_b32 s3, s49, 11
    v_add_u32 v67, s3, v14
    v_add_u32 v68, 129024, v67
    s_lshr_b32 s3, s49, 2
    s_lshl_b32 s3, s3, 3
    s_max_u32 s3, s3, 1
    s_sub_u32 s3, s3, 1
    s_lshl_b32 s3, s3, 10
    s_lshl_b32 s6, s5, 17
    s_add_u32 s3, s3, s6
    s_lshl_b32 s6, s4, 28
    s_add_u32 s3, s3, s6
    v_add_u32 v69, s3, v14
    buffer_load_dwordx4 v56, s[20:23], s0 offen offset:1024 lds
    s_lshl_b32 s100, s5, 1
    s_add_u32 s100, s100, s4
    s_lshl_b32 s100, s100, 10
    v_and_b32 v14, 1, v1
    v_mul_u32_u24 v14, 640, v14
    v_lshrrev_b32 v15, 2, v1
    v_lshlrev_b32 v15, 4, v15
    v_xor_b32 v14, v14, v15
    v_bfe_u32 v15, v1, 1, 1
    v_lshl_add_u32 v14, v15, 3, v14
    buffer_load_dwordx4 v57, s[20:23], s0 offen offset:2048 lds
    s_add_u32 s3, s58, 12288
    v_add_u32 v70, s3, v14
    s_sub_u32 s3, s3, 3072
    s_cmp_eq_u32 s48, 0
    s_cselect_b32 s3, 28672, s3
    v_add_u32 v71, s3, v14
    v_add_u32 v72, 65536, v70
    v_add_u32 v73, 65536, v71
    v_add_u32 v74, 131072, v70
    v_add_u32 v75, 131072, v71
    s_lshl_b32 s3, s49, 1
    v_min_u32 v14, 2, v3
    v_add_u32 v14, s3, v14
    v_max_u32 v14, 1, v14
    v_lshlrev_b32 v14, 1, v14
    v_and_b32 v15, 1, v7
    buffer_load_dwordx4 v58, s[20:23], s0 offen offset:3072 lds
    v_add_lshl_u32 v14, v14, v15, 7
    v_lshrrev_b32 v15, 1, v7
    v_lshl_add_u32 v15, v15, 2, v8
    v_lshl_add_u32 v14, v15, 2, v14
    v_add_u32 v77, 6291200, v14
    s_min_u32 s15, s48, 2
    s_lshl_b32 s15, s15, 6
    s_add_u32 s15, s15, 64
    s_lshl_b32 s82, s49, 5
    s_add_u32 s82, s82, s50
    s_lshl_b32 s82, s82, 10
    s_add_u32 s82, s82, 4194304
    s_lshr_b32 s69, s49, 2
    s_lshl_b32 s69, s69, 1
    s_and_b32 s3, s50, 1
    s_add_u32 s69, s69, s3
    s_lshl_b32 s69, s69, 7
    s_add_u32 s69, s69, 6361088
    s_and_b32 s7, s53, 1
    s_mul_i32 s3, s7, 28
    s_add_u32 s3, s3, s48
    s_lshl_b32 s3, s3, 17
    s_xor_b32 s6, s53, 1
    s_lshl_b32 s55, s6, 3
    s_lshl_b32 s6, s53, 7
    s_add_u32 s3, s3, s6
    v_lshlrev_b32 v14, 12, v5
    s_add_u32 m0, s58, 49152
    s_add_u32 s0, s0, 458752
    s_cmp_eq_u32 s0, 3670016
    s_cselect_b32 s0, 0, s0
    buffer_load_dwordx4 v55, s[20:23], s0 offen lds
    v_add3_u32 v59, v14, v83, s3
    v_add_u32 v60, 31744, v59
    v_add_u32 v61, 63488, v59
    v_add_u32 v62, 95232, v59
    v_mul_u32_u24 v14, 896, v5
    s_mul_i32 s3, s4, 25088
    s_mul_i32 s6, s5, 14336
    s_add_u32 s3, s3, s6
    s_lshl_b32 s6, s54, 7
    s_add_u32 s3, s3, s6
    v_add3_u32 v63, v14, v83, s3
    buffer_load_dwordx4 v56, s[20:23], s0 offen offset:1024 lds
    v_add_u32 v64, 6144, v63
    s_lshl_b32 s6, s53, 1
    s_add_u32 s6, s6, s5
    s_and_b32 s3, s53, 30
    s_add_u32 s3, s3, s4
    s_lshl_b32 s3, s3, 7
    s_add_u32 s39, s3, 6361088
    s_lshl_b32 s3, s6, 5
    s_add_u32 s3, s3, s4
    s_lshl_b32 s3, s3, 10
    s_add_u32 s3, s3, 4194304
    v_add_u32 v65, s3, v4
    v_add_u32 v66, 15360, v65
    s_xor_b32 s3, s4, s5
    s_lshl_b32 s3, s3, 6
    v_xor_b32 v43, s3, v31
    buffer_load_dwordx4 v57, s[20:23], s0 offen offset:2048 lds
    v_xor_b32 v44, 32, v43
    v_add_u32 v45, 65536, v43
    v_add_u32 v46, 65536, v44
    s_mul_i32 s3, s4, 12288
    v_add_u32 v47, s3, v4
    v_xor_b32 v48, 4096, v47
    v_add_u32 v49, 65536, v47
    v_add_u32 v50, 65536, v48
    v_add_u32 v51, 131072, v47
    v_add_u32 v52, 131072, v48
    s_lshl_b32 s6, s54, 1
    s_add_u32 s6, s6, s5
    s_lshl_b32 s3, s6, 1
    s_add_u32 s3, s3, s7
    s_mul_i32 s3, s3, 14
    s_add_u32 s3, s3, s4
    s_lshl_b32 s3, s3, 12
    s_add_u32 s3, s3, 2097152
    v_add_u32 v79, s3, v4
    buffer_load_dwordx4 v58, s[20:23], s0 offen offset:3072 lds
    s_lshl_b32 s3, s54, 1
    s_add_u32 s3, s3, s7
    s_lshl_b32 s3, s3, 1
    s_add_u32 s3, s3, s4
    s_lshl_b32 s3, s3, 7
    s_add_u32 s38, s3, 6356992
    s_and_b32 s3, s2, 6
    s_add_u32 s3, s3, s54
    s_sub_u32 s6, s3, 7
    s_cmp_ge_u32 s3, 7
    s_cselect_b32 s3, s6, s3
    s_lshl_b32 s64, s3, 19
    s_lshl_b32 s65, s3, 13
    s_add_u32 s55, s55, s54
    s_lshl_b32 s3, s55, 14
    s_add_u32 s3, s3, s58
    s_add_u32 s3, s3, 12582912
    v_add_u32 v21, s3, v4
    s_add_u32 m0, s58, 65536
    s_add_u32 s0, s0, 458752
    s_cmp_eq_u32 s0, 3670016
    s_cselect_b32 s0, 0, s0
    buffer_load_dwordx4 v55, s[20:23], s0 offen lds
    s_lshl_b32 s55, s55, 5
    s_add_u32 s55, s55, s48
    s_lshl_b32 s55, s55, 2
    s_add_u32 s55, s55, 6488064
    s_lshl_b32 s3, s5, 3
    v_add_u32 v13, s3, v3
    v_xor_b32 v13, v13, v6
    v_lshlrev_b32 v13, 4, v13
    v_lshl_add_u32 v13, v2, 8, v13
    buffer_load_dwordx4 v56, s[20:23], s0 offen offset:1024 lds
    s_lshl_b32 s3, s4, 14
    s_add_u32 s3, s3, 32768
    v_add_u32 v87, s3, v13
    v_xor_b32 v88, 64, v87
    s_lshr_b32 s3, s53, 1
    s_add_u32 s66, s3, s54
    s_mov_b32 s51, s66
    v_lshlrev_b32 v13, 1, v6
    v_xor_b32 v13, v13, v5
    v_lshlrev_b32 v13, 4, v13
    v_lshl_add_u32 v13, v5, 8, v13
    s_add_u32 s3, s58, 32768
    v_add_u32 v89, s3, v13
    v_xor_b32 v90, 16, v89
    v_xor_b32 v91, 24576, v89
    v_xor_b32 v92, 24592, v89
    buffer_load_dwordx4 v57, s[20:23], s0 offen offset:2048 lds
    v_lshlrev_b32 v150, 16, v246
    v_and_b32 v151, 0xffff0000, v246
    v_lshlrev_b32 v152, 16, v247
    v_and_b32 v153, 0xffff0000, v247
    v_lshlrev_b32 v154, 16, v248
    v_and_b32 v155, 0xffff0000, v248
    v_lshlrev_b32 v156, 16, v249
    v_and_b32 v157, 0xffff0000, v249
    v_lshlrev_b32 v158, 16, v246
    v_and_b32 v159, 0xffff0000, v246
    v_lshlrev_b32 v160, 16, v247
    v_and_b32 v161, 0xffff0000, v247
    v_lshlrev_b32 v162, 16, v248
    v_and_b32 v163, 0xffff0000, v248
    v_lshlrev_b32 v164, 16, v249
    v_and_b32 v165, 0xffff0000, v249
    buffer_load_dwordx4 v58, s[20:23], s0 offen offset:3072 lds
    s_add_u32 m0, s58, 81920
    s_add_u32 s0, s0, 458752
    s_cmp_eq_u32 s0, 3670016
    s_cselect_b32 s0, 0, s0
    buffer_load_dwordx4 v55, s[20:23], s0 offen lds
    buffer_load_dwordx4 v56, s[20:23], s0 offen offset:1024 lds
    buffer_load_dwordx4 v57, s[20:23], s0 offen offset:2048 lds
    buffer_load_dwordx4 v58, s[20:23], s0 offen offset:3072 lds
    s_add_u32 m0, s58, 98304
    s_add_u32 s0, s0, 458752
    s_cmp_eq_u32 s0, 3670016
    s_cselect_b32 s0, 0, s0
    buffer_load_dwordx4 v55, s[20:23], s0 offen lds
    buffer_load_dwordx4 v56, s[20:23], s0 offen offset:1024 lds
    buffer_load_dwordx4 v57, s[20:23], s0 offen offset:2048 lds
    buffer_load_dwordx4 v58, s[20:23], s0 offen offset:3072 lds
    buffer_load_dword v18, v20, s[28:31], 0 offen sc1
    s_add_u32 m0, s58, 114688
    s_add_u32 s0, s0, 458752
    s_cmp_eq_u32 s0, 3670016
    s_cselect_b32 s0, 0, s0
    buffer_load_dwordx4 v55, s[20:23], s0 offen lds
    buffer_load_dwordx4 v56, s[20:23], s0 offen offset:1024 lds
    buffer_load_dwordx4 v57, s[20:23], s0 offen offset:2048 lds
    buffer_load_dwordx4 v58, s[20:23], s0 offen offset:3072 lds
    s_mov_b32 s3, s48
    s_mov_b64 exec, 0
L_warm:
    s_add_u32 s3, s3, 4
    s_cmp_eq_u32 s3, 4
    s_cbranch_scc1 L_pad0
    s_cmp_eq_u32 s3, 5
    s_cbranch_scc1 L_pad1
    s_cmp_eq_u32 s3, 6
    s_cbranch_scc1 L_pad2
    s_cmp_eq_u32 s3, 7
    s_cbranch_scc1 L_pad3
    s_cmp_eq_u32 s3, 8
    s_cbranch_scc1 L_pad4
    s_mov_b64 exec, -1
    s_waitcnt vmcnt(4)
    v_cmp_ne_u32 vcc, s57, v18
    s_cbranch_vccnz L_pollin0
L_pollok0:
    s_barrier
    buffer_load_dwordx4 a[0:3], v78, s[28:31], s1 offen offset:0 sc1
    buffer_load_dwordx4 a[4:7], v78, s[28:31], s1 offen offset:256 sc1
    buffer_load_dwordx4 a[8:11], v78, s[28:31], s1 offen offset:2048 sc1
    buffer_load_dwordx4 a[12:15], v78, s[28:31], s1 offen offset:2304 sc1
    buffer_load_dword v76, v77, s[28:31], 0 offen sc1
    s_add_u32 s1, s1, 8192
    s_and_b32 s1, s1, 0xffff
    buffer_load_dwordx4 a[16:19], v78, s[28:31], s1 offen offset:0 sc1
    buffer_load_dwordx4 a[20:23], v78, s[28:31], s1 offen offset:256 sc1
    buffer_load_dwordx4 a[24:27], v78, s[28:31], s1 offen offset:2048 sc1
    buffer_load_dwordx4 a[28:31], v78, s[28:31], s1 offen offset:2304 sc1
    s_add_u32 s1, s1, 8192
    s_and_b32 s1, s1, 0xffff
    buffer_load_dwordx4 a[32:35], v78, s[28:31], s1 offen offset:0 sc1
    buffer_load_dwordx4 a[36:39], v78, s[28:31], s1 offen offset:256 sc1
    buffer_load_dwordx4 a[40:43], v78, s[28:31], s1 offen offset:2048 sc1
    buffer_load_dwordx4 a[44:47], v78, s[28:31], s1 offen offset:2304 sc1
    ds_read_b64_tr_b16 a[200:201], v31 offset:0
    ds_read_b64_tr_b16 a[202:203], v31 offset:2048
    ds_read_b64_tr_b16 a[204:205], v33 offset:0
    ds_read_b64_tr_b16 a[206:207], v33 offset:2048
    ds_read_b64_tr_b16 a[208:209], v32 offset:0
    ds_read_b64_tr_b16 a[210:211], v32 offset:2048
    ds_read_b64_tr_b16 a[212:213], v34 offset:0
    ds_read_b64_tr_b16 a[214:215], v34 offset:2048
    ds_read_b64_tr_b16 a[216:217], v31 offset:4096
    ds_read_b64_tr_b16 a[218:219], v31 offset:6144
    ds_read_b64_tr_b16 a[220:221], v33 offset:4096
    ds_read_b64_tr_b16 a[222:223], v33 offset:6144
    s_waitcnt vmcnt(11) lgkmcnt(8)
    v_mfma_f32_16x16x32_bf16 v[182:185], a[200:203], a[0:3], 0
    ds_read_b64_tr_b16 a[224:225], v32 offset:4096
    s_add_u32 s1, s1, 8192
    v_mfma_f32_16x16x32_bf16 v[190:193], a[200:203], a[4:7], 0
    ds_read_b64_tr_b16 a[226:227], v32 offset:6144
    s_and_b32 s1, s1, 0xffff
    s_mov_b32 s70, 0xaaaaaaaa
    s_mov_b32 s71, 0xaaaaaaaa
    s_mov_b32 s72, 0xfff0ffff
    s_mov_b32 s73, 0xf000ff00
    s_mov_b32 s74, 0xffc0fffc
    v_mfma_f32_16x16x32_bf16 v[198:201], a[204:207], a[0:3], 0
    ds_read_b64_tr_b16 a[228:229], v34 offset:4096
    buffer_load_dwordx4 a[48:51], v78, s[28:31], s1 offen offset:0 sc1
    v_mfma_f32_16x16x32_bf16 v[206:209], a[204:207], a[4:7], 0
    ds_read_b64_tr_b16 a[230:231], v34 offset:6144
    s_mov_b32 s75, 0xc000fc00
    s_waitcnt lgkmcnt(8)
    v_mfma_f32_16x16x32_bf16 v[186:189], a[208:211], a[0:3], 0
    ds_read_b64_tr_b16 a[200:201], v31 offset:16384
    s_mov_b32 s83, 0x3e8b97f6
    v_mfma_f32_16x16x32_bf16 v[194:197], a[208:211], a[4:7], 0
    ds_read_b64_tr_b16 a[202:203], v31 offset:18432
    buffer_load_dwordx4 a[52:55], v78, s[28:31], s1 offen offset:256 sc1
    v_lshlrev_b32 v13, 2, v2
    v_mfma_f32_16x16x32_bf16 v[202:205], a[212:215], a[0:3], 0
    ds_read_b64_tr_b16 a[204:205], v33 offset:16384
    v_and_b32 v14, 1, v1
    v_mfma_f32_16x16x32_bf16 v[210:213], a[212:215], a[4:7], 0
    ds_read_b64_tr_b16 a[206:207], v33 offset:18432
    s_waitcnt vmcnt(11) lgkmcnt(8)
    v_mfma_f32_16x16x32_bf16 v[182:185], a[216:219], a[8:11], v[182:185]
    ds_read_b64_tr_b16 a[208:209], v32 offset:16384
    buffer_load_dwordx4 a[56:59], v78, s[28:31], s1 offen offset:2048 sc1
    v_mfma_f32_16x16x32_bf16 v[190:193], a[216:219], a[12:15], v[190:193]
    ds_read_b64_tr_b16 a[210:211], v32 offset:18432
    v_lshl_add_u32 v14, v3, 2, v14
    v_mfma_f32_16x16x32_bf16 v[198:201], a[220:223], a[8:11], v[198:201]
    ds_read_b64_tr_b16 a[212:213], v34 offset:16384
    v_lshlrev_b32 v14, 2, v14
    v_mfma_f32_16x16x32_bf16 v[206:209], a[220:223], a[12:15], v[206:209]
    ds_read_b64_tr_b16 a[214:215], v34 offset:18432
    s_waitcnt lgkmcnt(8)
    v_mfma_f32_16x16x32_bf16 v[186:189], a[224:227], a[8:11], v[186:189]
    ds_read_b64_tr_b16 a[216:217], v31 offset:20480
    buffer_load_dwordx4 a[60:63], v78, s[28:31], s1 offen offset:2304 sc1
    v_mfma_f32_16x16x32_bf16 v[194:197], a[224:227], a[12:15], v[194:197]
    ds_read_b64_tr_b16 a[218:219], v31 offset:22528
    s_add_u32 s1, s1, 8192
    v_add_u32 v15, 64, v14
    v_mfma_f32_16x16x32_bf16 v[202:205], a[228:231], a[8:11], v[202:205]
    ds_read_b64_tr_b16 a[220:221], v33 offset:20480
    s_and_b32 s1, s1, 0xffff
    v_mfma_f32_16x16x32_bf16 v[210:213], a[228:231], a[12:15], v[210:213]
    ds_read_b64_tr_b16 a[222:223], v33 offset:22528
    s_waitcnt vmcnt(10) lgkmcnt(8)
    v_mfma_f32_16x16x32_bf16 v[182:185], a[200:203], a[16:19], v[182:185]
    ds_read_b64_tr_b16 a[224:225], v32 offset:20480
    buffer_load_dwordx4 a[64:67], v78, s[28:31], s1 offen offset:0 sc1
    v_mfma_f32_16x16x32_bf16 v[190:193], a[200:203], a[20:23], v[190:193]
    ds_read_b64_tr_b16 a[226:227], v32 offset:22528
    v_cndmask_b32 v16, v14, v15, s[72:73]
    v_mfma_f32_16x16x32_bf16 v[198:201], a[204:207], a[16:19], v[198:201]
    ds_read_b64_tr_b16 a[228:229], v34 offset:20480
    buffer_load_dwordx4 a[68:71], v78, s[28:31], s1 offen offset:256 sc1
    v_mfma_f32_16x16x32_bf16 v[206:209], a[204:207], a[20:23], v[206:209]
    ds_read_b64_tr_b16 a[230:231], v34 offset:22528
    v_cndmask_b32 v14, v14, v15, s[74:75]
    s_waitcnt lgkmcnt(8)
    v_mfma_f32_16x16x32_bf16 v[186:189], a[208:211], a[16:19], v[186:189]
    ds_read_b64_tr_b16 a[200:201], v31 offset:32768
    ds_bpermute_b32 v25, v13, v76 offset:64
    v_mfma_f32_16x16x32_bf16 v[194:197], a[208:211], a[20:23], v[194:197]
    ds_read_b64_tr_b16 a[202:203], v31 offset:34816
    buffer_load_dwordx4 a[72:75], v78, s[28:31], s1 offen offset:2048 sc1
    ds_bpermute_b32 v27, v16, v76 offset:0
    v_mfma_f32_16x16x32_bf16 v[202:205], a[212:215], a[16:19], v[202:205]
    ds_read_b64_tr_b16 a[204:205], v33 offset:32768
    ds_bpermute_b32 v28, v14, v76 offset:8
    v_mfma_f32_16x16x32_bf16 v[210:213], a[212:215], a[20:23], v[210:213]
    ds_read_b64_tr_b16 a[206:207], v33 offset:34816
    s_waitcnt vmcnt(11) lgkmcnt(11)
    v_mfma_f32_16x16x32_bf16 v[182:185], a[216:219], a[24:27], v[182:185]
    ds_read_b64_tr_b16 a[208:209], v32 offset:32768
    ds_bpermute_b32 v26, v13, v76 offset:128
    v_mfma_f32_16x16x32_bf16 v[190:193], a[216:219], a[28:31], v[190:193]
    ds_read_b64_tr_b16 a[210:211], v32 offset:34816
    buffer_load_dwordx4 a[76:79], v78, s[28:31], s1 offen offset:2304 sc1
    ds_bpermute_b32 v29, v16, v76 offset:64
    v_mfma_f32_16x16x32_bf16 v[198:201], a[220:223], a[24:27], v[198:201]
    ds_read_b64_tr_b16 a[212:213], v34 offset:32768
    s_add_u32 s1, s1, 8192
    v_mfma_f32_16x16x32_bf16 v[206:209], a[220:223], a[28:31], v[206:209]
    ds_read_b64_tr_b16 a[214:215], v34 offset:34816
    s_waitcnt lgkmcnt(13)
    v_mfma_f32_16x16x32_bf16 v[186:189], a[224:227], a[24:27], v[186:189]
    ds_read_b64_tr_b16 a[216:217], v31 offset:36864
    s_and_b32 s1, s1, 0xffff
    v_mfma_f32_16x16x32_bf16 v[194:197], a[224:227], a[28:31], v[194:197]
    ds_read_b64_tr_b16 a[218:219], v31 offset:38912
    buffer_load_dwordx4 a[80:83], v78, s[28:31], s1 offen offset:0 sc1
    ds_bpermute_b32 v30, v14, v76 offset:72
    v_mfma_f32_16x16x32_bf16 v[202:205], a[228:231], a[24:27], v[202:205]
    ds_read_b64_tr_b16 a[220:221], v33 offset:36864
    v_mfma_f32_16x16x32_bf16 v[210:213], a[228:231], a[28:31], v[210:213]
    ds_read_b64_tr_b16 a[222:223], v33 offset:38912
    s_waitcnt vmcnt(11) lgkmcnt(11)
    v_mfma_f32_16x16x32_bf16 v[182:185], a[200:203], a[32:35], v[182:185]
    ds_read_b64_tr_b16 a[224:225], v32 offset:36864
    buffer_load_dwordx4 a[84:87], v78, s[28:31], s1 offen offset:256 sc1
    v_mfma_f32_16x16x32_bf16 v[190:193], a[200:203], a[36:39], v[190:193]
    ds_read_b64_tr_b16 a[226:227], v32 offset:38912
    v_mfma_f32_16x16x32_bf16 v[198:201], a[204:207], a[32:35], v[198:201]
    ds_read_b64_tr_b16 a[228:229], v34 offset:36864
    v_mfma_f32_16x16x32_bf16 v[206:209], a[204:207], a[36:39], v[206:209]
    ds_read_b64_tr_b16 a[230:231], v34 offset:38912
    s_waitcnt lgkmcnt(9)
    v_mfma_f32_16x16x32_bf16 v[186:189], a[208:211], a[32:35], v[186:189]
    s_barrier
    ds_read_b64_tr_b16 a[200:201], v31 offset:49152
    buffer_load_dwordx4 a[88:91], v78, s[28:31], s1 offen offset:2048 sc1
    v_mfma_f32_16x16x32_bf16 v[194:197], a[208:211], a[36:39], v[194:197]
    ds_read_b64_tr_b16 a[202:203], v31 offset:51200
    v_mfma_f32_16x16x32_bf16 v[202:205], a[212:215], a[32:35], v[202:205]
    ds_read_b64_tr_b16 a[204:205], v33 offset:49152
    buffer_load_dwordx4 a[92:95], v78, s[28:31], s1 offen offset:2304 sc1
    v_mfma_f32_16x16x32_bf16 v[210:213], a[212:215], a[36:39], v[210:213]
    ds_read_b64_tr_b16 a[206:207], v33 offset:51200
    s_waitcnt vmcnt(12) lgkmcnt(8)
    v_mfma_f32_16x16x32_bf16 v[182:185], a[216:219], a[40:43], v[182:185]
    ds_read_b64_tr_b16 a[208:209], v32 offset:49152
    s_add_u32 m0, s58, 131072
    v_mfma_f32_16x16x32_bf16 v[190:193], a[216:219], a[44:47], v[190:193]
    ds_read_b64_tr_b16 a[210:211], v32 offset:51200
    s_add_u32 s0, s0, 458752
    v_mul_f32 v25, s83, v25
    v_mfma_f32_16x16x32_bf16 v[198:201], a[220:223], a[40:43], v[198:201]
    ds_read_b64_tr_b16 a[212:213], v34 offset:49152
    s_cmp_eq_u32 s0, 3670016
    v_mfma_f32_16x16x32_bf16 v[206:209], a[220:223], a[44:47], v[206:209]
    ds_read_b64_tr_b16 a[214:215], v34 offset:51200
    s_cselect_b32 s0, 0, s0
    v_xor_b32 v55, 128, v55
    buffer_load_dwordx4 v55, s[20:23], s0 offen lds
    s_waitcnt lgkmcnt(8)
    v_mfma_f32_16x16x32_bf16 v[186:189], a[224:227], a[40:43], v[186:189]
    ds_read_b64_tr_b16 a[216:217], v31 offset:53248
    v_xor_b32 v56, 128, v56
    v_mfma_f32_16x16x32_bf16 v[194:197], a[224:227], a[44:47], v[194:197]
    ds_read_b64_tr_b16 a[218:219], v31 offset:55296
    buffer_load_dwordx4 v56, s[20:23], s0 offen offset:1024 lds
    v_mul_f32 v26, s83, v26
    v_mfma_f32_16x16x32_bf16 v[202:205], a[228:231], a[40:43], v[202:205]
    ds_read_b64_tr_b16 a[220:221], v33 offset:53248
    v_xor_b32 v57, 128, v57
    v_mfma_f32_16x16x32_bf16 v[210:213], a[228:231], a[44:47], v[210:213]
    ds_read_b64_tr_b16 a[222:223], v33 offset:55296
    s_waitcnt vmcnt(12) lgkmcnt(8)
    v_mfma_f32_16x16x32_bf16 v[182:185], a[200:203], a[48:51], v[182:185]
    ds_read_b64_tr_b16 a[224:225], v32 offset:53248
    buffer_load_dwordx4 v57, s[20:23], s0 offen offset:2048 lds
    v_mfma_f32_16x16x32_bf16 v[190:193], a[200:203], a[52:55], v[190:193]
    ds_read_b64_tr_b16 a[226:227], v32 offset:55296
    v_xor_b32 v58, 128, v58
    s_cmp_eq_u32 s49, 0
    s_cselect_b64 s[76:77], 0, -1
    v_mfma_f32_16x16x32_bf16 v[198:201], a[204:207], a[48:51], v[198:201]
    ds_read_b64_tr_b16 a[228:229], v34 offset:53248
    v_mov_b32 v13, 0xffff
    v_mfma_f32_16x16x32_bf16 v[206:209], a[204:207], a[52:55], v[206:209]
    ds_read_b64_tr_b16 a[230:231], v34 offset:55296
    s_waitcnt lgkmcnt(8)
    v_mfma_f32_16x16x32_bf16 v[186:189], a[208:211], a[48:51], v[186:189]
    ds_read_b64_tr_b16 a[200:201], v35 offset:0
    buffer_load_dwordx4 v58, s[20:23], s0 offen offset:3072 lds
    v_mfma_f32_16x16x32_bf16 v[194:197], a[208:211], a[52:55], v[194:197]
    ds_read_b64_tr_b16 a[202:203], v35 offset:2048
    s_add_u32 s1, s1, 8192
    v_mov_b32 v14, 0xffff0000
    v_mfma_f32_16x16x32_bf16 v[202:205], a[212:215], a[48:51], v[202:205]
    ds_read_b64_tr_b16 a[204:205], v37 offset:0
    s_and_b32 s1, s1, 0xffff
    v_mfma_f32_16x16x32_bf16 v[210:213], a[212:215], a[52:55], v[210:213]
    ds_read_b64_tr_b16 a[206:207], v37 offset:2048
    v_cndmask_b32 v13, v13, v14, s[70:71]
    s_waitcnt vmcnt(12) lgkmcnt(8)
    v_mfma_f32_16x16x32_bf16 v[182:185], a[216:219], a[56:59], v[182:185]
    ds_read_b64_tr_b16 a[208:209], v36 offset:0
    buffer_load_dwordx4 a[96:99], v78, s[28:31], s1 offen offset:0 sc1
    v_mfma_f32_16x16x32_bf16 v[190:193], a[216:219], a[60:63], v[190:193]
    ds_read_b64_tr_b16 a[210:211], v36 offset:2048
    v_cndmask_b32 v104, v13, 0, s[72:73]
    v_mfma_f32_16x16x32_bf16 v[198:201], a[220:223], a[56:59], v[198:201]
    ds_read_b64_tr_b16 a[212:213], v38 offset:0
    buffer_load_dwordx4 a[100:103], v78, s[28:31], s1 offen offset:256 sc1
    v_mfma_f32_16x16x32_bf16 v[206:209], a[220:223], a[60:63], v[206:209]
    ds_read_b64_tr_b16 a[214:215], v38 offset:2048
    v_cndmask_b32 v106, 0, v13, s[72:73]
    s_waitcnt lgkmcnt(8)
    v_mfma_f32_16x16x32_bf16 v[186:189], a[224:227], a[56:59], v[186:189]
    ds_read_b64_tr_b16 a[216:217], v35 offset:4096
    v_cndmask_b32 v105, v13, 0, s[74:75]
    v_mfma_f32_16x16x32_bf16 v[194:197], a[224:227], a[60:63], v[194:197]
    ds_read_b64_tr_b16 a[218:219], v35 offset:6144
    buffer_load_dwordx4 a[104:107], v78, s[28:31], s1 offen offset:2048 sc1
    v_cndmask_b32 v107, 0, v13, s[74:75]
    v_mfma_f32_16x16x32_bf16 v[202:205], a[228:231], a[56:59], v[202:205]
    ds_read_b64_tr_b16 a[220:221], v37 offset:4096
    v_mov_b32 v84, 0xf149f2ca
    v_mfma_f32_16x16x32_bf16 v[210:213], a[228:231], a[60:63], v[210:213]
    ds_read_b64_tr_b16 a[222:223], v37 offset:6144
    s_waitcnt vmcnt(13) lgkmcnt(8)
    v_mfma_f32_16x16x32_bf16 v[182:185], a[200:203], a[64:67], v[182:185]
    ds_read_b64_tr_b16 a[224:225], v36 offset:4096
    buffer_load_dwordx4 a[108:111], v78, s[28:31], s1 offen offset:2304 sc1
    v_mfma_f32_16x16x32_bf16 v[190:193], a[200:203], a[68:71], v[190:193]
    ds_read_b64_tr_b16 a[226:227], v36 offset:6144
    s_add_u32 m0, s58, 147456
    s_mov_b32 s83, 0x3e8b97f6
    v_mfma_f32_16x16x32_bf16 v[198:201], a[204:207], a[64:67], v[198:201]
    ds_read_b64_tr_b16 a[228:229], v38 offset:4096
    s_add_u32 s0, s0, 458752
    v_mfma_f32_16x16x32_bf16 v[206:209], a[204:207], a[68:71], v[206:209]
    ds_read_b64_tr_b16 a[230:231], v38 offset:6144
    s_mov_b32 s78, 0xbdd2d3e8
    s_mov_b32 s79, 0xbdd2d3e8
    s_waitcnt lgkmcnt(8)
    v_mfma_f32_16x16x32_bf16 v[186:189], a[208:211], a[64:67], v[186:189]
    s_barrier
    s_load_dword s14, s[44:45], s15
    ds_read_b64_tr_b16 a[200:201], v35 offset:16384
    s_cmp_eq_u32 s0, 3670016
    s_cselect_b32 s0, 0, s0
    buffer_load_dwordx4 v55, s[20:23], s0 offen lds
    v_mfma_f32_16x16x32_bf16 v[194:197], a[208:211], a[68:71], v[194:197]
    ds_read_b64_tr_b16 a[202:203], v35 offset:18432
    s_mov_b32 s80, 1.0
    v_mfma_f32_16x16x32_bf16 v[202:205], a[212:215], a[64:67], v[202:205]
    ds_read_b64_tr_b16 a[204:205], v37 offset:16384
    buffer_load_dwordx4 v56, s[20:23], s0 offen offset:1024 lds
    v_mfma_f32_16x16x32_bf16 v[210:213], a[212:215], a[68:71], v[210:213]
    ds_read_b64_tr_b16 a[206:207], v37 offset:18432
    s_mov_b32 s81, 1.0
    s_waitcnt vmcnt(14) lgkmcnt(8)
    v_mfma_f32_16x16x32_bf16 v[182:185], a[216:219], a[72:75], v[182:185]
    ds_read_b64_tr_b16 a[208:209], v36 offset:16384
    v_mov_b32 v108, 0xc0135761
    v_mfma_f32_16x16x32_bf16 v[190:193], a[216:219], a[76:79], v[190:193]
    ds_read_b64_tr_b16 a[210:211], v36 offset:18432
    buffer_load_dwordx4 v57, s[20:23], s0 offen offset:2048 lds
    v_mov_b32 v109, 0xc0135761
    v_mfma_f32_16x16x32_bf16 v[198:201], a[220:223], a[72:75], v[198:201]
    ds_read_b64_tr_b16 a[212:213], v38 offset:16384
    v_lshrrev_b32 v13, 1, v2
    v_mfma_f32_16x16x32_bf16 v[206:209], a[220:223], a[76:79], v[206:209]
    ds_read_b64_tr_b16 a[214:215], v38 offset:18432
    s_waitcnt lgkmcnt(8)
    v_mfma_f32_16x16x32_bf16 v[186:189], a[224:227], a[72:75], v[186:189]
    ds_read_b64_tr_b16 a[216:217], v35 offset:20480
    buffer_load_dwordx4 v58, s[20:23], s0 offen offset:3072 lds
    v_mfma_f32_16x16x32_bf16 v[194:197], a[224:227], a[76:79], v[194:197]
    ds_read_b64_tr_b16 a[218:219], v35 offset:22528
    s_add_u32 s1, s1, 8192
    v_lshlrev_b32 v14, 1, v3
    v_mfma_f32_16x16x32_bf16 v[202:205], a[228:231], a[72:75], v[202:205]
    ds_read_b64_tr_b16 a[220:221], v37 offset:20480
    s_and_b32 s1, s1, 0xffff
    v_mfma_f32_16x16x32_bf16 v[210:213], a[228:231], a[76:79], v[210:213]
    ds_read_b64_tr_b16 a[222:223], v37 offset:22528
    s_waitcnt vmcnt(14) lgkmcnt(8)
    v_mfma_f32_16x16x32_bf16 v[182:185], a[200:203], a[80:83], v[182:185]
    ds_read_b64_tr_b16 a[224:225], v36 offset:20480
    buffer_load_dwordx4 a[112:115], v78, s[28:31], s1 offen offset:0 sc1
    v_mfma_f32_16x16x32_bf16 v[190:193], a[200:203], a[84:87], v[190:193]
    ds_read_b64_tr_b16 a[226:227], v36 offset:22528
L_pad0:
    s_cbranch_execz L_warm
    v_sub_u32 v13, v13, v14
    v_mfma_f32_16x16x32_bf16 v[198:201], a[204:207], a[80:83], v[198:201]
    ds_read_b64_tr_b16 a[228:229], v38 offset:20480
    buffer_load_dwordx4 a[116:119], v78, s[28:31], s1 offen offset:256 sc1
    v_mfma_f32_16x16x32_bf16 v[206:209], a[204:207], a[84:87], v[206:209]
    ds_read_b64_tr_b16 a[230:231], v38 offset:22528
    v_mov_b32 v14, 0x3f80
    s_waitcnt lgkmcnt(8)
    v_mfma_f32_16x16x32_bf16 v[186:189], a[208:211], a[80:83], v[186:189]
    ds_read_b64_tr_b16 a[200:201], v35 offset:32768
    v_cndmask_b32 v14, v14, 1.0, s[70:71]
    v_mfma_f32_16x16x32_bf16 v[194:197], a[208:211], a[84:87], v[194:197]
    ds_read_b64_tr_b16 a[202:203], v35 offset:34816
    buffer_load_dwordx4 a[120:123], v78, s[28:31], s1 offen offset:2048 sc1
    v_cmp_eq_i32 vcc, 0, v13
    v_mfma_f32_16x16x32_bf16 v[202:205], a[212:215], a[80:83], v[202:205]
    ds_read_b64_tr_b16 a[204:205], v37 offset:32768
    v_accvgpr_write_b32 a248, 0
    v_mfma_f32_16x16x32_bf16 v[210:213], a[212:215], a[84:87], v[210:213]
    ds_read_b64_tr_b16 a[206:207], v37 offset:34816
    s_waitcnt vmcnt(15) lgkmcnt(8)
    v_mfma_f32_16x16x32_bf16 v[182:185], a[216:219], a[88:91], v[182:185]
    ds_read_b64_tr_b16 a[208:209], v36 offset:32768
    buffer_load_dwordx4 a[124:127], v78, s[28:31], s1 offen offset:2304 sc1
    v_mfma_f32_16x16x32_bf16 v[190:193], a[216:219], a[92:95], v[190:193]
    ds_read_b64_tr_b16 a[210:211], v36 offset:34816
    s_add_u32 m0, s58, 0
    v_accvgpr_write_b32 a252, 0
    v_mfma_f32_16x16x32_bf16 v[198:201], a[220:223], a[88:91], v[198:201]
    ds_read_b64_tr_b16 a[212:213], v38 offset:32768
    s_add_u32 s0, s0, 458752
    v_mfma_f32_16x16x32_bf16 v[206:209], a[220:223], a[92:95], v[206:209]
    ds_read_b64_tr_b16 a[214:215], v38 offset:34816
    s_waitcnt lgkmcnt(8)
    v_mfma_f32_16x16x32_bf16 v[186:189], a[224:227], a[88:91], v[186:189]
    ds_read_b64_tr_b16 a[216:217], v35 offset:36864
    s_cmp_eq_u32 s0, 3670016
    v_mfma_f32_16x16x32_bf16 v[194:197], a[224:227], a[92:95], v[194:197]
    ds_read_b64_tr_b16 a[218:219], v35 offset:38912
    s_cselect_b32 s0, 0, s0
    buffer_load_dwordx4 v55, s[20:23], s0 offen lds
    v_cndmask_b32 v15, 0, v14, vcc
    v_mfma_f32_16x16x32_bf16 v[202:205], a[228:231], a[88:91], v[202:205]
    ds_read_b64_tr_b16 a[220:221], v37 offset:36864
    v_accvgpr_write_b32 a250, v15
    v_mfma_f32_16x16x32_bf16 v[210:213], a[228:231], a[92:95], v[210:213]
    ds_read_b64_tr_b16 a[222:223], v37 offset:38912
    s_waitcnt vmcnt(11) lgkmcnt(8)
    v_mfma_f32_16x16x32_bf16 v[182:185], a[200:203], a[96:99], v[182:185]
    ds_read_b64_tr_b16 a[224:225], v36 offset:36864
    buffer_load_dwordx4 v56, s[20:23], s0 offen offset:1024 lds
    v_mfma_f32_16x16x32_bf16 v[190:193], a[200:203], a[100:103], v[190:193]
    ds_read_b64_tr_b16 a[226:227], v36 offset:38912
    v_cmp_eq_i32 vcc, 1, v13
    v_mfma_f32_16x16x32_bf16 v[198:201], a[204:207], a[96:99], v[198:201]
    ds_read_b64_tr_b16 a[228:229], v38 offset:36864
    buffer_load_dwordx4 v57, s[20:23], s0 offen offset:2048 lds
    v_mfma_f32_16x16x32_bf16 v[206:209], a[204:207], a[100:103], v[206:209]
    ds_read_b64_tr_b16 a[230:231], v38 offset:38912
    v_accvgpr_write_b32 a249, 0
    s_waitcnt lgkmcnt(8)
    v_mfma_f32_16x16x32_bf16 v[186:189], a[208:211], a[96:99], v[186:189]
    s_waitcnt vmcnt(7)
    s_barrier
    ds_read_b64_tr_b16 a[200:201], v35 offset:49152
    buffer_load_dwordx4 v58, s[20:23], s0 offen offset:3072 lds
    v_mfma_f32_16x16x32_bf16 v[194:197], a[208:211], a[100:103], v[194:197]
    ds_read_b64_tr_b16 a[202:203], v35 offset:51200
    s_add_u32 m0, s58, 16384
    v_accvgpr_write_b32 a253, 0
    v_mfma_f32_16x16x32_bf16 v[202:205], a[212:215], a[96:99], v[202:205]
    ds_read_b64_tr_b16 a[204:205], v37 offset:49152
    s_add_u32 s0, s0, 458752
    v_mfma_f32_16x16x32_bf16 v[210:213], a[212:215], a[100:103], v[210:213]
    ds_read_b64_tr_b16 a[206:207], v37 offset:51200
    s_waitcnt lgkmcnt(8)
    v_mfma_f32_16x16x32_bf16 v[182:185], a[216:219], a[104:107], v[182:185]
    ds_read_b64_tr_b16 a[208:209], v36 offset:49152
    s_cmp_eq_u32 s0, 3670016
    v_mfma_f32_16x16x32_bf16 v[190:193], a[216:219], a[108:111], v[190:193]
    ds_read_b64_tr_b16 a[210:211], v36 offset:51200
    s_cselect_b32 s0, 0, s0
    buffer_load_dwordx4 v55, s[20:23], s0 offen lds
    v_cndmask_b32 v15, 0, v14, vcc
    v_mfma_f32_16x16x32_bf16 v[198:201], a[220:223], a[104:107], v[198:201]
    ds_read_b64_tr_b16 a[212:213], v38 offset:49152
    v_accvgpr_write_b32 a251, v15
    v_mfma_f32_16x16x32_bf16 v[206:209], a[220:223], a[108:111], v[206:209]
    ds_read_b64_tr_b16 a[214:215], v38 offset:51200
    s_waitcnt lgkmcnt(8)
    v_mfma_f32_16x16x32_bf16 v[186:189], a[224:227], a[104:107], v[186:189]
    ds_read_b64_tr_b16 a[216:217], v35 offset:53248
    buffer_load_dwordx4 v56, s[20:23], s0 offen offset:1024 lds
    v_mfma_f32_16x16x32_bf16 v[194:197], a[224:227], a[108:111], v[194:197]
    ds_read_b64_tr_b16 a[218:219], v35 offset:55296
    v_mfma_f32_16x16x32_bf16 v[202:205], a[228:231], a[104:107], v[202:205]
    ds_read_b64_tr_b16 a[220:221], v37 offset:53248
    buffer_load_dwordx4 v57, s[20:23], s0 offen offset:2048 lds
    v_mfma_f32_16x16x32_bf16 v[210:213], a[228:231], a[108:111], v[210:213]
    ds_read_b64_tr_b16 a[222:223], v37 offset:55296
    s_waitcnt vmcnt(9) lgkmcnt(8)
    v_mfma_f32_16x16x32_bf16 v[182:185], a[200:203], a[112:115], v[182:185]
    ds_read_b64_tr_b16 a[224:225], v36 offset:53248
    v_mfma_f32_16x16x32_bf16 v[190:193], a[200:203], a[116:119], v[190:193]
    ds_read_b64_tr_b16 a[226:227], v36 offset:55296
    buffer_load_dwordx4 v58, s[20:23], s0 offen offset:3072 lds
    v_mfma_f32_16x16x32_bf16 v[198:201], a[204:207], a[112:115], v[198:201]
    ds_read_b64_tr_b16 a[228:229], v38 offset:53248
    s_add_u32 m0, s58, 32768
    v_mfma_f32_16x16x32_bf16 v[206:209], a[204:207], a[116:119], v[206:209]
    ds_read_b64_tr_b16 a[230:231], v38 offset:55296
    s_waitcnt lgkmcnt(8)
    v_mfma_f32_16x16x32_bf16 v[186:189], a[208:211], a[112:115], v[186:189]
    s_waitcnt lgkmcnt(0)
    s_cmp_ge_u32 s14, 14
    s_cbranch_scc0 L_pollin1
L_pollok1:
    ds_read_b64_tr_b16 a[200:201], v39 offset:0
    s_add_u32 s0, s0, 458752
    v_mfma_f32_16x16x32_bf16 v[194:197], a[208:211], a[116:119], v[194:197]
    ds_read_b64_tr_b16 a[202:203], v39 offset:2048
    s_cmp_eq_u32 s0, 3670016
    s_cselect_b32 s0, 0, s0
    buffer_load_dwordx4 v55, s[20:23], s0 offen lds
    v_mfma_f32_16x16x32_bf16 v[202:205], a[212:215], a[112:115], v[202:205]
    ds_read_b64_tr_b16 a[204:205], v41 offset:0
    v_mfma_f32_16x16x32_bf16 v[210:213], a[212:215], a[116:119], v[210:213]
    ds_read_b64_tr_b16 a[206:207], v41 offset:2048
    s_waitcnt vmcnt(9)
    v_mfma_f32_16x16x32_bf16 v[182:185], a[216:219], a[120:123], v[182:185]
    ds_read_b64_tr_b16 a[208:209], v40 offset:0
    buffer_load_dwordx4 v56, s[20:23], s0 offen offset:1024 lds
    v_mfma_f32_16x16x32_bf16 v[190:193], a[216:219], a[124:127], v[190:193]
    ds_read_b64_tr_b16 a[210:211], v40 offset:2048
    v_mfma_f32_16x16x32_bf16 v[198:201], a[220:223], a[120:123], v[198:201]
    ds_read_b64_tr_b16 a[212:213], v42 offset:0
    buffer_load_dwordx4 v57, s[20:23], s0 offen offset:2048 lds
    v_mfma_f32_16x16x32_bf16 v[206:209], a[220:223], a[124:127], v[206:209]
    ds_read_b64_tr_b16 a[214:215], v42 offset:2048
    v_mfma_f32_16x16x32_bf16 v[186:189], a[224:227], a[120:123], v[186:189]
    ds_read_b64_tr_b16 a[216:217], v39 offset:4096
    v_mfma_f32_16x16x32_bf16 v[194:197], a[224:227], a[124:127], v[194:197]
    ds_read_b64_tr_b16 a[218:219], v39 offset:6144
    v_mfma_f32_16x16x32_bf16 v[202:205], a[228:231], a[120:123], v[202:205]
    ds_read_b64_tr_b16 a[220:221], v41 offset:4096
    buffer_load_dwordx4 v58, s[20:23], s0 offen offset:3072 lds
    v_mfma_f32_16x16x32_bf16 v[210:213], a[228:231], a[124:127], v[210:213]
    ds_read_b64_tr_b16 a[222:223], v41 offset:6144
    s_waitcnt lgkmcnt(8)
    v_mfma_f32_16x16x32_bf16 v[150:153], a[200:203], a[0:3], v[150:153]
    ds_read_b64_tr_b16 a[224:225], v40 offset:4096
    s_add_u32 m0, s58, 49152
    v_mfma_f32_16x16x32_bf16 v[158:161], a[200:203], a[4:7], v[158:161]
    ds_read_b64_tr_b16 a[226:227], v40 offset:6144
    s_add_u32 s0, s0, 458752
    v_mfma_f32_16x16x32_bf16 v[166:169], a[204:207], a[0:3], 0
    ds_read_b64_tr_b16 a[228:229], v42 offset:4096
    s_cmp_eq_u32 s0, 3670016
    s_cselect_b32 s0, 0, s0
    buffer_load_dwordx4 v55, s[20:23], s0 offen lds
    v_mfma_f32_16x16x32_bf16 v[174:177], a[204:207], a[4:7], 0
    ds_read_b64_tr_b16 a[230:231], v42 offset:6144
    v_cvt_pk_bf16_f32 v182, v182, v183
    v_cvt_pk_bf16_f32 v183, v184, v185
    v_cvt_pk_bf16_f32 v184, v186, v187
    s_waitcnt lgkmcnt(8)
    v_mfma_f32_16x16x32_bf16 v[154:157], a[208:211], a[0:3], v[154:157]
    s_waitcnt vmcnt(5)
    s_barrier
    ds_read_b64_tr_b16 a[200:201], v39 offset:16384
    buffer_load_dwordx4 v56, s[20:23], s0 offen offset:1024 lds
    v_mfma_f32_16x16x32_bf16 v[162:165], a[208:211], a[4:7], v[162:165]
    ds_read_b64_tr_b16 a[202:203], v39 offset:18432
    v_cvt_pk_bf16_f32 v185, v188, v189
    buffer_store_dwordx4 v[182:185], v23, s[28:31], 0 offen offset:0 sc1
    v_cvt_pk_bf16_f32 v190, v190, v191
    v_cvt_pk_bf16_f32 v191, v192, v193
    v_cvt_pk_bf16_f32 v192, v194, v195
    v_mfma_f32_16x16x32_bf16 v[170:173], a[212:215], a[0:3], 0
    ds_read_b64_tr_b16 a[204:205], v41 offset:16384
    v_cvt_pk_bf16_f32 v193, v196, v197
    v_mfma_f32_16x16x32_bf16 v[178:181], a[212:215], a[4:7], 0
    ds_read_b64_tr_b16 a[206:207], v41 offset:18432
    buffer_store_dwordx4 v[190:193], v23, s[28:31], 0 offen offset:1024 sc1
    v_cvt_pk_bf16_f32 v198, v198, v199
    v_cvt_pk_bf16_f32 v199, v200, v201
    v_cvt_pk_bf16_f32 v200, v202, v203
    s_waitcnt lgkmcnt(8)
    v_mfma_f32_16x16x32_bf16 v[150:153], a[216:219], a[8:11], v[150:153]
    ds_read_b64_tr_b16 a[208:209], v40 offset:16384
    buffer_load_dwordx4 v57, s[20:23], s0 offen offset:2048 lds
    v_mfma_f32_16x16x32_bf16 v[158:161], a[216:219], a[12:15], v[158:161]
    ds_read_b64_tr_b16 a[210:211], v40 offset:18432
    v_cvt_pk_bf16_f32 v201, v204, v205
    buffer_store_dwordx4 v[198:201], v23, s[28:31], 0 offen offset:2048 sc1
    v_cvt_pk_bf16_f32 v206, v206, v207
    v_cvt_pk_bf16_f32 v207, v208, v209
    v_cvt_pk_bf16_f32 v208, v210, v211
    v_mfma_f32_16x16x32_bf16 v[166:169], a[220:223], a[8:11], v[166:169]
    ds_read_b64_tr_b16 a[212:213], v42 offset:16384
    v_cvt_pk_bf16_f32 v209, v212, v213
    v_mfma_f32_16x16x32_bf16 v[174:177], a[220:223], a[12:15], v[174:177]
    ds_read_b64_tr_b16 a[214:215], v42 offset:18432
    s_waitcnt lgkmcnt(8)
    v_mfma_f32_16x16x32_bf16 v[154:157], a[224:227], a[8:11], v[154:157]
    ds_read_b64_tr_b16 a[216:217], v39 offset:20480
    buffer_load_dwordx4 v58, s[20:23], s0 offen offset:3072 lds
    v_mfma_f32_16x16x32_bf16 v[162:165], a[224:227], a[12:15], v[162:165]
    ds_read_b64_tr_b16 a[218:219], v39 offset:22528
    s_add_u32 m0, s58, 65536
    buffer_store_dwordx4 v[206:209], v23, s[28:31], 0 offen offset:3072 sc1
    v_mfma_f32_16x16x32_bf16 v[170:173], a[228:231], a[8:11], v[170:173]
    ds_read_b64_tr_b16 a[220:221], v41 offset:20480
    s_add_u32 s0, s0, 458752
    v_mfma_f32_16x16x32_bf16 v[178:181], a[228:231], a[12:15], v[178:181]
    ds_read_b64_tr_b16 a[222:223], v41 offset:22528
    s_waitcnt lgkmcnt(8)
    v_mfma_f32_16x16x32_bf16 v[150:153], a[200:203], a[16:19], v[150:153]
    ds_read_b64_tr_b16 a[224:225], v40 offset:20480
    s_cmp_eq_u32 s0, 3670016
    v_mfma_f32_16x16x32_bf16 v[158:161], a[200:203], a[20:23], v[158:161]
    ds_read_b64_tr_b16 a[226:227], v40 offset:22528
    s_cselect_b32 s0, 0, s0
    buffer_load_dwordx4 v55, s[20:23], s0 offen lds
    v_mfma_f32_16x16x32_bf16 v[166:169], a[204:207], a[16:19], v[166:169]
    ds_read_b64_tr_b16 a[228:229], v42 offset:20480
    v_mfma_f32_16x16x32_bf16 v[174:177], a[204:207], a[20:23], v[174:177]
    ds_read_b64_tr_b16 a[230:231], v42 offset:22528
    s_waitcnt lgkmcnt(8)
    v_mfma_f32_16x16x32_bf16 v[154:157], a[208:211], a[16:19], v[154:157]
    ds_read_b64_tr_b16 a[200:201], v31 offset:0
    buffer_load_dwordx4 v56, s[20:23], s0 offen offset:1024 lds
    v_mfma_f32_16x16x32_bf16 v[162:165], a[208:211], a[20:23], v[162:165]
    ds_read_b64_tr_b16 a[202:203], v31 offset:2048
    v_mfma_f32_16x16x32_bf16 v[170:173], a[212:215], a[16:19], v[170:173]
    ds_read_b64_tr_b16 a[204:205], v33 offset:0
    buffer_load_dwordx4 v57, s[20:23], s0 offen offset:2048 lds
    v_mfma_f32_16x16x32_bf16 v[178:181], a[212:215], a[20:23], v[178:181]
    ds_read_b64_tr_b16 a[206:207], v33 offset:2048
    s_waitcnt lgkmcnt(8)
    v_mfma_f32_16x16x32_bf16 v[150:153], a[216:219], a[24:27], v[150:153]
    ds_read_b64_tr_b16 a[208:209], v32 offset:0
    v_mfma_f32_16x16x32_bf16 v[158:161], a[216:219], a[28:31], v[158:161]
    ds_read_b64_tr_b16 a[210:211], v32 offset:2048
    buffer_load_dwordx4 v58, s[20:23], s0 offen offset:3072 lds
    v_mfma_f32_16x16x32_bf16 v[166:169], a[220:223], a[24:27], v[166:169]
    ds_read_b64_tr_b16 a[212:213], v34 offset:0
    s_add_u32 m0, s58, 81920
    v_mfma_f32_16x16x32_bf16 v[174:177], a[220:223], a[28:31], v[174:177]
    ds_read_b64_tr_b16 a[214:215], v34 offset:2048
    s_waitcnt lgkmcnt(8)
    v_mfma_f32_16x16x32_bf16 v[154:157], a[224:227], a[24:27], v[154:157]
    ds_read_b64_tr_b16 a[216:217], v31 offset:4096
    s_add_u32 s0, s0, 458752
    v_mfma_f32_16x16x32_bf16 v[162:165], a[224:227], a[28:31], v[162:165]
    ds_read_b64_tr_b16 a[218:219], v31 offset:6144
    s_cmp_eq_u32 s0, 3670016
    v_mfma_f32_16x16x32_bf16 v[170:173], a[228:231], a[24:27], v[170:173]
    ds_read_b64_tr_b16 a[220:221], v33 offset:4096
    s_cselect_b32 s0, 0, s0
    buffer_load_dwordx4 v55, s[20:23], s0 offen lds
    v_mfma_f32_16x16x32_bf16 v[178:181], a[228:231], a[28:31], v[178:181]
    ds_read_b64_tr_b16 a[222:223], v33 offset:6144
    s_waitcnt lgkmcnt(8)
    v_mfma_f32_16x16x32_bf16 v[150:153], a[200:203], a[32:35], v[150:153]
    ds_read_b64_tr_b16 a[224:225], v32 offset:4096
    buffer_load_dwordx4 v56, s[20:23], s0 offen offset:1024 lds
    v_mfma_f32_16x16x32_bf16 v[158:161], a[200:203], a[36:39], v[158:161]
    ds_read_b64_tr_b16 a[226:227], v32 offset:6144
    v_mfma_f32_16x16x32_bf16 v[166:169], a[204:207], a[32:35], v[166:169]
    ds_read_b64_tr_b16 a[228:229], v34 offset:4096
    v_mfma_f32_16x16x32_bf16 v[174:177], a[204:207], a[36:39], v[174:177]
    ds_read_b64_tr_b16 a[230:231], v34 offset:6144
    s_waitcnt lgkmcnt(8)
    v_mfma_f32_16x16x32_bf16 v[154:157], a[208:211], a[32:35], v[154:157]
    s_waitcnt vmcnt(7)
    s_barrier
    s_waitcnt vmcnt(6)
    s_atomic_add s36, s[28:29], s37
    ds_read_b64_tr_b16 a[200:201], v31 offset:16384
    buffer_load_dwordx4 v57, s[20:23], s0 offen offset:2048 lds
    v_mfma_f32_16x16x32_bf16 v[162:165], a[208:211], a[36:39], v[162:165]
    ds_read_b64_tr_b16 a[202:203], v31 offset:18432
    v_mfma_f32_16x16x32_bf16 v[170:173], a[212:215], a[32:35], v[170:173]
    ds_read_b64_tr_b16 a[204:205], v33 offset:16384
    buffer_load_dwordx4 v58, s[20:23], s0 offen offset:3072 lds
    v_mfma_f32_16x16x32_bf16 v[178:181], a[212:215], a[36:39], v[178:181]
    ds_read_b64_tr_b16 a[206:207], v33 offset:18432
    s_waitcnt lgkmcnt(8)
    v_mfma_f32_16x16x32_bf16 v[150:153], a[216:219], a[40:43], v[150:153]
    ds_read_b64_tr_b16 a[208:209], v32 offset:16384
    s_add_u32 m0, s59, 98304
    v_mfma_f32_16x16x32_bf16 v[158:161], a[216:219], a[44:47], v[158:161]
    ds_read_b64_tr_b16 a[210:211], v32 offset:18432
    buffer_load_dwordx4 v80, s[28:31], s63 offen sc1 lds
    v_mfma_f32_16x16x32_bf16 v[166:169], a[220:223], a[40:43], v[166:169]
    ds_read_b64_tr_b16 a[212:213], v34 offset:16384
    v_mfma_f32_16x16x32_bf16 v[174:177], a[220:223], a[44:47], v[174:177]
    ds_read_b64_tr_b16 a[214:215], v34 offset:18432
    s_waitcnt lgkmcnt(8)
    v_mfma_f32_16x16x32_bf16 v[154:157], a[224:227], a[40:43], v[154:157]
    ds_read_b64_tr_b16 a[216:217], v31 offset:20480
    v_mfma_f32_16x16x32_bf16 v[162:165], a[224:227], a[44:47], v[162:165]
    ds_read_b64_tr_b16 a[218:219], v31 offset:22528
    buffer_load_dwordx4 v80, s[28:31], s63 offen offset:1024 sc1 lds
    v_mfma_f32_16x16x32_bf16 v[170:173], a[228:231], a[40:43], v[170:173]
    ds_read_b64_tr_b16 a[220:221], v33 offset:20480
    v_mfma_f32_16x16x32_bf16 v[178:181], a[228:231], a[44:47], v[178:181]
    ds_read_b64_tr_b16 a[222:223], v33 offset:22528
    s_waitcnt lgkmcnt(8)
    v_mfma_f32_16x16x32_bf16 v[150:153], a[200:203], a[48:51], v[150:153]
    ds_read_b64_tr_b16 a[224:225], v32 offset:20480
    buffer_load_dwordx4 v80, s[28:31], s63 offen offset:2048 sc1 lds
    v_mfma_f32_16x16x32_bf16 v[158:161], a[200:203], a[52:55], v[158:161]
    ds_read_b64_tr_b16 a[226:227], v32 offset:22528
    s_add_u32 m0, s100, 126976
    v_mfma_f32_16x16x32_bf16 v[166:169], a[204:207], a[48:51], v[166:169]
    ds_read_b64_tr_b16 a[228:229], v34 offset:20480
    v_mfma_f32_16x16x32_bf16 v[174:177], a[204:207], a[52:55], v[174:177]
    ds_read_b64_tr_b16 a[230:231], v34 offset:22528
    s_waitcnt lgkmcnt(8)
    v_mfma_f32_16x16x32_bf16 v[154:157], a[208:211], a[48:51], v[154:157]
    ds_read_b64_tr_b16 a[200:201], v31 offset:32768
    buffer_load_dwordx4 v69, s[28:31], s62 offen sc1 lds
    v_mfma_f32_16x16x32_bf16 v[162:165], a[208:211], a[52:55], v[162:165]
    ds_read_b64_tr_b16 a[202:203], v31 offset:34816
    s_add_u32 m0, s58, 110592
    v_mfma_f32_16x16x32_bf16 v[170:173], a[212:215], a[48:51], v[170:173]
    ds_read_b64_tr_b16 a[204:205], v33 offset:32768
    v_mfma_f32_16x16x32_bf16 v[178:181], a[212:215], a[52:55], v[178:181]
    ds_read_b64_tr_b16 a[206:207], v33 offset:34816
    s_waitcnt lgkmcnt(8)
    v_mfma_f32_16x16x32_bf16 v[150:153], a[216:219], a[56:59], v[150:153]
    ds_read_b64_tr_b16 a[208:209], v32 offset:32768
    buffer_load_dwordx4 v67, s[28:31], s62 offen sc1 lds
    v_mfma_f32_16x16x32_bf16 v[158:161], a[216:219], a[60:63], v[158:161]
    ds_read_b64_tr_b16 a[210:211], v32 offset:34816
    v_mfma_f32_16x16x32_bf16 v[166:169], a[220:223], a[56:59], v[166:169]
    ds_read_b64_tr_b16 a[212:213], v34 offset:32768
    v_mfma_f32_16x16x32_bf16 v[174:177], a[220:223], a[60:63], v[174:177]
    ds_read_b64_tr_b16 a[214:215], v34 offset:34816
    s_waitcnt lgkmcnt(8)
    v_mfma_f32_16x16x32_bf16 v[154:157], a[224:227], a[56:59], v[154:157]
    ds_read_b64_tr_b16 a[216:217], v31 offset:36864
    buffer_load_dwordx4 v67, s[28:31], s62 offen offset:1024 sc1 lds
    v_mfma_f32_16x16x32_bf16 v[162:165], a[224:227], a[60:63], v[162:165]
    ds_read_b64_tr_b16 a[218:219], v31 offset:38912
    v_mfma_f32_16x16x32_bf16 v[170:173], a[228:231], a[56:59], v[170:173]
    ds_read_b64_tr_b16 a[220:221], v33 offset:36864
    buffer_load_dwordx4 v68, s[28:31], s62 offen offset:2048 sc1 lds
    v_mfma_f32_16x16x32_bf16 v[178:181], a[228:231], a[60:63], v[178:181]
    ds_read_b64_tr_b16 a[222:223], v33 offset:38912
    s_waitcnt lgkmcnt(8)
    v_mfma_f32_16x16x32_bf16 v[150:153], a[200:203], a[64:67], v[150:153]
    ds_read_b64_tr_b16 a[224:225], v32 offset:36864
    v_mfma_f32_16x16x32_bf16 v[158:161], a[200:203], a[68:71], v[158:161]
    ds_read_b64_tr_b16 a[226:227], v32 offset:38912
    v_mfma_f32_16x16x32_bf16 v[166:169], a[204:207], a[64:67], v[166:169]
    ds_read_b64_tr_b16 a[228:229], v34 offset:36864
    buffer_load_dwordx4 v68, s[28:31], s62 offen offset:3072 sc1 lds
    v_mfma_f32_16x16x32_bf16 v[174:177], a[204:207], a[68:71], v[174:177]
    ds_read_b64_tr_b16 a[230:231], v34 offset:38912
    s_waitcnt lgkmcnt(8)
    v_mfma_f32_16x16x32_bf16 v[154:157], a[208:211], a[64:67], v[154:157]
    s_waitcnt vmcnt(8)
    s_barrier
    s_xor_b32 s37, s37, 1024
    s_load_dword s14, s[28:29], s37
    ds_read_b64_tr_b16 a[200:201], v31 offset:49152
    s_add_u32 m0, s59, 131072
    v_mfma_f32_16x16x32_bf16 v[162:165], a[208:211], a[68:71], v[162:165]
    ds_read_b64_tr_b16 a[202:203], v31 offset:51200
    s_add_u32 s63, s63, 12288
    v_mfma_f32_16x16x32_bf16 v[170:173], a[212:215], a[64:67], v[170:173]
    ds_read_b64_tr_b16 a[204:205], v33 offset:49152
    s_cmp_eq_u32 s63, 86016
    s_cselect_b32 s63, 0, s63
    buffer_load_dwordx4 v80, s[28:31], s63 offen sc1 lds
    v_mfma_f32_16x16x32_bf16 v[178:181], a[212:215], a[68:71], v[178:181]
    ds_read_b64_tr_b16 a[206:207], v33 offset:51200
    s_waitcnt lgkmcnt(8)
    v_mfma_f32_16x16x32_bf16 v[150:153], a[216:219], a[72:75], v[150:153]
    ds_read_b64_tr_b16 a[208:209], v32 offset:49152
    buffer_load_dwordx4 v80, s[28:31], s63 offen offset:1024 sc1 lds
    v_mfma_f32_16x16x32_bf16 v[158:161], a[216:219], a[76:79], v[158:161]
    ds_read_b64_tr_b16 a[210:211], v32 offset:51200
    v_mfma_f32_16x16x32_bf16 v[166:169], a[220:223], a[72:75], v[166:169]
    ds_read_b64_tr_b16 a[212:213], v34 offset:49152
    v_mfma_f32_16x16x32_bf16 v[174:177], a[220:223], a[76:79], v[174:177]
    ds_read_b64_tr_b16 a[214:215], v34 offset:51200
    s_waitcnt lgkmcnt(8)
    v_mfma_f32_16x16x32_bf16 v[154:157], a[224:227], a[72:75], v[154:157]
    ds_read_b64_tr_b16 a[216:217], v31 offset:53248
    buffer_load_dwordx4 v80, s[28:31], s63 offen offset:2048 sc1 lds
    v_mfma_f32_16x16x32_bf16 v[162:165], a[224:227], a[76:79], v[162:165]
    ds_read_b64_tr_b16 a[218:219], v31 offset:55296
    s_add_u32 m0, s100, 159744
    v_mfma_f32_16x16x32_bf16 v[170:173], a[228:231], a[72:75], v[170:173]
    ds_read_b64_tr_b16 a[220:221], v33 offset:53248
    s_add_u32 s62, s62, 262144
    v_mfma_f32_16x16x32_bf16 v[178:181], a[228:231], a[76:79], v[178:181]
    ds_read_b64_tr_b16 a[222:223], v33 offset:55296
    s_waitcnt lgkmcnt(8)
    v_mfma_f32_16x16x32_bf16 v[150:153], a[200:203], a[80:83], v[150:153]
    ds_read_b64_tr_b16 a[224:225], v32 offset:53248
    s_cmp_eq_u32 s62, 1835008
    v_mfma_f32_16x16x32_bf16 v[158:161], a[200:203], a[84:87], v[158:161]
    ds_read_b64_tr_b16 a[226:227], v32 offset:55296
    s_cselect_b32 s62, 0, s62
    buffer_load_dwordx4 v69, s[28:31], s62 offen sc1 lds
    v_mfma_f32_16x16x32_bf16 v[166:169], a[204:207], a[80:83], v[166:169]
    ds_read_b64_tr_b16 a[228:229], v34 offset:53248
    s_add_u32 m0, s58, 143360
    v_mfma_f32_16x16x32_bf16 v[174:177], a[204:207], a[84:87], v[174:177]
    ds_read_b64_tr_b16 a[230:231], v34 offset:55296
    s_waitcnt lgkmcnt(8)
    v_mfma_f32_16x16x32_bf16 v[154:157], a[208:211], a[80:83], v[154:157]
    s_barrier
    ds_read_b64_tr_b16 a[200:201], v37 offset:0
    buffer_load_dwordx4 v67, s[28:31], s62 offen sc1 lds
    v_mfma_f32_16x16x32_bf16 v[162:165], a[208:211], a[84:87], v[162:165]
    ds_read_b64_tr_b16 a[202:203], v37 offset:2048
    v_mfma_f32_16x16x32_bf16 v[170:173], a[212:215], a[80:83], v[170:173]
    ds_read_b64_tr_b16 a[204:205], v38 offset:0
    buffer_load_dwordx4 v67, s[28:31], s62 offen offset:1024 sc1 lds
    v_mfma_f32_16x16x32_bf16 v[178:181], a[212:215], a[84:87], v[178:181]
    ds_read_b64_tr_b16 a[206:207], v38 offset:2048
    s_waitcnt lgkmcnt(8)
    v_mfma_f32_16x16x32_bf16 v[150:153], a[216:219], a[88:91], v[150:153]
    ds_read_b64_tr_b16 a[208:209], v37 offset:4096
    v_mfma_f32_16x16x32_bf16 v[158:161], a[216:219], a[92:95], v[158:161]
    ds_read_b64_tr_b16 a[210:211], v37 offset:6144
    v_mfma_f32_16x16x32_bf16 v[166:169], a[220:223], a[88:91], v[166:169]
    ds_read_b64_tr_b16 a[212:213], v38 offset:4096
    buffer_load_dwordx4 v68, s[28:31], s62 offen offset:2048 sc1 lds
    v_mfma_f32_16x16x32_bf16 v[174:177], a[220:223], a[92:95], v[174:177]
    ds_read_b64_tr_b16 a[214:215], v38 offset:6144
    s_waitcnt lgkmcnt(8)
    v_mfma_f32_16x16x32_bf16 v[154:157], a[224:227], a[88:91], v[154:157]
    ds_read_b64_tr_b16 a[216:217], v37 offset:16384
    v_mfma_f32_16x16x32_bf16 v[162:165], a[224:227], a[92:95], v[162:165]
    ds_read_b64_tr_b16 a[218:219], v37 offset:18432
    buffer_load_dwordx4 v68, s[28:31], s62 offen offset:3072 sc1 lds
    v_mfma_f32_16x16x32_bf16 v[170:173], a[228:231], a[88:91], v[170:173]
    ds_read_b64_tr_b16 a[220:221], v38 offset:16384
    s_add_u32 m0, s59, 0
    v_mfma_f32_16x16x32_bf16 v[178:181], a[228:231], a[92:95], v[178:181]
    ds_read_b64_tr_b16 a[222:223], v38 offset:18432
    s_waitcnt lgkmcnt(8)
    v_mfma_f32_16x16x32_bf16 v[166:169], a[200:203], a[96:99], v[166:169]
    s_waitcnt lgkmcnt(0)
    s_cmp_ge_u32 s14, 2
    s_cbranch_scc0 L_pollin2
L_pollok2:
    v_xor_b32 v23, 131072, v23
    v_xor_b32 v22, 8192, v23
    ds_read_b64_tr_b16 a[224:225], v37 offset:20480
    buffer_load_dwordx4 v[214:217], v23, s[28:31], 0 offen offset:0 sc1
    v_mfma_f32_16x16x32_bf16 v[174:177], a[200:203], a[100:103], v[174:177]
    ds_read_b64_tr_b16 a[226:227], v37 offset:22528
    v_mfma_f32_16x16x32_bf16 v[170:173], a[204:207], a[96:99], v[170:173]
    ds_read_b64_tr_b16 a[228:229], v38 offset:20480
    buffer_load_dwordx4 v[218:221], v23, s[28:31], 0 offen offset:1024 sc1
    v_mfma_f32_16x16x32_bf16 v[178:181], a[204:207], a[100:103], v[178:181]
    ds_read_b64_tr_b16 a[230:231], v38 offset:22528
    v_mfma_f32_16x16x32_bf16 v[166:169], a[208:211], a[104:107], v[166:169]
    ds_read_b64_tr_b16 a[200:201], v35 offset:0
    buffer_load_dwordx4 v[222:225], v22, s[28:31], 0 offen offset:2048 sc1
    v_mfma_f32_16x16x32_bf16 v[174:177], a[208:211], a[108:111], v[174:177]
    ds_read_b64_tr_b16 a[202:203], v35 offset:2048
    v_mfma_f32_16x16x32_bf16 v[170:173], a[212:215], a[104:107], v[170:173]
    ds_read_b64_tr_b16 a[204:205], v36 offset:0
    buffer_load_dwordx4 v[226:229], v22, s[28:31], 0 offen offset:3072 sc1
    v_mfma_f32_16x16x32_bf16 v[178:181], a[212:215], a[108:111], v[178:181]
    ds_read_b64_tr_b16 a[206:207], v36 offset:2048
    v_mfma_f32_16x16x32_bf16 v[166:169], a[216:219], a[112:115], v[166:169]
    ds_read_b64_tr_b16 a[208:209], v35 offset:4096
    s_add_u32 s63, s63, 12288
    v_mfma_f32_16x16x32_bf16 v[174:177], a[216:219], a[116:119], v[174:177]
    ds_read_b64_tr_b16 a[210:211], v35 offset:6144
    s_cmp_eq_u32 s63, 86016
    s_cselect_b32 s63, 0, s63
    buffer_load_dwordx4 v80, s[28:31], s63 offen sc1 lds
    v_mfma_f32_16x16x32_bf16 v[170:173], a[220:223], a[112:115], v[170:173]
    ds_read_b64_tr_b16 a[212:213], v36 offset:4096
    v_mfma_f32_16x16x32_bf16 v[178:181], a[220:223], a[116:119], v[178:181]
    ds_read_b64_tr_b16 a[214:215], v36 offset:6144
    s_waitcnt lgkmcnt(8)
    v_mfma_f32_16x16x32_bf16 v[166:169], a[224:227], a[120:123], v[166:169]
    ds_read_b64_tr_b16 a[216:217], v35 offset:16384
    buffer_load_dwordx4 v80, s[28:31], s63 offen offset:1024 sc1 lds
    v_mfma_f32_16x16x32_bf16 v[174:177], a[224:227], a[124:127], v[174:177]
    ds_read_b64_tr_b16 a[218:219], v35 offset:18432
    v_mfma_f32_16x16x32_bf16 v[170:173], a[228:231], a[120:123], v[170:173]
    ds_read_b64_tr_b16 a[220:221], v36 offset:16384
    v_mfma_f32_16x16x32_bf16 v[178:181], a[228:231], a[124:127], v[178:181]
    ds_read_b64_tr_b16 a[222:223], v36 offset:18432
    s_waitcnt lgkmcnt(8)
    v_mfma_f32_16x16x32_bf16 v[150:153], a[200:203], a[96:99], v[150:153]
    ds_read_b64_tr_b16 a[224:225], v35 offset:20480
    buffer_load_dwordx4 v80, s[28:31], s63 offen offset:2048 sc1 lds
    v_mfma_f32_16x16x32_bf16 v[158:161], a[200:203], a[100:103], v[158:161]
    ds_read_b64_tr_b16 a[226:227], v35 offset:22528
    s_add_u32 m0, s100, 28672
    v_mfma_f32_16x16x32_bf16 v[154:157], a[204:207], a[96:99], v[154:157]
    ds_read_b64_tr_b16 a[228:229], v36 offset:20480
    s_add_u32 s62, s62, 262144
    v_mfma_f32_16x16x32_bf16 v[162:165], a[204:207], a[100:103], v[162:165]
    ds_read_b64_tr_b16 a[230:231], v36 offset:22528
    ds_write_b128 v81, v[166:169] offset:32768
    s_waitcnt lgkmcnt(9)
    v_mfma_f32_16x16x32_bf16 v[150:153], a[208:211], a[104:107], v[150:153]
    s_cmp_eq_u32 s62, 1835008
    s_cselect_b32 s62, 0, s62
    buffer_load_dwordx4 v69, s[28:31], s62 offen sc1 lds
    v_mfma_f32_16x16x32_bf16 v[158:161], a[208:211], a[108:111], v[158:161]
    s_add_u32 m0, s58, 12288
    ds_write_b128 v81, v[170:173] offset:33792
    v_mfma_f32_16x16x32_bf16 v[154:157], a[212:215], a[104:107], v[154:157]
    buffer_load_dwordx4 v67, s[28:31], s62 offen sc1 lds
    ds_write_b128 v81, v[174:177] offset:34816
    v_mfma_f32_16x16x32_bf16 v[162:165], a[212:215], a[108:111], v[162:165]
    s_waitcnt lgkmcnt(7)
    v_mfma_f32_16x16x32_bf16 v[150:153], a[216:219], a[112:115], v[150:153]
    ds_write_b128 v81, v[178:181] offset:35840
    v_mfma_f32_16x16x32_bf16 v[158:161], a[216:219], a[116:119], v[158:161]
    v_mfma_f32_16x16x32_bf16 v[154:157], a[220:223], a[112:115], v[154:157]
    buffer_load_dwordx4 v67, s[28:31], s62 offen offset:1024 sc1 lds
    v_mfma_f32_16x16x32_bf16 v[162:165], a[220:223], a[116:119], v[162:165]
    s_waitcnt lgkmcnt(4)
    v_mfma_f32_16x16x32_bf16 v[150:153], a[224:227], a[120:123], v[150:153]
    v_mfma_f32_16x16x32_bf16 v[158:161], a[224:227], a[124:127], v[158:161]
    buffer_load_dwordx4 v68, s[28:31], s62 offen offset:2048 sc1 lds
    v_mfma_f32_16x16x32_bf16 v[154:157], a[228:231], a[120:123], v[154:157]
    v_mfma_f32_16x16x32_bf16 v[162:165], a[228:231], a[124:127], v[162:165]
    s_waitcnt vmcnt(10)
    v_mfma_f32_16x16x32_bf16 v[150:153], a[250:253], v[214:217], v[150:153]
    v_xor_b32 v81, 8192, v81
    s_waitcnt lgkmcnt(0)
    s_barrier
    ds_read_b128 v[182:185], v81 offset:32768
    ds_read_b128 v[186:189], v81 offset:33792
    ds_read_b128 v[190:193], v81 offset:34816
    ds_read_b128 v[194:197], v81 offset:35840
    v_mfma_f32_16x16x32_bf16 v[154:157], a[248:251], v[214:217], v[154:157]
    buffer_load_dwordx4 v68, s[28:31], s62 offen offset:3072 sc1 lds
    s_add_u32 m0, s59, 65536
    s_waitcnt vmcnt(10)
    v_mfma_f32_16x16x32_bf16 v[158:161], a[250:253], v[218:221], v[158:161]
    s_add_u32 s63, s63, 12288
    s_cmp_eq_u32 s63, 86016
    v_mfma_f32_16x16x32_bf16 v[162:165], a[248:251], v[218:221], v[162:165]
L_pad1:
    s_cbranch_execz L_warm
    s_cselect_b32 s63, 0, s63
    s_waitcnt vmcnt(9)
    v_mfma_f32_16x16x32_bf16 v[150:153], a[250:253], v[222:225], v[150:153]
    buffer_load_dwordx4 v80, s[28:31], s63 offen sc1 lds
    v_mfma_f32_16x16x32_bf16 v[154:157], a[248:251], v[222:225], v[154:157]
    s_waitcnt vmcnt(9)
    v_mfma_f32_16x16x32_bf16 v[158:161], a[250:253], v[226:229], v[158:161]
    v_mfma_f32_16x16x32_bf16 v[162:165], a[248:251], v[226:229], v[162:165]
    buffer_load_dwordx4 v80, s[28:31], s63 offen offset:1024 sc1 lds
    s_waitcnt lgkmcnt(3)
    s_nop 0
    v_pk_add_f32 v[150:151], v[150:151], v[182:183]
    v_pk_add_f32 v[152:153], v[152:153], v[184:185]
    s_waitcnt lgkmcnt(2)
    v_pk_add_f32 v[154:155], v[154:155], v[186:187]
    v_pk_add_f32 v[156:157], v[156:157], v[188:189]
    v_pk_mul_f32 v[182:183], v[150:151], v[150:151]
    v_pk_mul_f32 v[184:185], v[152:153], v[152:153]
    v_pk_mul_f32 v[186:187], v[154:155], v[154:155]
    v_pk_mul_f32 v[188:189], v[156:157], v[156:157]
    v_pk_fma_f32 v[182:183], v[182:183], s[78:79], v[108:109]
    v_pk_fma_f32 v[184:185], v[184:185], s[78:79], v[108:109]
    v_pk_fma_f32 v[186:187], v[186:187], s[78:79], v[108:109]
    v_pk_fma_f32 v[188:189], v[188:189], s[78:79], v[108:109]
    v_pk_mul_f32 v[182:183], v[182:183], v[150:151]
    buffer_load_dwordx4 v80, s[28:31], s63 offen offset:2048 sc1 lds
    v_pk_mul_f32 v[184:185], v[184:185], v[152:153]
    v_pk_mul_f32 v[186:187], v[186:187], v[154:155]
    v_pk_mul_f32 v[188:189], v[188:189], v[156:157]
    v_exp_f32 v182, v182
    v_exp_f32 v183, v183
    v_exp_f32 v184, v184
    v_exp_f32 v185, v185
    v_exp_f32 v186, v186
    v_exp_f32 v187, v187
    s_add_u32 m0, s100, 94208
    s_add_u32 s62, s62, 262144
    s_cmp_eq_u32 s62, 1835008
    s_cselect_b32 s62, 0, s62
    buffer_load_dwordx4 v69, s[28:31], s62 offen sc1 lds
    v_exp_f32 v188, v188
    v_exp_f32 v189, v189
    v_pk_add_f32 v[182:183], v[182:183], s[80:81]
    v_pk_add_f32 v[184:185], v[184:185], s[80:81]
    v_pk_add_f32 v[186:187], v[186:187], s[80:81]
    v_pk_add_f32 v[188:189], v[188:189], s[80:81]
    v_rcp_f32 v182, v182
    v_rcp_f32 v183, v183
    v_rcp_f32 v184, v184
    s_add_u32 m0, s58, 77824
    s_nop 0
    buffer_load_dwordx4 v67, s[28:31], s62 offen sc1 lds
    v_rcp_f32 v185, v185
    v_rcp_f32 v186, v186
    v_rcp_f32 v187, v187
    v_rcp_f32 v188, v188
    v_rcp_f32 v189, v189
    v_pk_mul_f32 v[182:183], v[182:183], v[150:151]
    v_pk_mul_f32 v[184:185], v[184:185], v[152:153]
    v_pk_mul_f32 v[186:187], v[186:187], v[154:155]
    buffer_load_dwordx4 v67, s[28:31], s62 offen offset:1024 sc1 lds
    v_pk_mul_f32 v[188:189], v[188:189], v[156:157]
    v_cvt_pk_bf16_f32 v110, v182, v183
    v_cvt_pk_bf16_f32 v111, v184, v185
    v_cvt_pk_bf16_f32 v112, v186, v187
    v_cvt_pk_bf16_f32 v113, v188, v189
    s_waitcnt lgkmcnt(1)
    v_pk_add_f32 v[158:159], v[158:159], v[190:191]
    v_pk_add_f32 v[160:161], v[160:161], v[192:193]
    s_waitcnt lgkmcnt(0)
    v_pk_add_f32 v[162:163], v[162:163], v[194:195]
    v_pk_add_f32 v[164:165], v[164:165], v[196:197]
    v_pk_mul_f32 v[190:191], v[158:159], v[158:159]
    v_pk_mul_f32 v[192:193], v[160:161], v[160:161]
    v_pk_mul_f32 v[194:195], v[162:163], v[162:163]
    v_pk_mul_f32 v[196:197], v[164:165], v[164:165]
    v_pk_fma_f32 v[190:191], v[190:191], s[78:79], v[108:109]
    buffer_load_dwordx4 v68, s[28:31], s62 offen offset:2048 sc1 lds
    v_pk_fma_f32 v[192:193], v[192:193], s[78:79], v[108:109]
    v_pk_fma_f32 v[194:195], v[194:195], s[78:79], v[108:109]
    v_pk_fma_f32 v[196:197], v[196:197], s[78:79], v[108:109]
    v_pk_mul_f32 v[190:191], v[190:191], v[158:159]
    v_pk_mul_f32 v[192:193], v[192:193], v[160:161]
    v_pk_mul_f32 v[194:195], v[194:195], v[162:163]
    v_pk_mul_f32 v[196:197], v[196:197], v[164:165]
    v_exp_f32 v190, v190
    v_exp_f32 v191, v191
    v_exp_f32 v192, v192
    v_exp_f32 v193, v193
    buffer_load_dwordx4 v68, s[28:31], s62 offen offset:3072 sc1 lds
    v_exp_f32 v194, v194
    v_exp_f32 v195, v195
    v_exp_f32 v196, v196
    v_exp_f32 v197, v197
    v_pk_add_f32 v[190:191], v[190:191], s[80:81]
    v_pk_add_f32 v[192:193], v[192:193], s[80:81]
    v_pk_add_f32 v[194:195], v[194:195], s[80:81]
    v_pk_add_f32 v[196:197], v[196:197], s[80:81]
    v_rcp_f32 v190, v190
    v_rcp_f32 v191, v191
    v_rcp_f32 v192, v192
    v_rcp_f32 v193, v193
    v_rcp_f32 v194, v194
    v_rcp_f32 v195, v195
    v_rcp_f32 v196, v196
    v_rcp_f32 v197, v197
    v_pk_mul_f32 v[190:191], v[190:191], v[158:159]
    v_pk_mul_f32 v[192:193], v[192:193], v[160:161]
    v_pk_mul_f32 v[194:195], v[194:195], v[162:163]
    v_pk_mul_f32 v[196:197], v[196:197], v[164:165]
    v_cvt_pk_bf16_f32 v114, v190, v191
    v_cvt_pk_bf16_f32 v115, v192, v193
    v_cvt_pk_bf16_f32 v116, v194, v195
    v_cvt_pk_bf16_f32 v117, v196, v197
    ds_read_b64_tr_b16 a[180:181], v72 offset:32768
    ds_read_b64_tr_b16 a[182:183], v72 offset:33024
    ds_read_b128 a[128:131], v53 offset:32768
    ds_read_b64_tr_b16 a[184:185], v72 offset:33792
    ds_read_b64_tr_b16 a[186:187], v72 offset:34048
    ds_read_b128 a[132:135], v53 offset:33792
    ds_read_b128 a[136:139], v53 offset:34816
    ds_read_b64_tr_b16 a[176:177], v73 offset:32768
    ds_read_b64_tr_b16 a[178:179], v73 offset:33024
    ds_read_b128 a[140:143], v53 offset:35840
    ds_read_b128 a[144:147], v53 offset:36864
    ds_read_b128 a[148:151], v53 offset:37888
    buffer_store_dwordx4 v[110:113], v4, s[28:31], s67 offen offset:0 sc1
    buffer_store_dwordx4 v[114:117], v4, s[28:31], s67 offen offset:1024 sc1
L_q:
    s_waitcnt lgkmcnt(6)
    v_mfma_f32_16x16x32_bf16 v[182:185], a[128:131], a[180:183], 0
    ds_read_b64_tr_b16 a[192:193], v72 offset:34816
    v_mfma_f32_16x16x32_bf16 v[190:193], a[128:131], a[184:187], 0
    ds_read_b64_tr_b16 a[194:195], v72 offset:35072
    v_mfma_f32_16x16x32_bf16 v[186:189], a[132:135], a[180:183], 0
    ds_read_b128 a[152:155], v53 offset:38912
    v_mfma_f32_16x16x32_bf16 v[194:197], a[132:135], a[184:187], 0
    ds_read_b64_tr_b16 a[196:197], v72 offset:35840
    s_waitcnt lgkmcnt(4)
    v_mfma_f32_16x16x32_bf16 v[206:209], a[136:139], a[180:183], 0
    ds_read_b64_tr_b16 a[198:199], v72 offset:36096
    v_mfma_f32_16x16x32_bf16 v[214:217], a[136:139], a[184:187], 0
    ds_read_b128 a[156:159], v53 offset:39936
    v_mfma_f32_16x16x32_bf16 v[198:201], a[136:139], a[176:179], 0
    ds_read_b128 a[160:163], v53 offset:40960
    v_mfma_f32_16x16x32_bf16 v[210:213], a[140:143], a[180:183], 0
    ds_read_b64_tr_b16 a[188:189], v73 offset:34816
    v_mfma_f32_16x16x32_bf16 v[218:221], a[140:143], a[184:187], 0
    ds_read_b64_tr_b16 a[190:191], v73 offset:35072
    v_mfma_f32_16x16x32_bf16 v[202:205], a[140:143], a[176:179], 0
    ds_read_b128 a[164:167], v53 offset:41984
    v_mfma_f32_16x16x32_bf16 v[230:233], a[180:183], a[144:147], 0
    ds_read_b128 a[168:171], v53 offset:43008
    v_mfma_f32_16x16x32_bf16 v[238:241], a[184:187], a[144:147], 0
    ds_read_b128 a[172:175], v53 offset:44032
    v_mfma_f32_16x16x32_bf16 v[222:225], a[176:179], a[144:147], 0
    v_mfma_f32_16x16x32_bf16 v[234:237], a[180:183], a[148:151], 0
    v_mfma_f32_16x16x32_bf16 v[242:245], a[184:187], a[148:151], 0
    v_mfma_f32_16x16x32_bf16 v[226:229], a[176:179], a[148:151], 0
    s_waitcnt lgkmcnt(0)
    s_barrier
    v_mfma_f32_16x16x32_bf16 v[182:185], a[152:155], a[192:195], v[182:185]
    ds_read_b64_tr_b16 a[180:181], v74 offset:0
    s_add_u32 m0, s59, 32768
    v_mfma_f32_16x16x32_bf16 v[190:193], a[152:155], a[196:199], v[190:193]
    ds_read_b64_tr_b16 a[182:183], v74 offset:256
    s_add_u32 s63, s63, 12288
    v_mfma_f32_16x16x32_bf16 v[186:189], a[156:159], a[192:195], v[186:189]
    ds_read_b128 a[128:131], v54 offset:0
    s_cmp_eq_u32 s63, 86016
    v_mfma_f32_16x16x32_bf16 v[194:197], a[156:159], a[196:199], v[194:197]
    ds_read_b64_tr_b16 a[184:185], v74 offset:1024
    v_mfma_f32_16x16x32_bf16 v[206:209], a[160:163], a[192:195], v[206:209]
    ds_read_b64_tr_b16 a[186:187], v74 offset:1280
    s_cselect_b32 s63, 0, s63
    v_mfma_f32_16x16x32_bf16 v[214:217], a[160:163], a[196:199], v[214:217]
    ds_read_b128 a[132:135], v54 offset:1024
    buffer_load_dwordx4 v80, s[28:31], s63 offen sc1 lds
    v_mfma_f32_16x16x32_bf16 v[198:201], a[160:163], a[188:191], v[198:201]
    ds_read_b128 a[136:139], v54 offset:2048
    v_mfma_f32_16x16x32_bf16 v[210:213], a[164:167], a[192:195], v[210:213]
    ds_read_b64_tr_b16 a[176:177], v75 offset:0
    buffer_load_dwordx4 v80, s[28:31], s63 offen offset:1024 sc1 lds
    v_mfma_f32_16x16x32_bf16 v[218:221], a[164:167], a[196:199], v[218:221]
    ds_read_b64_tr_b16 a[178:179], v75 offset:256
    v_mfma_f32_16x16x32_bf16 v[202:205], a[164:167], a[188:191], v[202:205]
    ds_read_b128 a[140:143], v54 offset:3072
    v_mfma_f32_16x16x32_bf16 v[230:233], a[192:195], a[168:171], v[230:233]
    ds_read_b128 a[144:147], v54 offset:4096
    buffer_load_dwordx4 v80, s[28:31], s63 offen offset:2048 sc1 lds
    v_mfma_f32_16x16x32_bf16 v[238:241], a[196:199], a[168:171], v[238:241]
    ds_read_b128 a[148:151], v54 offset:5120
    s_add_u32 m0, s100, 61440
    v_mfma_f32_16x16x32_bf16 v[222:225], a[188:191], a[168:171], v[222:225]
    s_add_u32 s62, s62, 262144
    s_cmp_eq_u32 s62, 1835008
    v_mfma_f32_16x16x32_bf16 v[234:237], a[192:195], a[172:175], v[234:237]
    s_cselect_b32 s62, 0, s62
    buffer_load_dwordx4 v69, s[28:31], s62 offen sc1 lds
    v_mfma_f32_16x16x32_bf16 v[242:245], a[196:199], a[172:175], v[242:245]
    s_add_u32 m0, s58, 45056
    v_mfma_f32_16x16x32_bf16 v[226:229], a[188:191], a[172:175], v[226:229]
    s_waitcnt lgkmcnt(6)
    v_mfma_f32_16x16x32_bf16 v[182:185], a[128:131], a[180:183], v[182:185]
    ds_read_b64_tr_b16 a[192:193], v74 offset:2048
    buffer_load_dwordx4 v67, s[28:31], s62 offen sc1 lds
    v_mfma_f32_16x16x32_bf16 v[190:193], a[128:131], a[184:187], v[190:193]
    ds_read_b64_tr_b16 a[194:195], v74 offset:2304
    v_mfma_f32_16x16x32_bf16 v[186:189], a[132:135], a[180:183], v[186:189]
    ds_read_b128 a[152:155], v54 offset:6144
    v_mfma_f32_16x16x32_bf16 v[194:197], a[132:135], a[184:187], v[194:197]
    ds_read_b64_tr_b16 a[196:197], v74 offset:3072
    s_waitcnt lgkmcnt(4)
    v_mfma_f32_16x16x32_bf16 v[206:209], a[136:139], a[180:183], v[206:209]
    ds_read_b64_tr_b16 a[198:199], v74 offset:3328
    buffer_load_dwordx4 v67, s[28:31], s62 offen offset:1024 sc1 lds
    v_mfma_f32_16x16x32_bf16 v[214:217], a[136:139], a[184:187], v[214:217]
    ds_read_b128 a[156:159], v54 offset:7168
    v_mfma_f32_16x16x32_bf16 v[198:201], a[136:139], a[176:179], v[198:201]
    ds_read_b128 a[160:163], v54 offset:8192
    buffer_load_dwordx4 v68, s[28:31], s62 offen offset:2048 sc1 lds
    v_mfma_f32_16x16x32_bf16 v[210:213], a[140:143], a[180:183], v[210:213]
    ds_read_b64_tr_b16 a[188:189], v75 offset:2048
    v_mfma_f32_16x16x32_bf16 v[218:221], a[140:143], a[184:187], v[218:221]
    ds_read_b64_tr_b16 a[190:191], v75 offset:2304
    v_mfma_f32_16x16x32_bf16 v[202:205], a[140:143], a[176:179], v[202:205]
    ds_read_b128 a[164:167], v54 offset:9216
    buffer_load_dwordx4 v68, s[28:31], s62 offen offset:3072 sc1 lds
    v_mfma_f32_16x16x32_bf16 v[230:233], a[180:183], a[144:147], v[230:233]
    ds_read_b128 a[168:171], v54 offset:10240
    s_add_u32 m0, s59, 98304
    v_mfma_f32_16x16x32_bf16 v[238:241], a[184:187], a[144:147], v[238:241]
    ds_read_b128 a[172:175], v54 offset:11264
    s_add_u32 s63, s63, 12288
    v_mfma_f32_16x16x32_bf16 v[222:225], a[176:179], a[144:147], v[222:225]
    s_cmp_eq_u32 s63, 86016
    s_cselect_b32 s63, 0, s63
    v_mfma_f32_16x16x32_bf16 v[234:237], a[180:183], a[148:151], v[234:237]
    buffer_load_dwordx4 v80, s[28:31], s63 offen sc1 lds
    v_mfma_f32_16x16x32_bf16 v[242:245], a[184:187], a[148:151], v[242:245]
    v_mfma_f32_16x16x32_bf16 v[226:229], a[176:179], a[148:151], v[226:229]
    s_waitcnt vmcnt(9) lgkmcnt(0)
    s_barrier
    s_cmp_lg_u32 s48, 0
    s_cbranch_scc1 L_sig2
    s_atomic_add s36, s[28:29], s68
L_sig2:
    v_mfma_f32_16x16x32_bf16 v[182:185], a[152:155], a[192:195], v[182:185]
    ds_read_b64_tr_b16 a[180:181], v70 offset:0
    buffer_load_dwordx4 v80, s[28:31], s63 offen offset:1024 sc1 lds
    v_mfma_f32_16x16x32_bf16 v[190:193], a[152:155], a[196:199], v[190:193]
    ds_read_b64_tr_b16 a[182:183], v70 offset:256
    v_mfma_f32_16x16x32_bf16 v[186:189], a[156:159], a[192:195], v[186:189]
    ds_read_b128 a[128:131], v4 offset:0
    buffer_load_dwordx4 v80, s[28:31], s63 offen offset:2048 sc1 lds
    v_mfma_f32_16x16x32_bf16 v[194:197], a[156:159], a[196:199], v[194:197]
    ds_read_b64_tr_b16 a[184:185], v70 offset:1024
    v_mfma_f32_16x16x32_bf16 v[206:209], a[160:163], a[192:195], v[206:209]
    ds_read_b64_tr_b16 a[186:187], v70 offset:1280
    s_add_u32 m0, s100, 126976
    v_mfma_f32_16x16x32_bf16 v[214:217], a[160:163], a[196:199], v[214:217]
    ds_read_b128 a[132:135], v4 offset:1024
    s_add_u32 s62, s62, 262144
    v_mfma_f32_16x16x32_bf16 v[198:201], a[160:163], a[188:191], v[198:201]
    ds_read_b128 a[136:139], v4 offset:2048
    s_cmp_eq_u32 s62, 1835008
    v_mfma_f32_16x16x32_bf16 v[210:213], a[164:167], a[192:195], v[210:213]
    ds_read_b64_tr_b16 a[176:177], v71 offset:0
    s_cselect_b32 s62, 0, s62
    v_mfma_f32_16x16x32_bf16 v[218:221], a[164:167], a[196:199], v[218:221]
    ds_read_b64_tr_b16 a[178:179], v71 offset:256
    buffer_load_dwordx4 v69, s[28:31], s62 offen sc1 lds
    v_mfma_f32_16x16x32_bf16 v[202:205], a[164:167], a[188:191], v[202:205]
    ds_read_b128 a[140:143], v4 offset:3072
    s_add_u32 m0, s58, 110592
    v_mfma_f32_16x16x32_bf16 v[230:233], a[192:195], a[168:171], v[230:233]
    ds_read_b128 a[144:147], v4 offset:4096
    buffer_load_dwordx4 v67, s[28:31], s62 offen sc1 lds
    v_mfma_f32_16x16x32_bf16 v[238:241], a[196:199], a[168:171], v[238:241]
    ds_read_b128 a[148:151], v4 offset:5120
    v_mfma_f32_16x16x32_bf16 v[222:225], a[188:191], a[168:171], v[222:225]
    v_mfma_f32_16x16x32_bf16 v[234:237], a[192:195], a[172:175], v[234:237]
    buffer_load_dwordx4 v67, s[28:31], s62 offen offset:1024 sc1 lds
    v_mfma_f32_16x16x32_bf16 v[242:245], a[196:199], a[172:175], v[242:245]
    v_mfma_f32_16x16x32_bf16 v[226:229], a[188:191], a[172:175], v[226:229]
    s_waitcnt lgkmcnt(6)
    v_mfma_f32_16x16x32_bf16 v[182:185], a[128:131], a[180:183], v[182:185]
    ds_read_b64_tr_b16 a[192:193], v70 offset:2048
    buffer_load_dwordx4 v68, s[28:31], s62 offen offset:2048 sc1 lds
    v_mfma_f32_16x16x32_bf16 v[190:193], a[128:131], a[184:187], v[190:193]
    ds_read_b64_tr_b16 a[194:195], v70 offset:2304
    v_mfma_f32_16x16x32_bf16 v[186:189], a[132:135], a[180:183], v[186:189]
    ds_read_b128 a[152:155], v4 offset:6144
    v_mfma_f32_16x16x32_bf16 v[194:197], a[132:135], a[184:187], v[194:197]
    ds_read_b64_tr_b16 a[196:197], v70 offset:3072
    s_waitcnt lgkmcnt(4)
    v_mfma_f32_16x16x32_bf16 v[206:209], a[136:139], a[180:183], v[206:209]
    ds_read_b64_tr_b16 a[198:199], v70 offset:3328
    buffer_load_dwordx4 v68, s[28:31], s62 offen offset:3072 sc1 lds
    v_mfma_f32_16x16x32_bf16 v[214:217], a[136:139], a[184:187], v[214:217]
    ds_read_b128 a[156:159], v4 offset:7168
    s_add_u32 m0, s59, 131072
    v_mfma_f32_16x16x32_bf16 v[198:201], a[136:139], a[176:179], v[198:201]
    ds_read_b128 a[160:163], v4 offset:8192
    s_add_u32 s63, s63, 12288
    v_mfma_f32_16x16x32_bf16 v[210:213], a[140:143], a[180:183], v[210:213]
    ds_read_b64_tr_b16 a[188:189], v71 offset:2048
    s_cmp_eq_u32 s63, 86016
    v_mfma_f32_16x16x32_bf16 v[218:221], a[140:143], a[184:187], v[218:221]
    ds_read_b64_tr_b16 a[190:191], v71 offset:2304
    s_cselect_b32 s63, 0, s63
    v_mfma_f32_16x16x32_bf16 v[202:205], a[140:143], a[176:179], v[202:205]
    ds_read_b128 a[164:167], v4 offset:9216
    buffer_load_dwordx4 v80, s[28:31], s63 offen sc1 lds
    v_mfma_f32_16x16x32_bf16 v[230:233], a[180:183], a[144:147], v[230:233]
    ds_read_b128 a[168:171], v4 offset:10240
    v_mfma_f32_16x16x32_bf16 v[238:241], a[184:187], a[144:147], v[238:241]
    ds_read_b128 a[172:175], v4 offset:11264
    buffer_load_dwordx4 v80, s[28:31], s63 offen offset:1024 sc1 lds
    v_mfma_f32_16x16x32_bf16 v[222:225], a[176:179], a[144:147], v[222:225]
    v_mfma_f32_16x16x32_bf16 v[234:237], a[180:183], a[148:151], v[234:237]
    v_mfma_f32_16x16x32_bf16 v[242:245], a[184:187], a[148:151], v[242:245]
    buffer_load_dwordx4 v80, s[28:31], s63 offen offset:2048 sc1 lds
    s_add_u32 m0, s100, 159744
    v_mfma_f32_16x16x32_bf16 v[226:229], a[176:179], a[148:151], v[226:229]
    s_add_u32 s62, s62, 262144
    ds_read_b32 v24, v4
    s_waitcnt lgkmcnt(1)
    s_barrier
    v_mfma_f32_16x16x32_bf16 v[182:185], a[152:155], a[192:195], v[182:185]
    ds_read_b64_tr_b16 a[180:181], v72 offset:0
    s_cmp_eq_u32 s62, 1835008
    v_mfma_f32_16x16x32_bf16 v[190:193], a[152:155], a[196:199], v[190:193]
    ds_read_b64_tr_b16 a[182:183], v72 offset:256
    s_cselect_b32 s62, 0, s62
    v_mfma_f32_16x16x32_bf16 v[186:189], a[156:159], a[192:195], v[186:189]
    ds_read_b128 a[128:131], v53 offset:0
    buffer_load_dwordx4 v69, s[28:31], s62 offen sc1 lds
    v_mfma_f32_16x16x32_bf16 v[194:197], a[156:159], a[196:199], v[194:197]
    ds_read_b64_tr_b16 a[184:185], v72 offset:1024
    v_mfma_f32_16x16x32_bf16 v[206:209], a[160:163], a[192:195], v[206:209]
    ds_read_b64_tr_b16 a[186:187], v72 offset:1280
    s_add_u32 m0, s58, 143360
    v_mfma_f32_16x16x32_bf16 v[214:217], a[160:163], a[196:199], v[214:217]
    ds_read_b128 a[132:135], v53 offset:1024
    buffer_load_dwordx4 v67, s[28:31], s62 offen sc1 lds
    v_mfma_f32_16x16x32_bf16 v[198:201], a[160:163], a[188:191], v[198:201]
    ds_read_b128 a[136:139], v53 offset:2048
    v_mfma_f32_16x16x32_bf16 v[210:213], a[164:167], a[192:195], v[210:213]
    ds_read_b64_tr_b16 a[176:177], v73 offset:0
    buffer_load_dwordx4 v67, s[28:31], s62 offen offset:1024 sc1 lds
    v_mfma_f32_16x16x32_bf16 v[218:221], a[164:167], a[196:199], v[218:221]
    ds_read_b64_tr_b16 a[178:179], v73 offset:256
    v_mfma_f32_16x16x32_bf16 v[202:205], a[164:167], a[188:191], v[202:205]
    ds_read_b128 a[140:143], v53 offset:3072
    v_mfma_f32_16x16x32_bf16 v[230:233], a[192:195], a[168:171], v[230:233]
    ds_read_b128 a[144:147], v53 offset:4096
    buffer_load_dwordx4 v68, s[28:31], s62 offen offset:2048 sc1 lds
    v_mfma_f32_16x16x32_bf16 v[238:241], a[196:199], a[168:171], v[238:241]
    ds_read_b128 a[148:151], v53 offset:5120
    v_mfma_f32_16x16x32_bf16 v[222:225], a[188:191], a[168:171], v[222:225]
    v_mfma_f32_16x16x32_bf16 v[234:237], a[192:195], a[172:175], v[234:237]
    buffer_load_dwordx4 v68, s[28:31], s62 offen offset:3072 sc1 lds
    s_add_u32 m0, s58, 0
    v_mfma_f32_16x16x32_bf16 v[242:245], a[196:199], a[172:175], v[242:245]
    v_mfma_f32_16x16x32_bf16 v[226:229], a[188:191], a[172:175], v[226:229]
    s_waitcnt lgkmcnt(6)
    v_mfma_f32_16x16x32_bf16 v[182:185], a[128:131], a[180:183], v[182:185]
    ds_read_b64_tr_b16 a[192:193], v72 offset:2048
    buffer_load_dwordx4 v59, s[24:27], s64 offen lds
    v_mfma_f32_16x16x32_bf16 v[190:193], a[128:131], a[184:187], v[190:193]
    ds_read_b64_tr_b16 a[194:195], v72 offset:2304
    v_mfma_f32_16x16x32_bf16 v[186:189], a[132:135], a[180:183], v[186:189]
    ds_read_b128 a[152:155], v53 offset:6144
    v_mfma_f32_16x16x32_bf16 v[194:197], a[132:135], a[184:187], v[194:197]
    ds_read_b64_tr_b16 a[196:197], v72 offset:3072
    s_waitcnt lgkmcnt(4)
    v_mfma_f32_16x16x32_bf16 v[206:209], a[136:139], a[180:183], v[206:209]
    ds_read_b64_tr_b16 a[198:199], v72 offset:3328
    buffer_load_dwordx4 v60, s[24:27], s64 offen offset:1024 lds
    v_mfma_f32_16x16x32_bf16 v[214:217], a[136:139], a[184:187], v[214:217]
    ds_read_b128 a[156:159], v53 offset:7168
    v_mfma_f32_16x16x32_bf16 v[198:201], a[136:139], a[176:179], v[198:201]
    ds_read_b128 a[160:163], v53 offset:8192
    v_mfma_f32_16x16x32_bf16 v[210:213], a[140:143], a[180:183], v[210:213]
    ds_read_b64_tr_b16 a[188:189], v73 offset:2048
    buffer_load_dwordx4 v61, s[24:27], s64 offen offset:2048 lds
    v_mfma_f32_16x16x32_bf16 v[218:221], a[140:143], a[184:187], v[218:221]
    ds_read_b64_tr_b16 a[190:191], v73 offset:2304
    v_mfma_f32_16x16x32_bf16 v[202:205], a[140:143], a[176:179], v[202:205]
    ds_read_b128 a[164:167], v53 offset:9216
    v_mfma_f32_16x16x32_bf16 v[230:233], a[180:183], a[144:147], v[230:233]
    ds_read_b128 a[168:171], v53 offset:10240
    buffer_load_dwordx4 v62, s[24:27], s64 offen offset:3072 lds
    v_mfma_f32_16x16x32_bf16 v[238:241], a[184:187], a[144:147], v[238:241]
    ds_read_b128 a[172:175], v53 offset:11264
    s_add_u32 m0, s58, 16384
    v_mfma_f32_16x16x32_bf16 v[222:225], a[176:179], a[144:147], v[222:225]
    v_xor_b32 v59, 128, v59
    v_mfma_f32_16x16x32_bf16 v[234:237], a[180:183], a[148:151], v[234:237]
    buffer_load_dwordx4 v59, s[24:27], s64 offen lds
    v_xor_b32 v60, 128, v60
    v_mfma_f32_16x16x32_bf16 v[242:245], a[184:187], a[148:151], v[242:245]
    v_mfma_f32_16x16x32_bf16 v[226:229], a[176:179], a[148:151], v[226:229]
    ds_read_b32 v24, v4
    s_waitcnt vmcnt(21) lgkmcnt(1)
    s_barrier
    v_mfma_f32_16x16x32_bf16 v[182:185], a[152:155], a[192:195], v[182:185]
    ds_read_b64_tr_b16 a[180:181], v70 offset:32768
    buffer_load_dwordx4 v60, s[24:27], s64 offen offset:1024 lds
    v_mfma_f32_16x16x32_bf16 v[190:193], a[152:155], a[196:199], v[190:193]
    ds_read_b64_tr_b16 a[182:183], v70 offset:33024
    v_xor_b32 v61, 128, v61
    v_mfma_f32_16x16x32_bf16 v[186:189], a[156:159], a[192:195], v[186:189]
    ds_read_b128 a[128:131], v4 offset:32768
    v_mfma_f32_16x16x32_bf16 v[194:197], a[156:159], a[196:199], v[194:197]
    ds_read_b64_tr_b16 a[184:185], v70 offset:33792
    v_mfma_f32_16x16x32_bf16 v[206:209], a[160:163], a[192:195], v[206:209]
    ds_read_b64_tr_b16 a[186:187], v70 offset:34048
    buffer_load_dwordx4 v61, s[24:27], s64 offen offset:2048 lds
    v_mfma_f32_16x16x32_bf16 v[214:217], a[160:163], a[196:199], v[214:217]
    ds_read_b128 a[132:135], v4 offset:33792
    v_xor_b32 v62, 128, v62
    v_mfma_f32_16x16x32_bf16 v[198:201], a[160:163], a[188:191], v[198:201]
    ds_read_b128 a[136:139], v4 offset:34816
    buffer_load_dwordx4 v62, s[24:27], s64 offen offset:3072 lds
    v_mfma_f32_16x16x32_bf16 v[210:213], a[164:167], a[192:195], v[210:213]
    ds_read_b64_tr_b16 a[176:177], v71 offset:32768
    s_add_u32 m0, s58, 65536
    v_mfma_f32_16x16x32_bf16 v[218:221], a[164:167], a[196:199], v[218:221]
    ds_read_b64_tr_b16 a[178:179], v71 offset:33024
    s_add_u32 s64, s64, 524288
    v_mfma_f32_16x16x32_bf16 v[202:205], a[164:167], a[188:191], v[202:205]
    ds_read_b128 a[140:143], v4 offset:35840
    s_cmp_eq_u32 s64, 3670016
    v_mfma_f32_16x16x32_bf16 v[230:233], a[192:195], a[168:171], v[230:233]
    ds_read_b128 a[144:147], v4 offset:36864
    s_cselect_b32 s64, 0, s64
    v_mfma_f32_16x16x32_bf16 v[238:241], a[196:199], a[168:171], v[238:241]
    ds_read_b128 a[148:151], v4 offset:37888
    buffer_load_dwordx4 v59, s[24:27], s64 offen lds
    v_mfma_f32_16x16x32_bf16 v[222:225], a[188:191], a[168:171], v[222:225]
    v_mfma_f32_16x16x32_bf16 v[234:237], a[192:195], a[172:175], v[234:237]
    buffer_load_dwordx4 v60, s[24:27], s64 offen offset:1024 lds
    v_mfma_f32_16x16x32_bf16 v[242:245], a[196:199], a[172:175], v[242:245]
    v_mfma_f32_16x16x32_bf16 v[226:229], a[188:191], a[172:175], v[226:229]
    s_waitcnt lgkmcnt(6)
    v_mfma_f32_16x16x32_bf16 v[182:185], a[128:131], a[180:183], v[182:185]
    ds_read_b64_tr_b16 a[192:193], v70 offset:34816
    buffer_load_dwordx4 v61, s[24:27], s64 offen offset:2048 lds
    v_mfma_f32_16x16x32_bf16 v[190:193], a[128:131], a[184:187], v[190:193]
    ds_read_b64_tr_b16 a[194:195], v70 offset:35072
    v_mfma_f32_16x16x32_bf16 v[186:189], a[132:135], a[180:183], v[186:189]
    ds_read_b128 a[152:155], v4 offset:38912
    v_mfma_f32_16x16x32_bf16 v[194:197], a[132:135], a[184:187], v[194:197]
    ds_read_b64_tr_b16 a[196:197], v70 offset:35840
    s_waitcnt lgkmcnt(4)
    v_mfma_f32_16x16x32_bf16 v[206:209], a[136:139], a[180:183], v[206:209]
    ds_read_b64_tr_b16 a[198:199], v70 offset:36096
    buffer_load_dwordx4 v62, s[24:27], s64 offen offset:3072 lds
    v_mfma_f32_16x16x32_bf16 v[214:217], a[136:139], a[184:187], v[214:217]
    ds_read_b128 a[156:159], v4 offset:39936
    s_add_u32 m0, s58, 81920
    v_mfma_f32_16x16x32_bf16 v[198:201], a[136:139], a[176:179], v[198:201]
    ds_read_b128 a[160:163], v4 offset:40960
    s_add_u32 s64, s64, 524288
    v_mfma_f32_16x16x32_bf16 v[210:213], a[140:143], a[180:183], v[210:213]
    ds_read_b64_tr_b16 a[188:189], v71 offset:34816
    s_cmp_eq_u32 s64, 3670016
    v_mfma_f32_16x16x32_bf16 v[218:221], a[140:143], a[184:187], v[218:221]
    ds_read_b64_tr_b16 a[190:191], v71 offset:35072
    s_cselect_b32 s64, 0, s64
    v_mfma_f32_16x16x32_bf16 v[202:205], a[140:143], a[176:179], v[202:205]
    ds_read_b128 a[164:167], v4 offset:41984
    buffer_load_dwordx4 v59, s[24:27], s64 offen lds
    v_mfma_f32_16x16x32_bf16 v[230:233], a[180:183], a[144:147], v[230:233]
    ds_read_b128 a[168:171], v4 offset:43008
    v_mfma_f32_16x16x32_bf16 v[238:241], a[184:187], a[144:147], v[238:241]
    ds_read_b128 a[172:175], v4 offset:44032
    buffer_load_dwordx4 v60, s[24:27], s64 offen offset:1024 lds
    v_mfma_f32_16x16x32_bf16 v[222:225], a[176:179], a[144:147], v[222:225]
    v_mfma_f32_16x16x32_bf16 v[234:237], a[180:183], a[148:151], v[234:237]
    v_mfma_f32_16x16x32_bf16 v[242:245], a[184:187], a[148:151], v[242:245]
    buffer_load_dwordx4 v61, s[24:27], s64 offen offset:2048 lds
    v_mfma_f32_16x16x32_bf16 v[226:229], a[176:179], a[148:151], v[226:229]
    ds_read_b32 v24, v4
    s_waitcnt vmcnt(23) lgkmcnt(1)
    s_barrier
    v_mfma_f32_16x16x32_bf16 v[182:185], a[152:155], a[192:195], v[182:185]
    ds_read_b64_tr_b16 a[180:181], v72 offset:32768
    v_mfma_f32_16x16x32_bf16 v[190:193], a[152:155], a[196:199], v[190:193]
    ds_read_b64_tr_b16 a[182:183], v72 offset:33024
    buffer_load_dwordx4 v62, s[24:27], s64 offen offset:3072 lds
    v_mfma_f32_16x16x32_bf16 v[186:189], a[156:159], a[192:195], v[186:189]
    ds_read_b128 a[128:131], v53 offset:32768
    s_add_u32 m0, s58, 32768
    v_mfma_f32_16x16x32_bf16 v[194:197], a[156:159], a[196:199], v[194:197]
    ds_read_b64_tr_b16 a[184:185], v72 offset:33792
    v_mfma_f32_16x16x32_bf16 v[206:209], a[160:163], a[192:195], v[206:209]
    ds_read_b64_tr_b16 a[186:187], v72 offset:34048
    s_add_u32 s64, s64, 524288
    v_mfma_f32_16x16x32_bf16 v[214:217], a[160:163], a[196:199], v[214:217]
    ds_read_b128 a[132:135], v53 offset:33792
    s_cmp_eq_u32 s64, 3670016
    v_mfma_f32_16x16x32_bf16 v[198:201], a[160:163], a[188:191], v[198:201]
    ds_read_b128 a[136:139], v53 offset:34816
    s_cselect_b32 s64, 0, s64
    v_mfma_f32_16x16x32_bf16 v[210:213], a[164:167], a[192:195], v[210:213]
    ds_read_b64_tr_b16 a[176:177], v73 offset:32768
    buffer_load_dwordx4 v59, s[24:27], s64 offen lds
    v_mfma_f32_16x16x32_bf16 v[218:221], a[164:167], a[196:199], v[218:221]
    ds_read_b64_tr_b16 a[178:179], v73 offset:33024
    v_mfma_f32_16x16x32_bf16 v[202:205], a[164:167], a[188:191], v[202:205]
    ds_read_b128 a[140:143], v53 offset:35840
    buffer_load_dwordx4 v60, s[24:27], s64 offen offset:1024 lds
    v_mfma_f32_16x16x32_bf16 v[230:233], a[192:195], a[168:171], v[230:233]
    ds_read_b128 a[144:147], v53 offset:36864
    v_mfma_f32_16x16x32_bf16 v[238:241], a[196:199], a[168:171], v[238:241]
    ds_read_b128 a[148:151], v53 offset:37888
    v_mfma_f32_16x16x32_bf16 v[222:225], a[188:191], a[168:171], v[222:225]
    buffer_load_dwordx4 v61, s[24:27], s64 offen offset:2048 lds
    v_mfma_f32_16x16x32_bf16 v[234:237], a[192:195], a[172:175], v[234:237]
    v_mfma_f32_16x16x32_bf16 v[242:245], a[196:199], a[172:175], v[242:245]
    v_mfma_f32_16x16x32_bf16 v[226:229], a[188:191], a[172:175], v[226:229]
    buffer_load_dwordx4 v62, s[24:27], s64 offen offset:3072 lds
    s_load_dword s14, s[28:29], s38
    s_waitcnt lgkmcnt(6)
    v_mfma_f32_16x16x32_bf16 v[182:185], a[128:131], a[180:183], v[182:185]
    ds_read_b64_tr_b16 a[192:193], v72 offset:34816
    s_add_u32 m0, s58, 49152
    v_mfma_f32_16x16x32_bf16 v[190:193], a[128:131], a[184:187], v[190:193]
    ds_read_b64_tr_b16 a[194:195], v72 offset:35072
    s_add_u32 s64, s64, 524288
    v_mfma_f32_16x16x32_bf16 v[186:189], a[132:135], a[180:183], v[186:189]
    ds_read_b128 a[152:155], v53 offset:38912
    s_cmp_eq_u32 s64, 3670016
    v_mfma_f32_16x16x32_bf16 v[194:197], a[132:135], a[184:187], v[194:197]
    ds_read_b64_tr_b16 a[196:197], v72 offset:35840
    s_waitcnt lgkmcnt(4)
    v_mfma_f32_16x16x32_bf16 v[206:209], a[136:139], a[180:183], v[206:209]
    ds_read_b64_tr_b16 a[198:199], v72 offset:36096
    s_cselect_b32 s64, 0, s64
    v_mfma_f32_16x16x32_bf16 v[214:217], a[136:139], a[184:187], v[214:217]
    ds_read_b128 a[156:159], v53 offset:39936
    buffer_load_dwordx4 v59, s[24:27], s64 offen lds
    v_mfma_f32_16x16x32_bf16 v[198:201], a[136:139], a[176:179], v[198:201]
    ds_read_b128 a[160:163], v53 offset:40960
    v_mfma_f32_16x16x32_bf16 v[210:213], a[140:143], a[180:183], v[210:213]
    ds_read_b64_tr_b16 a[188:189], v73 offset:34816
    buffer_load_dwordx4 v60, s[24:27], s64 offen offset:1024 lds
    v_mfma_f32_16x16x32_bf16 v[218:221], a[140:143], a[184:187], v[218:221]
    ds_read_b64_tr_b16 a[190:191], v73 offset:35072
L_pad2:
    s_cbranch_execz L_warm
    v_mfma_f32_16x16x32_bf16 v[202:205], a[140:143], a[176:179], v[202:205]
    ds_read_b128 a[164:167], v53 offset:41984
    v_mfma_f32_16x16x32_bf16 v[230:233], a[180:183], a[144:147], v[230:233]
    ds_read_b128 a[168:171], v53 offset:43008
    buffer_load_dwordx4 v61, s[24:27], s64 offen offset:2048 lds
    v_mfma_f32_16x16x32_bf16 v[238:241], a[184:187], a[144:147], v[238:241]
    ds_read_b128 a[172:175], v53 offset:44032
    v_mfma_f32_16x16x32_bf16 v[222:225], a[176:179], a[144:147], v[222:225]
    v_mfma_f32_16x16x32_bf16 v[234:237], a[180:183], a[148:151], v[234:237]
    buffer_load_dwordx4 v62, s[24:27], s64 offen offset:3072 lds
    v_mfma_f32_16x16x32_bf16 v[242:245], a[184:187], a[148:151], v[242:245]
    v_mfma_f32_16x16x32_bf16 v[226:229], a[176:179], a[148:151], v[226:229]
    ds_read_b32 v24, v4
    s_waitcnt vmcnt(24) lgkmcnt(1)
    s_barrier
    v_mfma_f32_16x16x32_bf16 v[182:185], a[152:155], a[192:195], v[182:185]
    ds_read_b64_tr_b16 a[180:181], v74 offset:0
    s_add_u32 m0, s58, 98304
    v_mfma_f32_16x16x32_bf16 v[190:193], a[152:155], a[196:199], v[190:193]
    ds_read_b64_tr_b16 a[182:183], v74 offset:256
    s_add_u32 s64, s64, 524288
    v_mfma_f32_16x16x32_bf16 v[186:189], a[156:159], a[192:195], v[186:189]
    ds_read_b128 a[128:131], v54 offset:0
    s_cmp_eq_u32 s64, 3670016
    v_mfma_f32_16x16x32_bf16 v[194:197], a[156:159], a[196:199], v[194:197]
    ds_read_b64_tr_b16 a[184:185], v74 offset:1024
    v_mfma_f32_16x16x32_bf16 v[206:209], a[160:163], a[192:195], v[206:209]
    ds_read_b64_tr_b16 a[186:187], v74 offset:1280
    s_cselect_b32 s64, 0, s64
    v_mfma_f32_16x16x32_bf16 v[214:217], a[160:163], a[196:199], v[214:217]
    ds_read_b128 a[132:135], v54 offset:1024
    buffer_load_dwordx4 v59, s[24:27], s64 offen lds
    v_mfma_f32_16x16x32_bf16 v[198:201], a[160:163], a[188:191], v[198:201]
    ds_read_b128 a[136:139], v54 offset:2048
    v_mfma_f32_16x16x32_bf16 v[210:213], a[164:167], a[192:195], v[210:213]
    ds_read_b64_tr_b16 a[176:177], v75 offset:0
    buffer_load_dwordx4 v60, s[24:27], s64 offen offset:1024 lds
    v_mfma_f32_16x16x32_bf16 v[218:221], a[164:167], a[196:199], v[218:221]
    ds_read_b64_tr_b16 a[178:179], v75 offset:256
    v_mfma_f32_16x16x32_bf16 v[202:205], a[164:167], a[188:191], v[202:205]
    ds_read_b128 a[140:143], v54 offset:3072
    v_mfma_f32_16x16x32_bf16 v[230:233], a[192:195], a[168:171], v[230:233]
    ds_read_b128 a[144:147], v54 offset:4096
    buffer_load_dwordx4 v61, s[24:27], s64 offen offset:2048 lds
    v_mfma_f32_16x16x32_bf16 v[238:241], a[196:199], a[168:171], v[238:241]
    ds_read_b128 a[148:151], v54 offset:5120
    v_mfma_f32_16x16x32_bf16 v[222:225], a[188:191], a[168:171], v[222:225]
    v_mfma_f32_16x16x32_bf16 v[234:237], a[192:195], a[172:175], v[234:237]
    buffer_load_dwordx4 v62, s[24:27], s64 offen offset:3072 lds
    s_add_u32 m0, s58, 114688
    v_mfma_f32_16x16x32_bf16 v[242:245], a[196:199], a[172:175], v[242:245]
    s_add_u32 s64, s64, 524288
    s_cmp_eq_u32 s64, 3670016
    v_mfma_f32_16x16x32_bf16 v[226:229], a[188:191], a[172:175], v[226:229]
    s_cselect_b32 s64, 0, s64
    s_waitcnt lgkmcnt(6)
    v_mfma_f32_16x16x32_bf16 v[182:185], a[128:131], a[180:183], v[182:185]
    ds_read_b64_tr_b16 a[192:193], v74 offset:2048
    buffer_load_dwordx4 v59, s[24:27], s64 offen lds
    v_mfma_f32_16x16x32_bf16 v[190:193], a[128:131], a[184:187], v[190:193]
    ds_read_b64_tr_b16 a[194:195], v74 offset:2304
    v_mfma_f32_16x16x32_bf16 v[186:189], a[132:135], a[180:183], v[186:189]
    ds_read_b128 a[152:155], v54 offset:6144
    v_mfma_f32_16x16x32_bf16 v[194:197], a[132:135], a[184:187], v[194:197]
    ds_read_b64_tr_b16 a[196:197], v74 offset:3072
    s_waitcnt lgkmcnt(4)
    v_mfma_f32_16x16x32_bf16 v[206:209], a[136:139], a[180:183], v[206:209]
    ds_read_b64_tr_b16 a[198:199], v74 offset:3328
    buffer_load_dwordx4 v60, s[24:27], s64 offen offset:1024 lds
    v_mfma_f32_16x16x32_bf16 v[214:217], a[136:139], a[184:187], v[214:217]
    ds_read_b128 a[156:159], v54 offset:7168
    v_mfma_f32_16x16x32_bf16 v[198:201], a[136:139], a[176:179], v[198:201]
    ds_read_b128 a[160:163], v54 offset:8192
    buffer_load_dwordx4 v61, s[24:27], s64 offen offset:2048 lds
    v_mfma_f32_16x16x32_bf16 v[210:213], a[140:143], a[180:183], v[210:213]
    ds_read_b64_tr_b16 a[188:189], v75 offset:2048
    v_mfma_f32_16x16x32_bf16 v[218:221], a[140:143], a[184:187], v[218:221]
    ds_read_b64_tr_b16 a[190:191], v75 offset:2304
    v_mfma_f32_16x16x32_bf16 v[202:205], a[140:143], a[176:179], v[202:205]
    ds_read_b128 a[164:167], v54 offset:9216
    buffer_load_dwordx4 v62, s[24:27], s64 offen offset:3072 lds
    v_mfma_f32_16x16x32_bf16 v[230:233], a[180:183], a[144:147], v[230:233]
    ds_read_b128 a[168:171], v54 offset:10240
    v_mfma_f32_16x16x32_bf16 v[238:241], a[184:187], a[144:147], v[238:241]
    ds_read_b128 a[172:175], v54 offset:11264
    v_mfma_f32_16x16x32_bf16 v[222:225], a[176:179], a[144:147], v[222:225]
    v_mfma_f32_16x16x32_bf16 v[234:237], a[180:183], a[148:151], v[234:237]
    v_mfma_f32_16x16x32_bf16 v[242:245], a[184:187], a[148:151], v[242:245]
    v_mfma_f32_16x16x32_bf16 v[226:229], a[176:179], a[148:151], v[226:229]
    s_waitcnt lgkmcnt(0)
    s_cmp_ge_u32 s14, 7
    s_cbranch_scc0 L_pollin5
L_pollok5:
    s_waitcnt vmcnt(16)
    s_barrier
    v_mfma_f32_16x16x32_bf16 v[182:185], a[152:155], a[192:195], v[182:185]
    ds_read_b64_tr_b16 a[200:201], v31 offset:16384
    buffer_load_dwordx4 a[0:3], v79, s[28:31], s65 offen offset:0 sc1
    v_mfma_f32_16x16x32_bf16 v[190:193], a[152:155], a[196:199], v[190:193]
    ds_read_b64_tr_b16 a[202:203], v31 offset:18432
    v_mfma_f32_16x16x32_bf16 v[186:189], a[156:159], a[192:195], v[186:189]
    ds_read_b64_tr_b16 a[204:205], v33 offset:16384
    buffer_load_dwordx4 a[4:7], v79, s[28:31], s65 offen offset:1024 sc1
    v_mfma_f32_16x16x32_bf16 v[194:197], a[156:159], a[196:199], v[194:197]
    ds_read_b64_tr_b16 a[206:207], v33 offset:18432
    v_mfma_f32_16x16x32_bf16 v[206:209], a[160:163], a[192:195], v[206:209]
    ds_read_b64_tr_b16 a[208:209], v32 offset:16384
    v_mfma_f32_16x16x32_bf16 v[214:217], a[160:163], a[196:199], v[214:217]
    ds_read_b64_tr_b16 a[210:211], v32 offset:18432
    v_mfma_f32_16x16x32_bf16 v[198:201], a[160:163], a[188:191], v[198:201]
    ds_read_b64_tr_b16 a[212:213], v34 offset:16384
    buffer_load_dwordx4 a[8:11], v79, s[28:31], s65 offen offset:2048 sc1
    v_mfma_f32_16x16x32_bf16 v[210:213], a[164:167], a[192:195], v[210:213]
    ds_read_b64_tr_b16 a[214:215], v34 offset:18432
    v_mfma_f32_16x16x32_bf16 v[218:221], a[164:167], a[196:199], v[218:221]
    ds_read_b64_tr_b16 a[216:217], v31 offset:20480
    v_mfma_f32_16x16x32_bf16 v[202:205], a[164:167], a[188:191], v[202:205]
    ds_read_b64_tr_b16 a[218:219], v31 offset:22528
    buffer_load_dwordx4 a[12:15], v79, s[28:31], s65 offen offset:3072 sc1
    v_mfma_f32_16x16x32_bf16 v[230:233], a[192:195], a[168:171], v[230:233]
    ds_read_b64_tr_b16 a[220:221], v33 offset:20480
    s_add_u32 s65, s65, 8192
    v_mfma_f32_16x16x32_bf16 v[238:241], a[196:199], a[168:171], v[238:241]
    ds_read_b64_tr_b16 a[222:223], v33 offset:22528
    s_cmp_eq_u32 s65, 57344
    v_mfma_f32_16x16x32_bf16 v[222:225], a[188:191], a[168:171], v[222:225]
    s_cselect_b32 s65, 0, s65
    v_mfma_f32_16x16x32_bf16 v[234:237], a[192:195], a[172:175], v[234:237]
    buffer_load_dwordx4 a[16:19], v79, s[28:31], s65 offen offset:0 sc1
    v_mfma_f32_16x16x32_bf16 v[242:245], a[196:199], a[172:175], v[242:245]
    v_mfma_f32_16x16x32_bf16 v[226:229], a[188:191], a[172:175], v[226:229]
    v_cvt_pk_bf16_f32 v118, v182, v183
    v_cvt_pk_bf16_f32 v119, v184, v185
    v_cvt_pk_bf16_f32 v120, v186, v187
    buffer_load_dwordx4 a[20:23], v79, s[28:31], s65 offen offset:1024 sc1
    v_cvt_pk_bf16_f32 v121, v188, v189
    v_cvt_pk_bf16_f32 v122, v190, v191
    v_cvt_pk_bf16_f32 v123, v192, v193
    v_cvt_pk_bf16_f32 v124, v194, v195
    v_cvt_pk_bf16_f32 v125, v196, v197
    v_cvt_pk_bf16_f32 v130, v206, v207
    v_cvt_pk_bf16_f32 v131, v208, v209
    v_cvt_pk_bf16_f32 v132, v210, v211
    v_cvt_pk_bf16_f32 v133, v212, v213
    v_cvt_pk_bf16_f32 v134, v214, v215
    v_cvt_pk_bf16_f32 v135, v216, v217
    v_cvt_pk_bf16_f32 v136, v218, v219
    v_cvt_pk_bf16_f32 v137, v220, v221
    v_cvt_pk_bf16_f32 v126, v198, v199
    buffer_load_dwordx4 a[24:27], v79, s[28:31], s65 offen offset:2048 sc1
    v_cvt_pk_bf16_f32 v127, v200, v201
    v_cvt_pk_bf16_f32 v128, v202, v203
    v_cvt_pk_bf16_f32 v129, v204, v205
    v_mfma_f32_16x16x32_bf16 v[154:157], v[130:133], v[118:121], 0
    v_mfma_f32_16x16x32_bf16 v[158:161], v[130:133], v[122:125], 0
    v_mfma_f32_16x16x32_bf16 v[162:165], v[134:137], v[122:125], 0
    buffer_load_dwordx4 a[28:31], v79, s[28:31], s65 offen offset:3072 sc1
    v_mfma_f32_16x16x32_bf16 v[150:153], v[126:129], v[118:121], 0
    v_cvt_pk_bf16_f32 v166, v222, v223
    v_cvt_pk_bf16_f32 v167, v224, v225
    v_cvt_pk_bf16_f32 v168, v230, v231
    v_cvt_pk_bf16_f32 v169, v232, v233
    v_cvt_pk_bf16_f32 v170, v238, v239
    v_cvt_pk_bf16_f32 v171, v240, v241
    v_cndmask_b32 v250, v158, v159, s[70:71]
    v_cndmask_b32 v253, v162, v163, s[70:71]
    v_cndmask_b32 v250, v250, v253, s[72:73]
    s_add_u32 s65, s65, 8192
    s_cmp_eq_u32 s65, 57344
    s_cselect_b32 s65, 0, s65
    buffer_load_dwordx4 a[32:35], v79, s[28:31], s65 offen offset:0 sc1
    v_mul_f32 v250, v250, v29
    v_cndmask_b32 v251, v160, v161, s[70:71]
    v_cndmask_b32 v253, v164, v165, s[70:71]
    v_cndmask_b32 v251, v251, v253, s[74:75]
    v_mul_f32 v251, v251, v30
    v_cndmask_b32 v246, v150, v151, s[70:71]
    v_cndmask_b32 v246, v84, v246, s[76:77]
    v_cndmask_b32 v249, v154, v155, s[70:71]
    v_cndmask_b32 v246, v246, v249, s[72:73]
    v_mul_f32 v246, v246, v27
    v_cndmask_b32 v247, v152, v153, s[70:71]
    v_cndmask_b32 v247, v84, v247, s[76:77]
    v_cndmask_b32 v249, v156, v157, s[70:71]
    v_cndmask_b32 v247, v247, v249, s[74:75]
    buffer_load_dwordx4 a[36:39], v79, s[28:31], s65 offen offset:1024 sc1
    v_mul_f32 v247, v247, v28
    v_max_f32 v248, v246, v247
    v_max_f32 v252, v250, v251
    v_mov_b32 v249, v248
    v_mov_b32 v253, v252
    v_cvt_pk_bf16_f32 v172, v226, v227
    v_permlane16_swap_b32 v248, v249
    v_permlane16_swap_b32 v252, v253
    v_max_f32 v248, v248, v249
    v_max_f32 v252, v252, v253
    v_mov_b32 v249, v248
    v_mov_b32 v253, v252
    v_cvt_pk_bf16_f32 v173, v228, v229
    v_permlane32_swap_b32 v248, v249
    buffer_load_dwordx4 a[40:43], v79, s[28:31], s65 offen offset:2048 sc1
    v_permlane32_swap_b32 v252, v253
    v_max_f32 v248, v248, v249
    v_max_f32 v252, v252, v253
    v_mul_f32 v248, v25, v248
    v_mul_f32 v252, v26, v252
    v_fma_f32 v246, v246, v25, -v248
    v_fma_f32 v247, v247, v25, -v248
    v_fma_f32 v250, v250, v26, -v252
    v_fma_f32 v251, v251, v26, -v252
    v_exp_f32 v246, v246
    v_exp_f32 v247, v247
    v_exp_f32 v250, v250
    buffer_load_dwordx4 a[44:47], v79, s[28:31], s65 offen offset:3072 sc1
    v_exp_f32 v251, v251
    v_add_f32 v248, v246, v247
    v_add_f32 v252, v250, v251
    v_mov_b32 v249, v248
    v_mov_b32 v253, v252
    v_cvt_pk_bf16_f32 v174, v234, v235
    v_permlane16_swap_b32 v248, v249
    v_permlane16_swap_b32 v252, v253
    v_add_f32 v248, v248, v249
    v_add_f32 v252, v252, v253
    v_mov_b32 v249, v248
    v_mov_b32 v253, v252
    s_add_u32 m0, s58, 131072
    s_add_u32 s64, s64, 524288
    s_cmp_eq_u32 s64, 3670016
    s_cselect_b32 s64, 0, s64
    s_add_u32 s64, s64, 524288
    s_cmp_eq_u32 s64, 3670016
    s_cselect_b32 s64, 0, s64
    v_xor_b32 v59, 128, v59
    buffer_load_dwordx4 v59, s[24:27], s64 offen lds
    v_cvt_pk_bf16_f32 v175, v236, v237
    v_permlane32_swap_b32 v248, v249
    v_permlane32_swap_b32 v252, v253
    v_add_f32 v248, v248, v249
    v_add_f32 v252, v252, v253
    v_rcp_f32 v248, v248
    v_rcp_f32 v252, v252
    v_cvt_pk_bf16_f32 v176, v242, v243
    v_cvt_pk_bf16_f32 v177, v244, v245
    v_mul_f32 v246, v246, v27
    v_xor_b32 v60, 128, v60
    buffer_load_dwordx4 v60, s[24:27], s64 offen offset:1024 lds
    v_mul_f32 v247, v247, v28
    v_mul_f32 v250, v250, v29
    v_mul_f32 v251, v251, v30
    v_mul_f32 v246, v246, v248
    v_mul_f32 v247, v247, v248
    v_mul_f32 v250, v250, v252
    v_mul_f32 v251, v251, v252
    v_cvt_pk_bf16_f32 v246, v246, v246
    v_cvt_pk_bf16_f32 v247, v247, v247
    v_cvt_pk_bf16_f32 v250, v250, v250
    v_cvt_pk_bf16_f32 v251, v251, v251
    v_and_b32 v138, v246, v104
    v_and_b32 v139, v247, v105
    v_xor_b32 v61, 128, v61
    buffer_load_dwordx4 v61, s[24:27], s64 offen offset:2048 lds
    v_and_b32 v140, v246, v106
    v_and_b32 v141, v247, v107
    v_and_b32 v142, v250, v104
    v_and_b32 v143, v251, v105
    v_and_b32 v144, v250, v106
    v_and_b32 v145, v251, v107
    v_mfma_f32_16x16x32_bf16 v[182:185], v[166:169], v[138:141], 0
    v_mfma_f32_16x16x32_bf16 v[186:189], v[172:175], v[138:141], 0
    v_xor_b32 v62, 128, v62
    buffer_load_dwordx4 v62, s[24:27], s64 offen offset:3072 lds
    v_mfma_f32_16x16x32_bf16 v[190:193], v[168:171], v[142:145], 0
    v_mfma_f32_16x16x32_bf16 v[194:197], v[174:177], v[142:145], 0
    s_add_u32 s83, s82, 16384
    s_nop 1
    v_cvt_pk_bf16_f32 v110, v182, v183
    v_cvt_pk_bf16_f32 v111, v184, v185
    s_add_u32 m0, s58, 147456
    s_add_u32 s64, s64, 524288
    s_cmp_eq_u32 s64, 3670016
    s_cselect_b32 s64, 0, s64
    buffer_load_dwordx4 v59, s[24:27], s64 offen lds
    v_cvt_pk_bf16_f32 v112, v186, v187
    v_cvt_pk_bf16_f32 v113, v188, v189
    v_cvt_pk_bf16_f32 v114, v190, v191
    v_cvt_pk_bf16_f32 v115, v192, v193
    v_cvt_pk_bf16_f32 v116, v194, v195
    v_cvt_pk_bf16_f32 v117, v196, v197
    buffer_store_dwordx4 v[110:113], v4, s[28:31], s82 offen sc1
    buffer_store_dwordx4 v[114:117], v4, s[28:31], s83 offen sc1
    s_cmp_lg_u32 s56, 0
    s_cbranch_scc0 L_nof
L_f:
    s_waitcnt vmcnt(17) lgkmcnt(8)
    v_mfma_f32_16x16x32_bf16 v[182:185], a[0:3], a[200:203], 0
    ds_read_b64_tr_b16 a[224:225], v32 offset:20480
    s_add_u32 s65, s65, 8192
    s_cmp_eq_u32 s65, 57344
    s_cselect_b32 s65, 0, s65
    buffer_load_dwordx4 a[48:51], v79, s[28:31], s65 offen offset:0 sc1
    v_mfma_f32_16x16x32_bf16 v[186:189], a[4:7], a[200:203], 0
    ds_read_b64_tr_b16 a[226:227], v32 offset:22528
    v_lshlrev_b32 v93, 16, v93
    v_mfma_f32_16x16x32_bf16 v[238:241], a[0:3], a[204:207], 0
    ds_read_b64_tr_b16 a[228:229], v34 offset:20480
    buffer_load_dwordx4 a[52:55], v79, s[28:31], s65 offen offset:1024 sc1
    v_mfma_f32_16x16x32_bf16 v[242:245], a[4:7], a[204:207], 0
    ds_read_b64_tr_b16 a[230:231], v34 offset:22528
    s_waitcnt lgkmcnt(8)
    v_mfma_f32_16x16x32_bf16 v[190:193], a[0:3], a[208:211], 0
    ds_read_b64_tr_b16 a[200:201], v35 offset:0
    v_lshlrev_b32 v222, 16, v96
    v_mfma_f32_16x16x32_bf16 v[194:197], a[4:7], a[208:211], 0
    ds_read_b64_tr_b16 a[202:203], v35 offset:2048
    v_and_b32 v223, 0xffff0000, v96
    v_mfma_f32_16x16x32_bf16 v[246:249], a[0:3], a[212:215], 0
    ds_read_b64_tr_b16 a[204:205], v37 offset:0
    buffer_load_dwordx4 a[56:59], v79, s[28:31], s65 offen offset:2048 sc1
    v_mfma_f32_16x16x32_bf16 v[250:253], a[4:7], a[212:215], 0
    ds_read_b64_tr_b16 a[206:207], v37 offset:2048
    s_waitcnt vmcnt(18) lgkmcnt(8)
    v_mfma_f32_16x16x32_bf16 v[182:185], a[8:11], a[216:219], v[182:185]
    ds_read_b64_tr_b16 a[208:209], v36 offset:0
    v_add_f32 v222, v222, v93
    v_mfma_f32_16x16x32_bf16 v[186:189], a[12:15], a[216:219], v[186:189]
    ds_read_b64_tr_b16 a[210:211], v36 offset:2048
    buffer_load_dwordx4 a[60:63], v79, s[28:31], s65 offen offset:3072 sc1
    v_add_f32 v223, v223, v93
    v_mfma_f32_16x16x32_bf16 v[238:241], a[8:11], a[220:223], v[238:241]
    ds_read_b64_tr_b16 a[212:213], v38 offset:0
    s_add_u32 s65, s65, 8192
    v_mfma_f32_16x16x32_bf16 v[242:245], a[12:15], a[220:223], v[242:245]
    ds_read_b64_tr_b16 a[214:215], v38 offset:2048
    s_waitcnt lgkmcnt(8)
    v_mfma_f32_16x16x32_bf16 v[190:193], a[8:11], a[224:227], v[190:193]
    ds_read_b64_tr_b16 a[216:217], v35 offset:4096
    s_cmp_eq_u32 s65, 57344
    v_mfma_f32_16x16x32_bf16 v[194:197], a[12:15], a[224:227], v[194:197]
    ds_read_b64_tr_b16 a[218:219], v35 offset:6144
    s_cselect_b32 s65, 0, s65
    v_lshlrev_b32 v224, 16, v97
    v_mfma_f32_16x16x32_bf16 v[246:249], a[8:11], a[228:231], v[246:249]
    ds_read_b64_tr_b16 a[220:221], v37 offset:4096
    buffer_load_dwordx4 a[64:67], v79, s[28:31], s65 offen offset:0 sc1
    v_mfma_f32_16x16x32_bf16 v[250:253], a[12:15], a[228:231], v[250:253]
    ds_read_b64_tr_b16 a[222:223], v37 offset:6144
    s_waitcnt vmcnt(18) lgkmcnt(8)
    v_mfma_f32_16x16x32_bf16 v[182:185], a[16:19], a[200:203], v[182:185]
    ds_read_b64_tr_b16 a[224:225], v36 offset:4096
    buffer_load_dwordx4 a[68:71], v79, s[28:31], s65 offen offset:1024 sc1
    v_mfma_f32_16x16x32_bf16 v[186:189], a[20:23], a[200:203], v[186:189]
    ds_read_b64_tr_b16 a[226:227], v36 offset:6144
    v_and_b32 v225, 0xffff0000, v97
    v_mfma_f32_16x16x32_bf16 v[238:241], a[16:19], a[204:207], v[238:241]
    ds_read_b64_tr_b16 a[228:229], v38 offset:4096
    v_add_f32 v224, v224, v93
    v_mfma_f32_16x16x32_bf16 v[242:245], a[20:23], a[204:207], v[242:245]
    ds_read_b64_tr_b16 a[230:231], v38 offset:6144
    s_waitcnt lgkmcnt(8)
    v_mfma_f32_16x16x32_bf16 v[190:193], a[16:19], a[208:211], v[190:193]
    ds_read_b64_tr_b16 a[200:201], v35 offset:16384
    buffer_load_dwordx4 a[72:75], v79, s[28:31], s65 offen offset:2048 sc1
    v_mfma_f32_16x16x32_bf16 v[194:197], a[20:23], a[208:211], v[194:197]
    ds_read_b64_tr_b16 a[202:203], v35 offset:18432
    v_add_f32 v225, v225, v93
    v_mfma_f32_16x16x32_bf16 v[246:249], a[16:19], a[212:215], v[246:249]
    ds_read_b64_tr_b16 a[204:205], v37 offset:16384
    v_lshlrev_b32 v226, 16, v98
    v_mfma_f32_16x16x32_bf16 v[250:253], a[20:23], a[212:215], v[250:253]
    ds_read_b64_tr_b16 a[206:207], v37 offset:18432
    s_waitcnt vmcnt(18) lgkmcnt(8)
    v_mfma_f32_16x16x32_bf16 v[182:185], a[24:27], a[216:219], v[182:185]
    ds_read_b64_tr_b16 a[208:209], v36 offset:16384
    buffer_load_dwordx4 a[76:79], v79, s[28:31], s65 offen offset:3072 sc1
    v_mfma_f32_16x16x32_bf16 v[186:189], a[28:31], a[216:219], v[186:189]
    ds_read_b64_tr_b16 a[210:211], v36 offset:18432
    s_add_u32 s65, s65, 8192
    v_and_b32 v227, 0xffff0000, v98
    v_mfma_f32_16x16x32_bf16 v[238:241], a[24:27], a[220:223], v[238:241]
    ds_read_b64_tr_b16 a[212:213], v38 offset:16384
    s_cmp_eq_u32 s65, 57344
    v_mfma_f32_16x16x32_bf16 v[242:245], a[28:31], a[220:223], v[242:245]
    ds_read_b64_tr_b16 a[214:215], v38 offset:18432
    v_add_f32 v226, v226, v93
    s_waitcnt lgkmcnt(8)
    v_mfma_f32_16x16x32_bf16 v[190:193], a[24:27], a[224:227], v[190:193]
    ds_read_b64_tr_b16 a[216:217], v35 offset:20480
    s_cselect_b32 s65, 0, s65
    buffer_load_dwordx4 a[80:83], v79, s[28:31], s65 offen offset:0 sc1
    v_mfma_f32_16x16x32_bf16 v[194:197], a[28:31], a[224:227], v[194:197]
    ds_read_b64_tr_b16 a[218:219], v35 offset:22528
    v_add_f32 v227, v227, v93
    v_mfma_f32_16x16x32_bf16 v[246:249], a[24:27], a[228:231], v[246:249]
    ds_read_b64_tr_b16 a[220:221], v37 offset:20480
    buffer_load_dwordx4 a[84:87], v79, s[28:31], s65 offen offset:1024 sc1
    v_mfma_f32_16x16x32_bf16 v[250:253], a[28:31], a[228:231], v[250:253]
    ds_read_b64_tr_b16 a[222:223], v37 offset:22528
    v_lshlrev_b32 v228, 16, v99
    s_waitcnt vmcnt(19) lgkmcnt(8)
    v_mfma_f32_16x16x32_bf16 v[182:185], a[32:35], a[200:203], v[182:185]
    ds_read_b64_tr_b16 a[224:225], v36 offset:20480
    v_and_b32 v229, 0xffff0000, v99
    v_mfma_f32_16x16x32_bf16 v[186:189], a[36:39], a[200:203], v[186:189]
    ds_read_b64_tr_b16 a[226:227], v36 offset:22528
    buffer_load_dwordx4 a[88:91], v79, s[28:31], s65 offen offset:2048 sc1
    v_add_f32 v228, v228, v93
    v_mfma_f32_16x16x32_bf16 v[238:241], a[32:35], a[204:207], v[238:241]
    ds_read_b64_tr_b16 a[228:229], v38 offset:20480
    v_add_f32 v229, v229, v93
    v_mfma_f32_16x16x32_bf16 v[242:245], a[36:39], a[204:207], v[242:245]
    ds_read_b64_tr_b16 a[230:231], v38 offset:22528
    s_waitcnt lgkmcnt(8)
    v_mfma_f32_16x16x32_bf16 v[190:193], a[32:35], a[208:211], v[190:193]
    s_waitcnt vmcnt(11)
    s_barrier
    s_cmp_lg_u32 s48, 0
    s_cbranch_scc1 L_sig4
    s_atomic_add s36, s[28:29], s69
L_sig4:
    ds_read_b64_tr_b16 a[200:201], v31 offset:32768
    buffer_load_dwordx4 a[92:95], v79, s[28:31], s65 offen offset:3072 sc1
    v_mfma_f32_16x16x32_bf16 v[194:197], a[36:39], a[208:211], v[194:197]
    ds_read_b64_tr_b16 a[202:203], v31 offset:34816
    s_add_u32 s65, s65, 8192
    v_lshlrev_b32 v94, 16, v94
    v_mfma_f32_16x16x32_bf16 v[246:249], a[32:35], a[212:215], v[246:249]
    ds_read_b64_tr_b16 a[204:205], v33 offset:32768
    s_cmp_eq_u32 s65, 57344
    v_mfma_f32_16x16x32_bf16 v[250:253], a[36:39], a[212:215], v[250:253]
    ds_read_b64_tr_b16 a[206:207], v33 offset:34816
    s_waitcnt lgkmcnt(8)
    v_mfma_f32_16x16x32_bf16 v[182:185], a[40:43], a[216:219], v[182:185]
    ds_read_b64_tr_b16 a[208:209], v32 offset:32768
    s_cselect_b32 s65, 0, s65
    v_mfma_f32_16x16x32_bf16 v[186:189], a[44:47], a[216:219], v[186:189]
    ds_read_b64_tr_b16 a[210:211], v32 offset:34816
    buffer_load_dwordx4 a[96:99], v79, s[28:31], s65 offen offset:0 sc1
    v_lshlrev_b32 v230, 16, v100
    v_mfma_f32_16x16x32_bf16 v[238:241], a[40:43], a[220:223], v[238:241]
    ds_read_b64_tr_b16 a[212:213], v34 offset:32768
    v_and_b32 v231, 0xffff0000, v100
    v_mfma_f32_16x16x32_bf16 v[242:245], a[44:47], a[220:223], v[242:245]
    ds_read_b64_tr_b16 a[214:215], v34 offset:34816
    s_waitcnt lgkmcnt(8)
    v_mfma_f32_16x16x32_bf16 v[190:193], a[40:43], a[224:227], v[190:193]
    ds_read_b64_tr_b16 a[216:217], v31 offset:36864
    buffer_load_dwordx4 a[100:103], v79, s[28:31], s65 offen offset:1024 sc1
    v_mfma_f32_16x16x32_bf16 v[194:197], a[44:47], a[224:227], v[194:197]
    ds_read_b64_tr_b16 a[218:219], v31 offset:38912
    v_add_f32 v230, v230, v94
    v_mfma_f32_16x16x32_bf16 v[246:249], a[40:43], a[228:231], v[246:249]
    ds_read_b64_tr_b16 a[220:221], v33 offset:36864
    buffer_load_dwordx4 a[104:107], v79, s[28:31], s65 offen offset:2048 sc1
    v_mfma_f32_16x16x32_bf16 v[250:253], a[44:47], a[228:231], v[250:253]
    ds_read_b64_tr_b16 a[222:223], v33 offset:38912
    v_add_f32 v231, v231, v94
    s_waitcnt vmcnt(13) lgkmcnt(8)
    v_mfma_f32_16x16x32_bf16 v[182:185], a[48:51], a[200:203], v[182:185]
    ds_read_b64_tr_b16 a[224:225], v32 offset:36864
    v_lshlrev_b32 v232, 16, v101
    v_mfma_f32_16x16x32_bf16 v[186:189], a[52:55], a[200:203], v[186:189]
    ds_read_b64_tr_b16 a[226:227], v32 offset:38912
    v_and_b32 v233, 0xffff0000, v101
    v_mfma_f32_16x16x32_bf16 v[238:241], a[48:51], a[204:207], v[238:241]
    ds_read_b64_tr_b16 a[228:229], v34 offset:36864
    buffer_load_dwordx4 a[108:111], v79, s[28:31], s65 offen offset:3072 sc1
    v_mfma_f32_16x16x32_bf16 v[242:245], a[52:55], a[204:207], v[242:245]
    ds_read_b64_tr_b16 a[230:231], v34 offset:38912
    s_waitcnt lgkmcnt(8)
    v_mfma_f32_16x16x32_bf16 v[190:193], a[48:51], a[208:211], v[190:193]
    ds_read_b64_tr_b16 a[200:201], v31 offset:49152
    v_add_f32 v232, v232, v94
    v_mfma_f32_16x16x32_bf16 v[194:197], a[52:55], a[208:211], v[194:197]
    ds_read_b64_tr_b16 a[202:203], v31 offset:51200
    buffer_load_dwordx4 v60, s[24:27], s64 offen offset:1024 lds
    v_add_f32 v233, v233, v94
    v_mfma_f32_16x16x32_bf16 v[246:249], a[48:51], a[212:215], v[246:249]
    ds_read_b64_tr_b16 a[204:205], v33 offset:49152
    v_lshlrev_b32 v234, 16, v102
    v_mfma_f32_16x16x32_bf16 v[250:253], a[52:55], a[212:215], v[250:253]
    ds_read_b64_tr_b16 a[206:207], v33 offset:51200
    s_waitcnt vmcnt(13) lgkmcnt(8)
    v_mfma_f32_16x16x32_bf16 v[182:185], a[56:59], a[216:219], v[182:185]
    ds_read_b64_tr_b16 a[208:209], v32 offset:49152
    buffer_load_dwordx4 v61, s[24:27], s64 offen offset:2048 lds
    v_mfma_f32_16x16x32_bf16 v[186:189], a[60:63], a[216:219], v[186:189]
    ds_read_b64_tr_b16 a[210:211], v32 offset:51200
    v_and_b32 v235, 0xffff0000, v102
    v_mfma_f32_16x16x32_bf16 v[238:241], a[56:59], a[220:223], v[238:241]
    ds_read_b64_tr_b16 a[212:213], v34 offset:49152
    buffer_load_dwordx4 v62, s[24:27], s64 offen offset:3072 lds
    v_mfma_f32_16x16x32_bf16 v[242:245], a[60:63], a[220:223], v[242:245]
    ds_read_b64_tr_b16 a[214:215], v34 offset:51200
    s_waitcnt lgkmcnt(8)
    v_mfma_f32_16x16x32_bf16 v[190:193], a[56:59], a[224:227], v[190:193]
    ds_read_b64_tr_b16 a[216:217], v31 offset:53248
    s_add_u32 m0, s58, 16384
    v_mfma_f32_16x16x32_bf16 v[194:197], a[60:63], a[224:227], v[194:197]
    ds_read_b64_tr_b16 a[218:219], v31 offset:55296
    s_add_u32 s64, s64, 524288
    v_add_f32 v234, v234, v94
    v_mfma_f32_16x16x32_bf16 v[246:249], a[56:59], a[228:231], v[246:249]
    ds_read_b64_tr_b16 a[220:221], v33 offset:53248
    s_cmp_eq_u32 s64, 3670016
    v_mfma_f32_16x16x32_bf16 v[250:253], a[60:63], a[228:231], v[250:253]
    ds_read_b64_tr_b16 a[222:223], v33 offset:55296
    s_cselect_b32 s64, 0, s64
    buffer_load_dwordx4 v59, s[24:27], s64 offen lds
    v_add_f32 v235, v235, v94
    s_waitcnt vmcnt(14) lgkmcnt(8)
    v_mfma_f32_16x16x32_bf16 v[182:185], a[64:67], a[200:203], v[182:185]
    ds_read_b64_tr_b16 a[224:225], v32 offset:53248
    v_lshlrev_b32 v236, 16, v103
    v_mfma_f32_16x16x32_bf16 v[186:189], a[68:71], a[200:203], v[186:189]
    ds_read_b64_tr_b16 a[226:227], v32 offset:55296
    buffer_load_dwordx4 v60, s[24:27], s64 offen offset:1024 lds
    v_and_b32 v237, 0xffff0000, v103
    v_mfma_f32_16x16x32_bf16 v[238:241], a[64:67], a[204:207], v[238:241]
    ds_read_b64_tr_b16 a[228:229], v34 offset:53248
    v_add_f32 v236, v236, v94
    v_mfma_f32_16x16x32_bf16 v[242:245], a[68:71], a[204:207], v[242:245]
    ds_read_b64_tr_b16 a[230:231], v34 offset:55296
    s_waitcnt lgkmcnt(8)
    v_mfma_f32_16x16x32_bf16 v[190:193], a[64:67], a[208:211], v[190:193]
    s_barrier
    ds_read_b64_tr_b16 a[200:201], v35 offset:32768
    buffer_load_dwordx4 v61, s[24:27], s64 offen offset:2048 lds
    v_mfma_f32_16x16x32_bf16 v[194:197], a[68:71], a[208:211], v[194:197]
    ds_read_b64_tr_b16 a[202:203], v35 offset:34816
    v_add_f32 v237, v237, v94
    v_mfma_f32_16x16x32_bf16 v[246:249], a[64:67], a[212:215], v[246:249]
    ds_read_b64_tr_b16 a[204:205], v37 offset:32768
    v_mfma_f32_16x16x32_bf16 v[250:253], a[68:71], a[212:215], v[250:253]
    ds_read_b64_tr_b16 a[206:207], v37 offset:34816
    s_waitcnt vmcnt(14) lgkmcnt(8)
    v_mfma_f32_16x16x32_bf16 v[182:185], a[72:75], a[216:219], v[182:185]
    ds_read_b64_tr_b16 a[208:209], v36 offset:32768
    buffer_load_dwordx4 v62, s[24:27], s64 offen offset:3072 lds
    v_mfma_f32_16x16x32_bf16 v[186:189], a[76:79], a[216:219], v[186:189]
    ds_read_b64_tr_b16 a[210:211], v36 offset:34816
    s_add_u32 m0, s58, 65536
    v_mfma_f32_16x16x32_bf16 v[238:241], a[72:75], a[220:223], v[238:241]
    ds_read_b64_tr_b16 a[212:213], v38 offset:32768
    s_add_u32 s64, s64, 524288
    v_mfma_f32_16x16x32_bf16 v[242:245], a[76:79], a[220:223], v[242:245]
    ds_read_b64_tr_b16 a[214:215], v38 offset:34816
    s_waitcnt lgkmcnt(8)
    v_mfma_f32_16x16x32_bf16 v[190:193], a[72:75], a[224:227], v[190:193]
    ds_read_b64_tr_b16 a[216:217], v35 offset:36864
    s_cmp_eq_u32 s64, 3670016
    v_mfma_f32_16x16x32_bf16 v[194:197], a[76:79], a[224:227], v[194:197]
    ds_read_b64_tr_b16 a[218:219], v35 offset:38912
    s_cselect_b32 s64, 0, s64
    buffer_load_dwordx4 v59, s[24:27], s64 offen lds
    v_mfma_f32_16x16x32_bf16 v[246:249], a[72:75], a[228:231], v[246:249]
    ds_read_b64_tr_b16 a[220:221], v37 offset:36864
    v_mfma_f32_16x16x32_bf16 v[250:253], a[76:79], a[228:231], v[250:253]
    ds_read_b64_tr_b16 a[222:223], v37 offset:38912
    s_waitcnt vmcnt(14) lgkmcnt(8)
    v_mfma_f32_16x16x32_bf16 v[182:185], a[80:83], a[200:203], v[182:185]
    ds_read_b64_tr_b16 a[224:225], v36 offset:36864
    buffer_load_dwordx4 v60, s[24:27], s64 offen offset:1024 lds
    v_mfma_f32_16x16x32_bf16 v[186:189], a[84:87], a[200:203], v[186:189]
    ds_read_b64_tr_b16 a[226:227], v36 offset:38912
    v_mfma_f32_16x16x32_bf16 v[238:241], a[80:83], a[204:207], v[238:241]
    ds_read_b64_tr_b16 a[228:229], v38 offset:36864
    v_mfma_f32_16x16x32_bf16 v[242:245], a[84:87], a[204:207], v[242:245]
    ds_read_b64_tr_b16 a[230:231], v38 offset:38912
    s_waitcnt lgkmcnt(8)
    v_mfma_f32_16x16x32_bf16 v[190:193], a[80:83], a[208:211], v[190:193]
    ds_read_b64_tr_b16 a[200:201], v35 offset:49152
    buffer_load_dwordx4 v61, s[24:27], s64 offen offset:2048 lds
    v_mfma_f32_16x16x32_bf16 v[194:197], a[84:87], a[208:211], v[194:197]
    ds_read_b64_tr_b16 a[202:203], v35 offset:51200
    v_mfma_f32_16x16x32_bf16 v[246:249], a[80:83], a[212:215], v[246:249]
    ds_read_b64_tr_b16 a[204:205], v37 offset:49152
    v_mfma_f32_16x16x32_bf16 v[250:253], a[84:87], a[212:215], v[250:253]
    ds_read_b64_tr_b16 a[206:207], v37 offset:51200
    s_waitcnt vmcnt(14) lgkmcnt(8)
    v_mfma_f32_16x16x32_bf16 v[182:185], a[88:91], a[216:219], v[182:185]
    ds_read_b64_tr_b16 a[208:209], v36 offset:49152
L_pad3:
    s_cbranch_execz L_warm
    buffer_load_dwordx4 v62, s[24:27], s64 offen offset:3072 lds
    v_mfma_f32_16x16x32_bf16 v[186:189], a[92:95], a[216:219], v[186:189]
    ds_read_b64_tr_b16 a[210:211], v36 offset:51200
    s_add_u32 m0, s58, 81920
    v_mfma_f32_16x16x32_bf16 v[238:241], a[88:91], a[220:223], v[238:241]
    ds_read_b64_tr_b16 a[212:213], v38 offset:49152
    s_add_u32 s64, s64, 524288
    v_mfma_f32_16x16x32_bf16 v[242:245], a[92:95], a[220:223], v[242:245]
    ds_read_b64_tr_b16 a[214:215], v38 offset:51200
    s_waitcnt lgkmcnt(8)
    v_mfma_f32_16x16x32_bf16 v[190:193], a[88:91], a[224:227], v[190:193]
    ds_read_b64_tr_b16 a[216:217], v35 offset:53248
    s_cmp_eq_u32 s64, 3670016
    s_cselect_b32 s64, 0, s64
    buffer_load_dwordx4 v59, s[24:27], s64 offen lds
    v_mfma_f32_16x16x32_bf16 v[194:197], a[92:95], a[224:227], v[194:197]
    ds_read_b64_tr_b16 a[218:219], v35 offset:55296
    v_mfma_f32_16x16x32_bf16 v[246:249], a[88:91], a[228:231], v[246:249]
    ds_read_b64_tr_b16 a[220:221], v37 offset:53248
    buffer_load_dwordx4 v60, s[24:27], s64 offen offset:1024 lds
    v_mfma_f32_16x16x32_bf16 v[250:253], a[92:95], a[228:231], v[250:253]
    ds_read_b64_tr_b16 a[222:223], v37 offset:55296
    s_waitcnt vmcnt(15) lgkmcnt(8)
    v_mfma_f32_16x16x32_bf16 v[182:185], a[96:99], a[200:203], v[182:185]
    ds_read_b64_tr_b16 a[224:225], v36 offset:53248
    v_mfma_f32_16x16x32_bf16 v[186:189], a[100:103], a[200:203], v[186:189]
    ds_read_b64_tr_b16 a[226:227], v36 offset:55296
    v_mfma_f32_16x16x32_bf16 v[238:241], a[96:99], a[204:207], v[238:241]
    ds_read_b64_tr_b16 a[228:229], v38 offset:53248
    buffer_load_dwordx4 v61, s[24:27], s64 offen offset:2048 lds
    v_mfma_f32_16x16x32_bf16 v[242:245], a[100:103], a[204:207], v[242:245]
    ds_read_b64_tr_b16 a[230:231], v38 offset:55296
    s_waitcnt lgkmcnt(8)
    v_mfma_f32_16x16x32_bf16 v[190:193], a[96:99], a[208:211], v[190:193]
    ds_read_b64_tr_b16 a[200:201], v31 offset:0
    v_mfma_f32_16x16x32_bf16 v[194:197], a[100:103], a[208:211], v[194:197]
    ds_read_b64_tr_b16 a[202:203], v31 offset:2048
    v_mfma_f32_16x16x32_bf16 v[246:249], a[96:99], a[212:215], v[246:249]
    ds_read_b64_tr_b16 a[204:205], v33 offset:0
    buffer_load_dwordx4 v62, s[24:27], s64 offen offset:3072 lds
    v_mfma_f32_16x16x32_bf16 v[250:253], a[100:103], a[212:215], v[250:253]
    ds_read_b64_tr_b16 a[206:207], v33 offset:2048
    s_waitcnt vmcnt(15) lgkmcnt(8)
    v_mfma_f32_16x16x32_bf16 v[182:185], a[104:107], a[216:219], v[182:185]
    ds_read_b64_tr_b16 a[208:209], v32 offset:0
    s_add_u32 m0, s58, 32768
    v_mfma_f32_16x16x32_bf16 v[186:189], a[108:111], a[216:219], v[186:189]
    ds_read_b64_tr_b16 a[210:211], v32 offset:2048
    s_add_u32 s64, s64, 524288
    v_mfma_f32_16x16x32_bf16 v[238:241], a[104:107], a[220:223], v[238:241]
    ds_read_b64_tr_b16 a[212:213], v34 offset:0
    s_cmp_eq_u32 s64, 3670016
    v_mfma_f32_16x16x32_bf16 v[242:245], a[108:111], a[220:223], v[242:245]
    ds_read_b64_tr_b16 a[214:215], v34 offset:2048
    s_cselect_b32 s64, 0, s64
    buffer_load_dwordx4 v59, s[24:27], s64 offen lds
    s_waitcnt lgkmcnt(8)
    v_mfma_f32_16x16x32_bf16 v[190:193], a[104:107], a[224:227], v[190:193]
    ds_read_b64_tr_b16 a[216:217], v31 offset:4096
    v_mfma_f32_16x16x32_bf16 v[194:197], a[108:111], a[224:227], v[194:197]
    ds_read_b64_tr_b16 a[218:219], v31 offset:6144
    buffer_load_dwordx4 v60, s[24:27], s64 offen offset:1024 lds
    v_mfma_f32_16x16x32_bf16 v[246:249], a[104:107], a[228:231], v[246:249]
    ds_read_b64_tr_b16 a[220:221], v33 offset:4096
    v_mfma_f32_16x16x32_bf16 v[250:253], a[108:111], a[228:231], v[250:253]
    ds_read_b64_tr_b16 a[222:223], v33 offset:6144
    s_waitcnt lgkmcnt(8)
    v_mfma_f32_16x16x32_bf16 v[150:153], a[0:3], a[200:203], 0
    ds_read_b64_tr_b16 a[224:225], v32 offset:4096
    v_mfma_f32_16x16x32_bf16 v[154:157], a[4:7], a[200:203], 0
    ds_read_b64_tr_b16 a[226:227], v32 offset:6144
    buffer_load_dwordx4 v61, s[24:27], s64 offen offset:2048 lds
    v_mfma_f32_16x16x32_bf16 v[166:169], a[0:3], a[204:207], 0
    ds_read_b64_tr_b16 a[228:229], v34 offset:4096
    v_cvt_pk_bf16_f32 v182, v182, v183
    v_mfma_f32_16x16x32_bf16 v[170:173], a[4:7], a[204:207], 0
    ds_read_b64_tr_b16 a[230:231], v34 offset:6144
    v_cvt_pk_bf16_f32 v183, v184, v185
    v_cvt_pk_bf16_f32 v184, v186, v187
    s_waitcnt lgkmcnt(8)
    v_mfma_f32_16x16x32_bf16 v[158:161], a[0:3], a[208:211], 0
    s_waitcnt vmcnt(15)
    s_barrier
    ds_read_b64_tr_b16 a[200:201], v39 offset:0
    buffer_load_dwordx4 v62, s[24:27], s64 offen offset:3072 lds
    v_mfma_f32_16x16x32_bf16 v[162:165], a[4:7], a[208:211], 0
    ds_read_b64_tr_b16 a[202:203], v39 offset:2048
    s_add_u32 m0, s58, 49152
    v_cvt_pk_bf16_f32 v185, v188, v189
    buffer_store_dwordx4 v[182:185], v21, s[28:31], 0 offen offset:0 sc1
    v_cvt_pk_bf16_f32 v190, v190, v191
    v_cvt_pk_bf16_f32 v191, v192, v193
    v_cvt_pk_bf16_f32 v192, v194, v195
    v_mfma_f32_16x16x32_bf16 v[174:177], a[0:3], a[212:215], 0
    ds_read_b64_tr_b16 a[204:205], v41 offset:0
    s_add_u32 s66, s66, 1
    v_mfma_f32_16x16x32_bf16 v[178:181], a[4:7], a[212:215], 0
    ds_read_b64_tr_b16 a[206:207], v41 offset:2048
    v_cvt_pk_bf16_f32 v193, v196, v197
    buffer_store_dwordx4 v[190:193], v21, s[28:31], 0 offen offset:1024 sc1
    v_cvt_pk_bf16_f32 v238, v238, v239
    v_cvt_pk_bf16_f32 v239, v240, v241
    v_cvt_pk_bf16_f32 v240, v242, v243
    s_waitcnt lgkmcnt(8)
    v_mfma_f32_16x16x32_bf16 v[150:153], a[8:11], a[216:219], v[150:153]
    ds_read_b64_tr_b16 a[208:209], v40 offset:0
    s_and_b32 s66, s66, 3
    v_mfma_f32_16x16x32_bf16 v[154:157], a[12:15], a[216:219], v[154:157]
    ds_read_b64_tr_b16 a[210:211], v40 offset:2048
    s_mul_i32 s61, s66, 100352
    buffer_load_dwordx4 v63, s[16:19], s61 offen lds
    v_cvt_pk_bf16_f32 v241, v244, v245
    buffer_store_dwordx4 v[238:241], v21, s[28:31], 0 offen offset:2048 sc1
    v_cvt_pk_bf16_f32 v246, v246, v247
    v_cvt_pk_bf16_f32 v247, v248, v249
    v_cvt_pk_bf16_f32 v248, v250, v251
    v_mfma_f32_16x16x32_bf16 v[166:169], a[8:11], a[220:223], v[166:169]
    ds_read_b64_tr_b16 a[212:213], v42 offset:0
    v_cvt_pk_bf16_f32 v249, v252, v253
    v_mfma_f32_16x16x32_bf16 v[170:173], a[12:15], a[220:223], v[170:173]
    ds_read_b64_tr_b16 a[214:215], v42 offset:2048
    s_waitcnt lgkmcnt(8)
    v_mfma_f32_16x16x32_bf16 v[158:161], a[8:11], a[224:227], v[158:161]
    ds_read_b64_tr_b16 a[216:217], v39 offset:4096
    buffer_load_dwordx4 v64, s[16:19], s61 offen offset:1024 lds
    v_mfma_f32_16x16x32_bf16 v[162:165], a[12:15], a[224:227], v[162:165]
    ds_read_b64_tr_b16 a[218:219], v39 offset:6144
    s_add_u32 s61, s61, 48128
    buffer_store_dwordx4 v[246:249], v21, s[28:31], 0 offen offset:3072 sc1
    v_mfma_f32_16x16x32_bf16 v[174:177], a[8:11], a[228:231], v[174:177]
    ds_read_b64_tr_b16 a[220:221], v41 offset:4096
    v_mfma_f32_16x16x32_bf16 v[178:181], a[12:15], a[228:231], v[178:181]
    ds_read_b64_tr_b16 a[222:223], v41 offset:6144
    s_waitcnt lgkmcnt(8)
    v_mfma_f32_16x16x32_bf16 v[150:153], a[16:19], a[200:203], v[150:153]
    ds_read_b64_tr_b16 a[224:225], v40 offset:4096
    buffer_load_dwordx4 v63, s[16:19], s61 offen offset:2048 lds
    v_mfma_f32_16x16x32_bf16 v[154:157], a[20:23], a[200:203], v[154:157]
    ds_read_b64_tr_b16 a[226:227], v40 offset:6144
    v_mfma_f32_16x16x32_bf16 v[166:169], a[16:19], a[204:207], v[166:169]
    ds_read_b64_tr_b16 a[228:229], v42 offset:4096
    v_mfma_f32_16x16x32_bf16 v[170:173], a[20:23], a[204:207], v[170:173]
    ds_read_b64_tr_b16 a[230:231], v42 offset:6144
    s_waitcnt lgkmcnt(8)
    v_mfma_f32_16x16x32_bf16 v[158:161], a[16:19], a[208:211], v[158:161]
    s_load_dword s14, s[28:29], s39
    ds_read_b64_tr_b16 a[200:201], v39 offset:16384
    buffer_load_dwordx4 v64, s[16:19], s61 offen offset:3072 lds
    v_mfma_f32_16x16x32_bf16 v[162:165], a[20:23], a[208:211], v[162:165]
    ds_read_b64_tr_b16 a[202:203], v39 offset:18432
    s_add_u32 m0, s58, 98304
    v_mfma_f32_16x16x32_bf16 v[174:177], a[16:19], a[212:215], v[174:177]
    ds_read_b64_tr_b16 a[204:205], v41 offset:16384
    s_add_u32 s66, s66, 1
    v_mfma_f32_16x16x32_bf16 v[178:181], a[20:23], a[212:215], v[178:181]
    ds_read_b64_tr_b16 a[206:207], v41 offset:18432
    s_waitcnt lgkmcnt(8)
    v_mfma_f32_16x16x32_bf16 v[150:153], a[24:27], a[216:219], v[150:153]
    ds_read_b64_tr_b16 a[208:209], v40 offset:16384
    s_and_b32 s66, s66, 3
    s_mul_i32 s61, s66, 100352
    buffer_load_dwordx4 v63, s[16:19], s61 offen lds
    v_mfma_f32_16x16x32_bf16 v[154:157], a[28:31], a[216:219], v[154:157]
    ds_read_b64_tr_b16 a[210:211], v40 offset:18432
    v_mfma_f32_16x16x32_bf16 v[166:169], a[24:27], a[220:223], v[166:169]
    ds_read_b64_tr_b16 a[212:213], v42 offset:16384
    buffer_load_dwordx4 v64, s[16:19], s61 offen offset:1024 lds
    v_mfma_f32_16x16x32_bf16 v[170:173], a[28:31], a[220:223], v[170:173]
    ds_read_b64_tr_b16 a[214:215], v42 offset:18432
    s_waitcnt lgkmcnt(8)
    v_mfma_f32_16x16x32_bf16 v[158:161], a[24:27], a[224:227], v[158:161]
    ds_read_b64_tr_b16 a[216:217], v39 offset:20480
    s_add_u32 s61, s61, 48128
    v_mfma_f32_16x16x32_bf16 v[162:165], a[28:31], a[224:227], v[162:165]
    ds_read_b64_tr_b16 a[218:219], v39 offset:22528
    v_mfma_f32_16x16x32_bf16 v[174:177], a[24:27], a[228:231], v[174:177]
    ds_read_b64_tr_b16 a[220:221], v41 offset:20480
    buffer_load_dwordx4 v63, s[16:19], s61 offen offset:2048 lds
    v_mfma_f32_16x16x32_bf16 v[178:181], a[28:31], a[228:231], v[178:181]
    ds_read_b64_tr_b16 a[222:223], v41 offset:22528
    s_waitcnt lgkmcnt(8)
    v_mfma_f32_16x16x32_bf16 v[150:153], a[32:35], a[200:203], v[150:153]
    ds_read_b64_tr_b16 a[224:225], v40 offset:20480
    v_mfma_f32_16x16x32_bf16 v[154:157], a[36:39], a[200:203], v[154:157]
    ds_read_b64_tr_b16 a[226:227], v40 offset:22528
    v_mfma_f32_16x16x32_bf16 v[166:169], a[32:35], a[204:207], v[166:169]
    ds_read_b64_tr_b16 a[228:229], v42 offset:20480
    buffer_load_dwordx4 v64, s[16:19], s61 offen offset:3072 lds
    v_mfma_f32_16x16x32_bf16 v[170:173], a[36:39], a[204:207], v[170:173]
    ds_read_b64_tr_b16 a[230:231], v42 offset:22528
    s_waitcnt lgkmcnt(8)
    v_mfma_f32_16x16x32_bf16 v[158:161], a[32:35], a[208:211], v[158:161]
    s_waitcnt vmcnt(20)
    s_barrier
    ds_read_b64_tr_b16 a[200:201], v31 offset:16384
    s_add_u32 m0, s58, 114688
    v_mfma_f32_16x16x32_bf16 v[162:165], a[36:39], a[208:211], v[162:165]
    ds_read_b64_tr_b16 a[202:203], v31 offset:18432
    s_add_u32 s66, s66, 1
    v_mfma_f32_16x16x32_bf16 v[174:177], a[32:35], a[212:215], v[174:177]
    ds_read_b64_tr_b16 a[204:205], v33 offset:16384
    s_and_b32 s66, s66, 3
    v_mfma_f32_16x16x32_bf16 v[178:181], a[36:39], a[212:215], v[178:181]
    ds_read_b64_tr_b16 a[206:207], v33 offset:18432
    s_mul_i32 s61, s66, 100352
    buffer_load_dwordx4 v63, s[16:19], s61 offen lds
    s_waitcnt lgkmcnt(8)
    v_mfma_f32_16x16x32_bf16 v[150:153], a[40:43], a[216:219], v[150:153]
    ds_read_b64_tr_b16 a[208:209], v32 offset:16384
    v_mfma_f32_16x16x32_bf16 v[154:157], a[44:47], a[216:219], v[154:157]
    ds_read_b64_tr_b16 a[210:211], v32 offset:18432
    buffer_load_dwordx4 v64, s[16:19], s61 offen offset:1024 lds
    v_mfma_f32_16x16x32_bf16 v[166:169], a[40:43], a[220:223], v[166:169]
    ds_read_b64_tr_b16 a[212:213], v34 offset:16384
    s_add_u32 s61, s61, 48128
    v_mfma_f32_16x16x32_bf16 v[170:173], a[44:47], a[220:223], v[170:173]
    ds_read_b64_tr_b16 a[214:215], v34 offset:18432
    s_waitcnt lgkmcnt(8)
    v_mfma_f32_16x16x32_bf16 v[158:161], a[40:43], a[224:227], v[158:161]
    ds_read_b64_tr_b16 a[216:217], v31 offset:20480
    v_mfma_f32_16x16x32_bf16 v[162:165], a[44:47], a[224:227], v[162:165]
    ds_read_b64_tr_b16 a[218:219], v31 offset:22528
    buffer_load_dwordx4 v63, s[16:19], s61 offen offset:2048 lds
    v_mfma_f32_16x16x32_bf16 v[174:177], a[40:43], a[228:231], v[174:177]
    ds_read_b64_tr_b16 a[220:221], v33 offset:20480
    v_mfma_f32_16x16x32_bf16 v[178:181], a[44:47], a[228:231], v[178:181]
    ds_read_b64_tr_b16 a[222:223], v33 offset:22528
    s_waitcnt lgkmcnt(8)
    v_mfma_f32_16x16x32_bf16 v[150:153], a[48:51], a[200:203], v[150:153]
    s_waitcnt lgkmcnt(0)
    s_cmp_ge_u32 s14, 8
    s_cbranch_scc0 L_pollin6
L_pollok6:
    ds_read_b64_tr_b16 a[224:225], v32 offset:20480
    buffer_load_dwordx4 v64, s[16:19], s61 offen offset:3072 lds
    v_mfma_f32_16x16x32_bf16 v[154:157], a[52:55], a[200:203], v[154:157]
    ds_read_b64_tr_b16 a[226:227], v32 offset:22528
    s_add_u32 m0, s58, 0
    v_mfma_f32_16x16x32_bf16 v[166:169], a[48:51], a[204:207], v[166:169]
    ds_read_b64_tr_b16 a[228:229], v34 offset:20480
    s_add_u32 s51, s51, 1
    v_mfma_f32_16x16x32_bf16 v[170:173], a[52:55], a[204:207], v[170:173]
    ds_read_b64_tr_b16 a[230:231], v34 offset:22528
    v_mfma_f32_16x16x32_bf16 v[158:161], a[48:51], a[208:211], v[158:161]
    s_waitcnt vmcnt(10)
    s_atomic_add s36, s[28:29], s55
    ds_read_b64_tr_b16 a[200:201], v35 offset:0
    s_and_b32 s51, s51, 3
    v_mfma_f32_16x16x32_bf16 v[162:165], a[52:55], a[208:211], v[162:165]
    ds_read_b64_tr_b16 a[202:203], v35 offset:2048
    s_lshl_b32 s61, s51, 12
    buffer_load_dwordx4 v65, s[28:31], s61 offen sc1 lds
    v_mfma_f32_16x16x32_bf16 v[174:177], a[48:51], a[212:215], v[174:177]
    ds_read_b64_tr_b16 a[204:205], v37 offset:0
    v_mfma_f32_16x16x32_bf16 v[178:181], a[52:55], a[212:215], v[178:181]
    ds_read_b64_tr_b16 a[206:207], v37 offset:2048
    v_mfma_f32_16x16x32_bf16 v[150:153], a[56:59], a[216:219], v[150:153]
    ds_read_b64_tr_b16 a[208:209], v36 offset:0
    buffer_load_dwordx4 v66, s[28:31], s61 offen offset:1024 sc1 lds
    v_mfma_f32_16x16x32_bf16 v[154:157], a[60:63], a[216:219], v[154:157]
    ds_read_b64_tr_b16 a[210:211], v36 offset:2048
    v_mfma_f32_16x16x32_bf16 v[166:169], a[56:59], a[220:223], v[166:169]
    ds_read_b64_tr_b16 a[212:213], v38 offset:0
    buffer_load_dwordx4 v65, s[28:31], s61 offen offset:2048 sc1 lds
    v_mfma_f32_16x16x32_bf16 v[170:173], a[60:63], a[220:223], v[170:173]
    ds_read_b64_tr_b16 a[214:215], v38 offset:2048
    s_waitcnt lgkmcnt(8)
    v_mfma_f32_16x16x32_bf16 v[158:161], a[56:59], a[224:227], v[158:161]
    ds_read_b64_tr_b16 a[216:217], v35 offset:4096
    v_mfma_f32_16x16x32_bf16 v[162:165], a[60:63], a[224:227], v[162:165]
    ds_read_b64_tr_b16 a[218:219], v35 offset:6144
    buffer_load_dwordx4 v66, s[28:31], s61 offen offset:3072 sc1 lds
    v_mfma_f32_16x16x32_bf16 v[174:177], a[56:59], a[228:231], v[174:177]
    ds_read_b64_tr_b16 a[220:221], v37 offset:4096
    s_add_u32 m0, s58, 131072
    v_mfma_f32_16x16x32_bf16 v[178:181], a[60:63], a[228:231], v[178:181]
    ds_read_b64_tr_b16 a[222:223], v37 offset:6144
    s_waitcnt lgkmcnt(8)
    v_mfma_f32_16x16x32_bf16 v[150:153], a[64:67], a[200:203], v[150:153]
    ds_read_b64_tr_b16 a[224:225], v36 offset:4096
    s_add_u32 s51, s51, 1
    v_mfma_f32_16x16x32_bf16 v[154:157], a[68:71], a[200:203], v[154:157]
    ds_read_b64_tr_b16 a[226:227], v36 offset:6144
    s_and_b32 s51, s51, 3
    s_lshl_b32 s61, s51, 12
    buffer_load_dwordx4 v65, s[28:31], s61 offen sc1 lds
    v_mfma_f32_16x16x32_bf16 v[166:169], a[64:67], a[204:207], v[166:169]
    ds_read_b64_tr_b16 a[228:229], v38 offset:4096
    v_mfma_f32_16x16x32_bf16 v[170:173], a[68:71], a[204:207], v[170:173]
    ds_read_b64_tr_b16 a[230:231], v38 offset:6144
    s_waitcnt lgkmcnt(8)
    v_mfma_f32_16x16x32_bf16 v[158:161], a[64:67], a[208:211], v[158:161]
    s_barrier
    ds_read_b64_tr_b16 a[200:201], v35 offset:16384
    buffer_load_dwordx4 v66, s[28:31], s61 offen offset:1024 sc1 lds
    v_mfma_f32_16x16x32_bf16 v[162:165], a[68:71], a[208:211], v[162:165]
    ds_read_b64_tr_b16 a[202:203], v35 offset:18432
    v_mfma_f32_16x16x32_bf16 v[174:177], a[64:67], a[212:215], v[174:177]
    ds_read_b64_tr_b16 a[204:205], v37 offset:16384
    buffer_load_dwordx4 v65, s[28:31], s61 offen offset:2048 sc1 lds
    v_mfma_f32_16x16x32_bf16 v[178:181], a[68:71], a[212:215], v[178:181]
    ds_read_b64_tr_b16 a[206:207], v37 offset:18432
    s_waitcnt lgkmcnt(8)
    v_mfma_f32_16x16x32_bf16 v[150:153], a[72:75], a[216:219], v[150:153]
    ds_read_b64_tr_b16 a[208:209], v36 offset:16384
    v_mfma_f32_16x16x32_bf16 v[154:157], a[76:79], a[216:219], v[154:157]
    ds_read_b64_tr_b16 a[210:211], v36 offset:18432
    buffer_load_dwordx4 v66, s[28:31], s61 offen offset:3072 sc1 lds
    v_mfma_f32_16x16x32_bf16 v[166:169], a[72:75], a[220:223], v[166:169]
    ds_read_b64_tr_b16 a[212:213], v38 offset:16384
    s_add_u32 m0, s58, 147456
    v_mfma_f32_16x16x32_bf16 v[170:173], a[76:79], a[220:223], v[170:173]
    ds_read_b64_tr_b16 a[214:215], v38 offset:18432
    s_waitcnt lgkmcnt(8)
    v_mfma_f32_16x16x32_bf16 v[158:161], a[72:75], a[224:227], v[158:161]
    ds_read_b64_tr_b16 a[216:217], v35 offset:20480
    s_add_u32 s51, s51, 1
    v_mfma_f32_16x16x32_bf16 v[162:165], a[76:79], a[224:227], v[162:165]
    ds_read_b64_tr_b16 a[218:219], v35 offset:22528
    s_and_b32 s51, s51, 3
    s_lshl_b32 s61, s51, 12
    buffer_load_dwordx4 v65, s[28:31], s61 offen sc1 lds
    v_mfma_f32_16x16x32_bf16 v[174:177], a[72:75], a[228:231], v[174:177]
    ds_read_b64_tr_b16 a[220:221], v37 offset:20480
    v_mfma_f32_16x16x32_bf16 v[178:181], a[76:79], a[228:231], v[178:181]
    ds_read_b64_tr_b16 a[222:223], v37 offset:22528
    s_waitcnt lgkmcnt(8)
    v_mfma_f32_16x16x32_bf16 v[150:153], a[80:83], a[200:203], v[150:153]
    ds_read_b64_tr_b16 a[224:225], v36 offset:20480
    buffer_load_dwordx4 v66, s[28:31], s61 offen offset:1024 sc1 lds
    v_mfma_f32_16x16x32_bf16 v[154:157], a[84:87], a[200:203], v[154:157]
    ds_read_b64_tr_b16 a[226:227], v36 offset:22528
    v_mfma_f32_16x16x32_bf16 v[166:169], a[80:83], a[204:207], v[166:169]
    ds_read_b64_tr_b16 a[228:229], v38 offset:20480
    buffer_load_dwordx4 v65, s[28:31], s61 offen offset:2048 sc1 lds
    v_mfma_f32_16x16x32_bf16 v[170:173], a[84:87], a[204:207], v[170:173]
    ds_read_b64_tr_b16 a[230:231], v38 offset:22528
    s_waitcnt lgkmcnt(8)
    v_mfma_f32_16x16x32_bf16 v[158:161], a[80:83], a[208:211], v[158:161]
    s_barrier
    ds_read_b64_tr_b16 a[200:201], v31 offset:32768
    buffer_load_dwordx4 v66, s[28:31], s61 offen offset:3072 sc1 lds
    v_mfma_f32_16x16x32_bf16 v[162:165], a[84:87], a[208:211], v[162:165]
    ds_read_b64_tr_b16 a[202:203], v31 offset:34816
    s_add_u32 m0, s58, 16384
    v_mfma_f32_16x16x32_bf16 v[174:177], a[80:83], a[212:215], v[174:177]
    ds_read_b64_tr_b16 a[204:205], v33 offset:32768
    s_add_u32 s66, s66, 1
    v_mfma_f32_16x16x32_bf16 v[178:181], a[84:87], a[212:215], v[178:181]
    ds_read_b64_tr_b16 a[206:207], v33 offset:34816
    s_waitcnt lgkmcnt(8)
    v_mfma_f32_16x16x32_bf16 v[150:153], a[88:91], a[216:219], v[150:153]
    ds_read_b64_tr_b16 a[208:209], v32 offset:32768
    s_and_b32 s66, s66, 3
    v_mfma_f32_16x16x32_bf16 v[154:157], a[92:95], a[216:219], v[154:157]
    ds_read_b64_tr_b16 a[210:211], v32 offset:34816
    s_mul_i32 s61, s66, 100352
    buffer_load_dwordx4 v63, s[16:19], s61 offen lds
    v_mfma_f32_16x16x32_bf16 v[166:169], a[88:91], a[220:223], v[166:169]
    ds_read_b64_tr_b16 a[212:213], v34 offset:32768
    v_mfma_f32_16x16x32_bf16 v[170:173], a[92:95], a[220:223], v[170:173]
    ds_read_b64_tr_b16 a[214:215], v34 offset:34816
    s_waitcnt lgkmcnt(8)
    v_mfma_f32_16x16x32_bf16 v[158:161], a[88:91], a[224:227], v[158:161]
    ds_read_b64_tr_b16 a[216:217], v31 offset:36864
    buffer_load_dwordx4 v64, s[16:19], s61 offen offset:1024 lds
    v_mfma_f32_16x16x32_bf16 v[162:165], a[92:95], a[224:227], v[162:165]
    ds_read_b64_tr_b16 a[218:219], v31 offset:38912
    s_add_u32 s61, s61, 48128
    v_mfma_f32_16x16x32_bf16 v[174:177], a[88:91], a[228:231], v[174:177]
    ds_read_b64_tr_b16 a[220:221], v33 offset:36864
    buffer_load_dwordx4 v63, s[16:19], s61 offen offset:2048 lds
    v_mfma_f32_16x16x32_bf16 v[178:181], a[92:95], a[228:231], v[178:181]
    ds_read_b64_tr_b16 a[222:223], v33 offset:38912
    s_waitcnt lgkmcnt(8)
    v_mfma_f32_16x16x32_bf16 v[150:153], a[96:99], a[200:203], v[150:153]
    ds_read_b64_tr_b16 a[224:225], v32 offset:36864
    v_mfma_f32_16x16x32_bf16 v[154:157], a[100:103], a[200:203], v[154:157]
    ds_read_b64_tr_b16 a[226:227], v32 offset:38912
    buffer_load_dwordx4 v64, s[16:19], s61 offen offset:3072 lds
    v_mfma_f32_16x16x32_bf16 v[166:169], a[96:99], a[204:207], v[166:169]
    ds_read_b64_tr_b16 a[228:229], v34 offset:36864
    s_add_u32 m0, s58, 65536
    v_mfma_f32_16x16x32_bf16 v[170:173], a[100:103], a[204:207], v[170:173]
    ds_read_b64_tr_b16 a[230:231], v34 offset:38912
    s_waitcnt lgkmcnt(8)
    v_mfma_f32_16x16x32_bf16 v[158:161], a[96:99], a[208:211], v[158:161]
    s_waitcnt vmcnt(12)
    s_barrier
    s_xor_b32 s55, s55, 1024
    s_load_dword s14, s[28:29], s55
    ds_read_b64_tr_b16 v[198:199], v43 offset:49152
    ds_read_b64_tr_b16 v[200:201], v43 offset:53248
    s_add_u32 s51, s51, 1
    s_and_b32 s51, s51, 3
    s_lshl_b32 s61, s51, 12
    buffer_load_dwordx4 v65, s[28:31], s61 offen sc1 lds
    v_mfma_f32_16x16x32_bf16 v[162:165], a[100:103], a[208:211], v[162:165]
    ds_read_b64_tr_b16 v[202:203], v44 offset:49152
    v_mfma_f32_16x16x32_bf16 v[174:177], a[96:99], a[212:215], v[174:177]
    ds_read_b64_tr_b16 v[204:205], v44 offset:53248
    buffer_load_dwordx4 v66, s[28:31], s61 offen offset:1024 sc1 lds
    v_mfma_f32_16x16x32_bf16 v[178:181], a[100:103], a[212:215], v[178:181]
    ds_read_b128 a[200:203], v47 offset:0
    s_waitcnt lgkmcnt(9)
    v_mfma_f32_16x16x32_bf16 v[150:153], a[104:107], a[216:219], v[150:153]
    ds_read_b128 a[204:207], v48 offset:0
    v_mfma_f32_16x16x32_bf16 v[154:157], a[108:111], a[216:219], v[154:157]
    ds_read_b128 a[208:211], v47 offset:1024
    buffer_load_dwordx4 v65, s[28:31], s61 offen offset:2048 sc1 lds
    v_mfma_f32_16x16x32_bf16 v[166:169], a[104:107], a[220:223], v[166:169]
    ds_read_b128 a[212:215], v48 offset:1024
    v_mfma_f32_16x16x32_bf16 v[170:173], a[108:111], a[220:223], v[170:173]
    s_waitcnt lgkmcnt(8)
    v_mfma_f32_16x16x32_bf16 v[158:161], a[104:107], a[224:227], v[158:161]
    ds_read_b64_tr_b16 v[206:207], v43 offset:51200
    ds_read_b64_tr_b16 v[208:209], v43 offset:55296
    v_mfma_f32_16x16x32_bf16 v[162:165], a[108:111], a[224:227], v[162:165]
    ds_read_b64_tr_b16 v[210:211], v44 offset:51200
    buffer_load_dwordx4 v66, s[28:31], s61 offen offset:3072 sc1 lds
    v_mfma_f32_16x16x32_bf16 v[174:177], a[104:107], a[228:231], v[174:177]
    ds_read_b64_tr_b16 v[212:213], v44 offset:55296
    v_mfma_f32_16x16x32_bf16 v[178:181], a[108:111], a[228:231], v[178:181]
    ds_read_b128 a[216:219], v47 offset:2048
    s_waitcnt lgkmcnt(7)
    v_mfma_f32_16x16x32_bf16 v[150:153], v[198:201], a[200:203], v[150:153]
    ds_read_b128 a[220:223], v48 offset:2048
    v_mfma_f32_16x16x32_bf16 v[154:157], v[202:205], a[200:203], v[154:157]
    ds_read_b128 a[224:227], v47 offset:3072
    v_mfma_f32_16x16x32_bf16 v[166:169], v[198:201], a[204:207], v[166:169]
    ds_read_b128 a[228:231], v48 offset:3072
    v_mfma_f32_16x16x32_bf16 v[170:173], v[202:205], a[204:207], v[170:173]
    s_waitcnt lgkmcnt(8)
    v_mfma_f32_16x16x32_bf16 v[158:161], v[198:201], a[208:211], v[158:161]
    s_waitcnt vmcnt(12)
    s_barrier
    ds_read_b64_tr_b16 v[214:215], v45 offset:32768
    ds_read_b64_tr_b16 v[216:217], v45 offset:36864
    v_mfma_f32_16x16x32_bf16 v[162:165], v[202:205], a[208:211], v[162:165]
    ds_read_b64_tr_b16 v[218:219], v46 offset:32768
    v_mfma_f32_16x16x32_bf16 v[174:177], v[198:201], a[212:215], v[174:177]
    ds_read_b64_tr_b16 v[220:221], v46 offset:36864
    v_mfma_f32_16x16x32_bf16 v[178:181], v[202:205], a[212:215], v[178:181]
    ds_read_b128 a[200:203], v51 offset:0
    s_waitcnt lgkmcnt(7)
    v_mfma_f32_16x16x32_bf16 v[150:153], v[206:209], a[216:219], v[150:153]
    ds_read_b128 a[204:207], v52 offset:0
    v_mfma_f32_16x16x32_bf16 v[154:157], v[210:213], a[216:219], v[154:157]
    ds_read_b128 a[208:211], v51 offset:1024
    v_mfma_f32_16x16x32_bf16 v[166:169], v[206:209], a[220:223], v[166:169]
    ds_read_b128 a[212:215], v52 offset:1024
    v_mfma_f32_16x16x32_bf16 v[170:173], v[210:213], a[220:223], v[170:173]
    s_waitcnt lgkmcnt(8)
    v_mfma_f32_16x16x32_bf16 v[158:161], v[206:209], a[224:227], v[158:161]
    s_waitcnt lgkmcnt(0)
    s_cmp_ge_u32 s14, 1
    s_cbranch_scc0 L_pollin7
L_pollok7:
    v_xor_b32 v21, 131072, v21
    ds_read_b64_tr_b16 v[198:199], v45 offset:34816
    ds_read_b64_tr_b16 v[200:201], v45 offset:38912
    buffer_load_dwordx4 v[246:249], v21, s[28:31], 0 offen offset:2048 sc1
    v_mfma_f32_16x16x32_bf16 v[162:165], v[210:213], a[224:227], v[162:165]
    ds_read_b64_tr_b16 v[202:203], v46 offset:34816
    buffer_load_dwordx4 v[250:253], v21, s[28:31], 0 offen offset:3072 sc1
    v_mfma_f32_16x16x32_bf16 v[174:177], v[206:209], a[228:231], v[174:177]
    ds_read_b64_tr_b16 v[204:205], v46 offset:38912
    v_mfma_f32_16x16x32_bf16 v[178:181], v[210:213], a[228:231], v[178:181]
    ds_read_b128 a[216:219], v51 offset:2048
    v_mfma_f32_16x16x32_bf16 v[150:153], v[214:217], a[200:203], v[150:153]
    ds_read_b128 a[220:223], v52 offset:2048
    buffer_load_dwordx4 v[238:241], v21, s[28:31], 0 offen offset:0 sc1
    v_mfma_f32_16x16x32_bf16 v[154:157], v[218:221], a[200:203], v[154:157]
    ds_read_b128 a[224:227], v51 offset:3072
    buffer_load_dwordx4 v[242:245], v21, s[28:31], 0 offen offset:1024 sc1
    v_mfma_f32_16x16x32_bf16 v[166:169], v[214:217], a[204:207], v[166:169]
    ds_read_b128 a[228:231], v52 offset:3072
    v_mfma_f32_16x16x32_bf16 v[170:173], v[218:221], a[204:207], v[170:173]
    v_mfma_f32_16x16x32_bf16 v[158:161], v[214:217], a[208:211], v[158:161]
    s_waitcnt vmcnt(12)
    s_barrier
    ds_read_b64_tr_b16 v[206:207], v45 offset:49152
    ds_read_b64_tr_b16 v[208:209], v45 offset:53248
    v_mfma_f32_16x16x32_bf16 v[162:165], v[218:221], a[208:211], v[162:165]
    ds_read_b64_tr_b16 v[210:211], v46 offset:49152
    v_mfma_f32_16x16x32_bf16 v[174:177], v[214:217], a[212:215], v[174:177]
    ds_read_b64_tr_b16 v[212:213], v46 offset:53248
    v_mfma_f32_16x16x32_bf16 v[178:181], v[218:221], a[212:215], v[178:181]
    ds_read_b128 a[200:203], v51 offset:16384
    s_waitcnt lgkmcnt(7)
    v_mfma_f32_16x16x32_bf16 v[150:153], v[198:201], a[216:219], v[150:153]
    ds_read_b128 a[204:207], v52 offset:16384
    v_mfma_f32_16x16x32_bf16 v[154:157], v[202:205], a[216:219], v[154:157]
    ds_read_b128 a[208:211], v51 offset:17408
    v_mfma_f32_16x16x32_bf16 v[166:169], v[198:201], a[220:223], v[166:169]
    ds_read_b128 a[212:215], v52 offset:17408
    v_mfma_f32_16x16x32_bf16 v[170:173], v[202:205], a[220:223], v[170:173]
    s_waitcnt lgkmcnt(8)
    v_mfma_f32_16x16x32_bf16 v[158:161], v[198:201], a[224:227], v[158:161]
    ds_read_b64_tr_b16 v[214:215], v45 offset:51200
    ds_read_b64_tr_b16 v[216:217], v45 offset:55296
    v_mfma_f32_16x16x32_bf16 v[162:165], v[202:205], a[224:227], v[162:165]
    ds_read_b64_tr_b16 v[218:219], v46 offset:51200
    v_mfma_f32_16x16x32_bf16 v[174:177], v[198:201], a[228:231], v[174:177]
    ds_read_b64_tr_b16 v[220:221], v46 offset:55296
    v_mfma_f32_16x16x32_bf16 v[178:181], v[202:205], a[228:231], v[178:181]
    ds_read_b128 a[216:219], v51 offset:18432
    s_waitcnt lgkmcnt(7)
    v_mfma_f32_16x16x32_bf16 v[150:153], v[206:209], a[200:203], v[150:153]
    ds_read_b128 a[220:223], v52 offset:18432
    v_mfma_f32_16x16x32_bf16 v[154:157], v[210:213], a[200:203], v[154:157]
    ds_read_b128 a[224:227], v51 offset:19456
    v_mfma_f32_16x16x32_bf16 v[166:169], v[206:209], a[204:207], v[166:169]
    ds_read_b128 a[228:231], v52 offset:19456
    v_mfma_f32_16x16x32_bf16 v[170:173], v[210:213], a[204:207], v[170:173]
    s_waitcnt lgkmcnt(8)
    v_mfma_f32_16x16x32_bf16 v[158:161], v[206:209], a[208:211], v[158:161]
    s_waitcnt vmcnt(4)
    s_barrier
    ds_read_b64_tr_b16 v[198:199], v43 offset:16384
    ds_read_b64_tr_b16 v[200:201], v43 offset:20480
    v_mfma_f32_16x16x32_bf16 v[162:165], v[210:213], a[208:211], v[162:165]
    ds_read_b64_tr_b16 v[202:203], v44 offset:16384
    v_mfma_f32_16x16x32_bf16 v[174:177], v[206:209], a[212:215], v[174:177]
    ds_read_b64_tr_b16 v[204:205], v44 offset:20480
    v_mfma_f32_16x16x32_bf16 v[178:181], v[210:213], a[212:215], v[178:181]
    ds_read_b128 a[200:203], v50 offset:0
    s_waitcnt lgkmcnt(7)
    v_mfma_f32_16x16x32_bf16 v[150:153], v[214:217], a[216:219], v[150:153]
    ds_read_b128 a[204:207], v50 offset:1024
    ds_read_b64_tr_b16 v[206:207], v43 offset:18432
    v_mfma_f32_16x16x32_bf16 v[154:157], v[218:221], a[216:219], v[154:157]
    ds_read_b64_tr_b16 v[208:209], v43 offset:22528
    ds_read_b64_tr_b16 v[210:211], v44 offset:18432
    v_mfma_f32_16x16x32_bf16 v[166:169], v[214:217], a[220:223], v[166:169]
    ds_read_b64_tr_b16 v[212:213], v44 offset:22528
    v_mfma_f32_16x16x32_bf16 v[170:173], v[218:221], a[220:223], v[170:173]
    ds_read_b128 a[208:211], v50 offset:2048
    s_waitcnt lgkmcnt(11)
    v_mfma_f32_16x16x32_bf16 v[158:161], v[214:217], a[224:227], v[158:161]
    ds_read_b128 a[212:215], v50 offset:3072
    v_mfma_f32_16x16x32_bf16 v[162:165], v[218:221], a[224:227], v[162:165]
    v_mfma_f32_16x16x32_bf16 v[174:177], v[214:217], a[228:231], v[174:177]
    v_mfma_f32_16x16x32_bf16 v[178:181], v[218:221], a[228:231], v[178:181]
    s_waitcnt lgkmcnt(6)
    v_mfma_f32_16x16x32_bf16 v[166:169], v[198:201], a[200:203], v[166:169]
    ds_read_b128 a[224:227], v49 offset:0
    v_mfma_f32_16x16x32_bf16 v[170:173], v[202:205], a[200:203], v[170:173]
    v_mfma_f32_16x16x32_bf16 v[174:177], v[198:201], a[204:207], v[174:177]
    ds_read_b128 a[228:231], v49 offset:1024
    v_mfma_f32_16x16x32_bf16 v[178:181], v[202:205], a[204:207], v[178:181]
    s_waitcnt lgkmcnt(2)
    v_mfma_f32_16x16x32_bf16 v[166:169], v[206:209], a[208:211], v[166:169]
    ds_read_b128 a[200:203], v49 offset:2048
    v_mfma_f32_16x16x32_bf16 v[170:173], v[210:213], a[208:211], v[170:173]
    v_mfma_f32_16x16x32_bf16 v[174:177], v[206:209], a[212:215], v[174:177]
    ds_read_b128 a[204:207], v49 offset:3072
L_pad4:
    s_cbranch_execz L_warm
    v_mfma_f32_16x16x32_bf16 v[178:181], v[210:213], a[212:215], v[178:181]
    s_waitcnt vmcnt(3)
    v_mfma_f32_16x16x32_bf16 v[166:169], a[250:253], v[246:249], v[166:169]
    v_mfma_f32_16x16x32_bf16 v[170:173], a[248:251], v[246:249], v[170:173]
    s_waitcnt vmcnt(2)
    v_mfma_f32_16x16x32_bf16 v[174:177], a[250:253], v[250:253], v[174:177]
    v_mfma_f32_16x16x32_bf16 v[178:181], a[248:251], v[250:253], v[178:181]
    s_waitcnt lgkmcnt(2)
    v_mfma_f32_16x16x32_bf16 v[150:153], v[198:201], a[224:227], v[150:153]
    v_mfma_f32_16x16x32_bf16 v[154:157], v[202:205], a[224:227], v[154:157]
    v_mfma_f32_16x16x32_bf16 v[158:161], v[198:201], a[228:231], v[158:161]
    ds_write_b128 v87, v[166:169] offset:8192
    v_mfma_f32_16x16x32_bf16 v[162:165], v[202:205], a[228:231], v[162:165]
    s_waitcnt lgkmcnt(1)
    v_mfma_f32_16x16x32_bf16 v[150:153], v[206:209], a[200:203], v[150:153]
    ds_write_b128 v88, v[170:173] offset:8192
    v_mfma_f32_16x16x32_bf16 v[154:157], v[210:213], a[200:203], v[154:157]
    v_mfma_f32_16x16x32_bf16 v[158:161], v[206:209], a[204:207], v[158:161]
    ds_write_b128 v87, v[174:177] offset:12288
    v_mfma_f32_16x16x32_bf16 v[162:165], v[210:213], a[204:207], v[162:165]
    s_waitcnt vmcnt(1)
    v_mfma_f32_16x16x32_bf16 v[150:153], a[250:253], v[238:241], v[150:153]
    ds_write_b128 v88, v[178:181] offset:12288
    v_mfma_f32_16x16x32_bf16 v[154:157], a[248:251], v[238:241], v[154:157]
    s_waitcnt vmcnt(0)
    v_mfma_f32_16x16x32_bf16 v[158:161], a[250:253], v[242:245], v[158:161]
    v_mfma_f32_16x16x32_bf16 v[162:165], a[248:251], v[242:245], v[162:165]
    s_nop 2
    ds_write_b128 v87, v[150:153] offset:0
    s_nop 0
    ds_write_b128 v88, v[154:157] offset:0
    s_nop 0
    ds_write_b128 v87, v[158:161] offset:4096
    ds_write_b128 v88, v[162:165] offset:4096
    s_waitcnt lgkmcnt(0)
    s_barrier
    ds_read_b128 v[118:121], v89 offset:0
    ds_read_b128 v[122:125], v90 offset:0
    ds_read_b128 v[126:129], v91 offset:0
    ds_read_b128 v[130:133], v92 offset:0
    ds_read_b128 v[134:137], v89 offset:2048
    ds_read_b128 v[138:141], v90 offset:2048
    ds_read_b128 v[142:145], v91 offset:2048
    ds_read_b128 v[146:149], v92 offset:2048
    s_waitcnt lgkmcnt(7)
    v_pk_add_f32 v[222:223], v[222:223], v[118:119]
    v_pk_add_f32 v[224:225], v[224:225], v[120:121]
    s_waitcnt lgkmcnt(6)
    v_pk_add_f32 v[226:227], v[226:227], v[122:123]
    v_pk_add_f32 v[228:229], v[228:229], v[124:125]
    s_waitcnt lgkmcnt(5)
    v_pk_add_f32 v[222:223], v[222:223], v[126:127]
    v_pk_add_f32 v[224:225], v[224:225], v[128:129]
    s_waitcnt lgkmcnt(4)
    v_pk_add_f32 v[226:227], v[226:227], v[130:131]
    v_pk_add_f32 v[228:229], v[228:229], v[132:133]
    v_cvt_pk_bf16_f32 v110, v222, v223
    v_cvt_pk_bf16_f32 v111, v224, v225
    v_cvt_pk_bf16_f32 v112, v226, v227
    v_cvt_pk_bf16_f32 v113, v228, v229
    buffer_store_dwordx4 v[110:113], v85, s[32:35], 0 offen
    s_waitcnt lgkmcnt(3)
    v_pk_add_f32 v[230:231], v[230:231], v[134:135]
    v_pk_add_f32 v[232:233], v[232:233], v[136:137]
    s_waitcnt lgkmcnt(2)
    v_pk_add_f32 v[234:235], v[234:235], v[138:139]
    v_pk_add_f32 v[236:237], v[236:237], v[140:141]
    s_waitcnt lgkmcnt(1)
    v_pk_add_f32 v[230:231], v[230:231], v[142:143]
    v_pk_add_f32 v[232:233], v[232:233], v[144:145]
    s_waitcnt lgkmcnt(0)
    v_pk_add_f32 v[234:235], v[234:235], v[146:147]
    v_pk_add_f32 v[236:237], v[236:237], v[148:149]
    v_cvt_pk_bf16_f32 v114, v230, v231
    v_cvt_pk_bf16_f32 v115, v232, v233
    v_cvt_pk_bf16_f32 v116, v234, v235
    v_cvt_pk_bf16_f32 v117, v236, v237
    buffer_store_dwordx4 v[114:117], v86, s[32:35], 0 offen
L_fin:
L_end:
    s_endpgm
L_nonce:
    buffer_load_dword v12, v16, s[44:47], 0 offen sc1
    s_add_u32 s60, s60, 1
    s_waitcnt vmcnt(0)
    v_readfirstlane_b32 s57, v12
    s_cmp_ge_u32 s60, 20000
    s_cbranch_scc1 L_nonce_ok
    s_cmp_eq_u32 s57, 0
    s_cbranch_scc1 L_nonce
    s_branch L_nonce_ok
L_pollin0:
    s_mov_b32 s60, 0
L_poll0:
    s_sleep 4
    buffer_load_dword v18, v20, s[28:31], 0 offen sc1
    s_add_u32 s60, s60, 1
    s_waitcnt vmcnt(0)
    v_cmp_ne_u32 vcc, s57, v18
    s_cbranch_vccz L_pollok0
    s_cmp_lt_u32 s60, 20000
    s_cbranch_scc1 L_poll0
    s_branch L_pollok0
L_pollin1:
    s_mov_b32 s60, 0
    s_branch L_poll1a
L_poll1:
    s_sleep 8
L_poll1a:
    buffer_load_dword v18, off, s[44:47], s15 sc1
    s_add_u32 s60, s60, 1
    s_waitcnt vmcnt(0)
    v_readfirstlane_b32 s14, v18
    s_nop 0
    s_cmp_ge_u32 s14, 14
    s_cbranch_scc1 L_pollok1
    s_cmp_lt_u32 s60, 20000
    s_cbranch_scc1 L_poll1
    s_branch L_pollok1
L_pollin2:
    s_mov_b32 s60, 0
    s_branch L_poll2a
L_poll2:
    s_sleep 4
L_poll2a:
    buffer_load_dword v18, off, s[28:31], s37 sc1
    s_add_u32 s60, s60, 1
    s_waitcnt vmcnt(0)
    v_readfirstlane_b32 s14, v18
    s_nop 0
    s_cmp_ge_u32 s14, 2
    s_cbranch_scc1 L_pollok2
    s_cmp_lt_u32 s60, 20000
    s_cbranch_scc1 L_poll2
    s_branch L_pollok2
L_nonceh:
    buffer_load_dword v12, v16, s[44:47], 0 offen sc1
    s_add_u32 s60, s60, 1
    s_waitcnt vmcnt(0)
    v_readfirstlane_b32 s57, v12
    s_cmp_ge_u32 s60, 20000
    s_cbranch_scc1 L_nonce_okh
    s_cmp_eq_u32 s57, 0
    s_cbranch_scc1 L_nonceh
    s_branch L_nonce_okh
L_pollin3:
    s_mov_b32 s60, 0
L_poll3:
    s_sleep 8
    buffer_load_dword v18, v20, s[28:31], 0 offen sc1
    s_add_u32 s60, s60, 1
    s_waitcnt vmcnt(0)
    v_cmp_ne_u32 vcc, s57, v18
    s_cbranch_vccz L_pollok3
    s_cmp_lt_u32 s60, 20000
    s_cbranch_scc1 L_poll3
    s_branch L_pollok3
L_pollin4:
    s_mov_b32 s60, 0
    s_branch L_poll4a
L_poll4:
    s_sleep 16
L_poll4a:
    buffer_load_dword v18, off, s[44:47], s15 sc1
    s_add_u32 s60, s60, 1
    s_waitcnt vmcnt(0)
    v_readfirstlane_b32 s14, v18
    s_nop 0
    s_cmp_ge_u32 s14, 14
    s_cbranch_scc1 L_pollok4
    s_cmp_lt_u32 s60, 20000
    s_cbranch_scc1 L_poll4
    s_branch L_pollok4
L_nog1:
    s_nop 1
    s_mov_b32 s14, 1204224
    s_mov_b32 s15, 0x20000
    s_sub_u32 s3, s2, 200
    s_cmp_lt_u32 s3, 42
    s_cselect_b32 s81, 0, 268435456
    s_cselect_b32 s3, s3, 0
    s_mul_i32 s79, s3, 43
    s_lshr_b32 s79, s79, 7
    s_mul_i32 s80, s79, 3
    s_sub_u32 s80, s3, s80
    v_min_u32 v13, 55, v1
    s_lshl_b32 s3, s79, 2
    s_add_u32 s3, s3, s48
    s_mul_i32 s3, s3, 21504
    s_mul_i32 s60, s80, 896
    s_add_u32 s3, s3, s60
    s_add_u32 s3, s3, s81
    v_lshl_add_u32 v242, v13, 4, s3
    s_mul_i32 s60, s48, 8448
    s_add_u32 m0, s60, 0
    s_mov_b32 s3, 0
    buffer_load_dwordx4 v242, s[12:15], s3 offen lds
    s_add_u32 m0, s60, 1056
    s_mov_b32 s3, 2688
    buffer_load_dwordx4 v242, s[12:15], s3 offen lds
    s_add_u32 m0, s60, 2112
    s_mov_b32 s3, 5376
    buffer_load_dwordx4 v242, s[12:15], s3 offen lds
    s_add_u32 m0, s60, 3168
    s_mov_b32 s3, 8064
    buffer_load_dwordx4 v242, s[12:15], s3 offen lds
    s_add_u32 m0, s60, 4224
    s_mov_b32 s3, 10752
    buffer_load_dwordx4 v242, s[12:15], s3 offen lds
    s_add_u32 m0, s60, 5280
    s_mov_b32 s3, 13440
    buffer_load_dwordx4 v242, s[12:15], s3 offen lds
    s_add_u32 m0, s60, 6336
    s_mov_b32 s3, 16128
    buffer_load_dwordx4 v242, s[12:15], s3 offen lds
    s_add_u32 m0, s60, 7392
    s_mov_b32 s3, 18816
    buffer_load_dwordx4 v242, s[12:15], s3 offen lds
    s_mul_i32 s53, s101, 37
    s_lshr_b32 s53, s53, 8
    s_mul_i32 s54, s53, 7
    s_sub_u32 s54, s101, s54
    s_and_b32 s53, s53, 3
    s_lshl_b32 s3, s6, 2
    s_add_u32 s53, s53, s3
    s_lshl_b32 s53, s53, 1
    s_add_u32 s53, s53, s7
    s_mov_b32 s42, 4096
    s_mov_b32 s43, 0x20000
    s_lshl_b32 s3, s53, 2
    s_add_u32 s3, s3, s48
    s_lshl_b32 s60, s3, 5
    v_lshl_add_u32 v82, v5, 1, s60
    s_mul_i32 s3, s3, 14336
    s_lshl_b32 s60, s54, 7
    s_add_u32 s3, s3, s60
    v_mul_u32_u24 v14, 896, v5
    v_lshl_add_u32 v14, v6, 4, v14
    v_add_u32 v85, s3, v14
    v_add_u32 v86, 7168, v85
    s_cmp_lt_u32 s101, 28
    s_cselect_b32 s56, 1, 0
    s_lshl_b32 s50, s7, 3
    s_and_b32 s3, s101, 7
    s_add_u32 s50, s50, s3
    s_lshr_b32 s60, s101, 3
    s_lshl_b32 s49, s6, 2
    s_add_u32 s49, s49, s60
    s_lshl_b32 s49, s49, 2
    s_add_u32 s49, s49, s48
    s_mul_i32 s60, s60, 0
    s_add_u32 s3, s3, s60
    s_sub_u32 s60, s3, 7
    s_cmp_ge_u32 s3, 7
    s_cselect_b32 s3, s60, s3
    s_lshl_b32 s62, s3, 18
    s_mul_i32 s63, s3, 12288
    s_mov_b32 s30, 20971520
    s_mov_b32 s31, 0x20000
    s_mov_b32 s75, 0x3727c5ac
    s_mov_b32 s76, 0x3b124925
    s_mov_b32 s77, 0x3f803f80
    v_lshlrev_b32 v4, 4, v1
    v_bfe_u32 v7, v1, 2, 2
    v_and_b32 v8, 3, v1
    v_mul_u32_u24 v13, 960, v9
    v_lshl_add_u32 v13, v10, 4, v13
    s_mul_i32 s3, s48, 1920
    s_add_u32 s3, s3, 147456
    v_add_u32 v230, s3, v13
    v_mul_u32_u24 v13, 960, v7
    v_lshl_add_u32 v13, v3, 5, v13
    v_lshl_add_u32 v13, v8, 3, v13
    s_lshl_b32 s3, s48, 8
    s_add_u32 s3, s3, 147456
    v_add_u32 v231, s3, v13
    s_lshl_b32 s3, s48, 3
    s_add_u32 s3, s3, 155648
    v_lshl_add_u32 v232, v9, 2, s3
    v_lshlrev_b32 v237, 2, v6
    v_and_b32 v2, 15, v1
    v_lshlrev_b32 v238, 14, v3
    v_add_lshl_u32 v238, v238, v2, 2
    v_add_u32 v237, 155648, v237
    v_lshlrev_b32 v13, 17, v9
    v_lshl_add_u32 v233, v10, 4, v13
    s_cmp_eq_u32 s48, 3
    s_cselect_b32 s60, 268435456, 0
    s_lshl_b32 s70, s48, 10
    s_add_u32 s70, s70, s2
    s_lshl_b32 s70, s70, 9
    s_add_u32 s71, s70, 262144
    s_add_u32 s71, s71, s60
    s_xor_b32 s60, s60, 268435456
    s_lshl_b32 s72, s2, 7
    s_add_u32 s72, s72, s60
    s_add_u32 s72, s72, 6291456
    s_lshr_b32 s74, s2, 2
    s_lshl_b32 s74, s74, 5
    s_and_b32 s3, s2, 3
    s_add_u32 s74, s74, s3
    s_lshl_b32 s74, s74, 2
    s_add_u32 s74, s74, 10485760
    v_cmp_gt_u32 vcc, 8, v0
    v_lshlrev_b32 v236, 13, v0
    v_mov_b32 v13, 268435456
    s_and_b32 s3, s2, 7
    s_lshl_b32 s3, s3, 13
    s_add_u32 s3, s3, 10485760
    v_lshrrev_b32 v14, 2, v0
    v_lshl_add_u32 v14, v14, 7, s3
    v_lshl_add_u32 v20, v8, 2, v14
    v_cndmask_b32 v236, v13, v236, vcc
    v_mov_b32 v16, 0
    s_lshl_b32 s3, s48, 14
    s_add_u32 s74, s74, s3
    s_add_u32 s73, s74, 8192
    s_waitcnt vmcnt(10)
    v_dot2_f32_bf16 v226, v182, s77, 0
    v_dot2_f32_bf16 v227, v182, v182, 0
    v_dot2_f32_bf16 v226, v183, s77, v226
    v_dot2_f32_bf16 v227, v183, v183, v227
    v_dot2_f32_bf16 v226, v184, s77, v226
    v_dot2_f32_bf16 v227, v184, v184, v227
    v_dot2_f32_bf16 v226, v185, s77, v226
    v_dot2_f32_bf16 v227, v185, v185, v227
    s_waitcnt vmcnt(9)
    v_dot2_f32_bf16 v226, v186, s77, v226
    v_dot2_f32_bf16 v227, v186, v186, v227
    v_dot2_f32_bf16 v226, v187, s77, v226
    v_dot2_f32_bf16 v227, v187, v187, v227
    v_dot2_f32_bf16 v226, v188, s77, v226
    v_dot2_f32_bf16 v227, v188, v188, v227
    v_dot2_f32_bf16 v226, v189, s77, v226
    v_dot2_f32_bf16 v227, v189, v189, v227
    buffer_load_dword v12, v16, s[44:47], 0 offen sc1
    v_lshlrev_b32 v190, 16, v182
    v_and_b32 v191, 0xffff0000, v182
    v_add_f32_dpp v226, v226, v226 quad_perm:[1,0,3,2] row_mask:0xf bank_mask:0xf
    v_add_f32_dpp v227, v227, v227 quad_perm:[1,0,3,2] row_mask:0xf bank_mask:0xf
    v_lshlrev_b32 v192, 16, v183
    v_add_f32_dpp v226, v226, v226 quad_perm:[2,3,0,1] row_mask:0xf bank_mask:0xf
    v_add_f32_dpp v227, v227, v227 quad_perm:[2,3,0,1] row_mask:0xf bank_mask:0xf
    v_and_b32 v193, 0xffff0000, v183
    v_add_f32_dpp v226, v226, v226 row_half_mirror row_mask:0xf bank_mask:0xf
    v_add_f32_dpp v227, v227, v227 row_half_mirror row_mask:0xf bank_mask:0xf
    v_lshlrev_b32 v194, 16, v184
    v_add_f32_dpp v226, v226, v226 row_mirror row_mask:0xf bank_mask:0xf
    v_add_f32_dpp v227, v227, v227 row_mirror row_mask:0xf bank_mask:0xf
    v_and_b32 v195, 0xffff0000, v184
    v_mov_b32 v228, v226
    v_mov_b32 v229, v227
    v_lshlrev_b32 v196, 16, v185
    v_permlane16_swap_b32 v226, v228
    v_permlane16_swap_b32 v227, v229
    v_add_f32 v226, v226, v228
    v_add_f32 v227, v227, v229
    v_mul_f32_e64 v226, -v226, s76
    v_mul_f32 v228, v226, v226
    v_fma_f32 v227, v227, s76, -v228
    v_max_f32 v227, 0, v227
    v_add_f32 v228, s75, v227
    v_rsq_f32 v222, v228
    v_and_b32 v197, 0xffff0000, v185
    v_mul_f32 v228, v222, v222
    v_fma_f32 v229, v228, v227, s75
    v_rsq_f32 v228, v229
    v_mul_f32 v223, v226, v222
    v_mul_f32 v224, v222, v228
    v_mul_f32 v225, v223, v228
    v_mul_f32 v229, v229, v228
    ds_write_b32 v232, v229
    v_lshlrev_b32 v198, 16, v186
    v_and_b32 v199, 0xffff0000, v186
    v_lshlrev_b32 v200, 16, v187
    v_and_b32 v201, 0xffff0000, v187
    v_lshlrev_b32 v202, 16, v188
    v_and_b32 v203, 0xffff0000, v188
    v_lshlrev_b32 v204, 16, v189
    v_and_b32 v205, 0xffff0000, v189
    v_pk_fma_f32 v[206:207], v[190:191], v[224:225], v[224:225] op_sel:[0,0,1] op_sel_hi:[1,0,1]
    v_pk_fma_f32 v[208:209], v[192:193], v[224:225], v[224:225] op_sel:[0,0,1] op_sel_hi:[1,0,1]
    v_pk_fma_f32 v[210:211], v[194:195], v[224:225], v[224:225] op_sel:[0,0,1] op_sel_hi:[1,0,1]
    v_pk_fma_f32 v[212:213], v[196:197], v[224:225], v[224:225] op_sel:[0,0,1] op_sel_hi:[1,0,1]
    v_cvt_pk_bf16_f32 v182, v206, v207
    v_cvt_pk_bf16_f32 v183, v208, v209
    v_cvt_pk_bf16_f32 v184, v210, v211
    v_cvt_pk_bf16_f32 v185, v212, v213
    ds_write_b128 v230, v[182:185] offset:0
    v_pk_fma_f32 v[214:215], v[198:199], v[224:225], v[224:225] op_sel:[0,0,1] op_sel_hi:[1,0,1]
    v_pk_fma_f32 v[216:217], v[200:201], v[224:225], v[224:225] op_sel:[0,0,1] op_sel_hi:[1,0,1]
    v_pk_fma_f32 v[218:219], v[202:203], v[224:225], v[224:225] op_sel:[0,0,1] op_sel_hi:[1,0,1]
    v_pk_fma_f32 v[220:221], v[204:205], v[224:225], v[224:225] op_sel:[0,0,1] op_sel_hi:[1,0,1]
    v_cvt_pk_bf16_f32 v186, v214, v215
    v_cvt_pk_bf16_f32 v187, v216, v217
    v_cvt_pk_bf16_f32 v188, v218, v219
    v_cvt_pk_bf16_f32 v189, v220, v221
    ds_write_b128 v230, v[186:189] offset:448
    s_waitcnt lgkmcnt(0)
    s_barrier
    ds_read_b64_tr_b16 v[110:111], v231 offset:0
    ds_read_b64_tr_b16 v[112:113], v231 offset:3840
    ds_read_b64_tr_b16 v[114:115], v231 offset:128
    ds_read_b64_tr_b16 v[116:117], v231 offset:3968
    ds_read_b32 v229, v237
    s_waitcnt lgkmcnt(3)
    buffer_store_dwordx4 v[110:113], v233, s[28:31], s70 offen sc1
    s_waitcnt lgkmcnt(1)
    buffer_store_dwordx4 v[114:117], v233, s[28:31], s71 offen sc1
    v_cmp_gt_u32 vcc, 16, v1
    s_waitcnt lgkmcnt(0)
    s_nop 0
    v_cndmask_b32 v229, 0, v229, vcc
    buffer_store_dword v229, v238, s[28:31], s72 offen sc1
    v_lshrrev_b32 v13, 2, v1
    v_mul_u32_u24 v13, 1056, v13
    v_lshl_add_u32 v13, v8, 3, v13
    s_mul_i32 s3, s48, 224
    v_add_u32 v243, s3, v13
    s_mov_b32 s18, 401408
    s_mov_b32 s19, 0x20000
    s_mov_b32 s26, 7340032
    s_mov_b32 s27, 0x20000
    s_mov_b32 s34, 1835008
    s_mov_b32 s35, 0x20000
    s_mov_b32 s36, 1
    v_lshrrev_b32 v14, 2, v1
    v_lshlrev_b32 v14, 7, v14
    v_lshl_add_u32 v14, v8, 3, v14
    v_and_b32 v15, 3, v5
    v_lshl_add_u32 v14, v15, 5, v14
    s_mul_i32 s3, s4, 8256
    v_xor_b32 v31, s3, v14
    v_xor_b32 v32, 32, v31
    v_xor_b32 v33, 64, v31
    v_xor_b32 v34, 96, v31
    v_add_u32 v35, 65536, v31
    v_add_u32 v36, 65536, v32
    v_add_u32 v37, 65536, v33
    v_add_u32 v38, 65536, v34
    v_add_u32 v39, 131072, v31
    v_add_u32 v40, 131072, v32
    v_add_u32 v41, 131072, v33
    v_add_u32 v42, 131072, v34
    s_lshl_b32 s6, s52, 1
    s_add_u32 s6, s6, s5
    s_lshl_b32 s3, s6, 1
    s_add_u32 s3, s3, s59
    s_lshl_b32 s3, s3, 4
    s_add_u32 s3, s3, s4
    s_lshl_b32 s3, s3, 12
    v_lshl_add_u32 v78, v3, 8, v4
    v_add_u32 v78, s3, v78
    s_xor_b32 s37, s51, 1
    s_lshl_b32 s37, s37, 3
    s_add_u32 s37, s37, s52
    s_lshl_b32 s3, s37, 14
    s_add_u32 s3, s3, s58
    s_add_u32 s3, s3, 16777216
    v_add_u32 v23, s3, v4
    s_lshl_b32 s37, s37, 5
    s_add_u32 s37, s37, s5
    s_lshl_b32 s37, s37, 2
    s_add_u32 s37, s37, 6422528
    s_mul_i32 s67, s6, 56
    s_lshl_b32 s3, s51, 1
    s_add_u32 s3, s3, s4
    s_add_u32 s67, s67, s3
    s_lshl_b32 s67, s67, 11
    s_add_u32 s67, s67, 2097152
    v_add_u32 v81, s58, v4
    s_lshl_b32 s68, s52, 2
    s_and_b32 s3, s51, 1
    s_add_u32 s68, s68, s3
    s_cmp_ge_u32 s51, 14
    s_cselect_b32 s3, 2, 0
    s_add_u32 s68, s68, s3
    s_lshl_b32 s68, s68, 7
    s_add_u32 s68, s68, 6356992
    s_waitcnt vmcnt(3)
    v_readfirstlane_b32 s57, v12
    s_mov_b32 s60, 0
    s_cmp_lg_u32 s57, 0
    s_cbranch_scc0 L_nonceh
L_nonce_okh:
    s_waitcnt vmcnt(0)
    s_barrier
    s_atomic_swap s57, s[28:29], s74
    s_atomic_swap s57, s[28:29], s73
    buffer_load_dwordx4 v[96:99], v85, s[8:11], 0 offen
    buffer_load_ushort v93, v82, s[40:43], 0 offen offset:0
    buffer_load_dwordx4 v[100:103], v86, s[8:11], 0 offen
    buffer_load_ushort v94, v82, s[40:43], 0 offen offset:16
    v_cmp_gt_u32 vcc, 12, v2
    s_mul_i32 s3, s48, 56
    s_add_u32 s3, s3, s79
    s_mul_i32 s3, s3, 3
    s_add_u32 s3, s3, s80
    s_lshl_b32 s3, s3, 11
    s_add_u32 s3, s3, 8388608
    s_add_u32 s3, s3, s81
    ds_read_b64_tr_b16 v[182:183], v243 offset:0
    ds_read_b64_tr_b16 v[184:185], v243 offset:16896
    ds_read_b64_tr_b16 v[186:187], v243 offset:32
    ds_read_b64_tr_b16 v[188:189], v243 offset:16928
    ds_read_b64_tr_b16 v[190:191], v243 offset:56
    ds_read_b64_tr_b16 v[192:193], v243 offset:16952
    ds_read_b64_tr_b16 v[194:195], v243 offset:88
    ds_read_b64_tr_b16 v[196:197], v243 offset:16984
    ds_read_b64_tr_b16 v[198:199], v243 offset:112
    ds_read_b64_tr_b16 v[200:201], v243 offset:17008
    ds_read_b64_tr_b16 v[202:203], v243 offset:144
    ds_read_b64_tr_b16 v[204:205], v243 offset:17040
    ds_read_b64_tr_b16 v[206:207], v243 offset:168
    ds_read_b64_tr_b16 v[208:209], v243 offset:17064
    ds_read_b64_tr_b16 v[210:211], v243 offset:200
    ds_read_b64_tr_b16 v[212:213], v243 offset:17096
    s_waitcnt lgkmcnt(13)
    v_cndmask_b32 v186, 0, v186, vcc
    v_cndmask_b32 v187, 0, v187, vcc
    s_waitcnt lgkmcnt(12)
    v_cndmask_b32 v188, 0, v188, vcc
    v_cndmask_b32 v189, 0, v189, vcc
    buffer_store_dwordx4 v[182:185], v4, s[28:31], s3 offen offset:0 sc1
    buffer_store_dwordx4 v[186:189], v4, s[28:31], s3 offen offset:1024 sc1
    s_add_u32 s3, s3, 86016
    s_waitcnt lgkmcnt(9)
    v_cndmask_b32 v194, 0, v194, vcc
    v_cndmask_b32 v195, 0, v195, vcc
    s_waitcnt lgkmcnt(8)
    v_cndmask_b32 v196, 0, v196, vcc
    v_cndmask_b32 v197, 0, v197, vcc
    buffer_store_dwordx4 v[190:193], v4, s[28:31], s3 offen offset:0 sc1
    buffer_store_dwordx4 v[194:197], v4, s[28:31], s3 offen offset:1024 sc1
    s_add_u32 s3, s3, 86016
    s_waitcnt lgkmcnt(5)
    v_cndmask_b32 v202, 0, v202, vcc
    v_cndmask_b32 v203, 0, v203, vcc
    s_waitcnt lgkmcnt(4)
    v_cndmask_b32 v204, 0, v204, vcc
    v_cndmask_b32 v205, 0, v205, vcc
    buffer_store_dwordx4 v[198:201], v4, s[28:31], s3 offen offset:0 sc1
    buffer_store_dwordx4 v[202:205], v4, s[28:31], s3 offen offset:1024 sc1
    s_add_u32 s3, s3, 86016
    ds_read_b32 v24, v4
    s_waitcnt lgkmcnt(2)
    v_cndmask_b32 v210, 0, v210, vcc
    v_cndmask_b32 v211, 0, v211, vcc
    ds_read_b32 v24, v4
    s_waitcnt lgkmcnt(2)
    v_cndmask_b32 v212, 0, v212, vcc
    v_cndmask_b32 v213, 0, v213, vcc
    buffer_store_dwordx4 v[206:209], v4, s[28:31], s3 offen offset:0 sc1
    buffer_store_dwordx4 v[210:213], v4, s[28:31], s3 offen offset:1024 sc1
    s_add_u32 s3, s3, 86016
    s_lshl_b32 s67, s80, 6
    s_add_u32 s67, s67, 64
    s_cmp_eq_u32 s81, 0
    s_cselect_b32 s37, s48, 1
    s_mov_b32 s68, 6369792
    s_and_b32 s3, s2, 1
    s_mul_i32 s3, s3, 3
    s_bfe_u32 s6, s2, 0x10001
    s_mul_i32 s7, s6, 6
    s_add_u32 s3, s3, s7
    s_add_u32 s3, s3, 1
    v_add_u32 v14, s3, v8
    s_mul_i32 s6, s6, 64
    s_add_u32 s6, s6, 7
    v_cmp_ne_u32 vcc, s6, v14
    v_lshrrev_b32 v15, 2, v1
    v_mul_u32_u24 v15, 3584, v15
    v_cndmask_b32 v14, 0, v14, vcc
    v_lshl_add_u32 v14, v14, 8, v15
    s_lshl_b32 s3, s52, 2
    s_add_u32 s3, s3, s48
    s_mul_i32 s3, s3, 37
    s_min_u32 s3, s3, 987
    s_mul_i32 s3, s3, 3584
    s_mul_i32 s6, s59, 3670144
    s_add_u32 s3, s3, s6
    buffer_load_dword v226, v14, s[20:23], s3 offen
    s_add_u32 s3, s3, 57344
    buffer_load_dword v227, v14, s[20:23], s3 offen
    s_add_u32 s3, s3, 57344
    v_cmp_gt_u32 vcc, 20, v1
    v_mov_b32 v15, 268435456
    s_nop 0
    v_cndmask_b32 v14, v15, v14, vcc
    buffer_load_dword v228, v14, s[20:23], s3 offen
    s_add_u32 s3, s3, 57344
    v_add_u32 v53, 65536, v4
    v_add_u32 v54, 131072, v4
    s_mul_i32 s59, s48, 3072
    s_mul_i32 s3, s50, 86016
    s_add_u32 s3, s3, s59
    s_add_u32 s3, s3, 8388608
    v_add_u32 v80, s3, v4
    v_lshlrev_b32 v14, 7, v9
    v_xor_b32 v14, v14, v4
    s_lshl_b32 s3, s49, 11
    v_add_u32 v67, s3, v14
    v_add_u32 v68, 129024, v67
    s_lshr_b32 s3, s49, 2
    s_lshl_b32 s3, s3, 3
    s_max_u32 s3, s3, 1
    s_sub_u32 s3, s3, 1
    s_lshl_b32 s3, s3, 10
    s_lshl_b32 s6, s5, 17
    s_add_u32 s3, s3, s6
    s_lshl_b32 s6, s4, 28
    s_add_u32 s3, s3, s6
    v_add_u32 v69, s3, v14
    s_lshl_b32 s100, s5, 1
    s_add_u32 s100, s100, s4
    s_lshl_b32 s100, s100, 10
    v_and_b32 v14, 1, v1
    v_mul_u32_u24 v14, 640, v14
    v_lshrrev_b32 v15, 2, v1
    v_lshlrev_b32 v15, 4, v15
    v_xor_b32 v14, v14, v15
    v_bfe_u32 v15, v1, 1, 1
    v_lshl_add_u32 v14, v15, 3, v14
    s_add_u32 s3, s58, 12288
    v_add_u32 v70, s3, v14
    s_sub_u32 s3, s3, 3072
    s_cmp_eq_u32 s48, 0
    s_cselect_b32 s3, 28672, s3
    v_add_u32 v71, s3, v14
    v_add_u32 v72, 65536, v70
    v_add_u32 v73, 65536, v71
    v_add_u32 v74, 131072, v70
    v_add_u32 v75, 131072, v71
    s_lshl_b32 s3, s49, 1
    v_min_u32 v14, 2, v3
    v_add_u32 v14, s3, v14
    v_max_u32 v14, 1, v14
    v_lshlrev_b32 v14, 1, v14
    v_and_b32 v15, 1, v7
    v_add_lshl_u32 v14, v14, v15, 7
    v_lshrrev_b32 v15, 1, v7
    v_lshl_add_u32 v15, v15, 2, v8
    v_lshl_add_u32 v14, v15, 2, v14
    v_add_u32 v77, 6291200, v14
    s_min_u32 s15, s48, 2
    s_lshl_b32 s15, s15, 6
    s_add_u32 s15, s15, 64
    s_lshl_b32 s82, s49, 5
    s_add_u32 s82, s82, s50
    s_lshl_b32 s82, s82, 10
    s_add_u32 s82, s82, 4194304
    s_lshr_b32 s69, s49, 2
    s_lshl_b32 s69, s69, 1
    s_and_b32 s3, s50, 1
    s_add_u32 s69, s69, s3
    s_lshl_b32 s69, s69, 7
    s_add_u32 s69, s69, 6361088
    s_and_b32 s7, s53, 1
    s_mul_i32 s3, s7, 28
    s_add_u32 s3, s3, s48
    s_lshl_b32 s3, s3, 17
    s_xor_b32 s6, s53, 1
    s_lshl_b32 s55, s6, 3
    s_lshl_b32 s6, s53, 7
    s_add_u32 s3, s3, s6
    v_lshlrev_b32 v14, 12, v5
    v_add3_u32 v59, v14, v83, s3
    v_add_u32 v60, 31744, v59
    v_add_u32 v61, 63488, v59
    v_add_u32 v62, 95232, v59
    v_mul_u32_u24 v14, 896, v5
    s_mul_i32 s3, s4, 25088
    s_mul_i32 s6, s5, 14336
    s_add_u32 s3, s3, s6
    s_lshl_b32 s6, s54, 7
    s_add_u32 s3, s3, s6
    v_add3_u32 v63, v14, v83, s3
    v_add_u32 v64, 6144, v63
    s_lshl_b32 s6, s53, 1
    s_add_u32 s6, s6, s5
    s_and_b32 s3, s53, 30
    s_add_u32 s3, s3, s4
    s_lshl_b32 s3, s3, 7
    s_add_u32 s39, s3, 6361088
    s_lshl_b32 s3, s6, 5
    s_add_u32 s3, s3, s4
    s_lshl_b32 s3, s3, 10
    s_add_u32 s3, s3, 4194304
    v_add_u32 v65, s3, v4
    v_add_u32 v66, 15360, v65
    s_xor_b32 s3, s4, s5
    s_lshl_b32 s3, s3, 6
    v_xor_b32 v43, s3, v31
    v_xor_b32 v44, 32, v43
    v_add_u32 v45, 65536, v43
    v_add_u32 v46, 65536, v44
    s_mul_i32 s3, s4, 12288
    v_add_u32 v47, s3, v4
    v_xor_b32 v48, 4096, v47
    v_add_u32 v49, 65536, v47
    v_add_u32 v50, 65536, v48
    v_add_u32 v51, 131072, v47
    v_add_u32 v52, 131072, v48
    s_lshl_b32 s6, s54, 1
    s_add_u32 s6, s6, s5
    s_lshl_b32 s3, s6, 1
    s_add_u32 s3, s3, s7
    s_mul_i32 s3, s3, 14
    s_add_u32 s3, s3, s4
    s_lshl_b32 s3, s3, 12
    s_add_u32 s3, s3, 2097152
    v_add_u32 v79, s3, v4
    s_lshl_b32 s3, s54, 1
    s_add_u32 s3, s3, s7
    s_lshl_b32 s3, s3, 1
    s_add_u32 s3, s3, s4
    s_lshl_b32 s3, s3, 7
    s_add_u32 s38, s3, 6356992
    s_and_b32 s3, s2, 6
    s_add_u32 s3, s3, s54
    s_sub_u32 s6, s3, 7
    s_cmp_ge_u32 s3, 7
    s_cselect_b32 s3, s6, s3
    s_lshl_b32 s64, s3, 19
    s_lshl_b32 s65, s3, 13
    s_add_u32 s55, s55, s54
    s_lshl_b32 s3, s55, 14
    s_add_u32 s3, s3, s58
    s_add_u32 s3, s3, 12582912
    v_add_u32 v21, s3, v4
    s_lshl_b32 s55, s55, 5
    s_add_u32 s55, s55, s48
    s_lshl_b32 s55, s55, 2
    s_add_u32 s55, s55, 6488064
    s_lshl_b32 s3, s5, 3
    v_add_u32 v13, s3, v3
    v_xor_b32 v13, v13, v6
    v_lshlrev_b32 v13, 4, v13
    v_lshl_add_u32 v13, v2, 8, v13
    s_lshl_b32 s3, s4, 14
    s_add_u32 s3, s3, 32768
    v_add_u32 v87, s3, v13
    v_xor_b32 v88, 64, v87
    s_lshr_b32 s3, s53, 1
    s_add_u32 s66, s3, s54
    s_mov_b32 s51, s66
    v_lshlrev_b32 v13, 1, v6
    v_xor_b32 v13, v13, v5
    v_lshlrev_b32 v13, 4, v13
    v_lshl_add_u32 v13, v5, 8, v13
    s_add_u32 s3, s58, 32768
    v_add_u32 v89, s3, v13
    v_xor_b32 v90, 16, v89
    v_xor_b32 v91, 24576, v89
    v_xor_b32 v92, 24592, v89
    s_mov_b32 s70, 0xaaaaaaaa
    s_mov_b32 s71, 0xaaaaaaaa
    s_mov_b32 s72, 0xfff0ffff
    s_mov_b32 s73, 0xf000ff00
    s_mov_b32 s74, 0xffc0fffc
    s_mov_b32 s75, 0xc000fc00
    s_cmp_eq_u32 s49, 0
    s_cselect_b64 s[76:77], 0, -1
    v_mov_b32 v13, 0xffff
    v_mov_b32 v14, 0xffff0000
    v_cndmask_b32 v13, v13, v14, s[70:71]
    v_cndmask_b32 v104, v13, 0, s[72:73]
    v_cndmask_b32 v106, 0, v13, s[72:73]
    v_cndmask_b32 v105, v13, 0, s[74:75]
    v_cndmask_b32 v107, 0, v13, s[74:75]
    v_mov_b32 v84, 0xf149f2ca
    s_mov_b32 s83, 0x3e8b97f6
    s_mov_b32 s78, 0xbdd2d3e8
    s_mov_b32 s79, 0xbdd2d3e8
    s_mov_b32 s80, 1.0
    s_mov_b32 s81, 1.0
    v_mov_b32 v108, 0xc0135761
    v_mov_b32 v109, 0xc0135761
    v_lshrrev_b32 v13, 1, v2
    v_lshlrev_b32 v14, 1, v3
    v_sub_u32 v13, v13, v14
    v_mov_b32 v14, 0x3f80
    v_cndmask_b32 v14, v14, 1.0, s[70:71]
    v_cmp_eq_i32 vcc, 0, v13
    v_accvgpr_write_b32 a248, 0
    v_accvgpr_write_b32 a252, 0
    v_cndmask_b32 v15, 0, v14, vcc
    v_accvgpr_write_b32 a250, v15
    v_cmp_eq_i32 vcc, 1, v13
    v_accvgpr_write_b32 a249, 0
    v_accvgpr_write_b32 a253, 0
    v_cndmask_b32 v15, 0, v14, vcc
    v_accvgpr_write_b32 a251, v15
    s_waitcnt vmcnt(3)
    s_barrier
    s_cmp_lg_u32 s37, 0
    s_cbranch_scc1 L_nowsig
    s_atomic_add s36, s[44:45], s67
L_nowsig:
    buffer_load_dword v18, v20, s[28:31], 0 offen sc1
    s_mov_b32 s26, 7340032
    s_and_b32 s3, s2, 1
    s_mul_i32 s3, s3, 7
    s_add_u32 s3, s3, s52
    s_lshl_b32 s3, s3, 2
    s_add_u32 s3, s3, s48
    s_lshl_b32 s3, s3, 17
    s_and_b32 s6, s2, 6
    s_lshl_b32 s6, s6, 9
    s_add_u32 s3, s3, s6
    v_lshlrev_b32 v242, 12, v10
    v_lshl_add_u32 v242, v9, 9, v242
    buffer_load_dword v232, v242, s[24:27], s3 offen offset:384
    buffer_load_dword v233, v242, s[24:27], s3 offen offset:256
    s_cmp_eq_u32 s56, 0
    s_cselect_b32 s26, 0, s26
    s_cmp_eq_u32 s56, 0
    s_cselect_b32 s26, 0, s26
    v_and_b32 v13, 0xfffff000, v78
    v_lshl_add_u32 v13, v10, 7, v13
    s_add_u32 s3, s1, 8192
    v_lshl_add_u32 v14, v9, 13, s3
    s_waitcnt vmcnt(2)
    v_cmp_ne_u32 vcc, s57, v18
    s_cbranch_vccnz L_pollin3
L_pollok3:
    s_load_dword s14, s[44:45], s15
    s_barrier
    buffer_load_dword v76, v77, s[28:31], 0 offen sc1
    s_waitcnt lgkmcnt(0)
    s_cmp_ge_u32 s14, 14
    s_cbranch_scc0 L_pollin4
L_pollok4:
    s_barrier
    s_cmp_eq_u32 s56, 0
    s_cselect_b32 s3, 268435456, 0
    v_add_u32 v79, s3, v79
    s_add_u32 m0, s59, 98304
    s_nop 0
    buffer_load_dwordx4 v80, s[28:31], s63 offen sc1 lds
    buffer_load_dwordx4 v80, s[28:31], s63 offen offset:1024 sc1 lds
    buffer_load_dwordx4 v80, s[28:31], s63 offen offset:2048 sc1 lds
    s_add_u32 m0, s100, 126976
    s_nop 0
    buffer_load_dwordx4 v69, s[28:31], s62 offen sc1 lds
    s_add_u32 m0, s58, 110592
    s_nop 0
    buffer_load_dwordx4 v67, s[28:31], s62 offen sc1 lds
    buffer_load_dwordx4 v67, s[28:31], s62 offen offset:1024 sc1 lds
    buffer_load_dwordx4 v68, s[28:31], s62 offen offset:2048 sc1 lds
    buffer_load_dwordx4 v68, s[28:31], s62 offen offset:3072 sc1 lds
    s_add_u32 m0, s59, 131072
    s_add_u32 s63, s63, 12288
    s_cmp_eq_u32 s63, 86016
    s_cselect_b32 s63, 0, s63
    buffer_load_dwordx4 v80, s[28:31], s63 offen sc1 lds
    buffer_load_dwordx4 v80, s[28:31], s63 offen offset:1024 sc1 lds
    buffer_load_dwordx4 v80, s[28:31], s63 offen offset:2048 sc1 lds
    s_add_u32 m0, s100, 159744
    s_add_u32 s62, s62, 262144
    s_cmp_eq_u32 s62, 1835008
    s_cselect_b32 s62, 0, s62
    buffer_load_dwordx4 v69, s[28:31], s62 offen sc1 lds
    s_add_u32 m0, s58, 143360
    s_nop 0
    buffer_load_dwordx4 v67, s[28:31], s62 offen sc1 lds
    buffer_load_dwordx4 v67, s[28:31], s62 offen offset:1024 sc1 lds
    buffer_load_dwordx4 v68, s[28:31], s62 offen offset:2048 sc1 lds
    buffer_load_dwordx4 v68, s[28:31], s62 offen offset:3072 sc1 lds
    s_add_u32 m0, s59, 0
    s_add_u32 s63, s63, 12288
    s_cmp_eq_u32 s63, 86016
    s_cselect_b32 s63, 0, s63
    buffer_load_dwordx4 v80, s[28:31], s63 offen sc1 lds
    buffer_load_dwordx4 v80, s[28:31], s63 offen offset:1024 sc1 lds
    buffer_load_dwordx4 v80, s[28:31], s63 offen offset:2048 sc1 lds
    s_add_u32 m0, s100, 28672
    s_add_u32 s62, s62, 262144
    s_cmp_eq_u32 s62, 1835008
    s_cselect_b32 s62, 0, s62
    buffer_load_dwordx4 v69, s[28:31], s62 offen sc1 lds
    s_add_u32 m0, s58, 12288
    s_nop 0
    buffer_load_dwordx4 v67, s[28:31], s62 offen sc1 lds
    buffer_load_dwordx4 v67, s[28:31], s62 offen offset:1024 sc1 lds
    buffer_load_dwordx4 v68, s[28:31], s62 offen offset:2048 sc1 lds
    buffer_load_dwordx4 v68, s[28:31], s62 offen offset:3072 sc1 lds
    s_add_u32 m0, s59, 65536
    s_add_u32 s63, s63, 12288
    s_cmp_eq_u32 s63, 86016
    s_cselect_b32 s63, 0, s63
    buffer_load_dwordx4 v80, s[28:31], s63 offen sc1 lds
    buffer_load_dwordx4 v80, s[28:31], s63 offen offset:1024 sc1 lds
    buffer_load_dwordx4 v80, s[28:31], s63 offen offset:2048 sc1 lds
    s_add_u32 m0, s100, 94208
    s_add_u32 s62, s62, 262144
    s_cmp_eq_u32 s62, 1835008
    s_cselect_b32 s62, 0, s62
    buffer_load_dwordx4 v69, s[28:31], s62 offen sc1 lds
    s_add_u32 m0, s58, 77824
    s_nop 0
    buffer_load_dwordx4 v67, s[28:31], s62 offen sc1 lds
    buffer_load_dwordx4 v67, s[28:31], s62 offen offset:1024 sc1 lds
    buffer_load_dwordx4 v68, s[28:31], s62 offen offset:2048 sc1 lds
    buffer_load_dwordx4 v68, s[28:31], s62 offen offset:3072 sc1 lds
    s_mov_b32 s3, 268435456
    buffer_store_dword v12, v11, s[28:31], s3 offen
    buffer_store_dword v12, v11, s[28:31], s3 offen
    v_lshlrev_b32 v13, 2, v2
    v_and_b32 v14, 1, v1
    v_lshl_add_u32 v14, v3, 2, v14
    v_lshlrev_b32 v14, 2, v14
    v_add_u32 v15, 64, v14
    v_cndmask_b32 v16, v14, v15, s[72:73]
    v_cndmask_b32 v14, v14, v15, s[74:75]
    s_waitcnt vmcnt(34)
    ds_bpermute_b32 v25, v13, v76 offset:64
    ds_bpermute_b32 v27, v16, v76 offset:0
    ds_bpermute_b32 v28, v14, v76 offset:8
    ds_bpermute_b32 v26, v13, v76 offset:128
    ds_bpermute_b32 v29, v16, v76 offset:64
    ds_bpermute_b32 v30, v14, v76 offset:72
    s_waitcnt lgkmcnt(5)
    v_mul_f32 v25, s83, v25
    s_waitcnt lgkmcnt(2)
    v_mul_f32 v26, s83, v26
    s_waitcnt vmcnt(18) lgkmcnt(0)
    s_barrier
    ds_read_b64_tr_b16 a[180:181], v72 offset:32768
    ds_read_b64_tr_b16 a[182:183], v72 offset:33024
    ds_read_b128 a[128:131], v53 offset:32768
    ds_read_b64_tr_b16 a[184:185], v72 offset:33792
    ds_read_b64_tr_b16 a[186:187], v72 offset:34048
    ds_read_b128 a[132:135], v53 offset:33792
    ds_read_b128 a[136:139], v53 offset:34816
    ds_read_b64_tr_b16 a[176:177], v73 offset:32768
    ds_read_b64_tr_b16 a[178:179], v73 offset:33024
    ds_read_b128 a[140:143], v53 offset:35840
    ds_read_b128 a[144:147], v53 offset:36864
    ds_read_b128 a[148:151], v53 offset:37888
    s_waitcnt lgkmcnt(0)
    s_nop 3
    s_branch L_q
L_pollin5:
    s_cmp_eq_u32 s56, 0
    s_cbranch_scc1 L_pollok5
    s_mov_b32 s60, 0
    s_branch L_poll5a
L_poll5:
    s_sleep 8
L_poll5a:
    buffer_load_dword v18, off, s[28:31], s38 sc1
    s_add_u32 s60, s60, 1
    s_waitcnt vmcnt(0)
    v_readfirstlane_b32 s14, v18
    s_nop 0
    s_cmp_ge_u32 s14, 7
    s_cbranch_scc1 L_pollok5
    s_cmp_lt_u32 s60, 20000
    s_cbranch_scc1 L_poll5
    s_branch L_pollok5
L_nof:
    s_waitcnt vmcnt(0)
    s_barrier
    s_cmp_lg_u32 s48, 0
    s_cbranch_scc1 L_sig3
    s_atomic_add s36, s[28:29], s69
L_sig3:
    v_lshlrev_b32 v14, 7, v1
    s_lshl_b32 s3, s54, 2
    s_add_u32 s3, s3, s48
    s_mul_i32 s3, s3, 25088
    buffer_load_dword v182, v14, s[16:19], s3 offen
    s_add_u32 s3, s3, 5632
    buffer_load_dword v183, v14, s[16:19], s3 offen
    s_add_u32 s3, s3, 5632
    buffer_load_dword v184, v14, s[16:19], s3 offen
    s_add_u32 s3, s3, 5632
    buffer_load_dword v185, v14, s[16:19], s3 offen
    s_add_u32 s3, s3, 5632
    s_branch L_fin
L_pollin6:
    s_mov_b32 s60, 0
    s_branch L_poll6a
L_poll6:
    s_sleep 8
L_poll6a:
    buffer_load_dword v18, off, s[28:31], s39 sc1
    s_add_u32 s60, s60, 1
    s_waitcnt vmcnt(0)
    v_readfirstlane_b32 s14, v18
    s_nop 0
    s_cmp_ge_u32 s14, 8
    s_cbranch_scc1 L_pollok6
    s_cmp_lt_u32 s60, 20000
    s_cbranch_scc1 L_poll6
    s_branch L_pollok6
L_pollin7:
    s_mov_b32 s60, 0
    s_branch L_poll7a
L_poll7:
    s_sleep 4
L_poll7a:
    buffer_load_dword v18, off, s[28:31], s55 sc1
    s_add_u32 s60, s60, 1
    s_waitcnt vmcnt(0)
    v_readfirstlane_b32 s14, v18
    s_nop 0
    s_cmp_ge_u32 s14, 1
    s_cbranch_scc1 L_pollok7
    s_cmp_lt_u32 s60, 20000
    s_cbranch_scc1 L_poll7
    s_branch L_pollok7
L_last:
    s_endpgm
.section .rodata,"a"
.p2align 6
.amdhsa_kernel parallel_sum__sliding_local_dilated__mixer_token_mlp__prompt_kernel
  .amdhsa_next_free_vgpr 512
  .amdhsa_next_free_sgpr 102
  .amdhsa_accum_offset 256
  .amdhsa_group_segment_fixed_size 0
  .amdhsa_kernarg_size 88
  .amdhsa_user_sgpr_count 2
  .amdhsa_user_sgpr_kernarg_segment_ptr 1
  .amdhsa_system_sgpr_workgroup_id_x 1
.end_amdhsa_kernel
```

```asm
; @launch grid=(256,1,1) block=(256,1,1) lds=163840
.amdgcn_target "amdgcn-amd-amdhsa--gfx950"
.text
.globl parallel_sum__sliding_local_dilated__mixer_token_mlp__prompt_kernel
.p2align 8
.type parallel_sum__sliding_local_dilated__mixer_token_mlp__prompt_kernel,@function
parallel_sum__sliding_local_dilated__mixer_token_mlp__prompt_kernel:
    s_cmp_ge_u32 s2, 256
    s_cbranch_scc1 L_end
    s_load_dwordx2 s[8:9], s[0:1], 0
    s_load_dwordx2 s[20:21], s[0:1], 32
    s_load_dwordx2 s[28:29], s[0:1], 80
    s_load_dwordx2 s[44:45], s[0:1], 72
    s_load_dwordx2 s[12:13], s[0:1], 8
    s_load_dwordx2 s[16:17], s[0:1], 16
    s_load_dwordx2 s[24:25], s[0:1], 48
    s_load_dwordx2 s[32:33], s[0:1], 64
    s_load_dwordx2 s[36:37], s[0:1], 40
    s_load_dwordx2 s[40:41], s[0:1], 56
    s_memrealtime s[78:79]
    s_getpc_b64 s[6:7]
L_pc:
    s_and_b32 s3, s2, 0xf8
    v_lshrrev_b32 v13, 5, v0
    v_add_lshl_u32 v13, s3, v13, 7
    v_min_u32 v13, L_last-L_pc, v13
    global_load_dword v18, v13, s[6:7]
    v_lshrrev_b32 v13, 6, v0
    v_and_b32 v10, 31, v0
    v_readfirstlane_b32 s48, v13
    v_bfe_u32 v9, v0, 5, 1
    v_mul_u32_u24 v14, 896, v9
    v_lshl_add_u32 v14, v10, 4, v14
    v_cmp_gt_u32 vcc, 28, v10
    v_mov_b32 v15, 268435456
    s_mov_b32 s10, 1835008
    s_mov_b32 s11, 0x20000
    v_cndmask_b32 v14, v15, v14, vcc
    s_lshr_b32 s4, s48, 1
    s_and_b32 s5, s48, 1
    s_and_b32 s3, s2, 0xfe
    s_add_u32 s3, s3, s4
    s_lshl_b32 s3, s3, 1
    s_and_b32 s60, s2, 1
    s_add_u32 s3, s3, s60
    s_lshl_b32 s3, s3, 1
    s_add_u32 s3, s3, s5
    s_mul_i32 s3, s3, 1792
    s_waitcnt lgkmcnt(0)
    buffer_load_dwordx4 v[182:185], v14, s[8:11], s3 offen
    buffer_load_dwordx4 v[186:189], v14, s[8:11], s3 offen offset:448
    v_and_b32 v1, 63, v0
    s_mov_b32 s46, 256
    s_mov_b32 s47, 0x20000
    s_lshl_b32 s3, s48, 8
    s_add_u32 s3, s3, s2
    s_cmp_lt_u32 s3, 8
    s_cselect_b32 s3, 0, 268435456
    s_or_b32 s78, s78, 1
    v_mov_b32 v234, s78
    v_mov_b32 v235, 0
    v_lshlrev_b32 v11, 25, v1
    buffer_atomic_cmpswap v[234:235], v11, s[44:47], s3 offen sc1
    s_bfe_u32 s6, s2, 0x20001
    s_and_b32 s7, s2, 1
    s_and_b32 s61, s2, 7
    s_lshr_b32 s101, s2, 3
    s_mul_i32 s52, s7, 25
    s_add_u32 s52, s52, s101
    s_mul_i32 s51, s52, 37
    s_lshr_b32 s51, s51, 8
    s_mul_i32 s3, s51, 7
    s_sub_u32 s52, s52, s3
    s_and_b32 s3, s6, 1
    s_mul_i32 s3, s3, 6
    s_add_u32 s51, s51, s3
    s_add_u32 s51, s51, 1
    s_add_u32 s3, s3, s51
    s_cmp_eq_u32 s3, 7
    s_cselect_b32 s51, 0, s51
    s_lshr_b32 s59, s6, 1
    s_lshl_b32 s51, s51, 1
    s_add_u32 s51, s51, s59
    s_max_u32 s60, s101, 25
    s_sub_u32 s60, s60, 25
    s_add_u32 s3, s101, s7
    s_cmp_lt_u32 s3, 25
    s_cselect_b32 s55, 1, 0
    s_cselect_b32 s52, s52, s60
    s_mov_b32 s22, 7340032
    s_mov_b32 s23, 0x20000
    s_lshl_b32 s3, s52, 1
    s_sub_u32 s60, s3, 7
    s_cmp_ge_u32 s3, 7
    s_cselect_b32 s3, s60, s3
    s_and_b32 s3, s3, 7
    s_mul_i32 s60, s61, 2
    s_add_u32 s3, s3, s60
    s_and_b32 s3, s3, 7
    s_mul_i32 s0, s3, 458752
    s_lshl_b32 s1, s3, 13
    s_lshl_b32 s58, s48, 12
    v_lshrrev_b32 v3, 4, v1
    v_lshrrev_b32 v5, 3, v1
    v_and_b32 v6, 7, v1
    v_lshlrev_b32 v14, 1, v3
    v_xor_b32 v14, v14, v6
    v_lshlrev_b32 v83, 4, v14
    s_cmp_eq_u32 s55, 0
    s_cbranch_scc1 L_nog1
    v_mul_u32_u24 v14, 3584, v5
    s_lshl_b32 s3, s59, 5
    s_add_u32 s3, s3, s48
    s_mul_i32 s3, s3, 114688
    s_lshl_b32 s60, s51, 7
    s_add_u32 s3, s3, s60
    v_add3_u32 v55, v14, v83, s3
    v_add_u32 v56, 56320, v55
    v_add_u32 v57, 26624, v55
    v_add_u32 v58, 82944, v55
    s_mov_b32 s38, 3584
    s_mov_b32 s39, 0x20000
    v_lshlrev_b32 v13, 3, v3
    s_lshl_b32 s3, s51, 1
    s_add_u32 s3, s3, s4
    s_lshl_b32 s3, s3, 6
    buffer_load_dwordx2 v[246:247], v13, s[36:39], s3 offen offset:0
    buffer_load_dwordx2 v[248:249], v13, s[36:39], s3 offen offset:32
    s_add_u32 m0, s58, 0
    v_xor_b32 v55, 128, v55
    buffer_load_dwordx4 v55, s[20:23], s0 offen lds
    v_xor_b32 v56, 128, v56
    buffer_load_dwordx4 v56, s[20:23], s0 offen offset:1024 lds
    v_xor_b32 v57, 128, v57
    buffer_load_dwordx4 v57, s[20:23], s0 offen offset:2048 lds
    v_xor_b32 v58, 128, v58
    buffer_load_dwordx4 v58, s[20:23], s0 offen offset:3072 lds
    s_mul_i32 s53, s101, 37
    s_lshr_b32 s53, s53, 8
    s_mul_i32 s54, s53, 7
    s_sub_u32 s54, s101, s54
    s_and_b32 s53, s53, 3
    s_lshl_b32 s3, s6, 2
    s_add_u32 s53, s53, s3
    s_lshl_b32 s53, s53, 1
    s_add_u32 s53, s53, s7
    s_mov_b32 s42, 4096
    s_mov_b32 s43, 0x20000
    s_lshl_b32 s3, s53, 2
    s_add_u32 s3, s3, s48
    s_lshl_b32 s60, s3, 5
    v_lshl_add_u32 v82, v5, 1, s60
    s_mul_i32 s3, s3, 14336
    s_lshl_b32 s60, s54, 7
    s_add_u32 s3, s3, s60
    v_mul_u32_u24 v14, 896, v5
    v_lshl_add_u32 v14, v6, 4, v14
    v_add_u32 v85, s3, v14
    v_add_u32 v86, 7168, v85
    s_cmp_lt_u32 s101, 28
    s_cselect_b32 s56, 1, 0
    s_lshl_b32 s50, s7, 3
    s_and_b32 s3, s101, 7
    s_add_u32 s50, s50, s3
    s_lshr_b32 s60, s101, 3
    s_lshl_b32 s49, s6, 2
    s_add_u32 s49, s49, s60
    s_lshl_b32 s49, s49, 2
    s_add_u32 s49, s49, s48
    s_mul_i32 s60, s60, 0
    s_add_u32 s3, s3, s60
    s_sub_u32 s60, s3, 7
    s_cmp_ge_u32 s3, 7
    s_cselect_b32 s3, s60, s3
    s_lshl_b32 s62, s3, 18
    s_mul_i32 s63, s3, 12288
    s_mov_b32 s30, 20971520
    s_mov_b32 s31, 0x20000
    s_mov_b32 s75, 0x3727c5ac
    s_mov_b32 s76, 0x3b124925
    s_mov_b32 s77, 0x3f803f80
    v_lshlrev_b32 v4, 4, v1
    v_bfe_u32 v7, v1, 2, 2
    v_and_b32 v8, 3, v1
    v_mul_u32_u24 v13, 960, v9
    v_lshl_add_u32 v13, v10, 4, v13
    s_mul_i32 s3, s48, 1920
    s_add_u32 s3, s3, 147456
    v_add_u32 v230, s3, v13
    v_mul_u32_u24 v13, 960, v7
    v_lshl_add_u32 v13, v3, 5, v13
    v_lshl_add_u32 v13, v8, 3, v13
    s_lshl_b32 s3, s48, 8
    s_add_u32 s3, s3, 147456
    v_add_u32 v231, s3, v13
    s_lshl_b32 s3, s48, 3
    s_add_u32 s3, s3, 155648
    v_lshl_add_u32 v232, v9, 2, s3
    v_lshlrev_b32 v237, 2, v6
    v_and_b32 v2, 15, v1
    v_lshlrev_b32 v238, 14, v3
    v_add_lshl_u32 v238, v238, v2, 2
    v_add_u32 v237, 155648, v237
    v_lshlrev_b32 v13, 17, v9
    v_lshl_add_u32 v233, v10, 4, v13
    s_cmp_eq_u32 s48, 3
    s_cselect_b32 s60, 268435456, 0
    s_lshl_b32 s70, s48, 10
    s_add_u32 s70, s70, s2
    s_lshl_b32 s70, s70, 9
    s_add_u32 s71, s70, 262144
    s_add_u32 s71, s71, s60
    s_xor_b32 s60, s60, 268435456
    s_lshl_b32 s72, s2, 7
    s_add_u32 s72, s72, s60
    s_add_u32 s72, s72, 6291456
    s_lshr_b32 s74, s2, 2
    s_lshl_b32 s74, s74, 5
    s_and_b32 s3, s2, 3
    s_add_u32 s74, s74, s3
    s_lshl_b32 s74, s74, 2
    s_add_u32 s74, s74, 10485760
    v_cmp_gt_u32 vcc, 8, v0
    v_lshlrev_b32 v236, 13, v0
    v_mov_b32 v13, 268435456
    s_and_b32 s3, s2, 7
    s_lshl_b32 s3, s3, 13
    s_add_u32 s3, s3, 10485760
    v_lshrrev_b32 v14, 2, v0
    v_lshl_add_u32 v14, v14, 7, s3
    v_lshl_add_u32 v20, v8, 2, v14
    v_cndmask_b32 v236, v13, v236, vcc
    v_mov_b32 v16, 0
    s_lshl_b32 s3, s48, 14
    s_add_u32 s74, s74, s3
    s_add_u32 s73, s74, 8192
    s_waitcnt vmcnt(8)
    v_dot2_f32_bf16 v226, v182, s77, 0
    v_dot2_f32_bf16 v227, v182, v182, 0
    v_dot2_f32_bf16 v226, v183, s77, v226
    v_dot2_f32_bf16 v227, v183, v183, v227
    v_dot2_f32_bf16 v226, v184, s77, v226
    v_dot2_f32_bf16 v227, v184, v184, v227
    v_dot2_f32_bf16 v226, v185, s77, v226
    v_dot2_f32_bf16 v227, v185, v185, v227
    s_waitcnt vmcnt(7)
    v_dot2_f32_bf16 v226, v186, s77, v226
    v_dot2_f32_bf16 v227, v186, v186, v227
    v_dot2_f32_bf16 v226, v187, s77, v226
    v_dot2_f32_bf16 v227, v187, v187, v227
    v_dot2_f32_bf16 v226, v188, s77, v226
    v_dot2_f32_bf16 v227, v188, v188, v227
    v_dot2_f32_bf16 v226, v189, s77, v226
    v_dot2_f32_bf16 v227, v189, v189, v227
    buffer_load_dword v12, v16, s[44:47], 0 offen sc1
    v_lshlrev_b32 v190, 16, v182
    v_and_b32 v191, 0xffff0000, v182
    v_add_f32_dpp v226, v226, v226 quad_perm:[1,0,3,2] row_mask:0xf bank_mask:0xf
    v_add_f32_dpp v227, v227, v227 quad_perm:[1,0,3,2] row_mask:0xf bank_mask:0xf
    v_lshlrev_b32 v192, 16, v183
    v_add_f32_dpp v226, v226, v226 quad_perm:[2,3,0,1] row_mask:0xf bank_mask:0xf
    v_add_f32_dpp v227, v227, v227 quad_perm:[2,3,0,1] row_mask:0xf bank_mask:0xf
    v_and_b32 v193, 0xffff0000, v183
    v_add_f32_dpp v226, v226, v226 row_half_mirror row_mask:0xf bank_mask:0xf
    v_add_f32_dpp v227, v227, v227 row_half_mirror row_mask:0xf bank_mask:0xf
    v_lshlrev_b32 v194, 16, v184
    v_add_f32_dpp v226, v226, v226 row_mirror row_mask:0xf bank_mask:0xf
    v_add_f32_dpp v227, v227, v227 row_mirror row_mask:0xf bank_mask:0xf
    v_and_b32 v195, 0xffff0000, v184
    v_mov_b32 v228, v226
    v_mov_b32 v229, v227
    v_lshlrev_b32 v196, 16, v185
    v_permlane16_swap_b32 v226, v228
    v_permlane16_swap_b32 v227, v229
    v_add_f32 v226, v226, v228
    v_add_f32 v227, v227, v229
    v_mul_f32_e64 v226, -v226, s76
    v_mul_f32 v228, v226, v226
    v_fma_f32 v227, v227, s76, -v228
    v_max_f32 v227, 0, v227
    v_add_f32 v228, s75, v227
    v_rsq_f32 v222, v228
    v_and_b32 v197, 0xffff0000, v185
    v_mul_f32 v228, v222, v222
    v_fma_f32 v229, v228, v227, s75
    v_rsq_f32 v228, v229
    v_mul_f32 v223, v226, v222
    v_mul_f32 v224, v222, v228
    v_mul_f32 v225, v223, v228
    v_mul_f32 v229, v229, v228
    ds_write_b32 v232, v229
    v_lshlrev_b32 v198, 16, v186
    v_and_b32 v199, 0xffff0000, v186
    v_lshlrev_b32 v200, 16, v187
    v_and_b32 v201, 0xffff0000, v187
    v_lshlrev_b32 v202, 16, v188
    v_and_b32 v203, 0xffff0000, v188
    v_lshlrev_b32 v204, 16, v189
    v_and_b32 v205, 0xffff0000, v189
    v_pk_fma_f32 v[206:207], v[190:191], v[224:225], v[224:225] op_sel:[0,0,1] op_sel_hi:[1,0,1]
    v_pk_fma_f32 v[208:209], v[192:193], v[224:225], v[224:225] op_sel:[0,0,1] op_sel_hi:[1,0,1]
    v_pk_fma_f32 v[210:211], v[194:195], v[224:225], v[224:225] op_sel:[0,0,1] op_sel_hi:[1,0,1]
    v_pk_fma_f32 v[212:213], v[196:197], v[224:225], v[224:225] op_sel:[0,0,1] op_sel_hi:[1,0,1]
    v_cvt_pk_bf16_f32 v182, v206, v207
    v_cvt_pk_bf16_f32 v183, v208, v209
    v_cvt_pk_bf16_f32 v184, v210, v211
    v_cvt_pk_bf16_f32 v185, v212, v213
    ds_write_b128 v230, v[182:185] offset:0
    v_pk_fma_f32 v[214:215], v[198:199], v[224:225], v[224:225] op_sel:[0,0,1] op_sel_hi:[1,0,1]
    v_pk_fma_f32 v[216:217], v[200:201], v[224:225], v[224:225] op_sel:[0,0,1] op_sel_hi:[1,0,1]
    v_pk_fma_f32 v[218:219], v[202:203], v[224:225], v[224:225] op_sel:[0,0,1] op_sel_hi:[1,0,1]
    v_pk_fma_f32 v[220:221], v[204:205], v[224:225], v[224:225] op_sel:[0,0,1] op_sel_hi:[1,0,1]
    v_cvt_pk_bf16_f32 v186, v214, v215
    v_cvt_pk_bf16_f32 v187, v216, v217
    v_cvt_pk_bf16_f32 v188, v218, v219
    v_cvt_pk_bf16_f32 v189, v220, v221
    ds_write_b128 v230, v[186:189] offset:448
    s_waitcnt lgkmcnt(0)
    s_barrier
    ds_read_b64_tr_b16 v[110:111], v231 offset:0
    ds_read_b64_tr_b16 v[112:113], v231 offset:3840
    ds_read_b64_tr_b16 v[114:115], v231 offset:128
    ds_read_b64_tr_b16 v[116:117], v231 offset:3968
    ds_read_b32 v229, v237
    s_waitcnt lgkmcnt(3)
    buffer_store_dwordx4 v[110:113], v233, s[28:31], s70 offen sc1
    s_waitcnt lgkmcnt(1)
    buffer_store_dwordx4 v[114:117], v233, s[28:31], s71 offen sc1
    v_cmp_gt_u32 vcc, 16, v1
    s_waitcnt lgkmcnt(0)
    s_nop 0
    v_cndmask_b32 v229, 0, v229, vcc
    buffer_store_dword v229, v238, s[28:31], s72 offen sc1
    s_add_u32 m0, s58, 16384
    s_add_u32 s0, s0, 458752
    s_cmp_eq_u32 s0, 3670016
    s_cselect_b32 s0, 0, s0
    buffer_load_dwordx4 v55, s[20:23], s0 offen lds
    buffer_load_dwordx4 v56, s[20:23], s0 offen offset:1024 lds
    buffer_load_dwordx4 v57, s[20:23], s0 offen offset:2048 lds
    buffer_load_dwordx4 v58, s[20:23], s0 offen offset:3072 lds
    s_branch L_anchor
.p2align 12
L_anchor:
    s_mov_b32 s18, 401408
    s_mov_b32 s19, 0x20000
    s_mov_b32 s26, 7340032
    s_mov_b32 s27, 0x20000
    s_mov_b32 s34, 1835008
    s_mov_b32 s35, 0x20000
    s_mov_b32 s36, 1
    v_lshrrev_b32 v14, 2, v1
    v_lshlrev_b32 v14, 7, v14
    v_lshl_add_u32 v14, v8, 3, v14
    v_and_b32 v15, 3, v5
    v_lshl_add_u32 v14, v15, 5, v14
    s_mul_i32 s3, s4, 8256
    v_xor_b32 v31, s3, v14
    v_xor_b32 v32, 32, v31
    v_xor_b32 v33, 64, v31
    v_xor_b32 v34, 96, v31
    v_add_u32 v35, 65536, v31
    v_add_u32 v36, 65536, v32
    v_add_u32 v37, 65536, v33
    v_add_u32 v38, 65536, v34
    v_add_u32 v39, 131072, v31
    v_add_u32 v40, 131072, v32
    v_add_u32 v41, 131072, v33
    v_add_u32 v42, 131072, v34
    s_lshl_b32 s6, s52, 1
    s_add_u32 s6, s6, s5
    s_lshl_b32 s3, s6, 1
    s_add_u32 s3, s3, s59
    s_lshl_b32 s3, s3, 4
    s_add_u32 s3, s3, s4
    s_lshl_b32 s3, s3, 12
    v_lshl_add_u32 v78, v3, 8, v4
    v_add_u32 v78, s3, v78
    s_xor_b32 s37, s51, 1
    s_lshl_b32 s37, s37, 3
    s_add_u32 s37, s37, s52
    s_lshl_b32 s3, s37, 14
    s_add_u32 s3, s3, s58
    s_add_u32 s3, s3, 16777216
    v_add_u32 v23, s3, v4
    s_lshl_b32 s37, s37, 5
    s_add_u32 s37, s37, s5
    s_lshl_b32 s37, s37, 2
    s_add_u32 s37, s37, 6422528
    s_mul_i32 s67, s6, 56
    s_lshl_b32 s3, s51, 1
    s_add_u32 s3, s3, s4
    s_add_u32 s67, s67, s3
    s_lshl_b32 s67, s67, 11
    s_add_u32 s67, s67, 2097152
    v_add_u32 v81, s58, v4
    s_lshl_b32 s68, s52, 2
    s_and_b32 s3, s51, 1
    s_add_u32 s68, s68, s3
    s_cmp_ge_u32 s51, 14
    s_cselect_b32 s3, 2, 0
    s_add_u32 s68, s68, s3
    s_lshl_b32 s68, s68, 7
    s_add_u32 s68, s68, 6356992
    s_waitcnt vmcnt(7)
    v_readfirstlane_b32 s57, v12
    s_mov_b32 s60, 0
    s_cmp_lg_u32 s57, 0
    s_cbranch_scc0 L_nonce
L_nonce_ok:
    s_waitcnt vmcnt(4)
    s_barrier
    s_atomic_swap s57, s[28:29], s74
    s_atomic_swap s57, s[28:29], s73
    buffer_load_dwordx4 v[96:99], v85, s[8:11], 0 offen
    buffer_load_ushort v93, v82, s[40:43], 0 offen offset:0
    buffer_load_dwordx4 v[100:103], v86, s[8:11], 0 offen
    buffer_load_ushort v94, v82, s[40:43], 0 offen offset:16
    v_add_u32 v53, 65536, v4
    s_add_u32 m0, s58, 32768
    s_add_u32 s0, s0, 458752
    s_cmp_eq_u32 s0, 3670016
    s_cselect_b32 s0, 0, s0
    buffer_load_dwordx4 v55, s[20:23], s0 offen lds
    v_add_u32 v54, 131072, v4
    s_mul_i32 s59, s48, 3072
    s_mul_i32 s3, s50, 86016
    s_add_u32 s3, s3, s59
    s_add_u32 s3, s3, 8388608
    v_add_u32 v80, s3, v4
    v_lshlrev_b32 v14, 7, v9
    v_xor_b32 v14, v14, v4
    s_lshl_b32 s3, s49, 11
    v_add_u32 v67, s3, v14
    v_add_u32 v68, 129024, v67
    s_lshr_b32 s3, s49, 2
    s_lshl_b32 s3, s3, 3
    s_max_u32 s3, s3, 1
    s_sub_u32 s3, s3, 1
    s_lshl_b32 s3, s3, 10
    s_lshl_b32 s6, s5, 17
    s_add_u32 s3, s3, s6
    s_lshl_b32 s6, s4, 28
    s_add_u32 s3, s3, s6
    v_add_u32 v69, s3, v14
    buffer_load_dwordx4 v56, s[20:23], s0 offen offset:1024 lds
    s_lshl_b32 s100, s5, 1
    s_add_u32 s100, s100, s4
    s_lshl_b32 s100, s100, 10
    v_and_b32 v14, 1, v1
    v_mul_u32_u24 v14, 640, v14
    v_lshrrev_b32 v15, 2, v1
    v_lshlrev_b32 v15, 4, v15
    v_xor_b32 v14, v14, v15
    v_bfe_u32 v15, v1, 1, 1
    v_lshl_add_u32 v14, v15, 3, v14
    buffer_load_dwordx4 v57, s[20:23], s0 offen offset:2048 lds
    s_add_u32 s3, s58, 12288
    v_add_u32 v70, s3, v14
    s_sub_u32 s3, s3, 3072
    s_cmp_eq_u32 s48, 0
    s_cselect_b32 s3, 28672, s3
    v_add_u32 v71, s3, v14
    v_add_u32 v72, 65536, v70
    v_add_u32 v73, 65536, v71
    v_add_u32 v74, 131072, v70
    v_add_u32 v75, 131072, v71
    s_lshl_b32 s3, s49, 1
    v_min_u32 v14, 2, v3
    v_add_u32 v14, s3, v14
    v_max_u32 v14, 1, v14
    v_lshlrev_b32 v14, 1, v14
    v_and_b32 v15, 1, v7
    buffer_load_dwordx4 v58, s[20:23], s0 offen offset:3072 lds
    v_add_lshl_u32 v14, v14, v15, 7
    v_lshrrev_b32 v15, 1, v7
    v_lshl_add_u32 v15, v15, 2, v8
    v_lshl_add_u32 v14, v15, 2, v14
    v_add_u32 v77, 6291200, v14
    s_min_u32 s15, s48, 2
    s_lshl_b32 s15, s15, 6
    s_add_u32 s15, s15, 64
    s_lshl_b32 s82, s49, 5
    s_add_u32 s82, s82, s50
    s_lshl_b32 s82, s82, 10
    s_add_u32 s82, s82, 4194304
    s_lshr_b32 s69, s49, 2
    s_lshl_b32 s69, s69, 1
    s_and_b32 s3, s50, 1
    s_add_u32 s69, s69, s3
    s_lshl_b32 s69, s69, 7
    s_add_u32 s69, s69, 6361088
    s_and_b32 s7, s53, 1
    s_mul_i32 s3, s7, 28
    s_add_u32 s3, s3, s48
    s_lshl_b32 s3, s3, 17
    s_xor_b32 s6, s53, 1
    s_lshl_b32 s55, s6, 3
    s_lshl_b32 s6, s53, 7
    s_add_u32 s3, s3, s6
    v_lshlrev_b32 v14, 12, v5
    s_add_u32 m0, s58, 49152
    s_add_u32 s0, s0, 458752
    s_cmp_eq_u32 s0, 3670016
    s_cselect_b32 s0, 0, s0
    buffer_load_dwordx4 v55, s[20:23], s0 offen lds
    v_add3_u32 v59, v14, v83, s3
    v_add_u32 v60, 31744, v59
    v_add_u32 v61, 63488, v59
    v_add_u32 v62, 95232, v59
    v_mul_u32_u24 v14, 896, v5
    s_mul_i32 s3, s4, 25088
    s_mul_i32 s6, s5, 14336
    s_add_u32 s3, s3, s6
    s_lshl_b32 s6, s54, 7
    s_add_u32 s3, s3, s6
    v_add3_u32 v63, v14, v83, s3
    buffer_load_dwordx4 v56, s[20:23], s0 offen offset:1024 lds
    v_add_u32 v64, 6144, v63
    s_lshl_b32 s6, s53, 1
    s_add_u32 s6, s6, s5
    s_and_b32 s3, s53, 30
    s_add_u32 s3, s3, s4
    s_lshl_b32 s3, s3, 7
    s_add_u32 s39, s3, 6361088
    s_lshl_b32 s3, s6, 5
    s_add_u32 s3, s3, s4
    s_lshl_b32 s3, s3, 10
    s_add_u32 s3, s3, 4194304
    v_add_u32 v65, s3, v4
    v_add_u32 v66, 15360, v65
    s_xor_b32 s3, s4, s5
    s_lshl_b32 s3, s3, 6
    v_xor_b32 v43, s3, v31
    buffer_load_dwordx4 v57, s[20:23], s0 offen offset:2048 lds
    v_xor_b32 v44, 32, v43
    v_add_u32 v45, 65536, v43
    v_add_u32 v46, 65536, v44
    s_mul_i32 s3, s4, 12288
    v_add_u32 v47, s3, v4
    v_xor_b32 v48, 4096, v47
    v_add_u32 v49, 65536, v47
    v_add_u32 v50, 65536, v48
    v_add_u32 v51, 131072, v47
    v_add_u32 v52, 131072, v48
    s_lshl_b32 s6, s54, 1
    s_add_u32 s6, s6, s5
    s_lshl_b32 s3, s6, 1
    s_add_u32 s3, s3, s7
    s_mul_i32 s3, s3, 14
    s_add_u32 s3, s3, s4
    s_lshl_b32 s3, s3, 12
    s_add_u32 s3, s3, 2097152
    v_add_u32 v79, s3, v4
    buffer_load_dwordx4 v58, s[20:23], s0 offen offset:3072 lds
    s_lshl_b32 s3, s54, 1
    s_add_u32 s3, s3, s7
    s_lshl_b32 s3, s3, 1
    s_add_u32 s3, s3, s4
    s_lshl_b32 s3, s3, 7
    s_add_u32 s38, s3, 6356992
    s_and_b32 s3, s2, 6
    s_add_u32 s3, s3, s54
    s_sub_u32 s6, s3, 7
    s_cmp_ge_u32 s3, 7
    s_cselect_b32 s3, s6, s3
    s_lshl_b32 s64, s3, 19
    s_lshl_b32 s65, s3, 13
    s_add_u32 s55, s55, s54
    s_lshl_b32 s3, s55, 14
    s_add_u32 s3, s3, s58
    s_add_u32 s3, s3, 12582912
    v_add_u32 v21, s3, v4
    s_add_u32 m0, s58, 65536
    s_add_u32 s0, s0, 458752
    s_cmp_eq_u32 s0, 3670016
    s_cselect_b32 s0, 0, s0
    buffer_load_dwordx4 v55, s[20:23], s0 offen lds
    s_lshl_b32 s55, s55, 5
    s_add_u32 s55, s55, s48
    s_lshl_b32 s55, s55, 2
    s_add_u32 s55, s55, 6488064
    s_lshl_b32 s3, s5, 3
    v_add_u32 v13, s3, v3
    v_xor_b32 v13, v13, v6
    v_lshlrev_b32 v13, 4, v13
    v_lshl_add_u32 v13, v2, 8, v13
    buffer_load_dwordx4 v56, s[20:23], s0 offen offset:1024 lds
    s_lshl_b32 s3, s4, 14
    s_add_u32 s3, s3, 32768
    v_add_u32 v87, s3, v13
    v_xor_b32 v88, 64, v87
    s_lshr_b32 s3, s53, 1
    s_add_u32 s66, s3, s54
    s_mov_b32 s51, s66
    v_lshlrev_b32 v13, 1, v6
    v_xor_b32 v13, v13, v5
    v_lshlrev_b32 v13, 4, v13
    v_lshl_add_u32 v13, v5, 8, v13
    s_add_u32 s3, s58, 32768
    v_add_u32 v89, s3, v13
    v_xor_b32 v90, 16, v89
    v_xor_b32 v91, 24576, v89
    v_xor_b32 v92, 24592, v89
    buffer_load_dwordx4 v57, s[20:23], s0 offen offset:2048 lds
    v_lshlrev_b32 v150, 16, v246
    v_and_b32 v151, 0xffff0000, v246
    v_lshlrev_b32 v152, 16, v247
    v_and_b32 v153, 0xffff0000, v247
    v_lshlrev_b32 v154, 16, v248
    v_and_b32 v155, 0xffff0000, v248
    v_lshlrev_b32 v156, 16, v249
    v_and_b32 v157, 0xffff0000, v249
    v_lshlrev_b32 v158, 16, v246
    v_and_b32 v159, 0xffff0000, v246
    v_lshlrev_b32 v160, 16, v247
    v_and_b32 v161, 0xffff0000, v247
    v_lshlrev_b32 v162, 16, v248
    v_and_b32 v163, 0xffff0000, v248
    v_lshlrev_b32 v164, 16, v249
    v_and_b32 v165, 0xffff0000, v249
    buffer_load_dwordx4 v58, s[20:23], s0 offen offset:3072 lds
    s_add_u32 m0, s58, 81920
    s_add_u32 s0, s0, 458752
    s_cmp_eq_u32 s0, 3670016
    s_cselect_b32 s0, 0, s0
    buffer_load_dwordx4 v55, s[20:23], s0 offen lds
    buffer_load_dwordx4 v56, s[20:23], s0 offen offset:1024 lds
    buffer_load_dwordx4 v57, s[20:23], s0 offen offset:2048 lds
    buffer_load_dwordx4 v58, s[20:23], s0 offen offset:3072 lds
    s_add_u32 m0, s58, 98304
    s_add_u32 s0, s0, 458752
    s_cmp_eq_u32 s0, 3670016
    s_cselect_b32 s0, 0, s0
    buffer_load_dwordx4 v55, s[20:23], s0 offen lds
    buffer_load_dwordx4 v56, s[20:23], s0 offen offset:1024 lds
    buffer_load_dwordx4 v57, s[20:23], s0 offen offset:2048 lds
    buffer_load_dwordx4 v58, s[20:23], s0 offen offset:3072 lds
    buffer_load_dword v18, v20, s[28:31], 0 offen sc1
    s_add_u32 m0, s58, 114688
    s_add_u32 s0, s0, 458752
    s_cmp_eq_u32 s0, 3670016
    s_cselect_b32 s0, 0, s0
    buffer_load_dwordx4 v55, s[20:23], s0 offen lds
    buffer_load_dwordx4 v56, s[20:23], s0 offen offset:1024 lds
    buffer_load_dwordx4 v57, s[20:23], s0 offen offset:2048 lds
    buffer_load_dwordx4 v58, s[20:23], s0 offen offset:3072 lds
    s_mov_b32 s3, s48
    s_mov_b64 exec, 0
L_warm:
    s_add_u32 s3, s3, 4
    s_cmp_eq_u32 s3, 4
    s_cbranch_scc1 L_pad0
    s_cmp_eq_u32 s3, 5
    s_cbranch_scc1 L_pad1
    s_cmp_eq_u32 s3, 6
    s_cbranch_scc1 L_pad2
    s_cmp_eq_u32 s3, 7
    s_cbranch_scc1 L_pad3
    s_cmp_eq_u32 s3, 8
    s_cbranch_scc1 L_pad4
    s_mov_b64 exec, -1
    s_waitcnt vmcnt(4)
    v_cmp_ne_u32 vcc, s57, v18
    s_cbranch_vccnz L_pollin0
L_pollok0:
    s_barrier
    buffer_load_dwordx4 a[0:3], v78, s[28:31], s1 offen offset:0 sc1
    buffer_load_dwordx4 a[4:7], v78, s[28:31], s1 offen offset:256 sc1
    buffer_load_dwordx4 a[8:11], v78, s[28:31], s1 offen offset:2048 sc1
    buffer_load_dwordx4 a[12:15], v78, s[28:31], s1 offen offset:2304 sc1
    buffer_load_dword v76, v77, s[28:31], 0 offen sc1
    s_add_u32 s1, s1, 8192
    s_and_b32 s1, s1, 0xffff
    buffer_load_dwordx4 a[16:19], v78, s[28:31], s1 offen offset:0 sc1
    buffer_load_dwordx4 a[20:23], v78, s[28:31], s1 offen offset:256 sc1
    buffer_load_dwordx4 a[24:27], v78, s[28:31], s1 offen offset:2048 sc1
    buffer_load_dwordx4 a[28:31], v78, s[28:31], s1 offen offset:2304 sc1
    s_add_u32 s1, s1, 8192
    s_and_b32 s1, s1, 0xffff
    buffer_load_dwordx4 a[32:35], v78, s[28:31], s1 offen offset:0 sc1
    buffer_load_dwordx4 a[36:39], v78, s[28:31], s1 offen offset:256 sc1
    buffer_load_dwordx4 a[40:43], v78, s[28:31], s1 offen offset:2048 sc1
    buffer_load_dwordx4 a[44:47], v78, s[28:31], s1 offen offset:2304 sc1
    ds_read_b64_tr_b16 a[200:201], v31 offset:0
    ds_read_b64_tr_b16 a[202:203], v31 offset:2048
    ds_read_b64_tr_b16 a[204:205], v33 offset:0
    ds_read_b64_tr_b16 a[206:207], v33 offset:2048
    ds_read_b64_tr_b16 a[208:209], v32 offset:0
    ds_read_b64_tr_b16 a[210:211], v32 offset:2048
    ds_read_b64_tr_b16 a[212:213], v34 offset:0
    ds_read_b64_tr_b16 a[214:215], v34 offset:2048
    ds_read_b64_tr_b16 a[216:217], v31 offset:4096
    ds_read_b64_tr_b16 a[218:219], v31 offset:6144
    ds_read_b64_tr_b16 a[220:221], v33 offset:4096
    ds_read_b64_tr_b16 a[222:223], v33 offset:6144
    s_waitcnt vmcnt(11) lgkmcnt(8)
    v_mfma_f32_16x16x32_bf16 v[182:185], a[200:203], a[0:3], 0
    ds_read_b64_tr_b16 a[224:225], v32 offset:4096
    s_add_u32 s1, s1, 8192
    v_mfma_f32_16x16x32_bf16 v[190:193], a[200:203], a[4:7], 0
    ds_read_b64_tr_b16 a[226:227], v32 offset:6144
    s_and_b32 s1, s1, 0xffff
    s_mov_b32 s70, 0xaaaaaaaa
    s_mov_b32 s71, 0xaaaaaaaa
    s_mov_b32 s72, 0xfff0ffff
    s_mov_b32 s73, 0xf000ff00
    s_mov_b32 s74, 0xffc0fffc
    v_mfma_f32_16x16x32_bf16 v[198:201], a[204:207], a[0:3], 0
    ds_read_b64_tr_b16 a[228:229], v34 offset:4096
    buffer_load_dwordx4 a[48:51], v78, s[28:31], s1 offen offset:0 sc1
    v_mfma_f32_16x16x32_bf16 v[206:209], a[204:207], a[4:7], 0
    ds_read_b64_tr_b16 a[230:231], v34 offset:6144
    s_mov_b32 s75, 0xc000fc00
    s_waitcnt lgkmcnt(8)
    v_mfma_f32_16x16x32_bf16 v[186:189], a[208:211], a[0:3], 0
    ds_read_b64_tr_b16 a[200:201], v31 offset:16384
    s_mov_b32 s83, 0x3e8b97f6
    v_mfma_f32_16x16x32_bf16 v[194:197], a[208:211], a[4:7], 0
    ds_read_b64_tr_b16 a[202:203], v31 offset:18432
    buffer_load_dwordx4 a[52:55], v78, s[28:31], s1 offen offset:256 sc1
    v_lshlrev_b32 v13, 2, v2
    v_mfma_f32_16x16x32_bf16 v[202:205], a[212:215], a[0:3], 0
    ds_read_b64_tr_b16 a[204:205], v33 offset:16384
    v_and_b32 v14, 1, v1
    v_mfma_f32_16x16x32_bf16 v[210:213], a[212:215], a[4:7], 0
    ds_read_b64_tr_b16 a[206:207], v33 offset:18432
    s_waitcnt vmcnt(11) lgkmcnt(8)
    v_mfma_f32_16x16x32_bf16 v[182:185], a[216:219], a[8:11], v[182:185]
    ds_read_b64_tr_b16 a[208:209], v32 offset:16384
    buffer_load_dwordx4 a[56:59], v78, s[28:31], s1 offen offset:2048 sc1
    v_mfma_f32_16x16x32_bf16 v[190:193], a[216:219], a[12:15], v[190:193]
    ds_read_b64_tr_b16 a[210:211], v32 offset:18432
    v_lshl_add_u32 v14, v3, 2, v14
    v_mfma_f32_16x16x32_bf16 v[198:201], a[220:223], a[8:11], v[198:201]
    ds_read_b64_tr_b16 a[212:213], v34 offset:16384
    v_lshlrev_b32 v14, 2, v14
    v_mfma_f32_16x16x32_bf16 v[206:209], a[220:223], a[12:15], v[206:209]
    ds_read_b64_tr_b16 a[214:215], v34 offset:18432
    s_waitcnt lgkmcnt(8)
    v_mfma_f32_16x16x32_bf16 v[186:189], a[224:227], a[8:11], v[186:189]
    ds_read_b64_tr_b16 a[216:217], v31 offset:20480
    buffer_load_dwordx4 a[60:63], v78, s[28:31], s1 offen offset:2304 sc1
    v_mfma_f32_16x16x32_bf16 v[194:197], a[224:227], a[12:15], v[194:197]
    ds_read_b64_tr_b16 a[218:219], v31 offset:22528
    s_add_u32 s1, s1, 8192
    v_add_u32 v15, 64, v14
    v_mfma_f32_16x16x32_bf16 v[202:205], a[228:231], a[8:11], v[202:205]
    ds_read_b64_tr_b16 a[220:221], v33 offset:20480
    s_and_b32 s1, s1, 0xffff
    v_mfma_f32_16x16x32_bf16 v[210:213], a[228:231], a[12:15], v[210:213]
    ds_read_b64_tr_b16 a[222:223], v33 offset:22528
    s_waitcnt vmcnt(10) lgkmcnt(8)
    v_mfma_f32_16x16x32_bf16 v[182:185], a[200:203], a[16:19], v[182:185]
    ds_read_b64_tr_b16 a[224:225], v32 offset:20480
    buffer_load_dwordx4 a[64:67], v78, s[28:31], s1 offen offset:0 sc1
    v_mfma_f32_16x16x32_bf16 v[190:193], a[200:203], a[20:23], v[190:193]
    ds_read_b64_tr_b16 a[226:227], v32 offset:22528
    v_cndmask_b32 v16, v14, v15, s[72:73]
    v_mfma_f32_16x16x32_bf16 v[198:201], a[204:207], a[16:19], v[198:201]
    ds_read_b64_tr_b16 a[228:229], v34 offset:20480
    buffer_load_dwordx4 a[68:71], v78, s[28:31], s1 offen offset:256 sc1
    v_mfma_f32_16x16x32_bf16 v[206:209], a[204:207], a[20:23], v[206:209]
    ds_read_b64_tr_b16 a[230:231], v34 offset:22528
    v_cndmask_b32 v14, v14, v15, s[74:75]
    s_waitcnt lgkmcnt(8)
    v_mfma_f32_16x16x32_bf16 v[186:189], a[208:211], a[16:19], v[186:189]
    ds_read_b64_tr_b16 a[200:201], v31 offset:32768
    ds_bpermute_b32 v25, v13, v76 offset:64
    v_mfma_f32_16x16x32_bf16 v[194:197], a[208:211], a[20:23], v[194:197]
    ds_read_b64_tr_b16 a[202:203], v31 offset:34816
    buffer_load_dwordx4 a[72:75], v78, s[28:31], s1 offen offset:2048 sc1
    ds_bpermute_b32 v27, v16, v76 offset:0
    v_mfma_f32_16x16x32_bf16 v[202:205], a[212:215], a[16:19], v[202:205]
    ds_read_b64_tr_b16 a[204:205], v33 offset:32768
    ds_bpermute_b32 v28, v14, v76 offset:8
    v_mfma_f32_16x16x32_bf16 v[210:213], a[212:215], a[20:23], v[210:213]
    ds_read_b64_tr_b16 a[206:207], v33 offset:34816
    s_waitcnt vmcnt(11) lgkmcnt(11)
    v_mfma_f32_16x16x32_bf16 v[182:185], a[216:219], a[24:27], v[182:185]
    ds_read_b64_tr_b16 a[208:209], v32 offset:32768
    ds_bpermute_b32 v26, v13, v76 offset:128
    v_mfma_f32_16x16x32_bf16 v[190:193], a[216:219], a[28:31], v[190:193]
    ds_read_b64_tr_b16 a[210:211], v32 offset:34816
    buffer_load_dwordx4 a[76:79], v78, s[28:31], s1 offen offset:2304 sc1
    ds_bpermute_b32 v29, v16, v76 offset:64
    v_mfma_f32_16x16x32_bf16 v[198:201], a[220:223], a[24:27], v[198:201]
    ds_read_b64_tr_b16 a[212:213], v34 offset:32768
    s_add_u32 s1, s1, 8192
    v_mfma_f32_16x16x32_bf16 v[206:209], a[220:223], a[28:31], v[206:209]
    ds_read_b64_tr_b16 a[214:215], v34 offset:34816
    s_waitcnt lgkmcnt(13)
    v_mfma_f32_16x16x32_bf16 v[186:189], a[224:227], a[24:27], v[186:189]
    ds_read_b64_tr_b16 a[216:217], v31 offset:36864
    s_and_b32 s1, s1, 0xffff
    v_mfma_f32_16x16x32_bf16 v[194:197], a[224:227], a[28:31], v[194:197]
    ds_read_b64_tr_b16 a[218:219], v31 offset:38912
    buffer_load_dwordx4 a[80:83], v78, s[28:31], s1 offen offset:0 sc1
    ds_bpermute_b32 v30, v14, v76 offset:72
    v_mfma_f32_16x16x32_bf16 v[202:205], a[228:231], a[24:27], v[202:205]
    ds_read_b64_tr_b16 a[220:221], v33 offset:36864
    v_mfma_f32_16x16x32_bf16 v[210:213], a[228:231], a[28:31], v[210:213]
    ds_read_b64_tr_b16 a[222:223], v33 offset:38912
    s_waitcnt vmcnt(11) lgkmcnt(11)
    v_mfma_f32_16x16x32_bf16 v[182:185], a[200:203], a[32:35], v[182:185]
    ds_read_b64_tr_b16 a[224:225], v32 offset:36864
    buffer_load_dwordx4 a[84:87], v78, s[28:31], s1 offen offset:256 sc1
    v_mfma_f32_16x16x32_bf16 v[190:193], a[200:203], a[36:39], v[190:193]
    ds_read_b64_tr_b16 a[226:227], v32 offset:38912
    v_mfma_f32_16x16x32_bf16 v[198:201], a[204:207], a[32:35], v[198:201]
    ds_read_b64_tr_b16 a[228:229], v34 offset:36864
    v_mfma_f32_16x16x32_bf16 v[206:209], a[204:207], a[36:39], v[206:209]
    ds_read_b64_tr_b16 a[230:231], v34 offset:38912
    s_waitcnt lgkmcnt(9)
    v_mfma_f32_16x16x32_bf16 v[186:189], a[208:211], a[32:35], v[186:189]
    s_barrier
    ds_read_b64_tr_b16 a[200:201], v31 offset:49152
    buffer_load_dwordx4 a[88:91], v78, s[28:31], s1 offen offset:2048 sc1
    v_mfma_f32_16x16x32_bf16 v[194:197], a[208:211], a[36:39], v[194:197]
    ds_read_b64_tr_b16 a[202:203], v31 offset:51200
    v_mfma_f32_16x16x32_bf16 v[202:205], a[212:215], a[32:35], v[202:205]
    ds_read_b64_tr_b16 a[204:205], v33 offset:49152
    buffer_load_dwordx4 a[92:95], v78, s[28:31], s1 offen offset:2304 sc1
    v_mfma_f32_16x16x32_bf16 v[210:213], a[212:215], a[36:39], v[210:213]
    ds_read_b64_tr_b16 a[206:207], v33 offset:51200
    s_waitcnt vmcnt(12) lgkmcnt(8)
    v_mfma_f32_16x16x32_bf16 v[182:185], a[216:219], a[40:43], v[182:185]
    ds_read_b64_tr_b16 a[208:209], v32 offset:49152
    s_add_u32 m0, s58, 131072
    v_mfma_f32_16x16x32_bf16 v[190:193], a[216:219], a[44:47], v[190:193]
    ds_read_b64_tr_b16 a[210:211], v32 offset:51200
    s_add_u32 s0, s0, 458752
    v_mul_f32 v25, s83, v25
    v_mfma_f32_16x16x32_bf16 v[198:201], a[220:223], a[40:43], v[198:201]
    ds_read_b64_tr_b16 a[212:213], v34 offset:49152
    s_cmp_eq_u32 s0, 3670016
    v_mfma_f32_16x16x32_bf16 v[206:209], a[220:223], a[44:47], v[206:209]
    ds_read_b64_tr_b16 a[214:215], v34 offset:51200
    s_cselect_b32 s0, 0, s0
    v_xor_b32 v55, 128, v55
    buffer_load_dwordx4 v55, s[20:23], s0 offen lds
    s_waitcnt lgkmcnt(8)
    v_mfma_f32_16x16x32_bf16 v[186:189], a[224:227], a[40:43], v[186:189]
    ds_read_b64_tr_b16 a[216:217], v31 offset:53248
    v_xor_b32 v56, 128, v56
    v_mfma_f32_16x16x32_bf16 v[194:197], a[224:227], a[44:47], v[194:197]
    ds_read_b64_tr_b16 a[218:219], v31 offset:55296
    buffer_load_dwordx4 v56, s[20:23], s0 offen offset:1024 lds
    v_mul_f32 v26, s83, v26
    v_mfma_f32_16x16x32_bf16 v[202:205], a[228:231], a[40:43], v[202:205]
    ds_read_b64_tr_b16 a[220:221], v33 offset:53248
    v_xor_b32 v57, 128, v57
    v_mfma_f32_16x16x32_bf16 v[210:213], a[228:231], a[44:47], v[210:213]
    ds_read_b64_tr_b16 a[222:223], v33 offset:55296
    s_waitcnt vmcnt(12) lgkmcnt(8)
    v_mfma_f32_16x16x32_bf16 v[182:185], a[200:203], a[48:51], v[182:185]
    ds_read_b64_tr_b16 a[224:225], v32 offset:53248
    buffer_load_dwordx4 v57, s[20:23], s0 offen offset:2048 lds
    v_mfma_f32_16x16x32_bf16 v[190:193], a[200:203], a[52:55], v[190:193]
    ds_read_b64_tr_b16 a[226:227], v32 offset:55296
    v_xor_b32 v58, 128, v58
    s_cmp_eq_u32 s49, 0
    s_cselect_b64 s[76:77], 0, -1
    v_mfma_f32_16x16x32_bf16 v[198:201], a[204:207], a[48:51], v[198:201]
    ds_read_b64_tr_b16 a[228:229], v34 offset:53248
    v_mov_b32 v13, 0xffff
    v_mfma_f32_16x16x32_bf16 v[206:209], a[204:207], a[52:55], v[206:209]
    ds_read_b64_tr_b16 a[230:231], v34 offset:55296
    s_waitcnt lgkmcnt(8)
    v_mfma_f32_16x16x32_bf16 v[186:189], a[208:211], a[48:51], v[186:189]
    ds_read_b64_tr_b16 a[200:201], v35 offset:0
    buffer_load_dwordx4 v58, s[20:23], s0 offen offset:3072 lds
    v_mfma_f32_16x16x32_bf16 v[194:197], a[208:211], a[52:55], v[194:197]
    ds_read_b64_tr_b16 a[202:203], v35 offset:2048
    s_add_u32 s1, s1, 8192
    v_mov_b32 v14, 0xffff0000
    v_mfma_f32_16x16x32_bf16 v[202:205], a[212:215], a[48:51], v[202:205]
    ds_read_b64_tr_b16 a[204:205], v37 offset:0
    s_and_b32 s1, s1, 0xffff
    v_mfma_f32_16x16x32_bf16 v[210:213], a[212:215], a[52:55], v[210:213]
    ds_read_b64_tr_b16 a[206:207], v37 offset:2048
    v_cndmask_b32 v13, v13, v14, s[70:71]
    s_waitcnt vmcnt(12) lgkmcnt(8)
    v_mfma_f32_16x16x32_bf16 v[182:185], a[216:219], a[56:59], v[182:185]
    ds_read_b64_tr_b16 a[208:209], v36 offset:0
    buffer_load_dwordx4 a[96:99], v78, s[28:31], s1 offen offset:0 sc1
    v_mfma_f32_16x16x32_bf16 v[190:193], a[216:219], a[60:63], v[190:193]
    ds_read_b64_tr_b16 a[210:211], v36 offset:2048
    v_cndmask_b32 v104, v13, 0, s[72:73]
    v_mfma_f32_16x16x32_bf16 v[198:201], a[220:223], a[56:59], v[198:201]
    ds_read_b64_tr_b16 a[212:213], v38 offset:0
    buffer_load_dwordx4 a[100:103], v78, s[28:31], s1 offen offset:256 sc1
    v_mfma_f32_16x16x32_bf16 v[206:209], a[220:223], a[60:63], v[206:209]
    ds_read_b64_tr_b16 a[214:215], v38 offset:2048
    v_cndmask_b32 v106, 0, v13, s[72:73]
    s_waitcnt lgkmcnt(8)
    v_mfma_f32_16x16x32_bf16 v[186:189], a[224:227], a[56:59], v[186:189]
    ds_read_b64_tr_b16 a[216:217], v35 offset:4096
    v_cndmask_b32 v105, v13, 0, s[74:75]
    v_mfma_f32_16x16x32_bf16 v[194:197], a[224:227], a[60:63], v[194:197]
    ds_read_b64_tr_b16 a[218:219], v35 offset:6144
    buffer_load_dwordx4 a[104:107], v78, s[28:31], s1 offen offset:2048 sc1
    v_cndmask_b32 v107, 0, v13, s[74:75]
    v_mfma_f32_16x16x32_bf16 v[202:205], a[228:231], a[56:59], v[202:205]
    ds_read_b64_tr_b16 a[220:221], v37 offset:4096
    v_mov_b32 v84, 0xf149f2ca
    v_mfma_f32_16x16x32_bf16 v[210:213], a[228:231], a[60:63], v[210:213]
    ds_read_b64_tr_b16 a[222:223], v37 offset:6144
    s_waitcnt vmcnt(13) lgkmcnt(8)
    v_mfma_f32_16x16x32_bf16 v[182:185], a[200:203], a[64:67], v[182:185]
    ds_read_b64_tr_b16 a[224:225], v36 offset:4096
    buffer_load_dwordx4 a[108:111], v78, s[28:31], s1 offen offset:2304 sc1
    v_mfma_f32_16x16x32_bf16 v[190:193], a[200:203], a[68:71], v[190:193]
    ds_read_b64_tr_b16 a[226:227], v36 offset:6144
    s_add_u32 m0, s58, 147456
    s_mov_b32 s83, 0x3e8b97f6
    v_mfma_f32_16x16x32_bf16 v[198:201], a[204:207], a[64:67], v[198:201]
    ds_read_b64_tr_b16 a[228:229], v38 offset:4096
    s_add_u32 s0, s0, 458752
    v_mfma_f32_16x16x32_bf16 v[206:209], a[204:207], a[68:71], v[206:209]
    ds_read_b64_tr_b16 a[230:231], v38 offset:6144
    s_mov_b32 s78, 0xbdd2d3e8
    s_mov_b32 s79, 0xbdd2d3e8
    s_waitcnt lgkmcnt(8)
    v_mfma_f32_16x16x32_bf16 v[186:189], a[208:211], a[64:67], v[186:189]
    s_barrier
    s_load_dword s14, s[44:45], s15
    ds_read_b64_tr_b16 a[200:201], v35 offset:16384
    s_cmp_eq_u32 s0, 3670016
    s_cselect_b32 s0, 0, s0
    buffer_load_dwordx4 v55, s[20:23], s0 offen lds
    v_mfma_f32_16x16x32_bf16 v[194:197], a[208:211], a[68:71], v[194:197]
    ds_read_b64_tr_b16 a[202:203], v35 offset:18432
    s_mov_b32 s80, 1.0
    v_mfma_f32_16x16x32_bf16 v[202:205], a[212:215], a[64:67], v[202:205]
    ds_read_b64_tr_b16 a[204:205], v37 offset:16384
    buffer_load_dwordx4 v56, s[20:23], s0 offen offset:1024 lds
    v_mfma_f32_16x16x32_bf16 v[210:213], a[212:215], a[68:71], v[210:213]
    ds_read_b64_tr_b16 a[206:207], v37 offset:18432
    s_mov_b32 s81, 1.0
    s_waitcnt vmcnt(14) lgkmcnt(8)
    v_mfma_f32_16x16x32_bf16 v[182:185], a[216:219], a[72:75], v[182:185]
    ds_read_b64_tr_b16 a[208:209], v36 offset:16384
    v_mov_b32 v108, 0xc0135761
    v_mfma_f32_16x16x32_bf16 v[190:193], a[216:219], a[76:79], v[190:193]
    ds_read_b64_tr_b16 a[210:211], v36 offset:18432
    buffer_load_dwordx4 v57, s[20:23], s0 offen offset:2048 lds
    v_mov_b32 v109, 0xc0135761
    v_mfma_f32_16x16x32_bf16 v[198:201], a[220:223], a[72:75], v[198:201]
    ds_read_b64_tr_b16 a[212:213], v38 offset:16384
    v_lshrrev_b32 v13, 1, v2
    v_mfma_f32_16x16x32_bf16 v[206:209], a[220:223], a[76:79], v[206:209]
    ds_read_b64_tr_b16 a[214:215], v38 offset:18432
    s_waitcnt lgkmcnt(8)
    v_mfma_f32_16x16x32_bf16 v[186:189], a[224:227], a[72:75], v[186:189]
    ds_read_b64_tr_b16 a[216:217], v35 offset:20480
    buffer_load_dwordx4 v58, s[20:23], s0 offen offset:3072 lds
    v_mfma_f32_16x16x32_bf16 v[194:197], a[224:227], a[76:79], v[194:197]
    ds_read_b64_tr_b16 a[218:219], v35 offset:22528
    s_add_u32 s1, s1, 8192
    v_lshlrev_b32 v14, 1, v3
    v_mfma_f32_16x16x32_bf16 v[202:205], a[228:231], a[72:75], v[202:205]
    ds_read_b64_tr_b16 a[220:221], v37 offset:20480
    s_and_b32 s1, s1, 0xffff
    v_mfma_f32_16x16x32_bf16 v[210:213], a[228:231], a[76:79], v[210:213]
    ds_read_b64_tr_b16 a[222:223], v37 offset:22528
    s_waitcnt vmcnt(14) lgkmcnt(8)
    v_mfma_f32_16x16x32_bf16 v[182:185], a[200:203], a[80:83], v[182:185]
    ds_read_b64_tr_b16 a[224:225], v36 offset:20480
    buffer_load_dwordx4 a[112:115], v78, s[28:31], s1 offen offset:0 sc1
    v_mfma_f32_16x16x32_bf16 v[190:193], a[200:203], a[84:87], v[190:193]
    ds_read_b64_tr_b16 a[226:227], v36 offset:22528
L_pad0:
    s_cbranch_execz L_warm
    v_sub_u32 v13, v13, v14
    v_mfma_f32_16x16x32_bf16 v[198:201], a[204:207], a[80:83], v[198:201]
    ds_read_b64_tr_b16 a[228:229], v38 offset:20480
    buffer_load_dwordx4 a[116:119], v78, s[28:31], s1 offen offset:256 sc1
    v_mfma_f32_16x16x32_bf16 v[206:209], a[204:207], a[84:87], v[206:209]
    ds_read_b64_tr_b16 a[230:231], v38 offset:22528
    v_mov_b32 v14, 0x3f80
    s_waitcnt lgkmcnt(8)
    v_mfma_f32_16x16x32_bf16 v[186:189], a[208:211], a[80:83], v[186:189]
    ds_read_b64_tr_b16 a[200:201], v35 offset:32768
    v_cndmask_b32 v14, v14, 1.0, s[70:71]
    v_mfma_f32_16x16x32_bf16 v[194:197], a[208:211], a[84:87], v[194:197]
    ds_read_b64_tr_b16 a[202:203], v35 offset:34816
    buffer_load_dwordx4 a[120:123], v78, s[28:31], s1 offen offset:2048 sc1
    v_cmp_eq_i32 vcc, 0, v13
    v_mfma_f32_16x16x32_bf16 v[202:205], a[212:215], a[80:83], v[202:205]
    ds_read_b64_tr_b16 a[204:205], v37 offset:32768
    v_accvgpr_write_b32 a248, 0
    v_mfma_f32_16x16x32_bf16 v[210:213], a[212:215], a[84:87], v[210:213]
    ds_read_b64_tr_b16 a[206:207], v37 offset:34816
    s_waitcnt vmcnt(15) lgkmcnt(8)
    v_mfma_f32_16x16x32_bf16 v[182:185], a[216:219], a[88:91], v[182:185]
    ds_read_b64_tr_b16 a[208:209], v36 offset:32768
    buffer_load_dwordx4 a[124:127], v78, s[28:31], s1 offen offset:2304 sc1
    v_mfma_f32_16x16x32_bf16 v[190:193], a[216:219], a[92:95], v[190:193]
    ds_read_b64_tr_b16 a[210:211], v36 offset:34816
    s_add_u32 m0, s58, 0
    v_accvgpr_write_b32 a252, 0
    v_mfma_f32_16x16x32_bf16 v[198:201], a[220:223], a[88:91], v[198:201]
    ds_read_b64_tr_b16 a[212:213], v38 offset:32768
    s_add_u32 s0, s0, 458752
    v_mfma_f32_16x16x32_bf16 v[206:209], a[220:223], a[92:95], v[206:209]
    ds_read_b64_tr_b16 a[214:215], v38 offset:34816
    s_waitcnt lgkmcnt(8)
    v_mfma_f32_16x16x32_bf16 v[186:189], a[224:227], a[88:91], v[186:189]
    ds_read_b64_tr_b16 a[216:217], v35 offset:36864
    s_cmp_eq_u32 s0, 3670016
    v_mfma_f32_16x16x32_bf16 v[194:197], a[224:227], a[92:95], v[194:197]
    ds_read_b64_tr_b16 a[218:219], v35 offset:38912
    s_cselect_b32 s0, 0, s0
    buffer_load_dwordx4 v55, s[20:23], s0 offen lds
    v_cndmask_b32 v15, 0, v14, vcc
    v_mfma_f32_16x16x32_bf16 v[202:205], a[228:231], a[88:91], v[202:205]
    ds_read_b64_tr_b16 a[220:221], v37 offset:36864
    v_accvgpr_write_b32 a250, v15
    v_mfma_f32_16x16x32_bf16 v[210:213], a[228:231], a[92:95], v[210:213]
    ds_read_b64_tr_b16 a[222:223], v37 offset:38912
    s_waitcnt vmcnt(11) lgkmcnt(8)
    v_mfma_f32_16x16x32_bf16 v[182:185], a[200:203], a[96:99], v[182:185]
    ds_read_b64_tr_b16 a[224:225], v36 offset:36864
    buffer_load_dwordx4 v56, s[20:23], s0 offen offset:1024 lds
    v_mfma_f32_16x16x32_bf16 v[190:193], a[200:203], a[100:103], v[190:193]
    ds_read_b64_tr_b16 a[226:227], v36 offset:38912
    v_cmp_eq_i32 vcc, 1, v13
    v_mfma_f32_16x16x32_bf16 v[198:201], a[204:207], a[96:99], v[198:201]
    ds_read_b64_tr_b16 a[228:229], v38 offset:36864
    buffer_load_dwordx4 v57, s[20:23], s0 offen offset:2048 lds
    v_mfma_f32_16x16x32_bf16 v[206:209], a[204:207], a[100:103], v[206:209]
    ds_read_b64_tr_b16 a[230:231], v38 offset:38912
    v_accvgpr_write_b32 a249, 0
    s_waitcnt lgkmcnt(8)
    v_mfma_f32_16x16x32_bf16 v[186:189], a[208:211], a[96:99], v[186:189]
    s_waitcnt vmcnt(7)
    s_barrier
    ds_read_b64_tr_b16 a[200:201], v35 offset:49152
    buffer_load_dwordx4 v58, s[20:23], s0 offen offset:3072 lds
    v_mfma_f32_16x16x32_bf16 v[194:197], a[208:211], a[100:103], v[194:197]
    ds_read_b64_tr_b16 a[202:203], v35 offset:51200
    s_add_u32 m0, s58, 16384
    v_accvgpr_write_b32 a253, 0
    v_mfma_f32_16x16x32_bf16 v[202:205], a[212:215], a[96:99], v[202:205]
    ds_read_b64_tr_b16 a[204:205], v37 offset:49152
    s_add_u32 s0, s0, 458752
    v_mfma_f32_16x16x32_bf16 v[210:213], a[212:215], a[100:103], v[210:213]
    ds_read_b64_tr_b16 a[206:207], v37 offset:51200
    s_waitcnt lgkmcnt(8)
    v_mfma_f32_16x16x32_bf16 v[182:185], a[216:219], a[104:107], v[182:185]
    ds_read_b64_tr_b16 a[208:209], v36 offset:49152
    s_cmp_eq_u32 s0, 3670016
    v_mfma_f32_16x16x32_bf16 v[190:193], a[216:219], a[108:111], v[190:193]
    ds_read_b64_tr_b16 a[210:211], v36 offset:51200
    s_cselect_b32 s0, 0, s0
    buffer_load_dwordx4 v55, s[20:23], s0 offen lds
    v_cndmask_b32 v15, 0, v14, vcc
    v_mfma_f32_16x16x32_bf16 v[198:201], a[220:223], a[104:107], v[198:201]
    ds_read_b64_tr_b16 a[212:213], v38 offset:49152
    v_accvgpr_write_b32 a251, v15
    v_mfma_f32_16x16x32_bf16 v[206:209], a[220:223], a[108:111], v[206:209]
    ds_read_b64_tr_b16 a[214:215], v38 offset:51200
    s_waitcnt lgkmcnt(8)
    v_mfma_f32_16x16x32_bf16 v[186:189], a[224:227], a[104:107], v[186:189]
    ds_read_b64_tr_b16 a[216:217], v35 offset:53248
    buffer_load_dwordx4 v56, s[20:23], s0 offen offset:1024 lds
    v_mfma_f32_16x16x32_bf16 v[194:197], a[224:227], a[108:111], v[194:197]
    ds_read_b64_tr_b16 a[218:219], v35 offset:55296
    v_mfma_f32_16x16x32_bf16 v[202:205], a[228:231], a[104:107], v[202:205]
    ds_read_b64_tr_b16 a[220:221], v37 offset:53248
    buffer_load_dwordx4 v57, s[20:23], s0 offen offset:2048 lds
    v_mfma_f32_16x16x32_bf16 v[210:213], a[228:231], a[108:111], v[210:213]
    ds_read_b64_tr_b16 a[222:223], v37 offset:55296
    s_waitcnt vmcnt(9) lgkmcnt(8)
    v_mfma_f32_16x16x32_bf16 v[182:185], a[200:203], a[112:115], v[182:185]
    ds_read_b64_tr_b16 a[224:225], v36 offset:53248
    v_mfma_f32_16x16x32_bf16 v[190:193], a[200:203], a[116:119], v[190:193]
    ds_read_b64_tr_b16 a[226:227], v36 offset:55296
    buffer_load_dwordx4 v58, s[20:23], s0 offen offset:3072 lds
    v_mfma_f32_16x16x32_bf16 v[198:201], a[204:207], a[112:115], v[198:201]
    ds_read_b64_tr_b16 a[228:229], v38 offset:53248
    s_add_u32 m0, s58, 32768
    v_mfma_f32_16x16x32_bf16 v[206:209], a[204:207], a[116:119], v[206:209]
    ds_read_b64_tr_b16 a[230:231], v38 offset:55296
    s_waitcnt lgkmcnt(8)
    v_mfma_f32_16x16x32_bf16 v[186:189], a[208:211], a[112:115], v[186:189]
    s_waitcnt lgkmcnt(0)
    s_cmp_ge_u32 s14, 14
    s_cbranch_scc0 L_pollin1
L_pollok1:
    ds_read_b64_tr_b16 a[200:201], v39 offset:0
    s_add_u32 s0, s0, 458752
    v_mfma_f32_16x16x32_bf16 v[194:197], a[208:211], a[116:119], v[194:197]
    ds_read_b64_tr_b16 a[202:203], v39 offset:2048
    s_cmp_eq_u32 s0, 3670016
    s_cselect_b32 s0, 0, s0
    buffer_load_dwordx4 v55, s[20:23], s0 offen lds
    v_mfma_f32_16x16x32_bf16 v[202:205], a[212:215], a[112:115], v[202:205]
    ds_read_b64_tr_b16 a[204:205], v41 offset:0
    v_mfma_f32_16x16x32_bf16 v[210:213], a[212:215], a[116:119], v[210:213]
    ds_read_b64_tr_b16 a[206:207], v41 offset:2048
    s_waitcnt vmcnt(9)
    v_mfma_f32_16x16x32_bf16 v[182:185], a[216:219], a[120:123], v[182:185]
    ds_read_b64_tr_b16 a[208:209], v40 offset:0
    buffer_load_dwordx4 v56, s[20:23], s0 offen offset:1024 lds
    v_mfma_f32_16x16x32_bf16 v[190:193], a[216:219], a[124:127], v[190:193]
    ds_read_b64_tr_b16 a[210:211], v40 offset:2048
    v_mfma_f32_16x16x32_bf16 v[198:201], a[220:223], a[120:123], v[198:201]
    ds_read_b64_tr_b16 a[212:213], v42 offset:0
    buffer_load_dwordx4 v57, s[20:23], s0 offen offset:2048 lds
    v_mfma_f32_16x16x32_bf16 v[206:209], a[220:223], a[124:127], v[206:209]
    ds_read_b64_tr_b16 a[214:215], v42 offset:2048
    v_mfma_f32_16x16x32_bf16 v[186:189], a[224:227], a[120:123], v[186:189]
    ds_read_b64_tr_b16 a[216:217], v39 offset:4096
    v_mfma_f32_16x16x32_bf16 v[194:197], a[224:227], a[124:127], v[194:197]
    ds_read_b64_tr_b16 a[218:219], v39 offset:6144
    v_mfma_f32_16x16x32_bf16 v[202:205], a[228:231], a[120:123], v[202:205]
    ds_read_b64_tr_b16 a[220:221], v41 offset:4096
    buffer_load_dwordx4 v58, s[20:23], s0 offen offset:3072 lds
    v_mfma_f32_16x16x32_bf16 v[210:213], a[228:231], a[124:127], v[210:213]
    ds_read_b64_tr_b16 a[222:223], v41 offset:6144
    s_waitcnt lgkmcnt(8)
    v_mfma_f32_16x16x32_bf16 v[150:153], a[200:203], a[0:3], v[150:153]
    ds_read_b64_tr_b16 a[224:225], v40 offset:4096
    s_add_u32 m0, s58, 49152
    v_mfma_f32_16x16x32_bf16 v[158:161], a[200:203], a[4:7], v[158:161]
    ds_read_b64_tr_b16 a[226:227], v40 offset:6144
    s_add_u32 s0, s0, 458752
    v_mfma_f32_16x16x32_bf16 v[166:169], a[204:207], a[0:3], 0
    ds_read_b64_tr_b16 a[228:229], v42 offset:4096
    s_cmp_eq_u32 s0, 3670016
    s_cselect_b32 s0, 0, s0
    buffer_load_dwordx4 v55, s[20:23], s0 offen lds
    v_mfma_f32_16x16x32_bf16 v[174:177], a[204:207], a[4:7], 0
    ds_read_b64_tr_b16 a[230:231], v42 offset:6144
    v_cvt_pk_bf16_f32 v182, v182, v183
    v_cvt_pk_bf16_f32 v183, v184, v185
    v_cvt_pk_bf16_f32 v184, v186, v187
    s_waitcnt lgkmcnt(8)
    v_mfma_f32_16x16x32_bf16 v[154:157], a[208:211], a[0:3], v[154:157]
    s_waitcnt vmcnt(5)
    s_barrier
    ds_read_b64_tr_b16 a[200:201], v39 offset:16384
    buffer_load_dwordx4 v56, s[20:23], s0 offen offset:1024 lds
    v_mfma_f32_16x16x32_bf16 v[162:165], a[208:211], a[4:7], v[162:165]
    ds_read_b64_tr_b16 a[202:203], v39 offset:18432
    v_cvt_pk_bf16_f32 v185, v188, v189
    buffer_store_dwordx4 v[182:185], v23, s[28:31], 0 offen offset:0 sc1
    v_cvt_pk_bf16_f32 v190, v190, v191
    v_cvt_pk_bf16_f32 v191, v192, v193
    v_cvt_pk_bf16_f32 v192, v194, v195
    v_mfma_f32_16x16x32_bf16 v[170:173], a[212:215], a[0:3], 0
    ds_read_b64_tr_b16 a[204:205], v41 offset:16384
    v_cvt_pk_bf16_f32 v193, v196, v197
    v_mfma_f32_16x16x32_bf16 v[178:181], a[212:215], a[4:7], 0
    ds_read_b64_tr_b16 a[206:207], v41 offset:18432
    buffer_store_dwordx4 v[190:193], v23, s[28:31], 0 offen offset:1024 sc1
    v_cvt_pk_bf16_f32 v198, v198, v199
    v_cvt_pk_bf16_f32 v199, v200, v201
    v_cvt_pk_bf16_f32 v200, v202, v203
    s_waitcnt lgkmcnt(8)
    v_mfma_f32_16x16x32_bf16 v[150:153], a[216:219], a[8:11], v[150:153]
    ds_read_b64_tr_b16 a[208:209], v40 offset:16384
    buffer_load_dwordx4 v57, s[20:23], s0 offen offset:2048 lds
    v_mfma_f32_16x16x32_bf16 v[158:161], a[216:219], a[12:15], v[158:161]
    ds_read_b64_tr_b16 a[210:211], v40 offset:18432
    v_cvt_pk_bf16_f32 v201, v204, v205
    buffer_store_dwordx4 v[198:201], v23, s[28:31], 0 offen offset:2048 sc1
    v_cvt_pk_bf16_f32 v206, v206, v207
    v_cvt_pk_bf16_f32 v207, v208, v209
    v_cvt_pk_bf16_f32 v208, v210, v211
    v_mfma_f32_16x16x32_bf16 v[166:169], a[220:223], a[8:11], v[166:169]
    ds_read_b64_tr_b16 a[212:213], v42 offset:16384
    v_cvt_pk_bf16_f32 v209, v212, v213
    v_mfma_f32_16x16x32_bf16 v[174:177], a[220:223], a[12:15], v[174:177]
    ds_read_b64_tr_b16 a[214:215], v42 offset:18432
    s_waitcnt lgkmcnt(8)
    v_mfma_f32_16x16x32_bf16 v[154:157], a[224:227], a[8:11], v[154:157]
    ds_read_b64_tr_b16 a[216:217], v39 offset:20480
    buffer_load_dwordx4 v58, s[20:23], s0 offen offset:3072 lds
    v_mfma_f32_16x16x32_bf16 v[162:165], a[224:227], a[12:15], v[162:165]
    ds_read_b64_tr_b16 a[218:219], v39 offset:22528
    s_add_u32 m0, s58, 65536
    buffer_store_dwordx4 v[206:209], v23, s[28:31], 0 offen offset:3072 sc1
    v_mfma_f32_16x16x32_bf16 v[170:173], a[228:231], a[8:11], v[170:173]
    ds_read_b64_tr_b16 a[220:221], v41 offset:20480
    s_add_u32 s0, s0, 458752
    v_mfma_f32_16x16x32_bf16 v[178:181], a[228:231], a[12:15], v[178:181]
    ds_read_b64_tr_b16 a[222:223], v41 offset:22528
    s_waitcnt lgkmcnt(8)
    v_mfma_f32_16x16x32_bf16 v[150:153], a[200:203], a[16:19], v[150:153]
    ds_read_b64_tr_b16 a[224:225], v40 offset:20480
    s_cmp_eq_u32 s0, 3670016
    v_mfma_f32_16x16x32_bf16 v[158:161], a[200:203], a[20:23], v[158:161]
    ds_read_b64_tr_b16 a[226:227], v40 offset:22528
    s_cselect_b32 s0, 0, s0
    buffer_load_dwordx4 v55, s[20:23], s0 offen lds
    v_mfma_f32_16x16x32_bf16 v[166:169], a[204:207], a[16:19], v[166:169]
    ds_read_b64_tr_b16 a[228:229], v42 offset:20480
    v_mfma_f32_16x16x32_bf16 v[174:177], a[204:207], a[20:23], v[174:177]
    ds_read_b64_tr_b16 a[230:231], v42 offset:22528
    s_waitcnt lgkmcnt(8)
    v_mfma_f32_16x16x32_bf16 v[154:157], a[208:211], a[16:19], v[154:157]
    ds_read_b64_tr_b16 a[200:201], v31 offset:0
    buffer_load_dwordx4 v56, s[20:23], s0 offen offset:1024 lds
    v_mfma_f32_16x16x32_bf16 v[162:165], a[208:211], a[20:23], v[162:165]
    ds_read_b64_tr_b16 a[202:203], v31 offset:2048
    v_mfma_f32_16x16x32_bf16 v[170:173], a[212:215], a[16:19], v[170:173]
    ds_read_b64_tr_b16 a[204:205], v33 offset:0
    buffer_load_dwordx4 v57, s[20:23], s0 offen offset:2048 lds
    v_mfma_f32_16x16x32_bf16 v[178:181], a[212:215], a[20:23], v[178:181]
    ds_read_b64_tr_b16 a[206:207], v33 offset:2048
    s_waitcnt lgkmcnt(8)
    v_mfma_f32_16x16x32_bf16 v[150:153], a[216:219], a[24:27], v[150:153]
    ds_read_b64_tr_b16 a[208:209], v32 offset:0
    v_mfma_f32_16x16x32_bf16 v[158:161], a[216:219], a[28:31], v[158:161]
    ds_read_b64_tr_b16 a[210:211], v32 offset:2048
    buffer_load_dwordx4 v58, s[20:23], s0 offen offset:3072 lds
    v_mfma_f32_16x16x32_bf16 v[166:169], a[220:223], a[24:27], v[166:169]
    ds_read_b64_tr_b16 a[212:213], v34 offset:0
    s_add_u32 m0, s58, 81920
    v_mfma_f32_16x16x32_bf16 v[174:177], a[220:223], a[28:31], v[174:177]
    ds_read_b64_tr_b16 a[214:215], v34 offset:2048
    s_waitcnt lgkmcnt(8)
    v_mfma_f32_16x16x32_bf16 v[154:157], a[224:227], a[24:27], v[154:157]
    ds_read_b64_tr_b16 a[216:217], v31 offset:4096
    s_add_u32 s0, s0, 458752
    v_mfma_f32_16x16x32_bf16 v[162:165], a[224:227], a[28:31], v[162:165]
    ds_read_b64_tr_b16 a[218:219], v31 offset:6144
    s_cmp_eq_u32 s0, 3670016
    v_mfma_f32_16x16x32_bf16 v[170:173], a[228:231], a[24:27], v[170:173]
    ds_read_b64_tr_b16 a[220:221], v33 offset:4096
    s_cselect_b32 s0, 0, s0
    buffer_load_dwordx4 v55, s[20:23], s0 offen lds
    v_mfma_f32_16x16x32_bf16 v[178:181], a[228:231], a[28:31], v[178:181]
    ds_read_b64_tr_b16 a[222:223], v33 offset:6144
    s_waitcnt lgkmcnt(8)
    v_mfma_f32_16x16x32_bf16 v[150:153], a[200:203], a[32:35], v[150:153]
    ds_read_b64_tr_b16 a[224:225], v32 offset:4096
    buffer_load_dwordx4 v56, s[20:23], s0 offen offset:1024 lds
    v_mfma_f32_16x16x32_bf16 v[158:161], a[200:203], a[36:39], v[158:161]
    ds_read_b64_tr_b16 a[226:227], v32 offset:6144
    v_mfma_f32_16x16x32_bf16 v[166:169], a[204:207], a[32:35], v[166:169]
    ds_read_b64_tr_b16 a[228:229], v34 offset:4096
    v_mfma_f32_16x16x32_bf16 v[174:177], a[204:207], a[36:39], v[174:177]
    ds_read_b64_tr_b16 a[230:231], v34 offset:6144
    s_waitcnt lgkmcnt(8)
    v_mfma_f32_16x16x32_bf16 v[154:157], a[208:211], a[32:35], v[154:157]
    s_waitcnt vmcnt(7)
    s_barrier
    s_waitcnt vmcnt(6)
    s_atomic_add s36, s[28:29], s37
    ds_read_b64_tr_b16 a[200:201], v31 offset:16384
    buffer_load_dwordx4 v57, s[20:23], s0 offen offset:2048 lds
    v_mfma_f32_16x16x32_bf16 v[162:165], a[208:211], a[36:39], v[162:165]
    ds_read_b64_tr_b16 a[202:203], v31 offset:18432
    v_mfma_f32_16x16x32_bf16 v[170:173], a[212:215], a[32:35], v[170:173]
    ds_read_b64_tr_b16 a[204:205], v33 offset:16384
    buffer_load_dwordx4 v58, s[20:23], s0 offen offset:3072 lds
    v_mfma_f32_16x16x32_bf16 v[178:181], a[212:215], a[36:39], v[178:181]
    ds_read_b64_tr_b16 a[206:207], v33 offset:18432
    s_waitcnt lgkmcnt(8)
    v_mfma_f32_16x16x32_bf16 v[150:153], a[216:219], a[40:43], v[150:153]
    ds_read_b64_tr_b16 a[208:209], v32 offset:16384
    s_add_u32 m0, s59, 98304
    v_mfma_f32_16x16x32_bf16 v[158:161], a[216:219], a[44:47], v[158:161]
    ds_read_b64_tr_b16 a[210:211], v32 offset:18432
    buffer_load_dwordx4 v80, s[28:31], s63 offen sc1 lds
    v_mfma_f32_16x16x32_bf16 v[166:169], a[220:223], a[40:43], v[166:169]
    ds_read_b64_tr_b16 a[212:213], v34 offset:16384
    v_mfma_f32_16x16x32_bf16 v[174:177], a[220:223], a[44:47], v[174:177]
    ds_read_b64_tr_b16 a[214:215], v34 offset:18432
    s_waitcnt lgkmcnt(8)
    v_mfma_f32_16x16x32_bf16 v[154:157], a[224:227], a[40:43], v[154:157]
    ds_read_b64_tr_b16 a[216:217], v31 offset:20480
    v_mfma_f32_16x16x32_bf16 v[162:165], a[224:227], a[44:47], v[162:165]
    ds_read_b64_tr_b16 a[218:219], v31 offset:22528
    buffer_load_dwordx4 v80, s[28:31], s63 offen offset:1024 sc1 lds
    v_mfma_f32_16x16x32_bf16 v[170:173], a[228:231], a[40:43], v[170:173]
    ds_read_b64_tr_b16 a[220:221], v33 offset:20480
    v_mfma_f32_16x16x32_bf16 v[178:181], a[228:231], a[44:47], v[178:181]
    ds_read_b64_tr_b16 a[222:223], v33 offset:22528
    s_waitcnt lgkmcnt(8)
    v_mfma_f32_16x16x32_bf16 v[150:153], a[200:203], a[48:51], v[150:153]
    ds_read_b64_tr_b16 a[224:225], v32 offset:20480
    buffer_load_dwordx4 v80, s[28:31], s63 offen offset:2048 sc1 lds
    v_mfma_f32_16x16x32_bf16 v[158:161], a[200:203], a[52:55], v[158:161]
    ds_read_b64_tr_b16 a[226:227], v32 offset:22528
    s_add_u32 m0, s100, 126976
    v_mfma_f32_16x16x32_bf16 v[166:169], a[204:207], a[48:51], v[166:169]
    ds_read_b64_tr_b16 a[228:229], v34 offset:20480
    v_mfma_f32_16x16x32_bf16 v[174:177], a[204:207], a[52:55], v[174:177]
    ds_read_b64_tr_b16 a[230:231], v34 offset:22528
    s_waitcnt lgkmcnt(8)
    v_mfma_f32_16x16x32_bf16 v[154:157], a[208:211], a[48:51], v[154:157]
    ds_read_b64_tr_b16 a[200:201], v31 offset:32768
    buffer_load_dwordx4 v69, s[28:31], s62 offen sc1 lds
    v_mfma_f32_16x16x32_bf16 v[162:165], a[208:211], a[52:55], v[162:165]
    ds_read_b64_tr_b16 a[202:203], v31 offset:34816
    s_add_u32 m0, s58, 110592
    v_mfma_f32_16x16x32_bf16 v[170:173], a[212:215], a[48:51], v[170:173]
    ds_read_b64_tr_b16 a[204:205], v33 offset:32768
    v_mfma_f32_16x16x32_bf16 v[178:181], a[212:215], a[52:55], v[178:181]
    ds_read_b64_tr_b16 a[206:207], v33 offset:34816
    s_waitcnt lgkmcnt(8)
    v_mfma_f32_16x16x32_bf16 v[150:153], a[216:219], a[56:59], v[150:153]
    ds_read_b64_tr_b16 a[208:209], v32 offset:32768
    buffer_load_dwordx4 v67, s[28:31], s62 offen sc1 lds
    v_mfma_f32_16x16x32_bf16 v[158:161], a[216:219], a[60:63], v[158:161]
    ds_read_b64_tr_b16 a[210:211], v32 offset:34816
    v_mfma_f32_16x16x32_bf16 v[166:169], a[220:223], a[56:59], v[166:169]
    ds_read_b64_tr_b16 a[212:213], v34 offset:32768
    v_mfma_f32_16x16x32_bf16 v[174:177], a[220:223], a[60:63], v[174:177]
    ds_read_b64_tr_b16 a[214:215], v34 offset:34816
    s_waitcnt lgkmcnt(8)
    v_mfma_f32_16x16x32_bf16 v[154:157], a[224:227], a[56:59], v[154:157]
    ds_read_b64_tr_b16 a[216:217], v31 offset:36864
    buffer_load_dwordx4 v67, s[28:31], s62 offen offset:1024 sc1 lds
    v_mfma_f32_16x16x32_bf16 v[162:165], a[224:227], a[60:63], v[162:165]
    ds_read_b64_tr_b16 a[218:219], v31 offset:38912
    v_mfma_f32_16x16x32_bf16 v[170:173], a[228:231], a[56:59], v[170:173]
    ds_read_b64_tr_b16 a[220:221], v33 offset:36864
    buffer_load_dwordx4 v68, s[28:31], s62 offen offset:2048 sc1 lds
    v_mfma_f32_16x16x32_bf16 v[178:181], a[228:231], a[60:63], v[178:181]
    ds_read_b64_tr_b16 a[222:223], v33 offset:38912
    s_waitcnt lgkmcnt(8)
    v_mfma_f32_16x16x32_bf16 v[150:153], a[200:203], a[64:67], v[150:153]
    ds_read_b64_tr_b16 a[224:225], v32 offset:36864
    v_mfma_f32_16x16x32_bf16 v[158:161], a[200:203], a[68:71], v[158:161]
    ds_read_b64_tr_b16 a[226:227], v32 offset:38912
    v_mfma_f32_16x16x32_bf16 v[166:169], a[204:207], a[64:67], v[166:169]
    ds_read_b64_tr_b16 a[228:229], v34 offset:36864
    buffer_load_dwordx4 v68, s[28:31], s62 offen offset:3072 sc1 lds
    v_mfma_f32_16x16x32_bf16 v[174:177], a[204:207], a[68:71], v[174:177]
    ds_read_b64_tr_b16 a[230:231], v34 offset:38912
    s_waitcnt lgkmcnt(8)
    v_mfma_f32_16x16x32_bf16 v[154:157], a[208:211], a[64:67], v[154:157]
    s_waitcnt vmcnt(8)
    s_barrier
    s_xor_b32 s37, s37, 1024
    s_load_dword s14, s[28:29], s37
    ds_read_b64_tr_b16 a[200:201], v31 offset:49152
    s_add_u32 m0, s59, 131072
    v_mfma_f32_16x16x32_bf16 v[162:165], a[208:211], a[68:71], v[162:165]
    ds_read_b64_tr_b16 a[202:203], v31 offset:51200
    s_add_u32 s63, s63, 12288
    v_mfma_f32_16x16x32_bf16 v[170:173], a[212:215], a[64:67], v[170:173]
    ds_read_b64_tr_b16 a[204:205], v33 offset:49152
    s_cmp_eq_u32 s63, 86016
    s_cselect_b32 s63, 0, s63
    buffer_load_dwordx4 v80, s[28:31], s63 offen sc1 lds
    v_mfma_f32_16x16x32_bf16 v[178:181], a[212:215], a[68:71], v[178:181]
    ds_read_b64_tr_b16 a[206:207], v33 offset:51200
    s_waitcnt lgkmcnt(8)
    v_mfma_f32_16x16x32_bf16 v[150:153], a[216:219], a[72:75], v[150:153]
    ds_read_b64_tr_b16 a[208:209], v32 offset:49152
    buffer_load_dwordx4 v80, s[28:31], s63 offen offset:1024 sc1 lds
    v_mfma_f32_16x16x32_bf16 v[158:161], a[216:219], a[76:79], v[158:161]
    ds_read_b64_tr_b16 a[210:211], v32 offset:51200
    v_mfma_f32_16x16x32_bf16 v[166:169], a[220:223], a[72:75], v[166:169]
    ds_read_b64_tr_b16 a[212:213], v34 offset:49152
    v_mfma_f32_16x16x32_bf16 v[174:177], a[220:223], a[76:79], v[174:177]
    ds_read_b64_tr_b16 a[214:215], v34 offset:51200
    s_waitcnt lgkmcnt(8)
    v_mfma_f32_16x16x32_bf16 v[154:157], a[224:227], a[72:75], v[154:157]
    ds_read_b64_tr_b16 a[216:217], v31 offset:53248
    buffer_load_dwordx4 v80, s[28:31], s63 offen offset:2048 sc1 lds
    v_mfma_f32_16x16x32_bf16 v[162:165], a[224:227], a[76:79], v[162:165]
    ds_read_b64_tr_b16 a[218:219], v31 offset:55296
    s_add_u32 m0, s100, 159744
    v_mfma_f32_16x16x32_bf16 v[170:173], a[228:231], a[72:75], v[170:173]
    ds_read_b64_tr_b16 a[220:221], v33 offset:53248
    s_add_u32 s62, s62, 262144
    v_mfma_f32_16x16x32_bf16 v[178:181], a[228:231], a[76:79], v[178:181]
    ds_read_b64_tr_b16 a[222:223], v33 offset:55296
    s_waitcnt lgkmcnt(8)
    v_mfma_f32_16x16x32_bf16 v[150:153], a[200:203], a[80:83], v[150:153]
    ds_read_b64_tr_b16 a[224:225], v32 offset:53248
    s_cmp_eq_u32 s62, 1835008
    v_mfma_f32_16x16x32_bf16 v[158:161], a[200:203], a[84:87], v[158:161]
    ds_read_b64_tr_b16 a[226:227], v32 offset:55296
    s_cselect_b32 s62, 0, s62
    buffer_load_dwordx4 v69, s[28:31], s62 offen sc1 lds
    v_mfma_f32_16x16x32_bf16 v[166:169], a[204:207], a[80:83], v[166:169]
    ds_read_b64_tr_b16 a[228:229], v34 offset:53248
    s_add_u32 m0, s58, 143360
    v_mfma_f32_16x16x32_bf16 v[174:177], a[204:207], a[84:87], v[174:177]
    ds_read_b64_tr_b16 a[230:231], v34 offset:55296
    s_waitcnt lgkmcnt(8)
    v_mfma_f32_16x16x32_bf16 v[154:157], a[208:211], a[80:83], v[154:157]
    s_barrier
    ds_read_b64_tr_b16 a[200:201], v37 offset:0
    buffer_load_dwordx4 v67, s[28:31], s62 offen sc1 lds
    v_mfma_f32_16x16x32_bf16 v[162:165], a[208:211], a[84:87], v[162:165]
    ds_read_b64_tr_b16 a[202:203], v37 offset:2048
    v_mfma_f32_16x16x32_bf16 v[170:173], a[212:215], a[80:83], v[170:173]
    ds_read_b64_tr_b16 a[204:205], v38 offset:0
    buffer_load_dwordx4 v67, s[28:31], s62 offen offset:1024 sc1 lds
    v_mfma_f32_16x16x32_bf16 v[178:181], a[212:215], a[84:87], v[178:181]
    ds_read_b64_tr_b16 a[206:207], v38 offset:2048
    s_waitcnt lgkmcnt(8)
    v_mfma_f32_16x16x32_bf16 v[150:153], a[216:219], a[88:91], v[150:153]
    ds_read_b64_tr_b16 a[208:209], v37 offset:4096
    v_mfma_f32_16x16x32_bf16 v[158:161], a[216:219], a[92:95], v[158:161]
    ds_read_b64_tr_b16 a[210:211], v37 offset:6144
    v_mfma_f32_16x16x32_bf16 v[166:169], a[220:223], a[88:91], v[166:169]
    ds_read_b64_tr_b16 a[212:213], v38 offset:4096
    buffer_load_dwordx4 v68, s[28:31], s62 offen offset:2048 sc1 lds
    v_mfma_f32_16x16x32_bf16 v[174:177], a[220:223], a[92:95], v[174:177]
    ds_read_b64_tr_b16 a[214:215], v38 offset:6144
    s_waitcnt lgkmcnt(8)
    v_mfma_f32_16x16x32_bf16 v[154:157], a[224:227], a[88:91], v[154:157]
    ds_read_b64_tr_b16 a[216:217], v37 offset:16384
    v_mfma_f32_16x16x32_bf16 v[162:165], a[224:227], a[92:95], v[162:165]
    ds_read_b64_tr_b16 a[218:219], v37 offset:18432
    buffer_load_dwordx4 v68, s[28:31], s62 offen offset:3072 sc1 lds
    v_mfma_f32_16x16x32_bf16 v[170:173], a[228:231], a[88:91], v[170:173]
    ds_read_b64_tr_b16 a[220:221], v38 offset:16384
    s_add_u32 m0, s59, 0
    v_mfma_f32_16x16x32_bf16 v[178:181], a[228:231], a[92:95], v[178:181]
    ds_read_b64_tr_b16 a[222:223], v38 offset:18432
    s_waitcnt lgkmcnt(8)
    v_mfma_f32_16x16x32_bf16 v[166:169], a[200:203], a[96:99], v[166:169]
    s_waitcnt lgkmcnt(0)
    s_cmp_ge_u32 s14, 2
    s_cbranch_scc0 L_pollin2
L_pollok2:
    v_xor_b32 v23, 131072, v23
    v_xor_b32 v22, 8192, v23
    ds_read_b64_tr_b16 a[224:225], v37 offset:20480
    buffer_load_dwordx4 v[214:217], v23, s[28:31], 0 offen offset:0 sc1
    v_mfma_f32_16x16x32_bf16 v[174:177], a[200:203], a[100:103], v[174:177]
    ds_read_b64_tr_b16 a[226:227], v37 offset:22528
    v_mfma_f32_16x16x32_bf16 v[170:173], a[204:207], a[96:99], v[170:173]
    ds_read_b64_tr_b16 a[228:229], v38 offset:20480
    buffer_load_dwordx4 v[218:221], v23, s[28:31], 0 offen offset:1024 sc1
    v_mfma_f32_16x16x32_bf16 v[178:181], a[204:207], a[100:103], v[178:181]
    ds_read_b64_tr_b16 a[230:231], v38 offset:22528
    v_mfma_f32_16x16x32_bf16 v[166:169], a[208:211], a[104:107], v[166:169]
    ds_read_b64_tr_b16 a[200:201], v35 offset:0
    buffer_load_dwordx4 v[222:225], v22, s[28:31], 0 offen offset:2048 sc1
    v_mfma_f32_16x16x32_bf16 v[174:177], a[208:211], a[108:111], v[174:177]
    ds_read_b64_tr_b16 a[202:203], v35 offset:2048
    v_mfma_f32_16x16x32_bf16 v[170:173], a[212:215], a[104:107], v[170:173]
    ds_read_b64_tr_b16 a[204:205], v36 offset:0
    buffer_load_dwordx4 v[226:229], v22, s[28:31], 0 offen offset:3072 sc1
    v_mfma_f32_16x16x32_bf16 v[178:181], a[212:215], a[108:111], v[178:181]
    ds_read_b64_tr_b16 a[206:207], v36 offset:2048
    v_mfma_f32_16x16x32_bf16 v[166:169], a[216:219], a[112:115], v[166:169]
    ds_read_b64_tr_b16 a[208:209], v35 offset:4096
    s_add_u32 s63, s63, 12288
    v_mfma_f32_16x16x32_bf16 v[174:177], a[216:219], a[116:119], v[174:177]
    ds_read_b64_tr_b16 a[210:211], v35 offset:6144
    s_cmp_eq_u32 s63, 86016
    s_cselect_b32 s63, 0, s63
    buffer_load_dwordx4 v80, s[28:31], s63 offen sc1 lds
    v_mfma_f32_16x16x32_bf16 v[170:173], a[220:223], a[112:115], v[170:173]
    ds_read_b64_tr_b16 a[212:213], v36 offset:4096
    v_mfma_f32_16x16x32_bf16 v[178:181], a[220:223], a[116:119], v[178:181]
    ds_read_b64_tr_b16 a[214:215], v36 offset:6144
    s_waitcnt lgkmcnt(8)
    v_mfma_f32_16x16x32_bf16 v[166:169], a[224:227], a[120:123], v[166:169]
    ds_read_b64_tr_b16 a[216:217], v35 offset:16384
    buffer_load_dwordx4 v80, s[28:31], s63 offen offset:1024 sc1 lds
    v_mfma_f32_16x16x32_bf16 v[174:177], a[224:227], a[124:127], v[174:177]
    ds_read_b64_tr_b16 a[218:219], v35 offset:18432
    v_mfma_f32_16x16x32_bf16 v[170:173], a[228:231], a[120:123], v[170:173]
    ds_read_b64_tr_b16 a[220:221], v36 offset:16384
    v_mfma_f32_16x16x32_bf16 v[178:181], a[228:231], a[124:127], v[178:181]
    ds_read_b64_tr_b16 a[222:223], v36 offset:18432
    s_waitcnt lgkmcnt(8)
    v_mfma_f32_16x16x32_bf16 v[150:153], a[200:203], a[96:99], v[150:153]
    ds_read_b64_tr_b16 a[224:225], v35 offset:20480
    buffer_load_dwordx4 v80, s[28:31], s63 offen offset:2048 sc1 lds
    v_mfma_f32_16x16x32_bf16 v[158:161], a[200:203], a[100:103], v[158:161]
    ds_read_b64_tr_b16 a[226:227], v35 offset:22528
    s_add_u32 m0, s100, 28672
    v_mfma_f32_16x16x32_bf16 v[154:157], a[204:207], a[96:99], v[154:157]
    ds_read_b64_tr_b16 a[228:229], v36 offset:20480
    s_add_u32 s62, s62, 262144
    v_mfma_f32_16x16x32_bf16 v[162:165], a[204:207], a[100:103], v[162:165]
    ds_read_b64_tr_b16 a[230:231], v36 offset:22528
    ds_write_b128 v81, v[166:169] offset:32768
    s_waitcnt lgkmcnt(9)
    v_mfma_f32_16x16x32_bf16 v[150:153], a[208:211], a[104:107], v[150:153]
    s_cmp_eq_u32 s62, 1835008
    s_cselect_b32 s62, 0, s62
    buffer_load_dwordx4 v69, s[28:31], s62 offen sc1 lds
    v_mfma_f32_16x16x32_bf16 v[158:161], a[208:211], a[108:111], v[158:161]
    s_add_u32 m0, s58, 12288
    ds_write_b128 v81, v[170:173] offset:33792
    v_mfma_f32_16x16x32_bf16 v[154:157], a[212:215], a[104:107], v[154:157]
    buffer_load_dwordx4 v67, s[28:31], s62 offen sc1 lds
    ds_write_b128 v81, v[174:177] offset:34816
    v_mfma_f32_16x16x32_bf16 v[162:165], a[212:215], a[108:111], v[162:165]
    s_waitcnt lgkmcnt(7)
    v_mfma_f32_16x16x32_bf16 v[150:153], a[216:219], a[112:115], v[150:153]
    ds_write_b128 v81, v[178:181] offset:35840
    v_mfma_f32_16x16x32_bf16 v[158:161], a[216:219], a[116:119], v[158:161]
    v_mfma_f32_16x16x32_bf16 v[154:157], a[220:223], a[112:115], v[154:157]
    buffer_load_dwordx4 v67, s[28:31], s62 offen offset:1024 sc1 lds
    v_mfma_f32_16x16x32_bf16 v[162:165], a[220:223], a[116:119], v[162:165]
    s_waitcnt lgkmcnt(4)
    v_mfma_f32_16x16x32_bf16 v[150:153], a[224:227], a[120:123], v[150:153]
    v_mfma_f32_16x16x32_bf16 v[158:161], a[224:227], a[124:127], v[158:161]
    buffer_load_dwordx4 v68, s[28:31], s62 offen offset:2048 sc1 lds
    v_mfma_f32_16x16x32_bf16 v[154:157], a[228:231], a[120:123], v[154:157]
    v_mfma_f32_16x16x32_bf16 v[162:165], a[228:231], a[124:127], v[162:165]
    s_waitcnt vmcnt(10)
    v_mfma_f32_16x16x32_bf16 v[150:153], a[250:253], v[214:217], v[150:153]
    v_xor_b32 v81, 8192, v81
    s_waitcnt lgkmcnt(0)
    s_barrier
    ds_read_b128 v[182:185], v81 offset:32768
    ds_read_b128 v[186:189], v81 offset:33792
    ds_read_b128 v[190:193], v81 offset:34816
    ds_read_b128 v[194:197], v81 offset:35840
    v_mfma_f32_16x16x32_bf16 v[154:157], a[248:251], v[214:217], v[154:157]
    buffer_load_dwordx4 v68, s[28:31], s62 offen offset:3072 sc1 lds
    s_add_u32 m0, s59, 65536
    s_waitcnt vmcnt(10)
    v_mfma_f32_16x16x32_bf16 v[158:161], a[250:253], v[218:221], v[158:161]
    s_add_u32 s63, s63, 12288
    s_cmp_eq_u32 s63, 86016
    v_mfma_f32_16x16x32_bf16 v[162:165], a[248:251], v[218:221], v[162:165]
L_pad1:
    s_cbranch_execz L_warm
    s_cselect_b32 s63, 0, s63
    s_waitcnt vmcnt(9)
    v_mfma_f32_16x16x32_bf16 v[150:153], a[250:253], v[222:225], v[150:153]
    buffer_load_dwordx4 v80, s[28:31], s63 offen sc1 lds
    v_mfma_f32_16x16x32_bf16 v[154:157], a[248:251], v[222:225], v[154:157]
    s_waitcnt vmcnt(9)
    v_mfma_f32_16x16x32_bf16 v[158:161], a[250:253], v[226:229], v[158:161]
    v_mfma_f32_16x16x32_bf16 v[162:165], a[248:251], v[226:229], v[162:165]
    buffer_load_dwordx4 v80, s[28:31], s63 offen offset:1024 sc1 lds
    s_waitcnt lgkmcnt(3)
    s_nop 0
    v_pk_add_f32 v[150:151], v[150:151], v[182:183]
    v_pk_add_f32 v[152:153], v[152:153], v[184:185]
    s_waitcnt lgkmcnt(2)
    v_pk_add_f32 v[154:155], v[154:155], v[186:187]
    v_pk_add_f32 v[156:157], v[156:157], v[188:189]
    v_pk_mul_f32 v[182:183], v[150:151], v[150:151]
    v_pk_mul_f32 v[184:185], v[152:153], v[152:153]
    v_pk_mul_f32 v[186:187], v[154:155], v[154:155]
    v_pk_mul_f32 v[188:189], v[156:157], v[156:157]
    v_pk_fma_f32 v[182:183], v[182:183], s[78:79], v[108:109]
    v_pk_fma_f32 v[184:185], v[184:185], s[78:79], v[108:109]
    v_pk_fma_f32 v[186:187], v[186:187], s[78:79], v[108:109]
    v_pk_fma_f32 v[188:189], v[188:189], s[78:79], v[108:109]
    v_pk_mul_f32 v[182:183], v[182:183], v[150:151]
    buffer_load_dwordx4 v80, s[28:31], s63 offen offset:2048 sc1 lds
    v_pk_mul_f32 v[184:185], v[184:185], v[152:153]
    v_pk_mul_f32 v[186:187], v[186:187], v[154:155]
    v_pk_mul_f32 v[188:189], v[188:189], v[156:157]
    v_exp_f32 v182, v182
    v_exp_f32 v183, v183
    v_exp_f32 v184, v184
    v_exp_f32 v185, v185
    v_exp_f32 v186, v186
    v_exp_f32 v187, v187
    s_add_u32 m0, s100, 94208
    s_add_u32 s62, s62, 262144
    s_cmp_eq_u32 s62, 1835008
    s_cselect_b32 s62, 0, s62
    buffer_load_dwordx4 v69, s[28:31], s62 offen sc1 lds
    v_exp_f32 v188, v188
    v_exp_f32 v189, v189
    v_pk_add_f32 v[182:183], v[182:183], s[80:81]
    v_pk_add_f32 v[184:185], v[184:185], s[80:81]
    v_pk_add_f32 v[186:187], v[186:187], s[80:81]
    v_pk_add_f32 v[188:189], v[188:189], s[80:81]
    v_rcp_f32 v182, v182
    v_rcp_f32 v183, v183
    v_rcp_f32 v184, v184
    s_add_u32 m0, s58, 77824
    s_nop 0
    buffer_load_dwordx4 v67, s[28:31], s62 offen sc1 lds
    v_rcp_f32 v185, v185
    v_rcp_f32 v186, v186
    v_rcp_f32 v187, v187
    v_rcp_f32 v188, v188
    v_rcp_f32 v189, v189
    v_pk_mul_f32 v[182:183], v[182:183], v[150:151]
    v_pk_mul_f32 v[184:185], v[184:185], v[152:153]
    v_pk_mul_f32 v[186:187], v[186:187], v[154:155]
    buffer_load_dwordx4 v67, s[28:31], s62 offen offset:1024 sc1 lds
    v_pk_mul_f32 v[188:189], v[188:189], v[156:157]
    v_cvt_pk_bf16_f32 v110, v182, v183
    v_cvt_pk_bf16_f32 v111, v184, v185
    v_cvt_pk_bf16_f32 v112, v186, v187
    v_cvt_pk_bf16_f32 v113, v188, v189
    s_waitcnt lgkmcnt(1)
    v_pk_add_f32 v[158:159], v[158:159], v[190:191]
    v_pk_add_f32 v[160:161], v[160:161], v[192:193]
    s_waitcnt lgkmcnt(0)
    v_pk_add_f32 v[162:163], v[162:163], v[194:195]
    v_pk_add_f32 v[164:165], v[164:165], v[196:197]
    v_pk_mul_f32 v[190:191], v[158:159], v[158:159]
    v_pk_mul_f32 v[192:193], v[160:161], v[160:161]
    v_pk_mul_f32 v[194:195], v[162:163], v[162:163]
    v_pk_mul_f32 v[196:197], v[164:165], v[164:165]
    v_pk_fma_f32 v[190:191], v[190:191], s[78:79], v[108:109]
    buffer_load_dwordx4 v68, s[28:31], s62 offen offset:2048 sc1 lds
    v_pk_fma_f32 v[192:193], v[192:193], s[78:79], v[108:109]
    v_pk_fma_f32 v[194:195], v[194:195], s[78:79], v[108:109]
    v_pk_fma_f32 v[196:197], v[196:197], s[78:79], v[108:109]
    v_pk_mul_f32 v[190:191], v[190:191], v[158:159]
    v_pk_mul_f32 v[192:193], v[192:193], v[160:161]
    v_pk_mul_f32 v[194:195], v[194:195], v[162:163]
    v_pk_mul_f32 v[196:197], v[196:197], v[164:165]
    v_exp_f32 v190, v190
    v_exp_f32 v191, v191
    v_exp_f32 v192, v192
    v_exp_f32 v193, v193
    buffer_load_dwordx4 v68, s[28:31], s62 offen offset:3072 sc1 lds
    v_exp_f32 v194, v194
    v_exp_f32 v195, v195
    v_exp_f32 v196, v196
    v_exp_f32 v197, v197
    v_pk_add_f32 v[190:191], v[190:191], s[80:81]
    v_pk_add_f32 v[192:193], v[192:193], s[80:81]
    v_pk_add_f32 v[194:195], v[194:195], s[80:81]
    v_pk_add_f32 v[196:197], v[196:197], s[80:81]
    v_rcp_f32 v190, v190
    v_rcp_f32 v191, v191
    v_rcp_f32 v192, v192
    v_rcp_f32 v193, v193
    v_rcp_f32 v194, v194
    v_rcp_f32 v195, v195
    v_rcp_f32 v196, v196
    v_rcp_f32 v197, v197
    v_pk_mul_f32 v[190:191], v[190:191], v[158:159]
    v_pk_mul_f32 v[192:193], v[192:193], v[160:161]
    v_pk_mul_f32 v[194:195], v[194:195], v[162:163]
    v_pk_mul_f32 v[196:197], v[196:197], v[164:165]
    v_cvt_pk_bf16_f32 v114, v190, v191
    v_cvt_pk_bf16_f32 v115, v192, v193
    v_cvt_pk_bf16_f32 v116, v194, v195
    v_cvt_pk_bf16_f32 v117, v196, v197
    ds_read_b64_tr_b16 a[180:181], v72 offset:32768
    ds_read_b64_tr_b16 a[182:183], v72 offset:33024
    ds_read_b128 a[128:131], v53 offset:32768
    ds_read_b64_tr_b16 a[184:185], v72 offset:33792
    ds_read_b64_tr_b16 a[186:187], v72 offset:34048
    ds_read_b128 a[132:135], v53 offset:33792
    ds_read_b128 a[136:139], v53 offset:34816
    ds_read_b64_tr_b16 a[176:177], v73 offset:32768
    ds_read_b64_tr_b16 a[178:179], v73 offset:33024
    ds_read_b128 a[140:143], v53 offset:35840
    ds_read_b128 a[144:147], v53 offset:36864
    ds_read_b128 a[148:151], v53 offset:37888
    buffer_store_dwordx4 v[110:113], v4, s[28:31], s67 offen offset:0 sc1
    buffer_store_dwordx4 v[114:117], v4, s[28:31], s67 offen offset:1024 sc1
L_q:
    s_waitcnt lgkmcnt(6)
    v_mfma_f32_16x16x32_bf16 v[182:185], a[128:131], a[180:183], 0
    ds_read_b64_tr_b16 a[192:193], v72 offset:34816
    v_mfma_f32_16x16x32_bf16 v[190:193], a[128:131], a[184:187], 0
    ds_read_b64_tr_b16 a[194:195], v72 offset:35072
    v_mfma_f32_16x16x32_bf16 v[186:189], a[132:135], a[180:183], 0
    ds_read_b128 a[152:155], v53 offset:38912
    v_mfma_f32_16x16x32_bf16 v[194:197], a[132:135], a[184:187], 0
    ds_read_b64_tr_b16 a[196:197], v72 offset:35840
    s_waitcnt lgkmcnt(4)
    v_mfma_f32_16x16x32_bf16 v[206:209], a[136:139], a[180:183], 0
    ds_read_b64_tr_b16 a[198:199], v72 offset:36096
    v_mfma_f32_16x16x32_bf16 v[214:217], a[136:139], a[184:187], 0
    ds_read_b128 a[156:159], v53 offset:39936
    v_mfma_f32_16x16x32_bf16 v[198:201], a[136:139], a[176:179], 0
    ds_read_b128 a[160:163], v53 offset:40960
    v_mfma_f32_16x16x32_bf16 v[210:213], a[140:143], a[180:183], 0
    ds_read_b64_tr_b16 a[188:189], v73 offset:34816
    v_mfma_f32_16x16x32_bf16 v[218:221], a[140:143], a[184:187], 0
    ds_read_b64_tr_b16 a[190:191], v73 offset:35072
    v_mfma_f32_16x16x32_bf16 v[202:205], a[140:143], a[176:179], 0
    ds_read_b128 a[164:167], v53 offset:41984
    v_mfma_f32_16x16x32_bf16 v[230:233], a[180:183], a[144:147], 0
    ds_read_b128 a[168:171], v53 offset:43008
    v_mfma_f32_16x16x32_bf16 v[238:241], a[184:187], a[144:147], 0
    ds_read_b128 a[172:175], v53 offset:44032
    v_mfma_f32_16x16x32_bf16 v[222:225], a[176:179], a[144:147], 0
    v_mfma_f32_16x16x32_bf16 v[234:237], a[180:183], a[148:151], 0
    v_mfma_f32_16x16x32_bf16 v[242:245], a[184:187], a[148:151], 0
    v_mfma_f32_16x16x32_bf16 v[226:229], a[176:179], a[148:151], 0
    s_waitcnt lgkmcnt(0)
    s_barrier
    v_mfma_f32_16x16x32_bf16 v[182:185], a[152:155], a[192:195], v[182:185]
    ds_read_b64_tr_b16 a[180:181], v74 offset:0
    s_add_u32 m0, s59, 32768
    v_mfma_f32_16x16x32_bf16 v[190:193], a[152:155], a[196:199], v[190:193]
    ds_read_b64_tr_b16 a[182:183], v74 offset:256
    s_add_u32 s63, s63, 12288
    v_mfma_f32_16x16x32_bf16 v[186:189], a[156:159], a[192:195], v[186:189]
    ds_read_b128 a[128:131], v54 offset:0
    s_cmp_eq_u32 s63, 86016
    v_mfma_f32_16x16x32_bf16 v[194:197], a[156:159], a[196:199], v[194:197]
    ds_read_b64_tr_b16 a[184:185], v74 offset:1024
    v_mfma_f32_16x16x32_bf16 v[206:209], a[160:163], a[192:195], v[206:209]
    ds_read_b64_tr_b16 a[186:187], v74 offset:1280
    s_cselect_b32 s63, 0, s63
    v_mfma_f32_16x16x32_bf16 v[214:217], a[160:163], a[196:199], v[214:217]
    ds_read_b128 a[132:135], v54 offset:1024
    buffer_load_dwordx4 v80, s[28:31], s63 offen sc1 lds
    v_mfma_f32_16x16x32_bf16 v[198:201], a[160:163], a[188:191], v[198:201]
    ds_read_b128 a[136:139], v54 offset:2048
    v_mfma_f32_16x16x32_bf16 v[210:213], a[164:167], a[192:195], v[210:213]
    ds_read_b64_tr_b16 a[176:177], v75 offset:0
    buffer_load_dwordx4 v80, s[28:31], s63 offen offset:1024 sc1 lds
    v_mfma_f32_16x16x32_bf16 v[218:221], a[164:167], a[196:199], v[218:221]
    ds_read_b64_tr_b16 a[178:179], v75 offset:256
    v_mfma_f32_16x16x32_bf16 v[202:205], a[164:167], a[188:191], v[202:205]
    ds_read_b128 a[140:143], v54 offset:3072
    v_mfma_f32_16x16x32_bf16 v[230:233], a[192:195], a[168:171], v[230:233]
    ds_read_b128 a[144:147], v54 offset:4096
    buffer_load_dwordx4 v80, s[28:31], s63 offen offset:2048 sc1 lds
    v_mfma_f32_16x16x32_bf16 v[238:241], a[196:199], a[168:171], v[238:241]
    ds_read_b128 a[148:151], v54 offset:5120
    s_add_u32 m0, s100, 61440
    v_mfma_f32_16x16x32_bf16 v[222:225], a[188:191], a[168:171], v[222:225]
    s_add_u32 s62, s62, 262144
    s_cmp_eq_u32 s62, 1835008
    v_mfma_f32_16x16x32_bf16 v[234:237], a[192:195], a[172:175], v[234:237]
    s_cselect_b32 s62, 0, s62
    buffer_load_dwordx4 v69, s[28:31], s62 offen sc1 lds
    v_mfma_f32_16x16x32_bf16 v[242:245], a[196:199], a[172:175], v[242:245]
    s_add_u32 m0, s58, 45056
    v_mfma_f32_16x16x32_bf16 v[226:229], a[188:191], a[172:175], v[226:229]
    s_waitcnt lgkmcnt(6)
    v_mfma_f32_16x16x32_bf16 v[182:185], a[128:131], a[180:183], v[182:185]
    ds_read_b64_tr_b16 a[192:193], v74 offset:2048
    buffer_load_dwordx4 v67, s[28:31], s62 offen sc1 lds
    v_mfma_f32_16x16x32_bf16 v[190:193], a[128:131], a[184:187], v[190:193]
    ds_read_b64_tr_b16 a[194:195], v74 offset:2304
    v_mfma_f32_16x16x32_bf16 v[186:189], a[132:135], a[180:183], v[186:189]
    ds_read_b128 a[152:155], v54 offset:6144
    v_mfma_f32_16x16x32_bf16 v[194:197], a[132:135], a[184:187], v[194:197]
    ds_read_b64_tr_b16 a[196:197], v74 offset:3072
    s_waitcnt lgkmcnt(4)
    v_mfma_f32_16x16x32_bf16 v[206:209], a[136:139], a[180:183], v[206:209]
    ds_read_b64_tr_b16 a[198:199], v74 offset:3328
    buffer_load_dwordx4 v67, s[28:31], s62 offen offset:1024 sc1 lds
    v_mfma_f32_16x16x32_bf16 v[214:217], a[136:139], a[184:187], v[214:217]
    ds_read_b128 a[156:159], v54 offset:7168
    v_mfma_f32_16x16x32_bf16 v[198:201], a[136:139], a[176:179], v[198:201]
    ds_read_b128 a[160:163], v54 offset:8192
    buffer_load_dwordx4 v68, s[28:31], s62 offen offset:2048 sc1 lds
    v_mfma_f32_16x16x32_bf16 v[210:213], a[140:143], a[180:183], v[210:213]
    ds_read_b64_tr_b16 a[188:189], v75 offset:2048
    v_mfma_f32_16x16x32_bf16 v[218:221], a[140:143], a[184:187], v[218:221]
    ds_read_b64_tr_b16 a[190:191], v75 offset:2304
    v_mfma_f32_16x16x32_bf16 v[202:205], a[140:143], a[176:179], v[202:205]
    ds_read_b128 a[164:167], v54 offset:9216
    buffer_load_dwordx4 v68, s[28:31], s62 offen offset:3072 sc1 lds
    v_mfma_f32_16x16x32_bf16 v[230:233], a[180:183], a[144:147], v[230:233]
    ds_read_b128 a[168:171], v54 offset:10240
    s_add_u32 m0, s59, 98304
    v_mfma_f32_16x16x32_bf16 v[238:241], a[184:187], a[144:147], v[238:241]
    ds_read_b128 a[172:175], v54 offset:11264
    s_add_u32 s63, s63, 12288
    v_mfma_f32_16x16x32_bf16 v[222:225], a[176:179], a[144:147], v[222:225]
    s_cmp_eq_u32 s63, 86016
    s_cselect_b32 s63, 0, s63
    v_mfma_f32_16x16x32_bf16 v[234:237], a[180:183], a[148:151], v[234:237]
    buffer_load_dwordx4 v80, s[28:31], s63 offen sc1 lds
    v_mfma_f32_16x16x32_bf16 v[242:245], a[184:187], a[148:151], v[242:245]
    v_mfma_f32_16x16x32_bf16 v[226:229], a[176:179], a[148:151], v[226:229]
    s_waitcnt vmcnt(9) lgkmcnt(0)
    s_barrier
    s_cmp_lg_u32 s48, 0
    s_cbranch_scc1 L_sig2
    s_atomic_add s36, s[28:29], s68
L_sig2:
    v_mfma_f32_16x16x32_bf16 v[182:185], a[152:155], a[192:195], v[182:185]
    ds_read_b64_tr_b16 a[180:181], v70 offset:0
    buffer_load_dwordx4 v80, s[28:31], s63 offen offset:1024 sc1 lds
    v_mfma_f32_16x16x32_bf16 v[190:193], a[152:155], a[196:199], v[190:193]
    ds_read_b64_tr_b16 a[182:183], v70 offset:256
    v_mfma_f32_16x16x32_bf16 v[186:189], a[156:159], a[192:195], v[186:189]
    ds_read_b128 a[128:131], v4 offset:0
    buffer_load_dwordx4 v80, s[28:31], s63 offen offset:2048 sc1 lds
    v_mfma_f32_16x16x32_bf16 v[194:197], a[156:159], a[196:199], v[194:197]
    ds_read_b64_tr_b16 a[184:185], v70 offset:1024
    v_mfma_f32_16x16x32_bf16 v[206:209], a[160:163], a[192:195], v[206:209]
    ds_read_b64_tr_b16 a[186:187], v70 offset:1280
    s_add_u32 m0, s100, 126976
    v_mfma_f32_16x16x32_bf16 v[214:217], a[160:163], a[196:199], v[214:217]
    ds_read_b128 a[132:135], v4 offset:1024
    s_add_u32 s62, s62, 262144
    v_mfma_f32_16x16x32_bf16 v[198:201], a[160:163], a[188:191], v[198:201]
    ds_read_b128 a[136:139], v4 offset:2048
    s_cmp_eq_u32 s62, 1835008
    v_mfma_f32_16x16x32_bf16 v[210:213], a[164:167], a[192:195], v[210:213]
    ds_read_b64_tr_b16 a[176:177], v71 offset:0
    s_cselect_b32 s62, 0, s62
    v_mfma_f32_16x16x32_bf16 v[218:221], a[164:167], a[196:199], v[218:221]
    ds_read_b64_tr_b16 a[178:179], v71 offset:256
    buffer_load_dwordx4 v69, s[28:31], s62 offen sc1 lds
    v_mfma_f32_16x16x32_bf16 v[202:205], a[164:167], a[188:191], v[202:205]
    ds_read_b128 a[140:143], v4 offset:3072
    s_add_u32 m0, s58, 110592
    v_mfma_f32_16x16x32_bf16 v[230:233], a[192:195], a[168:171], v[230:233]
    ds_read_b128 a[144:147], v4 offset:4096
    buffer_load_dwordx4 v67, s[28:31], s62 offen sc1 lds
    v_mfma_f32_16x16x32_bf16 v[238:241], a[196:199], a[168:171], v[238:241]
    ds_read_b128 a[148:151], v4 offset:5120
    v_mfma_f32_16x16x32_bf16 v[222:225], a[188:191], a[168:171], v[222:225]
    v_mfma_f32_16x16x32_bf16 v[234:237], a[192:195], a[172:175], v[234:237]
    buffer_load_dwordx4 v67, s[28:31], s62 offen offset:1024 sc1 lds
    v_mfma_f32_16x16x32_bf16 v[242:245], a[196:199], a[172:175], v[242:245]
    v_mfma_f32_16x16x32_bf16 v[226:229], a[188:191], a[172:175], v[226:229]
    s_waitcnt lgkmcnt(6)
    v_mfma_f32_16x16x32_bf16 v[182:185], a[128:131], a[180:183], v[182:185]
    ds_read_b64_tr_b16 a[192:193], v70 offset:2048
    buffer_load_dwordx4 v68, s[28:31], s62 offen offset:2048 sc1 lds
    v_mfma_f32_16x16x32_bf16 v[190:193], a[128:131], a[184:187], v[190:193]
    ds_read_b64_tr_b16 a[194:195], v70 offset:2304
    v_mfma_f32_16x16x32_bf16 v[186:189], a[132:135], a[180:183], v[186:189]
    ds_read_b128 a[152:155], v4 offset:6144
    v_mfma_f32_16x16x32_bf16 v[194:197], a[132:135], a[184:187], v[194:197]
    ds_read_b64_tr_b16 a[196:197], v70 offset:3072
    s_waitcnt lgkmcnt(4)
    v_mfma_f32_16x16x32_bf16 v[206:209], a[136:139], a[180:183], v[206:209]
    ds_read_b64_tr_b16 a[198:199], v70 offset:3328
    buffer_load_dwordx4 v68, s[28:31], s62 offen offset:3072 sc1 lds
    v_mfma_f32_16x16x32_bf16 v[214:217], a[136:139], a[184:187], v[214:217]
    ds_read_b128 a[156:159], v4 offset:7168
    s_add_u32 m0, s59, 131072
    v_mfma_f32_16x16x32_bf16 v[198:201], a[136:139], a[176:179], v[198:201]
    ds_read_b128 a[160:163], v4 offset:8192
    s_add_u32 s63, s63, 12288
    v_mfma_f32_16x16x32_bf16 v[210:213], a[140:143], a[180:183], v[210:213]
    ds_read_b64_tr_b16 a[188:189], v71 offset:2048
    s_cmp_eq_u32 s63, 86016
    v_mfma_f32_16x16x32_bf16 v[218:221], a[140:143], a[184:187], v[218:221]
    ds_read_b64_tr_b16 a[190:191], v71 offset:2304
    s_cselect_b32 s63, 0, s63
    v_mfma_f32_16x16x32_bf16 v[202:205], a[140:143], a[176:179], v[202:205]
    ds_read_b128 a[164:167], v4 offset:9216
    buffer_load_dwordx4 v80, s[28:31], s63 offen sc1 lds
    v_mfma_f32_16x16x32_bf16 v[230:233], a[180:183], a[144:147], v[230:233]
    ds_read_b128 a[168:171], v4 offset:10240
    v_mfma_f32_16x16x32_bf16 v[238:241], a[184:187], a[144:147], v[238:241]
    ds_read_b128 a[172:175], v4 offset:11264
    buffer_load_dwordx4 v80, s[28:31], s63 offen offset:1024 sc1 lds
    v_mfma_f32_16x16x32_bf16 v[222:225], a[176:179], a[144:147], v[222:225]
    v_mfma_f32_16x16x32_bf16 v[234:237], a[180:183], a[148:151], v[234:237]
    v_mfma_f32_16x16x32_bf16 v[242:245], a[184:187], a[148:151], v[242:245]
    buffer_load_dwordx4 v80, s[28:31], s63 offen offset:2048 sc1 lds
    s_add_u32 m0, s100, 159744
    v_mfma_f32_16x16x32_bf16 v[226:229], a[176:179], a[148:151], v[226:229]
    s_add_u32 s62, s62, 262144
    ds_read_b32 v24, v4
    s_waitcnt lgkmcnt(1)
    s_barrier
    v_mfma_f32_16x16x32_bf16 v[182:185], a[152:155], a[192:195], v[182:185]
    ds_read_b64_tr_b16 a[180:181], v72 offset:0
    s_cmp_eq_u32 s62, 1835008
    v_mfma_f32_16x16x32_bf16 v[190:193], a[152:155], a[196:199], v[190:193]
    ds_read_b64_tr_b16 a[182:183], v72 offset:256
    s_cselect_b32 s62, 0, s62
    v_mfma_f32_16x16x32_bf16 v[186:189], a[156:159], a[192:195], v[186:189]
    ds_read_b128 a[128:131], v53 offset:0
    buffer_load_dwordx4 v69, s[28:31], s62 offen sc1 lds
    v_mfma_f32_16x16x32_bf16 v[194:197], a[156:159], a[196:199], v[194:197]
    ds_read_b64_tr_b16 a[184:185], v72 offset:1024
    v_mfma_f32_16x16x32_bf16 v[206:209], a[160:163], a[192:195], v[206:209]
    ds_read_b64_tr_b16 a[186:187], v72 offset:1280
    s_add_u32 m0, s58, 143360
    v_mfma_f32_16x16x32_bf16 v[214:217], a[160:163], a[196:199], v[214:217]
    ds_read_b128 a[132:135], v53 offset:1024
    buffer_load_dwordx4 v67, s[28:31], s62 offen sc1 lds
    v_mfma_f32_16x16x32_bf16 v[198:201], a[160:163], a[188:191], v[198:201]
    ds_read_b128 a[136:139], v53 offset:2048
    v_mfma_f32_16x16x32_bf16 v[210:213], a[164:167], a[192:195], v[210:213]
    ds_read_b64_tr_b16 a[176:177], v73 offset:0
    buffer_load_dwordx4 v67, s[28:31], s62 offen offset:1024 sc1 lds
    v_mfma_f32_16x16x32_bf16 v[218:221], a[164:167], a[196:199], v[218:221]
    ds_read_b64_tr_b16 a[178:179], v73 offset:256
    v_mfma_f32_16x16x32_bf16 v[202:205], a[164:167], a[188:191], v[202:205]
    ds_read_b128 a[140:143], v53 offset:3072
    v_mfma_f32_16x16x32_bf16 v[230:233], a[192:195], a[168:171], v[230:233]
    ds_read_b128 a[144:147], v53 offset:4096
    buffer_load_dwordx4 v68, s[28:31], s62 offen offset:2048 sc1 lds
    v_mfma_f32_16x16x32_bf16 v[238:241], a[196:199], a[168:171], v[238:241]
    ds_read_b128 a[148:151], v53 offset:5120
    v_mfma_f32_16x16x32_bf16 v[222:225], a[188:191], a[168:171], v[222:225]
    v_mfma_f32_16x16x32_bf16 v[234:237], a[192:195], a[172:175], v[234:237]
    buffer_load_dwordx4 v68, s[28:31], s62 offen offset:3072 sc1 lds
    s_add_u32 m0, s58, 0
    v_mfma_f32_16x16x32_bf16 v[242:245], a[196:199], a[172:175], v[242:245]
    v_mfma_f32_16x16x32_bf16 v[226:229], a[188:191], a[172:175], v[226:229]
    s_waitcnt lgkmcnt(6)
    v_mfma_f32_16x16x32_bf16 v[182:185], a[128:131], a[180:183], v[182:185]
    ds_read_b64_tr_b16 a[192:193], v72 offset:2048
    buffer_load_dwordx4 v59, s[24:27], s64 offen lds
    v_mfma_f32_16x16x32_bf16 v[190:193], a[128:131], a[184:187], v[190:193]
    ds_read_b64_tr_b16 a[194:195], v72 offset:2304
    v_mfma_f32_16x16x32_bf16 v[186:189], a[132:135], a[180:183], v[186:189]
    ds_read_b128 a[152:155], v53 offset:6144
    v_mfma_f32_16x16x32_bf16 v[194:197], a[132:135], a[184:187], v[194:197]
    ds_read_b64_tr_b16 a[196:197], v72 offset:3072
    s_waitcnt lgkmcnt(4)
    v_mfma_f32_16x16x32_bf16 v[206:209], a[136:139], a[180:183], v[206:209]
    ds_read_b64_tr_b16 a[198:199], v72 offset:3328
    buffer_load_dwordx4 v60, s[24:27], s64 offen offset:1024 lds
    v_mfma_f32_16x16x32_bf16 v[214:217], a[136:139], a[184:187], v[214:217]
    ds_read_b128 a[156:159], v53 offset:7168
    v_mfma_f32_16x16x32_bf16 v[198:201], a[136:139], a[176:179], v[198:201]
    ds_read_b128 a[160:163], v53 offset:8192
    v_mfma_f32_16x16x32_bf16 v[210:213], a[140:143], a[180:183], v[210:213]
    ds_read_b64_tr_b16 a[188:189], v73 offset:2048
    buffer_load_dwordx4 v61, s[24:27], s64 offen offset:2048 lds
    v_mfma_f32_16x16x32_bf16 v[218:221], a[140:143], a[184:187], v[218:221]
    ds_read_b64_tr_b16 a[190:191], v73 offset:2304
    v_mfma_f32_16x16x32_bf16 v[202:205], a[140:143], a[176:179], v[202:205]
    ds_read_b128 a[164:167], v53 offset:9216
    v_mfma_f32_16x16x32_bf16 v[230:233], a[180:183], a[144:147], v[230:233]
    ds_read_b128 a[168:171], v53 offset:10240
    buffer_load_dwordx4 v62, s[24:27], s64 offen offset:3072 lds
    v_mfma_f32_16x16x32_bf16 v[238:241], a[184:187], a[144:147], v[238:241]
    ds_read_b128 a[172:175], v53 offset:11264
    s_add_u32 m0, s58, 16384
    v_mfma_f32_16x16x32_bf16 v[222:225], a[176:179], a[144:147], v[222:225]
    v_xor_b32 v59, 128, v59
    v_mfma_f32_16x16x32_bf16 v[234:237], a[180:183], a[148:151], v[234:237]
    buffer_load_dwordx4 v59, s[24:27], s64 offen lds
    v_xor_b32 v60, 128, v60
    v_mfma_f32_16x16x32_bf16 v[242:245], a[184:187], a[148:151], v[242:245]
    v_mfma_f32_16x16x32_bf16 v[226:229], a[176:179], a[148:151], v[226:229]
    ds_read_b32 v24, v4
    s_waitcnt vmcnt(21) lgkmcnt(1)
    s_barrier
    v_mfma_f32_16x16x32_bf16 v[182:185], a[152:155], a[192:195], v[182:185]
    ds_read_b64_tr_b16 a[180:181], v70 offset:32768
    buffer_load_dwordx4 v60, s[24:27], s64 offen offset:1024 lds
    v_mfma_f32_16x16x32_bf16 v[190:193], a[152:155], a[196:199], v[190:193]
    ds_read_b64_tr_b16 a[182:183], v70 offset:33024
    v_xor_b32 v61, 128, v61
    v_mfma_f32_16x16x32_bf16 v[186:189], a[156:159], a[192:195], v[186:189]
    ds_read_b128 a[128:131], v4 offset:32768
    v_mfma_f32_16x16x32_bf16 v[194:197], a[156:159], a[196:199], v[194:197]
    ds_read_b64_tr_b16 a[184:185], v70 offset:33792
    v_mfma_f32_16x16x32_bf16 v[206:209], a[160:163], a[192:195], v[206:209]
    ds_read_b64_tr_b16 a[186:187], v70 offset:34048
    buffer_load_dwordx4 v61, s[24:27], s64 offen offset:2048 lds
    v_mfma_f32_16x16x32_bf16 v[214:217], a[160:163], a[196:199], v[214:217]
    ds_read_b128 a[132:135], v4 offset:33792
    v_xor_b32 v62, 128, v62
    v_mfma_f32_16x16x32_bf16 v[198:201], a[160:163], a[188:191], v[198:201]
    ds_read_b128 a[136:139], v4 offset:34816
    buffer_load_dwordx4 v62, s[24:27], s64 offen offset:3072 lds
    v_mfma_f32_16x16x32_bf16 v[210:213], a[164:167], a[192:195], v[210:213]
    ds_read_b64_tr_b16 a[176:177], v71 offset:32768
    s_add_u32 m0, s58, 65536
    v_mfma_f32_16x16x32_bf16 v[218:221], a[164:167], a[196:199], v[218:221]
    ds_read_b64_tr_b16 a[178:179], v71 offset:33024
    s_add_u32 s64, s64, 524288
    v_mfma_f32_16x16x32_bf16 v[202:205], a[164:167], a[188:191], v[202:205]
    ds_read_b128 a[140:143], v4 offset:35840
    s_cmp_eq_u32 s64, 3670016
    v_mfma_f32_16x16x32_bf16 v[230:233], a[192:195], a[168:171], v[230:233]
    ds_read_b128 a[144:147], v4 offset:36864
    s_cselect_b32 s64, 0, s64
    v_mfma_f32_16x16x32_bf16 v[238:241], a[196:199], a[168:171], v[238:241]
    ds_read_b128 a[148:151], v4 offset:37888
    buffer_load_dwordx4 v59, s[24:27], s64 offen lds
    v_mfma_f32_16x16x32_bf16 v[222:225], a[188:191], a[168:171], v[222:225]
    v_mfma_f32_16x16x32_bf16 v[234:237], a[192:195], a[172:175], v[234:237]
    buffer_load_dwordx4 v60, s[24:27], s64 offen offset:1024 lds
    v_mfma_f32_16x16x32_bf16 v[242:245], a[196:199], a[172:175], v[242:245]
    v_mfma_f32_16x16x32_bf16 v[226:229], a[188:191], a[172:175], v[226:229]
    s_waitcnt lgkmcnt(6)
    v_mfma_f32_16x16x32_bf16 v[182:185], a[128:131], a[180:183], v[182:185]
    ds_read_b64_tr_b16 a[192:193], v70 offset:34816
    buffer_load_dwordx4 v61, s[24:27], s64 offen offset:2048 lds
    v_mfma_f32_16x16x32_bf16 v[190:193], a[128:131], a[184:187], v[190:193]
    ds_read_b64_tr_b16 a[194:195], v70 offset:35072
    v_mfma_f32_16x16x32_bf16 v[186:189], a[132:135], a[180:183], v[186:189]
    ds_read_b128 a[152:155], v4 offset:38912
    v_mfma_f32_16x16x32_bf16 v[194:197], a[132:135], a[184:187], v[194:197]
    ds_read_b64_tr_b16 a[196:197], v70 offset:35840
    s_waitcnt lgkmcnt(4)
    v_mfma_f32_16x16x32_bf16 v[206:209], a[136:139], a[180:183], v[206:209]
    ds_read_b64_tr_b16 a[198:199], v70 offset:36096
    buffer_load_dwordx4 v62, s[24:27], s64 offen offset:3072 lds
    v_mfma_f32_16x16x32_bf16 v[214:217], a[136:139], a[184:187], v[214:217]
    ds_read_b128 a[156:159], v4 offset:39936
    s_add_u32 m0, s58, 81920
    v_mfma_f32_16x16x32_bf16 v[198:201], a[136:139], a[176:179], v[198:201]
    ds_read_b128 a[160:163], v4 offset:40960
    s_add_u32 s64, s64, 524288
    v_mfma_f32_16x16x32_bf16 v[210:213], a[140:143], a[180:183], v[210:213]
    ds_read_b64_tr_b16 a[188:189], v71 offset:34816
    s_cmp_eq_u32 s64, 3670016
    v_mfma_f32_16x16x32_bf16 v[218:221], a[140:143], a[184:187], v[218:221]
    ds_read_b64_tr_b16 a[190:191], v71 offset:35072
    s_cselect_b32 s64, 0, s64
    v_mfma_f32_16x16x32_bf16 v[202:205], a[140:143], a[176:179], v[202:205]
    ds_read_b128 a[164:167], v4 offset:41984
    buffer_load_dwordx4 v59, s[24:27], s64 offen lds
    v_mfma_f32_16x16x32_bf16 v[230:233], a[180:183], a[144:147], v[230:233]
    ds_read_b128 a[168:171], v4 offset:43008
    v_mfma_f32_16x16x32_bf16 v[238:241], a[184:187], a[144:147], v[238:241]
    ds_read_b128 a[172:175], v4 offset:44032
    buffer_load_dwordx4 v60, s[24:27], s64 offen offset:1024 lds
    v_mfma_f32_16x16x32_bf16 v[222:225], a[176:179], a[144:147], v[222:225]
    v_mfma_f32_16x16x32_bf16 v[234:237], a[180:183], a[148:151], v[234:237]
    v_mfma_f32_16x16x32_bf16 v[242:245], a[184:187], a[148:151], v[242:245]
    buffer_load_dwordx4 v61, s[24:27], s64 offen offset:2048 lds
    v_mfma_f32_16x16x32_bf16 v[226:229], a[176:179], a[148:151], v[226:229]
    ds_read_b32 v24, v4
    s_waitcnt vmcnt(23) lgkmcnt(1)
    s_barrier
    v_mfma_f32_16x16x32_bf16 v[182:185], a[152:155], a[192:195], v[182:185]
    ds_read_b64_tr_b16 a[180:181], v72 offset:32768
    v_mfma_f32_16x16x32_bf16 v[190:193], a[152:155], a[196:199], v[190:193]
    ds_read_b64_tr_b16 a[182:183], v72 offset:33024
    buffer_load_dwordx4 v62, s[24:27], s64 offen offset:3072 lds
    v_mfma_f32_16x16x32_bf16 v[186:189], a[156:159], a[192:195], v[186:189]
    ds_read_b128 a[128:131], v53 offset:32768
    s_add_u32 m0, s58, 32768
    v_mfma_f32_16x16x32_bf16 v[194:197], a[156:159], a[196:199], v[194:197]
    ds_read_b64_tr_b16 a[184:185], v72 offset:33792
    v_mfma_f32_16x16x32_bf16 v[206:209], a[160:163], a[192:195], v[206:209]
    ds_read_b64_tr_b16 a[186:187], v72 offset:34048
    s_add_u32 s64, s64, 524288
    v_mfma_f32_16x16x32_bf16 v[214:217], a[160:163], a[196:199], v[214:217]
    ds_read_b128 a[132:135], v53 offset:33792
    s_cmp_eq_u32 s64, 3670016
    v_mfma_f32_16x16x32_bf16 v[198:201], a[160:163], a[188:191], v[198:201]
    ds_read_b128 a[136:139], v53 offset:34816
    s_cselect_b32 s64, 0, s64
    v_mfma_f32_16x16x32_bf16 v[210:213], a[164:167], a[192:195], v[210:213]
    ds_read_b64_tr_b16 a[176:177], v73 offset:32768
    buffer_load_dwordx4 v59, s[24:27], s64 offen lds
    v_mfma_f32_16x16x32_bf16 v[218:221], a[164:167], a[196:199], v[218:221]
    ds_read_b64_tr_b16 a[178:179], v73 offset:33024
    v_mfma_f32_16x16x32_bf16 v[202:205], a[164:167], a[188:191], v[202:205]
    ds_read_b128 a[140:143], v53 offset:35840
    buffer_load_dwordx4 v60, s[24:27], s64 offen offset:1024 lds
    v_mfma_f32_16x16x32_bf16 v[230:233], a[192:195], a[168:171], v[230:233]
    ds_read_b128 a[144:147], v53 offset:36864
    v_mfma_f32_16x16x32_bf16 v[238:241], a[196:199], a[168:171], v[238:241]
    ds_read_b128 a[148:151], v53 offset:37888
    v_mfma_f32_16x16x32_bf16 v[222:225], a[188:191], a[168:171], v[222:225]
    buffer_load_dwordx4 v61, s[24:27], s64 offen offset:2048 lds
    v_mfma_f32_16x16x32_bf16 v[234:237], a[192:195], a[172:175], v[234:237]
    v_mfma_f32_16x16x32_bf16 v[242:245], a[196:199], a[172:175], v[242:245]
    v_mfma_f32_16x16x32_bf16 v[226:229], a[188:191], a[172:175], v[226:229]
    buffer_load_dwordx4 v62, s[24:27], s64 offen offset:3072 lds
    s_load_dword s14, s[28:29], s38
    s_waitcnt lgkmcnt(6)
    v_mfma_f32_16x16x32_bf16 v[182:185], a[128:131], a[180:183], v[182:185]
    ds_read_b64_tr_b16 a[192:193], v72 offset:34816
    s_add_u32 m0, s58, 49152
    v_mfma_f32_16x16x32_bf16 v[190:193], a[128:131], a[184:187], v[190:193]
    ds_read_b64_tr_b16 a[194:195], v72 offset:35072
    s_add_u32 s64, s64, 524288
    v_mfma_f32_16x16x32_bf16 v[186:189], a[132:135], a[180:183], v[186:189]
    ds_read_b128 a[152:155], v53 offset:38912
    s_cmp_eq_u32 s64, 3670016
    v_mfma_f32_16x16x32_bf16 v[194:197], a[132:135], a[184:187], v[194:197]
    ds_read_b64_tr_b16 a[196:197], v72 offset:35840
    s_waitcnt lgkmcnt(4)
    v_mfma_f32_16x16x32_bf16 v[206:209], a[136:139], a[180:183], v[206:209]
    ds_read_b64_tr_b16 a[198:199], v72 offset:36096
    s_cselect_b32 s64, 0, s64
    v_mfma_f32_16x16x32_bf16 v[214:217], a[136:139], a[184:187], v[214:217]
    ds_read_b128 a[156:159], v53 offset:39936
    buffer_load_dwordx4 v59, s[24:27], s64 offen lds
    v_mfma_f32_16x16x32_bf16 v[198:201], a[136:139], a[176:179], v[198:201]
    ds_read_b128 a[160:163], v53 offset:40960
    v_mfma_f32_16x16x32_bf16 v[210:213], a[140:143], a[180:183], v[210:213]
    ds_read_b64_tr_b16 a[188:189], v73 offset:34816
    buffer_load_dwordx4 v60, s[24:27], s64 offen offset:1024 lds
    v_mfma_f32_16x16x32_bf16 v[218:221], a[140:143], a[184:187], v[218:221]
    ds_read_b64_tr_b16 a[190:191], v73 offset:35072
L_pad2:
    s_cbranch_execz L_warm
    v_mfma_f32_16x16x32_bf16 v[202:205], a[140:143], a[176:179], v[202:205]
    ds_read_b128 a[164:167], v53 offset:41984
    v_mfma_f32_16x16x32_bf16 v[230:233], a[180:183], a[144:147], v[230:233]
    ds_read_b128 a[168:171], v53 offset:43008
    buffer_load_dwordx4 v61, s[24:27], s64 offen offset:2048 lds
    v_mfma_f32_16x16x32_bf16 v[238:241], a[184:187], a[144:147], v[238:241]
    ds_read_b128 a[172:175], v53 offset:44032
    v_mfma_f32_16x16x32_bf16 v[222:225], a[176:179], a[144:147], v[222:225]
    v_mfma_f32_16x16x32_bf16 v[234:237], a[180:183], a[148:151], v[234:237]
    buffer_load_dwordx4 v62, s[24:27], s64 offen offset:3072 lds
    v_mfma_f32_16x16x32_bf16 v[242:245], a[184:187], a[148:151], v[242:245]
    v_mfma_f32_16x16x32_bf16 v[226:229], a[176:179], a[148:151], v[226:229]
    ds_read_b32 v24, v4
    s_waitcnt vmcnt(24) lgkmcnt(1)
    s_barrier
    v_mfma_f32_16x16x32_bf16 v[182:185], a[152:155], a[192:195], v[182:185]
    ds_read_b64_tr_b16 a[180:181], v74 offset:0
    s_add_u32 m0, s58, 98304
    v_mfma_f32_16x16x32_bf16 v[190:193], a[152:155], a[196:199], v[190:193]
    ds_read_b64_tr_b16 a[182:183], v74 offset:256
    s_add_u32 s64, s64, 524288
    v_mfma_f32_16x16x32_bf16 v[186:189], a[156:159], a[192:195], v[186:189]
    ds_read_b128 a[128:131], v54 offset:0
    s_cmp_eq_u32 s64, 3670016
    v_mfma_f32_16x16x32_bf16 v[194:197], a[156:159], a[196:199], v[194:197]
    ds_read_b64_tr_b16 a[184:185], v74 offset:1024
    v_mfma_f32_16x16x32_bf16 v[206:209], a[160:163], a[192:195], v[206:209]
    ds_read_b64_tr_b16 a[186:187], v74 offset:1280
    s_cselect_b32 s64, 0, s64
    v_mfma_f32_16x16x32_bf16 v[214:217], a[160:163], a[196:199], v[214:217]
    ds_read_b128 a[132:135], v54 offset:1024
    buffer_load_dwordx4 v59, s[24:27], s64 offen lds
    v_mfma_f32_16x16x32_bf16 v[198:201], a[160:163], a[188:191], v[198:201]
    ds_read_b128 a[136:139], v54 offset:2048
    v_mfma_f32_16x16x32_bf16 v[210:213], a[164:167], a[192:195], v[210:213]
    ds_read_b64_tr_b16 a[176:177], v75 offset:0
    buffer_load_dwordx4 v60, s[24:27], s64 offen offset:1024 lds
    v_mfma_f32_16x16x32_bf16 v[218:221], a[164:167], a[196:199], v[218:221]
    ds_read_b64_tr_b16 a[178:179], v75 offset:256
    v_mfma_f32_16x16x32_bf16 v[202:205], a[164:167], a[188:191], v[202:205]
    ds_read_b128 a[140:143], v54 offset:3072
    v_mfma_f32_16x16x32_bf16 v[230:233], a[192:195], a[168:171], v[230:233]
    ds_read_b128 a[144:147], v54 offset:4096
    buffer_load_dwordx4 v61, s[24:27], s64 offen offset:2048 lds
    v_mfma_f32_16x16x32_bf16 v[238:241], a[196:199], a[168:171], v[238:241]
    ds_read_b128 a[148:151], v54 offset:5120
    v_mfma_f32_16x16x32_bf16 v[222:225], a[188:191], a[168:171], v[222:225]
    v_mfma_f32_16x16x32_bf16 v[234:237], a[192:195], a[172:175], v[234:237]
    buffer_load_dwordx4 v62, s[24:27], s64 offen offset:3072 lds
    s_add_u32 m0, s58, 114688
    v_mfma_f32_16x16x32_bf16 v[242:245], a[196:199], a[172:175], v[242:245]
    s_add_u32 s64, s64, 524288
    s_cmp_eq_u32 s64, 3670016
    v_mfma_f32_16x16x32_bf16 v[226:229], a[188:191], a[172:175], v[226:229]
    s_cselect_b32 s64, 0, s64
    s_waitcnt lgkmcnt(6)
    v_mfma_f32_16x16x32_bf16 v[182:185], a[128:131], a[180:183], v[182:185]
    ds_read_b64_tr_b16 a[192:193], v74 offset:2048
    buffer_load_dwordx4 v59, s[24:27], s64 offen lds
    v_mfma_f32_16x16x32_bf16 v[190:193], a[128:131], a[184:187], v[190:193]
    ds_read_b64_tr_b16 a[194:195], v74 offset:2304
    v_mfma_f32_16x16x32_bf16 v[186:189], a[132:135], a[180:183], v[186:189]
    ds_read_b128 a[152:155], v54 offset:6144
    v_mfma_f32_16x16x32_bf16 v[194:197], a[132:135], a[184:187], v[194:197]
    ds_read_b64_tr_b16 a[196:197], v74 offset:3072
    s_waitcnt lgkmcnt(4)
    v_mfma_f32_16x16x32_bf16 v[206:209], a[136:139], a[180:183], v[206:209]
    ds_read_b64_tr_b16 a[198:199], v74 offset:3328
    buffer_load_dwordx4 v60, s[24:27], s64 offen offset:1024 lds
    v_mfma_f32_16x16x32_bf16 v[214:217], a[136:139], a[184:187], v[214:217]
    ds_read_b128 a[156:159], v54 offset:7168
    v_mfma_f32_16x16x32_bf16 v[198:201], a[136:139], a[176:179], v[198:201]
    ds_read_b128 a[160:163], v54 offset:8192
    buffer_load_dwordx4 v61, s[24:27], s64 offen offset:2048 lds
    v_mfma_f32_16x16x32_bf16 v[210:213], a[140:143], a[180:183], v[210:213]
    ds_read_b64_tr_b16 a[188:189], v75 offset:2048
    v_mfma_f32_16x16x32_bf16 v[218:221], a[140:143], a[184:187], v[218:221]
    ds_read_b64_tr_b16 a[190:191], v75 offset:2304
    v_mfma_f32_16x16x32_bf16 v[202:205], a[140:143], a[176:179], v[202:205]
    ds_read_b128 a[164:167], v54 offset:9216
    buffer_load_dwordx4 v62, s[24:27], s64 offen offset:3072 lds
    v_mfma_f32_16x16x32_bf16 v[230:233], a[180:183], a[144:147], v[230:233]
    ds_read_b128 a[168:171], v54 offset:10240
    v_mfma_f32_16x16x32_bf16 v[238:241], a[184:187], a[144:147], v[238:241]
    ds_read_b128 a[172:175], v54 offset:11264
    v_mfma_f32_16x16x32_bf16 v[222:225], a[176:179], a[144:147], v[222:225]
    v_mfma_f32_16x16x32_bf16 v[234:237], a[180:183], a[148:151], v[234:237]
    v_mfma_f32_16x16x32_bf16 v[242:245], a[184:187], a[148:151], v[242:245]
    v_mfma_f32_16x16x32_bf16 v[226:229], a[176:179], a[148:151], v[226:229]
    s_waitcnt lgkmcnt(0)
    s_cmp_ge_u32 s14, 7
    s_cbranch_scc0 L_pollin5
L_pollok5:
    s_waitcnt vmcnt(16)
    s_barrier
    v_mfma_f32_16x16x32_bf16 v[182:185], a[152:155], a[192:195], v[182:185]
    ds_read_b64_tr_b16 a[200:201], v31 offset:16384
    buffer_load_dwordx4 a[0:3], v79, s[28:31], s65 offen offset:0 sc1
    v_mfma_f32_16x16x32_bf16 v[190:193], a[152:155], a[196:199], v[190:193]
    ds_read_b64_tr_b16 a[202:203], v31 offset:18432
    v_mfma_f32_16x16x32_bf16 v[186:189], a[156:159], a[192:195], v[186:189]
    ds_read_b64_tr_b16 a[204:205], v33 offset:16384
    buffer_load_dwordx4 a[4:7], v79, s[28:31], s65 offen offset:1024 sc1
    v_mfma_f32_16x16x32_bf16 v[194:197], a[156:159], a[196:199], v[194:197]
    ds_read_b64_tr_b16 a[206:207], v33 offset:18432
    v_mfma_f32_16x16x32_bf16 v[206:209], a[160:163], a[192:195], v[206:209]
    ds_read_b64_tr_b16 a[208:209], v32 offset:16384
    v_mfma_f32_16x16x32_bf16 v[214:217], a[160:163], a[196:199], v[214:217]
    ds_read_b64_tr_b16 a[210:211], v32 offset:18432
    v_mfma_f32_16x16x32_bf16 v[198:201], a[160:163], a[188:191], v[198:201]
    ds_read_b64_tr_b16 a[212:213], v34 offset:16384
    buffer_load_dwordx4 a[8:11], v79, s[28:31], s65 offen offset:2048 sc1
    v_mfma_f32_16x16x32_bf16 v[210:213], a[164:167], a[192:195], v[210:213]
    ds_read_b64_tr_b16 a[214:215], v34 offset:18432
    v_mfma_f32_16x16x32_bf16 v[218:221], a[164:167], a[196:199], v[218:221]
    ds_read_b64_tr_b16 a[216:217], v31 offset:20480
    v_mfma_f32_16x16x32_bf16 v[202:205], a[164:167], a[188:191], v[202:205]
    ds_read_b64_tr_b16 a[218:219], v31 offset:22528
    buffer_load_dwordx4 a[12:15], v79, s[28:31], s65 offen offset:3072 sc1
    v_mfma_f32_16x16x32_bf16 v[230:233], a[192:195], a[168:171], v[230:233]
    ds_read_b64_tr_b16 a[220:221], v33 offset:20480
    s_add_u32 s65, s65, 8192
    v_mfma_f32_16x16x32_bf16 v[238:241], a[196:199], a[168:171], v[238:241]
    ds_read_b64_tr_b16 a[222:223], v33 offset:22528
    s_cmp_eq_u32 s65, 57344
    v_mfma_f32_16x16x32_bf16 v[222:225], a[188:191], a[168:171], v[222:225]
    s_cselect_b32 s65, 0, s65
    v_mfma_f32_16x16x32_bf16 v[234:237], a[192:195], a[172:175], v[234:237]
    buffer_load_dwordx4 a[16:19], v79, s[28:31], s65 offen offset:0 sc1
    v_mfma_f32_16x16x32_bf16 v[242:245], a[196:199], a[172:175], v[242:245]
    v_mfma_f32_16x16x32_bf16 v[226:229], a[188:191], a[172:175], v[226:229]
    v_cvt_pk_bf16_f32 v118, v182, v183
    v_cvt_pk_bf16_f32 v119, v184, v185
    v_cvt_pk_bf16_f32 v120, v186, v187
    buffer_load_dwordx4 a[20:23], v79, s[28:31], s65 offen offset:1024 sc1
    v_cvt_pk_bf16_f32 v121, v188, v189
    v_cvt_pk_bf16_f32 v122, v190, v191
    v_cvt_pk_bf16_f32 v123, v192, v193
    v_cvt_pk_bf16_f32 v124, v194, v195
    v_cvt_pk_bf16_f32 v125, v196, v197
    v_cvt_pk_bf16_f32 v130, v206, v207
    v_cvt_pk_bf16_f32 v131, v208, v209
    v_cvt_pk_bf16_f32 v132, v210, v211
    v_cvt_pk_bf16_f32 v133, v212, v213
    v_cvt_pk_bf16_f32 v134, v214, v215
    v_cvt_pk_bf16_f32 v135, v216, v217
    v_cvt_pk_bf16_f32 v136, v218, v219
    v_cvt_pk_bf16_f32 v137, v220, v221
    v_cvt_pk_bf16_f32 v126, v198, v199
    buffer_load_dwordx4 a[24:27], v79, s[28:31], s65 offen offset:2048 sc1
    v_cvt_pk_bf16_f32 v127, v200, v201
    v_cvt_pk_bf16_f32 v128, v202, v203
    v_cvt_pk_bf16_f32 v129, v204, v205
    v_mfma_f32_16x16x32_bf16 v[154:157], v[130:133], v[118:121], 0
    v_mfma_f32_16x16x32_bf16 v[158:161], v[130:133], v[122:125], 0
    v_mfma_f32_16x16x32_bf16 v[162:165], v[134:137], v[122:125], 0
    buffer_load_dwordx4 a[28:31], v79, s[28:31], s65 offen offset:3072 sc1
    v_mfma_f32_16x16x32_bf16 v[150:153], v[126:129], v[118:121], 0
    v_cvt_pk_bf16_f32 v166, v222, v223
    v_cvt_pk_bf16_f32 v167, v224, v225
    v_cvt_pk_bf16_f32 v168, v230, v231
    v_cvt_pk_bf16_f32 v169, v232, v233
    v_cvt_pk_bf16_f32 v170, v238, v239
    v_cvt_pk_bf16_f32 v171, v240, v241
    v_cndmask_b32 v250, v158, v159, s[70:71]
    v_cndmask_b32 v253, v162, v163, s[70:71]
    v_cndmask_b32 v250, v250, v253, s[72:73]
    s_add_u32 s65, s65, 8192
    s_cmp_eq_u32 s65, 57344
    s_cselect_b32 s65, 0, s65
    buffer_load_dwordx4 a[32:35], v79, s[28:31], s65 offen offset:0 sc1
    v_mul_f32 v250, v250, v29
    v_cndmask_b32 v251, v160, v161, s[70:71]
    v_cndmask_b32 v253, v164, v165, s[70:71]
    v_cndmask_b32 v251, v251, v253, s[74:75]
    v_mul_f32 v251, v251, v30
    v_cndmask_b32 v246, v150, v151, s[70:71]
    v_cndmask_b32 v246, v84, v246, s[76:77]
    v_cndmask_b32 v249, v154, v155, s[70:71]
    v_cndmask_b32 v246, v246, v249, s[72:73]
    v_mul_f32 v246, v246, v27
    v_cndmask_b32 v247, v152, v153, s[70:71]
    v_cndmask_b32 v247, v84, v247, s[76:77]
    v_cndmask_b32 v249, v156, v157, s[70:71]
    v_cndmask_b32 v247, v247, v249, s[74:75]
    buffer_load_dwordx4 a[36:39], v79, s[28:31], s65 offen offset:1024 sc1
    v_mul_f32 v247, v247, v28
    v_max_f32 v248, v246, v247
    v_max_f32 v252, v250, v251
    v_mov_b32 v249, v248
    v_mov_b32 v253, v252
    v_cvt_pk_bf16_f32 v172, v226, v227
    v_permlane16_swap_b32 v248, v249
    v_permlane16_swap_b32 v252, v253
    v_max_f32 v248, v248, v249
    v_max_f32 v252, v252, v253
    v_mov_b32 v249, v248
    v_mov_b32 v253, v252
    v_cvt_pk_bf16_f32 v173, v228, v229
    v_permlane32_swap_b32 v248, v249
    buffer_load_dwordx4 a[40:43], v79, s[28:31], s65 offen offset:2048 sc1
    v_permlane32_swap_b32 v252, v253
    v_max_f32 v248, v248, v249
    v_max_f32 v252, v252, v253
    v_mul_f32 v248, v25, v248
    v_mul_f32 v252, v26, v252
    v_fma_f32 v246, v246, v25, -v248
    v_fma_f32 v247, v247, v25, -v248
    v_fma_f32 v250, v250, v26, -v252
    v_fma_f32 v251, v251, v26, -v252
    v_exp_f32 v246, v246
    v_exp_f32 v247, v247
    v_exp_f32 v250, v250
    buffer_load_dwordx4 a[44:47], v79, s[28:31], s65 offen offset:3072 sc1
    v_exp_f32 v251, v251
    v_add_f32 v248, v246, v247
    v_add_f32 v252, v250, v251
    v_mov_b32 v249, v248
    v_mov_b32 v253, v252
    v_cvt_pk_bf16_f32 v174, v234, v235
    v_permlane16_swap_b32 v248, v249
    v_permlane16_swap_b32 v252, v253
    v_add_f32 v248, v248, v249
    v_add_f32 v252, v252, v253
    v_mov_b32 v249, v248
    v_mov_b32 v253, v252
    s_add_u32 m0, s58, 131072
    s_add_u32 s64, s64, 524288
    s_cmp_eq_u32 s64, 3670016
    s_cselect_b32 s64, 0, s64
    s_add_u32 s64, s64, 524288
    s_cmp_eq_u32 s64, 3670016
    s_cselect_b32 s64, 0, s64
    v_xor_b32 v59, 128, v59
    buffer_load_dwordx4 v59, s[24:27], s64 offen lds
    v_cvt_pk_bf16_f32 v175, v236, v237
    v_permlane32_swap_b32 v248, v249
    v_permlane32_swap_b32 v252, v253
    v_add_f32 v248, v248, v249
    v_add_f32 v252, v252, v253
    v_rcp_f32 v248, v248
    v_rcp_f32 v252, v252
    v_cvt_pk_bf16_f32 v176, v242, v243
    v_cvt_pk_bf16_f32 v177, v244, v245
    v_mul_f32 v246, v246, v27
    v_xor_b32 v60, 128, v60
    buffer_load_dwordx4 v60, s[24:27], s64 offen offset:1024 lds
    v_mul_f32 v247, v247, v28
    v_mul_f32 v250, v250, v29
    v_mul_f32 v251, v251, v30
    v_mul_f32 v246, v246, v248
    v_mul_f32 v247, v247, v248
    v_mul_f32 v250, v250, v252
    v_mul_f32 v251, v251, v252
    v_cvt_pk_bf16_f32 v246, v246, v246
    v_cvt_pk_bf16_f32 v247, v247, v247
    v_cvt_pk_bf16_f32 v250, v250, v250
    v_cvt_pk_bf16_f32 v251, v251, v251
    v_and_b32 v138, v246, v104
    v_and_b32 v139, v247, v105
    v_xor_b32 v61, 128, v61
    buffer_load_dwordx4 v61, s[24:27], s64 offen offset:2048 lds
    v_and_b32 v140, v246, v106
    v_and_b32 v141, v247, v107
    v_and_b32 v142, v250, v104
    v_and_b32 v143, v251, v105
    v_and_b32 v144, v250, v106
    v_and_b32 v145, v251, v107
    v_mfma_f32_16x16x32_bf16 v[182:185], v[166:169], v[138:141], 0
    v_mfma_f32_16x16x32_bf16 v[186:189], v[172:175], v[138:141], 0
    v_xor_b32 v62, 128, v62
    buffer_load_dwordx4 v62, s[24:27], s64 offen offset:3072 lds
    v_mfma_f32_16x16x32_bf16 v[190:193], v[168:171], v[142:145], 0
    v_mfma_f32_16x16x32_bf16 v[194:197], v[174:177], v[142:145], 0
    s_add_u32 s83, s82, 16384
    s_nop 1
    v_cvt_pk_bf16_f32 v110, v182, v183
    v_cvt_pk_bf16_f32 v111, v184, v185
    s_add_u32 m0, s58, 147456
    s_add_u32 s64, s64, 524288
    s_cmp_eq_u32 s64, 3670016
    s_cselect_b32 s64, 0, s64
    buffer_load_dwordx4 v59, s[24:27], s64 offen lds
    v_cvt_pk_bf16_f32 v112, v186, v187
    v_cvt_pk_bf16_f32 v113, v188, v189
    v_cvt_pk_bf16_f32 v114, v190, v191
    v_cvt_pk_bf16_f32 v115, v192, v193
    v_cvt_pk_bf16_f32 v116, v194, v195
    v_cvt_pk_bf16_f32 v117, v196, v197
    buffer_store_dwordx4 v[110:113], v4, s[28:31], s82 offen sc1
    buffer_store_dwordx4 v[114:117], v4, s[28:31], s83 offen sc1
    s_cmp_lg_u32 s56, 0
    s_cbranch_scc0 L_nof
L_f:
    s_waitcnt vmcnt(17) lgkmcnt(8)
    v_mfma_f32_16x16x32_bf16 v[182:185], a[0:3], a[200:203], 0
    ds_read_b64_tr_b16 a[224:225], v32 offset:20480
    s_add_u32 s65, s65, 8192
    s_cmp_eq_u32 s65, 57344
    s_cselect_b32 s65, 0, s65
    buffer_load_dwordx4 a[48:51], v79, s[28:31], s65 offen offset:0 sc1
    v_mfma_f32_16x16x32_bf16 v[186:189], a[4:7], a[200:203], 0
    ds_read_b64_tr_b16 a[226:227], v32 offset:22528
    v_lshlrev_b32 v93, 16, v93
    v_mfma_f32_16x16x32_bf16 v[238:241], a[0:3], a[204:207], 0
    ds_read_b64_tr_b16 a[228:229], v34 offset:20480
    buffer_load_dwordx4 a[52:55], v79, s[28:31], s65 offen offset:1024 sc1
    v_mfma_f32_16x16x32_bf16 v[242:245], a[4:7], a[204:207], 0
    ds_read_b64_tr_b16 a[230:231], v34 offset:22528
    s_waitcnt lgkmcnt(8)
    v_mfma_f32_16x16x32_bf16 v[190:193], a[0:3], a[208:211], 0
    ds_read_b64_tr_b16 a[200:201], v35 offset:0
    v_lshlrev_b32 v222, 16, v96
    v_mfma_f32_16x16x32_bf16 v[194:197], a[4:7], a[208:211], 0
    ds_read_b64_tr_b16 a[202:203], v35 offset:2048
    v_and_b32 v223, 0xffff0000, v96
    v_mfma_f32_16x16x32_bf16 v[246:249], a[0:3], a[212:215], 0
    ds_read_b64_tr_b16 a[204:205], v37 offset:0
    buffer_load_dwordx4 a[56:59], v79, s[28:31], s65 offen offset:2048 sc1
    v_mfma_f32_16x16x32_bf16 v[250:253], a[4:7], a[212:215], 0
    ds_read_b64_tr_b16 a[206:207], v37 offset:2048
    s_waitcnt vmcnt(18) lgkmcnt(8)
    v_mfma_f32_16x16x32_bf16 v[182:185], a[8:11], a[216:219], v[182:185]
    ds_read_b64_tr_b16 a[208:209], v36 offset:0
    v_add_f32 v222, v222, v93
    v_mfma_f32_16x16x32_bf16 v[186:189], a[12:15], a[216:219], v[186:189]
    ds_read_b64_tr_b16 a[210:211], v36 offset:2048
    buffer_load_dwordx4 a[60:63], v79, s[28:31], s65 offen offset:3072 sc1
    v_add_f32 v223, v223, v93
    v_mfma_f32_16x16x32_bf16 v[238:241], a[8:11], a[220:223], v[238:241]
    ds_read_b64_tr_b16 a[212:213], v38 offset:0
    s_add_u32 s65, s65, 8192
    v_mfma_f32_16x16x32_bf16 v[242:245], a[12:15], a[220:223], v[242:245]
    ds_read_b64_tr_b16 a[214:215], v38 offset:2048
    s_waitcnt lgkmcnt(8)
    v_mfma_f32_16x16x32_bf16 v[190:193], a[8:11], a[224:227], v[190:193]
    ds_read_b64_tr_b16 a[216:217], v35 offset:4096
    s_cmp_eq_u32 s65, 57344
    v_mfma_f32_16x16x32_bf16 v[194:197], a[12:15], a[224:227], v[194:197]
    ds_read_b64_tr_b16 a[218:219], v35 offset:6144
    s_cselect_b32 s65, 0, s65
    v_lshlrev_b32 v224, 16, v97
    v_mfma_f32_16x16x32_bf16 v[246:249], a[8:11], a[228:231], v[246:249]
    ds_read_b64_tr_b16 a[220:221], v37 offset:4096
    buffer_load_dwordx4 a[64:67], v79, s[28:31], s65 offen offset:0 sc1
    v_mfma_f32_16x16x32_bf16 v[250:253], a[12:15], a[228:231], v[250:253]
    ds_read_b64_tr_b16 a[222:223], v37 offset:6144
    s_waitcnt vmcnt(18) lgkmcnt(8)
    v_mfma_f32_16x16x32_bf16 v[182:185], a[16:19], a[200:203], v[182:185]
    ds_read_b64_tr_b16 a[224:225], v36 offset:4096
    buffer_load_dwordx4 a[68:71], v79, s[28:31], s65 offen offset:1024 sc1
    v_mfma_f32_16x16x32_bf16 v[186:189], a[20:23], a[200:203], v[186:189]
    ds_read_b64_tr_b16 a[226:227], v36 offset:6144
    v_and_b32 v225, 0xffff0000, v97
    v_mfma_f32_16x16x32_bf16 v[238:241], a[16:19], a[204:207], v[238:241]
    ds_read_b64_tr_b16 a[228:229], v38 offset:4096
    v_add_f32 v224, v224, v93
    v_mfma_f32_16x16x32_bf16 v[242:245], a[20:23], a[204:207], v[242:245]
    ds_read_b64_tr_b16 a[230:231], v38 offset:6144
    s_waitcnt lgkmcnt(8)
    v_mfma_f32_16x16x32_bf16 v[190:193], a[16:19], a[208:211], v[190:193]
    ds_read_b64_tr_b16 a[200:201], v35 offset:16384
    buffer_load_dwordx4 a[72:75], v79, s[28:31], s65 offen offset:2048 sc1
    v_mfma_f32_16x16x32_bf16 v[194:197], a[20:23], a[208:211], v[194:197]
    ds_read_b64_tr_b16 a[202:203], v35 offset:18432
    v_add_f32 v225, v225, v93
    v_mfma_f32_16x16x32_bf16 v[246:249], a[16:19], a[212:215], v[246:249]
    ds_read_b64_tr_b16 a[204:205], v37 offset:16384
    v_lshlrev_b32 v226, 16, v98
    v_mfma_f32_16x16x32_bf16 v[250:253], a[20:23], a[212:215], v[250:253]
    ds_read_b64_tr_b16 a[206:207], v37 offset:18432
    s_waitcnt vmcnt(18) lgkmcnt(8)
    v_mfma_f32_16x16x32_bf16 v[182:185], a[24:27], a[216:219], v[182:185]
    ds_read_b64_tr_b16 a[208:209], v36 offset:16384
    buffer_load_dwordx4 a[76:79], v79, s[28:31], s65 offen offset:3072 sc1
    v_mfma_f32_16x16x32_bf16 v[186:189], a[28:31], a[216:219], v[186:189]
    ds_read_b64_tr_b16 a[210:211], v36 offset:18432
    s_add_u32 s65, s65, 8192
    v_and_b32 v227, 0xffff0000, v98
    v_mfma_f32_16x16x32_bf16 v[238:241], a[24:27], a[220:223], v[238:241]
    ds_read_b64_tr_b16 a[212:213], v38 offset:16384
    s_cmp_eq_u32 s65, 57344
    v_mfma_f32_16x16x32_bf16 v[242:245], a[28:31], a[220:223], v[242:245]
    ds_read_b64_tr_b16 a[214:215], v38 offset:18432
    v_add_f32 v226, v226, v93
    s_waitcnt lgkmcnt(8)
    v_mfma_f32_16x16x32_bf16 v[190:193], a[24:27], a[224:227], v[190:193]
    ds_read_b64_tr_b16 a[216:217], v35 offset:20480
    s_cselect_b32 s65, 0, s65
    buffer_load_dwordx4 a[80:83], v79, s[28:31], s65 offen offset:0 sc1
    v_mfma_f32_16x16x32_bf16 v[194:197], a[28:31], a[224:227], v[194:197]
    ds_read_b64_tr_b16 a[218:219], v35 offset:22528
    v_add_f32 v227, v227, v93
    v_mfma_f32_16x16x32_bf16 v[246:249], a[24:27], a[228:231], v[246:249]
    ds_read_b64_tr_b16 a[220:221], v37 offset:20480
    buffer_load_dwordx4 a[84:87], v79, s[28:31], s65 offen offset:1024 sc1
    v_mfma_f32_16x16x32_bf16 v[250:253], a[28:31], a[228:231], v[250:253]
    ds_read_b64_tr_b16 a[222:223], v37 offset:22528
    v_lshlrev_b32 v228, 16, v99
    s_waitcnt vmcnt(19) lgkmcnt(8)
    v_mfma_f32_16x16x32_bf16 v[182:185], a[32:35], a[200:203], v[182:185]
    ds_read_b64_tr_b16 a[224:225], v36 offset:20480
    v_and_b32 v229, 0xffff0000, v99
    v_mfma_f32_16x16x32_bf16 v[186:189], a[36:39], a[200:203], v[186:189]
    ds_read_b64_tr_b16 a[226:227], v36 offset:22528
    buffer_load_dwordx4 a[88:91], v79, s[28:31], s65 offen offset:2048 sc1
    v_add_f32 v228, v228, v93
    v_mfma_f32_16x16x32_bf16 v[238:241], a[32:35], a[204:207], v[238:241]
    ds_read_b64_tr_b16 a[228:229], v38 offset:20480
    v_add_f32 v229, v229, v93
    v_mfma_f32_16x16x32_bf16 v[242:245], a[36:39], a[204:207], v[242:245]
    ds_read_b64_tr_b16 a[230:231], v38 offset:22528
    s_waitcnt lgkmcnt(8)
    v_mfma_f32_16x16x32_bf16 v[190:193], a[32:35], a[208:211], v[190:193]
    s_waitcnt vmcnt(11)
    s_barrier
    s_cmp_lg_u32 s48, 0
    s_cbranch_scc1 L_sig4
    s_atomic_add s36, s[28:29], s69
L_sig4:
    ds_read_b64_tr_b16 a[200:201], v31 offset:32768
    buffer_load_dwordx4 a[92:95], v79, s[28:31], s65 offen offset:3072 sc1
    v_mfma_f32_16x16x32_bf16 v[194:197], a[36:39], a[208:211], v[194:197]
    ds_read_b64_tr_b16 a[202:203], v31 offset:34816
    s_add_u32 s65, s65, 8192
    v_lshlrev_b32 v94, 16, v94
    v_mfma_f32_16x16x32_bf16 v[246:249], a[32:35], a[212:215], v[246:249]
    ds_read_b64_tr_b16 a[204:205], v33 offset:32768
    s_cmp_eq_u32 s65, 57344
    v_mfma_f32_16x16x32_bf16 v[250:253], a[36:39], a[212:215], v[250:253]
    ds_read_b64_tr_b16 a[206:207], v33 offset:34816
    s_waitcnt lgkmcnt(8)
    v_mfma_f32_16x16x32_bf16 v[182:185], a[40:43], a[216:219], v[182:185]
    ds_read_b64_tr_b16 a[208:209], v32 offset:32768
    s_cselect_b32 s65, 0, s65
    v_mfma_f32_16x16x32_bf16 v[186:189], a[44:47], a[216:219], v[186:189]
    ds_read_b64_tr_b16 a[210:211], v32 offset:34816
    buffer_load_dwordx4 a[96:99], v79, s[28:31], s65 offen offset:0 sc1
    v_lshlrev_b32 v230, 16, v100
    v_mfma_f32_16x16x32_bf16 v[238:241], a[40:43], a[220:223], v[238:241]
    ds_read_b64_tr_b16 a[212:213], v34 offset:32768
    v_and_b32 v231, 0xffff0000, v100
    v_mfma_f32_16x16x32_bf16 v[242:245], a[44:47], a[220:223], v[242:245]
    ds_read_b64_tr_b16 a[214:215], v34 offset:34816
    s_waitcnt lgkmcnt(8)
    v_mfma_f32_16x16x32_bf16 v[190:193], a[40:43], a[224:227], v[190:193]
    ds_read_b64_tr_b16 a[216:217], v31 offset:36864
    buffer_load_dwordx4 a[100:103], v79, s[28:31], s65 offen offset:1024 sc1
    v_mfma_f32_16x16x32_bf16 v[194:197], a[44:47], a[224:227], v[194:197]
    ds_read_b64_tr_b16 a[218:219], v31 offset:38912
    v_add_f32 v230, v230, v94
    v_mfma_f32_16x16x32_bf16 v[246:249], a[40:43], a[228:231], v[246:249]
    ds_read_b64_tr_b16 a[220:221], v33 offset:36864
    buffer_load_dwordx4 a[104:107], v79, s[28:31], s65 offen offset:2048 sc1
    v_mfma_f32_16x16x32_bf16 v[250:253], a[44:47], a[228:231], v[250:253]
    ds_read_b64_tr_b16 a[222:223], v33 offset:38912
    v_add_f32 v231, v231, v94
    s_waitcnt vmcnt(13) lgkmcnt(8)
    v_mfma_f32_16x16x32_bf16 v[182:185], a[48:51], a[200:203], v[182:185]
    ds_read_b64_tr_b16 a[224:225], v32 offset:36864
    v_lshlrev_b32 v232, 16, v101
    v_mfma_f32_16x16x32_bf16 v[186:189], a[52:55], a[200:203], v[186:189]
    ds_read_b64_tr_b16 a[226:227], v32 offset:38912
    v_and_b32 v233, 0xffff0000, v101
    v_mfma_f32_16x16x32_bf16 v[238:241], a[48:51], a[204:207], v[238:241]
    ds_read_b64_tr_b16 a[228:229], v34 offset:36864
    buffer_load_dwordx4 a[108:111], v79, s[28:31], s65 offen offset:3072 sc1
    v_mfma_f32_16x16x32_bf16 v[242:245], a[52:55], a[204:207], v[242:245]
    ds_read_b64_tr_b16 a[230:231], v34 offset:38912
    s_waitcnt lgkmcnt(8)
    v_mfma_f32_16x16x32_bf16 v[190:193], a[48:51], a[208:211], v[190:193]
    ds_read_b64_tr_b16 a[200:201], v31 offset:49152
    v_add_f32 v232, v232, v94
    v_mfma_f32_16x16x32_bf16 v[194:197], a[52:55], a[208:211], v[194:197]
    ds_read_b64_tr_b16 a[202:203], v31 offset:51200
    buffer_load_dwordx4 v60, s[24:27], s64 offen offset:1024 lds
    v_add_f32 v233, v233, v94
    v_mfma_f32_16x16x32_bf16 v[246:249], a[48:51], a[212:215], v[246:249]
    ds_read_b64_tr_b16 a[204:205], v33 offset:49152
    v_lshlrev_b32 v234, 16, v102
    v_mfma_f32_16x16x32_bf16 v[250:253], a[52:55], a[212:215], v[250:253]
    ds_read_b64_tr_b16 a[206:207], v33 offset:51200
    s_waitcnt vmcnt(13) lgkmcnt(8)
    v_mfma_f32_16x16x32_bf16 v[182:185], a[56:59], a[216:219], v[182:185]
    ds_read_b64_tr_b16 a[208:209], v32 offset:49152
    buffer_load_dwordx4 v61, s[24:27], s64 offen offset:2048 lds
    v_mfma_f32_16x16x32_bf16 v[186:189], a[60:63], a[216:219], v[186:189]
    ds_read_b64_tr_b16 a[210:211], v32 offset:51200
    v_and_b32 v235, 0xffff0000, v102
    v_mfma_f32_16x16x32_bf16 v[238:241], a[56:59], a[220:223], v[238:241]
    ds_read_b64_tr_b16 a[212:213], v34 offset:49152
    buffer_load_dwordx4 v62, s[24:27], s64 offen offset:3072 lds
    v_mfma_f32_16x16x32_bf16 v[242:245], a[60:63], a[220:223], v[242:245]
    ds_read_b64_tr_b16 a[214:215], v34 offset:51200
    s_waitcnt lgkmcnt(8)
    v_mfma_f32_16x16x32_bf16 v[190:193], a[56:59], a[224:227], v[190:193]
    ds_read_b64_tr_b16 a[216:217], v31 offset:53248
    s_add_u32 m0, s58, 16384
    v_mfma_f32_16x16x32_bf16 v[194:197], a[60:63], a[224:227], v[194:197]
    ds_read_b64_tr_b16 a[218:219], v31 offset:55296
    s_add_u32 s64, s64, 524288
    v_add_f32 v234, v234, v94
    v_mfma_f32_16x16x32_bf16 v[246:249], a[56:59], a[228:231], v[246:249]
    ds_read_b64_tr_b16 a[220:221], v33 offset:53248
    s_cmp_eq_u32 s64, 3670016
    v_mfma_f32_16x16x32_bf16 v[250:253], a[60:63], a[228:231], v[250:253]
    ds_read_b64_tr_b16 a[222:223], v33 offset:55296
    s_cselect_b32 s64, 0, s64
    buffer_load_dwordx4 v59, s[24:27], s64 offen lds
    v_add_f32 v235, v235, v94
    s_waitcnt vmcnt(14) lgkmcnt(8)
    v_mfma_f32_16x16x32_bf16 v[182:185], a[64:67], a[200:203], v[182:185]
    ds_read_b64_tr_b16 a[224:225], v32 offset:53248
    v_lshlrev_b32 v236, 16, v103
    v_mfma_f32_16x16x32_bf16 v[186:189], a[68:71], a[200:203], v[186:189]
    ds_read_b64_tr_b16 a[226:227], v32 offset:55296
    buffer_load_dwordx4 v60, s[24:27], s64 offen offset:1024 lds
    v_and_b32 v237, 0xffff0000, v103
    v_mfma_f32_16x16x32_bf16 v[238:241], a[64:67], a[204:207], v[238:241]
    ds_read_b64_tr_b16 a[228:229], v34 offset:53248
    v_add_f32 v236, v236, v94
    v_mfma_f32_16x16x32_bf16 v[242:245], a[68:71], a[204:207], v[242:245]
    ds_read_b64_tr_b16 a[230:231], v34 offset:55296
    s_waitcnt lgkmcnt(8)
    v_mfma_f32_16x16x32_bf16 v[190:193], a[64:67], a[208:211], v[190:193]
    s_barrier
    ds_read_b64_tr_b16 a[200:201], v35 offset:32768
    buffer_load_dwordx4 v61, s[24:27], s64 offen offset:2048 lds
    v_mfma_f32_16x16x32_bf16 v[194:197], a[68:71], a[208:211], v[194:197]
    ds_read_b64_tr_b16 a[202:203], v35 offset:34816
    v_add_f32 v237, v237, v94
    v_mfma_f32_16x16x32_bf16 v[246:249], a[64:67], a[212:215], v[246:249]
    ds_read_b64_tr_b16 a[204:205], v37 offset:32768
    v_mfma_f32_16x16x32_bf16 v[250:253], a[68:71], a[212:215], v[250:253]
    ds_read_b64_tr_b16 a[206:207], v37 offset:34816
    s_waitcnt vmcnt(14) lgkmcnt(8)
    v_mfma_f32_16x16x32_bf16 v[182:185], a[72:75], a[216:219], v[182:185]
    ds_read_b64_tr_b16 a[208:209], v36 offset:32768
    buffer_load_dwordx4 v62, s[24:27], s64 offen offset:3072 lds
    v_mfma_f32_16x16x32_bf16 v[186:189], a[76:79], a[216:219], v[186:189]
    ds_read_b64_tr_b16 a[210:211], v36 offset:34816
    s_add_u32 m0, s58, 65536
    v_mfma_f32_16x16x32_bf16 v[238:241], a[72:75], a[220:223], v[238:241]
    ds_read_b64_tr_b16 a[212:213], v38 offset:32768
    s_add_u32 s64, s64, 524288
    v_mfma_f32_16x16x32_bf16 v[242:245], a[76:79], a[220:223], v[242:245]
    ds_read_b64_tr_b16 a[214:215], v38 offset:34816
    s_waitcnt lgkmcnt(8)
    v_mfma_f32_16x16x32_bf16 v[190:193], a[72:75], a[224:227], v[190:193]
    ds_read_b64_tr_b16 a[216:217], v35 offset:36864
    s_cmp_eq_u32 s64, 3670016
    v_mfma_f32_16x16x32_bf16 v[194:197], a[76:79], a[224:227], v[194:197]
    ds_read_b64_tr_b16 a[218:219], v35 offset:38912
    s_cselect_b32 s64, 0, s64
    buffer_load_dwordx4 v59, s[24:27], s64 offen lds
    v_mfma_f32_16x16x32_bf16 v[246:249], a[72:75], a[228:231], v[246:249]
    ds_read_b64_tr_b16 a[220:221], v37 offset:36864
    v_mfma_f32_16x16x32_bf16 v[250:253], a[76:79], a[228:231], v[250:253]
    ds_read_b64_tr_b16 a[222:223], v37 offset:38912
    s_waitcnt vmcnt(14) lgkmcnt(8)
    v_mfma_f32_16x16x32_bf16 v[182:185], a[80:83], a[200:203], v[182:185]
    ds_read_b64_tr_b16 a[224:225], v36 offset:36864
    buffer_load_dwordx4 v60, s[24:27], s64 offen offset:1024 lds
    v_mfma_f32_16x16x32_bf16 v[186:189], a[84:87], a[200:203], v[186:189]
    ds_read_b64_tr_b16 a[226:227], v36 offset:38912
    v_mfma_f32_16x16x32_bf16 v[238:241], a[80:83], a[204:207], v[238:241]
    ds_read_b64_tr_b16 a[228:229], v38 offset:36864
    v_mfma_f32_16x16x32_bf16 v[242:245], a[84:87], a[204:207], v[242:245]
    ds_read_b64_tr_b16 a[230:231], v38 offset:38912
    s_waitcnt lgkmcnt(8)
    v_mfma_f32_16x16x32_bf16 v[190:193], a[80:83], a[208:211], v[190:193]
    ds_read_b64_tr_b16 a[200:201], v35 offset:49152
    buffer_load_dwordx4 v61, s[24:27], s64 offen offset:2048 lds
    v_mfma_f32_16x16x32_bf16 v[194:197], a[84:87], a[208:211], v[194:197]
    ds_read_b64_tr_b16 a[202:203], v35 offset:51200
    v_mfma_f32_16x16x32_bf16 v[246:249], a[80:83], a[212:215], v[246:249]
    ds_read_b64_tr_b16 a[204:205], v37 offset:49152
    v_mfma_f32_16x16x32_bf16 v[250:253], a[84:87], a[212:215], v[250:253]
    ds_read_b64_tr_b16 a[206:207], v37 offset:51200
    s_waitcnt vmcnt(14) lgkmcnt(8)
    v_mfma_f32_16x16x32_bf16 v[182:185], a[88:91], a[216:219], v[182:185]
    ds_read_b64_tr_b16 a[208:209], v36 offset:49152
L_pad3:
    s_cbranch_execz L_warm
    buffer_load_dwordx4 v62, s[24:27], s64 offen offset:3072 lds
    v_mfma_f32_16x16x32_bf16 v[186:189], a[92:95], a[216:219], v[186:189]
    ds_read_b64_tr_b16 a[210:211], v36 offset:51200
    s_add_u32 m0, s58, 81920
    v_mfma_f32_16x16x32_bf16 v[238:241], a[88:91], a[220:223], v[238:241]
    ds_read_b64_tr_b16 a[212:213], v38 offset:49152
    s_add_u32 s64, s64, 524288
    v_mfma_f32_16x16x32_bf16 v[242:245], a[92:95], a[220:223], v[242:245]
    ds_read_b64_tr_b16 a[214:215], v38 offset:51200
    s_waitcnt lgkmcnt(8)
    v_mfma_f32_16x16x32_bf16 v[190:193], a[88:91], a[224:227], v[190:193]
    ds_read_b64_tr_b16 a[216:217], v35 offset:53248
    s_cmp_eq_u32 s64, 3670016
    s_cselect_b32 s64, 0, s64
    buffer_load_dwordx4 v59, s[24:27], s64 offen lds
    v_mfma_f32_16x16x32_bf16 v[194:197], a[92:95], a[224:227], v[194:197]
    ds_read_b64_tr_b16 a[218:219], v35 offset:55296
    v_mfma_f32_16x16x32_bf16 v[246:249], a[88:91], a[228:231], v[246:249]
    ds_read_b64_tr_b16 a[220:221], v37 offset:53248
    buffer_load_dwordx4 v60, s[24:27], s64 offen offset:1024 lds
    v_mfma_f32_16x16x32_bf16 v[250:253], a[92:95], a[228:231], v[250:253]
    ds_read_b64_tr_b16 a[222:223], v37 offset:55296
    s_waitcnt vmcnt(15) lgkmcnt(8)
    v_mfma_f32_16x16x32_bf16 v[182:185], a[96:99], a[200:203], v[182:185]
    ds_read_b64_tr_b16 a[224:225], v36 offset:53248
    v_mfma_f32_16x16x32_bf16 v[186:189], a[100:103], a[200:203], v[186:189]
    ds_read_b64_tr_b16 a[226:227], v36 offset:55296
    v_mfma_f32_16x16x32_bf16 v[238:241], a[96:99], a[204:207], v[238:241]
    ds_read_b64_tr_b16 a[228:229], v38 offset:53248
    buffer_load_dwordx4 v61, s[24:27], s64 offen offset:2048 lds
    v_mfma_f32_16x16x32_bf16 v[242:245], a[100:103], a[204:207], v[242:245]
    ds_read_b64_tr_b16 a[230:231], v38 offset:55296
    s_waitcnt lgkmcnt(8)
    v_mfma_f32_16x16x32_bf16 v[190:193], a[96:99], a[208:211], v[190:193]
    ds_read_b64_tr_b16 a[200:201], v31 offset:0
    v_mfma_f32_16x16x32_bf16 v[194:197], a[100:103], a[208:211], v[194:197]
    ds_read_b64_tr_b16 a[202:203], v31 offset:2048
    v_mfma_f32_16x16x32_bf16 v[246:249], a[96:99], a[212:215], v[246:249]
    ds_read_b64_tr_b16 a[204:205], v33 offset:0
    buffer_load_dwordx4 v62, s[24:27], s64 offen offset:3072 lds
    v_mfma_f32_16x16x32_bf16 v[250:253], a[100:103], a[212:215], v[250:253]
    ds_read_b64_tr_b16 a[206:207], v33 offset:2048
    s_waitcnt vmcnt(15) lgkmcnt(8)
    v_mfma_f32_16x16x32_bf16 v[182:185], a[104:107], a[216:219], v[182:185]
    ds_read_b64_tr_b16 a[208:209], v32 offset:0
    s_add_u32 m0, s58, 32768
    v_mfma_f32_16x16x32_bf16 v[186:189], a[108:111], a[216:219], v[186:189]
    ds_read_b64_tr_b16 a[210:211], v32 offset:2048
    s_add_u32 s64, s64, 524288
    v_mfma_f32_16x16x32_bf16 v[238:241], a[104:107], a[220:223], v[238:241]
    ds_read_b64_tr_b16 a[212:213], v34 offset:0
    s_cmp_eq_u32 s64, 3670016
    v_mfma_f32_16x16x32_bf16 v[242:245], a[108:111], a[220:223], v[242:245]
    ds_read_b64_tr_b16 a[214:215], v34 offset:2048
    s_cselect_b32 s64, 0, s64
    buffer_load_dwordx4 v59, s[24:27], s64 offen lds
    s_waitcnt lgkmcnt(8)
    v_mfma_f32_16x16x32_bf16 v[190:193], a[104:107], a[224:227], v[190:193]
    ds_read_b64_tr_b16 a[216:217], v31 offset:4096
    v_mfma_f32_16x16x32_bf16 v[194:197], a[108:111], a[224:227], v[194:197]
    ds_read_b64_tr_b16 a[218:219], v31 offset:6144
    buffer_load_dwordx4 v60, s[24:27], s64 offen offset:1024 lds
    v_mfma_f32_16x16x32_bf16 v[246:249], a[104:107], a[228:231], v[246:249]
    ds_read_b64_tr_b16 a[220:221], v33 offset:4096
    v_mfma_f32_16x16x32_bf16 v[250:253], a[108:111], a[228:231], v[250:253]
    ds_read_b64_tr_b16 a[222:223], v33 offset:6144
    s_waitcnt lgkmcnt(8)
    v_mfma_f32_16x16x32_bf16 v[150:153], a[0:3], a[200:203], 0
    ds_read_b64_tr_b16 a[224:225], v32 offset:4096
    v_mfma_f32_16x16x32_bf16 v[154:157], a[4:7], a[200:203], 0
    ds_read_b64_tr_b16 a[226:227], v32 offset:6144
    buffer_load_dwordx4 v61, s[24:27], s64 offen offset:2048 lds
    v_mfma_f32_16x16x32_bf16 v[166:169], a[0:3], a[204:207], 0
    ds_read_b64_tr_b16 a[228:229], v34 offset:4096
    v_cvt_pk_bf16_f32 v182, v182, v183
    v_mfma_f32_16x16x32_bf16 v[170:173], a[4:7], a[204:207], 0
    ds_read_b64_tr_b16 a[230:231], v34 offset:6144
    v_cvt_pk_bf16_f32 v183, v184, v185
    v_cvt_pk_bf16_f32 v184, v186, v187
    s_waitcnt lgkmcnt(8)
    v_mfma_f32_16x16x32_bf16 v[158:161], a[0:3], a[208:211], 0
    s_waitcnt vmcnt(15)
    s_barrier
    ds_read_b64_tr_b16 a[200:201], v39 offset:0
    buffer_load_dwordx4 v62, s[24:27], s64 offen offset:3072 lds
    v_mfma_f32_16x16x32_bf16 v[162:165], a[4:7], a[208:211], 0
    ds_read_b64_tr_b16 a[202:203], v39 offset:2048
    s_add_u32 m0, s58, 49152
    v_cvt_pk_bf16_f32 v185, v188, v189
    buffer_store_dwordx4 v[182:185], v21, s[28:31], 0 offen offset:0 sc1
    v_cvt_pk_bf16_f32 v190, v190, v191
    v_cvt_pk_bf16_f32 v191, v192, v193
    v_cvt_pk_bf16_f32 v192, v194, v195
    v_mfma_f32_16x16x32_bf16 v[174:177], a[0:3], a[212:215], 0
    ds_read_b64_tr_b16 a[204:205], v41 offset:0
    s_add_u32 s66, s66, 1
    v_mfma_f32_16x16x32_bf16 v[178:181], a[4:7], a[212:215], 0
    ds_read_b64_tr_b16 a[206:207], v41 offset:2048
    v_cvt_pk_bf16_f32 v193, v196, v197
    buffer_store_dwordx4 v[190:193], v21, s[28:31], 0 offen offset:1024 sc1
    v_cvt_pk_bf16_f32 v238, v238, v239
    v_cvt_pk_bf16_f32 v239, v240, v241
    v_cvt_pk_bf16_f32 v240, v242, v243
    s_waitcnt lgkmcnt(8)
    v_mfma_f32_16x16x32_bf16 v[150:153], a[8:11], a[216:219], v[150:153]
    ds_read_b64_tr_b16 a[208:209], v40 offset:0
    s_and_b32 s66, s66, 3
    v_mfma_f32_16x16x32_bf16 v[154:157], a[12:15], a[216:219], v[154:157]
    ds_read_b64_tr_b16 a[210:211], v40 offset:2048
    s_mul_i32 s61, s66, 100352
    buffer_load_dwordx4 v63, s[16:19], s61 offen lds
    v_cvt_pk_bf16_f32 v241, v244, v245
    buffer_store_dwordx4 v[238:241], v21, s[28:31], 0 offen offset:2048 sc1
    v_cvt_pk_bf16_f32 v246, v246, v247
    v_cvt_pk_bf16_f32 v247, v248, v249
    v_cvt_pk_bf16_f32 v248, v250, v251
    v_mfma_f32_16x16x32_bf16 v[166:169], a[8:11], a[220:223], v[166:169]
    ds_read_b64_tr_b16 a[212:213], v42 offset:0
    v_cvt_pk_bf16_f32 v249, v252, v253
    v_mfma_f32_16x16x32_bf16 v[170:173], a[12:15], a[220:223], v[170:173]
    ds_read_b64_tr_b16 a[214:215], v42 offset:2048
    s_waitcnt lgkmcnt(8)
    v_mfma_f32_16x16x32_bf16 v[158:161], a[8:11], a[224:227], v[158:161]
    ds_read_b64_tr_b16 a[216:217], v39 offset:4096
    buffer_load_dwordx4 v64, s[16:19], s61 offen offset:1024 lds
    v_mfma_f32_16x16x32_bf16 v[162:165], a[12:15], a[224:227], v[162:165]
    ds_read_b64_tr_b16 a[218:219], v39 offset:6144
    s_add_u32 s61, s61, 48128
    buffer_store_dwordx4 v[246:249], v21, s[28:31], 0 offen offset:3072 sc1
    v_mfma_f32_16x16x32_bf16 v[174:177], a[8:11], a[228:231], v[174:177]
    ds_read_b64_tr_b16 a[220:221], v41 offset:4096
    v_mfma_f32_16x16x32_bf16 v[178:181], a[12:15], a[228:231], v[178:181]
    ds_read_b64_tr_b16 a[222:223], v41 offset:6144
    s_waitcnt lgkmcnt(8)
    v_mfma_f32_16x16x32_bf16 v[150:153], a[16:19], a[200:203], v[150:153]
    ds_read_b64_tr_b16 a[224:225], v40 offset:4096
    buffer_load_dwordx4 v63, s[16:19], s61 offen offset:2048 lds
    v_mfma_f32_16x16x32_bf16 v[154:157], a[20:23], a[200:203], v[154:157]
    ds_read_b64_tr_b16 a[226:227], v40 offset:6144
    v_mfma_f32_16x16x32_bf16 v[166:169], a[16:19], a[204:207], v[166:169]
    ds_read_b64_tr_b16 a[228:229], v42 offset:4096
    v_mfma_f32_16x16x32_bf16 v[170:173], a[20:23], a[204:207], v[170:173]
    ds_read_b64_tr_b16 a[230:231], v42 offset:6144
    s_waitcnt lgkmcnt(8)
    v_mfma_f32_16x16x32_bf16 v[158:161], a[16:19], a[208:211], v[158:161]
    s_load_dword s14, s[28:29], s39
    ds_read_b64_tr_b16 a[200:201], v39 offset:16384
    buffer_load_dwordx4 v64, s[16:19], s61 offen offset:3072 lds
    v_mfma_f32_16x16x32_bf16 v[162:165], a[20:23], a[208:211], v[162:165]
    ds_read_b64_tr_b16 a[202:203], v39 offset:18432
    s_add_u32 m0, s58, 98304
    v_mfma_f32_16x16x32_bf16 v[174:177], a[16:19], a[212:215], v[174:177]
    ds_read_b64_tr_b16 a[204:205], v41 offset:16384
    s_add_u32 s66, s66, 1
    v_mfma_f32_16x16x32_bf16 v[178:181], a[20:23], a[212:215], v[178:181]
    ds_read_b64_tr_b16 a[206:207], v41 offset:18432
    s_waitcnt lgkmcnt(8)
    v_mfma_f32_16x16x32_bf16 v[150:153], a[24:27], a[216:219], v[150:153]
    ds_read_b64_tr_b16 a[208:209], v40 offset:16384
    s_and_b32 s66, s66, 3
    s_mul_i32 s61, s66, 100352
    buffer_load_dwordx4 v63, s[16:19], s61 offen lds
    v_mfma_f32_16x16x32_bf16 v[154:157], a[28:31], a[216:219], v[154:157]
    ds_read_b64_tr_b16 a[210:211], v40 offset:18432
    v_mfma_f32_16x16x32_bf16 v[166:169], a[24:27], a[220:223], v[166:169]
    ds_read_b64_tr_b16 a[212:213], v42 offset:16384
    buffer_load_dwordx4 v64, s[16:19], s61 offen offset:1024 lds
    v_mfma_f32_16x16x32_bf16 v[170:173], a[28:31], a[220:223], v[170:173]
    ds_read_b64_tr_b16 a[214:215], v42 offset:18432
    s_waitcnt lgkmcnt(8)
    v_mfma_f32_16x16x32_bf16 v[158:161], a[24:27], a[224:227], v[158:161]
    ds_read_b64_tr_b16 a[216:217], v39 offset:20480
    s_add_u32 s61, s61, 48128
    v_mfma_f32_16x16x32_bf16 v[162:165], a[28:31], a[224:227], v[162:165]
    ds_read_b64_tr_b16 a[218:219], v39 offset:22528
    v_mfma_f32_16x16x32_bf16 v[174:177], a[24:27], a[228:231], v[174:177]
    ds_read_b64_tr_b16 a[220:221], v41 offset:20480
    buffer_load_dwordx4 v63, s[16:19], s61 offen offset:2048 lds
    v_mfma_f32_16x16x32_bf16 v[178:181], a[28:31], a[228:231], v[178:181]
    ds_read_b64_tr_b16 a[222:223], v41 offset:22528
    s_waitcnt lgkmcnt(8)
    v_mfma_f32_16x16x32_bf16 v[150:153], a[32:35], a[200:203], v[150:153]
    ds_read_b64_tr_b16 a[224:225], v40 offset:20480
    v_mfma_f32_16x16x32_bf16 v[154:157], a[36:39], a[200:203], v[154:157]
    ds_read_b64_tr_b16 a[226:227], v40 offset:22528
    v_mfma_f32_16x16x32_bf16 v[166:169], a[32:35], a[204:207], v[166:169]
    ds_read_b64_tr_b16 a[228:229], v42 offset:20480
    buffer_load_dwordx4 v64, s[16:19], s61 offen offset:3072 lds
    v_mfma_f32_16x16x32_bf16 v[170:173], a[36:39], a[204:207], v[170:173]
    ds_read_b64_tr_b16 a[230:231], v42 offset:22528
    s_waitcnt lgkmcnt(8)
    v_mfma_f32_16x16x32_bf16 v[158:161], a[32:35], a[208:211], v[158:161]
    s_waitcnt vmcnt(20)
    s_barrier
    ds_read_b64_tr_b16 a[200:201], v31 offset:16384
    s_add_u32 m0, s58, 114688
    v_mfma_f32_16x16x32_bf16 v[162:165], a[36:39], a[208:211], v[162:165]
    ds_read_b64_tr_b16 a[202:203], v31 offset:18432
    s_add_u32 s66, s66, 1
    v_mfma_f32_16x16x32_bf16 v[174:177], a[32:35], a[212:215], v[174:177]
    ds_read_b64_tr_b16 a[204:205], v33 offset:16384
    s_and_b32 s66, s66, 3
    v_mfma_f32_16x16x32_bf16 v[178:181], a[36:39], a[212:215], v[178:181]
    ds_read_b64_tr_b16 a[206:207], v33 offset:18432
    s_mul_i32 s61, s66, 100352
    buffer_load_dwordx4 v63, s[16:19], s61 offen lds
    s_waitcnt lgkmcnt(8)
    v_mfma_f32_16x16x32_bf16 v[150:153], a[40:43], a[216:219], v[150:153]
    ds_read_b64_tr_b16 a[208:209], v32 offset:16384
    v_mfma_f32_16x16x32_bf16 v[154:157], a[44:47], a[216:219], v[154:157]
    ds_read_b64_tr_b16 a[210:211], v32 offset:18432
    buffer_load_dwordx4 v64, s[16:19], s61 offen offset:1024 lds
    v_mfma_f32_16x16x32_bf16 v[166:169], a[40:43], a[220:223], v[166:169]
    ds_read_b64_tr_b16 a[212:213], v34 offset:16384
    s_add_u32 s61, s61, 48128
    v_mfma_f32_16x16x32_bf16 v[170:173], a[44:47], a[220:223], v[170:173]
    ds_read_b64_tr_b16 a[214:215], v34 offset:18432
    s_waitcnt lgkmcnt(8)
    v_mfma_f32_16x16x32_bf16 v[158:161], a[40:43], a[224:227], v[158:161]
    ds_read_b64_tr_b16 a[216:217], v31 offset:20480
    v_mfma_f32_16x16x32_bf16 v[162:165], a[44:47], a[224:227], v[162:165]
    ds_read_b64_tr_b16 a[218:219], v31 offset:22528
    buffer_load_dwordx4 v63, s[16:19], s61 offen offset:2048 lds
    v_mfma_f32_16x16x32_bf16 v[174:177], a[40:43], a[228:231], v[174:177]
    ds_read_b64_tr_b16 a[220:221], v33 offset:20480
    v_mfma_f32_16x16x32_bf16 v[178:181], a[44:47], a[228:231], v[178:181]
    ds_read_b64_tr_b16 a[222:223], v33 offset:22528
    s_waitcnt lgkmcnt(8)
    v_mfma_f32_16x16x32_bf16 v[150:153], a[48:51], a[200:203], v[150:153]
    s_waitcnt lgkmcnt(0)
    s_cmp_ge_u32 s14, 8
    s_cbranch_scc0 L_pollin6
L_pollok6:
    ds_read_b64_tr_b16 a[224:225], v32 offset:20480
    buffer_load_dwordx4 v64, s[16:19], s61 offen offset:3072 lds
    v_mfma_f32_16x16x32_bf16 v[154:157], a[52:55], a[200:203], v[154:157]
    ds_read_b64_tr_b16 a[226:227], v32 offset:22528
    s_add_u32 m0, s58, 0
    v_mfma_f32_16x16x32_bf16 v[166:169], a[48:51], a[204:207], v[166:169]
    ds_read_b64_tr_b16 a[228:229], v34 offset:20480
    s_add_u32 s51, s51, 1
    v_mfma_f32_16x16x32_bf16 v[170:173], a[52:55], a[204:207], v[170:173]
    ds_read_b64_tr_b16 a[230:231], v34 offset:22528
    v_mfma_f32_16x16x32_bf16 v[158:161], a[48:51], a[208:211], v[158:161]
    s_waitcnt vmcnt(10)
    s_atomic_add s36, s[28:29], s55
    ds_read_b64_tr_b16 a[200:201], v35 offset:0
    s_and_b32 s51, s51, 3
    v_mfma_f32_16x16x32_bf16 v[162:165], a[52:55], a[208:211], v[162:165]
    ds_read_b64_tr_b16 a[202:203], v35 offset:2048
    s_lshl_b32 s61, s51, 12
    buffer_load_dwordx4 v65, s[28:31], s61 offen sc1 lds
    v_mfma_f32_16x16x32_bf16 v[174:177], a[48:51], a[212:215], v[174:177]
    ds_read_b64_tr_b16 a[204:205], v37 offset:0
    v_mfma_f32_16x16x32_bf16 v[178:181], a[52:55], a[212:215], v[178:181]
    ds_read_b64_tr_b16 a[206:207], v37 offset:2048
    v_mfma_f32_16x16x32_bf16 v[150:153], a[56:59], a[216:219], v[150:153]
    ds_read_b64_tr_b16 a[208:209], v36 offset:0
    buffer_load_dwordx4 v66, s[28:31], s61 offen offset:1024 sc1 lds
    v_mfma_f32_16x16x32_bf16 v[154:157], a[60:63], a[216:219], v[154:157]
    ds_read_b64_tr_b16 a[210:211], v36 offset:2048
    v_mfma_f32_16x16x32_bf16 v[166:169], a[56:59], a[220:223], v[166:169]
    ds_read_b64_tr_b16 a[212:213], v38 offset:0
    buffer_load_dwordx4 v65, s[28:31], s61 offen offset:2048 sc1 lds
    v_mfma_f32_16x16x32_bf16 v[170:173], a[60:63], a[220:223], v[170:173]
    ds_read_b64_tr_b16 a[214:215], v38 offset:2048
    s_waitcnt lgkmcnt(8)
    v_mfma_f32_16x16x32_bf16 v[158:161], a[56:59], a[224:227], v[158:161]
    ds_read_b64_tr_b16 a[216:217], v35 offset:4096
    v_mfma_f32_16x16x32_bf16 v[162:165], a[60:63], a[224:227], v[162:165]
    ds_read_b64_tr_b16 a[218:219], v35 offset:6144
    buffer_load_dwordx4 v66, s[28:31], s61 offen offset:3072 sc1 lds
    v_mfma_f32_16x16x32_bf16 v[174:177], a[56:59], a[228:231], v[174:177]
    ds_read_b64_tr_b16 a[220:221], v37 offset:4096
    s_add_u32 m0, s58, 131072
    v_mfma_f32_16x16x32_bf16 v[178:181], a[60:63], a[228:231], v[178:181]
    ds_read_b64_tr_b16 a[222:223], v37 offset:6144
    s_waitcnt lgkmcnt(8)
    v_mfma_f32_16x16x32_bf16 v[150:153], a[64:67], a[200:203], v[150:153]
    ds_read_b64_tr_b16 a[224:225], v36 offset:4096
    s_add_u32 s51, s51, 1
    v_mfma_f32_16x16x32_bf16 v[154:157], a[68:71], a[200:203], v[154:157]
    ds_read_b64_tr_b16 a[226:227], v36 offset:6144
    s_and_b32 s51, s51, 3
    s_lshl_b32 s61, s51, 12
    buffer_load_dwordx4 v65, s[28:31], s61 offen sc1 lds
    v_mfma_f32_16x16x32_bf16 v[166:169], a[64:67], a[204:207], v[166:169]
    ds_read_b64_tr_b16 a[228:229], v38 offset:4096
    v_mfma_f32_16x16x32_bf16 v[170:173], a[68:71], a[204:207], v[170:173]
    ds_read_b64_tr_b16 a[230:231], v38 offset:6144
    s_waitcnt lgkmcnt(8)
    v_mfma_f32_16x16x32_bf16 v[158:161], a[64:67], a[208:211], v[158:161]
    s_barrier
    ds_read_b64_tr_b16 a[200:201], v35 offset:16384
    buffer_load_dwordx4 v66, s[28:31], s61 offen offset:1024 sc1 lds
    v_mfma_f32_16x16x32_bf16 v[162:165], a[68:71], a[208:211], v[162:165]
    ds_read_b64_tr_b16 a[202:203], v35 offset:18432
    v_mfma_f32_16x16x32_bf16 v[174:177], a[64:67], a[212:215], v[174:177]
    ds_read_b64_tr_b16 a[204:205], v37 offset:16384
    buffer_load_dwordx4 v65, s[28:31], s61 offen offset:2048 sc1 lds
    v_mfma_f32_16x16x32_bf16 v[178:181], a[68:71], a[212:215], v[178:181]
    ds_read_b64_tr_b16 a[206:207], v37 offset:18432
    s_waitcnt lgkmcnt(8)
    v_mfma_f32_16x16x32_bf16 v[150:153], a[72:75], a[216:219], v[150:153]
    ds_read_b64_tr_b16 a[208:209], v36 offset:16384
    v_mfma_f32_16x16x32_bf16 v[154:157], a[76:79], a[216:219], v[154:157]
    ds_read_b64_tr_b16 a[210:211], v36 offset:18432
    buffer_load_dwordx4 v66, s[28:31], s61 offen offset:3072 sc1 lds
    v_mfma_f32_16x16x32_bf16 v[166:169], a[72:75], a[220:223], v[166:169]
    ds_read_b64_tr_b16 a[212:213], v38 offset:16384
    s_add_u32 m0, s58, 147456
    v_mfma_f32_16x16x32_bf16 v[170:173], a[76:79], a[220:223], v[170:173]
    ds_read_b64_tr_b16 a[214:215], v38 offset:18432
    s_waitcnt lgkmcnt(8)
    v_mfma_f32_16x16x32_bf16 v[158:161], a[72:75], a[224:227], v[158:161]
    ds_read_b64_tr_b16 a[216:217], v35 offset:20480
    s_add_u32 s51, s51, 1
    v_mfma_f32_16x16x32_bf16 v[162:165], a[76:79], a[224:227], v[162:165]
    ds_read_b64_tr_b16 a[218:219], v35 offset:22528
    s_and_b32 s51, s51, 3
    s_lshl_b32 s61, s51, 12
    buffer_load_dwordx4 v65, s[28:31], s61 offen sc1 lds
    v_mfma_f32_16x16x32_bf16 v[174:177], a[72:75], a[228:231], v[174:177]
    ds_read_b64_tr_b16 a[220:221], v37 offset:20480
    v_mfma_f32_16x16x32_bf16 v[178:181], a[76:79], a[228:231], v[178:181]
    ds_read_b64_tr_b16 a[222:223], v37 offset:22528
    s_waitcnt lgkmcnt(8)
    v_mfma_f32_16x16x32_bf16 v[150:153], a[80:83], a[200:203], v[150:153]
    ds_read_b64_tr_b16 a[224:225], v36 offset:20480
    buffer_load_dwordx4 v66, s[28:31], s61 offen offset:1024 sc1 lds
    v_mfma_f32_16x16x32_bf16 v[154:157], a[84:87], a[200:203], v[154:157]
    ds_read_b64_tr_b16 a[226:227], v36 offset:22528
    v_mfma_f32_16x16x32_bf16 v[166:169], a[80:83], a[204:207], v[166:169]
    ds_read_b64_tr_b16 a[228:229], v38 offset:20480
    buffer_load_dwordx4 v65, s[28:31], s61 offen offset:2048 sc1 lds
    v_mfma_f32_16x16x32_bf16 v[170:173], a[84:87], a[204:207], v[170:173]
    ds_read_b64_tr_b16 a[230:231], v38 offset:22528
    s_waitcnt lgkmcnt(8)
    v_mfma_f32_16x16x32_bf16 v[158:161], a[80:83], a[208:211], v[158:161]
    s_barrier
    ds_read_b64_tr_b16 a[200:201], v31 offset:32768
    buffer_load_dwordx4 v66, s[28:31], s61 offen offset:3072 sc1 lds
    v_mfma_f32_16x16x32_bf16 v[162:165], a[84:87], a[208:211], v[162:165]
    ds_read_b64_tr_b16 a[202:203], v31 offset:34816
    s_add_u32 m0, s58, 16384
    v_mfma_f32_16x16x32_bf16 v[174:177], a[80:83], a[212:215], v[174:177]
    ds_read_b64_tr_b16 a[204:205], v33 offset:32768
    s_add_u32 s66, s66, 1
    v_mfma_f32_16x16x32_bf16 v[178:181], a[84:87], a[212:215], v[178:181]
    ds_read_b64_tr_b16 a[206:207], v33 offset:34816
    s_waitcnt lgkmcnt(8)
    v_mfma_f32_16x16x32_bf16 v[150:153], a[88:91], a[216:219], v[150:153]
    ds_read_b64_tr_b16 a[208:209], v32 offset:32768
    s_and_b32 s66, s66, 3
    v_mfma_f32_16x16x32_bf16 v[154:157], a[92:95], a[216:219], v[154:157]
    ds_read_b64_tr_b16 a[210:211], v32 offset:34816
    s_mul_i32 s61, s66, 100352
    buffer_load_dwordx4 v63, s[16:19], s61 offen lds
    v_mfma_f32_16x16x32_bf16 v[166:169], a[88:91], a[220:223], v[166:169]
    ds_read_b64_tr_b16 a[212:213], v34 offset:32768
    v_mfma_f32_16x16x32_bf16 v[170:173], a[92:95], a[220:223], v[170:173]
    ds_read_b64_tr_b16 a[214:215], v34 offset:34816
    s_waitcnt lgkmcnt(8)
    v_mfma_f32_16x16x32_bf16 v[158:161], a[88:91], a[224:227], v[158:161]
    ds_read_b64_tr_b16 a[216:217], v31 offset:36864
    buffer_load_dwordx4 v64, s[16:19], s61 offen offset:1024 lds
    v_mfma_f32_16x16x32_bf16 v[162:165], a[92:95], a[224:227], v[162:165]
    ds_read_b64_tr_b16 a[218:219], v31 offset:38912
    s_add_u32 s61, s61, 48128
    v_mfma_f32_16x16x32_bf16 v[174:177], a[88:91], a[228:231], v[174:177]
    ds_read_b64_tr_b16 a[220:221], v33 offset:36864
    buffer_load_dwordx4 v63, s[16:19], s61 offen offset:2048 lds
    v_mfma_f32_16x16x32_bf16 v[178:181], a[92:95], a[228:231], v[178:181]
    ds_read_b64_tr_b16 a[222:223], v33 offset:38912
    s_waitcnt lgkmcnt(8)
    v_mfma_f32_16x16x32_bf16 v[150:153], a[96:99], a[200:203], v[150:153]
    ds_read_b64_tr_b16 a[224:225], v32 offset:36864
    v_mfma_f32_16x16x32_bf16 v[154:157], a[100:103], a[200:203], v[154:157]
    ds_read_b64_tr_b16 a[226:227], v32 offset:38912
    buffer_load_dwordx4 v64, s[16:19], s61 offen offset:3072 lds
    v_mfma_f32_16x16x32_bf16 v[166:169], a[96:99], a[204:207], v[166:169]
    ds_read_b64_tr_b16 a[228:229], v34 offset:36864
    s_add_u32 m0, s58, 65536
    v_mfma_f32_16x16x32_bf16 v[170:173], a[100:103], a[204:207], v[170:173]
    ds_read_b64_tr_b16 a[230:231], v34 offset:38912
    s_waitcnt lgkmcnt(8)
    v_mfma_f32_16x16x32_bf16 v[158:161], a[96:99], a[208:211], v[158:161]
    s_waitcnt vmcnt(12)
    s_barrier
    s_xor_b32 s55, s55, 1024
    s_load_dword s14, s[28:29], s55
    ds_read_b64_tr_b16 v[198:199], v43 offset:49152
    ds_read_b64_tr_b16 v[200:201], v43 offset:53248
    s_add_u32 s51, s51, 1
    s_and_b32 s51, s51, 3
    s_lshl_b32 s61, s51, 12
    buffer_load_dwordx4 v65, s[28:31], s61 offen sc1 lds
    v_mfma_f32_16x16x32_bf16 v[162:165], a[100:103], a[208:211], v[162:165]
    ds_read_b64_tr_b16 v[202:203], v44 offset:49152
    v_mfma_f32_16x16x32_bf16 v[174:177], a[96:99], a[212:215], v[174:177]
    ds_read_b64_tr_b16 v[204:205], v44 offset:53248
    buffer_load_dwordx4 v66, s[28:31], s61 offen offset:1024 sc1 lds
    v_mfma_f32_16x16x32_bf16 v[178:181], a[100:103], a[212:215], v[178:181]
    ds_read_b128 a[200:203], v47 offset:0
    s_waitcnt lgkmcnt(9)
    v_mfma_f32_16x16x32_bf16 v[150:153], a[104:107], a[216:219], v[150:153]
    ds_read_b128 a[204:207], v48 offset:0
    v_mfma_f32_16x16x32_bf16 v[154:157], a[108:111], a[216:219], v[154:157]
    ds_read_b128 a[208:211], v47 offset:1024
    buffer_load_dwordx4 v65, s[28:31], s61 offen offset:2048 sc1 lds
    v_mfma_f32_16x16x32_bf16 v[166:169], a[104:107], a[220:223], v[166:169]
    ds_read_b128 a[212:215], v48 offset:1024
    v_mfma_f32_16x16x32_bf16 v[170:173], a[108:111], a[220:223], v[170:173]
    s_waitcnt lgkmcnt(8)
    v_mfma_f32_16x16x32_bf16 v[158:161], a[104:107], a[224:227], v[158:161]
    ds_read_b64_tr_b16 v[206:207], v43 offset:51200
    ds_read_b64_tr_b16 v[208:209], v43 offset:55296
    v_mfma_f32_16x16x32_bf16 v[162:165], a[108:111], a[224:227], v[162:165]
    ds_read_b64_tr_b16 v[210:211], v44 offset:51200
    buffer_load_dwordx4 v66, s[28:31], s61 offen offset:3072 sc1 lds
    v_mfma_f32_16x16x32_bf16 v[174:177], a[104:107], a[228:231], v[174:177]
    ds_read_b64_tr_b16 v[212:213], v44 offset:55296
    v_mfma_f32_16x16x32_bf16 v[178:181], a[108:111], a[228:231], v[178:181]
    ds_read_b128 a[216:219], v47 offset:2048
    s_waitcnt lgkmcnt(7)
    v_mfma_f32_16x16x32_bf16 v[150:153], v[198:201], a[200:203], v[150:153]
    ds_read_b128 a[220:223], v48 offset:2048
    v_mfma_f32_16x16x32_bf16 v[154:157], v[202:205], a[200:203], v[154:157]
    ds_read_b128 a[224:227], v47 offset:3072
    v_mfma_f32_16x16x32_bf16 v[166:169], v[198:201], a[204:207], v[166:169]
    ds_read_b128 a[228:231], v48 offset:3072
    v_mfma_f32_16x16x32_bf16 v[170:173], v[202:205], a[204:207], v[170:173]
    s_waitcnt lgkmcnt(8)
    v_mfma_f32_16x16x32_bf16 v[158:161], v[198:201], a[208:211], v[158:161]
    s_waitcnt vmcnt(12)
    s_barrier
    ds_read_b64_tr_b16 v[214:215], v45 offset:32768
    ds_read_b64_tr_b16 v[216:217], v45 offset:36864
    v_mfma_f32_16x16x32_bf16 v[162:165], v[202:205], a[208:211], v[162:165]
    ds_read_b64_tr_b16 v[218:219], v46 offset:32768
    v_mfma_f32_16x16x32_bf16 v[174:177], v[198:201], a[212:215], v[174:177]
    ds_read_b64_tr_b16 v[220:221], v46 offset:36864
    v_mfma_f32_16x16x32_bf16 v[178:181], v[202:205], a[212:215], v[178:181]
    ds_read_b128 a[200:203], v51 offset:0
    s_waitcnt lgkmcnt(7)
    v_mfma_f32_16x16x32_bf16 v[150:153], v[206:209], a[216:219], v[150:153]
    ds_read_b128 a[204:207], v52 offset:0
    v_mfma_f32_16x16x32_bf16 v[154:157], v[210:213], a[216:219], v[154:157]
    ds_read_b128 a[208:211], v51 offset:1024
    v_mfma_f32_16x16x32_bf16 v[166:169], v[206:209], a[220:223], v[166:169]
    ds_read_b128 a[212:215], v52 offset:1024
    v_mfma_f32_16x16x32_bf16 v[170:173], v[210:213], a[220:223], v[170:173]
    s_waitcnt lgkmcnt(8)
    v_mfma_f32_16x16x32_bf16 v[158:161], v[206:209], a[224:227], v[158:161]
    s_waitcnt lgkmcnt(0)
    s_cmp_ge_u32 s14, 1
    s_cbranch_scc0 L_pollin7
L_pollok7:
    v_xor_b32 v21, 131072, v21
    ds_read_b64_tr_b16 v[198:199], v45 offset:34816
    ds_read_b64_tr_b16 v[200:201], v45 offset:38912
    buffer_load_dwordx4 v[246:249], v21, s[28:31], 0 offen offset:2048 sc1
    v_mfma_f32_16x16x32_bf16 v[162:165], v[210:213], a[224:227], v[162:165]
    ds_read_b64_tr_b16 v[202:203], v46 offset:34816
    buffer_load_dwordx4 v[250:253], v21, s[28:31], 0 offen offset:3072 sc1
    v_mfma_f32_16x16x32_bf16 v[174:177], v[206:209], a[228:231], v[174:177]
    ds_read_b64_tr_b16 v[204:205], v46 offset:38912
    v_mfma_f32_16x16x32_bf16 v[178:181], v[210:213], a[228:231], v[178:181]
    ds_read_b128 a[216:219], v51 offset:2048
    v_mfma_f32_16x16x32_bf16 v[150:153], v[214:217], a[200:203], v[150:153]
    ds_read_b128 a[220:223], v52 offset:2048
    buffer_load_dwordx4 v[238:241], v21, s[28:31], 0 offen offset:0 sc1
    v_mfma_f32_16x16x32_bf16 v[154:157], v[218:221], a[200:203], v[154:157]
    ds_read_b128 a[224:227], v51 offset:3072
    buffer_load_dwordx4 v[242:245], v21, s[28:31], 0 offen offset:1024 sc1
    v_mfma_f32_16x16x32_bf16 v[166:169], v[214:217], a[204:207], v[166:169]
    ds_read_b128 a[228:231], v52 offset:3072
    v_mfma_f32_16x16x32_bf16 v[170:173], v[218:221], a[204:207], v[170:173]
    v_mfma_f32_16x16x32_bf16 v[158:161], v[214:217], a[208:211], v[158:161]
    s_waitcnt vmcnt(12)
    s_barrier
    ds_read_b64_tr_b16 v[206:207], v45 offset:49152
    ds_read_b64_tr_b16 v[208:209], v45 offset:53248
    v_mfma_f32_16x16x32_bf16 v[162:165], v[218:221], a[208:211], v[162:165]
    ds_read_b64_tr_b16 v[210:211], v46 offset:49152
    v_mfma_f32_16x16x32_bf16 v[174:177], v[214:217], a[212:215], v[174:177]
    ds_read_b64_tr_b16 v[212:213], v46 offset:53248
    v_mfma_f32_16x16x32_bf16 v[178:181], v[218:221], a[212:215], v[178:181]
    ds_read_b128 a[200:203], v51 offset:16384
    s_waitcnt lgkmcnt(7)
    v_mfma_f32_16x16x32_bf16 v[150:153], v[198:201], a[216:219], v[150:153]
    ds_read_b128 a[204:207], v52 offset:16384
    v_mfma_f32_16x16x32_bf16 v[154:157], v[202:205], a[216:219], v[154:157]
    ds_read_b128 a[208:211], v51 offset:17408
    v_mfma_f32_16x16x32_bf16 v[166:169], v[198:201], a[220:223], v[166:169]
    ds_read_b128 a[212:215], v52 offset:17408
    v_mfma_f32_16x16x32_bf16 v[170:173], v[202:205], a[220:223], v[170:173]
    s_waitcnt lgkmcnt(8)
    v_mfma_f32_16x16x32_bf16 v[158:161], v[198:201], a[224:227], v[158:161]
    ds_read_b64_tr_b16 v[214:215], v45 offset:51200
    ds_read_b64_tr_b16 v[216:217], v45 offset:55296
    v_mfma_f32_16x16x32_bf16 v[162:165], v[202:205], a[224:227], v[162:165]
    ds_read_b64_tr_b16 v[218:219], v46 offset:51200
    v_mfma_f32_16x16x32_bf16 v[174:177], v[198:201], a[228:231], v[174:177]
    ds_read_b64_tr_b16 v[220:221], v46 offset:55296
    v_mfma_f32_16x16x32_bf16 v[178:181], v[202:205], a[228:231], v[178:181]
    ds_read_b128 a[216:219], v51 offset:18432
    s_waitcnt lgkmcnt(7)
    v_mfma_f32_16x16x32_bf16 v[150:153], v[206:209], a[200:203], v[150:153]
    ds_read_b128 a[220:223], v52 offset:18432
    v_mfma_f32_16x16x32_bf16 v[154:157], v[210:213], a[200:203], v[154:157]
    ds_read_b128 a[224:227], v51 offset:19456
    v_mfma_f32_16x16x32_bf16 v[166:169], v[206:209], a[204:207], v[166:169]
    ds_read_b128 a[228:231], v52 offset:19456
    v_mfma_f32_16x16x32_bf16 v[170:173], v[210:213], a[204:207], v[170:173]
    s_waitcnt lgkmcnt(8)
    v_mfma_f32_16x16x32_bf16 v[158:161], v[206:209], a[208:211], v[158:161]
    s_waitcnt vmcnt(4)
    s_barrier
    ds_read_b64_tr_b16 v[198:199], v43 offset:16384
    ds_read_b64_tr_b16 v[200:201], v43 offset:20480
    v_mfma_f32_16x16x32_bf16 v[162:165], v[210:213], a[208:211], v[162:165]
    ds_read_b64_tr_b16 v[202:203], v44 offset:16384
    v_mfma_f32_16x16x32_bf16 v[174:177], v[206:209], a[212:215], v[174:177]
    ds_read_b64_tr_b16 v[204:205], v44 offset:20480
    v_mfma_f32_16x16x32_bf16 v[178:181], v[210:213], a[212:215], v[178:181]
    ds_read_b128 a[200:203], v50 offset:0
    s_waitcnt lgkmcnt(7)
    v_mfma_f32_16x16x32_bf16 v[150:153], v[214:217], a[216:219], v[150:153]
    ds_read_b128 a[204:207], v50 offset:1024
    ds_read_b64_tr_b16 v[206:207], v43 offset:18432
    v_mfma_f32_16x16x32_bf16 v[154:157], v[218:221], a[216:219], v[154:157]
    ds_read_b64_tr_b16 v[208:209], v43 offset:22528
    ds_read_b64_tr_b16 v[210:211], v44 offset:18432
    v_mfma_f32_16x16x32_bf16 v[166:169], v[214:217], a[220:223], v[166:169]
    ds_read_b64_tr_b16 v[212:213], v44 offset:22528
    v_mfma_f32_16x16x32_bf16 v[170:173], v[218:221], a[220:223], v[170:173]
    ds_read_b128 a[208:211], v50 offset:2048
    s_waitcnt lgkmcnt(11)
    v_mfma_f32_16x16x32_bf16 v[158:161], v[214:217], a[224:227], v[158:161]
    ds_read_b128 a[212:215], v50 offset:3072
    v_mfma_f32_16x16x32_bf16 v[162:165], v[218:221], a[224:227], v[162:165]
    v_mfma_f32_16x16x32_bf16 v[174:177], v[214:217], a[228:231], v[174:177]
    v_mfma_f32_16x16x32_bf16 v[178:181], v[218:221], a[228:231], v[178:181]
    s_waitcnt lgkmcnt(6)
    v_mfma_f32_16x16x32_bf16 v[166:169], v[198:201], a[200:203], v[166:169]
    ds_read_b128 a[224:227], v49 offset:0
    v_mfma_f32_16x16x32_bf16 v[170:173], v[202:205], a[200:203], v[170:173]
    v_mfma_f32_16x16x32_bf16 v[174:177], v[198:201], a[204:207], v[174:177]
    ds_read_b128 a[228:231], v49 offset:1024
    v_mfma_f32_16x16x32_bf16 v[178:181], v[202:205], a[204:207], v[178:181]
    s_waitcnt lgkmcnt(2)
    v_mfma_f32_16x16x32_bf16 v[166:169], v[206:209], a[208:211], v[166:169]
    ds_read_b128 a[200:203], v49 offset:2048
    v_mfma_f32_16x16x32_bf16 v[170:173], v[210:213], a[208:211], v[170:173]
    v_mfma_f32_16x16x32_bf16 v[174:177], v[206:209], a[212:215], v[174:177]
    ds_read_b128 a[204:207], v49 offset:3072
L_pad4:
    s_cbranch_execz L_warm
    v_mfma_f32_16x16x32_bf16 v[178:181], v[210:213], a[212:215], v[178:181]
    s_waitcnt vmcnt(3)
    v_mfma_f32_16x16x32_bf16 v[166:169], a[250:253], v[246:249], v[166:169]
    v_mfma_f32_16x16x32_bf16 v[170:173], a[248:251], v[246:249], v[170:173]
    s_waitcnt vmcnt(2)
    v_mfma_f32_16x16x32_bf16 v[174:177], a[250:253], v[250:253], v[174:177]
    v_mfma_f32_16x16x32_bf16 v[178:181], a[248:251], v[250:253], v[178:181]
    s_waitcnt lgkmcnt(2)
    v_mfma_f32_16x16x32_bf16 v[150:153], v[198:201], a[224:227], v[150:153]
    v_mfma_f32_16x16x32_bf16 v[154:157], v[202:205], a[224:227], v[154:157]
    v_mfma_f32_16x16x32_bf16 v[158:161], v[198:201], a[228:231], v[158:161]
    ds_write_b128 v87, v[166:169] offset:8192
    v_mfma_f32_16x16x32_bf16 v[162:165], v[202:205], a[228:231], v[162:165]
    s_waitcnt lgkmcnt(1)
    v_mfma_f32_16x16x32_bf16 v[150:153], v[206:209], a[200:203], v[150:153]
    ds_write_b128 v88, v[170:173] offset:8192
    v_mfma_f32_16x16x32_bf16 v[154:157], v[210:213], a[200:203], v[154:157]
    v_mfma_f32_16x16x32_bf16 v[158:161], v[206:209], a[204:207], v[158:161]
    ds_write_b128 v87, v[174:177] offset:12288
    v_mfma_f32_16x16x32_bf16 v[162:165], v[210:213], a[204:207], v[162:165]
    s_waitcnt vmcnt(1)
    v_mfma_f32_16x16x32_bf16 v[150:153], a[250:253], v[238:241], v[150:153]
    ds_write_b128 v88, v[178:181] offset:12288
    v_mfma_f32_16x16x32_bf16 v[154:157], a[248:251], v[238:241], v[154:157]
    s_waitcnt vmcnt(0)
    v_mfma_f32_16x16x32_bf16 v[158:161], a[250:253], v[242:245], v[158:161]
    v_mfma_f32_16x16x32_bf16 v[162:165], a[248:251], v[242:245], v[162:165]
    s_nop 2
    ds_write_b128 v87, v[150:153] offset:0
    s_nop 0
    ds_write_b128 v88, v[154:157] offset:0
    s_nop 0
    ds_write_b128 v87, v[158:161] offset:4096
    ds_write_b128 v88, v[162:165] offset:4096
    s_waitcnt lgkmcnt(0)
    s_barrier
    ds_read_b128 v[118:121], v89 offset:0
    ds_read_b128 v[122:125], v90 offset:0
    ds_read_b128 v[126:129], v91 offset:0
    ds_read_b128 v[130:133], v92 offset:0
    ds_read_b128 v[134:137], v89 offset:2048
    ds_read_b128 v[138:141], v90 offset:2048
    ds_read_b128 v[142:145], v91 offset:2048
    ds_read_b128 v[146:149], v92 offset:2048
    s_waitcnt lgkmcnt(7)
    v_pk_add_f32 v[222:223], v[222:223], v[118:119]
    v_pk_add_f32 v[224:225], v[224:225], v[120:121]
    s_waitcnt lgkmcnt(6)
    v_pk_add_f32 v[226:227], v[226:227], v[122:123]
    v_pk_add_f32 v[228:229], v[228:229], v[124:125]
    s_waitcnt lgkmcnt(5)
    v_pk_add_f32 v[222:223], v[222:223], v[126:127]
    v_pk_add_f32 v[224:225], v[224:225], v[128:129]
    s_waitcnt lgkmcnt(4)
    v_pk_add_f32 v[226:227], v[226:227], v[130:131]
    v_pk_add_f32 v[228:229], v[228:229], v[132:133]
    v_cvt_pk_bf16_f32 v110, v222, v223
    v_cvt_pk_bf16_f32 v111, v224, v225
    v_cvt_pk_bf16_f32 v112, v226, v227
    v_cvt_pk_bf16_f32 v113, v228, v229
    buffer_store_dwordx4 v[110:113], v85, s[32:35], 0 offen
    s_waitcnt lgkmcnt(3)
    v_pk_add_f32 v[230:231], v[230:231], v[134:135]
    v_pk_add_f32 v[232:233], v[232:233], v[136:137]
    s_waitcnt lgkmcnt(2)
    v_pk_add_f32 v[234:235], v[234:235], v[138:139]
    v_pk_add_f32 v[236:237], v[236:237], v[140:141]
    s_waitcnt lgkmcnt(1)
    v_pk_add_f32 v[230:231], v[230:231], v[142:143]
    v_pk_add_f32 v[232:233], v[232:233], v[144:145]
    s_waitcnt lgkmcnt(0)
    v_pk_add_f32 v[234:235], v[234:235], v[146:147]
    v_pk_add_f32 v[236:237], v[236:237], v[148:149]
    v_cvt_pk_bf16_f32 v114, v230, v231
    v_cvt_pk_bf16_f32 v115, v232, v233
    v_cvt_pk_bf16_f32 v116, v234, v235
    v_cvt_pk_bf16_f32 v117, v236, v237
    buffer_store_dwordx4 v[114:117], v86, s[32:35], 0 offen
L_fin:
L_end:
    s_endpgm
L_nonce:
    buffer_load_dword v12, v16, s[44:47], 0 offen sc1
    s_add_u32 s60, s60, 1
    s_waitcnt vmcnt(0)
    v_readfirstlane_b32 s57, v12
    s_cmp_ge_u32 s60, 20000
    s_cbranch_scc1 L_nonce_ok
    s_cmp_eq_u32 s57, 0
    s_cbranch_scc1 L_nonce
    s_branch L_nonce_ok
L_pollin0:
    s_mov_b32 s60, 0
L_poll0:
    s_sleep 4
    buffer_load_dword v18, v20, s[28:31], 0 offen sc1
    s_add_u32 s60, s60, 1
    s_waitcnt vmcnt(0)
    v_cmp_ne_u32 vcc, s57, v18
    s_cbranch_vccz L_pollok0
    s_cmp_lt_u32 s60, 20000
    s_cbranch_scc1 L_poll0
    s_branch L_pollok0
L_pollin1:
    s_mov_b32 s60, 0
    s_branch L_poll1a
L_poll1:
    s_sleep 8
L_poll1a:
    buffer_load_dword v18, off, s[44:47], s15 sc1
    s_add_u32 s60, s60, 1
    s_waitcnt vmcnt(0)
    v_readfirstlane_b32 s14, v18
    s_nop 0
    s_cmp_ge_u32 s14, 14
    s_cbranch_scc1 L_pollok1
    s_cmp_lt_u32 s60, 20000
    s_cbranch_scc1 L_poll1
    s_branch L_pollok1
L_pollin2:
    s_mov_b32 s60, 0
    s_branch L_poll2a
L_poll2:
    s_sleep 4
L_poll2a:
    buffer_load_dword v18, off, s[28:31], s37 sc1
    s_add_u32 s60, s60, 1
    s_waitcnt vmcnt(0)
    v_readfirstlane_b32 s14, v18
    s_nop 0
    s_cmp_ge_u32 s14, 2
    s_cbranch_scc1 L_pollok2
    s_cmp_lt_u32 s60, 20000
    s_cbranch_scc1 L_poll2
    s_branch L_pollok2
L_nonceh:
    buffer_load_dword v12, v16, s[44:47], 0 offen sc1
    s_add_u32 s60, s60, 1
    s_waitcnt vmcnt(0)
    v_readfirstlane_b32 s57, v12
    s_cmp_ge_u32 s60, 20000
    s_cbranch_scc1 L_nonce_okh
    s_cmp_eq_u32 s57, 0
    s_cbranch_scc1 L_nonceh
    s_branch L_nonce_okh
L_pollin3:
    s_mov_b32 s60, 0
L_poll3:
    s_sleep 8
    buffer_load_dword v18, v20, s[28:31], 0 offen sc1
    s_add_u32 s60, s60, 1
    s_waitcnt vmcnt(0)
    v_cmp_ne_u32 vcc, s57, v18
    s_cbranch_vccz L_pollok3
    s_cmp_lt_u32 s60, 20000
    s_cbranch_scc1 L_poll3
    s_branch L_pollok3
L_pollin4:
    s_mov_b32 s60, 0
    s_branch L_poll4a
L_poll4:
    s_sleep 16
L_poll4a:
    buffer_load_dword v18, off, s[44:47], s15 sc1
    s_add_u32 s60, s60, 1
    s_waitcnt vmcnt(0)
    v_readfirstlane_b32 s14, v18
    s_nop 0
    s_cmp_ge_u32 s14, 14
    s_cbranch_scc1 L_pollok4
    s_cmp_lt_u32 s60, 20000
    s_cbranch_scc1 L_poll4
    s_branch L_pollok4
L_nog1:
    s_nop 1
    s_mov_b32 s14, 1204224
    s_mov_b32 s15, 0x20000
    s_sub_u32 s3, s2, 200
    s_cmp_lt_u32 s3, 42
    s_cselect_b32 s81, 0, 268435456
    s_cselect_b32 s3, s3, 0
    s_mul_i32 s79, s3, 43
    s_lshr_b32 s79, s79, 7
    s_mul_i32 s80, s79, 3
    s_sub_u32 s80, s3, s80
    v_min_u32 v13, 55, v1
    s_lshl_b32 s3, s79, 2
    s_add_u32 s3, s3, s48
    s_mul_i32 s3, s3, 21504
    s_mul_i32 s60, s80, 896
    s_add_u32 s3, s3, s60
    s_add_u32 s3, s3, s81
    v_lshl_add_u32 v242, v13, 4, s3
    s_mul_i32 s60, s48, 8448
    s_add_u32 m0, s60, 0
    s_mov_b32 s3, 0
    buffer_load_dwordx4 v242, s[12:15], s3 offen lds
    s_add_u32 m0, s60, 1056
    s_mov_b32 s3, 2688
    buffer_load_dwordx4 v242, s[12:15], s3 offen lds
    s_add_u32 m0, s60, 2112
    s_mov_b32 s3, 5376
    buffer_load_dwordx4 v242, s[12:15], s3 offen lds
    s_add_u32 m0, s60, 3168
    s_mov_b32 s3, 8064
    buffer_load_dwordx4 v242, s[12:15], s3 offen lds
    s_add_u32 m0, s60, 4224
    s_mov_b32 s3, 10752
    buffer_load_dwordx4 v242, s[12:15], s3 offen lds
    s_add_u32 m0, s60, 5280
    s_mov_b32 s3, 13440
    buffer_load_dwordx4 v242, s[12:15], s3 offen lds
    s_add_u32 m0, s60, 6336
    s_mov_b32 s3, 16128
    buffer_load_dwordx4 v242, s[12:15], s3 offen lds
    s_add_u32 m0, s60, 7392
    s_mov_b32 s3, 18816
    buffer_load_dwordx4 v242, s[12:15], s3 offen lds
    s_mul_i32 s53, s101, 37
    s_lshr_b32 s53, s53, 8
    s_mul_i32 s54, s53, 7
    s_sub_u32 s54, s101, s54
    s_and_b32 s53, s53, 3
    s_lshl_b32 s3, s6, 2
    s_add_u32 s53, s53, s3
    s_lshl_b32 s53, s53, 1
    s_add_u32 s53, s53, s7
    s_mov_b32 s42, 4096
    s_mov_b32 s43, 0x20000
    s_lshl_b32 s3, s53, 2
    s_add_u32 s3, s3, s48
    s_lshl_b32 s60, s3, 5
    v_lshl_add_u32 v82, v5, 1, s60
    s_mul_i32 s3, s3, 14336
    s_lshl_b32 s60, s54, 7
    s_add_u32 s3, s3, s60
    v_mul_u32_u24 v14, 896, v5
    v_lshl_add_u32 v14, v6, 4, v14
    v_add_u32 v85, s3, v14
    v_add_u32 v86, 7168, v85
    s_cmp_lt_u32 s101, 28
    s_cselect_b32 s56, 1, 0
    s_lshl_b32 s50, s7, 3
    s_and_b32 s3, s101, 7
    s_add_u32 s50, s50, s3
    s_lshr_b32 s60, s101, 3
    s_lshl_b32 s49, s6, 2
    s_add_u32 s49, s49, s60
    s_lshl_b32 s49, s49, 2
    s_add_u32 s49, s49, s48
    s_mul_i32 s60, s60, 0
    s_add_u32 s3, s3, s60
    s_sub_u32 s60, s3, 7
    s_cmp_ge_u32 s3, 7
    s_cselect_b32 s3, s60, s3
    s_lshl_b32 s62, s3, 18
    s_mul_i32 s63, s3, 12288
    s_mov_b32 s30, 20971520
    s_mov_b32 s31, 0x20000
    s_mov_b32 s75, 0x3727c5ac
    s_mov_b32 s76, 0x3b124925
    s_mov_b32 s77, 0x3f803f80
    v_lshlrev_b32 v4, 4, v1
    v_bfe_u32 v7, v1, 2, 2
    v_and_b32 v8, 3, v1
    v_mul_u32_u24 v13, 960, v9
    v_lshl_add_u32 v13, v10, 4, v13
    s_mul_i32 s3, s48, 1920
    s_add_u32 s3, s3, 147456
    v_add_u32 v230, s3, v13
    v_mul_u32_u24 v13, 960, v7
    v_lshl_add_u32 v13, v3, 5, v13
    v_lshl_add_u32 v13, v8, 3, v13
    s_lshl_b32 s3, s48, 8
    s_add_u32 s3, s3, 147456
    v_add_u32 v231, s3, v13
    s_lshl_b32 s3, s48, 3
    s_add_u32 s3, s3, 155648
    v_lshl_add_u32 v232, v9, 2, s3
    v_lshlrev_b32 v237, 2, v6
    v_and_b32 v2, 15, v1
    v_lshlrev_b32 v238, 14, v3
    v_add_lshl_u32 v238, v238, v2, 2
    v_add_u32 v237, 155648, v237
    v_lshlrev_b32 v13, 17, v9
    v_lshl_add_u32 v233, v10, 4, v13
    s_cmp_eq_u32 s48, 3
    s_cselect_b32 s60, 268435456, 0
    s_lshl_b32 s70, s48, 10
    s_add_u32 s70, s70, s2
    s_lshl_b32 s70, s70, 9
    s_add_u32 s71, s70, 262144
    s_add_u32 s71, s71, s60
    s_xor_b32 s60, s60, 268435456
    s_lshl_b32 s72, s2, 7
    s_add_u32 s72, s72, s60
    s_add_u32 s72, s72, 6291456
    s_lshr_b32 s74, s2, 2
    s_lshl_b32 s74, s74, 5
    s_and_b32 s3, s2, 3
    s_add_u32 s74, s74, s3
    s_lshl_b32 s74, s74, 2
    s_add_u32 s74, s74, 10485760
    v_cmp_gt_u32 vcc, 8, v0
    v_lshlrev_b32 v236, 13, v0
    v_mov_b32 v13, 268435456
    s_and_b32 s3, s2, 7
    s_lshl_b32 s3, s3, 13
    s_add_u32 s3, s3, 10485760
    v_lshrrev_b32 v14, 2, v0
    v_lshl_add_u32 v14, v14, 7, s3
    v_lshl_add_u32 v20, v8, 2, v14
    v_cndmask_b32 v236, v13, v236, vcc
    v_mov_b32 v16, 0
    s_lshl_b32 s3, s48, 14
    s_add_u32 s74, s74, s3
    s_add_u32 s73, s74, 8192
    s_waitcnt vmcnt(10)
    v_dot2_f32_bf16 v226, v182, s77, 0
    v_dot2_f32_bf16 v227, v182, v182, 0
    v_dot2_f32_bf16 v226, v183, s77, v226
    v_dot2_f32_bf16 v227, v183, v183, v227
    v_dot2_f32_bf16 v226, v184, s77, v226
    v_dot2_f32_bf16 v227, v184, v184, v227
    v_dot2_f32_bf16 v226, v185, s77, v226
    v_dot2_f32_bf16 v227, v185, v185, v227
    s_waitcnt vmcnt(9)
    v_dot2_f32_bf16 v226, v186, s77, v226
    v_dot2_f32_bf16 v227, v186, v186, v227
    v_dot2_f32_bf16 v226, v187, s77, v226
    v_dot2_f32_bf16 v227, v187, v187, v227
    v_dot2_f32_bf16 v226, v188, s77, v226
    v_dot2_f32_bf16 v227, v188, v188, v227
    v_dot2_f32_bf16 v226, v189, s77, v226
    v_dot2_f32_bf16 v227, v189, v189, v227
    buffer_load_dword v12, v16, s[44:47], 0 offen sc1
    v_lshlrev_b32 v190, 16, v182
    v_and_b32 v191, 0xffff0000, v182
    v_add_f32_dpp v226, v226, v226 quad_perm:[1,0,3,2] row_mask:0xf bank_mask:0xf
    v_add_f32_dpp v227, v227, v227 quad_perm:[1,0,3,2] row_mask:0xf bank_mask:0xf
    v_lshlrev_b32 v192, 16, v183
    v_add_f32_dpp v226, v226, v226 quad_perm:[2,3,0,1] row_mask:0xf bank_mask:0xf
    v_add_f32_dpp v227, v227, v227 quad_perm:[2,3,0,1] row_mask:0xf bank_mask:0xf
    v_and_b32 v193, 0xffff0000, v183
    v_add_f32_dpp v226, v226, v226 row_half_mirror row_mask:0xf bank_mask:0xf
    v_add_f32_dpp v227, v227, v227 row_half_mirror row_mask:0xf bank_mask:0xf
    v_lshlrev_b32 v194, 16, v184
    v_add_f32_dpp v226, v226, v226 row_mirror row_mask:0xf bank_mask:0xf
    v_add_f32_dpp v227, v227, v227 row_mirror row_mask:0xf bank_mask:0xf
    v_and_b32 v195, 0xffff0000, v184
    v_mov_b32 v228, v226
    v_mov_b32 v229, v227
    v_lshlrev_b32 v196, 16, v185
    v_permlane16_swap_b32 v226, v228
    v_permlane16_swap_b32 v227, v229
    v_add_f32 v226, v226, v228
    v_add_f32 v227, v227, v229
    v_mul_f32_e64 v226, -v226, s76
    v_mul_f32 v228, v226, v226
    v_fma_f32 v227, v227, s76, -v228
    v_max_f32 v227, 0, v227
    v_add_f32 v228, s75, v227
    v_rsq_f32 v222, v228
    v_and_b32 v197, 0xffff0000, v185
    v_mul_f32 v228, v222, v222
    v_fma_f32 v229, v228, v227, s75
    v_rsq_f32 v228, v229
    v_mul_f32 v223, v226, v222
    v_mul_f32 v224, v222, v228
    v_mul_f32 v225, v223, v228
    v_mul_f32 v229, v229, v228
    ds_write_b32 v232, v229
    v_lshlrev_b32 v198, 16, v186
    v_and_b32 v199, 0xffff0000, v186
    v_lshlrev_b32 v200, 16, v187
    v_and_b32 v201, 0xffff0000, v187
    v_lshlrev_b32 v202, 16, v188
    v_and_b32 v203, 0xffff0000, v188
    v_lshlrev_b32 v204, 16, v189
    v_and_b32 v205, 0xffff0000, v189
    v_pk_fma_f32 v[206:207], v[190:191], v[224:225], v[224:225] op_sel:[0,0,1] op_sel_hi:[1,0,1]
    v_pk_fma_f32 v[208:209], v[192:193], v[224:225], v[224:225] op_sel:[0,0,1] op_sel_hi:[1,0,1]
    v_pk_fma_f32 v[210:211], v[194:195], v[224:225], v[224:225] op_sel:[0,0,1] op_sel_hi:[1,0,1]
    v_pk_fma_f32 v[212:213], v[196:197], v[224:225], v[224:225] op_sel:[0,0,1] op_sel_hi:[1,0,1]
    v_cvt_pk_bf16_f32 v182, v206, v207
    v_cvt_pk_bf16_f32 v183, v208, v209
    v_cvt_pk_bf16_f32 v184, v210, v211
    v_cvt_pk_bf16_f32 v185, v212, v213
    ds_write_b128 v230, v[182:185] offset:0
    v_pk_fma_f32 v[214:215], v[198:199], v[224:225], v[224:225] op_sel:[0,0,1] op_sel_hi:[1,0,1]
    v_pk_fma_f32 v[216:217], v[200:201], v[224:225], v[224:225] op_sel:[0,0,1] op_sel_hi:[1,0,1]
    v_pk_fma_f32 v[218:219], v[202:203], v[224:225], v[224:225] op_sel:[0,0,1] op_sel_hi:[1,0,1]
    v_pk_fma_f32 v[220:221], v[204:205], v[224:225], v[224:225] op_sel:[0,0,1] op_sel_hi:[1,0,1]
    v_cvt_pk_bf16_f32 v186, v214, v215
    v_cvt_pk_bf16_f32 v187, v216, v217
    v_cvt_pk_bf16_f32 v188, v218, v219
    v_cvt_pk_bf16_f32 v189, v220, v221
    ds_write_b128 v230, v[186:189] offset:448
    s_waitcnt lgkmcnt(0)
    s_barrier
    ds_read_b64_tr_b16 v[110:111], v231 offset:0
    ds_read_b64_tr_b16 v[112:113], v231 offset:3840
    ds_read_b64_tr_b16 v[114:115], v231 offset:128
    ds_read_b64_tr_b16 v[116:117], v231 offset:3968
    ds_read_b32 v229, v237
    s_waitcnt lgkmcnt(3)
    buffer_store_dwordx4 v[110:113], v233, s[28:31], s70 offen sc1
    s_waitcnt lgkmcnt(1)
    buffer_store_dwordx4 v[114:117], v233, s[28:31], s71 offen sc1
    v_cmp_gt_u32 vcc, 16, v1
    s_waitcnt lgkmcnt(0)
    s_nop 0
    v_cndmask_b32 v229, 0, v229, vcc
    buffer_store_dword v229, v238, s[28:31], s72 offen sc1
    v_lshrrev_b32 v13, 2, v1
    v_mul_u32_u24 v13, 1056, v13
    v_lshl_add_u32 v13, v8, 3, v13
    s_mul_i32 s3, s48, 224
    v_add_u32 v243, s3, v13
    s_mov_b32 s18, 401408
    s_mov_b32 s19, 0x20000
    s_mov_b32 s26, 7340032
    s_mov_b32 s27, 0x20000
    s_mov_b32 s34, 1835008
    s_mov_b32 s35, 0x20000
    s_mov_b32 s36, 1
    v_lshrrev_b32 v14, 2, v1
    v_lshlrev_b32 v14, 7, v14
    v_lshl_add_u32 v14, v8, 3, v14
    v_and_b32 v15, 3, v5
    v_lshl_add_u32 v14, v15, 5, v14
    s_mul_i32 s3, s4, 8256
    v_xor_b32 v31, s3, v14
    v_xor_b32 v32, 32, v31
    v_xor_b32 v33, 64, v31
    v_xor_b32 v34, 96, v31
    v_add_u32 v35, 65536, v31
    v_add_u32 v36, 65536, v32
    v_add_u32 v37, 65536, v33
    v_add_u32 v38, 65536, v34
    v_add_u32 v39, 131072, v31
    v_add_u32 v40, 131072, v32
    v_add_u32 v41, 131072, v33
    v_add_u32 v42, 131072, v34
    s_lshl_b32 s6, s52, 1
    s_add_u32 s6, s6, s5
    s_lshl_b32 s3, s6, 1
    s_add_u32 s3, s3, s59
    s_lshl_b32 s3, s3, 4
    s_add_u32 s3, s3, s4
    s_lshl_b32 s3, s3, 12
    v_lshl_add_u32 v78, v3, 8, v4
    v_add_u32 v78, s3, v78
    s_xor_b32 s37, s51, 1
    s_lshl_b32 s37, s37, 3
    s_add_u32 s37, s37, s52
    s_lshl_b32 s3, s37, 14
    s_add_u32 s3, s3, s58
    s_add_u32 s3, s3, 16777216
    v_add_u32 v23, s3, v4
    s_lshl_b32 s37, s37, 5
    s_add_u32 s37, s37, s5
    s_lshl_b32 s37, s37, 2
    s_add_u32 s37, s37, 6422528
    s_mul_i32 s67, s6, 56
    s_lshl_b32 s3, s51, 1
    s_add_u32 s3, s3, s4
    s_add_u32 s67, s67, s3
    s_lshl_b32 s67, s67, 11
    s_add_u32 s67, s67, 2097152
    v_add_u32 v81, s58, v4
    s_lshl_b32 s68, s52, 2
    s_and_b32 s3, s51, 1
    s_add_u32 s68, s68, s3
    s_cmp_ge_u32 s51, 14
    s_cselect_b32 s3, 2, 0
    s_add_u32 s68, s68, s3
    s_lshl_b32 s68, s68, 7
    s_add_u32 s68, s68, 6356992
    s_waitcnt vmcnt(3)
    v_readfirstlane_b32 s57, v12
    s_mov_b32 s60, 0
    s_cmp_lg_u32 s57, 0
    s_cbranch_scc0 L_nonceh
L_nonce_okh:
    s_waitcnt vmcnt(0)
    s_barrier
    s_atomic_swap s57, s[28:29], s74
    s_atomic_swap s57, s[28:29], s73
    buffer_load_dwordx4 v[96:99], v85, s[8:11], 0 offen
    buffer_load_ushort v93, v82, s[40:43], 0 offen offset:0
    buffer_load_dwordx4 v[100:103], v86, s[8:11], 0 offen
    buffer_load_ushort v94, v82, s[40:43], 0 offen offset:16
    v_cmp_gt_u32 vcc, 12, v2
    s_mul_i32 s3, s48, 56
    s_add_u32 s3, s3, s79
    s_mul_i32 s3, s3, 3
    s_add_u32 s3, s3, s80
    s_lshl_b32 s3, s3, 11
    s_add_u32 s3, s3, 8388608
    s_add_u32 s3, s3, s81
    ds_read_b64_tr_b16 v[182:183], v243 offset:0
    ds_read_b64_tr_b16 v[184:185], v243 offset:16896
    ds_read_b64_tr_b16 v[186:187], v243 offset:32
    ds_read_b64_tr_b16 v[188:189], v243 offset:16928
    ds_read_b64_tr_b16 v[190:191], v243 offset:56
    ds_read_b64_tr_b16 v[192:193], v243 offset:16952
    ds_read_b64_tr_b16 v[194:195], v243 offset:88
    ds_read_b64_tr_b16 v[196:197], v243 offset:16984
    ds_read_b64_tr_b16 v[198:199], v243 offset:112
    ds_read_b64_tr_b16 v[200:201], v243 offset:17008
    ds_read_b64_tr_b16 v[202:203], v243 offset:144
    ds_read_b64_tr_b16 v[204:205], v243 offset:17040
    ds_read_b64_tr_b16 v[206:207], v243 offset:168
    ds_read_b64_tr_b16 v[208:209], v243 offset:17064
    ds_read_b64_tr_b16 v[210:211], v243 offset:200
    ds_read_b64_tr_b16 v[212:213], v243 offset:17096
    s_waitcnt lgkmcnt(13)
    v_cndmask_b32 v186, 0, v186, vcc
    v_cndmask_b32 v187, 0, v187, vcc
    s_waitcnt lgkmcnt(12)
    v_cndmask_b32 v188, 0, v188, vcc
    v_cndmask_b32 v189, 0, v189, vcc
    buffer_store_dwordx4 v[182:185], v4, s[28:31], s3 offen offset:0 sc1
    buffer_store_dwordx4 v[186:189], v4, s[28:31], s3 offen offset:1024 sc1
    s_add_u32 s3, s3, 86016
    s_waitcnt lgkmcnt(9)
    v_cndmask_b32 v194, 0, v194, vcc
    v_cndmask_b32 v195, 0, v195, vcc
    s_waitcnt lgkmcnt(8)
    v_cndmask_b32 v196, 0, v196, vcc
    v_cndmask_b32 v197, 0, v197, vcc
    buffer_store_dwordx4 v[190:193], v4, s[28:31], s3 offen offset:0 sc1
    buffer_store_dwordx4 v[194:197], v4, s[28:31], s3 offen offset:1024 sc1
    s_add_u32 s3, s3, 86016
    s_waitcnt lgkmcnt(5)
    v_cndmask_b32 v202, 0, v202, vcc
    v_cndmask_b32 v203, 0, v203, vcc
    s_waitcnt lgkmcnt(4)
    v_cndmask_b32 v204, 0, v204, vcc
    v_cndmask_b32 v205, 0, v205, vcc
    buffer_store_dwordx4 v[198:201], v4, s[28:31], s3 offen offset:0 sc1
    buffer_store_dwordx4 v[202:205], v4, s[28:31], s3 offen offset:1024 sc1
    s_add_u32 s3, s3, 86016
    ds_read_b32 v24, v4
    s_waitcnt lgkmcnt(2)
    v_cndmask_b32 v210, 0, v210, vcc
    v_cndmask_b32 v211, 0, v211, vcc
    ds_read_b32 v24, v4
    s_waitcnt lgkmcnt(2)
    v_cndmask_b32 v212, 0, v212, vcc
    v_cndmask_b32 v213, 0, v213, vcc
    buffer_store_dwordx4 v[206:209], v4, s[28:31], s3 offen offset:0 sc1
    buffer_store_dwordx4 v[210:213], v4, s[28:31], s3 offen offset:1024 sc1
    s_add_u32 s3, s3, 86016
    s_lshl_b32 s67, s80, 6
    s_add_u32 s67, s67, 64
    s_cmp_eq_u32 s81, 0
    s_cselect_b32 s37, s48, 1
    s_mov_b32 s68, 6369792
    s_and_b32 s3, s2, 1
    s_mul_i32 s3, s3, 3
    s_bfe_u32 s6, s2, 0x10001
    s_mul_i32 s7, s6, 6
    s_add_u32 s3, s3, s7
    s_add_u32 s3, s3, 1
    v_add_u32 v14, s3, v8
    s_mul_i32 s6, s6, 64
    s_add_u32 s6, s6, 7
    v_cmp_ne_u32 vcc, s6, v14
    v_lshrrev_b32 v15, 2, v1
    v_mul_u32_u24 v15, 3584, v15
    v_cndmask_b32 v14, 0, v14, vcc
    v_lshl_add_u32 v14, v14, 8, v15
    s_lshl_b32 s3, s52, 2
    s_add_u32 s3, s3, s48
    s_mul_i32 s3, s3, 37
    s_min_u32 s3, s3, 987
    s_mul_i32 s3, s3, 3584
    s_mul_i32 s6, s59, 3670144
    s_add_u32 s3, s3, s6
    buffer_load_dword v226, v14, s[20:23], s3 offen
    s_add_u32 s3, s3, 57344
    buffer_load_dword v227, v14, s[20:23], s3 offen
    s_add_u32 s3, s3, 57344
    v_cmp_gt_u32 vcc, 20, v1
    v_mov_b32 v15, 268435456
    s_nop 0
    v_cndmask_b32 v14, v15, v14, vcc
    buffer_load_dword v228, v14, s[20:23], s3 offen
    s_add_u32 s3, s3, 57344
    v_add_u32 v53, 65536, v4
    v_add_u32 v54, 131072, v4
    s_mul_i32 s59, s48, 3072
    s_mul_i32 s3, s50, 86016
    s_add_u32 s3, s3, s59
    s_add_u32 s3, s3, 8388608
    v_add_u32 v80, s3, v4
    v_lshlrev_b32 v14, 7, v9
    v_xor_b32 v14, v14, v4
    s_lshl_b32 s3, s49, 11
    v_add_u32 v67, s3, v14
    v_add_u32 v68, 129024, v67
    s_lshr_b32 s3, s49, 2
    s_lshl_b32 s3, s3, 3
    s_max_u32 s3, s3, 1
    s_sub_u32 s3, s3, 1
    s_lshl_b32 s3, s3, 10
    s_lshl_b32 s6, s5, 17
    s_add_u32 s3, s3, s6
    s_lshl_b32 s6, s4, 28
    s_add_u32 s3, s3, s6
    v_add_u32 v69, s3, v14
    s_lshl_b32 s100, s5, 1
    s_add_u32 s100, s100, s4
    s_lshl_b32 s100, s100, 10
    v_and_b32 v14, 1, v1
    v_mul_u32_u24 v14, 640, v14
    v_lshrrev_b32 v15, 2, v1
    v_lshlrev_b32 v15, 4, v15
    v_xor_b32 v14, v14, v15
    v_bfe_u32 v15, v1, 1, 1
    v_lshl_add_u32 v14, v15, 3, v14
    s_add_u32 s3, s58, 12288
    v_add_u32 v70, s3, v14
    s_sub_u32 s3, s3, 3072
    s_cmp_eq_u32 s48, 0
    s_cselect_b32 s3, 28672, s3
    v_add_u32 v71, s3, v14
    v_add_u32 v72, 65536, v70
    v_add_u32 v73, 65536, v71
    v_add_u32 v74, 131072, v70
    v_add_u32 v75, 131072, v71
    s_lshl_b32 s3, s49, 1
    v_min_u32 v14, 2, v3
    v_add_u32 v14, s3, v14
    v_max_u32 v14, 1, v14
    v_lshlrev_b32 v14, 1, v14
    v_and_b32 v15, 1, v7
    v_add_lshl_u32 v14, v14, v15, 7
    v_lshrrev_b32 v15, 1, v7
    v_lshl_add_u32 v15, v15, 2, v8
    v_lshl_add_u32 v14, v15, 2, v14
    v_add_u32 v77, 6291200, v14
    s_min_u32 s15, s48, 2
    s_lshl_b32 s15, s15, 6
    s_add_u32 s15, s15, 64
    s_lshl_b32 s82, s49, 5
    s_add_u32 s82, s82, s50
    s_lshl_b32 s82, s82, 10
    s_add_u32 s82, s82, 4194304
    s_lshr_b32 s69, s49, 2
    s_lshl_b32 s69, s69, 1
    s_and_b32 s3, s50, 1
    s_add_u32 s69, s69, s3
    s_lshl_b32 s69, s69, 7
    s_add_u32 s69, s69, 6361088
    s_and_b32 s7, s53, 1
    s_mul_i32 s3, s7, 28
    s_add_u32 s3, s3, s48
    s_lshl_b32 s3, s3, 17
    s_xor_b32 s6, s53, 1
    s_lshl_b32 s55, s6, 3
    s_lshl_b32 s6, s53, 7
    s_add_u32 s3, s3, s6
    v_lshlrev_b32 v14, 12, v5
    v_add3_u32 v59, v14, v83, s3
    v_add_u32 v60, 31744, v59
    v_add_u32 v61, 63488, v59
    v_add_u32 v62, 95232, v59
    v_mul_u32_u24 v14, 896, v5
    s_mul_i32 s3, s4, 25088
    s_mul_i32 s6, s5, 14336
    s_add_u32 s3, s3, s6
    s_lshl_b32 s6, s54, 7
    s_add_u32 s3, s3, s6
    v_add3_u32 v63, v14, v83, s3
    v_add_u32 v64, 6144, v63
    s_lshl_b32 s6, s53, 1
    s_add_u32 s6, s6, s5
    s_and_b32 s3, s53, 30
    s_add_u32 s3, s3, s4
    s_lshl_b32 s3, s3, 7
    s_add_u32 s39, s3, 6361088
    s_lshl_b32 s3, s6, 5
    s_add_u32 s3, s3, s4
    s_lshl_b32 s3, s3, 10
    s_add_u32 s3, s3, 4194304
    v_add_u32 v65, s3, v4
    v_add_u32 v66, 15360, v65
    s_xor_b32 s3, s4, s5
    s_lshl_b32 s3, s3, 6
    v_xor_b32 v43, s3, v31
    v_xor_b32 v44, 32, v43
    v_add_u32 v45, 65536, v43
    v_add_u32 v46, 65536, v44
    s_mul_i32 s3, s4, 12288
    v_add_u32 v47, s3, v4
    v_xor_b32 v48, 4096, v47
    v_add_u32 v49, 65536, v47
    v_add_u32 v50, 65536, v48
    v_add_u32 v51, 131072, v47
    v_add_u32 v52, 131072, v48
    s_lshl_b32 s6, s54, 1
    s_add_u32 s6, s6, s5
    s_lshl_b32 s3, s6, 1
    s_add_u32 s3, s3, s7
    s_mul_i32 s3, s3, 14
    s_add_u32 s3, s3, s4
    s_lshl_b32 s3, s3, 12
    s_add_u32 s3, s3, 2097152
    v_add_u32 v79, s3, v4
    s_lshl_b32 s3, s54, 1
    s_add_u32 s3, s3, s7
    s_lshl_b32 s3, s3, 1
    s_add_u32 s3, s3, s4
    s_lshl_b32 s3, s3, 7
    s_add_u32 s38, s3, 6356992
    s_and_b32 s3, s2, 6
    s_add_u32 s3, s3, s54
    s_sub_u32 s6, s3, 7
    s_cmp_ge_u32 s3, 7
    s_cselect_b32 s3, s6, s3
    s_lshl_b32 s64, s3, 19
    s_lshl_b32 s65, s3, 13
    s_add_u32 s55, s55, s54
    s_lshl_b32 s3, s55, 14
    s_add_u32 s3, s3, s58
    s_add_u32 s3, s3, 12582912
    v_add_u32 v21, s3, v4
    s_lshl_b32 s55, s55, 5
    s_add_u32 s55, s55, s48
    s_lshl_b32 s55, s55, 2
    s_add_u32 s55, s55, 6488064
    s_lshl_b32 s3, s5, 3
    v_add_u32 v13, s3, v3
    v_xor_b32 v13, v13, v6
    v_lshlrev_b32 v13, 4, v13
    v_lshl_add_u32 v13, v2, 8, v13
    s_lshl_b32 s3, s4, 14
    s_add_u32 s3, s3, 32768
    v_add_u32 v87, s3, v13
    v_xor_b32 v88, 64, v87
    s_lshr_b32 s3, s53, 1
    s_add_u32 s66, s3, s54
    s_mov_b32 s51, s66
    v_lshlrev_b32 v13, 1, v6
    v_xor_b32 v13, v13, v5
    v_lshlrev_b32 v13, 4, v13
    v_lshl_add_u32 v13, v5, 8, v13
    s_add_u32 s3, s58, 32768
    v_add_u32 v89, s3, v13
    v_xor_b32 v90, 16, v89
    v_xor_b32 v91, 24576, v89
    v_xor_b32 v92, 24592, v89
    s_mov_b32 s70, 0xaaaaaaaa
    s_mov_b32 s71, 0xaaaaaaaa
    s_mov_b32 s72, 0xfff0ffff
    s_mov_b32 s73, 0xf000ff00
    s_mov_b32 s74, 0xffc0fffc
    s_mov_b32 s75, 0xc000fc00
    s_cmp_eq_u32 s49, 0
    s_cselect_b64 s[76:77], 0, -1
    v_mov_b32 v13, 0xffff
    v_mov_b32 v14, 0xffff0000
    v_cndmask_b32 v13, v13, v14, s[70:71]
    v_cndmask_b32 v104, v13, 0, s[72:73]
    v_cndmask_b32 v106, 0, v13, s[72:73]
    v_cndmask_b32 v105, v13, 0, s[74:75]
    v_cndmask_b32 v107, 0, v13, s[74:75]
    v_mov_b32 v84, 0xf149f2ca
    s_mov_b32 s83, 0x3e8b97f6
    s_mov_b32 s78, 0xbdd2d3e8
    s_mov_b32 s79, 0xbdd2d3e8
    s_mov_b32 s80, 1.0
    s_mov_b32 s81, 1.0
    v_mov_b32 v108, 0xc0135761
    v_mov_b32 v109, 0xc0135761
    v_lshrrev_b32 v13, 1, v2
    v_lshlrev_b32 v14, 1, v3
    v_sub_u32 v13, v13, v14
    v_mov_b32 v14, 0x3f80
    v_cndmask_b32 v14, v14, 1.0, s[70:71]
    v_cmp_eq_i32 vcc, 0, v13
    v_accvgpr_write_b32 a248, 0
    v_accvgpr_write_b32 a252, 0
    v_cndmask_b32 v15, 0, v14, vcc
    v_accvgpr_write_b32 a250, v15
    v_cmp_eq_i32 vcc, 1, v13
    v_accvgpr_write_b32 a249, 0
    v_accvgpr_write_b32 a253, 0
    v_cndmask_b32 v15, 0, v14, vcc
    v_accvgpr_write_b32 a251, v15
    s_waitcnt vmcnt(3)
    s_barrier
    s_cmp_lg_u32 s37, 0
    s_cbranch_scc1 L_nowsig
    s_atomic_add s36, s[44:45], s67
L_nowsig:
    buffer_load_dword v18, v20, s[28:31], 0 offen sc1
    s_mov_b32 s26, 7340032
    s_and_b32 s3, s2, 1
    s_mul_i32 s3, s3, 7
    s_add_u32 s3, s3, s52
    s_lshl_b32 s3, s3, 2
    s_add_u32 s3, s3, s48
    s_lshl_b32 s3, s3, 17
    s_and_b32 s6, s2, 6
    s_lshl_b32 s6, s6, 9
    s_add_u32 s3, s3, s6
    v_lshlrev_b32 v242, 12, v10
    v_lshl_add_u32 v242, v9, 9, v242
    buffer_load_dword v232, v242, s[24:27], s3 offen offset:384
    buffer_load_dword v233, v242, s[24:27], s3 offen offset:256
    s_cmp_eq_u32 s56, 0
    s_cselect_b32 s26, 0, s26
    s_cmp_eq_u32 s56, 0
    s_cselect_b32 s26, 0, s26
    v_and_b32 v13, 0xfffff000, v78
    v_lshl_add_u32 v13, v10, 7, v13
    s_add_u32 s3, s1, 8192
    v_lshl_add_u32 v14, v9, 13, s3
    s_waitcnt vmcnt(2)
    v_cmp_ne_u32 vcc, s57, v18
    s_cbranch_vccnz L_pollin3
L_pollok3:
    s_load_dword s14, s[44:45], s15
    s_barrier
    buffer_load_dword v76, v77, s[28:31], 0 offen sc1
    s_waitcnt lgkmcnt(0)
    s_cmp_ge_u32 s14, 14
    s_cbranch_scc0 L_pollin4
L_pollok4:
    s_barrier
    s_cmp_eq_u32 s56, 0
    s_cselect_b32 s3, 268435456, 0
    v_add_u32 v79, s3, v79
    s_add_u32 m0, s59, 98304
    s_nop 0
    buffer_load_dwordx4 v80, s[28:31], s63 offen sc1 lds
    buffer_load_dwordx4 v80, s[28:31], s63 offen offset:1024 sc1 lds
    buffer_load_dwordx4 v80, s[28:31], s63 offen offset:2048 sc1 lds
    s_add_u32 m0, s100, 126976
    s_nop 0
    buffer_load_dwordx4 v69, s[28:31], s62 offen sc1 lds
    s_add_u32 m0, s58, 110592
    s_nop 0
    buffer_load_dwordx4 v67, s[28:31], s62 offen sc1 lds
    buffer_load_dwordx4 v67, s[28:31], s62 offen offset:1024 sc1 lds
    buffer_load_dwordx4 v68, s[28:31], s62 offen offset:2048 sc1 lds
    buffer_load_dwordx4 v68, s[28:31], s62 offen offset:3072 sc1 lds
    s_add_u32 m0, s59, 131072
    s_add_u32 s63, s63, 12288
    s_cmp_eq_u32 s63, 86016
    s_cselect_b32 s63, 0, s63
    buffer_load_dwordx4 v80, s[28:31], s63 offen sc1 lds
    buffer_load_dwordx4 v80, s[28:31], s63 offen offset:1024 sc1 lds
    buffer_load_dwordx4 v80, s[28:31], s63 offen offset:2048 sc1 lds
    s_add_u32 m0, s100, 159744
    s_add_u32 s62, s62, 262144
    s_cmp_eq_u32 s62, 1835008
    s_cselect_b32 s62, 0, s62
    buffer_load_dwordx4 v69, s[28:31], s62 offen sc1 lds
    s_add_u32 m0, s58, 143360
    s_nop 0
    buffer_load_dwordx4 v67, s[28:31], s62 offen sc1 lds
    buffer_load_dwordx4 v67, s[28:31], s62 offen offset:1024 sc1 lds
    buffer_load_dwordx4 v68, s[28:31], s62 offen offset:2048 sc1 lds
    buffer_load_dwordx4 v68, s[28:31], s62 offen offset:3072 sc1 lds
    s_add_u32 m0, s59, 0
    s_add_u32 s63, s63, 12288
    s_cmp_eq_u32 s63, 86016
    s_cselect_b32 s63, 0, s63
    buffer_load_dwordx4 v80, s[28:31], s63 offen sc1 lds
    buffer_load_dwordx4 v80, s[28:31], s63 offen offset:1024 sc1 lds
    buffer_load_dwordx4 v80, s[28:31], s63 offen offset:2048 sc1 lds
    s_add_u32 m0, s100, 28672
    s_add_u32 s62, s62, 262144
    s_cmp_eq_u32 s62, 1835008
    s_cselect_b32 s62, 0, s62
    buffer_load_dwordx4 v69, s[28:31], s62 offen sc1 lds
    s_add_u32 m0, s58, 12288
    s_nop 0
    buffer_load_dwordx4 v67, s[28:31], s62 offen sc1 lds
    buffer_load_dwordx4 v67, s[28:31], s62 offen offset:1024 sc1 lds
    buffer_load_dwordx4 v68, s[28:31], s62 offen offset:2048 sc1 lds
    buffer_load_dwordx4 v68, s[28:31], s62 offen offset:3072 sc1 lds
    s_add_u32 m0, s59, 65536
    s_add_u32 s63, s63, 12288
    s_cmp_eq_u32 s63, 86016
    s_cselect_b32 s63, 0, s63
    buffer_load_dwordx4 v80, s[28:31], s63 offen sc1 lds
    buffer_load_dwordx4 v80, s[28:31], s63 offen offset:1024 sc1 lds
    buffer_load_dwordx4 v80, s[28:31], s63 offen offset:2048 sc1 lds
    s_add_u32 m0, s100, 94208
    s_add_u32 s62, s62, 262144
    s_cmp_eq_u32 s62, 1835008
    s_cselect_b32 s62, 0, s62
    buffer_load_dwordx4 v69, s[28:31], s62 offen sc1 lds
    s_add_u32 m0, s58, 77824
    s_nop 0
    buffer_load_dwordx4 v67, s[28:31], s62 offen sc1 lds
    buffer_load_dwordx4 v67, s[28:31], s62 offen offset:1024 sc1 lds
    buffer_load_dwordx4 v68, s[28:31], s62 offen offset:2048 sc1 lds
    buffer_load_dwordx4 v68, s[28:31], s62 offen offset:3072 sc1 lds
    s_mov_b32 s3, 268435456
    buffer_store_dword v12, v11, s[28:31], s3 offen
    buffer_store_dword v12, v11, s[28:31], s3 offen
    v_lshlrev_b32 v13, 2, v2
    v_and_b32 v14, 1, v1
    v_lshl_add_u32 v14, v3, 2, v14
    v_lshlrev_b32 v14, 2, v14
    v_add_u32 v15, 64, v14
    v_cndmask_b32 v16, v14, v15, s[72:73]
    v_cndmask_b32 v14, v14, v15, s[74:75]
    s_waitcnt vmcnt(34)
    ds_bpermute_b32 v25, v13, v76 offset:64
    ds_bpermute_b32 v27, v16, v76 offset:0
    ds_bpermute_b32 v28, v14, v76 offset:8
    ds_bpermute_b32 v26, v13, v76 offset:128
    ds_bpermute_b32 v29, v16, v76 offset:64
    ds_bpermute_b32 v30, v14, v76 offset:72
    s_waitcnt lgkmcnt(5)
    v_mul_f32 v25, s83, v25
    s_waitcnt lgkmcnt(2)
    v_mul_f32 v26, s83, v26
    s_waitcnt vmcnt(18) lgkmcnt(0)
    s_barrier
    ds_read_b64_tr_b16 a[180:181], v72 offset:32768
    ds_read_b64_tr_b16 a[182:183], v72 offset:33024
    ds_read_b128 a[128:131], v53 offset:32768
    ds_read_b64_tr_b16 a[184:185], v72 offset:33792
    ds_read_b64_tr_b16 a[186:187], v72 offset:34048
    ds_read_b128 a[132:135], v53 offset:33792
    ds_read_b128 a[136:139], v53 offset:34816
    ds_read_b64_tr_b16 a[176:177], v73 offset:32768
    ds_read_b64_tr_b16 a[178:179], v73 offset:33024
    ds_read_b128 a[140:143], v53 offset:35840
    ds_read_b128 a[144:147], v53 offset:36864
    ds_read_b128 a[148:151], v53 offset:37888
    s_waitcnt lgkmcnt(0)
    s_nop 3
    s_branch L_q
L_pollin5:
    s_cmp_eq_u32 s56, 0
    s_cbranch_scc1 L_pollok5
    s_mov_b32 s60, 0
    s_branch L_poll5a
L_poll5:
    s_sleep 8
L_poll5a:
    buffer_load_dword v18, off, s[28:31], s38 sc1
    s_add_u32 s60, s60, 1
    s_waitcnt vmcnt(0)
    v_readfirstlane_b32 s14, v18
    s_nop 0
    s_cmp_ge_u32 s14, 7
    s_cbranch_scc1 L_pollok5
    s_cmp_lt_u32 s60, 20000
    s_cbranch_scc1 L_poll5
    s_branch L_pollok5
L_nof:
    v_min_u32 v14, 48, v1
    s_lshl_b32 s3, s54, 2
    s_add_u32 s3, s3, s48
    s_mul_i32 s3, s3, 25088
    v_lshl_add_u32 v14, v14, 7, s3
    s_add_u32 s3, s2, 0
    s_and_b32 s3, s3, 3
    s_mul_i32 s3, s3, 6272
    buffer_load_dword v182, v14, s[16:19], s3 offen
    s_waitcnt vmcnt(1)
    s_barrier
    s_cmp_lg_u32 s48, 0
    s_cbranch_scc1 L_sig3
    s_atomic_add s36, s[28:29], s69
L_sig3:
    s_add_u32 s3, s2, 1
    s_and_b32 s3, s3, 3
    s_mul_i32 s3, s3, 6272
    buffer_load_dword v183, v14, s[16:19], s3 offen
    s_add_u32 s3, s2, 2
    s_and_b32 s3, s3, 3
    s_mul_i32 s3, s3, 6272
    buffer_load_dword v184, v14, s[16:19], s3 offen
    s_add_u32 s3, s2, 3
    s_and_b32 s3, s3, 3
    s_mul_i32 s3, s3, 6272
    buffer_load_dword v185, v14, s[16:19], s3 offen
    s_branch L_fin
L_pollin6:
    s_mov_b32 s60, 0
    s_branch L_poll6a
L_poll6:
    s_sleep 8
L_poll6a:
    buffer_load_dword v18, off, s[28:31], s39 sc1
    s_add_u32 s60, s60, 1
    s_waitcnt vmcnt(0)
    v_readfirstlane_b32 s14, v18
    s_nop 0
    s_cmp_ge_u32 s14, 8
    s_cbranch_scc1 L_pollok6
    s_cmp_lt_u32 s60, 20000
    s_cbranch_scc1 L_poll6
    s_branch L_pollok6
L_pollin7:
    s_mov_b32 s60, 0
    s_branch L_poll7a
L_poll7:
    s_sleep 4
L_poll7a:
    buffer_load_dword v18, off, s[28:31], s55 sc1
    s_add_u32 s60, s60, 1
    s_waitcnt vmcnt(0)
    v_readfirstlane_b32 s14, v18
    s_nop 0
    s_cmp_ge_u32 s14, 1
    s_cbranch_scc1 L_pollok7
    s_cmp_lt_u32 s60, 20000
    s_cbranch_scc1 L_poll7
    s_branch L_pollok7
L_last:
    s_endpgm
.section .rodata,"a"
.p2align 6
.amdhsa_kernel parallel_sum__sliding_local_dilated__mixer_token_mlp__prompt_kernel
  .amdhsa_next_free_vgpr 512
  .amdhsa_next_free_sgpr 102
  .amdhsa_accum_offset 256
  .amdhsa_group_segment_fixed_size 0
  .amdhsa_kernarg_size 88
  .amdhsa_user_sgpr_count 2
  .amdhsa_user_sgpr_kernarg_segment_ptr 1
  .amdhsa_system_sgpr_workgroup_id_x 1
.end_amdhsa_kernel
```

```asm
; @launch grid=(256,1,1) block=(256,1,1) lds=163840
.amdgcn_target "amdgcn-amd-amdhsa--gfx950"
.text
.globl parallel_sum__sliding_local_dilated__mixer_token_mlp__prompt_kernel
.p2align 8
.type parallel_sum__sliding_local_dilated__mixer_token_mlp__prompt_kernel,@function
parallel_sum__sliding_local_dilated__mixer_token_mlp__prompt_kernel:
    s_cmp_ge_u32 s2, 256
    s_cbranch_scc1 L_end
    s_load_dwordx2 s[8:9], s[0:1], 0
    s_load_dwordx2 s[20:21], s[0:1], 32
    s_load_dwordx2 s[28:29], s[0:1], 80
    s_load_dwordx2 s[44:45], s[0:1], 72
    s_load_dwordx2 s[12:13], s[0:1], 8
    s_load_dwordx2 s[16:17], s[0:1], 16
    s_load_dwordx2 s[24:25], s[0:1], 48
    s_load_dwordx2 s[32:33], s[0:1], 64
    s_load_dwordx2 s[36:37], s[0:1], 40
    s_load_dwordx2 s[40:41], s[0:1], 56
    s_memrealtime s[78:79]
    s_getpc_b64 s[6:7]
L_pc:
    s_and_b32 s3, s2, 0xf8
    v_lshrrev_b32 v13, 5, v0
    v_add_lshl_u32 v13, s3, v13, 7
    v_min_u32 v13, L_last-L_pc, v13
    global_load_dword v18, v13, s[6:7]
    v_lshrrev_b32 v13, 6, v0
    v_and_b32 v10, 31, v0
    v_readfirstlane_b32 s48, v13
    v_bfe_u32 v9, v0, 5, 1
    v_mul_u32_u24 v14, 896, v9
    v_lshl_add_u32 v14, v10, 4, v14
    v_cmp_gt_u32 vcc, 28, v10
    v_mov_b32 v15, 268435456
    s_mov_b32 s10, 1835008
    s_mov_b32 s11, 0x20000
    v_cndmask_b32 v14, v15, v14, vcc
    s_lshr_b32 s4, s48, 1
    s_and_b32 s5, s48, 1
    s_and_b32 s3, s2, 0xfe
    s_add_u32 s3, s3, s4
    s_lshl_b32 s3, s3, 1
    s_and_b32 s60, s2, 1
    s_add_u32 s3, s3, s60
    s_lshl_b32 s3, s3, 1
    s_add_u32 s3, s3, s5
    s_mul_i32 s3, s3, 1792
    s_waitcnt lgkmcnt(0)
    buffer_load_dwordx4 v[182:185], v14, s[8:11], s3 offen
    buffer_load_dwordx4 v[186:189], v14, s[8:11], s3 offen offset:448
    v_and_b32 v1, 63, v0
    s_mov_b32 s46, 256
    s_mov_b32 s47, 0x20000
    s_lshl_b32 s3, s48, 8
    s_add_u32 s3, s3, s2
    s_cmp_lt_u32 s3, 8
    s_cselect_b32 s3, 0, 268435456
    s_or_b32 s78, s78, 1
    v_mov_b32 v234, s78
    v_mov_b32 v235, 0
    v_lshlrev_b32 v11, 25, v1
    buffer_atomic_cmpswap v[234:235], v11, s[44:47], s3 offen sc1
    s_bfe_u32 s6, s2, 0x20001
    s_and_b32 s7, s2, 1
    s_and_b32 s61, s2, 7
    s_lshr_b32 s101, s2, 3
    s_mul_i32 s52, s7, 25
    s_add_u32 s52, s52, s101
    s_mul_i32 s51, s52, 37
    s_lshr_b32 s51, s51, 8
    s_mul_i32 s3, s51, 7
    s_sub_u32 s52, s52, s3
    s_and_b32 s3, s6, 1
    s_mul_i32 s3, s3, 6
    s_add_u32 s51, s51, s3
    s_add_u32 s51, s51, 1
    s_add_u32 s3, s3, s51
    s_cmp_eq_u32 s3, 7
    s_cselect_b32 s51, 0, s51
    s_lshr_b32 s59, s6, 1
    s_lshl_b32 s51, s51, 1
    s_add_u32 s51, s51, s59
    s_max_u32 s60, s101, 25
    s_sub_u32 s60, s60, 25
    s_add_u32 s3, s101, s7
    s_cmp_lt_u32 s3, 25
    s_cselect_b32 s55, 1, 0
    s_cselect_b32 s52, s52, s60
    s_mov_b32 s22, 7340032
    s_mov_b32 s23, 0x20000
    s_lshl_b32 s3, s52, 1
    s_sub_u32 s60, s3, 7
    s_cmp_ge_u32 s3, 7
    s_cselect_b32 s3, s60, s3
    s_and_b32 s3, s3, 7
    s_mul_i32 s60, s61, 2
    s_add_u32 s3, s3, s60
    s_and_b32 s3, s3, 7
    s_mul_i32 s0, s3, 458752
    s_lshl_b32 s1, s3, 13
    s_lshl_b32 s58, s48, 12
    v_lshrrev_b32 v3, 4, v1
    v_lshrrev_b32 v5, 3, v1
    v_and_b32 v6, 7, v1
    v_lshlrev_b32 v14, 1, v3
    v_xor_b32 v14, v14, v6
    v_lshlrev_b32 v83, 4, v14
    s_cmp_eq_u32 s55, 0
    s_cbranch_scc1 L_nog1
    v_mul_u32_u24 v14, 3584, v5
    s_lshl_b32 s3, s59, 5
    s_add_u32 s3, s3, s48
    s_mul_i32 s3, s3, 114688
    s_lshl_b32 s60, s51, 7
    s_add_u32 s3, s3, s60
    v_add3_u32 v55, v14, v83, s3
    v_add_u32 v56, 56320, v55
    v_add_u32 v57, 26624, v55
    v_add_u32 v58, 82944, v55
    s_mov_b32 s38, 3584
    s_mov_b32 s39, 0x20000
    v_lshlrev_b32 v13, 3, v3
    s_lshl_b32 s3, s51, 1
    s_add_u32 s3, s3, s4
    s_lshl_b32 s3, s3, 6
    buffer_load_dwordx2 v[246:247], v13, s[36:39], s3 offen offset:0
    buffer_load_dwordx2 v[248:249], v13, s[36:39], s3 offen offset:32
    s_add_u32 m0, s58, 0
    v_xor_b32 v55, 128, v55
    buffer_load_dwordx4 v55, s[20:23], s0 offen lds
    v_xor_b32 v56, 128, v56
    buffer_load_dwordx4 v56, s[20:23], s0 offen offset:1024 lds
    v_xor_b32 v57, 128, v57
    buffer_load_dwordx4 v57, s[20:23], s0 offen offset:2048 lds
    v_xor_b32 v58, 128, v58
    buffer_load_dwordx4 v58, s[20:23], s0 offen offset:3072 lds
    s_mul_i32 s53, s101, 37
    s_lshr_b32 s53, s53, 8
    s_mul_i32 s54, s53, 7
    s_sub_u32 s54, s101, s54
    s_and_b32 s53, s53, 3
    s_lshl_b32 s3, s6, 2
    s_add_u32 s53, s53, s3
    s_lshl_b32 s53, s53, 1
    s_add_u32 s53, s53, s7
    s_mov_b32 s42, 4096
    s_mov_b32 s43, 0x20000
    s_lshl_b32 s3, s53, 2
    s_add_u32 s3, s3, s48
    s_lshl_b32 s60, s3, 5
    v_lshl_add_u32 v82, v5, 1, s60
    s_mul_i32 s3, s3, 14336
    s_lshl_b32 s60, s54, 7
    s_add_u32 s3, s3, s60
    v_mul_u32_u24 v14, 896, v5
    v_lshl_add_u32 v14, v6, 4, v14
    v_add_u32 v85, s3, v14
    v_add_u32 v86, 7168, v85
    s_cmp_lt_u32 s101, 28
    s_cselect_b32 s56, 1, 0
    s_lshl_b32 s50, s7, 3
    s_and_b32 s3, s101, 7
    s_add_u32 s50, s50, s3
    s_lshr_b32 s60, s101, 3
    s_lshl_b32 s49, s6, 2
    s_add_u32 s49, s49, s60
    s_lshl_b32 s49, s49, 2
    s_add_u32 s49, s49, s48
    s_mul_i32 s60, s60, 0
    s_add_u32 s3, s3, s60
    s_sub_u32 s60, s3, 7
    s_cmp_ge_u32 s3, 7
    s_cselect_b32 s3, s60, s3
    s_lshl_b32 s62, s3, 18
    s_mul_i32 s63, s3, 12288
    s_mov_b32 s30, 20971520
    s_mov_b32 s31, 0x20000
    s_mov_b32 s75, 0x3727c5ac
    s_mov_b32 s76, 0x3b124925
    s_mov_b32 s77, 0x3f803f80
    v_lshlrev_b32 v4, 4, v1
    v_bfe_u32 v7, v1, 2, 2
    v_and_b32 v8, 3, v1
    v_mul_u32_u24 v13, 960, v9
    v_lshl_add_u32 v13, v10, 4, v13
    s_mul_i32 s3, s48, 1920
    s_add_u32 s3, s3, 147456
    v_add_u32 v230, s3, v13
    v_mul_u32_u24 v13, 960, v7
    v_lshl_add_u32 v13, v3, 5, v13
    v_lshl_add_u32 v13, v8, 3, v13
    s_lshl_b32 s3, s48, 8
    s_add_u32 s3, s3, 147456
    v_add_u32 v231, s3, v13
    s_lshl_b32 s3, s48, 3
    s_add_u32 s3, s3, 155648
    v_lshl_add_u32 v232, v9, 2, s3
    v_lshlrev_b32 v237, 2, v6
    v_and_b32 v2, 15, v1
    v_lshlrev_b32 v238, 14, v3
    v_add_lshl_u32 v238, v238, v2, 2
    v_add_u32 v237, 155648, v237
    v_lshlrev_b32 v13, 17, v9
    v_lshl_add_u32 v233, v10, 4, v13
    s_cmp_eq_u32 s48, 3
    s_cselect_b32 s60, 268435456, 0
    s_lshl_b32 s70, s48, 10
    s_add_u32 s70, s70, s2
    s_lshl_b32 s70, s70, 9
    s_add_u32 s71, s70, 262144
    s_add_u32 s71, s71, s60
    s_xor_b32 s60, s60, 268435456
    s_lshl_b32 s72, s2, 7
    s_add_u32 s72, s72, s60
    s_add_u32 s72, s72, 6291456
    s_lshr_b32 s74, s2, 2
    s_lshl_b32 s74, s74, 5
    s_and_b32 s3, s2, 3
    s_add_u32 s74, s74, s3
    s_lshl_b32 s74, s74, 2
    s_add_u32 s74, s74, 10485760
    v_cmp_gt_u32 vcc, 8, v0
    v_lshlrev_b32 v236, 13, v0
    v_mov_b32 v13, 268435456
    s_and_b32 s3, s2, 7
    s_lshl_b32 s3, s3, 13
    s_add_u32 s3, s3, 10485760
    v_lshrrev_b32 v14, 2, v0
    v_lshl_add_u32 v14, v14, 7, s3
    v_lshl_add_u32 v20, v8, 2, v14
    v_cndmask_b32 v236, v13, v236, vcc
    v_mov_b32 v16, 0
    s_lshl_b32 s3, s48, 14
    s_add_u32 s74, s74, s3
    s_add_u32 s73, s74, 8192
    s_waitcnt vmcnt(8)
    v_dot2_f32_bf16 v226, v182, s77, 0
    v_dot2_f32_bf16 v227, v182, v182, 0
    v_dot2_f32_bf16 v226, v183, s77, v226
    v_dot2_f32_bf16 v227, v183, v183, v227
    v_dot2_f32_bf16 v226, v184, s77, v226
    v_dot2_f32_bf16 v227, v184, v184, v227
    v_dot2_f32_bf16 v226, v185, s77, v226
    v_dot2_f32_bf16 v227, v185, v185, v227
    s_waitcnt vmcnt(7)
    v_dot2_f32_bf16 v226, v186, s77, v226
    v_dot2_f32_bf16 v227, v186, v186, v227
    v_dot2_f32_bf16 v226, v187, s77, v226
    v_dot2_f32_bf16 v227, v187, v187, v227
    v_dot2_f32_bf16 v226, v188, s77, v226
    v_dot2_f32_bf16 v227, v188, v188, v227
    v_dot2_f32_bf16 v226, v189, s77, v226
    v_dot2_f32_bf16 v227, v189, v189, v227
    buffer_load_dword v12, v16, s[44:47], 0 offen sc1
    v_lshlrev_b32 v190, 16, v182
    v_and_b32 v191, 0xffff0000, v182
    v_add_f32_dpp v226, v226, v226 quad_perm:[1,0,3,2] row_mask:0xf bank_mask:0xf
    v_add_f32_dpp v227, v227, v227 quad_perm:[1,0,3,2] row_mask:0xf bank_mask:0xf
    v_lshlrev_b32 v192, 16, v183
    v_add_f32_dpp v226, v226, v226 quad_perm:[2,3,0,1] row_mask:0xf bank_mask:0xf
    v_add_f32_dpp v227, v227, v227 quad_perm:[2,3,0,1] row_mask:0xf bank_mask:0xf
    v_and_b32 v193, 0xffff0000, v183
    v_add_f32_dpp v226, v226, v226 row_half_mirror row_mask:0xf bank_mask:0xf
    v_add_f32_dpp v227, v227, v227 row_half_mirror row_mask:0xf bank_mask:0xf
    v_lshlrev_b32 v194, 16, v184
    v_add_f32_dpp v226, v226, v226 row_mirror row_mask:0xf bank_mask:0xf
    v_add_f32_dpp v227, v227, v227 row_mirror row_mask:0xf bank_mask:0xf
    v_and_b32 v195, 0xffff0000, v184
    v_mov_b32 v228, v226
    v_mov_b32 v229, v227
    v_lshlrev_b32 v196, 16, v185
    v_permlane16_swap_b32 v226, v228
    v_permlane16_swap_b32 v227, v229
    v_add_f32 v226, v226, v228
    v_add_f32 v227, v227, v229
    v_mul_f32_e64 v226, -v226, s76
    v_mul_f32 v228, v226, v226
    v_fma_f32 v227, v227, s76, -v228
    v_max_f32 v227, 0, v227
    v_add_f32 v228, s75, v227
    v_rsq_f32 v222, v228
    v_and_b32 v197, 0xffff0000, v185
    v_mul_f32 v228, v222, v222
    v_fma_f32 v229, v228, v227, s75
    v_rsq_f32 v228, v229
    v_mul_f32 v223, v226, v222
    v_mul_f32 v224, v222, v228
    v_mul_f32 v225, v223, v228
    v_mul_f32 v229, v229, v228
    ds_write_b32 v232, v229
    v_lshlrev_b32 v198, 16, v186
    v_and_b32 v199, 0xffff0000, v186
    v_lshlrev_b32 v200, 16, v187
    v_and_b32 v201, 0xffff0000, v187
    v_lshlrev_b32 v202, 16, v188
    v_and_b32 v203, 0xffff0000, v188
    v_lshlrev_b32 v204, 16, v189
    v_and_b32 v205, 0xffff0000, v189
    v_pk_fma_f32 v[206:207], v[190:191], v[224:225], v[224:225] op_sel:[0,0,1] op_sel_hi:[1,0,1]
    v_pk_fma_f32 v[208:209], v[192:193], v[224:225], v[224:225] op_sel:[0,0,1] op_sel_hi:[1,0,1]
    v_pk_fma_f32 v[210:211], v[194:195], v[224:225], v[224:225] op_sel:[0,0,1] op_sel_hi:[1,0,1]
    v_pk_fma_f32 v[212:213], v[196:197], v[224:225], v[224:225] op_sel:[0,0,1] op_sel_hi:[1,0,1]
    v_cvt_pk_bf16_f32 v182, v206, v207
    v_cvt_pk_bf16_f32 v183, v208, v209
    v_cvt_pk_bf16_f32 v184, v210, v211
    v_cvt_pk_bf16_f32 v185, v212, v213
    ds_write_b128 v230, v[182:185] offset:0
    v_pk_fma_f32 v[214:215], v[198:199], v[224:225], v[224:225] op_sel:[0,0,1] op_sel_hi:[1,0,1]
    v_pk_fma_f32 v[216:217], v[200:201], v[224:225], v[224:225] op_sel:[0,0,1] op_sel_hi:[1,0,1]
    v_pk_fma_f32 v[218:219], v[202:203], v[224:225], v[224:225] op_sel:[0,0,1] op_sel_hi:[1,0,1]
    v_pk_fma_f32 v[220:221], v[204:205], v[224:225], v[224:225] op_sel:[0,0,1] op_sel_hi:[1,0,1]
    v_cvt_pk_bf16_f32 v186, v214, v215
    v_cvt_pk_bf16_f32 v187, v216, v217
    v_cvt_pk_bf16_f32 v188, v218, v219
    v_cvt_pk_bf16_f32 v189, v220, v221
    ds_write_b128 v230, v[186:189] offset:448
    s_waitcnt lgkmcnt(0)
    s_barrier
    ds_read_b64_tr_b16 v[110:111], v231 offset:0
    ds_read_b64_tr_b16 v[112:113], v231 offset:3840
    ds_read_b64_tr_b16 v[114:115], v231 offset:128
    ds_read_b64_tr_b16 v[116:117], v231 offset:3968
    ds_read_b32 v229, v237
    s_waitcnt lgkmcnt(3)
    buffer_store_dwordx4 v[110:113], v233, s[28:31], s70 offen sc1
    s_waitcnt lgkmcnt(1)
    buffer_store_dwordx4 v[114:117], v233, s[28:31], s71 offen sc1
    v_cmp_gt_u32 vcc, 16, v1
    s_waitcnt lgkmcnt(0)
    s_nop 0
    v_cndmask_b32 v229, 0, v229, vcc
    buffer_store_dword v229, v238, s[28:31], s72 offen sc1
    s_add_u32 m0, s58, 16384
    s_add_u32 s0, s0, 458752
    s_cmp_eq_u32 s0, 3670016
    s_cselect_b32 s0, 0, s0
    buffer_load_dwordx4 v55, s[20:23], s0 offen lds
    buffer_load_dwordx4 v56, s[20:23], s0 offen offset:1024 lds
    buffer_load_dwordx4 v57, s[20:23], s0 offen offset:2048 lds
    buffer_load_dwordx4 v58, s[20:23], s0 offen offset:3072 lds
    s_branch L_anchor
.p2align 12
L_anchor:
    s_mov_b32 s18, 401408
    s_mov_b32 s19, 0x20000
    s_mov_b32 s26, 7340032
    s_mov_b32 s27, 0x20000
    s_mov_b32 s34, 1835008
    s_mov_b32 s35, 0x20000
    s_mov_b32 s36, 1
    v_lshrrev_b32 v14, 2, v1
    v_lshlrev_b32 v14, 7, v14
    v_lshl_add_u32 v14, v8, 3, v14
    v_and_b32 v15, 3, v5
    v_lshl_add_u32 v14, v15, 5, v14
    s_mul_i32 s3, s4, 8256
    v_xor_b32 v31, s3, v14
    v_xor_b32 v32, 32, v31
    v_xor_b32 v33, 64, v31
    v_xor_b32 v34, 96, v31
    v_add_u32 v35, 65536, v31
    v_add_u32 v36, 65536, v32
    v_add_u32 v37, 65536, v33
    v_add_u32 v38, 65536, v34
    v_add_u32 v39, 131072, v31
    v_add_u32 v40, 131072, v32
    v_add_u32 v41, 131072, v33
    v_add_u32 v42, 131072, v34
    s_lshl_b32 s6, s52, 1
    s_add_u32 s6, s6, s5
    s_lshl_b32 s3, s6, 1
    s_add_u32 s3, s3, s59
    s_lshl_b32 s3, s3, 4
    s_add_u32 s3, s3, s4
    s_lshl_b32 s3, s3, 12
    v_lshl_add_u32 v78, v3, 8, v4
    v_add_u32 v78, s3, v78
    s_xor_b32 s37, s51, 1
    s_lshl_b32 s37, s37, 3
    s_add_u32 s37, s37, s52
    s_lshl_b32 s3, s37, 14
    s_add_u32 s3, s3, s58
    s_add_u32 s3, s3, 16777216
    v_add_u32 v23, s3, v4
    s_lshl_b32 s37, s37, 5
    s_add_u32 s37, s37, s5
    s_lshl_b32 s37, s37, 2
    s_add_u32 s37, s37, 6422528
    s_mul_i32 s67, s6, 56
    s_lshl_b32 s3, s51, 1
    s_add_u32 s3, s3, s4
    s_add_u32 s67, s67, s3
    s_lshl_b32 s67, s67, 11
    s_add_u32 s67, s67, 2097152
    v_add_u32 v81, s58, v4
    s_lshl_b32 s68, s52, 2
    s_and_b32 s3, s51, 1
    s_add_u32 s68, s68, s3
    s_cmp_ge_u32 s51, 14
    s_cselect_b32 s3, 2, 0
    s_add_u32 s68, s68, s3
    s_lshl_b32 s68, s68, 7
    s_add_u32 s68, s68, 6356992
    s_waitcnt vmcnt(7)
    v_readfirstlane_b32 s57, v12
    s_mov_b32 s60, 0
    s_cmp_lg_u32 s57, 0
    s_cbranch_scc0 L_nonce
L_nonce_ok:
    s_waitcnt vmcnt(4)
    s_barrier
    s_atomic_swap s57, s[28:29], s74
    s_atomic_swap s57, s[28:29], s73
    buffer_load_dwordx4 v[96:99], v85, s[8:11], 0 offen
    buffer_load_ushort v93, v82, s[40:43], 0 offen offset:0
    buffer_load_dwordx4 v[100:103], v86, s[8:11], 0 offen
    buffer_load_ushort v94, v82, s[40:43], 0 offen offset:16
    v_add_u32 v53, 65536, v4
    s_add_u32 m0, s58, 32768
    s_add_u32 s0, s0, 458752
    s_cmp_eq_u32 s0, 3670016
    s_cselect_b32 s0, 0, s0
    buffer_load_dwordx4 v55, s[20:23], s0 offen lds
    v_add_u32 v54, 131072, v4
    s_mul_i32 s59, s48, 3072
    s_mul_i32 s3, s50, 86016
    s_add_u32 s3, s3, s59
    s_add_u32 s3, s3, 8388608
    v_add_u32 v80, s3, v4
    v_lshlrev_b32 v14, 7, v9
    v_xor_b32 v14, v14, v4
    s_lshl_b32 s3, s49, 11
    v_add_u32 v67, s3, v14
    v_add_u32 v68, 129024, v67
    s_lshr_b32 s3, s49, 2
    s_lshl_b32 s3, s3, 3
    s_max_u32 s3, s3, 1
    s_sub_u32 s3, s3, 1
    s_lshl_b32 s3, s3, 10
    s_lshl_b32 s6, s5, 17
    s_add_u32 s3, s3, s6
    s_lshl_b32 s6, s4, 28
    s_add_u32 s3, s3, s6
    v_add_u32 v69, s3, v14
    buffer_load_dwordx4 v56, s[20:23], s0 offen offset:1024 lds
    s_lshl_b32 s100, s5, 1
    s_add_u32 s100, s100, s4
    s_lshl_b32 s100, s100, 10
    v_and_b32 v14, 1, v1
    v_mul_u32_u24 v14, 640, v14
    v_lshrrev_b32 v15, 2, v1
    v_lshlrev_b32 v15, 4, v15
    v_xor_b32 v14, v14, v15
    v_bfe_u32 v15, v1, 1, 1
    v_lshl_add_u32 v14, v15, 3, v14
    buffer_load_dwordx4 v57, s[20:23], s0 offen offset:2048 lds
    s_add_u32 s3, s58, 12288
    v_add_u32 v70, s3, v14
    s_sub_u32 s3, s3, 3072
    s_cmp_eq_u32 s48, 0
    s_cselect_b32 s3, 28672, s3
    v_add_u32 v71, s3, v14
    v_add_u32 v72, 65536, v70
    v_add_u32 v73, 65536, v71
    v_add_u32 v74, 131072, v70
    v_add_u32 v75, 131072, v71
    s_lshl_b32 s3, s49, 1
    v_min_u32 v14, 2, v3
    v_add_u32 v14, s3, v14
    v_max_u32 v14, 1, v14
    v_lshlrev_b32 v14, 1, v14
    v_and_b32 v15, 1, v7
    buffer_load_dwordx4 v58, s[20:23], s0 offen offset:3072 lds
    v_add_lshl_u32 v14, v14, v15, 7
    v_lshrrev_b32 v15, 1, v7
    v_lshl_add_u32 v15, v15, 2, v8
    v_lshl_add_u32 v14, v15, 2, v14
    v_add_u32 v77, 6291200, v14
    s_min_u32 s15, s48, 2
    s_lshl_b32 s15, s15, 6
    s_add_u32 s15, s15, 64
    s_lshl_b32 s82, s49, 5
    s_add_u32 s82, s82, s50
    s_lshl_b32 s82, s82, 10
    s_add_u32 s82, s82, 4194304
    s_lshr_b32 s69, s49, 2
    s_lshl_b32 s69, s69, 1
    s_and_b32 s3, s50, 1
    s_add_u32 s69, s69, s3
    s_lshl_b32 s69, s69, 7
    s_add_u32 s69, s69, 6361088
    s_and_b32 s7, s53, 1
    s_mul_i32 s3, s7, 28
    s_add_u32 s3, s3, s48
    s_lshl_b32 s3, s3, 17
    s_xor_b32 s6, s53, 1
    s_lshl_b32 s55, s6, 3
    s_lshl_b32 s6, s53, 7
    s_add_u32 s3, s3, s6
    v_lshlrev_b32 v14, 12, v5
    s_add_u32 m0, s58, 49152
    s_add_u32 s0, s0, 458752
    s_cmp_eq_u32 s0, 3670016
    s_cselect_b32 s0, 0, s0
    buffer_load_dwordx4 v55, s[20:23], s0 offen lds
    v_add3_u32 v59, v14, v83, s3
    v_add_u32 v60, 31744, v59
    v_add_u32 v61, 63488, v59
    v_add_u32 v62, 95232, v59
    v_mul_u32_u24 v14, 896, v5
    s_mul_i32 s3, s4, 25088
    s_mul_i32 s6, s5, 14336
    s_add_u32 s3, s3, s6
    s_lshl_b32 s6, s54, 7
    s_add_u32 s3, s3, s6
    v_add3_u32 v63, v14, v83, s3
    buffer_load_dwordx4 v56, s[20:23], s0 offen offset:1024 lds
    v_add_u32 v64, 6144, v63
    s_lshl_b32 s6, s53, 1
    s_add_u32 s6, s6, s5
    s_and_b32 s3, s53, 30
    s_add_u32 s3, s3, s4
    s_lshl_b32 s3, s3, 7
    s_add_u32 s39, s3, 6361088
    s_lshl_b32 s3, s6, 5
    s_add_u32 s3, s3, s4
    s_lshl_b32 s3, s3, 10
    s_add_u32 s3, s3, 4194304
    v_add_u32 v65, s3, v4
    v_add_u32 v66, 15360, v65
    s_xor_b32 s3, s4, s5
    s_lshl_b32 s3, s3, 6
    v_xor_b32 v43, s3, v31
    buffer_load_dwordx4 v57, s[20:23], s0 offen offset:2048 lds
    v_xor_b32 v44, 32, v43
    v_add_u32 v45, 65536, v43
    v_add_u32 v46, 65536, v44
    s_mul_i32 s3, s4, 12288
    v_add_u32 v47, s3, v4
    v_xor_b32 v48, 4096, v47
    v_add_u32 v49, 65536, v47
    v_add_u32 v50, 65536, v48
    v_add_u32 v51, 131072, v47
    v_add_u32 v52, 131072, v48
    s_lshl_b32 s6, s54, 1
    s_add_u32 s6, s6, s5
    s_lshl_b32 s3, s6, 1
    s_add_u32 s3, s3, s7
    s_mul_i32 s3, s3, 14
    s_add_u32 s3, s3, s4
    s_lshl_b32 s3, s3, 12
    s_add_u32 s3, s3, 2097152
    v_add_u32 v79, s3, v4
    buffer_load_dwordx4 v58, s[20:23], s0 offen offset:3072 lds
    s_lshl_b32 s3, s54, 1
    s_add_u32 s3, s3, s7
    s_lshl_b32 s3, s3, 1
    s_add_u32 s3, s3, s4
    s_lshl_b32 s3, s3, 7
    s_add_u32 s38, s3, 6356992
    s_and_b32 s3, s2, 6
    s_add_u32 s3, s3, s54
    s_sub_u32 s6, s3, 7
    s_cmp_ge_u32 s3, 7
    s_cselect_b32 s3, s6, s3
    s_lshl_b32 s64, s3, 19
    s_lshl_b32 s65, s3, 13
    s_add_u32 s55, s55, s54
    s_lshl_b32 s3, s55, 14
    s_add_u32 s3, s3, s58
    s_add_u32 s3, s3, 12582912
    v_add_u32 v21, s3, v4
    s_add_u32 m0, s58, 65536
    s_add_u32 s0, s0, 458752
    s_cmp_eq_u32 s0, 3670016
    s_cselect_b32 s0, 0, s0
    buffer_load_dwordx4 v55, s[20:23], s0 offen lds
    s_lshl_b32 s55, s55, 5
    s_add_u32 s55, s55, s48
    s_lshl_b32 s55, s55, 2
    s_add_u32 s55, s55, 6488064
    s_lshl_b32 s3, s5, 3
    v_add_u32 v13, s3, v3
    v_xor_b32 v13, v13, v6
    v_lshlrev_b32 v13, 4, v13
    v_lshl_add_u32 v13, v2, 8, v13
    buffer_load_dwordx4 v56, s[20:23], s0 offen offset:1024 lds
    s_lshl_b32 s3, s4, 14
    s_add_u32 s3, s3, 32768
    v_add_u32 v87, s3, v13
    v_xor_b32 v88, 64, v87
    s_lshr_b32 s3, s53, 1
    s_add_u32 s66, s3, s54
    s_mov_b32 s51, s66
    v_lshlrev_b32 v13, 1, v6
    v_xor_b32 v13, v13, v5
    v_lshlrev_b32 v13, 4, v13
    v_lshl_add_u32 v13, v5, 8, v13
    s_add_u32 s3, s58, 32768
    v_add_u32 v89, s3, v13
    v_xor_b32 v90, 16, v89
    v_xor_b32 v91, 24576, v89
    v_xor_b32 v92, 24592, v89
    buffer_load_dwordx4 v57, s[20:23], s0 offen offset:2048 lds
    v_lshlrev_b32 v150, 16, v246
    v_and_b32 v151, 0xffff0000, v246
    v_lshlrev_b32 v152, 16, v247
    v_and_b32 v153, 0xffff0000, v247
    v_lshlrev_b32 v154, 16, v248
    v_and_b32 v155, 0xffff0000, v248
    v_lshlrev_b32 v156, 16, v249
    v_and_b32 v157, 0xffff0000, v249
    v_lshlrev_b32 v158, 16, v246
    v_and_b32 v159, 0xffff0000, v246
    v_lshlrev_b32 v160, 16, v247
    v_and_b32 v161, 0xffff0000, v247
    v_lshlrev_b32 v162, 16, v248
    v_and_b32 v163, 0xffff0000, v248
    v_lshlrev_b32 v164, 16, v249
    v_and_b32 v165, 0xffff0000, v249
    buffer_load_dwordx4 v58, s[20:23], s0 offen offset:3072 lds
    s_add_u32 m0, s58, 81920
    s_add_u32 s0, s0, 458752
    s_cmp_eq_u32 s0, 3670016
    s_cselect_b32 s0, 0, s0
    buffer_load_dwordx4 v55, s[20:23], s0 offen lds
    buffer_load_dwordx4 v56, s[20:23], s0 offen offset:1024 lds
    buffer_load_dwordx4 v57, s[20:23], s0 offen offset:2048 lds
    buffer_load_dwordx4 v58, s[20:23], s0 offen offset:3072 lds
    s_add_u32 m0, s58, 98304
    s_add_u32 s0, s0, 458752
    s_cmp_eq_u32 s0, 3670016
    s_cselect_b32 s0, 0, s0
    buffer_load_dwordx4 v55, s[20:23], s0 offen lds
    buffer_load_dwordx4 v56, s[20:23], s0 offen offset:1024 lds
    buffer_load_dwordx4 v57, s[20:23], s0 offen offset:2048 lds
    buffer_load_dwordx4 v58, s[20:23], s0 offen offset:3072 lds
    buffer_load_dword v18, v20, s[28:31], 0 offen sc1
    s_add_u32 m0, s58, 114688
    s_add_u32 s0, s0, 458752
    s_cmp_eq_u32 s0, 3670016
    s_cselect_b32 s0, 0, s0
    buffer_load_dwordx4 v55, s[20:23], s0 offen lds
    buffer_load_dwordx4 v56, s[20:23], s0 offen offset:1024 lds
    buffer_load_dwordx4 v57, s[20:23], s0 offen offset:2048 lds
    buffer_load_dwordx4 v58, s[20:23], s0 offen offset:3072 lds
    s_mov_b32 s3, s48
    s_mov_b64 exec, 0
L_warm:
    s_add_u32 s3, s3, 4
    s_cmp_eq_u32 s3, 4
    s_cbranch_scc1 L_pad0
    s_cmp_eq_u32 s3, 5
    s_cbranch_scc1 L_pad1
    s_cmp_eq_u32 s3, 6
    s_cbranch_scc1 L_pad2
    s_cmp_eq_u32 s3, 7
    s_cbranch_scc1 L_pad3
    s_cmp_eq_u32 s3, 8
    s_cbranch_scc1 L_pad4
    s_mov_b64 exec, -1
    s_waitcnt vmcnt(4)
    v_cmp_ne_u32 vcc, s57, v18
    s_cbranch_vccnz L_pollin0
L_pollok0:
    s_barrier
    buffer_load_dwordx4 a[0:3], v78, s[28:31], s1 offen offset:0 sc1
    buffer_load_dwordx4 a[4:7], v78, s[28:31], s1 offen offset:256 sc1
    buffer_load_dwordx4 a[8:11], v78, s[28:31], s1 offen offset:2048 sc1
    buffer_load_dwordx4 a[12:15], v78, s[28:31], s1 offen offset:2304 sc1
    buffer_load_dword v76, v77, s[28:31], 0 offen sc1
    s_add_u32 s1, s1, 8192
    s_and_b32 s1, s1, 0xffff
    buffer_load_dwordx4 a[16:19], v78, s[28:31], s1 offen offset:0 sc1
    buffer_load_dwordx4 a[20:23], v78, s[28:31], s1 offen offset:256 sc1
    buffer_load_dwordx4 a[24:27], v78, s[28:31], s1 offen offset:2048 sc1
    buffer_load_dwordx4 a[28:31], v78, s[28:31], s1 offen offset:2304 sc1
    s_add_u32 s1, s1, 8192
    s_and_b32 s1, s1, 0xffff
    buffer_load_dwordx4 a[32:35], v78, s[28:31], s1 offen offset:0 sc1
    buffer_load_dwordx4 a[36:39], v78, s[28:31], s1 offen offset:256 sc1
    buffer_load_dwordx4 a[40:43], v78, s[28:31], s1 offen offset:2048 sc1
    buffer_load_dwordx4 a[44:47], v78, s[28:31], s1 offen offset:2304 sc1
    ds_read_b64_tr_b16 a[200:201], v31 offset:0
    ds_read_b64_tr_b16 a[202:203], v31 offset:2048
    ds_read_b64_tr_b16 a[204:205], v33 offset:0
    ds_read_b64_tr_b16 a[206:207], v33 offset:2048
    ds_read_b64_tr_b16 a[208:209], v32 offset:0
    ds_read_b64_tr_b16 a[210:211], v32 offset:2048
    ds_read_b64_tr_b16 a[212:213], v34 offset:0
    ds_read_b64_tr_b16 a[214:215], v34 offset:2048
    ds_read_b64_tr_b16 a[216:217], v31 offset:4096
    ds_read_b64_tr_b16 a[218:219], v31 offset:6144
    ds_read_b64_tr_b16 a[220:221], v33 offset:4096
    ds_read_b64_tr_b16 a[222:223], v33 offset:6144
    s_waitcnt vmcnt(11) lgkmcnt(8)
    v_mfma_f32_16x16x32_bf16 v[182:185], a[200:203], a[0:3], 0
    ds_read_b64_tr_b16 a[224:225], v32 offset:4096
    s_add_u32 s1, s1, 8192
    v_mfma_f32_16x16x32_bf16 v[190:193], a[200:203], a[4:7], 0
    ds_read_b64_tr_b16 a[226:227], v32 offset:6144
    s_and_b32 s1, s1, 0xffff
    s_mov_b32 s70, 0xaaaaaaaa
    s_mov_b32 s71, 0xaaaaaaaa
    s_mov_b32 s72, 0xfff0ffff
    s_mov_b32 s73, 0xf000ff00
    s_mov_b32 s74, 0xffc0fffc
    v_mfma_f32_16x16x32_bf16 v[198:201], a[204:207], a[0:3], 0
    ds_read_b64_tr_b16 a[228:229], v34 offset:4096
    buffer_load_dwordx4 a[48:51], v78, s[28:31], s1 offen offset:0 sc1
    v_mfma_f32_16x16x32_bf16 v[206:209], a[204:207], a[4:7], 0
    ds_read_b64_tr_b16 a[230:231], v34 offset:6144
    s_mov_b32 s75, 0xc000fc00
    s_waitcnt lgkmcnt(8)
    v_mfma_f32_16x16x32_bf16 v[186:189], a[208:211], a[0:3], 0
    ds_read_b64_tr_b16 a[200:201], v31 offset:16384
    s_mov_b32 s83, 0x3e8b97f6
    v_mfma_f32_16x16x32_bf16 v[194:197], a[208:211], a[4:7], 0
    ds_read_b64_tr_b16 a[202:203], v31 offset:18432
    buffer_load_dwordx4 a[52:55], v78, s[28:31], s1 offen offset:256 sc1
    v_lshlrev_b32 v13, 2, v2
    v_mfma_f32_16x16x32_bf16 v[202:205], a[212:215], a[0:3], 0
    ds_read_b64_tr_b16 a[204:205], v33 offset:16384
    v_and_b32 v14, 1, v1
    v_mfma_f32_16x16x32_bf16 v[210:213], a[212:215], a[4:7], 0
    ds_read_b64_tr_b16 a[206:207], v33 offset:18432
    s_waitcnt vmcnt(11) lgkmcnt(8)
    v_mfma_f32_16x16x32_bf16 v[182:185], a[216:219], a[8:11], v[182:185]
    ds_read_b64_tr_b16 a[208:209], v32 offset:16384
    buffer_load_dwordx4 a[56:59], v78, s[28:31], s1 offen offset:2048 sc1
    v_mfma_f32_16x16x32_bf16 v[190:193], a[216:219], a[12:15], v[190:193]
    ds_read_b64_tr_b16 a[210:211], v32 offset:18432
    v_lshl_add_u32 v14, v3, 2, v14
    v_mfma_f32_16x16x32_bf16 v[198:201], a[220:223], a[8:11], v[198:201]
    ds_read_b64_tr_b16 a[212:213], v34 offset:16384
    v_lshlrev_b32 v14, 2, v14
    v_mfma_f32_16x16x32_bf16 v[206:209], a[220:223], a[12:15], v[206:209]
    ds_read_b64_tr_b16 a[214:215], v34 offset:18432
    s_waitcnt lgkmcnt(8)
    v_mfma_f32_16x16x32_bf16 v[186:189], a[224:227], a[8:11], v[186:189]
    ds_read_b64_tr_b16 a[216:217], v31 offset:20480
    buffer_load_dwordx4 a[60:63], v78, s[28:31], s1 offen offset:2304 sc1
    v_mfma_f32_16x16x32_bf16 v[194:197], a[224:227], a[12:15], v[194:197]
    ds_read_b64_tr_b16 a[218:219], v31 offset:22528
    s_add_u32 s1, s1, 8192
    v_add_u32 v15, 64, v14
    v_mfma_f32_16x16x32_bf16 v[202:205], a[228:231], a[8:11], v[202:205]
    ds_read_b64_tr_b16 a[220:221], v33 offset:20480
    s_and_b32 s1, s1, 0xffff
    v_mfma_f32_16x16x32_bf16 v[210:213], a[228:231], a[12:15], v[210:213]
    ds_read_b64_tr_b16 a[222:223], v33 offset:22528
    s_waitcnt vmcnt(10) lgkmcnt(8)
    v_mfma_f32_16x16x32_bf16 v[182:185], a[200:203], a[16:19], v[182:185]
    ds_read_b64_tr_b16 a[224:225], v32 offset:20480
    buffer_load_dwordx4 a[64:67], v78, s[28:31], s1 offen offset:0 sc1
    v_mfma_f32_16x16x32_bf16 v[190:193], a[200:203], a[20:23], v[190:193]
    ds_read_b64_tr_b16 a[226:227], v32 offset:22528
    v_cndmask_b32 v16, v14, v15, s[72:73]
    v_mfma_f32_16x16x32_bf16 v[198:201], a[204:207], a[16:19], v[198:201]
    ds_read_b64_tr_b16 a[228:229], v34 offset:20480
    buffer_load_dwordx4 a[68:71], v78, s[28:31], s1 offen offset:256 sc1
    v_mfma_f32_16x16x32_bf16 v[206:209], a[204:207], a[20:23], v[206:209]
    ds_read_b64_tr_b16 a[230:231], v34 offset:22528
    v_cndmask_b32 v14, v14, v15, s[74:75]
    s_waitcnt lgkmcnt(8)
    v_mfma_f32_16x16x32_bf16 v[186:189], a[208:211], a[16:19], v[186:189]
    ds_read_b64_tr_b16 a[200:201], v31 offset:32768
    ds_bpermute_b32 v25, v13, v76 offset:64
    v_mfma_f32_16x16x32_bf16 v[194:197], a[208:211], a[20:23], v[194:197]
    ds_read_b64_tr_b16 a[202:203], v31 offset:34816
    buffer_load_dwordx4 a[72:75], v78, s[28:31], s1 offen offset:2048 sc1
    ds_bpermute_b32 v27, v16, v76 offset:0
    v_mfma_f32_16x16x32_bf16 v[202:205], a[212:215], a[16:19], v[202:205]
    ds_read_b64_tr_b16 a[204:205], v33 offset:32768
    ds_bpermute_b32 v28, v14, v76 offset:8
    v_mfma_f32_16x16x32_bf16 v[210:213], a[212:215], a[20:23], v[210:213]
    ds_read_b64_tr_b16 a[206:207], v33 offset:34816
    s_waitcnt vmcnt(11) lgkmcnt(11)
    v_mfma_f32_16x16x32_bf16 v[182:185], a[216:219], a[24:27], v[182:185]
    ds_read_b64_tr_b16 a[208:209], v32 offset:32768
    ds_bpermute_b32 v26, v13, v76 offset:128
    v_mfma_f32_16x16x32_bf16 v[190:193], a[216:219], a[28:31], v[190:193]
    ds_read_b64_tr_b16 a[210:211], v32 offset:34816
    buffer_load_dwordx4 a[76:79], v78, s[28:31], s1 offen offset:2304 sc1
    ds_bpermute_b32 v29, v16, v76 offset:64
    v_mfma_f32_16x16x32_bf16 v[198:201], a[220:223], a[24:27], v[198:201]
    ds_read_b64_tr_b16 a[212:213], v34 offset:32768
    s_add_u32 s1, s1, 8192
    v_mfma_f32_16x16x32_bf16 v[206:209], a[220:223], a[28:31], v[206:209]
    ds_read_b64_tr_b16 a[214:215], v34 offset:34816
    s_waitcnt lgkmcnt(13)
    v_mfma_f32_16x16x32_bf16 v[186:189], a[224:227], a[24:27], v[186:189]
    ds_read_b64_tr_b16 a[216:217], v31 offset:36864
    s_and_b32 s1, s1, 0xffff
    v_mfma_f32_16x16x32_bf16 v[194:197], a[224:227], a[28:31], v[194:197]
    ds_read_b64_tr_b16 a[218:219], v31 offset:38912
    buffer_load_dwordx4 a[80:83], v78, s[28:31], s1 offen offset:0 sc1
    ds_bpermute_b32 v30, v14, v76 offset:72
    v_mfma_f32_16x16x32_bf16 v[202:205], a[228:231], a[24:27], v[202:205]
    ds_read_b64_tr_b16 a[220:221], v33 offset:36864
    v_mfma_f32_16x16x32_bf16 v[210:213], a[228:231], a[28:31], v[210:213]
    ds_read_b64_tr_b16 a[222:223], v33 offset:38912
    s_waitcnt vmcnt(11) lgkmcnt(11)
    v_mfma_f32_16x16x32_bf16 v[182:185], a[200:203], a[32:35], v[182:185]
    ds_read_b64_tr_b16 a[224:225], v32 offset:36864
    buffer_load_dwordx4 a[84:87], v78, s[28:31], s1 offen offset:256 sc1
    v_mfma_f32_16x16x32_bf16 v[190:193], a[200:203], a[36:39], v[190:193]
    ds_read_b64_tr_b16 a[226:227], v32 offset:38912
    v_mfma_f32_16x16x32_bf16 v[198:201], a[204:207], a[32:35], v[198:201]
    ds_read_b64_tr_b16 a[228:229], v34 offset:36864
    v_mfma_f32_16x16x32_bf16 v[206:209], a[204:207], a[36:39], v[206:209]
    ds_read_b64_tr_b16 a[230:231], v34 offset:38912
    s_waitcnt lgkmcnt(9)
    v_mfma_f32_16x16x32_bf16 v[186:189], a[208:211], a[32:35], v[186:189]
    s_barrier
    ds_read_b64_tr_b16 a[200:201], v31 offset:49152
    buffer_load_dwordx4 a[88:91], v78, s[28:31], s1 offen offset:2048 sc1
    v_mfma_f32_16x16x32_bf16 v[194:197], a[208:211], a[36:39], v[194:197]
    ds_read_b64_tr_b16 a[202:203], v31 offset:51200
    v_mfma_f32_16x16x32_bf16 v[202:205], a[212:215], a[32:35], v[202:205]
    ds_read_b64_tr_b16 a[204:205], v33 offset:49152
    buffer_load_dwordx4 a[92:95], v78, s[28:31], s1 offen offset:2304 sc1
    v_mfma_f32_16x16x32_bf16 v[210:213], a[212:215], a[36:39], v[210:213]
    ds_read_b64_tr_b16 a[206:207], v33 offset:51200
    s_waitcnt vmcnt(12) lgkmcnt(8)
    v_mfma_f32_16x16x32_bf16 v[182:185], a[216:219], a[40:43], v[182:185]
    ds_read_b64_tr_b16 a[208:209], v32 offset:49152
    s_add_u32 m0, s58, 131072
    v_mfma_f32_16x16x32_bf16 v[190:193], a[216:219], a[44:47], v[190:193]
    ds_read_b64_tr_b16 a[210:211], v32 offset:51200
    s_add_u32 s0, s0, 458752
    v_mul_f32 v25, s83, v25
    v_mfma_f32_16x16x32_bf16 v[198:201], a[220:223], a[40:43], v[198:201]
    ds_read_b64_tr_b16 a[212:213], v34 offset:49152
    s_cmp_eq_u32 s0, 3670016
    v_mfma_f32_16x16x32_bf16 v[206:209], a[220:223], a[44:47], v[206:209]
    ds_read_b64_tr_b16 a[214:215], v34 offset:51200
    s_cselect_b32 s0, 0, s0
    v_xor_b32 v55, 128, v55
    buffer_load_dwordx4 v55, s[20:23], s0 offen lds
    s_waitcnt lgkmcnt(8)
    v_mfma_f32_16x16x32_bf16 v[186:189], a[224:227], a[40:43], v[186:189]
    ds_read_b64_tr_b16 a[216:217], v31 offset:53248
    v_xor_b32 v56, 128, v56
    v_mfma_f32_16x16x32_bf16 v[194:197], a[224:227], a[44:47], v[194:197]
    ds_read_b64_tr_b16 a[218:219], v31 offset:55296
    buffer_load_dwordx4 v56, s[20:23], s0 offen offset:1024 lds
    v_mul_f32 v26, s83, v26
    v_mfma_f32_16x16x32_bf16 v[202:205], a[228:231], a[40:43], v[202:205]
    ds_read_b64_tr_b16 a[220:221], v33 offset:53248
    v_xor_b32 v57, 128, v57
    v_mfma_f32_16x16x32_bf16 v[210:213], a[228:231], a[44:47], v[210:213]
    ds_read_b64_tr_b16 a[222:223], v33 offset:55296
    s_waitcnt vmcnt(12) lgkmcnt(8)
    v_mfma_f32_16x16x32_bf16 v[182:185], a[200:203], a[48:51], v[182:185]
    ds_read_b64_tr_b16 a[224:225], v32 offset:53248
    buffer_load_dwordx4 v57, s[20:23], s0 offen offset:2048 lds
    v_mfma_f32_16x16x32_bf16 v[190:193], a[200:203], a[52:55], v[190:193]
    ds_read_b64_tr_b16 a[226:227], v32 offset:55296
    v_xor_b32 v58, 128, v58
    s_cmp_eq_u32 s49, 0
    s_cselect_b64 s[76:77], 0, -1
    v_mfma_f32_16x16x32_bf16 v[198:201], a[204:207], a[48:51], v[198:201]
    ds_read_b64_tr_b16 a[228:229], v34 offset:53248
    v_mov_b32 v13, 0xffff
    v_mfma_f32_16x16x32_bf16 v[206:209], a[204:207], a[52:55], v[206:209]
    ds_read_b64_tr_b16 a[230:231], v34 offset:55296
    s_waitcnt lgkmcnt(8)
    v_mfma_f32_16x16x32_bf16 v[186:189], a[208:211], a[48:51], v[186:189]
    ds_read_b64_tr_b16 a[200:201], v35 offset:0
    buffer_load_dwordx4 v58, s[20:23], s0 offen offset:3072 lds
    v_mfma_f32_16x16x32_bf16 v[194:197], a[208:211], a[52:55], v[194:197]
    ds_read_b64_tr_b16 a[202:203], v35 offset:2048
    s_add_u32 s1, s1, 8192
    v_mov_b32 v14, 0xffff0000
    v_mfma_f32_16x16x32_bf16 v[202:205], a[212:215], a[48:51], v[202:205]
    ds_read_b64_tr_b16 a[204:205], v37 offset:0
    s_and_b32 s1, s1, 0xffff
    v_mfma_f32_16x16x32_bf16 v[210:213], a[212:215], a[52:55], v[210:213]
    ds_read_b64_tr_b16 a[206:207], v37 offset:2048
    v_cndmask_b32 v13, v13, v14, s[70:71]
    s_waitcnt vmcnt(12) lgkmcnt(8)
    v_mfma_f32_16x16x32_bf16 v[182:185], a[216:219], a[56:59], v[182:185]
    ds_read_b64_tr_b16 a[208:209], v36 offset:0
    buffer_load_dwordx4 a[96:99], v78, s[28:31], s1 offen offset:0 sc1
    v_mfma_f32_16x16x32_bf16 v[190:193], a[216:219], a[60:63], v[190:193]
    ds_read_b64_tr_b16 a[210:211], v36 offset:2048
    v_cndmask_b32 v104, v13, 0, s[72:73]
    v_mfma_f32_16x16x32_bf16 v[198:201], a[220:223], a[56:59], v[198:201]
    ds_read_b64_tr_b16 a[212:213], v38 offset:0
    buffer_load_dwordx4 a[100:103], v78, s[28:31], s1 offen offset:256 sc1
    v_mfma_f32_16x16x32_bf16 v[206:209], a[220:223], a[60:63], v[206:209]
    ds_read_b64_tr_b16 a[214:215], v38 offset:2048
    v_cndmask_b32 v106, 0, v13, s[72:73]
    s_waitcnt lgkmcnt(8)
    v_mfma_f32_16x16x32_bf16 v[186:189], a[224:227], a[56:59], v[186:189]
    ds_read_b64_tr_b16 a[216:217], v35 offset:4096
    v_cndmask_b32 v105, v13, 0, s[74:75]
    v_mfma_f32_16x16x32_bf16 v[194:197], a[224:227], a[60:63], v[194:197]
    ds_read_b64_tr_b16 a[218:219], v35 offset:6144
    buffer_load_dwordx4 a[104:107], v78, s[28:31], s1 offen offset:2048 sc1
    v_cndmask_b32 v107, 0, v13, s[74:75]
    v_mfma_f32_16x16x32_bf16 v[202:205], a[228:231], a[56:59], v[202:205]
    ds_read_b64_tr_b16 a[220:221], v37 offset:4096
    v_mov_b32 v84, 0xf149f2ca
    v_mfma_f32_16x16x32_bf16 v[210:213], a[228:231], a[60:63], v[210:213]
    ds_read_b64_tr_b16 a[222:223], v37 offset:6144
    s_waitcnt vmcnt(13) lgkmcnt(8)
    v_mfma_f32_16x16x32_bf16 v[182:185], a[200:203], a[64:67], v[182:185]
    ds_read_b64_tr_b16 a[224:225], v36 offset:4096
    buffer_load_dwordx4 a[108:111], v78, s[28:31], s1 offen offset:2304 sc1
    v_mfma_f32_16x16x32_bf16 v[190:193], a[200:203], a[68:71], v[190:193]
    ds_read_b64_tr_b16 a[226:227], v36 offset:6144
    s_add_u32 m0, s58, 147456
    s_mov_b32 s83, 0x3e8b97f6
    v_mfma_f32_16x16x32_bf16 v[198:201], a[204:207], a[64:67], v[198:201]
    ds_read_b64_tr_b16 a[228:229], v38 offset:4096
    s_add_u32 s0, s0, 458752
    v_mfma_f32_16x16x32_bf16 v[206:209], a[204:207], a[68:71], v[206:209]
    ds_read_b64_tr_b16 a[230:231], v38 offset:6144
    s_mov_b32 s78, 0xbdd2d3e8
    s_mov_b32 s79, 0xbdd2d3e8
    s_waitcnt lgkmcnt(8)
    v_mfma_f32_16x16x32_bf16 v[186:189], a[208:211], a[64:67], v[186:189]
    s_barrier
    s_load_dword s14, s[44:45], s15
    ds_read_b64_tr_b16 a[200:201], v35 offset:16384
    s_cmp_eq_u32 s0, 3670016
    s_cselect_b32 s0, 0, s0
    buffer_load_dwordx4 v55, s[20:23], s0 offen lds
    v_mfma_f32_16x16x32_bf16 v[194:197], a[208:211], a[68:71], v[194:197]
    ds_read_b64_tr_b16 a[202:203], v35 offset:18432
    s_mov_b32 s80, 1.0
    v_mfma_f32_16x16x32_bf16 v[202:205], a[212:215], a[64:67], v[202:205]
    ds_read_b64_tr_b16 a[204:205], v37 offset:16384
    buffer_load_dwordx4 v56, s[20:23], s0 offen offset:1024 lds
    v_mfma_f32_16x16x32_bf16 v[210:213], a[212:215], a[68:71], v[210:213]
    ds_read_b64_tr_b16 a[206:207], v37 offset:18432
    s_mov_b32 s81, 1.0
    s_waitcnt vmcnt(14) lgkmcnt(8)
    v_mfma_f32_16x16x32_bf16 v[182:185], a[216:219], a[72:75], v[182:185]
    ds_read_b64_tr_b16 a[208:209], v36 offset:16384
    v_mov_b32 v108, 0xc0135761
    v_mfma_f32_16x16x32_bf16 v[190:193], a[216:219], a[76:79], v[190:193]
    ds_read_b64_tr_b16 a[210:211], v36 offset:18432
    buffer_load_dwordx4 v57, s[20:23], s0 offen offset:2048 lds
    v_mov_b32 v109, 0xc0135761
    v_mfma_f32_16x16x32_bf16 v[198:201], a[220:223], a[72:75], v[198:201]
    ds_read_b64_tr_b16 a[212:213], v38 offset:16384
    v_lshrrev_b32 v13, 1, v2
    v_mfma_f32_16x16x32_bf16 v[206:209], a[220:223], a[76:79], v[206:209]
    ds_read_b64_tr_b16 a[214:215], v38 offset:18432
    s_waitcnt lgkmcnt(8)
    v_mfma_f32_16x16x32_bf16 v[186:189], a[224:227], a[72:75], v[186:189]
    ds_read_b64_tr_b16 a[216:217], v35 offset:20480
    buffer_load_dwordx4 v58, s[20:23], s0 offen offset:3072 lds
    v_mfma_f32_16x16x32_bf16 v[194:197], a[224:227], a[76:79], v[194:197]
    ds_read_b64_tr_b16 a[218:219], v35 offset:22528
    s_add_u32 s1, s1, 8192
    v_lshlrev_b32 v14, 1, v3
    v_mfma_f32_16x16x32_bf16 v[202:205], a[228:231], a[72:75], v[202:205]
    ds_read_b64_tr_b16 a[220:221], v37 offset:20480
    s_and_b32 s1, s1, 0xffff
    v_mfma_f32_16x16x32_bf16 v[210:213], a[228:231], a[76:79], v[210:213]
    ds_read_b64_tr_b16 a[222:223], v37 offset:22528
    s_waitcnt vmcnt(14) lgkmcnt(8)
    v_mfma_f32_16x16x32_bf16 v[182:185], a[200:203], a[80:83], v[182:185]
    ds_read_b64_tr_b16 a[224:225], v36 offset:20480
    buffer_load_dwordx4 a[112:115], v78, s[28:31], s1 offen offset:0 sc1
    v_mfma_f32_16x16x32_bf16 v[190:193], a[200:203], a[84:87], v[190:193]
    ds_read_b64_tr_b16 a[226:227], v36 offset:22528
L_pad0:
    s_cbranch_execz L_warm
    v_sub_u32 v13, v13, v14
    v_mfma_f32_16x16x32_bf16 v[198:201], a[204:207], a[80:83], v[198:201]
    ds_read_b64_tr_b16 a[228:229], v38 offset:20480
    buffer_load_dwordx4 a[116:119], v78, s[28:31], s1 offen offset:256 sc1
    v_mfma_f32_16x16x32_bf16 v[206:209], a[204:207], a[84:87], v[206:209]
    ds_read_b64_tr_b16 a[230:231], v38 offset:22528
    v_mov_b32 v14, 0x3f80
    s_waitcnt lgkmcnt(8)
    v_mfma_f32_16x16x32_bf16 v[186:189], a[208:211], a[80:83], v[186:189]
    ds_read_b64_tr_b16 a[200:201], v35 offset:32768
    v_cndmask_b32 v14, v14, 1.0, s[70:71]
    v_mfma_f32_16x16x32_bf16 v[194:197], a[208:211], a[84:87], v[194:197]
    ds_read_b64_tr_b16 a[202:203], v35 offset:34816
    buffer_load_dwordx4 a[120:123], v78, s[28:31], s1 offen offset:2048 sc1
    v_cmp_eq_i32 vcc, 0, v13
    v_mfma_f32_16x16x32_bf16 v[202:205], a[212:215], a[80:83], v[202:205]
    ds_read_b64_tr_b16 a[204:205], v37 offset:32768
    v_accvgpr_write_b32 a248, 0
    v_mfma_f32_16x16x32_bf16 v[210:213], a[212:215], a[84:87], v[210:213]
    ds_read_b64_tr_b16 a[206:207], v37 offset:34816
    s_waitcnt vmcnt(15) lgkmcnt(8)
    v_mfma_f32_16x16x32_bf16 v[182:185], a[216:219], a[88:91], v[182:185]
    ds_read_b64_tr_b16 a[208:209], v36 offset:32768
    buffer_load_dwordx4 a[124:127], v78, s[28:31], s1 offen offset:2304 sc1
    v_mfma_f32_16x16x32_bf16 v[190:193], a[216:219], a[92:95], v[190:193]
    ds_read_b64_tr_b16 a[210:211], v36 offset:34816
    s_add_u32 m0, s58, 0
    v_accvgpr_write_b32 a252, 0
    v_mfma_f32_16x16x32_bf16 v[198:201], a[220:223], a[88:91], v[198:201]
    ds_read_b64_tr_b16 a[212:213], v38 offset:32768
    s_add_u32 s0, s0, 458752
    v_mfma_f32_16x16x32_bf16 v[206:209], a[220:223], a[92:95], v[206:209]
    ds_read_b64_tr_b16 a[214:215], v38 offset:34816
    s_waitcnt lgkmcnt(8)
    v_mfma_f32_16x16x32_bf16 v[186:189], a[224:227], a[88:91], v[186:189]
    ds_read_b64_tr_b16 a[216:217], v35 offset:36864
    s_cmp_eq_u32 s0, 3670016
    v_mfma_f32_16x16x32_bf16 v[194:197], a[224:227], a[92:95], v[194:197]
    ds_read_b64_tr_b16 a[218:219], v35 offset:38912
    s_cselect_b32 s0, 0, s0
    buffer_load_dwordx4 v55, s[20:23], s0 offen lds
    v_cndmask_b32 v15, 0, v14, vcc
    v_mfma_f32_16x16x32_bf16 v[202:205], a[228:231], a[88:91], v[202:205]
    ds_read_b64_tr_b16 a[220:221], v37 offset:36864
    v_accvgpr_write_b32 a250, v15
    v_mfma_f32_16x16x32_bf16 v[210:213], a[228:231], a[92:95], v[210:213]
    ds_read_b64_tr_b16 a[222:223], v37 offset:38912
    s_waitcnt vmcnt(11) lgkmcnt(8)
    v_mfma_f32_16x16x32_bf16 v[182:185], a[200:203], a[96:99], v[182:185]
    ds_read_b64_tr_b16 a[224:225], v36 offset:36864
    buffer_load_dwordx4 v56, s[20:23], s0 offen offset:1024 lds
    v_mfma_f32_16x16x32_bf16 v[190:193], a[200:203], a[100:103], v[190:193]
    ds_read_b64_tr_b16 a[226:227], v36 offset:38912
    v_cmp_eq_i32 vcc, 1, v13
    v_mfma_f32_16x16x32_bf16 v[198:201], a[204:207], a[96:99], v[198:201]
    ds_read_b64_tr_b16 a[228:229], v38 offset:36864
    buffer_load_dwordx4 v57, s[20:23], s0 offen offset:2048 lds
    v_mfma_f32_16x16x32_bf16 v[206:209], a[204:207], a[100:103], v[206:209]
    ds_read_b64_tr_b16 a[230:231], v38 offset:38912
    v_accvgpr_write_b32 a249, 0
    s_waitcnt lgkmcnt(8)
    v_mfma_f32_16x16x32_bf16 v[186:189], a[208:211], a[96:99], v[186:189]
    s_waitcnt vmcnt(7)
    s_barrier
    ds_read_b64_tr_b16 a[200:201], v35 offset:49152
    buffer_load_dwordx4 v58, s[20:23], s0 offen offset:3072 lds
    v_mfma_f32_16x16x32_bf16 v[194:197], a[208:211], a[100:103], v[194:197]
    ds_read_b64_tr_b16 a[202:203], v35 offset:51200
    s_add_u32 m0, s58, 16384
    v_accvgpr_write_b32 a253, 0
    v_mfma_f32_16x16x32_bf16 v[202:205], a[212:215], a[96:99], v[202:205]
    ds_read_b64_tr_b16 a[204:205], v37 offset:49152
    s_add_u32 s0, s0, 458752
    v_mfma_f32_16x16x32_bf16 v[210:213], a[212:215], a[100:103], v[210:213]
    ds_read_b64_tr_b16 a[206:207], v37 offset:51200
    s_waitcnt lgkmcnt(8)
    v_mfma_f32_16x16x32_bf16 v[182:185], a[216:219], a[104:107], v[182:185]
    ds_read_b64_tr_b16 a[208:209], v36 offset:49152
    s_cmp_eq_u32 s0, 3670016
    v_mfma_f32_16x16x32_bf16 v[190:193], a[216:219], a[108:111], v[190:193]
    ds_read_b64_tr_b16 a[210:211], v36 offset:51200
    s_cselect_b32 s0, 0, s0
    buffer_load_dwordx4 v55, s[20:23], s0 offen lds
    v_cndmask_b32 v15, 0, v14, vcc
    v_mfma_f32_16x16x32_bf16 v[198:201], a[220:223], a[104:107], v[198:201]
    ds_read_b64_tr_b16 a[212:213], v38 offset:49152
    v_accvgpr_write_b32 a251, v15
    v_mfma_f32_16x16x32_bf16 v[206:209], a[220:223], a[108:111], v[206:209]
    ds_read_b64_tr_b16 a[214:215], v38 offset:51200
    s_waitcnt lgkmcnt(8)
    v_mfma_f32_16x16x32_bf16 v[186:189], a[224:227], a[104:107], v[186:189]
    ds_read_b64_tr_b16 a[216:217], v35 offset:53248
    buffer_load_dwordx4 v56, s[20:23], s0 offen offset:1024 lds
    v_mfma_f32_16x16x32_bf16 v[194:197], a[224:227], a[108:111], v[194:197]
    ds_read_b64_tr_b16 a[218:219], v35 offset:55296
    v_mfma_f32_16x16x32_bf16 v[202:205], a[228:231], a[104:107], v[202:205]
    ds_read_b64_tr_b16 a[220:221], v37 offset:53248
    buffer_load_dwordx4 v57, s[20:23], s0 offen offset:2048 lds
    v_mfma_f32_16x16x32_bf16 v[210:213], a[228:231], a[108:111], v[210:213]
    ds_read_b64_tr_b16 a[222:223], v37 offset:55296
    s_waitcnt vmcnt(9) lgkmcnt(8)
    v_mfma_f32_16x16x32_bf16 v[182:185], a[200:203], a[112:115], v[182:185]
    ds_read_b64_tr_b16 a[224:225], v36 offset:53248
    v_mfma_f32_16x16x32_bf16 v[190:193], a[200:203], a[116:119], v[190:193]
    ds_read_b64_tr_b16 a[226:227], v36 offset:55296
    buffer_load_dwordx4 v58, s[20:23], s0 offen offset:3072 lds
    v_mfma_f32_16x16x32_bf16 v[198:201], a[204:207], a[112:115], v[198:201]
    ds_read_b64_tr_b16 a[228:229], v38 offset:53248
    s_add_u32 m0, s58, 32768
    v_mfma_f32_16x16x32_bf16 v[206:209], a[204:207], a[116:119], v[206:209]
    ds_read_b64_tr_b16 a[230:231], v38 offset:55296
    s_waitcnt lgkmcnt(8)
    v_mfma_f32_16x16x32_bf16 v[186:189], a[208:211], a[112:115], v[186:189]
    s_waitcnt lgkmcnt(0)
    s_cmp_ge_u32 s14, 14
    s_cbranch_scc0 L_pollin1
L_pollok1:
    ds_read_b64_tr_b16 a[200:201], v39 offset:0
    s_add_u32 s0, s0, 458752
    v_mfma_f32_16x16x32_bf16 v[194:197], a[208:211], a[116:119], v[194:197]
    ds_read_b64_tr_b16 a[202:203], v39 offset:2048
    s_cmp_eq_u32 s0, 3670016
    s_cselect_b32 s0, 0, s0
    buffer_load_dwordx4 v55, s[20:23], s0 offen lds
    v_mfma_f32_16x16x32_bf16 v[202:205], a[212:215], a[112:115], v[202:205]
    ds_read_b64_tr_b16 a[204:205], v41 offset:0
    v_mfma_f32_16x16x32_bf16 v[210:213], a[212:215], a[116:119], v[210:213]
    ds_read_b64_tr_b16 a[206:207], v41 offset:2048
    s_waitcnt vmcnt(9)
    v_mfma_f32_16x16x32_bf16 v[182:185], a[216:219], a[120:123], v[182:185]
    ds_read_b64_tr_b16 a[208:209], v40 offset:0
    buffer_load_dwordx4 v56, s[20:23], s0 offen offset:1024 lds
    v_mfma_f32_16x16x32_bf16 v[190:193], a[216:219], a[124:127], v[190:193]
    ds_read_b64_tr_b16 a[210:211], v40 offset:2048
    v_mfma_f32_16x16x32_bf16 v[198:201], a[220:223], a[120:123], v[198:201]
    ds_read_b64_tr_b16 a[212:213], v42 offset:0
    buffer_load_dwordx4 v57, s[20:23], s0 offen offset:2048 lds
    v_mfma_f32_16x16x32_bf16 v[206:209], a[220:223], a[124:127], v[206:209]
    ds_read_b64_tr_b16 a[214:215], v42 offset:2048
    v_mfma_f32_16x16x32_bf16 v[186:189], a[224:227], a[120:123], v[186:189]
    ds_read_b64_tr_b16 a[216:217], v39 offset:4096
    v_mfma_f32_16x16x32_bf16 v[194:197], a[224:227], a[124:127], v[194:197]
    ds_read_b64_tr_b16 a[218:219], v39 offset:6144
    v_mfma_f32_16x16x32_bf16 v[202:205], a[228:231], a[120:123], v[202:205]
    ds_read_b64_tr_b16 a[220:221], v41 offset:4096
    buffer_load_dwordx4 v58, s[20:23], s0 offen offset:3072 lds
    v_mfma_f32_16x16x32_bf16 v[210:213], a[228:231], a[124:127], v[210:213]
    ds_read_b64_tr_b16 a[222:223], v41 offset:6144
    s_waitcnt lgkmcnt(8)
    v_mfma_f32_16x16x32_bf16 v[150:153], a[200:203], a[0:3], v[150:153]
    ds_read_b64_tr_b16 a[224:225], v40 offset:4096
    s_add_u32 m0, s58, 49152
    v_mfma_f32_16x16x32_bf16 v[158:161], a[200:203], a[4:7], v[158:161]
    ds_read_b64_tr_b16 a[226:227], v40 offset:6144
    s_add_u32 s0, s0, 458752
    v_mfma_f32_16x16x32_bf16 v[166:169], a[204:207], a[0:3], 0
    ds_read_b64_tr_b16 a[228:229], v42 offset:4096
    s_cmp_eq_u32 s0, 3670016
    s_cselect_b32 s0, 0, s0
    buffer_load_dwordx4 v55, s[20:23], s0 offen lds
    v_mfma_f32_16x16x32_bf16 v[174:177], a[204:207], a[4:7], 0
    ds_read_b64_tr_b16 a[230:231], v42 offset:6144
    v_cvt_pk_bf16_f32 v182, v182, v183
    v_cvt_pk_bf16_f32 v183, v184, v185
    v_cvt_pk_bf16_f32 v184, v186, v187
    s_waitcnt lgkmcnt(8)
    v_mfma_f32_16x16x32_bf16 v[154:157], a[208:211], a[0:3], v[154:157]
    s_waitcnt vmcnt(5)
    s_barrier
    ds_read_b64_tr_b16 a[200:201], v39 offset:16384
    buffer_load_dwordx4 v56, s[20:23], s0 offen offset:1024 lds
    v_mfma_f32_16x16x32_bf16 v[162:165], a[208:211], a[4:7], v[162:165]
    ds_read_b64_tr_b16 a[202:203], v39 offset:18432
    v_cvt_pk_bf16_f32 v185, v188, v189
    buffer_store_dwordx4 v[182:185], v23, s[28:31], 0 offen offset:0 sc1
    v_cvt_pk_bf16_f32 v190, v190, v191
    v_cvt_pk_bf16_f32 v191, v192, v193
    v_cvt_pk_bf16_f32 v192, v194, v195
    v_mfma_f32_16x16x32_bf16 v[170:173], a[212:215], a[0:3], 0
    ds_read_b64_tr_b16 a[204:205], v41 offset:16384
    v_cvt_pk_bf16_f32 v193, v196, v197
    v_mfma_f32_16x16x32_bf16 v[178:181], a[212:215], a[4:7], 0
    ds_read_b64_tr_b16 a[206:207], v41 offset:18432
    buffer_store_dwordx4 v[190:193], v23, s[28:31], 0 offen offset:1024 sc1
    v_cvt_pk_bf16_f32 v198, v198, v199
    v_cvt_pk_bf16_f32 v199, v200, v201
    v_cvt_pk_bf16_f32 v200, v202, v203
    s_waitcnt lgkmcnt(8)
    v_mfma_f32_16x16x32_bf16 v[150:153], a[216:219], a[8:11], v[150:153]
    ds_read_b64_tr_b16 a[208:209], v40 offset:16384
    buffer_load_dwordx4 v57, s[20:23], s0 offen offset:2048 lds
    v_mfma_f32_16x16x32_bf16 v[158:161], a[216:219], a[12:15], v[158:161]
    ds_read_b64_tr_b16 a[210:211], v40 offset:18432
    v_cvt_pk_bf16_f32 v201, v204, v205
    buffer_store_dwordx4 v[198:201], v23, s[28:31], 0 offen offset:2048 sc1
    v_cvt_pk_bf16_f32 v206, v206, v207
    v_cvt_pk_bf16_f32 v207, v208, v209
    v_cvt_pk_bf16_f32 v208, v210, v211
    v_mfma_f32_16x16x32_bf16 v[166:169], a[220:223], a[8:11], v[166:169]
    ds_read_b64_tr_b16 a[212:213], v42 offset:16384
    v_cvt_pk_bf16_f32 v209, v212, v213
    v_mfma_f32_16x16x32_bf16 v[174:177], a[220:223], a[12:15], v[174:177]
    ds_read_b64_tr_b16 a[214:215], v42 offset:18432
    s_waitcnt lgkmcnt(8)
    v_mfma_f32_16x16x32_bf16 v[154:157], a[224:227], a[8:11], v[154:157]
    ds_read_b64_tr_b16 a[216:217], v39 offset:20480
    buffer_load_dwordx4 v58, s[20:23], s0 offen offset:3072 lds
    v_mfma_f32_16x16x32_bf16 v[162:165], a[224:227], a[12:15], v[162:165]
    ds_read_b64_tr_b16 a[218:219], v39 offset:22528
    s_add_u32 m0, s58, 65536
    buffer_store_dwordx4 v[206:209], v23, s[28:31], 0 offen offset:3072 sc1
    v_mfma_f32_16x16x32_bf16 v[170:173], a[228:231], a[8:11], v[170:173]
    ds_read_b64_tr_b16 a[220:221], v41 offset:20480
    s_add_u32 s0, s0, 458752
    v_mfma_f32_16x16x32_bf16 v[178:181], a[228:231], a[12:15], v[178:181]
    ds_read_b64_tr_b16 a[222:223], v41 offset:22528
    s_waitcnt lgkmcnt(8)
    v_mfma_f32_16x16x32_bf16 v[150:153], a[200:203], a[16:19], v[150:153]
    ds_read_b64_tr_b16 a[224:225], v40 offset:20480
    s_cmp_eq_u32 s0, 3670016
    v_mfma_f32_16x16x32_bf16 v[158:161], a[200:203], a[20:23], v[158:161]
    ds_read_b64_tr_b16 a[226:227], v40 offset:22528
    s_cselect_b32 s0, 0, s0
    buffer_load_dwordx4 v55, s[20:23], s0 offen lds
    v_mfma_f32_16x16x32_bf16 v[166:169], a[204:207], a[16:19], v[166:169]
    ds_read_b64_tr_b16 a[228:229], v42 offset:20480
    v_mfma_f32_16x16x32_bf16 v[174:177], a[204:207], a[20:23], v[174:177]
    ds_read_b64_tr_b16 a[230:231], v42 offset:22528
    s_waitcnt lgkmcnt(8)
    v_mfma_f32_16x16x32_bf16 v[154:157], a[208:211], a[16:19], v[154:157]
    ds_read_b64_tr_b16 a[200:201], v31 offset:0
    buffer_load_dwordx4 v56, s[20:23], s0 offen offset:1024 lds
    v_mfma_f32_16x16x32_bf16 v[162:165], a[208:211], a[20:23], v[162:165]
    ds_read_b64_tr_b16 a[202:203], v31 offset:2048
    v_mfma_f32_16x16x32_bf16 v[170:173], a[212:215], a[16:19], v[170:173]
    ds_read_b64_tr_b16 a[204:205], v33 offset:0
    buffer_load_dwordx4 v57, s[20:23], s0 offen offset:2048 lds
    v_mfma_f32_16x16x32_bf16 v[178:181], a[212:215], a[20:23], v[178:181]
    ds_read_b64_tr_b16 a[206:207], v33 offset:2048
    s_waitcnt lgkmcnt(8)
    v_mfma_f32_16x16x32_bf16 v[150:153], a[216:219], a[24:27], v[150:153]
    ds_read_b64_tr_b16 a[208:209], v32 offset:0
    v_mfma_f32_16x16x32_bf16 v[158:161], a[216:219], a[28:31], v[158:161]
    ds_read_b64_tr_b16 a[210:211], v32 offset:2048
    buffer_load_dwordx4 v58, s[20:23], s0 offen offset:3072 lds
    v_mfma_f32_16x16x32_bf16 v[166:169], a[220:223], a[24:27], v[166:169]
    ds_read_b64_tr_b16 a[212:213], v34 offset:0
    s_add_u32 m0, s58, 81920
    v_mfma_f32_16x16x32_bf16 v[174:177], a[220:223], a[28:31], v[174:177]
    ds_read_b64_tr_b16 a[214:215], v34 offset:2048
    s_waitcnt lgkmcnt(8)
    v_mfma_f32_16x16x32_bf16 v[154:157], a[224:227], a[24:27], v[154:157]
    ds_read_b64_tr_b16 a[216:217], v31 offset:4096
    s_add_u32 s0, s0, 458752
    v_mfma_f32_16x16x32_bf16 v[162:165], a[224:227], a[28:31], v[162:165]
    ds_read_b64_tr_b16 a[218:219], v31 offset:6144
    s_cmp_eq_u32 s0, 3670016
    v_mfma_f32_16x16x32_bf16 v[170:173], a[228:231], a[24:27], v[170:173]
    ds_read_b64_tr_b16 a[220:221], v33 offset:4096
    s_cselect_b32 s0, 0, s0
    buffer_load_dwordx4 v55, s[20:23], s0 offen lds
    v_mfma_f32_16x16x32_bf16 v[178:181], a[228:231], a[28:31], v[178:181]
    ds_read_b64_tr_b16 a[222:223], v33 offset:6144
    s_waitcnt lgkmcnt(8)
    v_mfma_f32_16x16x32_bf16 v[150:153], a[200:203], a[32:35], v[150:153]
    ds_read_b64_tr_b16 a[224:225], v32 offset:4096
    buffer_load_dwordx4 v56, s[20:23], s0 offen offset:1024 lds
    v_mfma_f32_16x16x32_bf16 v[158:161], a[200:203], a[36:39], v[158:161]
    ds_read_b64_tr_b16 a[226:227], v32 offset:6144
    v_mfma_f32_16x16x32_bf16 v[166:169], a[204:207], a[32:35], v[166:169]
    ds_read_b64_tr_b16 a[228:229], v34 offset:4096
    v_mfma_f32_16x16x32_bf16 v[174:177], a[204:207], a[36:39], v[174:177]
    ds_read_b64_tr_b16 a[230:231], v34 offset:6144
    s_waitcnt lgkmcnt(8)
    v_mfma_f32_16x16x32_bf16 v[154:157], a[208:211], a[32:35], v[154:157]
    s_waitcnt vmcnt(7)
    s_barrier
    s_waitcnt vmcnt(6)
    s_atomic_add s36, s[28:29], s37
    ds_read_b64_tr_b16 a[200:201], v31 offset:16384
    buffer_load_dwordx4 v57, s[20:23], s0 offen offset:2048 lds
    v_mfma_f32_16x16x32_bf16 v[162:165], a[208:211], a[36:39], v[162:165]
    ds_read_b64_tr_b16 a[202:203], v31 offset:18432
    v_mfma_f32_16x16x32_bf16 v[170:173], a[212:215], a[32:35], v[170:173]
    ds_read_b64_tr_b16 a[204:205], v33 offset:16384
    buffer_load_dwordx4 v58, s[20:23], s0 offen offset:3072 lds
    v_mfma_f32_16x16x32_bf16 v[178:181], a[212:215], a[36:39], v[178:181]
    ds_read_b64_tr_b16 a[206:207], v33 offset:18432
    s_waitcnt lgkmcnt(8)
    v_mfma_f32_16x16x32_bf16 v[150:153], a[216:219], a[40:43], v[150:153]
    ds_read_b64_tr_b16 a[208:209], v32 offset:16384
    s_add_u32 m0, s59, 98304
    v_mfma_f32_16x16x32_bf16 v[158:161], a[216:219], a[44:47], v[158:161]
    ds_read_b64_tr_b16 a[210:211], v32 offset:18432
    buffer_load_dwordx4 v80, s[28:31], s63 offen sc1 lds
    v_mfma_f32_16x16x32_bf16 v[166:169], a[220:223], a[40:43], v[166:169]
    ds_read_b64_tr_b16 a[212:213], v34 offset:16384
    v_mfma_f32_16x16x32_bf16 v[174:177], a[220:223], a[44:47], v[174:177]
    ds_read_b64_tr_b16 a[214:215], v34 offset:18432
    s_waitcnt lgkmcnt(8)
    v_mfma_f32_16x16x32_bf16 v[154:157], a[224:227], a[40:43], v[154:157]
    ds_read_b64_tr_b16 a[216:217], v31 offset:20480
    v_mfma_f32_16x16x32_bf16 v[162:165], a[224:227], a[44:47], v[162:165]
    ds_read_b64_tr_b16 a[218:219], v31 offset:22528
    buffer_load_dwordx4 v80, s[28:31], s63 offen offset:1024 sc1 lds
    v_mfma_f32_16x16x32_bf16 v[170:173], a[228:231], a[40:43], v[170:173]
    ds_read_b64_tr_b16 a[220:221], v33 offset:20480
    v_mfma_f32_16x16x32_bf16 v[178:181], a[228:231], a[44:47], v[178:181]
    ds_read_b64_tr_b16 a[222:223], v33 offset:22528
    s_waitcnt lgkmcnt(8)
    v_mfma_f32_16x16x32_bf16 v[150:153], a[200:203], a[48:51], v[150:153]
    ds_read_b64_tr_b16 a[224:225], v32 offset:20480
    buffer_load_dwordx4 v80, s[28:31], s63 offen offset:2048 sc1 lds
    v_mfma_f32_16x16x32_bf16 v[158:161], a[200:203], a[52:55], v[158:161]
    ds_read_b64_tr_b16 a[226:227], v32 offset:22528
    s_add_u32 m0, s100, 126976
    v_mfma_f32_16x16x32_bf16 v[166:169], a[204:207], a[48:51], v[166:169]
    ds_read_b64_tr_b16 a[228:229], v34 offset:20480
    v_mfma_f32_16x16x32_bf16 v[174:177], a[204:207], a[52:55], v[174:177]
    ds_read_b64_tr_b16 a[230:231], v34 offset:22528
    s_waitcnt lgkmcnt(8)
    v_mfma_f32_16x16x32_bf16 v[154:157], a[208:211], a[48:51], v[154:157]
    ds_read_b64_tr_b16 a[200:201], v31 offset:32768
    buffer_load_dwordx4 v69, s[28:31], s62 offen sc1 lds
    v_mfma_f32_16x16x32_bf16 v[162:165], a[208:211], a[52:55], v[162:165]
    ds_read_b64_tr_b16 a[202:203], v31 offset:34816
    s_add_u32 m0, s58, 110592
    v_mfma_f32_16x16x32_bf16 v[170:173], a[212:215], a[48:51], v[170:173]
    ds_read_b64_tr_b16 a[204:205], v33 offset:32768
    v_mfma_f32_16x16x32_bf16 v[178:181], a[212:215], a[52:55], v[178:181]
    ds_read_b64_tr_b16 a[206:207], v33 offset:34816
    s_waitcnt lgkmcnt(8)
    v_mfma_f32_16x16x32_bf16 v[150:153], a[216:219], a[56:59], v[150:153]
    ds_read_b64_tr_b16 a[208:209], v32 offset:32768
    buffer_load_dwordx4 v67, s[28:31], s62 offen sc1 lds
    v_mfma_f32_16x16x32_bf16 v[158:161], a[216:219], a[60:63], v[158:161]
    ds_read_b64_tr_b16 a[210:211], v32 offset:34816
    v_mfma_f32_16x16x32_bf16 v[166:169], a[220:223], a[56:59], v[166:169]
    ds_read_b64_tr_b16 a[212:213], v34 offset:32768
    v_mfma_f32_16x16x32_bf16 v[174:177], a[220:223], a[60:63], v[174:177]
    ds_read_b64_tr_b16 a[214:215], v34 offset:34816
    s_waitcnt lgkmcnt(8)
    v_mfma_f32_16x16x32_bf16 v[154:157], a[224:227], a[56:59], v[154:157]
    ds_read_b64_tr_b16 a[216:217], v31 offset:36864
    buffer_load_dwordx4 v67, s[28:31], s62 offen offset:1024 sc1 lds
    v_mfma_f32_16x16x32_bf16 v[162:165], a[224:227], a[60:63], v[162:165]
    ds_read_b64_tr_b16 a[218:219], v31 offset:38912
    v_mfma_f32_16x16x32_bf16 v[170:173], a[228:231], a[56:59], v[170:173]
    ds_read_b64_tr_b16 a[220:221], v33 offset:36864
    buffer_load_dwordx4 v68, s[28:31], s62 offen offset:2048 sc1 lds
    v_mfma_f32_16x16x32_bf16 v[178:181], a[228:231], a[60:63], v[178:181]
    ds_read_b64_tr_b16 a[222:223], v33 offset:38912
    s_waitcnt lgkmcnt(8)
    v_mfma_f32_16x16x32_bf16 v[150:153], a[200:203], a[64:67], v[150:153]
    ds_read_b64_tr_b16 a[224:225], v32 offset:36864
    v_mfma_f32_16x16x32_bf16 v[158:161], a[200:203], a[68:71], v[158:161]
    ds_read_b64_tr_b16 a[226:227], v32 offset:38912
    v_mfma_f32_16x16x32_bf16 v[166:169], a[204:207], a[64:67], v[166:169]
    ds_read_b64_tr_b16 a[228:229], v34 offset:36864
    buffer_load_dwordx4 v68, s[28:31], s62 offen offset:3072 sc1 lds
    v_mfma_f32_16x16x32_bf16 v[174:177], a[204:207], a[68:71], v[174:177]
    ds_read_b64_tr_b16 a[230:231], v34 offset:38912
    s_waitcnt lgkmcnt(8)
    v_mfma_f32_16x16x32_bf16 v[154:157], a[208:211], a[64:67], v[154:157]
    s_waitcnt vmcnt(8)
    s_barrier
    s_xor_b32 s37, s37, 1024
    s_load_dword s14, s[28:29], s37
    ds_read_b64_tr_b16 a[200:201], v31 offset:49152
    s_add_u32 m0, s59, 131072
    v_mfma_f32_16x16x32_bf16 v[162:165], a[208:211], a[68:71], v[162:165]
    ds_read_b64_tr_b16 a[202:203], v31 offset:51200
    s_add_u32 s63, s63, 12288
    v_mfma_f32_16x16x32_bf16 v[170:173], a[212:215], a[64:67], v[170:173]
    ds_read_b64_tr_b16 a[204:205], v33 offset:49152
    s_cmp_eq_u32 s63, 86016
    s_cselect_b32 s63, 0, s63
    buffer_load_dwordx4 v80, s[28:31], s63 offen sc1 lds
    v_mfma_f32_16x16x32_bf16 v[178:181], a[212:215], a[68:71], v[178:181]
    ds_read_b64_tr_b16 a[206:207], v33 offset:51200
    s_waitcnt lgkmcnt(8)
    v_mfma_f32_16x16x32_bf16 v[150:153], a[216:219], a[72:75], v[150:153]
    ds_read_b64_tr_b16 a[208:209], v32 offset:49152
    buffer_load_dwordx4 v80, s[28:31], s63 offen offset:1024 sc1 lds
    v_mfma_f32_16x16x32_bf16 v[158:161], a[216:219], a[76:79], v[158:161]
    ds_read_b64_tr_b16 a[210:211], v32 offset:51200
    v_mfma_f32_16x16x32_bf16 v[166:169], a[220:223], a[72:75], v[166:169]
    ds_read_b64_tr_b16 a[212:213], v34 offset:49152
    v_mfma_f32_16x16x32_bf16 v[174:177], a[220:223], a[76:79], v[174:177]
    ds_read_b64_tr_b16 a[214:215], v34 offset:51200
    s_waitcnt lgkmcnt(8)
    v_mfma_f32_16x16x32_bf16 v[154:157], a[224:227], a[72:75], v[154:157]
    ds_read_b64_tr_b16 a[216:217], v31 offset:53248
    buffer_load_dwordx4 v80, s[28:31], s63 offen offset:2048 sc1 lds
    v_mfma_f32_16x16x32_bf16 v[162:165], a[224:227], a[76:79], v[162:165]
    ds_read_b64_tr_b16 a[218:219], v31 offset:55296
    s_add_u32 m0, s100, 159744
    v_mfma_f32_16x16x32_bf16 v[170:173], a[228:231], a[72:75], v[170:173]
    ds_read_b64_tr_b16 a[220:221], v33 offset:53248
    s_add_u32 s62, s62, 262144
    v_mfma_f32_16x16x32_bf16 v[178:181], a[228:231], a[76:79], v[178:181]
    ds_read_b64_tr_b16 a[222:223], v33 offset:55296
    s_waitcnt lgkmcnt(8)
    v_mfma_f32_16x16x32_bf16 v[150:153], a[200:203], a[80:83], v[150:153]
    ds_read_b64_tr_b16 a[224:225], v32 offset:53248
    s_cmp_eq_u32 s62, 1835008
    v_mfma_f32_16x16x32_bf16 v[158:161], a[200:203], a[84:87], v[158:161]
    ds_read_b64_tr_b16 a[226:227], v32 offset:55296
    s_cselect_b32 s62, 0, s62
    buffer_load_dwordx4 v69, s[28:31], s62 offen sc1 lds
    v_mfma_f32_16x16x32_bf16 v[166:169], a[204:207], a[80:83], v[166:169]
    ds_read_b64_tr_b16 a[228:229], v34 offset:53248
    s_add_u32 m0, s58, 143360
    v_mfma_f32_16x16x32_bf16 v[174:177], a[204:207], a[84:87], v[174:177]
    ds_read_b64_tr_b16 a[230:231], v34 offset:55296
    s_waitcnt lgkmcnt(8)
    v_mfma_f32_16x16x32_bf16 v[154:157], a[208:211], a[80:83], v[154:157]
    s_barrier
    ds_read_b64_tr_b16 a[200:201], v37 offset:0
    buffer_load_dwordx4 v67, s[28:31], s62 offen sc1 lds
    v_mfma_f32_16x16x32_bf16 v[162:165], a[208:211], a[84:87], v[162:165]
    ds_read_b64_tr_b16 a[202:203], v37 offset:2048
    v_mfma_f32_16x16x32_bf16 v[170:173], a[212:215], a[80:83], v[170:173]
    ds_read_b64_tr_b16 a[204:205], v38 offset:0
    buffer_load_dwordx4 v67, s[28:31], s62 offen offset:1024 sc1 lds
    v_mfma_f32_16x16x32_bf16 v[178:181], a[212:215], a[84:87], v[178:181]
    ds_read_b64_tr_b16 a[206:207], v38 offset:2048
    s_waitcnt lgkmcnt(8)
    v_mfma_f32_16x16x32_bf16 v[150:153], a[216:219], a[88:91], v[150:153]
    ds_read_b64_tr_b16 a[208:209], v37 offset:4096
    v_mfma_f32_16x16x32_bf16 v[158:161], a[216:219], a[92:95], v[158:161]
    ds_read_b64_tr_b16 a[210:211], v37 offset:6144
    v_mfma_f32_16x16x32_bf16 v[166:169], a[220:223], a[88:91], v[166:169]
    ds_read_b64_tr_b16 a[212:213], v38 offset:4096
    buffer_load_dwordx4 v68, s[28:31], s62 offen offset:2048 sc1 lds
    v_mfma_f32_16x16x32_bf16 v[174:177], a[220:223], a[92:95], v[174:177]
    ds_read_b64_tr_b16 a[214:215], v38 offset:6144
    s_waitcnt lgkmcnt(8)
    v_mfma_f32_16x16x32_bf16 v[154:157], a[224:227], a[88:91], v[154:157]
    ds_read_b64_tr_b16 a[216:217], v37 offset:16384
    v_mfma_f32_16x16x32_bf16 v[162:165], a[224:227], a[92:95], v[162:165]
    ds_read_b64_tr_b16 a[218:219], v37 offset:18432
    buffer_load_dwordx4 v68, s[28:31], s62 offen offset:3072 sc1 lds
    v_mfma_f32_16x16x32_bf16 v[170:173], a[228:231], a[88:91], v[170:173]
    ds_read_b64_tr_b16 a[220:221], v38 offset:16384
    s_add_u32 m0, s59, 0
    v_mfma_f32_16x16x32_bf16 v[178:181], a[228:231], a[92:95], v[178:181]
    ds_read_b64_tr_b16 a[222:223], v38 offset:18432
    s_waitcnt lgkmcnt(8)
    v_mfma_f32_16x16x32_bf16 v[166:169], a[200:203], a[96:99], v[166:169]
    s_waitcnt lgkmcnt(0)
    s_cmp_ge_u32 s14, 2
    s_cbranch_scc0 L_pollin2
L_pollok2:
    v_xor_b32 v23, 131072, v23
    v_xor_b32 v22, 8192, v23
    ds_read_b64_tr_b16 a[224:225], v37 offset:20480
    buffer_load_dwordx4 v[214:217], v23, s[28:31], 0 offen offset:0 sc1
    v_mfma_f32_16x16x32_bf16 v[174:177], a[200:203], a[100:103], v[174:177]
    ds_read_b64_tr_b16 a[226:227], v37 offset:22528
    v_mfma_f32_16x16x32_bf16 v[170:173], a[204:207], a[96:99], v[170:173]
    ds_read_b64_tr_b16 a[228:229], v38 offset:20480
    buffer_load_dwordx4 v[218:221], v23, s[28:31], 0 offen offset:1024 sc1
    v_mfma_f32_16x16x32_bf16 v[178:181], a[204:207], a[100:103], v[178:181]
    ds_read_b64_tr_b16 a[230:231], v38 offset:22528
    v_mfma_f32_16x16x32_bf16 v[166:169], a[208:211], a[104:107], v[166:169]
    ds_read_b64_tr_b16 a[200:201], v35 offset:0
    buffer_load_dwordx4 v[222:225], v22, s[28:31], 0 offen offset:2048 sc1
    v_mfma_f32_16x16x32_bf16 v[174:177], a[208:211], a[108:111], v[174:177]
    ds_read_b64_tr_b16 a[202:203], v35 offset:2048
    v_mfma_f32_16x16x32_bf16 v[170:173], a[212:215], a[104:107], v[170:173]
    ds_read_b64_tr_b16 a[204:205], v36 offset:0
    buffer_load_dwordx4 v[226:229], v22, s[28:31], 0 offen offset:3072 sc1
    v_mfma_f32_16x16x32_bf16 v[178:181], a[212:215], a[108:111], v[178:181]
    ds_read_b64_tr_b16 a[206:207], v36 offset:2048
    v_mfma_f32_16x16x32_bf16 v[166:169], a[216:219], a[112:115], v[166:169]
    ds_read_b64_tr_b16 a[208:209], v35 offset:4096
    s_add_u32 s63, s63, 12288
    v_mfma_f32_16x16x32_bf16 v[174:177], a[216:219], a[116:119], v[174:177]
    ds_read_b64_tr_b16 a[210:211], v35 offset:6144
    s_cmp_eq_u32 s63, 86016
    s_cselect_b32 s63, 0, s63
    buffer_load_dwordx4 v80, s[28:31], s63 offen sc1 lds
    v_mfma_f32_16x16x32_bf16 v[170:173], a[220:223], a[112:115], v[170:173]
    ds_read_b64_tr_b16 a[212:213], v36 offset:4096
    v_mfma_f32_16x16x32_bf16 v[178:181], a[220:223], a[116:119], v[178:181]
    ds_read_b64_tr_b16 a[214:215], v36 offset:6144
    s_waitcnt lgkmcnt(8)
    v_mfma_f32_16x16x32_bf16 v[166:169], a[224:227], a[120:123], v[166:169]
    ds_read_b64_tr_b16 a[216:217], v35 offset:16384
    buffer_load_dwordx4 v80, s[28:31], s63 offen offset:1024 sc1 lds
    v_mfma_f32_16x16x32_bf16 v[174:177], a[224:227], a[124:127], v[174:177]
    ds_read_b64_tr_b16 a[218:219], v35 offset:18432
    v_mfma_f32_16x16x32_bf16 v[170:173], a[228:231], a[120:123], v[170:173]
    ds_read_b64_tr_b16 a[220:221], v36 offset:16384
    v_mfma_f32_16x16x32_bf16 v[178:181], a[228:231], a[124:127], v[178:181]
    ds_read_b64_tr_b16 a[222:223], v36 offset:18432
    s_waitcnt lgkmcnt(8)
    v_mfma_f32_16x16x32_bf16 v[150:153], a[200:203], a[96:99], v[150:153]
    ds_read_b64_tr_b16 a[224:225], v35 offset:20480
    buffer_load_dwordx4 v80, s[28:31], s63 offen offset:2048 sc1 lds
    v_mfma_f32_16x16x32_bf16 v[158:161], a[200:203], a[100:103], v[158:161]
    ds_read_b64_tr_b16 a[226:227], v35 offset:22528
    s_add_u32 m0, s100, 28672
    v_mfma_f32_16x16x32_bf16 v[154:157], a[204:207], a[96:99], v[154:157]
    ds_read_b64_tr_b16 a[228:229], v36 offset:20480
    s_add_u32 s62, s62, 262144
    v_mfma_f32_16x16x32_bf16 v[162:165], a[204:207], a[100:103], v[162:165]
    ds_read_b64_tr_b16 a[230:231], v36 offset:22528
    ds_write_b128 v81, v[166:169] offset:32768
    s_waitcnt lgkmcnt(9)
    v_mfma_f32_16x16x32_bf16 v[150:153], a[208:211], a[104:107], v[150:153]
    s_cmp_eq_u32 s62, 1835008
    s_cselect_b32 s62, 0, s62
    buffer_load_dwordx4 v69, s[28:31], s62 offen sc1 lds
    v_mfma_f32_16x16x32_bf16 v[158:161], a[208:211], a[108:111], v[158:161]
    s_add_u32 m0, s58, 12288
    ds_write_b128 v81, v[170:173] offset:33792
    v_mfma_f32_16x16x32_bf16 v[154:157], a[212:215], a[104:107], v[154:157]
    buffer_load_dwordx4 v67, s[28:31], s62 offen sc1 lds
    ds_write_b128 v81, v[174:177] offset:34816
    v_mfma_f32_16x16x32_bf16 v[162:165], a[212:215], a[108:111], v[162:165]
    s_waitcnt lgkmcnt(7)
    v_mfma_f32_16x16x32_bf16 v[150:153], a[216:219], a[112:115], v[150:153]
    ds_write_b128 v81, v[178:181] offset:35840
    v_mfma_f32_16x16x32_bf16 v[158:161], a[216:219], a[116:119], v[158:161]
    v_mfma_f32_16x16x32_bf16 v[154:157], a[220:223], a[112:115], v[154:157]
    buffer_load_dwordx4 v67, s[28:31], s62 offen offset:1024 sc1 lds
    v_mfma_f32_16x16x32_bf16 v[162:165], a[220:223], a[116:119], v[162:165]
    s_waitcnt lgkmcnt(4)
    v_mfma_f32_16x16x32_bf16 v[150:153], a[224:227], a[120:123], v[150:153]
    v_mfma_f32_16x16x32_bf16 v[158:161], a[224:227], a[124:127], v[158:161]
    buffer_load_dwordx4 v68, s[28:31], s62 offen offset:2048 sc1 lds
    v_mfma_f32_16x16x32_bf16 v[154:157], a[228:231], a[120:123], v[154:157]
    v_mfma_f32_16x16x32_bf16 v[162:165], a[228:231], a[124:127], v[162:165]
    s_waitcnt vmcnt(10)
    v_mfma_f32_16x16x32_bf16 v[150:153], a[250:253], v[214:217], v[150:153]
    v_xor_b32 v81, 8192, v81
    s_waitcnt lgkmcnt(0)
    s_barrier
    ds_read_b128 v[182:185], v81 offset:32768
    ds_read_b128 v[186:189], v81 offset:33792
    ds_read_b128 v[190:193], v81 offset:34816
    ds_read_b128 v[194:197], v81 offset:35840
    v_mfma_f32_16x16x32_bf16 v[154:157], a[248:251], v[214:217], v[154:157]
    buffer_load_dwordx4 v68, s[28:31], s62 offen offset:3072 sc1 lds
    s_add_u32 m0, s59, 65536
    s_waitcnt vmcnt(10)
    v_mfma_f32_16x16x32_bf16 v[158:161], a[250:253], v[218:221], v[158:161]
    s_add_u32 s63, s63, 12288
    s_cmp_eq_u32 s63, 86016
    v_mfma_f32_16x16x32_bf16 v[162:165], a[248:251], v[218:221], v[162:165]
L_pad1:
    s_cbranch_execz L_warm
    s_cselect_b32 s63, 0, s63
    s_waitcnt vmcnt(9)
    v_mfma_f32_16x16x32_bf16 v[150:153], a[250:253], v[222:225], v[150:153]
    buffer_load_dwordx4 v80, s[28:31], s63 offen sc1 lds
    v_mfma_f32_16x16x32_bf16 v[154:157], a[248:251], v[222:225], v[154:157]
    s_waitcnt vmcnt(9)
    v_mfma_f32_16x16x32_bf16 v[158:161], a[250:253], v[226:229], v[158:161]
    v_mfma_f32_16x16x32_bf16 v[162:165], a[248:251], v[226:229], v[162:165]
    buffer_load_dwordx4 v80, s[28:31], s63 offen offset:1024 sc1 lds
    s_waitcnt lgkmcnt(3)
    s_nop 0
    v_pk_add_f32 v[150:151], v[150:151], v[182:183]
    v_pk_add_f32 v[152:153], v[152:153], v[184:185]
    s_waitcnt lgkmcnt(2)
    v_pk_add_f32 v[154:155], v[154:155], v[186:187]
    v_pk_add_f32 v[156:157], v[156:157], v[188:189]
    v_pk_mul_f32 v[182:183], v[150:151], v[150:151]
    v_pk_mul_f32 v[184:185], v[152:153], v[152:153]
    v_pk_mul_f32 v[186:187], v[154:155], v[154:155]
    v_pk_mul_f32 v[188:189], v[156:157], v[156:157]
    v_pk_fma_f32 v[182:183], v[182:183], s[78:79], v[108:109]
    v_pk_fma_f32 v[184:185], v[184:185], s[78:79], v[108:109]
    v_pk_fma_f32 v[186:187], v[186:187], s[78:79], v[108:109]
    v_pk_fma_f32 v[188:189], v[188:189], s[78:79], v[108:109]
    v_pk_mul_f32 v[182:183], v[182:183], v[150:151]
    buffer_load_dwordx4 v80, s[28:31], s63 offen offset:2048 sc1 lds
    v_pk_mul_f32 v[184:185], v[184:185], v[152:153]
    v_pk_mul_f32 v[186:187], v[186:187], v[154:155]
    v_pk_mul_f32 v[188:189], v[188:189], v[156:157]
    v_exp_f32 v182, v182
    v_exp_f32 v183, v183
    v_exp_f32 v184, v184
    v_exp_f32 v185, v185
    v_exp_f32 v186, v186
    v_exp_f32 v187, v187
    s_add_u32 m0, s100, 94208
    s_add_u32 s62, s62, 262144
    s_cmp_eq_u32 s62, 1835008
    s_cselect_b32 s62, 0, s62
    buffer_load_dwordx4 v69, s[28:31], s62 offen sc1 lds
    v_exp_f32 v188, v188
    v_exp_f32 v189, v189
    v_pk_add_f32 v[182:183], v[182:183], s[80:81]
    v_pk_add_f32 v[184:185], v[184:185], s[80:81]
    v_pk_add_f32 v[186:187], v[186:187], s[80:81]
    v_pk_add_f32 v[188:189], v[188:189], s[80:81]
    v_rcp_f32 v182, v182
    v_rcp_f32 v183, v183
    v_rcp_f32 v184, v184
    s_add_u32 m0, s58, 77824
    s_nop 0
    buffer_load_dwordx4 v67, s[28:31], s62 offen sc1 lds
    v_rcp_f32 v185, v185
    v_rcp_f32 v186, v186
    v_rcp_f32 v187, v187
    v_rcp_f32 v188, v188
    v_rcp_f32 v189, v189
    v_pk_mul_f32 v[182:183], v[182:183], v[150:151]
    v_pk_mul_f32 v[184:185], v[184:185], v[152:153]
    v_pk_mul_f32 v[186:187], v[186:187], v[154:155]
    buffer_load_dwordx4 v67, s[28:31], s62 offen offset:1024 sc1 lds
    v_pk_mul_f32 v[188:189], v[188:189], v[156:157]
    v_cvt_pk_bf16_f32 v110, v182, v183
    v_cvt_pk_bf16_f32 v111, v184, v185
    v_cvt_pk_bf16_f32 v112, v186, v187
    v_cvt_pk_bf16_f32 v113, v188, v189
    s_waitcnt lgkmcnt(1)
    v_pk_add_f32 v[158:159], v[158:159], v[190:191]
    v_pk_add_f32 v[160:161], v[160:161], v[192:193]
    s_waitcnt lgkmcnt(0)
    v_pk_add_f32 v[162:163], v[162:163], v[194:195]
    v_pk_add_f32 v[164:165], v[164:165], v[196:197]
    v_pk_mul_f32 v[190:191], v[158:159], v[158:159]
    v_pk_mul_f32 v[192:193], v[160:161], v[160:161]
    v_pk_mul_f32 v[194:195], v[162:163], v[162:163]
    v_pk_mul_f32 v[196:197], v[164:165], v[164:165]
    v_pk_fma_f32 v[190:191], v[190:191], s[78:79], v[108:109]
    buffer_load_dwordx4 v68, s[28:31], s62 offen offset:2048 sc1 lds
    v_pk_fma_f32 v[192:193], v[192:193], s[78:79], v[108:109]
    v_pk_fma_f32 v[194:195], v[194:195], s[78:79], v[108:109]
    v_pk_fma_f32 v[196:197], v[196:197], s[78:79], v[108:109]
    v_pk_mul_f32 v[190:191], v[190:191], v[158:159]
    v_pk_mul_f32 v[192:193], v[192:193], v[160:161]
    v_pk_mul_f32 v[194:195], v[194:195], v[162:163]
    v_pk_mul_f32 v[196:197], v[196:197], v[164:165]
    v_exp_f32 v190, v190
    v_exp_f32 v191, v191
    v_exp_f32 v192, v192
    v_exp_f32 v193, v193
    buffer_load_dwordx4 v68, s[28:31], s62 offen offset:3072 sc1 lds
    v_exp_f32 v194, v194
    v_exp_f32 v195, v195
    v_exp_f32 v196, v196
    v_exp_f32 v197, v197
    v_pk_add_f32 v[190:191], v[190:191], s[80:81]
    v_pk_add_f32 v[192:193], v[192:193], s[80:81]
    v_pk_add_f32 v[194:195], v[194:195], s[80:81]
    v_pk_add_f32 v[196:197], v[196:197], s[80:81]
    v_rcp_f32 v190, v190
    v_rcp_f32 v191, v191
    v_rcp_f32 v192, v192
    v_rcp_f32 v193, v193
    v_rcp_f32 v194, v194
    v_rcp_f32 v195, v195
    v_rcp_f32 v196, v196
    v_rcp_f32 v197, v197
    v_pk_mul_f32 v[190:191], v[190:191], v[158:159]
    v_pk_mul_f32 v[192:193], v[192:193], v[160:161]
    v_pk_mul_f32 v[194:195], v[194:195], v[162:163]
    v_pk_mul_f32 v[196:197], v[196:197], v[164:165]
    v_cvt_pk_bf16_f32 v114, v190, v191
    v_cvt_pk_bf16_f32 v115, v192, v193
    v_cvt_pk_bf16_f32 v116, v194, v195
    v_cvt_pk_bf16_f32 v117, v196, v197
    ds_read_b64_tr_b16 a[180:181], v72 offset:32768
    ds_read_b64_tr_b16 a[182:183], v72 offset:33024
    ds_read_b128 a[128:131], v53 offset:32768
    ds_read_b64_tr_b16 a[184:185], v72 offset:33792
    ds_read_b64_tr_b16 a[186:187], v72 offset:34048
    ds_read_b128 a[132:135], v53 offset:33792
    ds_read_b128 a[136:139], v53 offset:34816
    ds_read_b64_tr_b16 a[176:177], v73 offset:32768
    ds_read_b64_tr_b16 a[178:179], v73 offset:33024
    ds_read_b128 a[140:143], v53 offset:35840
    ds_read_b128 a[144:147], v53 offset:36864
    ds_read_b128 a[148:151], v53 offset:37888
    buffer_store_dwordx4 v[110:113], v4, s[28:31], s67 offen offset:0 sc1
    buffer_store_dwordx4 v[114:117], v4, s[28:31], s67 offen offset:1024 sc1
L_q:
    s_waitcnt lgkmcnt(6)
    v_mfma_f32_16x16x32_bf16 v[182:185], a[128:131], a[180:183], 0
    ds_read_b64_tr_b16 a[192:193], v72 offset:34816
    v_mfma_f32_16x16x32_bf16 v[190:193], a[128:131], a[184:187], 0
    ds_read_b64_tr_b16 a[194:195], v72 offset:35072
    v_mfma_f32_16x16x32_bf16 v[186:189], a[132:135], a[180:183], 0
    ds_read_b128 a[152:155], v53 offset:38912
    v_mfma_f32_16x16x32_bf16 v[194:197], a[132:135], a[184:187], 0
    ds_read_b64_tr_b16 a[196:197], v72 offset:35840
    s_waitcnt lgkmcnt(4)
    v_mfma_f32_16x16x32_bf16 v[206:209], a[136:139], a[180:183], 0
    ds_read_b64_tr_b16 a[198:199], v72 offset:36096
    v_mfma_f32_16x16x32_bf16 v[214:217], a[136:139], a[184:187], 0
    ds_read_b128 a[156:159], v53 offset:39936
    v_mfma_f32_16x16x32_bf16 v[198:201], a[136:139], a[176:179], 0
    ds_read_b128 a[160:163], v53 offset:40960
    v_mfma_f32_16x16x32_bf16 v[210:213], a[140:143], a[180:183], 0
    ds_read_b64_tr_b16 a[188:189], v73 offset:34816
    v_mfma_f32_16x16x32_bf16 v[218:221], a[140:143], a[184:187], 0
    ds_read_b64_tr_b16 a[190:191], v73 offset:35072
    v_mfma_f32_16x16x32_bf16 v[202:205], a[140:143], a[176:179], 0
    ds_read_b128 a[164:167], v53 offset:41984
    v_mfma_f32_16x16x32_bf16 v[230:233], a[180:183], a[144:147], 0
    ds_read_b128 a[168:171], v53 offset:43008
    v_mfma_f32_16x16x32_bf16 v[238:241], a[184:187], a[144:147], 0
    ds_read_b128 a[172:175], v53 offset:44032
    v_mfma_f32_16x16x32_bf16 v[222:225], a[176:179], a[144:147], 0
    v_mfma_f32_16x16x32_bf16 v[234:237], a[180:183], a[148:151], 0
    v_mfma_f32_16x16x32_bf16 v[242:245], a[184:187], a[148:151], 0
    v_mfma_f32_16x16x32_bf16 v[226:229], a[176:179], a[148:151], 0
    s_waitcnt lgkmcnt(0)
    s_barrier
    v_mfma_f32_16x16x32_bf16 v[182:185], a[152:155], a[192:195], v[182:185]
    ds_read_b64_tr_b16 a[180:181], v74 offset:0
    s_add_u32 m0, s59, 32768
    v_mfma_f32_16x16x32_bf16 v[190:193], a[152:155], a[196:199], v[190:193]
    ds_read_b64_tr_b16 a[182:183], v74 offset:256
    s_add_u32 s63, s63, 12288
    v_mfma_f32_16x16x32_bf16 v[186:189], a[156:159], a[192:195], v[186:189]
    ds_read_b128 a[128:131], v54 offset:0
    s_cmp_eq_u32 s63, 86016
    v_mfma_f32_16x16x32_bf16 v[194:197], a[156:159], a[196:199], v[194:197]
    ds_read_b64_tr_b16 a[184:185], v74 offset:1024
    v_mfma_f32_16x16x32_bf16 v[206:209], a[160:163], a[192:195], v[206:209]
    ds_read_b64_tr_b16 a[186:187], v74 offset:1280
    s_cselect_b32 s63, 0, s63
    v_mfma_f32_16x16x32_bf16 v[214:217], a[160:163], a[196:199], v[214:217]
    ds_read_b128 a[132:135], v54 offset:1024
    buffer_load_dwordx4 v80, s[28:31], s63 offen sc1 lds
    v_mfma_f32_16x16x32_bf16 v[198:201], a[160:163], a[188:191], v[198:201]
    ds_read_b128 a[136:139], v54 offset:2048
    v_mfma_f32_16x16x32_bf16 v[210:213], a[164:167], a[192:195], v[210:213]
    ds_read_b64_tr_b16 a[176:177], v75 offset:0
    buffer_load_dwordx4 v80, s[28:31], s63 offen offset:1024 sc1 lds
    v_mfma_f32_16x16x32_bf16 v[218:221], a[164:167], a[196:199], v[218:221]
    ds_read_b64_tr_b16 a[178:179], v75 offset:256
    v_mfma_f32_16x16x32_bf16 v[202:205], a[164:167], a[188:191], v[202:205]
    ds_read_b128 a[140:143], v54 offset:3072
    v_mfma_f32_16x16x32_bf16 v[230:233], a[192:195], a[168:171], v[230:233]
    ds_read_b128 a[144:147], v54 offset:4096
    buffer_load_dwordx4 v80, s[28:31], s63 offen offset:2048 sc1 lds
    v_mfma_f32_16x16x32_bf16 v[238:241], a[196:199], a[168:171], v[238:241]
    ds_read_b128 a[148:151], v54 offset:5120
    s_add_u32 m0, s100, 61440
    v_mfma_f32_16x16x32_bf16 v[222:225], a[188:191], a[168:171], v[222:225]
    s_add_u32 s62, s62, 262144
    s_cmp_eq_u32 s62, 1835008
    v_mfma_f32_16x16x32_bf16 v[234:237], a[192:195], a[172:175], v[234:237]
    s_cselect_b32 s62, 0, s62
    buffer_load_dwordx4 v69, s[28:31], s62 offen sc1 lds
    v_mfma_f32_16x16x32_bf16 v[242:245], a[196:199], a[172:175], v[242:245]
    s_add_u32 m0, s58, 45056
    v_mfma_f32_16x16x32_bf16 v[226:229], a[188:191], a[172:175], v[226:229]
    s_waitcnt lgkmcnt(6)
    v_mfma_f32_16x16x32_bf16 v[182:185], a[128:131], a[180:183], v[182:185]
    ds_read_b64_tr_b16 a[192:193], v74 offset:2048
    buffer_load_dwordx4 v67, s[28:31], s62 offen sc1 lds
    v_mfma_f32_16x16x32_bf16 v[190:193], a[128:131], a[184:187], v[190:193]
    ds_read_b64_tr_b16 a[194:195], v74 offset:2304
    v_mfma_f32_16x16x32_bf16 v[186:189], a[132:135], a[180:183], v[186:189]
    ds_read_b128 a[152:155], v54 offset:6144
    v_mfma_f32_16x16x32_bf16 v[194:197], a[132:135], a[184:187], v[194:197]
    ds_read_b64_tr_b16 a[196:197], v74 offset:3072
    s_waitcnt lgkmcnt(4)
    v_mfma_f32_16x16x32_bf16 v[206:209], a[136:139], a[180:183], v[206:209]
    ds_read_b64_tr_b16 a[198:199], v74 offset:3328
    buffer_load_dwordx4 v67, s[28:31], s62 offen offset:1024 sc1 lds
    v_mfma_f32_16x16x32_bf16 v[214:217], a[136:139], a[184:187], v[214:217]
    ds_read_b128 a[156:159], v54 offset:7168
    v_mfma_f32_16x16x32_bf16 v[198:201], a[136:139], a[176:179], v[198:201]
    ds_read_b128 a[160:163], v54 offset:8192
    buffer_load_dwordx4 v68, s[28:31], s62 offen offset:2048 sc1 lds
    v_mfma_f32_16x16x32_bf16 v[210:213], a[140:143], a[180:183], v[210:213]
    ds_read_b64_tr_b16 a[188:189], v75 offset:2048
    v_mfma_f32_16x16x32_bf16 v[218:221], a[140:143], a[184:187], v[218:221]
    ds_read_b64_tr_b16 a[190:191], v75 offset:2304
    v_mfma_f32_16x16x32_bf16 v[202:205], a[140:143], a[176:179], v[202:205]
    ds_read_b128 a[164:167], v54 offset:9216
    buffer_load_dwordx4 v68, s[28:31], s62 offen offset:3072 sc1 lds
    v_mfma_f32_16x16x32_bf16 v[230:233], a[180:183], a[144:147], v[230:233]
    ds_read_b128 a[168:171], v54 offset:10240
    s_add_u32 m0, s59, 98304
    v_mfma_f32_16x16x32_bf16 v[238:241], a[184:187], a[144:147], v[238:241]
    ds_read_b128 a[172:175], v54 offset:11264
    s_add_u32 s63, s63, 12288
    v_mfma_f32_16x16x32_bf16 v[222:225], a[176:179], a[144:147], v[222:225]
    s_cmp_eq_u32 s63, 86016
    s_cselect_b32 s63, 0, s63
    v_mfma_f32_16x16x32_bf16 v[234:237], a[180:183], a[148:151], v[234:237]
    buffer_load_dwordx4 v80, s[28:31], s63 offen sc1 lds
    v_mfma_f32_16x16x32_bf16 v[242:245], a[184:187], a[148:151], v[242:245]
    v_mfma_f32_16x16x32_bf16 v[226:229], a[176:179], a[148:151], v[226:229]
    s_waitcnt vmcnt(9) lgkmcnt(0)
    s_barrier
    s_cmp_lg_u32 s48, 0
    s_cbranch_scc1 L_sig2
    s_atomic_add s36, s[28:29], s68
L_sig2:
    v_mfma_f32_16x16x32_bf16 v[182:185], a[152:155], a[192:195], v[182:185]
    ds_read_b64_tr_b16 a[180:181], v70 offset:0
    buffer_load_dwordx4 v80, s[28:31], s63 offen offset:1024 sc1 lds
    v_mfma_f32_16x16x32_bf16 v[190:193], a[152:155], a[196:199], v[190:193]
    ds_read_b64_tr_b16 a[182:183], v70 offset:256
    v_mfma_f32_16x16x32_bf16 v[186:189], a[156:159], a[192:195], v[186:189]
    ds_read_b128 a[128:131], v4 offset:0
    buffer_load_dwordx4 v80, s[28:31], s63 offen offset:2048 sc1 lds
    v_mfma_f32_16x16x32_bf16 v[194:197], a[156:159], a[196:199], v[194:197]
    ds_read_b64_tr_b16 a[184:185], v70 offset:1024
    v_mfma_f32_16x16x32_bf16 v[206:209], a[160:163], a[192:195], v[206:209]
    ds_read_b64_tr_b16 a[186:187], v70 offset:1280
    s_add_u32 m0, s100, 126976
    v_mfma_f32_16x16x32_bf16 v[214:217], a[160:163], a[196:199], v[214:217]
    ds_read_b128 a[132:135], v4 offset:1024
    s_add_u32 s62, s62, 262144
    v_mfma_f32_16x16x32_bf16 v[198:201], a[160:163], a[188:191], v[198:201]
    ds_read_b128 a[136:139], v4 offset:2048
    s_cmp_eq_u32 s62, 1835008
    v_mfma_f32_16x16x32_bf16 v[210:213], a[164:167], a[192:195], v[210:213]
    ds_read_b64_tr_b16 a[176:177], v71 offset:0
    s_cselect_b32 s62, 0, s62
    v_mfma_f32_16x16x32_bf16 v[218:221], a[164:167], a[196:199], v[218:221]
    ds_read_b64_tr_b16 a[178:179], v71 offset:256
    buffer_load_dwordx4 v69, s[28:31], s62 offen sc1 lds
    v_mfma_f32_16x16x32_bf16 v[202:205], a[164:167], a[188:191], v[202:205]
    ds_read_b128 a[140:143], v4 offset:3072
    s_add_u32 m0, s58, 110592
    v_mfma_f32_16x16x32_bf16 v[230:233], a[192:195], a[168:171], v[230:233]
    ds_read_b128 a[144:147], v4 offset:4096
    buffer_load_dwordx4 v67, s[28:31], s62 offen sc1 lds
    v_mfma_f32_16x16x32_bf16 v[238:241], a[196:199], a[168:171], v[238:241]
    ds_read_b128 a[148:151], v4 offset:5120
    v_mfma_f32_16x16x32_bf16 v[222:225], a[188:191], a[168:171], v[222:225]
    v_mfma_f32_16x16x32_bf16 v[234:237], a[192:195], a[172:175], v[234:237]
    buffer_load_dwordx4 v67, s[28:31], s62 offen offset:1024 sc1 lds
    v_mfma_f32_16x16x32_bf16 v[242:245], a[196:199], a[172:175], v[242:245]
    v_mfma_f32_16x16x32_bf16 v[226:229], a[188:191], a[172:175], v[226:229]
    s_waitcnt lgkmcnt(6)
    v_mfma_f32_16x16x32_bf16 v[182:185], a[128:131], a[180:183], v[182:185]
    ds_read_b64_tr_b16 a[192:193], v70 offset:2048
    buffer_load_dwordx4 v68, s[28:31], s62 offen offset:2048 sc1 lds
    v_mfma_f32_16x16x32_bf16 v[190:193], a[128:131], a[184:187], v[190:193]
    ds_read_b64_tr_b16 a[194:195], v70 offset:2304
    v_mfma_f32_16x16x32_bf16 v[186:189], a[132:135], a[180:183], v[186:189]
    ds_read_b128 a[152:155], v4 offset:6144
    v_mfma_f32_16x16x32_bf16 v[194:197], a[132:135], a[184:187], v[194:197]
    ds_read_b64_tr_b16 a[196:197], v70 offset:3072
    s_waitcnt lgkmcnt(4)
    v_mfma_f32_16x16x32_bf16 v[206:209], a[136:139], a[180:183], v[206:209]
    ds_read_b64_tr_b16 a[198:199], v70 offset:3328
    buffer_load_dwordx4 v68, s[28:31], s62 offen offset:3072 sc1 lds
    v_mfma_f32_16x16x32_bf16 v[214:217], a[136:139], a[184:187], v[214:217]
    ds_read_b128 a[156:159], v4 offset:7168
    s_add_u32 m0, s59, 131072
    v_mfma_f32_16x16x32_bf16 v[198:201], a[136:139], a[176:179], v[198:201]
    ds_read_b128 a[160:163], v4 offset:8192
    s_add_u32 s63, s63, 12288
    v_mfma_f32_16x16x32_bf16 v[210:213], a[140:143], a[180:183], v[210:213]
    ds_read_b64_tr_b16 a[188:189], v71 offset:2048
    s_cmp_eq_u32 s63, 86016
    v_mfma_f32_16x16x32_bf16 v[218:221], a[140:143], a[184:187], v[218:221]
    ds_read_b64_tr_b16 a[190:191], v71 offset:2304
    s_cselect_b32 s63, 0, s63
    v_mfma_f32_16x16x32_bf16 v[202:205], a[140:143], a[176:179], v[202:205]
    ds_read_b128 a[164:167], v4 offset:9216
    buffer_load_dwordx4 v80, s[28:31], s63 offen sc1 lds
    v_mfma_f32_16x16x32_bf16 v[230:233], a[180:183], a[144:147], v[230:233]
    ds_read_b128 a[168:171], v4 offset:10240
    v_mfma_f32_16x16x32_bf16 v[238:241], a[184:187], a[144:147], v[238:241]
    ds_read_b128 a[172:175], v4 offset:11264
    buffer_load_dwordx4 v80, s[28:31], s63 offen offset:1024 sc1 lds
    v_mfma_f32_16x16x32_bf16 v[222:225], a[176:179], a[144:147], v[222:225]
    v_mfma_f32_16x16x32_bf16 v[234:237], a[180:183], a[148:151], v[234:237]
    v_mfma_f32_16x16x32_bf16 v[242:245], a[184:187], a[148:151], v[242:245]
    buffer_load_dwordx4 v80, s[28:31], s63 offen offset:2048 sc1 lds
    s_add_u32 m0, s100, 159744
    v_mfma_f32_16x16x32_bf16 v[226:229], a[176:179], a[148:151], v[226:229]
    s_add_u32 s62, s62, 262144
    ds_read_b32 v24, v4
    s_waitcnt lgkmcnt(1)
    s_barrier
    v_mfma_f32_16x16x32_bf16 v[182:185], a[152:155], a[192:195], v[182:185]
    ds_read_b64_tr_b16 a[180:181], v72 offset:0
    s_cmp_eq_u32 s62, 1835008
    v_mfma_f32_16x16x32_bf16 v[190:193], a[152:155], a[196:199], v[190:193]
    ds_read_b64_tr_b16 a[182:183], v72 offset:256
    s_cselect_b32 s62, 0, s62
    v_mfma_f32_16x16x32_bf16 v[186:189], a[156:159], a[192:195], v[186:189]
    ds_read_b128 a[128:131], v53 offset:0
    buffer_load_dwordx4 v69, s[28:31], s62 offen sc1 lds
    v_mfma_f32_16x16x32_bf16 v[194:197], a[156:159], a[196:199], v[194:197]
    ds_read_b64_tr_b16 a[184:185], v72 offset:1024
    v_mfma_f32_16x16x32_bf16 v[206:209], a[160:163], a[192:195], v[206:209]
    ds_read_b64_tr_b16 a[186:187], v72 offset:1280
    s_add_u32 m0, s58, 143360
    v_mfma_f32_16x16x32_bf16 v[214:217], a[160:163], a[196:199], v[214:217]
    ds_read_b128 a[132:135], v53 offset:1024
    buffer_load_dwordx4 v67, s[28:31], s62 offen sc1 lds
    v_mfma_f32_16x16x32_bf16 v[198:201], a[160:163], a[188:191], v[198:201]
    ds_read_b128 a[136:139], v53 offset:2048
    v_mfma_f32_16x16x32_bf16 v[210:213], a[164:167], a[192:195], v[210:213]
    ds_read_b64_tr_b16 a[176:177], v73 offset:0
    buffer_load_dwordx4 v67, s[28:31], s62 offen offset:1024 sc1 lds
    v_mfma_f32_16x16x32_bf16 v[218:221], a[164:167], a[196:199], v[218:221]
    ds_read_b64_tr_b16 a[178:179], v73 offset:256
    v_mfma_f32_16x16x32_bf16 v[202:205], a[164:167], a[188:191], v[202:205]
    ds_read_b128 a[140:143], v53 offset:3072
    v_mfma_f32_16x16x32_bf16 v[230:233], a[192:195], a[168:171], v[230:233]
    ds_read_b128 a[144:147], v53 offset:4096
    buffer_load_dwordx4 v68, s[28:31], s62 offen offset:2048 sc1 lds
    v_mfma_f32_16x16x32_bf16 v[238:241], a[196:199], a[168:171], v[238:241]
    ds_read_b128 a[148:151], v53 offset:5120
    v_mfma_f32_16x16x32_bf16 v[222:225], a[188:191], a[168:171], v[222:225]
    v_mfma_f32_16x16x32_bf16 v[234:237], a[192:195], a[172:175], v[234:237]
    buffer_load_dwordx4 v68, s[28:31], s62 offen offset:3072 sc1 lds
    s_add_u32 m0, s58, 0
    v_mfma_f32_16x16x32_bf16 v[242:245], a[196:199], a[172:175], v[242:245]
    v_mfma_f32_16x16x32_bf16 v[226:229], a[188:191], a[172:175], v[226:229]
    s_waitcnt lgkmcnt(6)
    v_mfma_f32_16x16x32_bf16 v[182:185], a[128:131], a[180:183], v[182:185]
    ds_read_b64_tr_b16 a[192:193], v72 offset:2048
    buffer_load_dwordx4 v59, s[24:27], s64 offen lds
    v_mfma_f32_16x16x32_bf16 v[190:193], a[128:131], a[184:187], v[190:193]
    ds_read_b64_tr_b16 a[194:195], v72 offset:2304
    v_mfma_f32_16x16x32_bf16 v[186:189], a[132:135], a[180:183], v[186:189]
    ds_read_b128 a[152:155], v53 offset:6144
    v_mfma_f32_16x16x32_bf16 v[194:197], a[132:135], a[184:187], v[194:197]
    ds_read_b64_tr_b16 a[196:197], v72 offset:3072
    s_waitcnt lgkmcnt(4)
    v_mfma_f32_16x16x32_bf16 v[206:209], a[136:139], a[180:183], v[206:209]
    ds_read_b64_tr_b16 a[198:199], v72 offset:3328
    buffer_load_dwordx4 v60, s[24:27], s64 offen offset:1024 lds
    v_mfma_f32_16x16x32_bf16 v[214:217], a[136:139], a[184:187], v[214:217]
    ds_read_b128 a[156:159], v53 offset:7168
    v_mfma_f32_16x16x32_bf16 v[198:201], a[136:139], a[176:179], v[198:201]
    ds_read_b128 a[160:163], v53 offset:8192
    v_mfma_f32_16x16x32_bf16 v[210:213], a[140:143], a[180:183], v[210:213]
    ds_read_b64_tr_b16 a[188:189], v73 offset:2048
    buffer_load_dwordx4 v61, s[24:27], s64 offen offset:2048 lds
    v_mfma_f32_16x16x32_bf16 v[218:221], a[140:143], a[184:187], v[218:221]
    ds_read_b64_tr_b16 a[190:191], v73 offset:2304
    v_mfma_f32_16x16x32_bf16 v[202:205], a[140:143], a[176:179], v[202:205]
    ds_read_b128 a[164:167], v53 offset:9216
    v_mfma_f32_16x16x32_bf16 v[230:233], a[180:183], a[144:147], v[230:233]
    ds_read_b128 a[168:171], v53 offset:10240
    buffer_load_dwordx4 v62, s[24:27], s64 offen offset:3072 lds
    v_mfma_f32_16x16x32_bf16 v[238:241], a[184:187], a[144:147], v[238:241]
    ds_read_b128 a[172:175], v53 offset:11264
    s_add_u32 m0, s58, 16384
    v_mfma_f32_16x16x32_bf16 v[222:225], a[176:179], a[144:147], v[222:225]
    v_xor_b32 v59, 128, v59
    v_mfma_f32_16x16x32_bf16 v[234:237], a[180:183], a[148:151], v[234:237]
    buffer_load_dwordx4 v59, s[24:27], s64 offen lds
    v_xor_b32 v60, 128, v60
    v_mfma_f32_16x16x32_bf16 v[242:245], a[184:187], a[148:151], v[242:245]
    v_mfma_f32_16x16x32_bf16 v[226:229], a[176:179], a[148:151], v[226:229]
    ds_read_b32 v24, v4
    s_waitcnt vmcnt(21) lgkmcnt(1)
    s_barrier
    v_mfma_f32_16x16x32_bf16 v[182:185], a[152:155], a[192:195], v[182:185]
    ds_read_b64_tr_b16 a[180:181], v70 offset:32768
    buffer_load_dwordx4 v60, s[24:27], s64 offen offset:1024 lds
    v_mfma_f32_16x16x32_bf16 v[190:193], a[152:155], a[196:199], v[190:193]
    ds_read_b64_tr_b16 a[182:183], v70 offset:33024
    v_xor_b32 v61, 128, v61
    v_mfma_f32_16x16x32_bf16 v[186:189], a[156:159], a[192:195], v[186:189]
    ds_read_b128 a[128:131], v4 offset:32768
    v_mfma_f32_16x16x32_bf16 v[194:197], a[156:159], a[196:199], v[194:197]
    ds_read_b64_tr_b16 a[184:185], v70 offset:33792
    v_mfma_f32_16x16x32_bf16 v[206:209], a[160:163], a[192:195], v[206:209]
    ds_read_b64_tr_b16 a[186:187], v70 offset:34048
    buffer_load_dwordx4 v61, s[24:27], s64 offen offset:2048 lds
    v_mfma_f32_16x16x32_bf16 v[214:217], a[160:163], a[196:199], v[214:217]
    ds_read_b128 a[132:135], v4 offset:33792
    v_xor_b32 v62, 128, v62
    v_mfma_f32_16x16x32_bf16 v[198:201], a[160:163], a[188:191], v[198:201]
    ds_read_b128 a[136:139], v4 offset:34816
    buffer_load_dwordx4 v62, s[24:27], s64 offen offset:3072 lds
    v_mfma_f32_16x16x32_bf16 v[210:213], a[164:167], a[192:195], v[210:213]
    ds_read_b64_tr_b16 a[176:177], v71 offset:32768
    s_add_u32 m0, s58, 65536
    v_mfma_f32_16x16x32_bf16 v[218:221], a[164:167], a[196:199], v[218:221]
    ds_read_b64_tr_b16 a[178:179], v71 offset:33024
    s_add_u32 s64, s64, 524288
    v_mfma_f32_16x16x32_bf16 v[202:205], a[164:167], a[188:191], v[202:205]
    ds_read_b128 a[140:143], v4 offset:35840
    s_cmp_eq_u32 s64, 3670016
    v_mfma_f32_16x16x32_bf16 v[230:233], a[192:195], a[168:171], v[230:233]
    ds_read_b128 a[144:147], v4 offset:36864
    s_cselect_b32 s64, 0, s64
    v_mfma_f32_16x16x32_bf16 v[238:241], a[196:199], a[168:171], v[238:241]
    ds_read_b128 a[148:151], v4 offset:37888
    buffer_load_dwordx4 v59, s[24:27], s64 offen lds
    v_mfma_f32_16x16x32_bf16 v[222:225], a[188:191], a[168:171], v[222:225]
    v_mfma_f32_16x16x32_bf16 v[234:237], a[192:195], a[172:175], v[234:237]
    buffer_load_dwordx4 v60, s[24:27], s64 offen offset:1024 lds
    v_mfma_f32_16x16x32_bf16 v[242:245], a[196:199], a[172:175], v[242:245]
    v_mfma_f32_16x16x32_bf16 v[226:229], a[188:191], a[172:175], v[226:229]
    s_waitcnt lgkmcnt(6)
    v_mfma_f32_16x16x32_bf16 v[182:185], a[128:131], a[180:183], v[182:185]
    ds_read_b64_tr_b16 a[192:193], v70 offset:34816
    buffer_load_dwordx4 v61, s[24:27], s64 offen offset:2048 lds
    v_mfma_f32_16x16x32_bf16 v[190:193], a[128:131], a[184:187], v[190:193]
    ds_read_b64_tr_b16 a[194:195], v70 offset:35072
    v_mfma_f32_16x16x32_bf16 v[186:189], a[132:135], a[180:183], v[186:189]
    ds_read_b128 a[152:155], v4 offset:38912
    v_mfma_f32_16x16x32_bf16 v[194:197], a[132:135], a[184:187], v[194:197]
    ds_read_b64_tr_b16 a[196:197], v70 offset:35840
    s_waitcnt lgkmcnt(4)
    v_mfma_f32_16x16x32_bf16 v[206:209], a[136:139], a[180:183], v[206:209]
    ds_read_b64_tr_b16 a[198:199], v70 offset:36096
    buffer_load_dwordx4 v62, s[24:27], s64 offen offset:3072 lds
    v_mfma_f32_16x16x32_bf16 v[214:217], a[136:139], a[184:187], v[214:217]
    ds_read_b128 a[156:159], v4 offset:39936
    s_add_u32 m0, s58, 81920
    v_mfma_f32_16x16x32_bf16 v[198:201], a[136:139], a[176:179], v[198:201]
    ds_read_b128 a[160:163], v4 offset:40960
    s_add_u32 s64, s64, 524288
    v_mfma_f32_16x16x32_bf16 v[210:213], a[140:143], a[180:183], v[210:213]
    ds_read_b64_tr_b16 a[188:189], v71 offset:34816
    s_cmp_eq_u32 s64, 3670016
    v_mfma_f32_16x16x32_bf16 v[218:221], a[140:143], a[184:187], v[218:221]
    ds_read_b64_tr_b16 a[190:191], v71 offset:35072
    s_cselect_b32 s64, 0, s64
    v_mfma_f32_16x16x32_bf16 v[202:205], a[140:143], a[176:179], v[202:205]
    ds_read_b128 a[164:167], v4 offset:41984
    buffer_load_dwordx4 v59, s[24:27], s64 offen lds
    v_mfma_f32_16x16x32_bf16 v[230:233], a[180:183], a[144:147], v[230:233]
    ds_read_b128 a[168:171], v4 offset:43008
    v_mfma_f32_16x16x32_bf16 v[238:241], a[184:187], a[144:147], v[238:241]
    ds_read_b128 a[172:175], v4 offset:44032
    buffer_load_dwordx4 v60, s[24:27], s64 offen offset:1024 lds
    v_mfma_f32_16x16x32_bf16 v[222:225], a[176:179], a[144:147], v[222:225]
    v_mfma_f32_16x16x32_bf16 v[234:237], a[180:183], a[148:151], v[234:237]
    v_mfma_f32_16x16x32_bf16 v[242:245], a[184:187], a[148:151], v[242:245]
    buffer_load_dwordx4 v61, s[24:27], s64 offen offset:2048 lds
    v_mfma_f32_16x16x32_bf16 v[226:229], a[176:179], a[148:151], v[226:229]
    ds_read_b32 v24, v4
    s_waitcnt vmcnt(23) lgkmcnt(1)
    s_barrier
    v_mfma_f32_16x16x32_bf16 v[182:185], a[152:155], a[192:195], v[182:185]
    ds_read_b64_tr_b16 a[180:181], v72 offset:32768
    v_mfma_f32_16x16x32_bf16 v[190:193], a[152:155], a[196:199], v[190:193]
    ds_read_b64_tr_b16 a[182:183], v72 offset:33024
    buffer_load_dwordx4 v62, s[24:27], s64 offen offset:3072 lds
    v_mfma_f32_16x16x32_bf16 v[186:189], a[156:159], a[192:195], v[186:189]
    ds_read_b128 a[128:131], v53 offset:32768
    s_add_u32 m0, s58, 32768
    v_mfma_f32_16x16x32_bf16 v[194:197], a[156:159], a[196:199], v[194:197]
    ds_read_b64_tr_b16 a[184:185], v72 offset:33792
    v_mfma_f32_16x16x32_bf16 v[206:209], a[160:163], a[192:195], v[206:209]
    ds_read_b64_tr_b16 a[186:187], v72 offset:34048
    s_add_u32 s64, s64, 524288
    v_mfma_f32_16x16x32_bf16 v[214:217], a[160:163], a[196:199], v[214:217]
    ds_read_b128 a[132:135], v53 offset:33792
    s_cmp_eq_u32 s64, 3670016
    v_mfma_f32_16x16x32_bf16 v[198:201], a[160:163], a[188:191], v[198:201]
    ds_read_b128 a[136:139], v53 offset:34816
    s_cselect_b32 s64, 0, s64
    v_mfma_f32_16x16x32_bf16 v[210:213], a[164:167], a[192:195], v[210:213]
    ds_read_b64_tr_b16 a[176:177], v73 offset:32768
    buffer_load_dwordx4 v59, s[24:27], s64 offen lds
    v_mfma_f32_16x16x32_bf16 v[218:221], a[164:167], a[196:199], v[218:221]
    ds_read_b64_tr_b16 a[178:179], v73 offset:33024
    v_mfma_f32_16x16x32_bf16 v[202:205], a[164:167], a[188:191], v[202:205]
    ds_read_b128 a[140:143], v53 offset:35840
    buffer_load_dwordx4 v60, s[24:27], s64 offen offset:1024 lds
    v_mfma_f32_16x16x32_bf16 v[230:233], a[192:195], a[168:171], v[230:233]
    ds_read_b128 a[144:147], v53 offset:36864
    v_mfma_f32_16x16x32_bf16 v[238:241], a[196:199], a[168:171], v[238:241]
    ds_read_b128 a[148:151], v53 offset:37888
    v_mfma_f32_16x16x32_bf16 v[222:225], a[188:191], a[168:171], v[222:225]
    buffer_load_dwordx4 v61, s[24:27], s64 offen offset:2048 lds
    v_mfma_f32_16x16x32_bf16 v[234:237], a[192:195], a[172:175], v[234:237]
    v_mfma_f32_16x16x32_bf16 v[242:245], a[196:199], a[172:175], v[242:245]
    v_mfma_f32_16x16x32_bf16 v[226:229], a[188:191], a[172:175], v[226:229]
    buffer_load_dwordx4 v62, s[24:27], s64 offen offset:3072 lds
    s_load_dword s14, s[28:29], s38
    s_waitcnt lgkmcnt(6)
    v_mfma_f32_16x16x32_bf16 v[182:185], a[128:131], a[180:183], v[182:185]
    ds_read_b64_tr_b16 a[192:193], v72 offset:34816
    s_add_u32 m0, s58, 49152
    v_mfma_f32_16x16x32_bf16 v[190:193], a[128:131], a[184:187], v[190:193]
    ds_read_b64_tr_b16 a[194:195], v72 offset:35072
    s_add_u32 s64, s64, 524288
    v_mfma_f32_16x16x32_bf16 v[186:189], a[132:135], a[180:183], v[186:189]
    ds_read_b128 a[152:155], v53 offset:38912
    s_cmp_eq_u32 s64, 3670016
    v_mfma_f32_16x16x32_bf16 v[194:197], a[132:135], a[184:187], v[194:197]
    ds_read_b64_tr_b16 a[196:197], v72 offset:35840
    s_waitcnt lgkmcnt(4)
    v_mfma_f32_16x16x32_bf16 v[206:209], a[136:139], a[180:183], v[206:209]
    ds_read_b64_tr_b16 a[198:199], v72 offset:36096
    s_cselect_b32 s64, 0, s64
    v_mfma_f32_16x16x32_bf16 v[214:217], a[136:139], a[184:187], v[214:217]
    ds_read_b128 a[156:159], v53 offset:39936
    buffer_load_dwordx4 v59, s[24:27], s64 offen lds
    v_mfma_f32_16x16x32_bf16 v[198:201], a[136:139], a[176:179], v[198:201]
    ds_read_b128 a[160:163], v53 offset:40960
    v_mfma_f32_16x16x32_bf16 v[210:213], a[140:143], a[180:183], v[210:213]
    ds_read_b64_tr_b16 a[188:189], v73 offset:34816
    buffer_load_dwordx4 v60, s[24:27], s64 offen offset:1024 lds
    v_mfma_f32_16x16x32_bf16 v[218:221], a[140:143], a[184:187], v[218:221]
    ds_read_b64_tr_b16 a[190:191], v73 offset:35072
L_pad2:
    s_cbranch_execz L_warm
    v_mfma_f32_16x16x32_bf16 v[202:205], a[140:143], a[176:179], v[202:205]
    ds_read_b128 a[164:167], v53 offset:41984
    v_mfma_f32_16x16x32_bf16 v[230:233], a[180:183], a[144:147], v[230:233]
    ds_read_b128 a[168:171], v53 offset:43008
    buffer_load_dwordx4 v61, s[24:27], s64 offen offset:2048 lds
    v_mfma_f32_16x16x32_bf16 v[238:241], a[184:187], a[144:147], v[238:241]
    ds_read_b128 a[172:175], v53 offset:44032
    v_mfma_f32_16x16x32_bf16 v[222:225], a[176:179], a[144:147], v[222:225]
    v_mfma_f32_16x16x32_bf16 v[234:237], a[180:183], a[148:151], v[234:237]
    buffer_load_dwordx4 v62, s[24:27], s64 offen offset:3072 lds
    v_mfma_f32_16x16x32_bf16 v[242:245], a[184:187], a[148:151], v[242:245]
    v_mfma_f32_16x16x32_bf16 v[226:229], a[176:179], a[148:151], v[226:229]
    ds_read_b32 v24, v4
    s_waitcnt vmcnt(24) lgkmcnt(1)
    s_barrier
    v_mfma_f32_16x16x32_bf16 v[182:185], a[152:155], a[192:195], v[182:185]
    ds_read_b64_tr_b16 a[180:181], v74 offset:0
    s_add_u32 m0, s58, 98304
    v_mfma_f32_16x16x32_bf16 v[190:193], a[152:155], a[196:199], v[190:193]
    ds_read_b64_tr_b16 a[182:183], v74 offset:256
    s_add_u32 s64, s64, 524288
    v_mfma_f32_16x16x32_bf16 v[186:189], a[156:159], a[192:195], v[186:189]
    ds_read_b128 a[128:131], v54 offset:0
    s_cmp_eq_u32 s64, 3670016
    v_mfma_f32_16x16x32_bf16 v[194:197], a[156:159], a[196:199], v[194:197]
    ds_read_b64_tr_b16 a[184:185], v74 offset:1024
    v_mfma_f32_16x16x32_bf16 v[206:209], a[160:163], a[192:195], v[206:209]
    ds_read_b64_tr_b16 a[186:187], v74 offset:1280
    s_cselect_b32 s64, 0, s64
    v_mfma_f32_16x16x32_bf16 v[214:217], a[160:163], a[196:199], v[214:217]
    ds_read_b128 a[132:135], v54 offset:1024
    buffer_load_dwordx4 v59, s[24:27], s64 offen lds
    v_mfma_f32_16x16x32_bf16 v[198:201], a[160:163], a[188:191], v[198:201]
    ds_read_b128 a[136:139], v54 offset:2048
    v_mfma_f32_16x16x32_bf16 v[210:213], a[164:167], a[192:195], v[210:213]
    ds_read_b64_tr_b16 a[176:177], v75 offset:0
    buffer_load_dwordx4 v60, s[24:27], s64 offen offset:1024 lds
    v_mfma_f32_16x16x32_bf16 v[218:221], a[164:167], a[196:199], v[218:221]
    ds_read_b64_tr_b16 a[178:179], v75 offset:256
    v_mfma_f32_16x16x32_bf16 v[202:205], a[164:167], a[188:191], v[202:205]
    ds_read_b128 a[140:143], v54 offset:3072
    v_mfma_f32_16x16x32_bf16 v[230:233], a[192:195], a[168:171], v[230:233]
    ds_read_b128 a[144:147], v54 offset:4096
    buffer_load_dwordx4 v61, s[24:27], s64 offen offset:2048 lds
    v_mfma_f32_16x16x32_bf16 v[238:241], a[196:199], a[168:171], v[238:241]
    ds_read_b128 a[148:151], v54 offset:5120
    v_mfma_f32_16x16x32_bf16 v[222:225], a[188:191], a[168:171], v[222:225]
    v_mfma_f32_16x16x32_bf16 v[234:237], a[192:195], a[172:175], v[234:237]
    buffer_load_dwordx4 v62, s[24:27], s64 offen offset:3072 lds
    s_add_u32 m0, s58, 114688
    v_mfma_f32_16x16x32_bf16 v[242:245], a[196:199], a[172:175], v[242:245]
    s_add_u32 s64, s64, 524288
    s_cmp_eq_u32 s64, 3670016
    v_mfma_f32_16x16x32_bf16 v[226:229], a[188:191], a[172:175], v[226:229]
    s_cselect_b32 s64, 0, s64
    s_waitcnt lgkmcnt(6)
    v_mfma_f32_16x16x32_bf16 v[182:185], a[128:131], a[180:183], v[182:185]
    ds_read_b64_tr_b16 a[192:193], v74 offset:2048
    buffer_load_dwordx4 v59, s[24:27], s64 offen lds
    v_mfma_f32_16x16x32_bf16 v[190:193], a[128:131], a[184:187], v[190:193]
    ds_read_b64_tr_b16 a[194:195], v74 offset:2304
    v_mfma_f32_16x16x32_bf16 v[186:189], a[132:135], a[180:183], v[186:189]
    ds_read_b128 a[152:155], v54 offset:6144
    v_mfma_f32_16x16x32_bf16 v[194:197], a[132:135], a[184:187], v[194:197]
    ds_read_b64_tr_b16 a[196:197], v74 offset:3072
    s_waitcnt lgkmcnt(4)
    v_mfma_f32_16x16x32_bf16 v[206:209], a[136:139], a[180:183], v[206:209]
    ds_read_b64_tr_b16 a[198:199], v74 offset:3328
    buffer_load_dwordx4 v60, s[24:27], s64 offen offset:1024 lds
    v_mfma_f32_16x16x32_bf16 v[214:217], a[136:139], a[184:187], v[214:217]
    ds_read_b128 a[156:159], v54 offset:7168
    v_mfma_f32_16x16x32_bf16 v[198:201], a[136:139], a[176:179], v[198:201]
    ds_read_b128 a[160:163], v54 offset:8192
    buffer_load_dwordx4 v61, s[24:27], s64 offen offset:2048 lds
    v_mfma_f32_16x16x32_bf16 v[210:213], a[140:143], a[180:183], v[210:213]
    ds_read_b64_tr_b16 a[188:189], v75 offset:2048
    v_mfma_f32_16x16x32_bf16 v[218:221], a[140:143], a[184:187], v[218:221]
    ds_read_b64_tr_b16 a[190:191], v75 offset:2304
    v_mfma_f32_16x16x32_bf16 v[202:205], a[140:143], a[176:179], v[202:205]
    ds_read_b128 a[164:167], v54 offset:9216
    buffer_load_dwordx4 v62, s[24:27], s64 offen offset:3072 lds
    v_mfma_f32_16x16x32_bf16 v[230:233], a[180:183], a[144:147], v[230:233]
    ds_read_b128 a[168:171], v54 offset:10240
    v_mfma_f32_16x16x32_bf16 v[238:241], a[184:187], a[144:147], v[238:241]
    ds_read_b128 a[172:175], v54 offset:11264
    v_mfma_f32_16x16x32_bf16 v[222:225], a[176:179], a[144:147], v[222:225]
    v_mfma_f32_16x16x32_bf16 v[234:237], a[180:183], a[148:151], v[234:237]
    v_mfma_f32_16x16x32_bf16 v[242:245], a[184:187], a[148:151], v[242:245]
    v_mfma_f32_16x16x32_bf16 v[226:229], a[176:179], a[148:151], v[226:229]
    s_waitcnt lgkmcnt(0)
    s_cmp_ge_u32 s14, 7
    s_cbranch_scc0 L_pollin5
L_pollok5:
    s_waitcnt vmcnt(16)
    s_barrier
    v_mfma_f32_16x16x32_bf16 v[182:185], a[152:155], a[192:195], v[182:185]
    ds_read_b64_tr_b16 a[200:201], v31 offset:16384
    buffer_load_dwordx4 a[0:3], v79, s[28:31], s65 offen offset:0 sc1
    v_mfma_f32_16x16x32_bf16 v[190:193], a[152:155], a[196:199], v[190:193]
    ds_read_b64_tr_b16 a[202:203], v31 offset:18432
    v_mfma_f32_16x16x32_bf16 v[186:189], a[156:159], a[192:195], v[186:189]
    ds_read_b64_tr_b16 a[204:205], v33 offset:16384
    buffer_load_dwordx4 a[4:7], v79, s[28:31], s65 offen offset:1024 sc1
    v_mfma_f32_16x16x32_bf16 v[194:197], a[156:159], a[196:199], v[194:197]
    ds_read_b64_tr_b16 a[206:207], v33 offset:18432
    v_mfma_f32_16x16x32_bf16 v[206:209], a[160:163], a[192:195], v[206:209]
    ds_read_b64_tr_b16 a[208:209], v32 offset:16384
    v_mfma_f32_16x16x32_bf16 v[214:217], a[160:163], a[196:199], v[214:217]
    ds_read_b64_tr_b16 a[210:211], v32 offset:18432
    v_mfma_f32_16x16x32_bf16 v[198:201], a[160:163], a[188:191], v[198:201]
    ds_read_b64_tr_b16 a[212:213], v34 offset:16384
    buffer_load_dwordx4 a[8:11], v79, s[28:31], s65 offen offset:2048 sc1
    v_mfma_f32_16x16x32_bf16 v[210:213], a[164:167], a[192:195], v[210:213]
    ds_read_b64_tr_b16 a[214:215], v34 offset:18432
    v_mfma_f32_16x16x32_bf16 v[218:221], a[164:167], a[196:199], v[218:221]
    ds_read_b64_tr_b16 a[216:217], v31 offset:20480
    v_mfma_f32_16x16x32_bf16 v[202:205], a[164:167], a[188:191], v[202:205]
    ds_read_b64_tr_b16 a[218:219], v31 offset:22528
    buffer_load_dwordx4 a[12:15], v79, s[28:31], s65 offen offset:3072 sc1
    v_mfma_f32_16x16x32_bf16 v[230:233], a[192:195], a[168:171], v[230:233]
    ds_read_b64_tr_b16 a[220:221], v33 offset:20480
    s_add_u32 s65, s65, 8192
    v_mfma_f32_16x16x32_bf16 v[238:241], a[196:199], a[168:171], v[238:241]
    ds_read_b64_tr_b16 a[222:223], v33 offset:22528
    s_cmp_eq_u32 s65, 57344
    v_mfma_f32_16x16x32_bf16 v[222:225], a[188:191], a[168:171], v[222:225]
    s_cselect_b32 s65, 0, s65
    v_mfma_f32_16x16x32_bf16 v[234:237], a[192:195], a[172:175], v[234:237]
    buffer_load_dwordx4 a[16:19], v79, s[28:31], s65 offen offset:0 sc1
    v_mfma_f32_16x16x32_bf16 v[242:245], a[196:199], a[172:175], v[242:245]
    v_mfma_f32_16x16x32_bf16 v[226:229], a[188:191], a[172:175], v[226:229]
    v_cvt_pk_bf16_f32 v118, v182, v183
    v_cvt_pk_bf16_f32 v119, v184, v185
    v_cvt_pk_bf16_f32 v120, v186, v187
    buffer_load_dwordx4 a[20:23], v79, s[28:31], s65 offen offset:1024 sc1
    v_cvt_pk_bf16_f32 v121, v188, v189
    v_cvt_pk_bf16_f32 v122, v190, v191
    v_cvt_pk_bf16_f32 v123, v192, v193
    v_cvt_pk_bf16_f32 v124, v194, v195
    v_cvt_pk_bf16_f32 v125, v196, v197
    v_cvt_pk_bf16_f32 v130, v206, v207
    v_cvt_pk_bf16_f32 v131, v208, v209
    v_cvt_pk_bf16_f32 v132, v210, v211
    v_cvt_pk_bf16_f32 v133, v212, v213
    v_cvt_pk_bf16_f32 v134, v214, v215
    v_cvt_pk_bf16_f32 v135, v216, v217
    v_cvt_pk_bf16_f32 v136, v218, v219
    v_cvt_pk_bf16_f32 v137, v220, v221
    v_cvt_pk_bf16_f32 v126, v198, v199
    buffer_load_dwordx4 a[24:27], v79, s[28:31], s65 offen offset:2048 sc1
    v_cvt_pk_bf16_f32 v127, v200, v201
    v_cvt_pk_bf16_f32 v128, v202, v203
    v_cvt_pk_bf16_f32 v129, v204, v205
    v_mfma_f32_16x16x32_bf16 v[154:157], v[130:133], v[118:121], 0
    v_mfma_f32_16x16x32_bf16 v[158:161], v[130:133], v[122:125], 0
    v_mfma_f32_16x16x32_bf16 v[162:165], v[134:137], v[122:125], 0
    buffer_load_dwordx4 a[28:31], v79, s[28:31], s65 offen offset:3072 sc1
    v_mfma_f32_16x16x32_bf16 v[150:153], v[126:129], v[118:121], 0
    v_cvt_pk_bf16_f32 v166, v222, v223
    v_cvt_pk_bf16_f32 v167, v224, v225
    v_cvt_pk_bf16_f32 v168, v230, v231
    v_cvt_pk_bf16_f32 v169, v232, v233
    v_cvt_pk_bf16_f32 v170, v238, v239
    v_cvt_pk_bf16_f32 v171, v240, v241
    v_cndmask_b32 v250, v158, v159, s[70:71]
    v_cndmask_b32 v253, v162, v163, s[70:71]
    v_cndmask_b32 v250, v250, v253, s[72:73]
    s_add_u32 s65, s65, 8192
    s_cmp_eq_u32 s65, 57344
    s_cselect_b32 s65, 0, s65
    buffer_load_dwordx4 a[32:35], v79, s[28:31], s65 offen offset:0 sc1
    v_mul_f32 v250, v250, v29
    v_cndmask_b32 v251, v160, v161, s[70:71]
    v_cndmask_b32 v253, v164, v165, s[70:71]
    v_cndmask_b32 v251, v251, v253, s[74:75]
    v_mul_f32 v251, v251, v30
    v_cndmask_b32 v246, v150, v151, s[70:71]
    v_cndmask_b32 v246, v84, v246, s[76:77]
    v_cndmask_b32 v249, v154, v155, s[70:71]
    v_cndmask_b32 v246, v246, v249, s[72:73]
    v_mul_f32 v246, v246, v27
    v_cndmask_b32 v247, v152, v153, s[70:71]
    v_cndmask_b32 v247, v84, v247, s[76:77]
    v_cndmask_b32 v249, v156, v157, s[70:71]
    v_cndmask_b32 v247, v247, v249, s[74:75]
    buffer_load_dwordx4 a[36:39], v79, s[28:31], s65 offen offset:1024 sc1
    v_mul_f32 v247, v247, v28
    v_max_f32 v248, v246, v247
    v_max_f32 v252, v250, v251
    v_mov_b32 v249, v248
    v_mov_b32 v253, v252
    v_cvt_pk_bf16_f32 v172, v226, v227
    v_permlane16_swap_b32 v248, v249
    v_permlane16_swap_b32 v252, v253
    v_max_f32 v248, v248, v249
    v_max_f32 v252, v252, v253
    v_mov_b32 v249, v248
    v_mov_b32 v253, v252
    v_cvt_pk_bf16_f32 v173, v228, v229
    v_permlane32_swap_b32 v248, v249
    buffer_load_dwordx4 a[40:43], v79, s[28:31], s65 offen offset:2048 sc1
    v_permlane32_swap_b32 v252, v253
    v_max_f32 v248, v248, v249
    v_max_f32 v252, v252, v253
    v_mul_f32 v248, v25, v248
    v_mul_f32 v252, v26, v252
    v_fma_f32 v246, v246, v25, -v248
    v_fma_f32 v247, v247, v25, -v248
    v_fma_f32 v250, v250, v26, -v252
    v_fma_f32 v251, v251, v26, -v252
    v_exp_f32 v246, v246
    v_exp_f32 v247, v247
    v_exp_f32 v250, v250
    buffer_load_dwordx4 a[44:47], v79, s[28:31], s65 offen offset:3072 sc1
    v_exp_f32 v251, v251
    v_add_f32 v248, v246, v247
    v_add_f32 v252, v250, v251
    v_mov_b32 v249, v248
    v_mov_b32 v253, v252
    v_cvt_pk_bf16_f32 v174, v234, v235
    v_permlane16_swap_b32 v248, v249
    v_permlane16_swap_b32 v252, v253
    v_add_f32 v248, v248, v249
    v_add_f32 v252, v252, v253
    v_mov_b32 v249, v248
    v_mov_b32 v253, v252
    s_add_u32 m0, s58, 131072
    s_add_u32 s64, s64, 524288
    s_cmp_eq_u32 s64, 3670016
    s_cselect_b32 s64, 0, s64
    s_add_u32 s64, s64, 524288
    s_cmp_eq_u32 s64, 3670016
    s_cselect_b32 s64, 0, s64
    v_xor_b32 v59, 128, v59
    buffer_load_dwordx4 v59, s[24:27], s64 offen lds
    v_cvt_pk_bf16_f32 v175, v236, v237
    v_permlane32_swap_b32 v248, v249
    v_permlane32_swap_b32 v252, v253
    v_add_f32 v248, v248, v249
    v_add_f32 v252, v252, v253
    v_rcp_f32 v248, v248
    v_rcp_f32 v252, v252
    v_cvt_pk_bf16_f32 v176, v242, v243
    v_cvt_pk_bf16_f32 v177, v244, v245
    v_mul_f32 v246, v246, v27
    v_xor_b32 v60, 128, v60
    buffer_load_dwordx4 v60, s[24:27], s64 offen offset:1024 lds
    v_mul_f32 v247, v247, v28
    v_mul_f32 v250, v250, v29
    v_mul_f32 v251, v251, v30
    v_mul_f32 v246, v246, v248
    v_mul_f32 v247, v247, v248
    v_mul_f32 v250, v250, v252
    v_mul_f32 v251, v251, v252
    v_cvt_pk_bf16_f32 v246, v246, v246
    v_cvt_pk_bf16_f32 v247, v247, v247
    v_cvt_pk_bf16_f32 v250, v250, v250
    v_cvt_pk_bf16_f32 v251, v251, v251
    v_and_b32 v138, v246, v104
    v_and_b32 v139, v247, v105
    v_xor_b32 v61, 128, v61
    buffer_load_dwordx4 v61, s[24:27], s64 offen offset:2048 lds
    v_and_b32 v140, v246, v106
    v_and_b32 v141, v247, v107
    v_and_b32 v142, v250, v104
    v_and_b32 v143, v251, v105
    v_and_b32 v144, v250, v106
    v_and_b32 v145, v251, v107
    v_mfma_f32_16x16x32_bf16 v[182:185], v[166:169], v[138:141], 0
    v_mfma_f32_16x16x32_bf16 v[186:189], v[172:175], v[138:141], 0
    v_xor_b32 v62, 128, v62
    buffer_load_dwordx4 v62, s[24:27], s64 offen offset:3072 lds
    v_mfma_f32_16x16x32_bf16 v[190:193], v[168:171], v[142:145], 0
    v_mfma_f32_16x16x32_bf16 v[194:197], v[174:177], v[142:145], 0
    s_add_u32 s83, s82, 16384
    s_nop 1
    v_cvt_pk_bf16_f32 v110, v182, v183
    v_cvt_pk_bf16_f32 v111, v184, v185
    s_add_u32 m0, s58, 147456
    s_add_u32 s64, s64, 524288
    s_cmp_eq_u32 s64, 3670016
    s_cselect_b32 s64, 0, s64
    buffer_load_dwordx4 v59, s[24:27], s64 offen lds
    v_cvt_pk_bf16_f32 v112, v186, v187
    v_cvt_pk_bf16_f32 v113, v188, v189
    v_cvt_pk_bf16_f32 v114, v190, v191
    v_cvt_pk_bf16_f32 v115, v192, v193
    v_cvt_pk_bf16_f32 v116, v194, v195
    v_cvt_pk_bf16_f32 v117, v196, v197
    buffer_store_dwordx4 v[110:113], v4, s[28:31], s82 offen sc1
    buffer_store_dwordx4 v[114:117], v4, s[28:31], s83 offen sc1
    s_cmp_lg_u32 s56, 0
    s_cbranch_scc0 L_nof
L_f:
    s_waitcnt vmcnt(17) lgkmcnt(8)
    v_mfma_f32_16x16x32_bf16 v[182:185], a[0:3], a[200:203], 0
    ds_read_b64_tr_b16 a[224:225], v32 offset:20480
    s_add_u32 s65, s65, 8192
    s_cmp_eq_u32 s65, 57344
    s_cselect_b32 s65, 0, s65
    buffer_load_dwordx4 a[48:51], v79, s[28:31], s65 offen offset:0 sc1
    v_mfma_f32_16x16x32_bf16 v[186:189], a[4:7], a[200:203], 0
    ds_read_b64_tr_b16 a[226:227], v32 offset:22528
    v_lshlrev_b32 v93, 16, v93
    v_mfma_f32_16x16x32_bf16 v[238:241], a[0:3], a[204:207], 0
    ds_read_b64_tr_b16 a[228:229], v34 offset:20480
    buffer_load_dwordx4 a[52:55], v79, s[28:31], s65 offen offset:1024 sc1
    v_mfma_f32_16x16x32_bf16 v[242:245], a[4:7], a[204:207], 0
    ds_read_b64_tr_b16 a[230:231], v34 offset:22528
    s_waitcnt lgkmcnt(8)
    v_mfma_f32_16x16x32_bf16 v[190:193], a[0:3], a[208:211], 0
    ds_read_b64_tr_b16 a[200:201], v35 offset:0
    v_lshlrev_b32 v222, 16, v96
    v_mfma_f32_16x16x32_bf16 v[194:197], a[4:7], a[208:211], 0
    ds_read_b64_tr_b16 a[202:203], v35 offset:2048
    v_and_b32 v223, 0xffff0000, v96
    v_mfma_f32_16x16x32_bf16 v[246:249], a[0:3], a[212:215], 0
    ds_read_b64_tr_b16 a[204:205], v37 offset:0
    buffer_load_dwordx4 a[56:59], v79, s[28:31], s65 offen offset:2048 sc1
    v_mfma_f32_16x16x32_bf16 v[250:253], a[4:7], a[212:215], 0
    ds_read_b64_tr_b16 a[206:207], v37 offset:2048
    s_waitcnt vmcnt(18) lgkmcnt(8)
    v_mfma_f32_16x16x32_bf16 v[182:185], a[8:11], a[216:219], v[182:185]
    ds_read_b64_tr_b16 a[208:209], v36 offset:0
    v_add_f32 v222, v222, v93
    v_mfma_f32_16x16x32_bf16 v[186:189], a[12:15], a[216:219], v[186:189]
    ds_read_b64_tr_b16 a[210:211], v36 offset:2048
    buffer_load_dwordx4 a[60:63], v79, s[28:31], s65 offen offset:3072 sc1
    v_add_f32 v223, v223, v93
    v_mfma_f32_16x16x32_bf16 v[238:241], a[8:11], a[220:223], v[238:241]
    ds_read_b64_tr_b16 a[212:213], v38 offset:0
    s_add_u32 s65, s65, 8192
    v_mfma_f32_16x16x32_bf16 v[242:245], a[12:15], a[220:223], v[242:245]
    ds_read_b64_tr_b16 a[214:215], v38 offset:2048
    s_waitcnt lgkmcnt(8)
    v_mfma_f32_16x16x32_bf16 v[190:193], a[8:11], a[224:227], v[190:193]
    ds_read_b64_tr_b16 a[216:217], v35 offset:4096
    s_cmp_eq_u32 s65, 57344
    v_mfma_f32_16x16x32_bf16 v[194:197], a[12:15], a[224:227], v[194:197]
    ds_read_b64_tr_b16 a[218:219], v35 offset:6144
    s_cselect_b32 s65, 0, s65
    v_lshlrev_b32 v224, 16, v97
    v_mfma_f32_16x16x32_bf16 v[246:249], a[8:11], a[228:231], v[246:249]
    ds_read_b64_tr_b16 a[220:221], v37 offset:4096
    buffer_load_dwordx4 a[64:67], v79, s[28:31], s65 offen offset:0 sc1
    v_mfma_f32_16x16x32_bf16 v[250:253], a[12:15], a[228:231], v[250:253]
    ds_read_b64_tr_b16 a[222:223], v37 offset:6144
    s_waitcnt vmcnt(18) lgkmcnt(8)
    v_mfma_f32_16x16x32_bf16 v[182:185], a[16:19], a[200:203], v[182:185]
    ds_read_b64_tr_b16 a[224:225], v36 offset:4096
    buffer_load_dwordx4 a[68:71], v79, s[28:31], s65 offen offset:1024 sc1
    v_mfma_f32_16x16x32_bf16 v[186:189], a[20:23], a[200:203], v[186:189]
    ds_read_b64_tr_b16 a[226:227], v36 offset:6144
    v_and_b32 v225, 0xffff0000, v97
    v_mfma_f32_16x16x32_bf16 v[238:241], a[16:19], a[204:207], v[238:241]
    ds_read_b64_tr_b16 a[228:229], v38 offset:4096
    v_add_f32 v224, v224, v93
    v_mfma_f32_16x16x32_bf16 v[242:245], a[20:23], a[204:207], v[242:245]
    ds_read_b64_tr_b16 a[230:231], v38 offset:6144
    s_waitcnt lgkmcnt(8)
    v_mfma_f32_16x16x32_bf16 v[190:193], a[16:19], a[208:211], v[190:193]
    ds_read_b64_tr_b16 a[200:201], v35 offset:16384
    buffer_load_dwordx4 a[72:75], v79, s[28:31], s65 offen offset:2048 sc1
    v_mfma_f32_16x16x32_bf16 v[194:197], a[20:23], a[208:211], v[194:197]
    ds_read_b64_tr_b16 a[202:203], v35 offset:18432
    v_add_f32 v225, v225, v93
    v_mfma_f32_16x16x32_bf16 v[246:249], a[16:19], a[212:215], v[246:249]
    ds_read_b64_tr_b16 a[204:205], v37 offset:16384
    v_lshlrev_b32 v226, 16, v98
    v_mfma_f32_16x16x32_bf16 v[250:253], a[20:23], a[212:215], v[250:253]
    ds_read_b64_tr_b16 a[206:207], v37 offset:18432
    s_waitcnt vmcnt(18) lgkmcnt(8)
    v_mfma_f32_16x16x32_bf16 v[182:185], a[24:27], a[216:219], v[182:185]
    ds_read_b64_tr_b16 a[208:209], v36 offset:16384
    buffer_load_dwordx4 a[76:79], v79, s[28:31], s65 offen offset:3072 sc1
    v_mfma_f32_16x16x32_bf16 v[186:189], a[28:31], a[216:219], v[186:189]
    ds_read_b64_tr_b16 a[210:211], v36 offset:18432
    s_add_u32 s65, s65, 8192
    v_and_b32 v227, 0xffff0000, v98
    v_mfma_f32_16x16x32_bf16 v[238:241], a[24:27], a[220:223], v[238:241]
    ds_read_b64_tr_b16 a[212:213], v38 offset:16384
    s_cmp_eq_u32 s65, 57344
    v_mfma_f32_16x16x32_bf16 v[242:245], a[28:31], a[220:223], v[242:245]
    ds_read_b64_tr_b16 a[214:215], v38 offset:18432
    v_add_f32 v226, v226, v93
    s_waitcnt lgkmcnt(8)
    v_mfma_f32_16x16x32_bf16 v[190:193], a[24:27], a[224:227], v[190:193]
    ds_read_b64_tr_b16 a[216:217], v35 offset:20480
    s_cselect_b32 s65, 0, s65
    buffer_load_dwordx4 a[80:83], v79, s[28:31], s65 offen offset:0 sc1
    v_mfma_f32_16x16x32_bf16 v[194:197], a[28:31], a[224:227], v[194:197]
    ds_read_b64_tr_b16 a[218:219], v35 offset:22528
    v_add_f32 v227, v227, v93
    v_mfma_f32_16x16x32_bf16 v[246:249], a[24:27], a[228:231], v[246:249]
    ds_read_b64_tr_b16 a[220:221], v37 offset:20480
    buffer_load_dwordx4 a[84:87], v79, s[28:31], s65 offen offset:1024 sc1
    v_mfma_f32_16x16x32_bf16 v[250:253], a[28:31], a[228:231], v[250:253]
    ds_read_b64_tr_b16 a[222:223], v37 offset:22528
    v_lshlrev_b32 v228, 16, v99
    s_waitcnt vmcnt(19) lgkmcnt(8)
    v_mfma_f32_16x16x32_bf16 v[182:185], a[32:35], a[200:203], v[182:185]
    ds_read_b64_tr_b16 a[224:225], v36 offset:20480
    v_and_b32 v229, 0xffff0000, v99
    v_mfma_f32_16x16x32_bf16 v[186:189], a[36:39], a[200:203], v[186:189]
    ds_read_b64_tr_b16 a[226:227], v36 offset:22528
    buffer_load_dwordx4 a[88:91], v79, s[28:31], s65 offen offset:2048 sc1
    v_add_f32 v228, v228, v93
    v_mfma_f32_16x16x32_bf16 v[238:241], a[32:35], a[204:207], v[238:241]
    ds_read_b64_tr_b16 a[228:229], v38 offset:20480
    v_add_f32 v229, v229, v93
    v_mfma_f32_16x16x32_bf16 v[242:245], a[36:39], a[204:207], v[242:245]
    ds_read_b64_tr_b16 a[230:231], v38 offset:22528
    s_waitcnt lgkmcnt(8)
    v_mfma_f32_16x16x32_bf16 v[190:193], a[32:35], a[208:211], v[190:193]
    s_waitcnt vmcnt(11)
    s_barrier
    s_cmp_lg_u32 s48, 0
    s_cbranch_scc1 L_sig4
    s_atomic_add s36, s[28:29], s69
L_sig4:
    ds_read_b64_tr_b16 a[200:201], v31 offset:32768
    buffer_load_dwordx4 a[92:95], v79, s[28:31], s65 offen offset:3072 sc1
    v_mfma_f32_16x16x32_bf16 v[194:197], a[36:39], a[208:211], v[194:197]
    ds_read_b64_tr_b16 a[202:203], v31 offset:34816
    s_add_u32 s65, s65, 8192
    v_lshlrev_b32 v94, 16, v94
    v_mfma_f32_16x16x32_bf16 v[246:249], a[32:35], a[212:215], v[246:249]
    ds_read_b64_tr_b16 a[204:205], v33 offset:32768
    s_cmp_eq_u32 s65, 57344
    v_mfma_f32_16x16x32_bf16 v[250:253], a[36:39], a[212:215], v[250:253]
    ds_read_b64_tr_b16 a[206:207], v33 offset:34816
    s_waitcnt lgkmcnt(8)
    v_mfma_f32_16x16x32_bf16 v[182:185], a[40:43], a[216:219], v[182:185]
    ds_read_b64_tr_b16 a[208:209], v32 offset:32768
    s_cselect_b32 s65, 0, s65
    v_mfma_f32_16x16x32_bf16 v[186:189], a[44:47], a[216:219], v[186:189]
    ds_read_b64_tr_b16 a[210:211], v32 offset:34816
    buffer_load_dwordx4 a[96:99], v79, s[28:31], s65 offen offset:0 sc1
    v_lshlrev_b32 v230, 16, v100
    v_mfma_f32_16x16x32_bf16 v[238:241], a[40:43], a[220:223], v[238:241]
    ds_read_b64_tr_b16 a[212:213], v34 offset:32768
    v_and_b32 v231, 0xffff0000, v100
    v_mfma_f32_16x16x32_bf16 v[242:245], a[44:47], a[220:223], v[242:245]
    ds_read_b64_tr_b16 a[214:215], v34 offset:34816
    s_waitcnt lgkmcnt(8)
    v_mfma_f32_16x16x32_bf16 v[190:193], a[40:43], a[224:227], v[190:193]
    ds_read_b64_tr_b16 a[216:217], v31 offset:36864
    buffer_load_dwordx4 a[100:103], v79, s[28:31], s65 offen offset:1024 sc1
    v_mfma_f32_16x16x32_bf16 v[194:197], a[44:47], a[224:227], v[194:197]
    ds_read_b64_tr_b16 a[218:219], v31 offset:38912
    v_add_f32 v230, v230, v94
    v_mfma_f32_16x16x32_bf16 v[246:249], a[40:43], a[228:231], v[246:249]
    ds_read_b64_tr_b16 a[220:221], v33 offset:36864
    buffer_load_dwordx4 a[104:107], v79, s[28:31], s65 offen offset:2048 sc1
    v_mfma_f32_16x16x32_bf16 v[250:253], a[44:47], a[228:231], v[250:253]
    ds_read_b64_tr_b16 a[222:223], v33 offset:38912
    v_add_f32 v231, v231, v94
    s_waitcnt vmcnt(13) lgkmcnt(8)
    v_mfma_f32_16x16x32_bf16 v[182:185], a[48:51], a[200:203], v[182:185]
    ds_read_b64_tr_b16 a[224:225], v32 offset:36864
    v_lshlrev_b32 v232, 16, v101
    v_mfma_f32_16x16x32_bf16 v[186:189], a[52:55], a[200:203], v[186:189]
    ds_read_b64_tr_b16 a[226:227], v32 offset:38912
    v_and_b32 v233, 0xffff0000, v101
    v_mfma_f32_16x16x32_bf16 v[238:241], a[48:51], a[204:207], v[238:241]
    ds_read_b64_tr_b16 a[228:229], v34 offset:36864
    buffer_load_dwordx4 a[108:111], v79, s[28:31], s65 offen offset:3072 sc1
    v_mfma_f32_16x16x32_bf16 v[242:245], a[52:55], a[204:207], v[242:245]
    ds_read_b64_tr_b16 a[230:231], v34 offset:38912
    s_waitcnt lgkmcnt(8)
    v_mfma_f32_16x16x32_bf16 v[190:193], a[48:51], a[208:211], v[190:193]
    ds_read_b64_tr_b16 a[200:201], v31 offset:49152
    v_add_f32 v232, v232, v94
    v_mfma_f32_16x16x32_bf16 v[194:197], a[52:55], a[208:211], v[194:197]
    ds_read_b64_tr_b16 a[202:203], v31 offset:51200
    buffer_load_dwordx4 v60, s[24:27], s64 offen offset:1024 lds
    v_add_f32 v233, v233, v94
    v_mfma_f32_16x16x32_bf16 v[246:249], a[48:51], a[212:215], v[246:249]
    ds_read_b64_tr_b16 a[204:205], v33 offset:49152
    v_lshlrev_b32 v234, 16, v102
    v_mfma_f32_16x16x32_bf16 v[250:253], a[52:55], a[212:215], v[250:253]
    ds_read_b64_tr_b16 a[206:207], v33 offset:51200
    s_waitcnt vmcnt(13) lgkmcnt(8)
    v_mfma_f32_16x16x32_bf16 v[182:185], a[56:59], a[216:219], v[182:185]
    ds_read_b64_tr_b16 a[208:209], v32 offset:49152
    buffer_load_dwordx4 v61, s[24:27], s64 offen offset:2048 lds
    v_mfma_f32_16x16x32_bf16 v[186:189], a[60:63], a[216:219], v[186:189]
    ds_read_b64_tr_b16 a[210:211], v32 offset:51200
    v_and_b32 v235, 0xffff0000, v102
    v_mfma_f32_16x16x32_bf16 v[238:241], a[56:59], a[220:223], v[238:241]
    ds_read_b64_tr_b16 a[212:213], v34 offset:49152
    buffer_load_dwordx4 v62, s[24:27], s64 offen offset:3072 lds
    v_mfma_f32_16x16x32_bf16 v[242:245], a[60:63], a[220:223], v[242:245]
    ds_read_b64_tr_b16 a[214:215], v34 offset:51200
    s_waitcnt lgkmcnt(8)
    v_mfma_f32_16x16x32_bf16 v[190:193], a[56:59], a[224:227], v[190:193]
    ds_read_b64_tr_b16 a[216:217], v31 offset:53248
    s_add_u32 m0, s58, 16384
    v_mfma_f32_16x16x32_bf16 v[194:197], a[60:63], a[224:227], v[194:197]
    ds_read_b64_tr_b16 a[218:219], v31 offset:55296
    s_add_u32 s64, s64, 524288
    v_add_f32 v234, v234, v94
    v_mfma_f32_16x16x32_bf16 v[246:249], a[56:59], a[228:231], v[246:249]
    ds_read_b64_tr_b16 a[220:221], v33 offset:53248
    s_cmp_eq_u32 s64, 3670016
    v_mfma_f32_16x16x32_bf16 v[250:253], a[60:63], a[228:231], v[250:253]
    ds_read_b64_tr_b16 a[222:223], v33 offset:55296
    s_cselect_b32 s64, 0, s64
    buffer_load_dwordx4 v59, s[24:27], s64 offen lds
    v_add_f32 v235, v235, v94
    s_waitcnt vmcnt(14) lgkmcnt(8)
    v_mfma_f32_16x16x32_bf16 v[182:185], a[64:67], a[200:203], v[182:185]
    ds_read_b64_tr_b16 a[224:225], v32 offset:53248
    v_lshlrev_b32 v236, 16, v103
    v_mfma_f32_16x16x32_bf16 v[186:189], a[68:71], a[200:203], v[186:189]
    ds_read_b64_tr_b16 a[226:227], v32 offset:55296
    buffer_load_dwordx4 v60, s[24:27], s64 offen offset:1024 lds
    v_and_b32 v237, 0xffff0000, v103
    v_mfma_f32_16x16x32_bf16 v[238:241], a[64:67], a[204:207], v[238:241]
    ds_read_b64_tr_b16 a[228:229], v34 offset:53248
    v_add_f32 v236, v236, v94
    v_mfma_f32_16x16x32_bf16 v[242:245], a[68:71], a[204:207], v[242:245]
    ds_read_b64_tr_b16 a[230:231], v34 offset:55296
    s_waitcnt lgkmcnt(8)
    v_mfma_f32_16x16x32_bf16 v[190:193], a[64:67], a[208:211], v[190:193]
    s_barrier
    ds_read_b64_tr_b16 a[200:201], v35 offset:32768
    buffer_load_dwordx4 v61, s[24:27], s64 offen offset:2048 lds
    v_mfma_f32_16x16x32_bf16 v[194:197], a[68:71], a[208:211], v[194:197]
    ds_read_b64_tr_b16 a[202:203], v35 offset:34816
    v_add_f32 v237, v237, v94
    v_mfma_f32_16x16x32_bf16 v[246:249], a[64:67], a[212:215], v[246:249]
    ds_read_b64_tr_b16 a[204:205], v37 offset:32768
    v_mfma_f32_16x16x32_bf16 v[250:253], a[68:71], a[212:215], v[250:253]
    ds_read_b64_tr_b16 a[206:207], v37 offset:34816
    s_waitcnt vmcnt(14) lgkmcnt(8)
    v_mfma_f32_16x16x32_bf16 v[182:185], a[72:75], a[216:219], v[182:185]
    ds_read_b64_tr_b16 a[208:209], v36 offset:32768
    buffer_load_dwordx4 v62, s[24:27], s64 offen offset:3072 lds
    v_mfma_f32_16x16x32_bf16 v[186:189], a[76:79], a[216:219], v[186:189]
    ds_read_b64_tr_b16 a[210:211], v36 offset:34816
    s_add_u32 m0, s58, 65536
    v_mfma_f32_16x16x32_bf16 v[238:241], a[72:75], a[220:223], v[238:241]
    ds_read_b64_tr_b16 a[212:213], v38 offset:32768
    s_add_u32 s64, s64, 524288
    v_mfma_f32_16x16x32_bf16 v[242:245], a[76:79], a[220:223], v[242:245]
    ds_read_b64_tr_b16 a[214:215], v38 offset:34816
    s_waitcnt lgkmcnt(8)
    v_mfma_f32_16x16x32_bf16 v[190:193], a[72:75], a[224:227], v[190:193]
    ds_read_b64_tr_b16 a[216:217], v35 offset:36864
    s_cmp_eq_u32 s64, 3670016
    v_mfma_f32_16x16x32_bf16 v[194:197], a[76:79], a[224:227], v[194:197]
    ds_read_b64_tr_b16 a[218:219], v35 offset:38912
    s_cselect_b32 s64, 0, s64
    buffer_load_dwordx4 v59, s[24:27], s64 offen lds
    v_mfma_f32_16x16x32_bf16 v[246:249], a[72:75], a[228:231], v[246:249]
    ds_read_b64_tr_b16 a[220:221], v37 offset:36864
    v_mfma_f32_16x16x32_bf16 v[250:253], a[76:79], a[228:231], v[250:253]
    ds_read_b64_tr_b16 a[222:223], v37 offset:38912
    s_waitcnt vmcnt(14) lgkmcnt(8)
    v_mfma_f32_16x16x32_bf16 v[182:185], a[80:83], a[200:203], v[182:185]
    ds_read_b64_tr_b16 a[224:225], v36 offset:36864
    buffer_load_dwordx4 v60, s[24:27], s64 offen offset:1024 lds
    v_mfma_f32_16x16x32_bf16 v[186:189], a[84:87], a[200:203], v[186:189]
    ds_read_b64_tr_b16 a[226:227], v36 offset:38912
    v_mfma_f32_16x16x32_bf16 v[238:241], a[80:83], a[204:207], v[238:241]
    ds_read_b64_tr_b16 a[228:229], v38 offset:36864
    v_mfma_f32_16x16x32_bf16 v[242:245], a[84:87], a[204:207], v[242:245]
    ds_read_b64_tr_b16 a[230:231], v38 offset:38912
    s_waitcnt lgkmcnt(8)
    v_mfma_f32_16x16x32_bf16 v[190:193], a[80:83], a[208:211], v[190:193]
    ds_read_b64_tr_b16 a[200:201], v35 offset:49152
    buffer_load_dwordx4 v61, s[24:27], s64 offen offset:2048 lds
    v_mfma_f32_16x16x32_bf16 v[194:197], a[84:87], a[208:211], v[194:197]
    ds_read_b64_tr_b16 a[202:203], v35 offset:51200
    v_mfma_f32_16x16x32_bf16 v[246:249], a[80:83], a[212:215], v[246:249]
    ds_read_b64_tr_b16 a[204:205], v37 offset:49152
    v_mfma_f32_16x16x32_bf16 v[250:253], a[84:87], a[212:215], v[250:253]
    ds_read_b64_tr_b16 a[206:207], v37 offset:51200
    s_waitcnt vmcnt(14) lgkmcnt(8)
    v_mfma_f32_16x16x32_bf16 v[182:185], a[88:91], a[216:219], v[182:185]
    ds_read_b64_tr_b16 a[208:209], v36 offset:49152
L_pad3:
    s_cbranch_execz L_warm
    buffer_load_dwordx4 v62, s[24:27], s64 offen offset:3072 lds
    v_mfma_f32_16x16x32_bf16 v[186:189], a[92:95], a[216:219], v[186:189]
    ds_read_b64_tr_b16 a[210:211], v36 offset:51200
    s_add_u32 m0, s58, 81920
    v_mfma_f32_16x16x32_bf16 v[238:241], a[88:91], a[220:223], v[238:241]
    ds_read_b64_tr_b16 a[212:213], v38 offset:49152
    s_add_u32 s64, s64, 524288
    v_mfma_f32_16x16x32_bf16 v[242:245], a[92:95], a[220:223], v[242:245]
    ds_read_b64_tr_b16 a[214:215], v38 offset:51200
    s_waitcnt lgkmcnt(8)
    v_mfma_f32_16x16x32_bf16 v[190:193], a[88:91], a[224:227], v[190:193]
    ds_read_b64_tr_b16 a[216:217], v35 offset:53248
    s_cmp_eq_u32 s64, 3670016
    s_cselect_b32 s64, 0, s64
    buffer_load_dwordx4 v59, s[24:27], s64 offen lds
    v_mfma_f32_16x16x32_bf16 v[194:197], a[92:95], a[224:227], v[194:197]
    ds_read_b64_tr_b16 a[218:219], v35 offset:55296
    v_mfma_f32_16x16x32_bf16 v[246:249], a[88:91], a[228:231], v[246:249]
    ds_read_b64_tr_b16 a[220:221], v37 offset:53248
    buffer_load_dwordx4 v60, s[24:27], s64 offen offset:1024 lds
    v_mfma_f32_16x16x32_bf16 v[250:253], a[92:95], a[228:231], v[250:253]
    ds_read_b64_tr_b16 a[222:223], v37 offset:55296
    s_waitcnt vmcnt(15) lgkmcnt(8)
    v_mfma_f32_16x16x32_bf16 v[182:185], a[96:99], a[200:203], v[182:185]
    ds_read_b64_tr_b16 a[224:225], v36 offset:53248
    v_mfma_f32_16x16x32_bf16 v[186:189], a[100:103], a[200:203], v[186:189]
    ds_read_b64_tr_b16 a[226:227], v36 offset:55296
    v_mfma_f32_16x16x32_bf16 v[238:241], a[96:99], a[204:207], v[238:241]
    ds_read_b64_tr_b16 a[228:229], v38 offset:53248
    buffer_load_dwordx4 v61, s[24:27], s64 offen offset:2048 lds
    v_mfma_f32_16x16x32_bf16 v[242:245], a[100:103], a[204:207], v[242:245]
    ds_read_b64_tr_b16 a[230:231], v38 offset:55296
    s_waitcnt lgkmcnt(8)
    v_mfma_f32_16x16x32_bf16 v[190:193], a[96:99], a[208:211], v[190:193]
    ds_read_b64_tr_b16 a[200:201], v31 offset:0
    v_mfma_f32_16x16x32_bf16 v[194:197], a[100:103], a[208:211], v[194:197]
    ds_read_b64_tr_b16 a[202:203], v31 offset:2048
    v_mfma_f32_16x16x32_bf16 v[246:249], a[96:99], a[212:215], v[246:249]
    ds_read_b64_tr_b16 a[204:205], v33 offset:0
    buffer_load_dwordx4 v62, s[24:27], s64 offen offset:3072 lds
    v_mfma_f32_16x16x32_bf16 v[250:253], a[100:103], a[212:215], v[250:253]
    ds_read_b64_tr_b16 a[206:207], v33 offset:2048
    s_waitcnt vmcnt(15) lgkmcnt(8)
    v_mfma_f32_16x16x32_bf16 v[182:185], a[104:107], a[216:219], v[182:185]
    ds_read_b64_tr_b16 a[208:209], v32 offset:0
    s_add_u32 m0, s58, 32768
    v_mfma_f32_16x16x32_bf16 v[186:189], a[108:111], a[216:219], v[186:189]
    ds_read_b64_tr_b16 a[210:211], v32 offset:2048
    s_add_u32 s64, s64, 524288
    v_mfma_f32_16x16x32_bf16 v[238:241], a[104:107], a[220:223], v[238:241]
    ds_read_b64_tr_b16 a[212:213], v34 offset:0
    s_cmp_eq_u32 s64, 3670016
    v_mfma_f32_16x16x32_bf16 v[242:245], a[108:111], a[220:223], v[242:245]
    ds_read_b64_tr_b16 a[214:215], v34 offset:2048
    s_cselect_b32 s64, 0, s64
    buffer_load_dwordx4 v59, s[24:27], s64 offen lds
    s_waitcnt lgkmcnt(8)
    v_mfma_f32_16x16x32_bf16 v[190:193], a[104:107], a[224:227], v[190:193]
    ds_read_b64_tr_b16 a[216:217], v31 offset:4096
    v_mfma_f32_16x16x32_bf16 v[194:197], a[108:111], a[224:227], v[194:197]
    ds_read_b64_tr_b16 a[218:219], v31 offset:6144
    buffer_load_dwordx4 v60, s[24:27], s64 offen offset:1024 lds
    v_mfma_f32_16x16x32_bf16 v[246:249], a[104:107], a[228:231], v[246:249]
    ds_read_b64_tr_b16 a[220:221], v33 offset:4096
    v_mfma_f32_16x16x32_bf16 v[250:253], a[108:111], a[228:231], v[250:253]
    ds_read_b64_tr_b16 a[222:223], v33 offset:6144
    s_waitcnt lgkmcnt(8)
    v_mfma_f32_16x16x32_bf16 v[150:153], a[0:3], a[200:203], 0
    ds_read_b64_tr_b16 a[224:225], v32 offset:4096
    v_mfma_f32_16x16x32_bf16 v[154:157], a[4:7], a[200:203], 0
    ds_read_b64_tr_b16 a[226:227], v32 offset:6144
    buffer_load_dwordx4 v61, s[24:27], s64 offen offset:2048 lds
    v_mfma_f32_16x16x32_bf16 v[166:169], a[0:3], a[204:207], 0
    ds_read_b64_tr_b16 a[228:229], v34 offset:4096
    v_cvt_pk_bf16_f32 v182, v182, v183
    v_mfma_f32_16x16x32_bf16 v[170:173], a[4:7], a[204:207], 0
    ds_read_b64_tr_b16 a[230:231], v34 offset:6144
    v_cvt_pk_bf16_f32 v183, v184, v185
    v_cvt_pk_bf16_f32 v184, v186, v187
    s_waitcnt lgkmcnt(8)
    v_mfma_f32_16x16x32_bf16 v[158:161], a[0:3], a[208:211], 0
    s_waitcnt vmcnt(15)
    s_barrier
    ds_read_b64_tr_b16 a[200:201], v39 offset:0
    buffer_load_dwordx4 v62, s[24:27], s64 offen offset:3072 lds
    v_mfma_f32_16x16x32_bf16 v[162:165], a[4:7], a[208:211], 0
    ds_read_b64_tr_b16 a[202:203], v39 offset:2048
    s_add_u32 m0, s58, 49152
    v_cvt_pk_bf16_f32 v185, v188, v189
    buffer_store_dwordx4 v[182:185], v21, s[28:31], 0 offen offset:0 sc1
    v_cvt_pk_bf16_f32 v190, v190, v191
    v_cvt_pk_bf16_f32 v191, v192, v193
    v_cvt_pk_bf16_f32 v192, v194, v195
    v_mfma_f32_16x16x32_bf16 v[174:177], a[0:3], a[212:215], 0
    ds_read_b64_tr_b16 a[204:205], v41 offset:0
    s_add_u32 s66, s66, 1
    v_mfma_f32_16x16x32_bf16 v[178:181], a[4:7], a[212:215], 0
    ds_read_b64_tr_b16 a[206:207], v41 offset:2048
    v_cvt_pk_bf16_f32 v193, v196, v197
    buffer_store_dwordx4 v[190:193], v21, s[28:31], 0 offen offset:1024 sc1
    v_cvt_pk_bf16_f32 v238, v238, v239
    v_cvt_pk_bf16_f32 v239, v240, v241
    v_cvt_pk_bf16_f32 v240, v242, v243
    s_waitcnt lgkmcnt(8)
    v_mfma_f32_16x16x32_bf16 v[150:153], a[8:11], a[216:219], v[150:153]
    ds_read_b64_tr_b16 a[208:209], v40 offset:0
    s_and_b32 s66, s66, 3
    v_mfma_f32_16x16x32_bf16 v[154:157], a[12:15], a[216:219], v[154:157]
    ds_read_b64_tr_b16 a[210:211], v40 offset:2048
    s_mul_i32 s61, s66, 100352
    buffer_load_dwordx4 v63, s[16:19], s61 offen lds
    v_cvt_pk_bf16_f32 v241, v244, v245
    buffer_store_dwordx4 v[238:241], v21, s[28:31], 0 offen offset:2048 sc1
    v_cvt_pk_bf16_f32 v246, v246, v247
    v_cvt_pk_bf16_f32 v247, v248, v249
    v_cvt_pk_bf16_f32 v248, v250, v251
    v_mfma_f32_16x16x32_bf16 v[166:169], a[8:11], a[220:223], v[166:169]
    ds_read_b64_tr_b16 a[212:213], v42 offset:0
    v_cvt_pk_bf16_f32 v249, v252, v253
    v_mfma_f32_16x16x32_bf16 v[170:173], a[12:15], a[220:223], v[170:173]
    ds_read_b64_tr_b16 a[214:215], v42 offset:2048
    s_waitcnt lgkmcnt(8)
    v_mfma_f32_16x16x32_bf16 v[158:161], a[8:11], a[224:227], v[158:161]
    ds_read_b64_tr_b16 a[216:217], v39 offset:4096
    buffer_load_dwordx4 v64, s[16:19], s61 offen offset:1024 lds
    v_mfma_f32_16x16x32_bf16 v[162:165], a[12:15], a[224:227], v[162:165]
    ds_read_b64_tr_b16 a[218:219], v39 offset:6144
    s_add_u32 s61, s61, 48128
    buffer_store_dwordx4 v[246:249], v21, s[28:31], 0 offen offset:3072 sc1
    v_mfma_f32_16x16x32_bf16 v[174:177], a[8:11], a[228:231], v[174:177]
    ds_read_b64_tr_b16 a[220:221], v41 offset:4096
    v_mfma_f32_16x16x32_bf16 v[178:181], a[12:15], a[228:231], v[178:181]
    ds_read_b64_tr_b16 a[222:223], v41 offset:6144
    s_waitcnt lgkmcnt(8)
    v_mfma_f32_16x16x32_bf16 v[150:153], a[16:19], a[200:203], v[150:153]
    ds_read_b64_tr_b16 a[224:225], v40 offset:4096
    buffer_load_dwordx4 v63, s[16:19], s61 offen offset:2048 lds
    v_mfma_f32_16x16x32_bf16 v[154:157], a[20:23], a[200:203], v[154:157]
    ds_read_b64_tr_b16 a[226:227], v40 offset:6144
    v_mfma_f32_16x16x32_bf16 v[166:169], a[16:19], a[204:207], v[166:169]
    ds_read_b64_tr_b16 a[228:229], v42 offset:4096
    v_mfma_f32_16x16x32_bf16 v[170:173], a[20:23], a[204:207], v[170:173]
    ds_read_b64_tr_b16 a[230:231], v42 offset:6144
    s_waitcnt lgkmcnt(8)
    v_mfma_f32_16x16x32_bf16 v[158:161], a[16:19], a[208:211], v[158:161]
    s_load_dword s14, s[28:29], s39
    ds_read_b64_tr_b16 a[200:201], v39 offset:16384
    buffer_load_dwordx4 v64, s[16:19], s61 offen offset:3072 lds
    v_mfma_f32_16x16x32_bf16 v[162:165], a[20:23], a[208:211], v[162:165]
    ds_read_b64_tr_b16 a[202:203], v39 offset:18432
    s_add_u32 m0, s58, 98304
    v_mfma_f32_16x16x32_bf16 v[174:177], a[16:19], a[212:215], v[174:177]
    ds_read_b64_tr_b16 a[204:205], v41 offset:16384
    s_add_u32 s66, s66, 1
    v_mfma_f32_16x16x32_bf16 v[178:181], a[20:23], a[212:215], v[178:181]
    ds_read_b64_tr_b16 a[206:207], v41 offset:18432
    s_waitcnt lgkmcnt(8)
    v_mfma_f32_16x16x32_bf16 v[150:153], a[24:27], a[216:219], v[150:153]
    ds_read_b64_tr_b16 a[208:209], v40 offset:16384
    s_and_b32 s66, s66, 3
    s_mul_i32 s61, s66, 100352
    buffer_load_dwordx4 v63, s[16:19], s61 offen lds
    v_mfma_f32_16x16x32_bf16 v[154:157], a[28:31], a[216:219], v[154:157]
    ds_read_b64_tr_b16 a[210:211], v40 offset:18432
    v_mfma_f32_16x16x32_bf16 v[166:169], a[24:27], a[220:223], v[166:169]
    ds_read_b64_tr_b16 a[212:213], v42 offset:16384
    buffer_load_dwordx4 v64, s[16:19], s61 offen offset:1024 lds
    v_mfma_f32_16x16x32_bf16 v[170:173], a[28:31], a[220:223], v[170:173]
    ds_read_b64_tr_b16 a[214:215], v42 offset:18432
    s_waitcnt lgkmcnt(8)
    v_mfma_f32_16x16x32_bf16 v[158:161], a[24:27], a[224:227], v[158:161]
    ds_read_b64_tr_b16 a[216:217], v39 offset:20480
    s_add_u32 s61, s61, 48128
    v_mfma_f32_16x16x32_bf16 v[162:165], a[28:31], a[224:227], v[162:165]
    ds_read_b64_tr_b16 a[218:219], v39 offset:22528
    v_mfma_f32_16x16x32_bf16 v[174:177], a[24:27], a[228:231], v[174:177]
    ds_read_b64_tr_b16 a[220:221], v41 offset:20480
    buffer_load_dwordx4 v63, s[16:19], s61 offen offset:2048 lds
    v_mfma_f32_16x16x32_bf16 v[178:181], a[28:31], a[228:231], v[178:181]
    ds_read_b64_tr_b16 a[222:223], v41 offset:22528
    s_waitcnt lgkmcnt(8)
    v_mfma_f32_16x16x32_bf16 v[150:153], a[32:35], a[200:203], v[150:153]
    ds_read_b64_tr_b16 a[224:225], v40 offset:20480
    v_mfma_f32_16x16x32_bf16 v[154:157], a[36:39], a[200:203], v[154:157]
    ds_read_b64_tr_b16 a[226:227], v40 offset:22528
    v_mfma_f32_16x16x32_bf16 v[166:169], a[32:35], a[204:207], v[166:169]
    ds_read_b64_tr_b16 a[228:229], v42 offset:20480
    buffer_load_dwordx4 v64, s[16:19], s61 offen offset:3072 lds
    v_mfma_f32_16x16x32_bf16 v[170:173], a[36:39], a[204:207], v[170:173]
    ds_read_b64_tr_b16 a[230:231], v42 offset:22528
    s_waitcnt lgkmcnt(8)
    v_mfma_f32_16x16x32_bf16 v[158:161], a[32:35], a[208:211], v[158:161]
    s_waitcnt vmcnt(20)
    s_barrier
    ds_read_b64_tr_b16 a[200:201], v31 offset:16384
    s_add_u32 m0, s58, 114688
    v_mfma_f32_16x16x32_bf16 v[162:165], a[36:39], a[208:211], v[162:165]
    ds_read_b64_tr_b16 a[202:203], v31 offset:18432
    s_add_u32 s66, s66, 1
    v_mfma_f32_16x16x32_bf16 v[174:177], a[32:35], a[212:215], v[174:177]
    ds_read_b64_tr_b16 a[204:205], v33 offset:16384
    s_and_b32 s66, s66, 3
    v_mfma_f32_16x16x32_bf16 v[178:181], a[36:39], a[212:215], v[178:181]
    ds_read_b64_tr_b16 a[206:207], v33 offset:18432
    s_mul_i32 s61, s66, 100352
    buffer_load_dwordx4 v63, s[16:19], s61 offen lds
    s_waitcnt lgkmcnt(8)
    v_mfma_f32_16x16x32_bf16 v[150:153], a[40:43], a[216:219], v[150:153]
    ds_read_b64_tr_b16 a[208:209], v32 offset:16384
    v_mfma_f32_16x16x32_bf16 v[154:157], a[44:47], a[216:219], v[154:157]
    ds_read_b64_tr_b16 a[210:211], v32 offset:18432
    buffer_load_dwordx4 v64, s[16:19], s61 offen offset:1024 lds
    v_mfma_f32_16x16x32_bf16 v[166:169], a[40:43], a[220:223], v[166:169]
    ds_read_b64_tr_b16 a[212:213], v34 offset:16384
    s_add_u32 s61, s61, 48128
    v_mfma_f32_16x16x32_bf16 v[170:173], a[44:47], a[220:223], v[170:173]
    ds_read_b64_tr_b16 a[214:215], v34 offset:18432
    s_waitcnt lgkmcnt(8)
    v_mfma_f32_16x16x32_bf16 v[158:161], a[40:43], a[224:227], v[158:161]
    ds_read_b64_tr_b16 a[216:217], v31 offset:20480
    v_mfma_f32_16x16x32_bf16 v[162:165], a[44:47], a[224:227], v[162:165]
    ds_read_b64_tr_b16 a[218:219], v31 offset:22528
    buffer_load_dwordx4 v63, s[16:19], s61 offen offset:2048 lds
    v_mfma_f32_16x16x32_bf16 v[174:177], a[40:43], a[228:231], v[174:177]
    ds_read_b64_tr_b16 a[220:221], v33 offset:20480
    v_mfma_f32_16x16x32_bf16 v[178:181], a[44:47], a[228:231], v[178:181]
    ds_read_b64_tr_b16 a[222:223], v33 offset:22528
    s_waitcnt lgkmcnt(8)
    v_mfma_f32_16x16x32_bf16 v[150:153], a[48:51], a[200:203], v[150:153]
    ds_read_b64_tr_b16 a[224:225], v32 offset:20480
    v_mfma_f32_16x16x32_bf16 v[154:157], a[52:55], a[200:203], v[154:157]
    ds_read_b64_tr_b16 a[226:227], v32 offset:22528
    buffer_load_dwordx4 v64, s[16:19], s61 offen offset:3072 lds
    v_mfma_f32_16x16x32_bf16 v[166:169], a[48:51], a[204:207], v[166:169]
    ds_read_b64_tr_b16 a[228:229], v34 offset:20480
    v_mfma_f32_16x16x32_bf16 v[170:173], a[52:55], a[204:207], v[170:173]
    ds_read_b64_tr_b16 a[230:231], v34 offset:22528
    s_waitcnt lgkmcnt(8)
    v_mfma_f32_16x16x32_bf16 v[158:161], a[48:51], a[208:211], v[158:161]
    s_waitcnt vmcnt(10)
    s_atomic_add s36, s[28:29], s55
    ds_read_b64_tr_b16 a[200:201], v35 offset:0
    v_mfma_f32_16x16x32_bf16 v[162:165], a[52:55], a[208:211], v[162:165]
    ds_read_b64_tr_b16 a[202:203], v35 offset:2048
    v_mfma_f32_16x16x32_bf16 v[174:177], a[48:51], a[212:215], v[174:177]
    ds_read_b64_tr_b16 a[204:205], v37 offset:0
    v_mfma_f32_16x16x32_bf16 v[178:181], a[52:55], a[212:215], v[178:181]
    ds_read_b64_tr_b16 a[206:207], v37 offset:2048
    s_waitcnt lgkmcnt(8)
    v_mfma_f32_16x16x32_bf16 v[150:153], a[56:59], a[216:219], v[150:153]
    ds_read_b64_tr_b16 a[208:209], v36 offset:0
    v_mfma_f32_16x16x32_bf16 v[154:157], a[60:63], a[216:219], v[154:157]
    ds_read_b64_tr_b16 a[210:211], v36 offset:2048
    v_mfma_f32_16x16x32_bf16 v[166:169], a[56:59], a[220:223], v[166:169]
    ds_read_b64_tr_b16 a[212:213], v38 offset:0
    v_mfma_f32_16x16x32_bf16 v[170:173], a[60:63], a[220:223], v[170:173]
    ds_read_b64_tr_b16 a[214:215], v38 offset:2048
    s_waitcnt lgkmcnt(8)
    v_mfma_f32_16x16x32_bf16 v[158:161], a[56:59], a[224:227], v[158:161]
    ds_read_b64_tr_b16 a[216:217], v35 offset:4096
    v_mfma_f32_16x16x32_bf16 v[162:165], a[60:63], a[224:227], v[162:165]
    ds_read_b64_tr_b16 a[218:219], v35 offset:6144
    v_mfma_f32_16x16x32_bf16 v[174:177], a[56:59], a[228:231], v[174:177]
    ds_read_b64_tr_b16 a[220:221], v37 offset:4096
    v_mfma_f32_16x16x32_bf16 v[178:181], a[60:63], a[228:231], v[178:181]
    ds_read_b64_tr_b16 a[222:223], v37 offset:6144
    s_waitcnt lgkmcnt(8)
    v_mfma_f32_16x16x32_bf16 v[150:153], a[64:67], a[200:203], v[150:153]
    s_waitcnt lgkmcnt(0)
    s_cmp_ge_u32 s14, 8
    s_cbranch_scc0 L_pollin6
L_pollok6:
    ds_read_b64_tr_b16 a[224:225], v36 offset:4096
    s_add_u32 m0, s58, 0
    s_add_u32 s51, s51, 1
    s_and_b32 s51, s51, 3
    s_lshl_b32 s61, s51, 12
    buffer_load_dwordx4 v65, s[28:31], s61 offen sc1 lds
    v_mfma_f32_16x16x32_bf16 v[154:157], a[68:71], a[200:203], v[154:157]
    ds_read_b64_tr_b16 a[226:227], v36 offset:6144
    v_mfma_f32_16x16x32_bf16 v[166:169], a[64:67], a[204:207], v[166:169]
    ds_read_b64_tr_b16 a[228:229], v38 offset:4096
    buffer_load_dwordx4 v66, s[28:31], s61 offen offset:1024 sc1 lds
    v_mfma_f32_16x16x32_bf16 v[170:173], a[68:71], a[204:207], v[170:173]
    ds_read_b64_tr_b16 a[230:231], v38 offset:6144
    v_mfma_f32_16x16x32_bf16 v[158:161], a[64:67], a[208:211], v[158:161]
    s_barrier
    ds_read_b64_tr_b16 a[200:201], v35 offset:16384
    buffer_load_dwordx4 v65, s[28:31], s61 offen offset:2048 sc1 lds
    v_mfma_f32_16x16x32_bf16 v[162:165], a[68:71], a[208:211], v[162:165]
    ds_read_b64_tr_b16 a[202:203], v35 offset:18432
    v_mfma_f32_16x16x32_bf16 v[174:177], a[64:67], a[212:215], v[174:177]
    ds_read_b64_tr_b16 a[204:205], v37 offset:16384
    v_mfma_f32_16x16x32_bf16 v[178:181], a[68:71], a[212:215], v[178:181]
    ds_read_b64_tr_b16 a[206:207], v37 offset:18432
    v_mfma_f32_16x16x32_bf16 v[150:153], a[72:75], a[216:219], v[150:153]
    ds_read_b64_tr_b16 a[208:209], v36 offset:16384
    buffer_load_dwordx4 v66, s[28:31], s61 offen offset:3072 sc1 lds
    v_mfma_f32_16x16x32_bf16 v[154:157], a[76:79], a[216:219], v[154:157]
    ds_read_b64_tr_b16 a[210:211], v36 offset:18432
    s_add_u32 m0, s58, 131072
    v_mfma_f32_16x16x32_bf16 v[166:169], a[72:75], a[220:223], v[166:169]
    ds_read_b64_tr_b16 a[212:213], v38 offset:16384
    s_add_u32 s51, s51, 1
    v_mfma_f32_16x16x32_bf16 v[170:173], a[76:79], a[220:223], v[170:173]
    ds_read_b64_tr_b16 a[214:215], v38 offset:18432
    s_waitcnt lgkmcnt(8)
    v_mfma_f32_16x16x32_bf16 v[158:161], a[72:75], a[224:227], v[158:161]
    ds_read_b64_tr_b16 a[216:217], v35 offset:20480
    s_and_b32 s51, s51, 3
    s_lshl_b32 s61, s51, 12
    buffer_load_dwordx4 v65, s[28:31], s61 offen sc1 lds
    v_mfma_f32_16x16x32_bf16 v[162:165], a[76:79], a[224:227], v[162:165]
    ds_read_b64_tr_b16 a[218:219], v35 offset:22528
    v_mfma_f32_16x16x32_bf16 v[174:177], a[72:75], a[228:231], v[174:177]
    ds_read_b64_tr_b16 a[220:221], v37 offset:20480
    buffer_load_dwordx4 v66, s[28:31], s61 offen offset:1024 sc1 lds
    v_mfma_f32_16x16x32_bf16 v[178:181], a[76:79], a[228:231], v[178:181]
    ds_read_b64_tr_b16 a[222:223], v37 offset:22528
    s_waitcnt lgkmcnt(8)
    v_mfma_f32_16x16x32_bf16 v[150:153], a[80:83], a[200:203], v[150:153]
    ds_read_b64_tr_b16 a[224:225], v36 offset:20480
    v_mfma_f32_16x16x32_bf16 v[154:157], a[84:87], a[200:203], v[154:157]
    ds_read_b64_tr_b16 a[226:227], v36 offset:22528
    buffer_load_dwordx4 v65, s[28:31], s61 offen offset:2048 sc1 lds
    v_mfma_f32_16x16x32_bf16 v[166:169], a[80:83], a[204:207], v[166:169]
    ds_read_b64_tr_b16 a[228:229], v38 offset:20480
    v_mfma_f32_16x16x32_bf16 v[170:173], a[84:87], a[204:207], v[170:173]
    ds_read_b64_tr_b16 a[230:231], v38 offset:22528
    s_waitcnt lgkmcnt(8)
    v_mfma_f32_16x16x32_bf16 v[158:161], a[80:83], a[208:211], v[158:161]
    s_barrier
    ds_read_b64_tr_b16 a[200:201], v31 offset:32768
    buffer_load_dwordx4 v66, s[28:31], s61 offen offset:3072 sc1 lds
    v_mfma_f32_16x16x32_bf16 v[162:165], a[84:87], a[208:211], v[162:165]
    ds_read_b64_tr_b16 a[202:203], v31 offset:34816
    s_add_u32 m0, s58, 147456
    v_mfma_f32_16x16x32_bf16 v[174:177], a[80:83], a[212:215], v[174:177]
    ds_read_b64_tr_b16 a[204:205], v33 offset:32768
    s_add_u32 s51, s51, 1
    v_mfma_f32_16x16x32_bf16 v[178:181], a[84:87], a[212:215], v[178:181]
    ds_read_b64_tr_b16 a[206:207], v33 offset:34816
    s_waitcnt lgkmcnt(8)
    v_mfma_f32_16x16x32_bf16 v[150:153], a[88:91], a[216:219], v[150:153]
    ds_read_b64_tr_b16 a[208:209], v32 offset:32768
    s_and_b32 s51, s51, 3
    s_lshl_b32 s61, s51, 12
    buffer_load_dwordx4 v65, s[28:31], s61 offen sc1 lds
    v_mfma_f32_16x16x32_bf16 v[154:157], a[92:95], a[216:219], v[154:157]
    ds_read_b64_tr_b16 a[210:211], v32 offset:34816
    v_mfma_f32_16x16x32_bf16 v[166:169], a[88:91], a[220:223], v[166:169]
    ds_read_b64_tr_b16 a[212:213], v34 offset:32768
    buffer_load_dwordx4 v66, s[28:31], s61 offen offset:1024 sc1 lds
    v_mfma_f32_16x16x32_bf16 v[170:173], a[92:95], a[220:223], v[170:173]
    ds_read_b64_tr_b16 a[214:215], v34 offset:34816
    s_waitcnt lgkmcnt(8)
    v_mfma_f32_16x16x32_bf16 v[158:161], a[88:91], a[224:227], v[158:161]
    ds_read_b64_tr_b16 a[216:217], v31 offset:36864
    v_mfma_f32_16x16x32_bf16 v[162:165], a[92:95], a[224:227], v[162:165]
    ds_read_b64_tr_b16 a[218:219], v31 offset:38912
    buffer_load_dwordx4 v65, s[28:31], s61 offen offset:2048 sc1 lds
    v_mfma_f32_16x16x32_bf16 v[174:177], a[88:91], a[228:231], v[174:177]
    ds_read_b64_tr_b16 a[220:221], v33 offset:36864
    v_mfma_f32_16x16x32_bf16 v[178:181], a[92:95], a[228:231], v[178:181]
    ds_read_b64_tr_b16 a[222:223], v33 offset:38912
    s_waitcnt lgkmcnt(8)
    v_mfma_f32_16x16x32_bf16 v[150:153], a[96:99], a[200:203], v[150:153]
    ds_read_b64_tr_b16 a[224:225], v32 offset:36864
    buffer_load_dwordx4 v66, s[28:31], s61 offen offset:3072 sc1 lds
    v_mfma_f32_16x16x32_bf16 v[154:157], a[100:103], a[200:203], v[154:157]
    ds_read_b64_tr_b16 a[226:227], v32 offset:38912
    s_add_u32 m0, s58, 16384
    v_mfma_f32_16x16x32_bf16 v[166:169], a[96:99], a[204:207], v[166:169]
    ds_read_b64_tr_b16 a[228:229], v34 offset:36864
    s_add_u32 s66, s66, 1
    v_mfma_f32_16x16x32_bf16 v[170:173], a[100:103], a[204:207], v[170:173]
    ds_read_b64_tr_b16 a[230:231], v34 offset:38912
    s_waitcnt lgkmcnt(8)
    v_mfma_f32_16x16x32_bf16 v[158:161], a[96:99], a[208:211], v[158:161]
    s_waitcnt vmcnt(8)
    s_barrier
    s_xor_b32 s55, s55, 1024
    s_load_dword s14, s[28:29], s55
    ds_read_b64_tr_b16 v[198:199], v43 offset:49152
    ds_read_b64_tr_b16 v[200:201], v43 offset:53248
    s_and_b32 s66, s66, 3
    s_mul_i32 s61, s66, 100352
    buffer_load_dwordx4 v63, s[16:19], s61 offen lds
    v_mfma_f32_16x16x32_bf16 v[162:165], a[100:103], a[208:211], v[162:165]
    ds_read_b64_tr_b16 v[202:203], v44 offset:49152
    v_mfma_f32_16x16x32_bf16 v[174:177], a[96:99], a[212:215], v[174:177]
    ds_read_b64_tr_b16 v[204:205], v44 offset:53248
    buffer_load_dwordx4 v64, s[16:19], s61 offen offset:1024 lds
    v_mfma_f32_16x16x32_bf16 v[178:181], a[100:103], a[212:215], v[178:181]
    ds_read_b128 a[200:203], v47 offset:0
    s_waitcnt lgkmcnt(9)
    v_mfma_f32_16x16x32_bf16 v[150:153], a[104:107], a[216:219], v[150:153]
    ds_read_b128 a[204:207], v48 offset:0
    s_add_u32 s61, s61, 48128
    v_mfma_f32_16x16x32_bf16 v[154:157], a[108:111], a[216:219], v[154:157]
    ds_read_b128 a[208:211], v47 offset:1024
    buffer_load_dwordx4 v63, s[16:19], s61 offen offset:2048 lds
    v_mfma_f32_16x16x32_bf16 v[166:169], a[104:107], a[220:223], v[166:169]
    ds_read_b128 a[212:215], v48 offset:1024
    v_mfma_f32_16x16x32_bf16 v[170:173], a[108:111], a[220:223], v[170:173]
    s_waitcnt lgkmcnt(8)
    v_mfma_f32_16x16x32_bf16 v[158:161], a[104:107], a[224:227], v[158:161]
    ds_read_b64_tr_b16 v[206:207], v43 offset:51200
    ds_read_b64_tr_b16 v[208:209], v43 offset:55296
    v_mfma_f32_16x16x32_bf16 v[162:165], a[108:111], a[224:227], v[162:165]
    ds_read_b64_tr_b16 v[210:211], v44 offset:51200
    buffer_load_dwordx4 v64, s[16:19], s61 offen offset:3072 lds
    v_mfma_f32_16x16x32_bf16 v[174:177], a[104:107], a[228:231], v[174:177]
    ds_read_b64_tr_b16 v[212:213], v44 offset:55296
    s_add_u32 m0, s58, 65536
    v_mfma_f32_16x16x32_bf16 v[178:181], a[108:111], a[228:231], v[178:181]
    ds_read_b128 a[216:219], v47 offset:2048
    s_waitcnt lgkmcnt(7)
    v_mfma_f32_16x16x32_bf16 v[150:153], v[198:201], a[200:203], v[150:153]
    ds_read_b128 a[220:223], v48 offset:2048
    s_add_u32 s51, s51, 1
    s_and_b32 s51, s51, 3
    s_lshl_b32 s61, s51, 12
    buffer_load_dwordx4 v65, s[28:31], s61 offen sc1 lds
    v_mfma_f32_16x16x32_bf16 v[154:157], v[202:205], a[200:203], v[154:157]
    ds_read_b128 a[224:227], v47 offset:3072
    v_mfma_f32_16x16x32_bf16 v[166:169], v[198:201], a[204:207], v[166:169]
    ds_read_b128 a[228:231], v48 offset:3072
    buffer_load_dwordx4 v66, s[28:31], s61 offen offset:1024 sc1 lds
    v_mfma_f32_16x16x32_bf16 v[170:173], v[202:205], a[204:207], v[170:173]
    s_waitcnt lgkmcnt(8)
    v_mfma_f32_16x16x32_bf16 v[158:161], v[198:201], a[208:211], v[158:161]
    s_waitcnt vmcnt(10)
    s_barrier
    ds_read_b64_tr_b16 v[214:215], v45 offset:32768
    ds_read_b64_tr_b16 v[216:217], v45 offset:36864
    v_mfma_f32_16x16x32_bf16 v[162:165], v[202:205], a[208:211], v[162:165]
    ds_read_b64_tr_b16 v[218:219], v46 offset:32768
    buffer_load_dwordx4 v65, s[28:31], s61 offen offset:2048 sc1 lds
    v_mfma_f32_16x16x32_bf16 v[174:177], v[198:201], a[212:215], v[174:177]
    ds_read_b64_tr_b16 v[220:221], v46 offset:36864
    v_mfma_f32_16x16x32_bf16 v[178:181], v[202:205], a[212:215], v[178:181]
    ds_read_b128 a[200:203], v51 offset:0
    s_waitcnt lgkmcnt(7)
    v_mfma_f32_16x16x32_bf16 v[150:153], v[206:209], a[216:219], v[150:153]
    ds_read_b128 a[204:207], v52 offset:0
    buffer_load_dwordx4 v66, s[28:31], s61 offen offset:3072 sc1 lds
    v_mfma_f32_16x16x32_bf16 v[154:157], v[210:213], a[216:219], v[154:157]
    ds_read_b128 a[208:211], v51 offset:1024
    v_mfma_f32_16x16x32_bf16 v[166:169], v[206:209], a[220:223], v[166:169]
    ds_read_b128 a[212:215], v52 offset:1024
    v_mfma_f32_16x16x32_bf16 v[170:173], v[210:213], a[220:223], v[170:173]
    s_waitcnt lgkmcnt(8)
    v_mfma_f32_16x16x32_bf16 v[158:161], v[206:209], a[224:227], v[158:161]
    s_waitcnt lgkmcnt(0)
    s_cmp_ge_u32 s14, 1
    s_cbranch_scc0 L_pollin7
L_pollok7:
    v_xor_b32 v21, 131072, v21
    ds_read_b64_tr_b16 v[198:199], v45 offset:34816
    ds_read_b64_tr_b16 v[200:201], v45 offset:38912
    buffer_load_dwordx4 v[246:249], v21, s[28:31], 0 offen offset:2048 sc1
    v_mfma_f32_16x16x32_bf16 v[162:165], v[210:213], a[224:227], v[162:165]
    ds_read_b64_tr_b16 v[202:203], v46 offset:34816
    buffer_load_dwordx4 v[250:253], v21, s[28:31], 0 offen offset:3072 sc1
    v_mfma_f32_16x16x32_bf16 v[174:177], v[206:209], a[228:231], v[174:177]
    ds_read_b64_tr_b16 v[204:205], v46 offset:38912
    v_mfma_f32_16x16x32_bf16 v[178:181], v[210:213], a[228:231], v[178:181]
    ds_read_b128 a[216:219], v51 offset:2048
    v_mfma_f32_16x16x32_bf16 v[150:153], v[214:217], a[200:203], v[150:153]
    ds_read_b128 a[220:223], v52 offset:2048
    buffer_load_dwordx4 v[238:241], v21, s[28:31], 0 offen offset:0 sc1
    v_mfma_f32_16x16x32_bf16 v[154:157], v[218:221], a[200:203], v[154:157]
    ds_read_b128 a[224:227], v51 offset:3072
    buffer_load_dwordx4 v[242:245], v21, s[28:31], 0 offen offset:1024 sc1
    v_mfma_f32_16x16x32_bf16 v[166:169], v[214:217], a[204:207], v[166:169]
    ds_read_b128 a[228:231], v52 offset:3072
    v_mfma_f32_16x16x32_bf16 v[170:173], v[218:221], a[204:207], v[170:173]
    v_mfma_f32_16x16x32_bf16 v[158:161], v[214:217], a[208:211], v[158:161]
    s_waitcnt vmcnt(12)
    s_barrier
    ds_read_b64_tr_b16 v[206:207], v45 offset:49152
    ds_read_b64_tr_b16 v[208:209], v45 offset:53248
    v_mfma_f32_16x16x32_bf16 v[162:165], v[218:221], a[208:211], v[162:165]
    ds_read_b64_tr_b16 v[210:211], v46 offset:49152
    v_mfma_f32_16x16x32_bf16 v[174:177], v[214:217], a[212:215], v[174:177]
    ds_read_b64_tr_b16 v[212:213], v46 offset:53248
    v_mfma_f32_16x16x32_bf16 v[178:181], v[218:221], a[212:215], v[178:181]
    ds_read_b128 a[200:203], v51 offset:16384
    s_waitcnt lgkmcnt(7)
    v_mfma_f32_16x16x32_bf16 v[150:153], v[198:201], a[216:219], v[150:153]
    ds_read_b128 a[204:207], v52 offset:16384
    v_mfma_f32_16x16x32_bf16 v[154:157], v[202:205], a[216:219], v[154:157]
    ds_read_b128 a[208:211], v51 offset:17408
    v_mfma_f32_16x16x32_bf16 v[166:169], v[198:201], a[220:223], v[166:169]
    ds_read_b128 a[212:215], v52 offset:17408
    v_mfma_f32_16x16x32_bf16 v[170:173], v[202:205], a[220:223], v[170:173]
    s_waitcnt lgkmcnt(8)
    v_mfma_f32_16x16x32_bf16 v[158:161], v[198:201], a[224:227], v[158:161]
    ds_read_b64_tr_b16 v[214:215], v45 offset:51200
    ds_read_b64_tr_b16 v[216:217], v45 offset:55296
    v_mfma_f32_16x16x32_bf16 v[162:165], v[202:205], a[224:227], v[162:165]
    ds_read_b64_tr_b16 v[218:219], v46 offset:51200
    v_mfma_f32_16x16x32_bf16 v[174:177], v[198:201], a[228:231], v[174:177]
    ds_read_b64_tr_b16 v[220:221], v46 offset:55296
    v_mfma_f32_16x16x32_bf16 v[178:181], v[202:205], a[228:231], v[178:181]
    ds_read_b128 a[216:219], v51 offset:18432
    s_waitcnt lgkmcnt(7)
    v_mfma_f32_16x16x32_bf16 v[150:153], v[206:209], a[200:203], v[150:153]
    ds_read_b128 a[220:223], v52 offset:18432
    v_mfma_f32_16x16x32_bf16 v[154:157], v[210:213], a[200:203], v[154:157]
    ds_read_b128 a[224:227], v51 offset:19456
    v_mfma_f32_16x16x32_bf16 v[166:169], v[206:209], a[204:207], v[166:169]
    ds_read_b128 a[228:231], v52 offset:19456
    v_mfma_f32_16x16x32_bf16 v[170:173], v[210:213], a[204:207], v[170:173]
    s_waitcnt lgkmcnt(8)
    v_mfma_f32_16x16x32_bf16 v[158:161], v[206:209], a[208:211], v[158:161]
    s_waitcnt vmcnt(4)
    s_barrier
    ds_read_b64_tr_b16 v[198:199], v43 offset:16384
    ds_read_b64_tr_b16 v[200:201], v43 offset:20480
    v_mfma_f32_16x16x32_bf16 v[162:165], v[210:213], a[208:211], v[162:165]
    ds_read_b64_tr_b16 v[202:203], v44 offset:16384
    v_mfma_f32_16x16x32_bf16 v[174:177], v[206:209], a[212:215], v[174:177]
    ds_read_b64_tr_b16 v[204:205], v44 offset:20480
    v_mfma_f32_16x16x32_bf16 v[178:181], v[210:213], a[212:215], v[178:181]
    ds_read_b128 a[200:203], v50 offset:0
    s_waitcnt lgkmcnt(7)
    v_mfma_f32_16x16x32_bf16 v[150:153], v[214:217], a[216:219], v[150:153]
    ds_read_b128 a[204:207], v50 offset:1024
    ds_read_b64_tr_b16 v[206:207], v43 offset:18432
    v_mfma_f32_16x16x32_bf16 v[154:157], v[218:221], a[216:219], v[154:157]
    ds_read_b64_tr_b16 v[208:209], v43 offset:22528
    ds_read_b64_tr_b16 v[210:211], v44 offset:18432
    v_mfma_f32_16x16x32_bf16 v[166:169], v[214:217], a[220:223], v[166:169]
    ds_read_b64_tr_b16 v[212:213], v44 offset:22528
    v_mfma_f32_16x16x32_bf16 v[170:173], v[218:221], a[220:223], v[170:173]
    ds_read_b128 a[208:211], v50 offset:2048
    s_waitcnt lgkmcnt(11)
    v_mfma_f32_16x16x32_bf16 v[158:161], v[214:217], a[224:227], v[158:161]
    ds_read_b128 a[212:215], v50 offset:3072
    v_mfma_f32_16x16x32_bf16 v[162:165], v[218:221], a[224:227], v[162:165]
    v_mfma_f32_16x16x32_bf16 v[174:177], v[214:217], a[228:231], v[174:177]
    v_mfma_f32_16x16x32_bf16 v[178:181], v[218:221], a[228:231], v[178:181]
    s_waitcnt lgkmcnt(6)
    v_mfma_f32_16x16x32_bf16 v[166:169], v[198:201], a[200:203], v[166:169]
    ds_read_b128 a[224:227], v49 offset:0
    v_mfma_f32_16x16x32_bf16 v[170:173], v[202:205], a[200:203], v[170:173]
    v_mfma_f32_16x16x32_bf16 v[174:177], v[198:201], a[204:207], v[174:177]
    ds_read_b128 a[228:231], v49 offset:1024
    v_mfma_f32_16x16x32_bf16 v[178:181], v[202:205], a[204:207], v[178:181]
    s_waitcnt lgkmcnt(2)
    v_mfma_f32_16x16x32_bf16 v[166:169], v[206:209], a[208:211], v[166:169]
    ds_read_b128 a[200:203], v49 offset:2048
    v_mfma_f32_16x16x32_bf16 v[170:173], v[210:213], a[208:211], v[170:173]
    v_mfma_f32_16x16x32_bf16 v[174:177], v[206:209], a[212:215], v[174:177]
    ds_read_b128 a[204:207], v49 offset:3072
L_pad4:
    s_cbranch_execz L_warm
    v_mfma_f32_16x16x32_bf16 v[178:181], v[210:213], a[212:215], v[178:181]
    s_waitcnt vmcnt(3)
    v_mfma_f32_16x16x32_bf16 v[166:169], a[250:253], v[246:249], v[166:169]
    v_mfma_f32_16x16x32_bf16 v[170:173], a[248:251], v[246:249], v[170:173]
    s_waitcnt vmcnt(2)
    v_mfma_f32_16x16x32_bf16 v[174:177], a[250:253], v[250:253], v[174:177]
    v_mfma_f32_16x16x32_bf16 v[178:181], a[248:251], v[250:253], v[178:181]
    s_waitcnt lgkmcnt(2)
    v_mfma_f32_16x16x32_bf16 v[150:153], v[198:201], a[224:227], v[150:153]
    v_mfma_f32_16x16x32_bf16 v[154:157], v[202:205], a[224:227], v[154:157]
    v_mfma_f32_16x16x32_bf16 v[158:161], v[198:201], a[228:231], v[158:161]
    ds_write_b128 v87, v[166:169] offset:8192
    v_mfma_f32_16x16x32_bf16 v[162:165], v[202:205], a[228:231], v[162:165]
    s_waitcnt lgkmcnt(1)
    v_mfma_f32_16x16x32_bf16 v[150:153], v[206:209], a[200:203], v[150:153]
    ds_write_b128 v88, v[170:173] offset:8192
    v_mfma_f32_16x16x32_bf16 v[154:157], v[210:213], a[200:203], v[154:157]
    v_mfma_f32_16x16x32_bf16 v[158:161], v[206:209], a[204:207], v[158:161]
    ds_write_b128 v87, v[174:177] offset:12288
    v_mfma_f32_16x16x32_bf16 v[162:165], v[210:213], a[204:207], v[162:165]
    s_waitcnt vmcnt(1)
    v_mfma_f32_16x16x32_bf16 v[150:153], a[250:253], v[238:241], v[150:153]
    ds_write_b128 v88, v[178:181] offset:12288
    v_mfma_f32_16x16x32_bf16 v[154:157], a[248:251], v[238:241], v[154:157]
    s_waitcnt vmcnt(0)
    v_mfma_f32_16x16x32_bf16 v[158:161], a[250:253], v[242:245], v[158:161]
    v_mfma_f32_16x16x32_bf16 v[162:165], a[248:251], v[242:245], v[162:165]
    s_nop 2
    ds_write_b128 v87, v[150:153] offset:0
    s_nop 0
    ds_write_b128 v88, v[154:157] offset:0
    s_nop 0
    ds_write_b128 v87, v[158:161] offset:4096
    ds_write_b128 v88, v[162:165] offset:4096
    s_waitcnt lgkmcnt(0)
    s_barrier
    ds_read_b128 v[118:121], v89 offset:0
    ds_read_b128 v[122:125], v90 offset:0
    ds_read_b128 v[126:129], v91 offset:0
    ds_read_b128 v[130:133], v92 offset:0
    ds_read_b128 v[134:137], v89 offset:2048
    ds_read_b128 v[138:141], v90 offset:2048
    ds_read_b128 v[142:145], v91 offset:2048
    ds_read_b128 v[146:149], v92 offset:2048
    s_waitcnt lgkmcnt(7)
    v_pk_add_f32 v[222:223], v[222:223], v[118:119]
    v_pk_add_f32 v[224:225], v[224:225], v[120:121]
    s_waitcnt lgkmcnt(6)
    v_pk_add_f32 v[226:227], v[226:227], v[122:123]
    v_pk_add_f32 v[228:229], v[228:229], v[124:125]
    s_waitcnt lgkmcnt(5)
    v_pk_add_f32 v[222:223], v[222:223], v[126:127]
    v_pk_add_f32 v[224:225], v[224:225], v[128:129]
    s_waitcnt lgkmcnt(4)
    v_pk_add_f32 v[226:227], v[226:227], v[130:131]
    v_pk_add_f32 v[228:229], v[228:229], v[132:133]
    v_cvt_pk_bf16_f32 v110, v222, v223
    v_cvt_pk_bf16_f32 v111, v224, v225
    v_cvt_pk_bf16_f32 v112, v226, v227
    v_cvt_pk_bf16_f32 v113, v228, v229
    buffer_store_dwordx4 v[110:113], v85, s[32:35], 0 offen
    s_waitcnt lgkmcnt(3)
    v_pk_add_f32 v[230:231], v[230:231], v[134:135]
    v_pk_add_f32 v[232:233], v[232:233], v[136:137]
    s_waitcnt lgkmcnt(2)
    v_pk_add_f32 v[234:235], v[234:235], v[138:139]
    v_pk_add_f32 v[236:237], v[236:237], v[140:141]
    s_waitcnt lgkmcnt(1)
    v_pk_add_f32 v[230:231], v[230:231], v[142:143]
    v_pk_add_f32 v[232:233], v[232:233], v[144:145]
    s_waitcnt lgkmcnt(0)
    v_pk_add_f32 v[234:235], v[234:235], v[146:147]
    v_pk_add_f32 v[236:237], v[236:237], v[148:149]
    v_cvt_pk_bf16_f32 v114, v230, v231
    v_cvt_pk_bf16_f32 v115, v232, v233
    v_cvt_pk_bf16_f32 v116, v234, v235
    v_cvt_pk_bf16_f32 v117, v236, v237
    buffer_store_dwordx4 v[114:117], v86, s[32:35], 0 offen
L_fin:
L_end:
    s_endpgm
L_nonce:
    buffer_load_dword v12, v16, s[44:47], 0 offen sc1
    s_add_u32 s60, s60, 1
    s_waitcnt vmcnt(0)
    v_readfirstlane_b32 s57, v12
    s_cmp_ge_u32 s60, 20000
    s_cbranch_scc1 L_nonce_ok
    s_cmp_eq_u32 s57, 0
    s_cbranch_scc1 L_nonce
    s_branch L_nonce_ok
L_pollin0:
    s_mov_b32 s60, 0
L_poll0:
    s_sleep 4
    buffer_load_dword v18, v20, s[28:31], 0 offen sc1
    s_add_u32 s60, s60, 1
    s_waitcnt vmcnt(0)
    v_cmp_ne_u32 vcc, s57, v18
    s_cbranch_vccz L_pollok0
    s_cmp_lt_u32 s60, 20000
    s_cbranch_scc1 L_poll0
    s_branch L_pollok0
L_pollin1:
    s_mov_b32 s60, 0
    s_branch L_poll1a
L_poll1:
    s_sleep 8
L_poll1a:
    buffer_load_dword v18, off, s[44:47], s15 sc1
    s_add_u32 s60, s60, 1
    s_waitcnt vmcnt(0)
    v_readfirstlane_b32 s14, v18
    s_nop 0
    s_cmp_ge_u32 s14, 14
    s_cbranch_scc1 L_pollok1
    s_cmp_lt_u32 s60, 20000
    s_cbranch_scc1 L_poll1
    s_branch L_pollok1
L_pollin2:
    s_mov_b32 s60, 0
    s_branch L_poll2a
L_poll2:
    s_sleep 4
L_poll2a:
    buffer_load_dword v18, off, s[28:31], s37 sc1
    s_add_u32 s60, s60, 1
    s_waitcnt vmcnt(0)
    v_readfirstlane_b32 s14, v18
    s_nop 0
    s_cmp_ge_u32 s14, 2
    s_cbranch_scc1 L_pollok2
    s_cmp_lt_u32 s60, 20000
    s_cbranch_scc1 L_poll2
    s_branch L_pollok2
L_nonceh:
    buffer_load_dword v12, v16, s[44:47], 0 offen sc1
    s_add_u32 s60, s60, 1
    s_waitcnt vmcnt(0)
    v_readfirstlane_b32 s57, v12
    s_cmp_ge_u32 s60, 20000
    s_cbranch_scc1 L_nonce_okh
    s_cmp_eq_u32 s57, 0
    s_cbranch_scc1 L_nonceh
    s_branch L_nonce_okh
L_pollin3:
    s_mov_b32 s60, 0
L_poll3:
    s_sleep 8
    buffer_load_dword v18, v20, s[28:31], 0 offen sc1
    s_add_u32 s60, s60, 1
    s_waitcnt vmcnt(0)
    v_cmp_ne_u32 vcc, s57, v18
    s_cbranch_vccz L_pollok3
    s_cmp_lt_u32 s60, 20000
    s_cbranch_scc1 L_poll3
    s_branch L_pollok3
L_pollin4:
    s_mov_b32 s60, 0
    s_branch L_poll4a
L_poll4:
    s_sleep 16
L_poll4a:
    buffer_load_dword v18, off, s[44:47], s15 sc1
    s_add_u32 s60, s60, 1
    s_waitcnt vmcnt(0)
    v_readfirstlane_b32 s14, v18
    s_nop 0
    s_cmp_ge_u32 s14, 14
    s_cbranch_scc1 L_pollok4
    s_cmp_lt_u32 s60, 20000
    s_cbranch_scc1 L_poll4
    s_branch L_pollok4
L_nog1:
    s_nop 1
    s_mov_b32 s14, 1204224
    s_mov_b32 s15, 0x20000
    s_sub_u32 s3, s2, 200
    s_cmp_lt_u32 s3, 42
    s_cselect_b32 s81, 0, 268435456
    s_cselect_b32 s3, s3, 0
    s_mul_i32 s79, s3, 43
    s_lshr_b32 s79, s79, 7
    s_mul_i32 s80, s79, 3
    s_sub_u32 s80, s3, s80
    v_min_u32 v13, 55, v1
    s_lshl_b32 s3, s79, 2
    s_add_u32 s3, s3, s48
    s_mul_i32 s3, s3, 21504
    s_mul_i32 s60, s80, 896
    s_add_u32 s3, s3, s60
    s_add_u32 s3, s3, s81
    v_lshl_add_u32 v242, v13, 4, s3
    s_mul_i32 s60, s48, 8448
    s_add_u32 m0, s60, 0
    s_mov_b32 s3, 0
    buffer_load_dwordx4 v242, s[12:15], s3 offen lds
    s_add_u32 m0, s60, 1056
    s_mov_b32 s3, 2688
    buffer_load_dwordx4 v242, s[12:15], s3 offen lds
    s_add_u32 m0, s60, 2112
    s_mov_b32 s3, 5376
    buffer_load_dwordx4 v242, s[12:15], s3 offen lds
    s_add_u32 m0, s60, 3168
    s_mov_b32 s3, 8064
    buffer_load_dwordx4 v242, s[12:15], s3 offen lds
    s_add_u32 m0, s60, 4224
    s_mov_b32 s3, 10752
    buffer_load_dwordx4 v242, s[12:15], s3 offen lds
    s_add_u32 m0, s60, 5280
    s_mov_b32 s3, 13440
    buffer_load_dwordx4 v242, s[12:15], s3 offen lds
    s_add_u32 m0, s60, 6336
    s_mov_b32 s3, 16128
    buffer_load_dwordx4 v242, s[12:15], s3 offen lds
    s_add_u32 m0, s60, 7392
    s_mov_b32 s3, 18816
    buffer_load_dwordx4 v242, s[12:15], s3 offen lds
    s_mul_i32 s53, s101, 37
    s_lshr_b32 s53, s53, 8
    s_mul_i32 s54, s53, 7
    s_sub_u32 s54, s101, s54
    s_and_b32 s53, s53, 3
    s_lshl_b32 s3, s6, 2
    s_add_u32 s53, s53, s3
    s_lshl_b32 s53, s53, 1
    s_add_u32 s53, s53, s7
    s_mov_b32 s42, 4096
    s_mov_b32 s43, 0x20000
    s_lshl_b32 s3, s53, 2
    s_add_u32 s3, s3, s48
    s_lshl_b32 s60, s3, 5
    v_lshl_add_u32 v82, v5, 1, s60
    s_mul_i32 s3, s3, 14336
    s_lshl_b32 s60, s54, 7
    s_add_u32 s3, s3, s60
    v_mul_u32_u24 v14, 896, v5
    v_lshl_add_u32 v14, v6, 4, v14
    v_add_u32 v85, s3, v14
    v_add_u32 v86, 7168, v85
    s_cmp_lt_u32 s101, 28
    s_cselect_b32 s56, 1, 0
    s_lshl_b32 s50, s7, 3
    s_and_b32 s3, s101, 7
    s_add_u32 s50, s50, s3
    s_lshr_b32 s60, s101, 3
    s_lshl_b32 s49, s6, 2
    s_add_u32 s49, s49, s60
    s_lshl_b32 s49, s49, 2
    s_add_u32 s49, s49, s48
    s_mul_i32 s60, s60, 0
    s_add_u32 s3, s3, s60
    s_sub_u32 s60, s3, 7
    s_cmp_ge_u32 s3, 7
    s_cselect_b32 s3, s60, s3
    s_lshl_b32 s62, s3, 18
    s_mul_i32 s63, s3, 12288
    s_mov_b32 s30, 20971520
    s_mov_b32 s31, 0x20000
    s_mov_b32 s75, 0x3727c5ac
    s_mov_b32 s76, 0x3b124925
    s_mov_b32 s77, 0x3f803f80
    v_lshlrev_b32 v4, 4, v1
    v_bfe_u32 v7, v1, 2, 2
    v_and_b32 v8, 3, v1
    v_mul_u32_u24 v13, 960, v9
    v_lshl_add_u32 v13, v10, 4, v13
    s_mul_i32 s3, s48, 1920
    s_add_u32 s3, s3, 147456
    v_add_u32 v230, s3, v13
    v_mul_u32_u24 v13, 960, v7
    v_lshl_add_u32 v13, v3, 5, v13
    v_lshl_add_u32 v13, v8, 3, v13
    s_lshl_b32 s3, s48, 8
    s_add_u32 s3, s3, 147456
    v_add_u32 v231, s3, v13
    s_lshl_b32 s3, s48, 3
    s_add_u32 s3, s3, 155648
    v_lshl_add_u32 v232, v9, 2, s3
    v_lshlrev_b32 v237, 2, v6
    v_and_b32 v2, 15, v1
    v_lshlrev_b32 v238, 14, v3
    v_add_lshl_u32 v238, v238, v2, 2
    v_add_u32 v237, 155648, v237
    v_lshlrev_b32 v13, 17, v9
    v_lshl_add_u32 v233, v10, 4, v13
    s_cmp_eq_u32 s48, 3
    s_cselect_b32 s60, 268435456, 0
    s_lshl_b32 s70, s48, 10
    s_add_u32 s70, s70, s2
    s_lshl_b32 s70, s70, 9
    s_add_u32 s71, s70, 262144
    s_add_u32 s71, s71, s60
    s_xor_b32 s60, s60, 268435456
    s_lshl_b32 s72, s2, 7
    s_add_u32 s72, s72, s60
    s_add_u32 s72, s72, 6291456
    s_lshr_b32 s74, s2, 2
    s_lshl_b32 s74, s74, 5
    s_and_b32 s3, s2, 3
    s_add_u32 s74, s74, s3
    s_lshl_b32 s74, s74, 2
    s_add_u32 s74, s74, 10485760
    v_cmp_gt_u32 vcc, 8, v0
    v_lshlrev_b32 v236, 13, v0
    v_mov_b32 v13, 268435456
    s_and_b32 s3, s2, 7
    s_lshl_b32 s3, s3, 13
    s_add_u32 s3, s3, 10485760
    v_lshrrev_b32 v14, 2, v0
    v_lshl_add_u32 v14, v14, 7, s3
    v_lshl_add_u32 v20, v8, 2, v14
    v_cndmask_b32 v236, v13, v236, vcc
    v_mov_b32 v16, 0
    s_lshl_b32 s3, s48, 14
    s_add_u32 s74, s74, s3
    s_add_u32 s73, s74, 8192
    s_waitcnt vmcnt(10)
    v_dot2_f32_bf16 v226, v182, s77, 0
    v_dot2_f32_bf16 v227, v182, v182, 0
    v_dot2_f32_bf16 v226, v183, s77, v226
    v_dot2_f32_bf16 v227, v183, v183, v227
    v_dot2_f32_bf16 v226, v184, s77, v226
    v_dot2_f32_bf16 v227, v184, v184, v227
    v_dot2_f32_bf16 v226, v185, s77, v226
    v_dot2_f32_bf16 v227, v185, v185, v227
    s_waitcnt vmcnt(9)
    v_dot2_f32_bf16 v226, v186, s77, v226
    v_dot2_f32_bf16 v227, v186, v186, v227
    v_dot2_f32_bf16 v226, v187, s77, v226
    v_dot2_f32_bf16 v227, v187, v187, v227
    v_dot2_f32_bf16 v226, v188, s77, v226
    v_dot2_f32_bf16 v227, v188, v188, v227
    v_dot2_f32_bf16 v226, v189, s77, v226
    v_dot2_f32_bf16 v227, v189, v189, v227
    buffer_load_dword v12, v16, s[44:47], 0 offen sc1
    v_lshlrev_b32 v190, 16, v182
    v_and_b32 v191, 0xffff0000, v182
    v_add_f32_dpp v226, v226, v226 quad_perm:[1,0,3,2] row_mask:0xf bank_mask:0xf
    v_add_f32_dpp v227, v227, v227 quad_perm:[1,0,3,2] row_mask:0xf bank_mask:0xf
    v_lshlrev_b32 v192, 16, v183
    v_add_f32_dpp v226, v226, v226 quad_perm:[2,3,0,1] row_mask:0xf bank_mask:0xf
    v_add_f32_dpp v227, v227, v227 quad_perm:[2,3,0,1] row_mask:0xf bank_mask:0xf
    v_and_b32 v193, 0xffff0000, v183
    v_add_f32_dpp v226, v226, v226 row_half_mirror row_mask:0xf bank_mask:0xf
    v_add_f32_dpp v227, v227, v227 row_half_mirror row_mask:0xf bank_mask:0xf
    v_lshlrev_b32 v194, 16, v184
    v_add_f32_dpp v226, v226, v226 row_mirror row_mask:0xf bank_mask:0xf
    v_add_f32_dpp v227, v227, v227 row_mirror row_mask:0xf bank_mask:0xf
    v_and_b32 v195, 0xffff0000, v184
    v_mov_b32 v228, v226
    v_mov_b32 v229, v227
    v_lshlrev_b32 v196, 16, v185
    v_permlane16_swap_b32 v226, v228
    v_permlane16_swap_b32 v227, v229
    v_add_f32 v226, v226, v228
    v_add_f32 v227, v227, v229
    v_mul_f32_e64 v226, -v226, s76
    v_mul_f32 v228, v226, v226
    v_fma_f32 v227, v227, s76, -v228
    v_max_f32 v227, 0, v227
    v_add_f32 v228, s75, v227
    v_rsq_f32 v222, v228
    v_and_b32 v197, 0xffff0000, v185
    v_mul_f32 v228, v222, v222
    v_fma_f32 v229, v228, v227, s75
    v_rsq_f32 v228, v229
    v_mul_f32 v223, v226, v222
    v_mul_f32 v224, v222, v228
    v_mul_f32 v225, v223, v228
    v_mul_f32 v229, v229, v228
    ds_write_b32 v232, v229
    v_lshlrev_b32 v198, 16, v186
    v_and_b32 v199, 0xffff0000, v186
    v_lshlrev_b32 v200, 16, v187
    v_and_b32 v201, 0xffff0000, v187
    v_lshlrev_b32 v202, 16, v188
    v_and_b32 v203, 0xffff0000, v188
    v_lshlrev_b32 v204, 16, v189
    v_and_b32 v205, 0xffff0000, v189
    v_pk_fma_f32 v[206:207], v[190:191], v[224:225], v[224:225] op_sel:[0,0,1] op_sel_hi:[1,0,1]
    v_pk_fma_f32 v[208:209], v[192:193], v[224:225], v[224:225] op_sel:[0,0,1] op_sel_hi:[1,0,1]
    v_pk_fma_f32 v[210:211], v[194:195], v[224:225], v[224:225] op_sel:[0,0,1] op_sel_hi:[1,0,1]
    v_pk_fma_f32 v[212:213], v[196:197], v[224:225], v[224:225] op_sel:[0,0,1] op_sel_hi:[1,0,1]
    v_cvt_pk_bf16_f32 v182, v206, v207
    v_cvt_pk_bf16_f32 v183, v208, v209
    v_cvt_pk_bf16_f32 v184, v210, v211
    v_cvt_pk_bf16_f32 v185, v212, v213
    ds_write_b128 v230, v[182:185] offset:0
    v_pk_fma_f32 v[214:215], v[198:199], v[224:225], v[224:225] op_sel:[0,0,1] op_sel_hi:[1,0,1]
    v_pk_fma_f32 v[216:217], v[200:201], v[224:225], v[224:225] op_sel:[0,0,1] op_sel_hi:[1,0,1]
    v_pk_fma_f32 v[218:219], v[202:203], v[224:225], v[224:225] op_sel:[0,0,1] op_sel_hi:[1,0,1]
    v_pk_fma_f32 v[220:221], v[204:205], v[224:225], v[224:225] op_sel:[0,0,1] op_sel_hi:[1,0,1]
    v_cvt_pk_bf16_f32 v186, v214, v215
    v_cvt_pk_bf16_f32 v187, v216, v217
    v_cvt_pk_bf16_f32 v188, v218, v219
    v_cvt_pk_bf16_f32 v189, v220, v221
    ds_write_b128 v230, v[186:189] offset:448
    s_waitcnt lgkmcnt(0)
    s_barrier
    ds_read_b64_tr_b16 v[110:111], v231 offset:0
    ds_read_b64_tr_b16 v[112:113], v231 offset:3840
    ds_read_b64_tr_b16 v[114:115], v231 offset:128
    ds_read_b64_tr_b16 v[116:117], v231 offset:3968
    ds_read_b32 v229, v237
    s_waitcnt lgkmcnt(3)
    buffer_store_dwordx4 v[110:113], v233, s[28:31], s70 offen sc1
    s_waitcnt lgkmcnt(1)
    buffer_store_dwordx4 v[114:117], v233, s[28:31], s71 offen sc1
    v_cmp_gt_u32 vcc, 16, v1
    s_waitcnt lgkmcnt(0)
    s_nop 0
    v_cndmask_b32 v229, 0, v229, vcc
    buffer_store_dword v229, v238, s[28:31], s72 offen sc1
    v_lshrrev_b32 v13, 2, v1
    v_mul_u32_u24 v13, 1056, v13
    v_lshl_add_u32 v13, v8, 3, v13
    s_mul_i32 s3, s48, 224
    v_add_u32 v243, s3, v13
    s_mov_b32 s18, 401408
    s_mov_b32 s19, 0x20000
    s_mov_b32 s26, 7340032
    s_mov_b32 s27, 0x20000
    s_mov_b32 s34, 1835008
    s_mov_b32 s35, 0x20000
    s_mov_b32 s36, 1
    v_lshrrev_b32 v14, 2, v1
    v_lshlrev_b32 v14, 7, v14
    v_lshl_add_u32 v14, v8, 3, v14
    v_and_b32 v15, 3, v5
    v_lshl_add_u32 v14, v15, 5, v14
    s_mul_i32 s3, s4, 8256
    v_xor_b32 v31, s3, v14
    v_xor_b32 v32, 32, v31
    v_xor_b32 v33, 64, v31
    v_xor_b32 v34, 96, v31
    v_add_u32 v35, 65536, v31
    v_add_u32 v36, 65536, v32
    v_add_u32 v37, 65536, v33
    v_add_u32 v38, 65536, v34
    v_add_u32 v39, 131072, v31
    v_add_u32 v40, 131072, v32
    v_add_u32 v41, 131072, v33
    v_add_u32 v42, 131072, v34
    s_lshl_b32 s6, s52, 1
    s_add_u32 s6, s6, s5
    s_lshl_b32 s3, s6, 1
    s_add_u32 s3, s3, s59
    s_lshl_b32 s3, s3, 4
    s_add_u32 s3, s3, s4
    s_lshl_b32 s3, s3, 12
    v_lshl_add_u32 v78, v3, 8, v4
    v_add_u32 v78, s3, v78
    s_xor_b32 s37, s51, 1
    s_lshl_b32 s37, s37, 3
    s_add_u32 s37, s37, s52
    s_lshl_b32 s3, s37, 14
    s_add_u32 s3, s3, s58
    s_add_u32 s3, s3, 16777216
    v_add_u32 v23, s3, v4
    s_lshl_b32 s37, s37, 5
    s_add_u32 s37, s37, s5
    s_lshl_b32 s37, s37, 2
    s_add_u32 s37, s37, 6422528
    s_mul_i32 s67, s6, 56
    s_lshl_b32 s3, s51, 1
    s_add_u32 s3, s3, s4
    s_add_u32 s67, s67, s3
    s_lshl_b32 s67, s67, 11
    s_add_u32 s67, s67, 2097152
    v_add_u32 v81, s58, v4
    s_lshl_b32 s68, s52, 2
    s_and_b32 s3, s51, 1
    s_add_u32 s68, s68, s3
    s_cmp_ge_u32 s51, 14
    s_cselect_b32 s3, 2, 0
    s_add_u32 s68, s68, s3
    s_lshl_b32 s68, s68, 7
    s_add_u32 s68, s68, 6356992
    s_waitcnt vmcnt(3)
    v_readfirstlane_b32 s57, v12
    s_mov_b32 s60, 0
    s_cmp_lg_u32 s57, 0
    s_cbranch_scc0 L_nonceh
L_nonce_okh:
    s_waitcnt vmcnt(0)
    s_barrier
    s_atomic_swap s57, s[28:29], s74
    s_atomic_swap s57, s[28:29], s73
    buffer_load_dwordx4 v[96:99], v85, s[8:11], 0 offen
    buffer_load_ushort v93, v82, s[40:43], 0 offen offset:0
    buffer_load_dwordx4 v[100:103], v86, s[8:11], 0 offen
    buffer_load_ushort v94, v82, s[40:43], 0 offen offset:16
    v_cmp_gt_u32 vcc, 12, v2
    s_mul_i32 s3, s48, 56
    s_add_u32 s3, s3, s79
    s_mul_i32 s3, s3, 3
    s_add_u32 s3, s3, s80
    s_lshl_b32 s3, s3, 11
    s_add_u32 s3, s3, 8388608
    s_add_u32 s3, s3, s81
    ds_read_b64_tr_b16 v[182:183], v243 offset:0
    ds_read_b64_tr_b16 v[184:185], v243 offset:16896
    ds_read_b64_tr_b16 v[186:187], v243 offset:32
    ds_read_b64_tr_b16 v[188:189], v243 offset:16928
    ds_read_b64_tr_b16 v[190:191], v243 offset:56
    ds_read_b64_tr_b16 v[192:193], v243 offset:16952
    ds_read_b64_tr_b16 v[194:195], v243 offset:88
    ds_read_b64_tr_b16 v[196:197], v243 offset:16984
    ds_read_b64_tr_b16 v[198:199], v243 offset:112
    ds_read_b64_tr_b16 v[200:201], v243 offset:17008
    ds_read_b64_tr_b16 v[202:203], v243 offset:144
    ds_read_b64_tr_b16 v[204:205], v243 offset:17040
    ds_read_b64_tr_b16 v[206:207], v243 offset:168
    ds_read_b64_tr_b16 v[208:209], v243 offset:17064
    ds_read_b64_tr_b16 v[210:211], v243 offset:200
    ds_read_b64_tr_b16 v[212:213], v243 offset:17096
    s_waitcnt lgkmcnt(13)
    v_cndmask_b32 v186, 0, v186, vcc
    v_cndmask_b32 v187, 0, v187, vcc
    s_waitcnt lgkmcnt(12)
    v_cndmask_b32 v188, 0, v188, vcc
    v_cndmask_b32 v189, 0, v189, vcc
    buffer_store_dwordx4 v[182:185], v4, s[28:31], s3 offen offset:0 sc1
    buffer_store_dwordx4 v[186:189], v4, s[28:31], s3 offen offset:1024 sc1
    s_add_u32 s3, s3, 86016
    s_waitcnt lgkmcnt(9)
    v_cndmask_b32 v194, 0, v194, vcc
    v_cndmask_b32 v195, 0, v195, vcc
    s_waitcnt lgkmcnt(8)
    v_cndmask_b32 v196, 0, v196, vcc
    v_cndmask_b32 v197, 0, v197, vcc
    buffer_store_dwordx4 v[190:193], v4, s[28:31], s3 offen offset:0 sc1
    buffer_store_dwordx4 v[194:197], v4, s[28:31], s3 offen offset:1024 sc1
    s_add_u32 s3, s3, 86016
    s_waitcnt lgkmcnt(5)
    v_cndmask_b32 v202, 0, v202, vcc
    v_cndmask_b32 v203, 0, v203, vcc
    s_waitcnt lgkmcnt(4)
    v_cndmask_b32 v204, 0, v204, vcc
    v_cndmask_b32 v205, 0, v205, vcc
    buffer_store_dwordx4 v[198:201], v4, s[28:31], s3 offen offset:0 sc1
    buffer_store_dwordx4 v[202:205], v4, s[28:31], s3 offen offset:1024 sc1
    s_add_u32 s3, s3, 86016
    ds_read_b32 v24, v4
    s_waitcnt lgkmcnt(2)
    v_cndmask_b32 v210, 0, v210, vcc
    v_cndmask_b32 v211, 0, v211, vcc
    ds_read_b32 v24, v4
    s_waitcnt lgkmcnt(2)
    v_cndmask_b32 v212, 0, v212, vcc
    v_cndmask_b32 v213, 0, v213, vcc
    buffer_store_dwordx4 v[206:209], v4, s[28:31], s3 offen offset:0 sc1
    buffer_store_dwordx4 v[210:213], v4, s[28:31], s3 offen offset:1024 sc1
    s_add_u32 s3, s3, 86016
    s_lshl_b32 s67, s80, 6
    s_add_u32 s67, s67, 64
    s_cmp_eq_u32 s81, 0
    s_cselect_b32 s37, s48, 1
    s_mov_b32 s68, 6369792
    s_and_b32 s3, s2, 1
    s_mul_i32 s3, s3, 3
    s_bfe_u32 s6, s2, 0x10001
    s_mul_i32 s7, s6, 6
    s_add_u32 s3, s3, s7
    s_add_u32 s3, s3, 1
    v_add_u32 v14, s3, v8
    s_mul_i32 s6, s6, 64
    s_add_u32 s6, s6, 7
    v_cmp_ne_u32 vcc, s6, v14
    v_lshrrev_b32 v15, 2, v1
    v_mul_u32_u24 v15, 3584, v15
    v_cndmask_b32 v14, 0, v14, vcc
    v_lshl_add_u32 v14, v14, 8, v15
    s_lshl_b32 s3, s52, 2
    s_add_u32 s3, s3, s48
    s_mul_i32 s3, s3, 37
    s_min_u32 s3, s3, 987
    s_mul_i32 s3, s3, 3584
    s_mul_i32 s6, s59, 3670144
    s_add_u32 s3, s3, s6
    buffer_load_dword v226, v14, s[20:23], s3 offen
    s_add_u32 s3, s3, 57344
    buffer_load_dword v227, v14, s[20:23], s3 offen
    s_add_u32 s3, s3, 57344
    v_cmp_gt_u32 vcc, 20, v1
    v_mov_b32 v15, 268435456
    s_nop 0
    v_cndmask_b32 v14, v15, v14, vcc
    buffer_load_dword v228, v14, s[20:23], s3 offen
    s_add_u32 s3, s3, 57344
    v_add_u32 v53, 65536, v4
    v_add_u32 v54, 131072, v4
    s_mul_i32 s59, s48, 3072
    s_mul_i32 s3, s50, 86016
    s_add_u32 s3, s3, s59
    s_add_u32 s3, s3, 8388608
    v_add_u32 v80, s3, v4
    v_lshlrev_b32 v14, 7, v9
    v_xor_b32 v14, v14, v4
    s_lshl_b32 s3, s49, 11
    v_add_u32 v67, s3, v14
    v_add_u32 v68, 129024, v67
    s_lshr_b32 s3, s49, 2
    s_lshl_b32 s3, s3, 3
    s_max_u32 s3, s3, 1
    s_sub_u32 s3, s3, 1
    s_lshl_b32 s3, s3, 10
    s_lshl_b32 s6, s5, 17
    s_add_u32 s3, s3, s6
    s_lshl_b32 s6, s4, 28
    s_add_u32 s3, s3, s6
    v_add_u32 v69, s3, v14
    s_lshl_b32 s100, s5, 1
    s_add_u32 s100, s100, s4
    s_lshl_b32 s100, s100, 10
    v_and_b32 v14, 1, v1
    v_mul_u32_u24 v14, 640, v14
    v_lshrrev_b32 v15, 2, v1
    v_lshlrev_b32 v15, 4, v15
    v_xor_b32 v14, v14, v15
    v_bfe_u32 v15, v1, 1, 1
    v_lshl_add_u32 v14, v15, 3, v14
    s_add_u32 s3, s58, 12288
    v_add_u32 v70, s3, v14
    s_sub_u32 s3, s3, 3072
    s_cmp_eq_u32 s48, 0
    s_cselect_b32 s3, 28672, s3
    v_add_u32 v71, s3, v14
    v_add_u32 v72, 65536, v70
    v_add_u32 v73, 65536, v71
    v_add_u32 v74, 131072, v70
    v_add_u32 v75, 131072, v71
    s_lshl_b32 s3, s49, 1
    v_min_u32 v14, 2, v3
    v_add_u32 v14, s3, v14
    v_max_u32 v14, 1, v14
    v_lshlrev_b32 v14, 1, v14
    v_and_b32 v15, 1, v7
    v_add_lshl_u32 v14, v14, v15, 7
    v_lshrrev_b32 v15, 1, v7
    v_lshl_add_u32 v15, v15, 2, v8
    v_lshl_add_u32 v14, v15, 2, v14
    v_add_u32 v77, 6291200, v14
    s_min_u32 s15, s48, 2
    s_lshl_b32 s15, s15, 6
    s_add_u32 s15, s15, 64
    s_lshl_b32 s82, s49, 5
    s_add_u32 s82, s82, s50
    s_lshl_b32 s82, s82, 10
    s_add_u32 s82, s82, 4194304
    s_lshr_b32 s69, s49, 2
    s_lshl_b32 s69, s69, 1
    s_and_b32 s3, s50, 1
    s_add_u32 s69, s69, s3
    s_lshl_b32 s69, s69, 7
    s_add_u32 s69, s69, 6361088
    s_and_b32 s7, s53, 1
    s_mul_i32 s3, s7, 28
    s_add_u32 s3, s3, s48
    s_lshl_b32 s3, s3, 17
    s_xor_b32 s6, s53, 1
    s_lshl_b32 s55, s6, 3
    s_lshl_b32 s6, s53, 7
    s_add_u32 s3, s3, s6
    v_lshlrev_b32 v14, 12, v5
    v_add3_u32 v59, v14, v83, s3
    v_add_u32 v60, 31744, v59
    v_add_u32 v61, 63488, v59
    v_add_u32 v62, 95232, v59
    v_mul_u32_u24 v14, 896, v5
    s_mul_i32 s3, s4, 25088
    s_mul_i32 s6, s5, 14336
    s_add_u32 s3, s3, s6
    s_lshl_b32 s6, s54, 7
    s_add_u32 s3, s3, s6
    v_add3_u32 v63, v14, v83, s3
    v_add_u32 v64, 6144, v63
    s_lshl_b32 s6, s53, 1
    s_add_u32 s6, s6, s5
    s_and_b32 s3, s53, 30
    s_add_u32 s3, s3, s4
    s_lshl_b32 s3, s3, 7
    s_add_u32 s39, s3, 6361088
    s_lshl_b32 s3, s6, 5
    s_add_u32 s3, s3, s4
    s_lshl_b32 s3, s3, 10
    s_add_u32 s3, s3, 4194304
    v_add_u32 v65, s3, v4
    v_add_u32 v66, 15360, v65
    s_xor_b32 s3, s4, s5
    s_lshl_b32 s3, s3, 6
    v_xor_b32 v43, s3, v31
    v_xor_b32 v44, 32, v43
    v_add_u32 v45, 65536, v43
    v_add_u32 v46, 65536, v44
    s_mul_i32 s3, s4, 12288
    v_add_u32 v47, s3, v4
    v_xor_b32 v48, 4096, v47
    v_add_u32 v49, 65536, v47
    v_add_u32 v50, 65536, v48
    v_add_u32 v51, 131072, v47
    v_add_u32 v52, 131072, v48
    s_lshl_b32 s6, s54, 1
    s_add_u32 s6, s6, s5
    s_lshl_b32 s3, s6, 1
    s_add_u32 s3, s3, s7
    s_mul_i32 s3, s3, 14
    s_add_u32 s3, s3, s4
    s_lshl_b32 s3, s3, 12
    s_add_u32 s3, s3, 2097152
    v_add_u32 v79, s3, v4
    s_lshl_b32 s3, s54, 1
    s_add_u32 s3, s3, s7
    s_lshl_b32 s3, s3, 1
    s_add_u32 s3, s3, s4
    s_lshl_b32 s3, s3, 7
    s_add_u32 s38, s3, 6356992
    s_and_b32 s3, s2, 6
    s_add_u32 s3, s3, s54
    s_sub_u32 s6, s3, 7
    s_cmp_ge_u32 s3, 7
    s_cselect_b32 s3, s6, s3
    s_lshl_b32 s64, s3, 19
    s_lshl_b32 s65, s3, 13
    s_add_u32 s55, s55, s54
    s_lshl_b32 s3, s55, 14
    s_add_u32 s3, s3, s58
    s_add_u32 s3, s3, 12582912
    v_add_u32 v21, s3, v4
    s_lshl_b32 s55, s55, 5
    s_add_u32 s55, s55, s48
    s_lshl_b32 s55, s55, 2
    s_add_u32 s55, s55, 6488064
    s_lshl_b32 s3, s5, 3
    v_add_u32 v13, s3, v3
    v_xor_b32 v13, v13, v6
    v_lshlrev_b32 v13, 4, v13
    v_lshl_add_u32 v13, v2, 8, v13
    s_lshl_b32 s3, s4, 14
    s_add_u32 s3, s3, 32768
    v_add_u32 v87, s3, v13
    v_xor_b32 v88, 64, v87
    s_lshr_b32 s3, s53, 1
    s_add_u32 s66, s3, s54
    s_mov_b32 s51, s66
    v_lshlrev_b32 v13, 1, v6
    v_xor_b32 v13, v13, v5
    v_lshlrev_b32 v13, 4, v13
    v_lshl_add_u32 v13, v5, 8, v13
    s_add_u32 s3, s58, 32768
    v_add_u32 v89, s3, v13
    v_xor_b32 v90, 16, v89
    v_xor_b32 v91, 24576, v89
    v_xor_b32 v92, 24592, v89
    s_mov_b32 s70, 0xaaaaaaaa
    s_mov_b32 s71, 0xaaaaaaaa
    s_mov_b32 s72, 0xfff0ffff
    s_mov_b32 s73, 0xf000ff00
    s_mov_b32 s74, 0xffc0fffc
    s_mov_b32 s75, 0xc000fc00
    s_cmp_eq_u32 s49, 0
    s_cselect_b64 s[76:77], 0, -1
    v_mov_b32 v13, 0xffff
    v_mov_b32 v14, 0xffff0000
    v_cndmask_b32 v13, v13, v14, s[70:71]
    v_cndmask_b32 v104, v13, 0, s[72:73]
    v_cndmask_b32 v106, 0, v13, s[72:73]
    v_cndmask_b32 v105, v13, 0, s[74:75]
    v_cndmask_b32 v107, 0, v13, s[74:75]
    v_mov_b32 v84, 0xf149f2ca
    s_mov_b32 s83, 0x3e8b97f6
    s_mov_b32 s78, 0xbdd2d3e8
    s_mov_b32 s79, 0xbdd2d3e8
    s_mov_b32 s80, 1.0
    s_mov_b32 s81, 1.0
    v_mov_b32 v108, 0xc0135761
    v_mov_b32 v109, 0xc0135761
    v_lshrrev_b32 v13, 1, v2
    v_lshlrev_b32 v14, 1, v3
    v_sub_u32 v13, v13, v14
    v_mov_b32 v14, 0x3f80
    v_cndmask_b32 v14, v14, 1.0, s[70:71]
    v_cmp_eq_i32 vcc, 0, v13
    v_accvgpr_write_b32 a248, 0
    v_accvgpr_write_b32 a252, 0
    v_cndmask_b32 v15, 0, v14, vcc
    v_accvgpr_write_b32 a250, v15
    v_cmp_eq_i32 vcc, 1, v13
    v_accvgpr_write_b32 a249, 0
    v_accvgpr_write_b32 a253, 0
    v_cndmask_b32 v15, 0, v14, vcc
    v_accvgpr_write_b32 a251, v15
    s_waitcnt vmcnt(3)
    s_barrier
    s_cmp_lg_u32 s37, 0
    s_cbranch_scc1 L_nowsig
    s_atomic_add s36, s[44:45], s67
L_nowsig:
    buffer_load_dword v18, v20, s[28:31], 0 offen sc1
    s_mov_b32 s26, 7340032
    s_and_b32 s3, s2, 1
    s_mul_i32 s3, s3, 7
    s_add_u32 s3, s3, s52
    s_lshl_b32 s3, s3, 2
    s_add_u32 s3, s3, s48
    s_lshl_b32 s3, s3, 17
    s_and_b32 s6, s2, 6
    s_lshl_b32 s6, s6, 9
    s_add_u32 s3, s3, s6
    v_lshlrev_b32 v242, 12, v10
    v_lshl_add_u32 v242, v9, 9, v242
    buffer_load_dword v232, v242, s[24:27], s3 offen offset:384
    buffer_load_dword v233, v242, s[24:27], s3 offen offset:256
    s_cmp_eq_u32 s56, 0
    s_cselect_b32 s26, 0, s26
    s_cmp_eq_u32 s56, 0
    s_cselect_b32 s26, 0, s26
    v_and_b32 v13, 0xfffff000, v78
    v_lshl_add_u32 v13, v10, 7, v13
    s_add_u32 s3, s1, 8192
    v_lshl_add_u32 v14, v9, 13, s3
    s_waitcnt vmcnt(2)
    v_cmp_ne_u32 vcc, s57, v18
    s_cbranch_vccnz L_pollin3
L_pollok3:
    s_load_dword s14, s[44:45], s15
    s_barrier
    buffer_load_dword v76, v77, s[28:31], 0 offen sc1
    s_waitcnt lgkmcnt(0)
    s_cmp_ge_u32 s14, 14
    s_cbranch_scc0 L_pollin4
L_pollok4:
    s_barrier
    s_cmp_eq_u32 s56, 0
    s_cselect_b32 s3, 268435456, 0
    v_add_u32 v79, s3, v79
    s_add_u32 m0, s59, 98304
    s_nop 0
    buffer_load_dwordx4 v80, s[28:31], s63 offen sc1 lds
    buffer_load_dwordx4 v80, s[28:31], s63 offen offset:1024 sc1 lds
    buffer_load_dwordx4 v80, s[28:31], s63 offen offset:2048 sc1 lds
    s_add_u32 m0, s100, 126976
    s_nop 0
    buffer_load_dwordx4 v69, s[28:31], s62 offen sc1 lds
    s_add_u32 m0, s58, 110592
    s_nop 0
    buffer_load_dwordx4 v67, s[28:31], s62 offen sc1 lds
    buffer_load_dwordx4 v67, s[28:31], s62 offen offset:1024 sc1 lds
    buffer_load_dwordx4 v68, s[28:31], s62 offen offset:2048 sc1 lds
    buffer_load_dwordx4 v68, s[28:31], s62 offen offset:3072 sc1 lds
    s_add_u32 m0, s59, 131072
    s_add_u32 s63, s63, 12288
    s_cmp_eq_u32 s63, 86016
    s_cselect_b32 s63, 0, s63
    buffer_load_dwordx4 v80, s[28:31], s63 offen sc1 lds
    buffer_load_dwordx4 v80, s[28:31], s63 offen offset:1024 sc1 lds
    buffer_load_dwordx4 v80, s[28:31], s63 offen offset:2048 sc1 lds
    s_add_u32 m0, s100, 159744
    s_add_u32 s62, s62, 262144
    s_cmp_eq_u32 s62, 1835008
    s_cselect_b32 s62, 0, s62
    buffer_load_dwordx4 v69, s[28:31], s62 offen sc1 lds
    s_add_u32 m0, s58, 143360
    s_nop 0
    buffer_load_dwordx4 v67, s[28:31], s62 offen sc1 lds
    buffer_load_dwordx4 v67, s[28:31], s62 offen offset:1024 sc1 lds
    buffer_load_dwordx4 v68, s[28:31], s62 offen offset:2048 sc1 lds
    buffer_load_dwordx4 v68, s[28:31], s62 offen offset:3072 sc1 lds
    s_add_u32 m0, s59, 0
    s_add_u32 s63, s63, 12288
    s_cmp_eq_u32 s63, 86016
    s_cselect_b32 s63, 0, s63
    buffer_load_dwordx4 v80, s[28:31], s63 offen sc1 lds
    buffer_load_dwordx4 v80, s[28:31], s63 offen offset:1024 sc1 lds
    buffer_load_dwordx4 v80, s[28:31], s63 offen offset:2048 sc1 lds
    s_add_u32 m0, s100, 28672
    s_add_u32 s62, s62, 262144
    s_cmp_eq_u32 s62, 1835008
    s_cselect_b32 s62, 0, s62
    buffer_load_dwordx4 v69, s[28:31], s62 offen sc1 lds
    s_add_u32 m0, s58, 12288
    s_nop 0
    buffer_load_dwordx4 v67, s[28:31], s62 offen sc1 lds
    buffer_load_dwordx4 v67, s[28:31], s62 offen offset:1024 sc1 lds
    buffer_load_dwordx4 v68, s[28:31], s62 offen offset:2048 sc1 lds
    buffer_load_dwordx4 v68, s[28:31], s62 offen offset:3072 sc1 lds
    s_add_u32 m0, s59, 65536
    s_add_u32 s63, s63, 12288
    s_cmp_eq_u32 s63, 86016
    s_cselect_b32 s63, 0, s63
    buffer_load_dwordx4 v80, s[28:31], s63 offen sc1 lds
    buffer_load_dwordx4 v80, s[28:31], s63 offen offset:1024 sc1 lds
    buffer_load_dwordx4 v80, s[28:31], s63 offen offset:2048 sc1 lds
    s_add_u32 m0, s100, 94208
    s_add_u32 s62, s62, 262144
    s_cmp_eq_u32 s62, 1835008
    s_cselect_b32 s62, 0, s62
    buffer_load_dwordx4 v69, s[28:31], s62 offen sc1 lds
    s_add_u32 m0, s58, 77824
    s_nop 0
    buffer_load_dwordx4 v67, s[28:31], s62 offen sc1 lds
    buffer_load_dwordx4 v67, s[28:31], s62 offen offset:1024 sc1 lds
    buffer_load_dwordx4 v68, s[28:31], s62 offen offset:2048 sc1 lds
    buffer_load_dwordx4 v68, s[28:31], s62 offen offset:3072 sc1 lds
    s_mov_b32 s3, 268435456
    buffer_store_dword v12, v11, s[28:31], s3 offen
    buffer_store_dword v12, v11, s[28:31], s3 offen
    v_lshlrev_b32 v13, 2, v2
    v_and_b32 v14, 1, v1
    v_lshl_add_u32 v14, v3, 2, v14
    v_lshlrev_b32 v14, 2, v14
    v_add_u32 v15, 64, v14
    v_cndmask_b32 v16, v14, v15, s[72:73]
    v_cndmask_b32 v14, v14, v15, s[74:75]
    s_waitcnt vmcnt(34)
    ds_bpermute_b32 v25, v13, v76 offset:64
    ds_bpermute_b32 v27, v16, v76 offset:0
    ds_bpermute_b32 v28, v14, v76 offset:8
    ds_bpermute_b32 v26, v13, v76 offset:128
    ds_bpermute_b32 v29, v16, v76 offset:64
    ds_bpermute_b32 v30, v14, v76 offset:72
    s_waitcnt lgkmcnt(5)
    v_mul_f32 v25, s83, v25
    s_waitcnt lgkmcnt(2)
    v_mul_f32 v26, s83, v26
    s_waitcnt vmcnt(18) lgkmcnt(0)
    s_barrier
    ds_read_b64_tr_b16 a[180:181], v72 offset:32768
    ds_read_b64_tr_b16 a[182:183], v72 offset:33024
    ds_read_b128 a[128:131], v53 offset:32768
    ds_read_b64_tr_b16 a[184:185], v72 offset:33792
    ds_read_b64_tr_b16 a[186:187], v72 offset:34048
    ds_read_b128 a[132:135], v53 offset:33792
    ds_read_b128 a[136:139], v53 offset:34816
    ds_read_b64_tr_b16 a[176:177], v73 offset:32768
    ds_read_b64_tr_b16 a[178:179], v73 offset:33024
    ds_read_b128 a[140:143], v53 offset:35840
    ds_read_b128 a[144:147], v53 offset:36864
    ds_read_b128 a[148:151], v53 offset:37888
    s_waitcnt lgkmcnt(0)
    s_nop 3
    s_branch L_q
L_pollin5:
    s_cmp_eq_u32 s56, 0
    s_cbranch_scc1 L_pollok5
    s_mov_b32 s60, 0
    s_branch L_poll5a
L_poll5:
    s_sleep 8
L_poll5a:
    buffer_load_dword v18, off, s[28:31], s38 sc1
    s_add_u32 s60, s60, 1
    s_waitcnt vmcnt(0)
    v_readfirstlane_b32 s14, v18
    s_nop 0
    s_cmp_ge_u32 s14, 7
    s_cbranch_scc1 L_pollok5
    s_cmp_lt_u32 s60, 20000
    s_cbranch_scc1 L_poll5
    s_branch L_pollok5
L_nof:
    v_min_u32 v14, 48, v1
    s_lshl_b32 s3, s54, 2
    s_add_u32 s3, s3, s48
    s_mul_i32 s3, s3, 25088
    v_lshl_add_u32 v14, v14, 7, s3
    s_add_u32 s3, s2, 0
    s_and_b32 s3, s3, 3
    s_mul_i32 s3, s3, 6272
    buffer_load_dword v182, v14, s[16:19], s3 offen
    s_waitcnt vmcnt(1)
    s_barrier
    s_cmp_lg_u32 s48, 0
    s_cbranch_scc1 L_sig3
    s_atomic_add s36, s[28:29], s69
L_sig3:
    s_add_u32 s3, s2, 1
    s_and_b32 s3, s3, 3
    s_mul_i32 s3, s3, 6272
    buffer_load_dword v183, v14, s[16:19], s3 offen
    s_add_u32 s3, s2, 2
    s_and_b32 s3, s3, 3
    s_mul_i32 s3, s3, 6272
    buffer_load_dword v184, v14, s[16:19], s3 offen
    s_add_u32 s3, s2, 3
    s_and_b32 s3, s3, 3
    s_mul_i32 s3, s3, 6272
    buffer_load_dword v185, v14, s[16:19], s3 offen
    s_branch L_fin
L_pollin6:
    s_mov_b32 s60, 0
    s_branch L_poll6a
L_poll6:
    s_sleep 8
L_poll6a:
    buffer_load_dword v18, off, s[28:31], s39 sc1
    s_add_u32 s60, s60, 1
    s_waitcnt vmcnt(0)
    v_readfirstlane_b32 s14, v18
    s_nop 0
    s_cmp_ge_u32 s14, 8
    s_cbranch_scc1 L_pollok6
    s_cmp_lt_u32 s60, 20000
    s_cbranch_scc1 L_poll6
    s_branch L_pollok6
L_pollin7:
    s_mov_b32 s60, 0
    s_branch L_poll7a
L_poll7:
    s_sleep 4
L_poll7a:
    buffer_load_dword v18, off, s[28:31], s55 sc1
    s_add_u32 s60, s60, 1
    s_waitcnt vmcnt(0)
    v_readfirstlane_b32 s14, v18
    s_nop 0
    s_cmp_ge_u32 s14, 1
    s_cbranch_scc1 L_pollok7
    s_cmp_lt_u32 s60, 20000
    s_cbranch_scc1 L_poll7
    s_branch L_pollok7
L_last:
    s_endpgm
.section .rodata,"a"
.p2align 6
.amdhsa_kernel parallel_sum__sliding_local_dilated__mixer_token_mlp__prompt_kernel
  .amdhsa_next_free_vgpr 512
  .amdhsa_next_free_sgpr 102
  .amdhsa_accum_offset 256
  .amdhsa_group_segment_fixed_size 0
  .amdhsa_kernarg_size 88
  .amdhsa_user_sgpr_count 2
  .amdhsa_user_sgpr_kernarg_segment_ptr 1
  .amdhsa_system_sgpr_workgroup_id_x 1
.end_amdhsa_kernel
```

```asm
; @launch grid=(256,1,1) block=(256,1,1) lds=163840
.amdgcn_target "amdgcn-amd-amdhsa--gfx950"
.text
.globl parallel_sum__sliding_local_dilated__mixer_token_mlp__prompt_kernel
.p2align 8
.type parallel_sum__sliding_local_dilated__mixer_token_mlp__prompt_kernel,@function
parallel_sum__sliding_local_dilated__mixer_token_mlp__prompt_kernel:
    s_cmp_ge_u32 s2, 256
    s_cbranch_scc1 L_end
    s_load_dwordx2 s[8:9], s[0:1], 0
    s_load_dwordx2 s[20:21], s[0:1], 32
    s_load_dwordx2 s[28:29], s[0:1], 80
    s_load_dwordx2 s[44:45], s[0:1], 72
    s_load_dwordx2 s[12:13], s[0:1], 8
    s_load_dwordx2 s[16:17], s[0:1], 16
    s_load_dwordx2 s[24:25], s[0:1], 48
    s_load_dwordx2 s[32:33], s[0:1], 64
    s_load_dwordx2 s[36:37], s[0:1], 40
    s_load_dwordx2 s[40:41], s[0:1], 56
    s_memrealtime s[78:79]
    s_getpc_b64 s[6:7]
L_pc:
    s_and_b32 s3, s2, 0xf8
    v_lshrrev_b32 v13, 5, v0
    v_add_lshl_u32 v13, s3, v13, 7
    v_min_u32 v13, L_last-L_pc, v13
    global_load_dword v18, v13, s[6:7]
    v_lshrrev_b32 v13, 6, v0
    v_and_b32 v10, 31, v0
    v_readfirstlane_b32 s48, v13
    v_bfe_u32 v9, v0, 5, 1
    v_mul_u32_u24 v14, 896, v9
    v_lshl_add_u32 v14, v10, 4, v14
    v_cmp_gt_u32 vcc, 28, v10
    v_mov_b32 v15, 268435456
    s_mov_b32 s10, 1835008
    s_mov_b32 s11, 0x20000
    v_cndmask_b32 v14, v15, v14, vcc
    s_lshr_b32 s4, s48, 1
    s_and_b32 s5, s48, 1
    s_and_b32 s3, s2, 0xfe
    s_add_u32 s3, s3, s4
    s_lshl_b32 s3, s3, 1
    s_and_b32 s60, s2, 1
    s_add_u32 s3, s3, s60
    s_lshl_b32 s3, s3, 1
    s_add_u32 s3, s3, s5
    s_mul_i32 s3, s3, 1792
    s_waitcnt lgkmcnt(0)
    buffer_load_dwordx4 v[182:185], v14, s[8:11], s3 offen
    buffer_load_dwordx4 v[186:189], v14, s[8:11], s3 offen offset:448
    v_and_b32 v1, 63, v0
    s_mov_b32 s46, 256
    s_mov_b32 s47, 0x20000
    s_lshl_b32 s3, s48, 8
    s_add_u32 s3, s3, s2
    s_cmp_lt_u32 s3, 8
    s_cselect_b32 s3, 0, 268435456
    s_or_b32 s78, s78, 1
    v_mov_b32 v234, s78
    v_mov_b32 v235, 0
    v_lshlrev_b32 v11, 25, v1
    buffer_atomic_cmpswap v[234:235], v11, s[44:47], s3 offen sc1
    s_bfe_u32 s6, s2, 0x20001
    s_and_b32 s7, s2, 1
    s_and_b32 s61, s2, 7
    s_lshr_b32 s101, s2, 3
    s_mul_i32 s52, s7, 25
    s_add_u32 s52, s52, s101
    s_mul_i32 s51, s52, 37
    s_lshr_b32 s51, s51, 8
    s_mul_i32 s3, s51, 7
    s_sub_u32 s52, s52, s3
    s_and_b32 s3, s6, 1
    s_mul_i32 s3, s3, 6
    s_add_u32 s51, s51, s3
    s_add_u32 s51, s51, 1
    s_add_u32 s3, s3, s51
    s_cmp_eq_u32 s3, 7
    s_cselect_b32 s51, 0, s51
    s_lshr_b32 s59, s6, 1
    s_lshl_b32 s51, s51, 1
    s_add_u32 s51, s51, s59
    s_max_u32 s60, s101, 25
    s_sub_u32 s60, s60, 25
    s_add_u32 s3, s101, s7
    s_cmp_lt_u32 s3, 25
    s_cselect_b32 s55, 1, 0
    s_cselect_b32 s52, s52, s60
    s_mov_b32 s22, 7340032
    s_mov_b32 s23, 0x20000
    s_lshl_b32 s3, s52, 1
    s_sub_u32 s60, s3, 7
    s_cmp_ge_u32 s3, 7
    s_cselect_b32 s3, s60, s3
    s_and_b32 s3, s3, 7
    s_mul_i32 s60, s61, 2
    s_add_u32 s3, s3, s60
    s_and_b32 s3, s3, 7
    s_mul_i32 s0, s3, 458752
    s_lshl_b32 s1, s3, 13
    s_lshl_b32 s58, s48, 12
    v_lshrrev_b32 v3, 4, v1
    v_lshrrev_b32 v5, 3, v1
    v_and_b32 v6, 7, v1
    v_lshlrev_b32 v14, 1, v3
    v_xor_b32 v14, v14, v6
    v_lshlrev_b32 v83, 4, v14
    s_cmp_eq_u32 s55, 0
    s_cbranch_scc1 L_nog1
    v_mul_u32_u24 v14, 3584, v5
    s_lshl_b32 s3, s59, 5
    s_add_u32 s3, s3, s48
    s_mul_i32 s3, s3, 114688
    s_lshl_b32 s60, s51, 7
    s_add_u32 s3, s3, s60
    v_add3_u32 v55, v14, v83, s3
    v_add_u32 v56, 56320, v55
    v_add_u32 v57, 26624, v55
    v_add_u32 v58, 82944, v55
    s_mov_b32 s38, 3584
    s_mov_b32 s39, 0x20000
    v_lshlrev_b32 v13, 3, v3
    s_lshl_b32 s3, s51, 1
    s_add_u32 s3, s3, s4
    s_lshl_b32 s3, s3, 6
    buffer_load_dwordx2 v[246:247], v13, s[36:39], s3 offen offset:0
    buffer_load_dwordx2 v[248:249], v13, s[36:39], s3 offen offset:32
    s_add_u32 m0, s58, 0
    v_xor_b32 v55, 128, v55
    buffer_load_dwordx4 v55, s[20:23], s0 offen lds
    v_xor_b32 v56, 128, v56
    buffer_load_dwordx4 v56, s[20:23], s0 offen offset:1024 lds
    v_xor_b32 v57, 128, v57
    buffer_load_dwordx4 v57, s[20:23], s0 offen offset:2048 lds
    v_xor_b32 v58, 128, v58
    buffer_load_dwordx4 v58, s[20:23], s0 offen offset:3072 lds
    s_mul_i32 s53, s101, 37
    s_lshr_b32 s53, s53, 8
    s_mul_i32 s54, s53, 7
    s_sub_u32 s54, s101, s54
    s_and_b32 s53, s53, 3
    s_xor_b32 s53, s53, 0
    s_lshl_b32 s3, s6, 2
    s_add_u32 s53, s53, s3
    s_lshl_b32 s53, s53, 1
    s_add_u32 s53, s53, s7
    s_mov_b32 s42, 4096
    s_mov_b32 s43, 0x20000
    s_lshl_b32 s3, s53, 2
    s_add_u32 s3, s3, s48
    s_lshl_b32 s60, s3, 5
    v_lshl_add_u32 v82, v5, 1, s60
    s_mul_i32 s3, s3, 14336
    s_lshl_b32 s60, s54, 7
    s_add_u32 s3, s3, s60
    v_mul_u32_u24 v14, 896, v5
    v_lshl_add_u32 v14, v6, 4, v14
    v_add_u32 v85, s3, v14
    v_add_u32 v86, 7168, v85
    s_cmp_lt_u32 s101, 28
    s_cselect_b32 s56, 1, 0
    s_lshl_b32 s50, s7, 3
    s_and_b32 s3, s101, 7
    s_add_u32 s50, s50, s3
    s_lshr_b32 s60, s101, 3
    s_lshl_b32 s49, s6, 2
    s_add_u32 s49, s49, s60
    s_lshl_b32 s49, s49, 2
    s_add_u32 s49, s49, s48
    s_mul_i32 s60, s60, 0
    s_add_u32 s3, s3, s60
    s_sub_u32 s60, s3, 7
    s_cmp_ge_u32 s3, 7
    s_cselect_b32 s3, s60, s3
    s_lshl_b32 s62, s3, 18
    s_mul_i32 s63, s3, 12288
    s_mov_b32 s30, 20971520
    s_mov_b32 s31, 0x20000
    s_mov_b32 s75, 0x3727c5ac
    s_mov_b32 s76, 0x3b124925
    s_mov_b32 s77, 0x3f803f80
    v_lshlrev_b32 v4, 4, v1
    v_bfe_u32 v7, v1, 2, 2
    v_and_b32 v8, 3, v1
    v_mul_u32_u24 v13, 960, v9
    v_lshl_add_u32 v13, v10, 4, v13
    s_mul_i32 s3, s48, 1920
    s_add_u32 s3, s3, 147456
    v_add_u32 v230, s3, v13
    v_mul_u32_u24 v13, 960, v7
    v_lshl_add_u32 v13, v3, 5, v13
    v_lshl_add_u32 v13, v8, 3, v13
    s_lshl_b32 s3, s48, 8
    s_add_u32 s3, s3, 147456
    v_add_u32 v231, s3, v13
    s_lshl_b32 s3, s48, 3
    s_add_u32 s3, s3, 155648
    v_lshl_add_u32 v232, v9, 2, s3
    v_lshlrev_b32 v237, 2, v6
    v_and_b32 v2, 15, v1
    v_lshlrev_b32 v238, 14, v3
    v_add_lshl_u32 v238, v238, v2, 2
    v_add_u32 v237, 155648, v237
    v_lshlrev_b32 v13, 17, v9
    v_lshl_add_u32 v233, v10, 4, v13
    s_cmp_eq_u32 s48, 3
    s_cselect_b32 s60, 268435456, 0
    s_lshl_b32 s70, s48, 10
    s_add_u32 s70, s70, s2
    s_lshl_b32 s70, s70, 9
    s_add_u32 s71, s70, 262144
    s_add_u32 s71, s71, s60
    s_xor_b32 s60, s60, 268435456
    s_lshl_b32 s72, s2, 7
    s_add_u32 s72, s72, s60
    s_add_u32 s72, s72, 6291456
    s_lshr_b32 s74, s2, 2
    s_lshl_b32 s74, s74, 5
    s_and_b32 s3, s2, 3
    s_add_u32 s74, s74, s3
    s_lshl_b32 s74, s74, 2
    s_add_u32 s74, s74, 10485760
    v_cmp_gt_u32 vcc, 8, v0
    v_lshlrev_b32 v236, 13, v0
    v_mov_b32 v13, 268435456
    s_and_b32 s3, s2, 7
    s_lshl_b32 s3, s3, 13
    s_add_u32 s3, s3, 10485760
    v_lshrrev_b32 v14, 2, v0
    v_lshl_add_u32 v14, v14, 7, s3
    v_lshl_add_u32 v20, v8, 2, v14
    v_cndmask_b32 v236, v13, v236, vcc
    v_mov_b32 v16, 0
    s_lshl_b32 s3, s48, 14
    s_add_u32 s74, s74, s3
    s_add_u32 s73, s74, 8192
    s_waitcnt vmcnt(8)
    v_dot2_f32_bf16 v226, v182, s77, 0
    v_dot2_f32_bf16 v227, v182, v182, 0
    v_dot2_f32_bf16 v226, v183, s77, v226
    v_dot2_f32_bf16 v227, v183, v183, v227
    v_dot2_f32_bf16 v226, v184, s77, v226
    v_dot2_f32_bf16 v227, v184, v184, v227
    v_dot2_f32_bf16 v226, v185, s77, v226
    v_dot2_f32_bf16 v227, v185, v185, v227
    s_waitcnt vmcnt(7)
    v_dot2_f32_bf16 v226, v186, s77, v226
    v_dot2_f32_bf16 v227, v186, v186, v227
    v_dot2_f32_bf16 v226, v187, s77, v226
    v_dot2_f32_bf16 v227, v187, v187, v227
    v_dot2_f32_bf16 v226, v188, s77, v226
    v_dot2_f32_bf16 v227, v188, v188, v227
    v_dot2_f32_bf16 v226, v189, s77, v226
    v_dot2_f32_bf16 v227, v189, v189, v227
    buffer_load_dword v12, v16, s[44:47], 0 offen sc1
    v_lshlrev_b32 v190, 16, v182
    v_and_b32 v191, 0xffff0000, v182
    v_add_f32_dpp v226, v226, v226 quad_perm:[1,0,3,2] row_mask:0xf bank_mask:0xf
    v_add_f32_dpp v227, v227, v227 quad_perm:[1,0,3,2] row_mask:0xf bank_mask:0xf
    v_lshlrev_b32 v192, 16, v183
    v_add_f32_dpp v226, v226, v226 quad_perm:[2,3,0,1] row_mask:0xf bank_mask:0xf
    v_add_f32_dpp v227, v227, v227 quad_perm:[2,3,0,1] row_mask:0xf bank_mask:0xf
    v_and_b32 v193, 0xffff0000, v183
    v_add_f32_dpp v226, v226, v226 row_half_mirror row_mask:0xf bank_mask:0xf
    v_add_f32_dpp v227, v227, v227 row_half_mirror row_mask:0xf bank_mask:0xf
    v_lshlrev_b32 v194, 16, v184
    v_add_f32_dpp v226, v226, v226 row_mirror row_mask:0xf bank_mask:0xf
    v_add_f32_dpp v227, v227, v227 row_mirror row_mask:0xf bank_mask:0xf
    v_and_b32 v195, 0xffff0000, v184
    v_mov_b32 v228, v226
    v_mov_b32 v229, v227
    v_lshlrev_b32 v196, 16, v185
    v_permlane16_swap_b32 v226, v228
    v_permlane16_swap_b32 v227, v229
    v_add_f32 v226, v226, v228
    v_add_f32 v227, v227, v229
    v_mul_f32_e64 v226, -v226, s76
    v_mul_f32 v228, v226, v226
    v_fma_f32 v227, v227, s76, -v228
    v_max_f32 v227, 0, v227
    v_add_f32 v228, s75, v227
    v_rsq_f32 v222, v228
    v_and_b32 v197, 0xffff0000, v185
    v_mul_f32 v228, v222, v222
    v_fma_f32 v229, v228, v227, s75
    v_rsq_f32 v228, v229
    v_mul_f32 v223, v226, v222
    v_mul_f32 v224, v222, v228
    v_mul_f32 v225, v223, v228
    v_mul_f32 v229, v229, v228
    ds_write_b32 v232, v229
    v_lshlrev_b32 v198, 16, v186
    v_and_b32 v199, 0xffff0000, v186
    v_lshlrev_b32 v200, 16, v187
    v_and_b32 v201, 0xffff0000, v187
    v_lshlrev_b32 v202, 16, v188
    v_and_b32 v203, 0xffff0000, v188
    v_lshlrev_b32 v204, 16, v189
    v_and_b32 v205, 0xffff0000, v189
    v_pk_fma_f32 v[206:207], v[190:191], v[224:225], v[224:225] op_sel:[0,0,1] op_sel_hi:[1,0,1]
    v_pk_fma_f32 v[208:209], v[192:193], v[224:225], v[224:225] op_sel:[0,0,1] op_sel_hi:[1,0,1]
    v_pk_fma_f32 v[210:211], v[194:195], v[224:225], v[224:225] op_sel:[0,0,1] op_sel_hi:[1,0,1]
    v_pk_fma_f32 v[212:213], v[196:197], v[224:225], v[224:225] op_sel:[0,0,1] op_sel_hi:[1,0,1]
    v_cvt_pk_bf16_f32 v182, v206, v207
    v_cvt_pk_bf16_f32 v183, v208, v209
    v_cvt_pk_bf16_f32 v184, v210, v211
    v_cvt_pk_bf16_f32 v185, v212, v213
    ds_write_b128 v230, v[182:185] offset:0
    v_pk_fma_f32 v[214:215], v[198:199], v[224:225], v[224:225] op_sel:[0,0,1] op_sel_hi:[1,0,1]
    v_pk_fma_f32 v[216:217], v[200:201], v[224:225], v[224:225] op_sel:[0,0,1] op_sel_hi:[1,0,1]
    v_pk_fma_f32 v[218:219], v[202:203], v[224:225], v[224:225] op_sel:[0,0,1] op_sel_hi:[1,0,1]
    v_pk_fma_f32 v[220:221], v[204:205], v[224:225], v[224:225] op_sel:[0,0,1] op_sel_hi:[1,0,1]
    v_cvt_pk_bf16_f32 v186, v214, v215
    v_cvt_pk_bf16_f32 v187, v216, v217
    v_cvt_pk_bf16_f32 v188, v218, v219
    v_cvt_pk_bf16_f32 v189, v220, v221
    ds_write_b128 v230, v[186:189] offset:448
    s_waitcnt lgkmcnt(0)
    s_barrier
    ds_read_b64_tr_b16 v[110:111], v231 offset:0
    ds_read_b64_tr_b16 v[112:113], v231 offset:3840
    ds_read_b64_tr_b16 v[114:115], v231 offset:128
    ds_read_b64_tr_b16 v[116:117], v231 offset:3968
    ds_read_b32 v229, v237
    s_waitcnt lgkmcnt(3)
    buffer_store_dwordx4 v[110:113], v233, s[28:31], s70 offen sc1
    s_waitcnt lgkmcnt(1)
    buffer_store_dwordx4 v[114:117], v233, s[28:31], s71 offen sc1
    v_cmp_gt_u32 vcc, 16, v1
    s_waitcnt lgkmcnt(0)
    s_nop 0
    v_cndmask_b32 v229, 0, v229, vcc
    buffer_store_dword v229, v238, s[28:31], s72 offen sc1
    s_add_u32 m0, s58, 16384
    s_add_u32 s0, s0, 458752
    s_cmp_eq_u32 s0, 3670016
    s_cselect_b32 s0, 0, s0
    buffer_load_dwordx4 v55, s[20:23], s0 offen lds
    buffer_load_dwordx4 v56, s[20:23], s0 offen offset:1024 lds
    buffer_load_dwordx4 v57, s[20:23], s0 offen offset:2048 lds
    buffer_load_dwordx4 v58, s[20:23], s0 offen offset:3072 lds
    s_branch L_anchor
.p2align 12
L_anchor:
    s_mov_b32 s18, 401408
    s_mov_b32 s19, 0x20000
    s_mov_b32 s26, 7340032
    s_mov_b32 s27, 0x20000
    s_mov_b32 s34, 1835008
    s_mov_b32 s35, 0x20000
    s_mov_b32 s36, 1
    v_lshrrev_b32 v14, 2, v1
    v_lshlrev_b32 v14, 7, v14
    v_lshl_add_u32 v14, v8, 3, v14
    v_and_b32 v15, 3, v5
    v_lshl_add_u32 v14, v15, 5, v14
    s_mul_i32 s3, s4, 8256
    v_xor_b32 v31, s3, v14
    v_xor_b32 v32, 32, v31
    v_xor_b32 v33, 64, v31
    v_xor_b32 v34, 96, v31
    v_add_u32 v35, 65536, v31
    v_add_u32 v36, 65536, v32
    v_add_u32 v37, 65536, v33
    v_add_u32 v38, 65536, v34
    v_add_u32 v39, 131072, v31
    v_add_u32 v40, 131072, v32
    v_add_u32 v41, 131072, v33
    v_add_u32 v42, 131072, v34
    s_lshl_b32 s6, s52, 1
    s_add_u32 s6, s6, s5
    s_lshl_b32 s3, s6, 1
    s_add_u32 s3, s3, s59
    s_lshl_b32 s3, s3, 4
    s_add_u32 s3, s3, s4
    s_lshl_b32 s3, s3, 12
    v_lshl_add_u32 v78, v3, 8, v4
    v_add_u32 v78, s3, v78
    s_xor_b32 s37, s51, 1
    s_lshl_b32 s37, s37, 3
    s_add_u32 s37, s37, s52
    s_lshl_b32 s3, s37, 14
    s_add_u32 s3, s3, s58
    s_add_u32 s3, s3, 16777216
    v_add_u32 v23, s3, v4
    s_lshl_b32 s37, s37, 5
    s_add_u32 s37, s37, s5
    s_lshl_b32 s37, s37, 2
    s_add_u32 s37, s37, 6422528
    s_mul_i32 s67, s6, 56
    s_lshl_b32 s3, s51, 1
    s_add_u32 s3, s3, s4
    s_add_u32 s67, s67, s3
    s_lshl_b32 s67, s67, 11
    s_add_u32 s67, s67, 2097152
    v_add_u32 v81, s58, v4
    s_lshl_b32 s68, s52, 2
    s_and_b32 s3, s51, 1
    s_add_u32 s68, s68, s3
    s_cmp_ge_u32 s51, 14
    s_cselect_b32 s3, 2, 0
    s_add_u32 s68, s68, s3
    s_lshl_b32 s68, s68, 7
    s_add_u32 s68, s68, 6356992
    s_waitcnt vmcnt(7)
    v_readfirstlane_b32 s57, v12
    s_mov_b32 s60, 0
    s_cmp_lg_u32 s57, 0
    s_cbranch_scc0 L_nonce
L_nonce_ok:
    s_waitcnt vmcnt(4)
    s_barrier
    s_atomic_swap s57, s[28:29], s74
    s_atomic_swap s57, s[28:29], s73
    buffer_load_dwordx4 v[96:99], v85, s[8:11], 0 offen
    buffer_load_ushort v93, v82, s[40:43], 0 offen offset:0
    buffer_load_dwordx4 v[100:103], v86, s[8:11], 0 offen
    buffer_load_ushort v94, v82, s[40:43], 0 offen offset:16
    v_add_u32 v53, 65536, v4
    s_add_u32 m0, s58, 32768
    s_add_u32 s0, s0, 458752
    s_cmp_eq_u32 s0, 3670016
    s_cselect_b32 s0, 0, s0
    buffer_load_dwordx4 v55, s[20:23], s0 offen lds
    v_add_u32 v54, 131072, v4
    s_mul_i32 s59, s48, 3072
    s_mul_i32 s3, s50, 86016
    s_add_u32 s3, s3, s59
    s_add_u32 s3, s3, 8388608
    v_add_u32 v80, s3, v4
    v_lshlrev_b32 v14, 7, v9
    v_xor_b32 v14, v14, v4
    s_lshl_b32 s3, s49, 11
    v_add_u32 v67, s3, v14
    v_add_u32 v68, 129024, v67
    s_lshr_b32 s3, s49, 2
    s_lshl_b32 s3, s3, 3
    s_max_u32 s3, s3, 1
    s_sub_u32 s3, s3, 1
    s_lshl_b32 s3, s3, 10
    s_lshl_b32 s6, s5, 17
    s_add_u32 s3, s3, s6
    s_lshl_b32 s6, s4, 28
    s_add_u32 s3, s3, s6
    v_add_u32 v69, s3, v14
    buffer_load_dwordx4 v56, s[20:23], s0 offen offset:1024 lds
    s_lshl_b32 s100, s5, 1
    s_add_u32 s100, s100, s4
    s_lshl_b32 s100, s100, 10
    v_and_b32 v14, 1, v1
    v_mul_u32_u24 v14, 640, v14
    v_lshrrev_b32 v15, 2, v1
    v_lshlrev_b32 v15, 4, v15
    v_xor_b32 v14, v14, v15
    v_bfe_u32 v15, v1, 1, 1
    v_lshl_add_u32 v14, v15, 3, v14
    buffer_load_dwordx4 v57, s[20:23], s0 offen offset:2048 lds
    s_add_u32 s3, s58, 12288
    v_add_u32 v70, s3, v14
    s_sub_u32 s3, s3, 3072
    s_cmp_eq_u32 s48, 0
    s_cselect_b32 s3, 28672, s3
    v_add_u32 v71, s3, v14
    v_add_u32 v72, 65536, v70
    v_add_u32 v73, 65536, v71
    v_add_u32 v74, 131072, v70
    v_add_u32 v75, 131072, v71
    s_lshl_b32 s3, s49, 1
    v_min_u32 v14, 2, v3
    v_add_u32 v14, s3, v14
    v_max_u32 v14, 1, v14
    v_lshlrev_b32 v14, 1, v14
    v_and_b32 v15, 1, v7
    buffer_load_dwordx4 v58, s[20:23], s0 offen offset:3072 lds
    v_add_lshl_u32 v14, v14, v15, 7
    v_lshrrev_b32 v15, 1, v7
    v_lshl_add_u32 v15, v15, 2, v8
    v_lshl_add_u32 v14, v15, 2, v14
    v_add_u32 v77, 6291200, v14
    s_min_u32 s15, s48, 2
    s_lshl_b32 s15, s15, 6
    s_add_u32 s15, s15, 64
    s_lshl_b32 s82, s49, 5
    s_add_u32 s82, s82, s50
    s_lshl_b32 s82, s82, 10
    s_add_u32 s82, s82, 4194304
    s_lshr_b32 s69, s49, 2
    s_lshl_b32 s69, s69, 1
    s_and_b32 s3, s50, 1
    s_add_u32 s69, s69, s3
    s_lshl_b32 s69, s69, 7
    s_add_u32 s69, s69, 6361088
    s_and_b32 s7, s53, 1
    s_mul_i32 s3, s7, 28
    s_add_u32 s3, s3, s48
    s_lshl_b32 s3, s3, 17
    s_xor_b32 s6, s53, 1
    s_lshl_b32 s55, s6, 3
    s_lshl_b32 s6, s53, 7
    s_add_u32 s3, s3, s6
    v_lshlrev_b32 v14, 12, v5
    s_add_u32 m0, s58, 49152
    s_add_u32 s0, s0, 458752
    s_cmp_eq_u32 s0, 3670016
    s_cselect_b32 s0, 0, s0
    buffer_load_dwordx4 v55, s[20:23], s0 offen lds
    v_add3_u32 v59, v14, v83, s3
    v_add_u32 v60, 31744, v59
    v_add_u32 v61, 63488, v59
    v_add_u32 v62, 95232, v59
    v_mul_u32_u24 v14, 896, v5
    s_mul_i32 s3, s4, 25088
    s_mul_i32 s6, s5, 14336
    s_add_u32 s3, s3, s6
    s_lshl_b32 s6, s54, 7
    s_add_u32 s3, s3, s6
    v_add3_u32 v63, v14, v83, s3
    buffer_load_dwordx4 v56, s[20:23], s0 offen offset:1024 lds
    v_add_u32 v64, 6144, v63
    s_lshl_b32 s6, s53, 1
    s_add_u32 s6, s6, s5
    s_and_b32 s3, s53, 30
    s_add_u32 s3, s3, s4
    s_lshl_b32 s3, s3, 7
    s_add_u32 s39, s3, 6361088
    s_lshl_b32 s3, s6, 5
    s_add_u32 s3, s3, s4
    s_lshl_b32 s3, s3, 10
    s_add_u32 s3, s3, 4194304
    v_add_u32 v65, s3, v4
    v_add_u32 v66, 15360, v65
    s_xor_b32 s3, s4, s5
    s_lshl_b32 s3, s3, 6
    v_xor_b32 v43, s3, v31
    buffer_load_dwordx4 v57, s[20:23], s0 offen offset:2048 lds
    v_xor_b32 v44, 32, v43
    v_add_u32 v45, 65536, v43
    v_add_u32 v46, 65536, v44
    s_mul_i32 s3, s4, 12288
    v_add_u32 v47, s3, v4
    v_xor_b32 v48, 4096, v47
    v_add_u32 v49, 65536, v47
    v_add_u32 v50, 65536, v48
    v_add_u32 v51, 131072, v47
    v_add_u32 v52, 131072, v48
    s_lshl_b32 s6, s54, 1
    s_add_u32 s6, s6, s5
    s_lshl_b32 s3, s6, 1
    s_add_u32 s3, s3, s7
    s_mul_i32 s3, s3, 14
    s_add_u32 s3, s3, s4
    s_lshl_b32 s3, s3, 12
    s_add_u32 s3, s3, 2097152
    v_add_u32 v79, s3, v4
    buffer_load_dwordx4 v58, s[20:23], s0 offen offset:3072 lds
    s_lshl_b32 s3, s54, 1
    s_add_u32 s3, s3, s7
    s_lshl_b32 s3, s3, 1
    s_add_u32 s3, s3, s4
    s_lshl_b32 s3, s3, 7
    s_add_u32 s38, s3, 6356992
    s_and_b32 s3, s2, 6
    s_add_u32 s3, s3, s54
    s_sub_u32 s6, s3, 7
    s_cmp_ge_u32 s3, 7
    s_cselect_b32 s3, s6, s3
    s_lshl_b32 s64, s3, 19
    s_lshl_b32 s65, s3, 13
    s_add_u32 s55, s55, s54
    s_lshl_b32 s3, s55, 14
    s_add_u32 s3, s3, s58
    s_add_u32 s3, s3, 12582912
    v_add_u32 v21, s3, v4
    s_add_u32 m0, s58, 65536
    s_add_u32 s0, s0, 458752
    s_cmp_eq_u32 s0, 3670016
    s_cselect_b32 s0, 0, s0
    buffer_load_dwordx4 v55, s[20:23], s0 offen lds
    s_lshl_b32 s55, s55, 5
    s_add_u32 s55, s55, s48
    s_lshl_b32 s55, s55, 2
    s_add_u32 s55, s55, 6488064
    s_lshl_b32 s3, s5, 3
    v_add_u32 v13, s3, v3
    v_xor_b32 v13, v13, v6
    v_lshlrev_b32 v13, 4, v13
    v_lshl_add_u32 v13, v2, 8, v13
    buffer_load_dwordx4 v56, s[20:23], s0 offen offset:1024 lds
    s_lshl_b32 s3, s4, 14
    s_add_u32 s3, s3, 32768
    v_add_u32 v87, s3, v13
    v_xor_b32 v88, 64, v87
    s_lshr_b32 s3, s53, 1
    s_add_u32 s66, s3, s54
    s_mov_b32 s51, s66
    v_lshlrev_b32 v13, 1, v6
    v_xor_b32 v13, v13, v5
    v_lshlrev_b32 v13, 4, v13
    v_lshl_add_u32 v13, v5, 8, v13
    s_add_u32 s3, s58, 32768
    v_add_u32 v89, s3, v13
    v_xor_b32 v90, 16, v89
    v_xor_b32 v91, 24576, v89
    v_xor_b32 v92, 24592, v89
    buffer_load_dwordx4 v57, s[20:23], s0 offen offset:2048 lds
    v_lshlrev_b32 v150, 16, v246
    v_and_b32 v151, 0xffff0000, v246
    v_lshlrev_b32 v152, 16, v247
    v_and_b32 v153, 0xffff0000, v247
    v_lshlrev_b32 v154, 16, v248
    v_and_b32 v155, 0xffff0000, v248
    v_lshlrev_b32 v156, 16, v249
    v_and_b32 v157, 0xffff0000, v249
    v_lshlrev_b32 v158, 16, v246
    v_and_b32 v159, 0xffff0000, v246
    v_lshlrev_b32 v160, 16, v247
    v_and_b32 v161, 0xffff0000, v247
    v_lshlrev_b32 v162, 16, v248
    v_and_b32 v163, 0xffff0000, v248
    v_lshlrev_b32 v164, 16, v249
    v_and_b32 v165, 0xffff0000, v249
    buffer_load_dwordx4 v58, s[20:23], s0 offen offset:3072 lds
    s_add_u32 m0, s58, 81920
    s_add_u32 s0, s0, 458752
    s_cmp_eq_u32 s0, 3670016
    s_cselect_b32 s0, 0, s0
    buffer_load_dwordx4 v55, s[20:23], s0 offen lds
    buffer_load_dwordx4 v56, s[20:23], s0 offen offset:1024 lds
    buffer_load_dwordx4 v57, s[20:23], s0 offen offset:2048 lds
    buffer_load_dwordx4 v58, s[20:23], s0 offen offset:3072 lds
    s_add_u32 m0, s58, 98304
    s_add_u32 s0, s0, 458752
    s_cmp_eq_u32 s0, 3670016
    s_cselect_b32 s0, 0, s0
    buffer_load_dwordx4 v55, s[20:23], s0 offen lds
    buffer_load_dwordx4 v56, s[20:23], s0 offen offset:1024 lds
    buffer_load_dwordx4 v57, s[20:23], s0 offen offset:2048 lds
    buffer_load_dwordx4 v58, s[20:23], s0 offen offset:3072 lds
    buffer_load_dword v18, v20, s[28:31], 0 offen sc1
    s_add_u32 m0, s58, 114688
    s_add_u32 s0, s0, 458752
    s_cmp_eq_u32 s0, 3670016
    s_cselect_b32 s0, 0, s0
    buffer_load_dwordx4 v55, s[20:23], s0 offen lds
    buffer_load_dwordx4 v56, s[20:23], s0 offen offset:1024 lds
    buffer_load_dwordx4 v57, s[20:23], s0 offen offset:2048 lds
    buffer_load_dwordx4 v58, s[20:23], s0 offen offset:3072 lds
    s_mov_b32 s3, s48
    s_mov_b64 exec, 0
L_warm:
    s_add_u32 s3, s3, 4
    s_cmp_eq_u32 s3, 4
    s_cbranch_scc1 L_pad0
    s_cmp_eq_u32 s3, 5
    s_cbranch_scc1 L_pad1
    s_cmp_eq_u32 s3, 6
    s_cbranch_scc1 L_pad2
    s_cmp_eq_u32 s3, 7
    s_cbranch_scc1 L_pad3
    s_cmp_eq_u32 s3, 8
    s_cbranch_scc1 L_pad4
    s_mov_b64 exec, -1
    s_waitcnt vmcnt(4)
    v_cmp_ne_u32 vcc, s57, v18
    s_cbranch_vccnz L_pollin0
L_pollok0:
    s_barrier
    buffer_load_dwordx4 a[0:3], v78, s[28:31], s1 offen offset:0 sc1
    buffer_load_dwordx4 a[4:7], v78, s[28:31], s1 offen offset:256 sc1
    buffer_load_dwordx4 a[8:11], v78, s[28:31], s1 offen offset:2048 sc1
    buffer_load_dwordx4 a[12:15], v78, s[28:31], s1 offen offset:2304 sc1
    buffer_load_dword v76, v77, s[28:31], 0 offen sc1
    s_add_u32 s1, s1, 8192
    s_and_b32 s1, s1, 0xffff
    buffer_load_dwordx4 a[16:19], v78, s[28:31], s1 offen offset:0 sc1
    buffer_load_dwordx4 a[20:23], v78, s[28:31], s1 offen offset:256 sc1
    buffer_load_dwordx4 a[24:27], v78, s[28:31], s1 offen offset:2048 sc1
    buffer_load_dwordx4 a[28:31], v78, s[28:31], s1 offen offset:2304 sc1
    s_add_u32 s1, s1, 8192
    s_and_b32 s1, s1, 0xffff
    buffer_load_dwordx4 a[32:35], v78, s[28:31], s1 offen offset:0 sc1
    buffer_load_dwordx4 a[36:39], v78, s[28:31], s1 offen offset:256 sc1
    buffer_load_dwordx4 a[40:43], v78, s[28:31], s1 offen offset:2048 sc1
    buffer_load_dwordx4 a[44:47], v78, s[28:31], s1 offen offset:2304 sc1
    ds_read_b64_tr_b16 a[200:201], v31 offset:0
    ds_read_b64_tr_b16 a[202:203], v31 offset:2048
    ds_read_b64_tr_b16 a[204:205], v33 offset:0
    ds_read_b64_tr_b16 a[206:207], v33 offset:2048
    ds_read_b64_tr_b16 a[208:209], v32 offset:0
    ds_read_b64_tr_b16 a[210:211], v32 offset:2048
    ds_read_b64_tr_b16 a[212:213], v34 offset:0
    ds_read_b64_tr_b16 a[214:215], v34 offset:2048
    ds_read_b64_tr_b16 a[216:217], v31 offset:4096
    ds_read_b64_tr_b16 a[218:219], v31 offset:6144
    ds_read_b64_tr_b16 a[220:221], v33 offset:4096
    ds_read_b64_tr_b16 a[222:223], v33 offset:6144
    s_waitcnt vmcnt(11) lgkmcnt(8)
    v_mfma_f32_16x16x32_bf16 v[182:185], a[200:203], a[0:3], 0
    ds_read_b64_tr_b16 a[224:225], v32 offset:4096
    s_add_u32 s1, s1, 8192
    v_mfma_f32_16x16x32_bf16 v[190:193], a[200:203], a[4:7], 0
    ds_read_b64_tr_b16 a[226:227], v32 offset:6144
    s_and_b32 s1, s1, 0xffff
    s_mov_b32 s70, 0xaaaaaaaa
    s_mov_b32 s71, 0xaaaaaaaa
    s_mov_b32 s72, 0xfff0ffff
    s_mov_b32 s73, 0xf000ff00
    s_mov_b32 s74, 0xffc0fffc
    v_mfma_f32_16x16x32_bf16 v[198:201], a[204:207], a[0:3], 0
    ds_read_b64_tr_b16 a[228:229], v34 offset:4096
    buffer_load_dwordx4 a[48:51], v78, s[28:31], s1 offen offset:0 sc1
    v_mfma_f32_16x16x32_bf16 v[206:209], a[204:207], a[4:7], 0
    ds_read_b64_tr_b16 a[230:231], v34 offset:6144
    s_mov_b32 s75, 0xc000fc00
    s_waitcnt lgkmcnt(8)
    v_mfma_f32_16x16x32_bf16 v[186:189], a[208:211], a[0:3], 0
    ds_read_b64_tr_b16 a[200:201], v31 offset:16384
    s_mov_b32 s83, 0x3e8b97f6
    v_mfma_f32_16x16x32_bf16 v[194:197], a[208:211], a[4:7], 0
    ds_read_b64_tr_b16 a[202:203], v31 offset:18432
    buffer_load_dwordx4 a[52:55], v78, s[28:31], s1 offen offset:256 sc1
    v_lshlrev_b32 v13, 2, v2
    v_mfma_f32_16x16x32_bf16 v[202:205], a[212:215], a[0:3], 0
    ds_read_b64_tr_b16 a[204:205], v33 offset:16384
    v_and_b32 v14, 1, v1
    v_mfma_f32_16x16x32_bf16 v[210:213], a[212:215], a[4:7], 0
    ds_read_b64_tr_b16 a[206:207], v33 offset:18432
    s_waitcnt vmcnt(11) lgkmcnt(8)
    v_mfma_f32_16x16x32_bf16 v[182:185], a[216:219], a[8:11], v[182:185]
    ds_read_b64_tr_b16 a[208:209], v32 offset:16384
    buffer_load_dwordx4 a[56:59], v78, s[28:31], s1 offen offset:2048 sc1
    v_mfma_f32_16x16x32_bf16 v[190:193], a[216:219], a[12:15], v[190:193]
    ds_read_b64_tr_b16 a[210:211], v32 offset:18432
    v_lshl_add_u32 v14, v3, 2, v14
    v_mfma_f32_16x16x32_bf16 v[198:201], a[220:223], a[8:11], v[198:201]
    ds_read_b64_tr_b16 a[212:213], v34 offset:16384
    v_lshlrev_b32 v14, 2, v14
    v_mfma_f32_16x16x32_bf16 v[206:209], a[220:223], a[12:15], v[206:209]
    ds_read_b64_tr_b16 a[214:215], v34 offset:18432
    s_waitcnt lgkmcnt(8)
    v_mfma_f32_16x16x32_bf16 v[186:189], a[224:227], a[8:11], v[186:189]
    ds_read_b64_tr_b16 a[216:217], v31 offset:20480
    buffer_load_dwordx4 a[60:63], v78, s[28:31], s1 offen offset:2304 sc1
    v_mfma_f32_16x16x32_bf16 v[194:197], a[224:227], a[12:15], v[194:197]
    ds_read_b64_tr_b16 a[218:219], v31 offset:22528
    s_add_u32 s1, s1, 8192
    v_add_u32 v15, 64, v14
    v_mfma_f32_16x16x32_bf16 v[202:205], a[228:231], a[8:11], v[202:205]
    ds_read_b64_tr_b16 a[220:221], v33 offset:20480
    s_and_b32 s1, s1, 0xffff
    v_mfma_f32_16x16x32_bf16 v[210:213], a[228:231], a[12:15], v[210:213]
    ds_read_b64_tr_b16 a[222:223], v33 offset:22528
    s_waitcnt vmcnt(10) lgkmcnt(8)
    v_mfma_f32_16x16x32_bf16 v[182:185], a[200:203], a[16:19], v[182:185]
    ds_read_b64_tr_b16 a[224:225], v32 offset:20480
    buffer_load_dwordx4 a[64:67], v78, s[28:31], s1 offen offset:0 sc1
    v_mfma_f32_16x16x32_bf16 v[190:193], a[200:203], a[20:23], v[190:193]
    ds_read_b64_tr_b16 a[226:227], v32 offset:22528
    v_cndmask_b32 v16, v14, v15, s[72:73]
    v_mfma_f32_16x16x32_bf16 v[198:201], a[204:207], a[16:19], v[198:201]
    ds_read_b64_tr_b16 a[228:229], v34 offset:20480
    buffer_load_dwordx4 a[68:71], v78, s[28:31], s1 offen offset:256 sc1
    v_mfma_f32_16x16x32_bf16 v[206:209], a[204:207], a[20:23], v[206:209]
    ds_read_b64_tr_b16 a[230:231], v34 offset:22528
    v_cndmask_b32 v14, v14, v15, s[74:75]
    s_waitcnt lgkmcnt(8)
    v_mfma_f32_16x16x32_bf16 v[186:189], a[208:211], a[16:19], v[186:189]
    ds_read_b64_tr_b16 a[200:201], v31 offset:32768
    ds_bpermute_b32 v25, v13, v76 offset:64
    v_mfma_f32_16x16x32_bf16 v[194:197], a[208:211], a[20:23], v[194:197]
    ds_read_b64_tr_b16 a[202:203], v31 offset:34816
    buffer_load_dwordx4 a[72:75], v78, s[28:31], s1 offen offset:2048 sc1
    ds_bpermute_b32 v27, v16, v76 offset:0
    v_mfma_f32_16x16x32_bf16 v[202:205], a[212:215], a[16:19], v[202:205]
    ds_read_b64_tr_b16 a[204:205], v33 offset:32768
    ds_bpermute_b32 v28, v14, v76 offset:8
    v_mfma_f32_16x16x32_bf16 v[210:213], a[212:215], a[20:23], v[210:213]
    ds_read_b64_tr_b16 a[206:207], v33 offset:34816
    s_waitcnt vmcnt(11) lgkmcnt(11)
    v_mfma_f32_16x16x32_bf16 v[182:185], a[216:219], a[24:27], v[182:185]
    ds_read_b64_tr_b16 a[208:209], v32 offset:32768
    ds_bpermute_b32 v26, v13, v76 offset:128
    v_mfma_f32_16x16x32_bf16 v[190:193], a[216:219], a[28:31], v[190:193]
    ds_read_b64_tr_b16 a[210:211], v32 offset:34816
    buffer_load_dwordx4 a[76:79], v78, s[28:31], s1 offen offset:2304 sc1
    ds_bpermute_b32 v29, v16, v76 offset:64
    v_mfma_f32_16x16x32_bf16 v[198:201], a[220:223], a[24:27], v[198:201]
    ds_read_b64_tr_b16 a[212:213], v34 offset:32768
    s_add_u32 s1, s1, 8192
    v_mfma_f32_16x16x32_bf16 v[206:209], a[220:223], a[28:31], v[206:209]
    ds_read_b64_tr_b16 a[214:215], v34 offset:34816
    s_waitcnt lgkmcnt(13)
    v_mfma_f32_16x16x32_bf16 v[186:189], a[224:227], a[24:27], v[186:189]
    ds_read_b64_tr_b16 a[216:217], v31 offset:36864
    s_and_b32 s1, s1, 0xffff
    v_mfma_f32_16x16x32_bf16 v[194:197], a[224:227], a[28:31], v[194:197]
    ds_read_b64_tr_b16 a[218:219], v31 offset:38912
    buffer_load_dwordx4 a[80:83], v78, s[28:31], s1 offen offset:0 sc1
    ds_bpermute_b32 v30, v14, v76 offset:72
    v_mfma_f32_16x16x32_bf16 v[202:205], a[228:231], a[24:27], v[202:205]
    ds_read_b64_tr_b16 a[220:221], v33 offset:36864
    v_mfma_f32_16x16x32_bf16 v[210:213], a[228:231], a[28:31], v[210:213]
    ds_read_b64_tr_b16 a[222:223], v33 offset:38912
    s_waitcnt vmcnt(11) lgkmcnt(11)
    v_mfma_f32_16x16x32_bf16 v[182:185], a[200:203], a[32:35], v[182:185]
    ds_read_b64_tr_b16 a[224:225], v32 offset:36864
    buffer_load_dwordx4 a[84:87], v78, s[28:31], s1 offen offset:256 sc1
    v_mfma_f32_16x16x32_bf16 v[190:193], a[200:203], a[36:39], v[190:193]
    ds_read_b64_tr_b16 a[226:227], v32 offset:38912
    v_mfma_f32_16x16x32_bf16 v[198:201], a[204:207], a[32:35], v[198:201]
    ds_read_b64_tr_b16 a[228:229], v34 offset:36864
    v_mfma_f32_16x16x32_bf16 v[206:209], a[204:207], a[36:39], v[206:209]
    ds_read_b64_tr_b16 a[230:231], v34 offset:38912
    s_waitcnt lgkmcnt(9)
    v_mfma_f32_16x16x32_bf16 v[186:189], a[208:211], a[32:35], v[186:189]
    s_barrier
    ds_read_b64_tr_b16 a[200:201], v31 offset:49152
    buffer_load_dwordx4 a[88:91], v78, s[28:31], s1 offen offset:2048 sc1
    v_mfma_f32_16x16x32_bf16 v[194:197], a[208:211], a[36:39], v[194:197]
    ds_read_b64_tr_b16 a[202:203], v31 offset:51200
    v_mfma_f32_16x16x32_bf16 v[202:205], a[212:215], a[32:35], v[202:205]
    ds_read_b64_tr_b16 a[204:205], v33 offset:49152
    buffer_load_dwordx4 a[92:95], v78, s[28:31], s1 offen offset:2304 sc1
    v_mfma_f32_16x16x32_bf16 v[210:213], a[212:215], a[36:39], v[210:213]
    ds_read_b64_tr_b16 a[206:207], v33 offset:51200
    s_waitcnt vmcnt(12) lgkmcnt(8)
    v_mfma_f32_16x16x32_bf16 v[182:185], a[216:219], a[40:43], v[182:185]
    ds_read_b64_tr_b16 a[208:209], v32 offset:49152
    s_add_u32 m0, s58, 131072
    v_mfma_f32_16x16x32_bf16 v[190:193], a[216:219], a[44:47], v[190:193]
    ds_read_b64_tr_b16 a[210:211], v32 offset:51200
    s_add_u32 s0, s0, 458752
    v_mul_f32 v25, s83, v25
    v_mfma_f32_16x16x32_bf16 v[198:201], a[220:223], a[40:43], v[198:201]
    ds_read_b64_tr_b16 a[212:213], v34 offset:49152
    s_cmp_eq_u32 s0, 3670016
    v_mfma_f32_16x16x32_bf16 v[206:209], a[220:223], a[44:47], v[206:209]
    ds_read_b64_tr_b16 a[214:215], v34 offset:51200
    s_cselect_b32 s0, 0, s0
    v_xor_b32 v55, 128, v55
    buffer_load_dwordx4 v55, s[20:23], s0 offen lds
    s_waitcnt lgkmcnt(8)
    v_mfma_f32_16x16x32_bf16 v[186:189], a[224:227], a[40:43], v[186:189]
    ds_read_b64_tr_b16 a[216:217], v31 offset:53248
    v_xor_b32 v56, 128, v56
    v_mfma_f32_16x16x32_bf16 v[194:197], a[224:227], a[44:47], v[194:197]
    ds_read_b64_tr_b16 a[218:219], v31 offset:55296
    buffer_load_dwordx4 v56, s[20:23], s0 offen offset:1024 lds
    v_mul_f32 v26, s83, v26
    v_mfma_f32_16x16x32_bf16 v[202:205], a[228:231], a[40:43], v[202:205]
    ds_read_b64_tr_b16 a[220:221], v33 offset:53248
    v_xor_b32 v57, 128, v57
    v_mfma_f32_16x16x32_bf16 v[210:213], a[228:231], a[44:47], v[210:213]
    ds_read_b64_tr_b16 a[222:223], v33 offset:55296
    s_waitcnt vmcnt(12) lgkmcnt(8)
    v_mfma_f32_16x16x32_bf16 v[182:185], a[200:203], a[48:51], v[182:185]
    ds_read_b64_tr_b16 a[224:225], v32 offset:53248
    buffer_load_dwordx4 v57, s[20:23], s0 offen offset:2048 lds
    v_mfma_f32_16x16x32_bf16 v[190:193], a[200:203], a[52:55], v[190:193]
    ds_read_b64_tr_b16 a[226:227], v32 offset:55296
    v_xor_b32 v58, 128, v58
    s_cmp_eq_u32 s49, 0
    s_cselect_b64 s[76:77], 0, -1
    v_mfma_f32_16x16x32_bf16 v[198:201], a[204:207], a[48:51], v[198:201]
    ds_read_b64_tr_b16 a[228:229], v34 offset:53248
    v_mov_b32 v13, 0xffff
    v_mfma_f32_16x16x32_bf16 v[206:209], a[204:207], a[52:55], v[206:209]
    ds_read_b64_tr_b16 a[230:231], v34 offset:55296
    s_waitcnt lgkmcnt(8)
    v_mfma_f32_16x16x32_bf16 v[186:189], a[208:211], a[48:51], v[186:189]
    ds_read_b64_tr_b16 a[200:201], v35 offset:0
    buffer_load_dwordx4 v58, s[20:23], s0 offen offset:3072 lds
    v_mfma_f32_16x16x32_bf16 v[194:197], a[208:211], a[52:55], v[194:197]
    ds_read_b64_tr_b16 a[202:203], v35 offset:2048
    s_add_u32 s1, s1, 8192
    v_mov_b32 v14, 0xffff0000
    v_mfma_f32_16x16x32_bf16 v[202:205], a[212:215], a[48:51], v[202:205]
    ds_read_b64_tr_b16 a[204:205], v37 offset:0
    s_and_b32 s1, s1, 0xffff
    v_mfma_f32_16x16x32_bf16 v[210:213], a[212:215], a[52:55], v[210:213]
    ds_read_b64_tr_b16 a[206:207], v37 offset:2048
    v_cndmask_b32 v13, v13, v14, s[70:71]
    s_waitcnt vmcnt(12) lgkmcnt(8)
    v_mfma_f32_16x16x32_bf16 v[182:185], a[216:219], a[56:59], v[182:185]
    ds_read_b64_tr_b16 a[208:209], v36 offset:0
    buffer_load_dwordx4 a[96:99], v78, s[28:31], s1 offen offset:0 sc1
    v_mfma_f32_16x16x32_bf16 v[190:193], a[216:219], a[60:63], v[190:193]
    ds_read_b64_tr_b16 a[210:211], v36 offset:2048
    v_cndmask_b32 v104, v13, 0, s[72:73]
    v_mfma_f32_16x16x32_bf16 v[198:201], a[220:223], a[56:59], v[198:201]
    ds_read_b64_tr_b16 a[212:213], v38 offset:0
    buffer_load_dwordx4 a[100:103], v78, s[28:31], s1 offen offset:256 sc1
    v_mfma_f32_16x16x32_bf16 v[206:209], a[220:223], a[60:63], v[206:209]
    ds_read_b64_tr_b16 a[214:215], v38 offset:2048
    v_cndmask_b32 v106, 0, v13, s[72:73]
    s_waitcnt lgkmcnt(8)
    v_mfma_f32_16x16x32_bf16 v[186:189], a[224:227], a[56:59], v[186:189]
    ds_read_b64_tr_b16 a[216:217], v35 offset:4096
    v_cndmask_b32 v105, v13, 0, s[74:75]
    v_mfma_f32_16x16x32_bf16 v[194:197], a[224:227], a[60:63], v[194:197]
    ds_read_b64_tr_b16 a[218:219], v35 offset:6144
    buffer_load_dwordx4 a[104:107], v78, s[28:31], s1 offen offset:2048 sc1
    v_cndmask_b32 v107, 0, v13, s[74:75]
    v_mfma_f32_16x16x32_bf16 v[202:205], a[228:231], a[56:59], v[202:205]
    ds_read_b64_tr_b16 a[220:221], v37 offset:4096
    v_mov_b32 v84, 0xf149f2ca
    v_mfma_f32_16x16x32_bf16 v[210:213], a[228:231], a[60:63], v[210:213]
    ds_read_b64_tr_b16 a[222:223], v37 offset:6144
    s_waitcnt vmcnt(13) lgkmcnt(8)
    v_mfma_f32_16x16x32_bf16 v[182:185], a[200:203], a[64:67], v[182:185]
    ds_read_b64_tr_b16 a[224:225], v36 offset:4096
    buffer_load_dwordx4 a[108:111], v78, s[28:31], s1 offen offset:2304 sc1
    v_mfma_f32_16x16x32_bf16 v[190:193], a[200:203], a[68:71], v[190:193]
    ds_read_b64_tr_b16 a[226:227], v36 offset:6144
    s_add_u32 m0, s58, 147456
    s_mov_b32 s83, 0x3e8b97f6
    v_mfma_f32_16x16x32_bf16 v[198:201], a[204:207], a[64:67], v[198:201]
    ds_read_b64_tr_b16 a[228:229], v38 offset:4096
    s_add_u32 s0, s0, 458752
    v_mfma_f32_16x16x32_bf16 v[206:209], a[204:207], a[68:71], v[206:209]
    ds_read_b64_tr_b16 a[230:231], v38 offset:6144
    s_mov_b32 s78, 0xbdd2d3e8
    s_mov_b32 s79, 0xbdd2d3e8
    s_waitcnt lgkmcnt(8)
    v_mfma_f32_16x16x32_bf16 v[186:189], a[208:211], a[64:67], v[186:189]
    s_barrier
    s_load_dword s14, s[44:45], s15
    ds_read_b64_tr_b16 a[200:201], v35 offset:16384
    s_cmp_eq_u32 s0, 3670016
    s_cselect_b32 s0, 0, s0
    buffer_load_dwordx4 v55, s[20:23], s0 offen lds
    v_mfma_f32_16x16x32_bf16 v[194:197], a[208:211], a[68:71], v[194:197]
    ds_read_b64_tr_b16 a[202:203], v35 offset:18432
    s_mov_b32 s80, 1.0
    v_mfma_f32_16x16x32_bf16 v[202:205], a[212:215], a[64:67], v[202:205]
    ds_read_b64_tr_b16 a[204:205], v37 offset:16384
    buffer_load_dwordx4 v56, s[20:23], s0 offen offset:1024 lds
    v_mfma_f32_16x16x32_bf16 v[210:213], a[212:215], a[68:71], v[210:213]
    ds_read_b64_tr_b16 a[206:207], v37 offset:18432
    s_mov_b32 s81, 1.0
    s_waitcnt vmcnt(14) lgkmcnt(8)
    v_mfma_f32_16x16x32_bf16 v[182:185], a[216:219], a[72:75], v[182:185]
    ds_read_b64_tr_b16 a[208:209], v36 offset:16384
    v_mov_b32 v108, 0xc0135761
    v_mfma_f32_16x16x32_bf16 v[190:193], a[216:219], a[76:79], v[190:193]
    ds_read_b64_tr_b16 a[210:211], v36 offset:18432
    buffer_load_dwordx4 v57, s[20:23], s0 offen offset:2048 lds
    v_mov_b32 v109, 0xc0135761
    v_mfma_f32_16x16x32_bf16 v[198:201], a[220:223], a[72:75], v[198:201]
    ds_read_b64_tr_b16 a[212:213], v38 offset:16384
    v_lshrrev_b32 v13, 1, v2
    v_mfma_f32_16x16x32_bf16 v[206:209], a[220:223], a[76:79], v[206:209]
    ds_read_b64_tr_b16 a[214:215], v38 offset:18432
    s_waitcnt lgkmcnt(8)
    v_mfma_f32_16x16x32_bf16 v[186:189], a[224:227], a[72:75], v[186:189]
    ds_read_b64_tr_b16 a[216:217], v35 offset:20480
    buffer_load_dwordx4 v58, s[20:23], s0 offen offset:3072 lds
    v_mfma_f32_16x16x32_bf16 v[194:197], a[224:227], a[76:79], v[194:197]
    ds_read_b64_tr_b16 a[218:219], v35 offset:22528
    s_add_u32 s1, s1, 8192
    v_lshlrev_b32 v14, 1, v3
    v_mfma_f32_16x16x32_bf16 v[202:205], a[228:231], a[72:75], v[202:205]
    ds_read_b64_tr_b16 a[220:221], v37 offset:20480
    s_and_b32 s1, s1, 0xffff
    v_mfma_f32_16x16x32_bf16 v[210:213], a[228:231], a[76:79], v[210:213]
    ds_read_b64_tr_b16 a[222:223], v37 offset:22528
    s_waitcnt vmcnt(14) lgkmcnt(8)
    v_mfma_f32_16x16x32_bf16 v[182:185], a[200:203], a[80:83], v[182:185]
    ds_read_b64_tr_b16 a[224:225], v36 offset:20480
    buffer_load_dwordx4 a[112:115], v78, s[28:31], s1 offen offset:0 sc1
    v_mfma_f32_16x16x32_bf16 v[190:193], a[200:203], a[84:87], v[190:193]
    ds_read_b64_tr_b16 a[226:227], v36 offset:22528
L_pad0:
    s_cbranch_execz L_warm
    v_sub_u32 v13, v13, v14
    v_mfma_f32_16x16x32_bf16 v[198:201], a[204:207], a[80:83], v[198:201]
    ds_read_b64_tr_b16 a[228:229], v38 offset:20480
    buffer_load_dwordx4 a[116:119], v78, s[28:31], s1 offen offset:256 sc1
    v_mfma_f32_16x16x32_bf16 v[206:209], a[204:207], a[84:87], v[206:209]
    ds_read_b64_tr_b16 a[230:231], v38 offset:22528
    v_mov_b32 v14, 0x3f80
    s_waitcnt lgkmcnt(8)
    v_mfma_f32_16x16x32_bf16 v[186:189], a[208:211], a[80:83], v[186:189]
    ds_read_b64_tr_b16 a[200:201], v35 offset:32768
    v_cndmask_b32 v14, v14, 1.0, s[70:71]
    v_mfma_f32_16x16x32_bf16 v[194:197], a[208:211], a[84:87], v[194:197]
    ds_read_b64_tr_b16 a[202:203], v35 offset:34816
    buffer_load_dwordx4 a[120:123], v78, s[28:31], s1 offen offset:2048 sc1
    v_cmp_eq_i32 vcc, 0, v13
    v_mfma_f32_16x16x32_bf16 v[202:205], a[212:215], a[80:83], v[202:205]
    ds_read_b64_tr_b16 a[204:205], v37 offset:32768
    v_accvgpr_write_b32 a248, 0
    v_mfma_f32_16x16x32_bf16 v[210:213], a[212:215], a[84:87], v[210:213]
    ds_read_b64_tr_b16 a[206:207], v37 offset:34816
    s_waitcnt vmcnt(15) lgkmcnt(8)
    v_mfma_f32_16x16x32_bf16 v[182:185], a[216:219], a[88:91], v[182:185]
    ds_read_b64_tr_b16 a[208:209], v36 offset:32768
    buffer_load_dwordx4 a[124:127], v78, s[28:31], s1 offen offset:2304 sc1
    v_mfma_f32_16x16x32_bf16 v[190:193], a[216:219], a[92:95], v[190:193]
    ds_read_b64_tr_b16 a[210:211], v36 offset:34816
    s_add_u32 m0, s58, 0
    v_accvgpr_write_b32 a252, 0
    v_mfma_f32_16x16x32_bf16 v[198:201], a[220:223], a[88:91], v[198:201]
    ds_read_b64_tr_b16 a[212:213], v38 offset:32768
    s_add_u32 s0, s0, 458752
    v_mfma_f32_16x16x32_bf16 v[206:209], a[220:223], a[92:95], v[206:209]
    ds_read_b64_tr_b16 a[214:215], v38 offset:34816
    s_waitcnt lgkmcnt(8)
    v_mfma_f32_16x16x32_bf16 v[186:189], a[224:227], a[88:91], v[186:189]
    ds_read_b64_tr_b16 a[216:217], v35 offset:36864
    s_cmp_eq_u32 s0, 3670016
    v_mfma_f32_16x16x32_bf16 v[194:197], a[224:227], a[92:95], v[194:197]
    ds_read_b64_tr_b16 a[218:219], v35 offset:38912
    s_cselect_b32 s0, 0, s0
    buffer_load_dwordx4 v55, s[20:23], s0 offen lds
    v_cndmask_b32 v15, 0, v14, vcc
    v_mfma_f32_16x16x32_bf16 v[202:205], a[228:231], a[88:91], v[202:205]
    ds_read_b64_tr_b16 a[220:221], v37 offset:36864
    v_accvgpr_write_b32 a250, v15
    v_mfma_f32_16x16x32_bf16 v[210:213], a[228:231], a[92:95], v[210:213]
    ds_read_b64_tr_b16 a[222:223], v37 offset:38912
    s_waitcnt vmcnt(11) lgkmcnt(8)
    v_mfma_f32_16x16x32_bf16 v[182:185], a[200:203], a[96:99], v[182:185]
    ds_read_b64_tr_b16 a[224:225], v36 offset:36864
    buffer_load_dwordx4 v56, s[20:23], s0 offen offset:1024 lds
    v_mfma_f32_16x16x32_bf16 v[190:193], a[200:203], a[100:103], v[190:193]
    ds_read_b64_tr_b16 a[226:227], v36 offset:38912
    v_cmp_eq_i32 vcc, 1, v13
    v_mfma_f32_16x16x32_bf16 v[198:201], a[204:207], a[96:99], v[198:201]
    ds_read_b64_tr_b16 a[228:229], v38 offset:36864
    buffer_load_dwordx4 v57, s[20:23], s0 offen offset:2048 lds
    v_mfma_f32_16x16x32_bf16 v[206:209], a[204:207], a[100:103], v[206:209]
    ds_read_b64_tr_b16 a[230:231], v38 offset:38912
    v_accvgpr_write_b32 a249, 0
    s_waitcnt lgkmcnt(8)
    v_mfma_f32_16x16x32_bf16 v[186:189], a[208:211], a[96:99], v[186:189]
    s_waitcnt vmcnt(7)
    s_barrier
    ds_read_b64_tr_b16 a[200:201], v35 offset:49152
    buffer_load_dwordx4 v58, s[20:23], s0 offen offset:3072 lds
    v_mfma_f32_16x16x32_bf16 v[194:197], a[208:211], a[100:103], v[194:197]
    ds_read_b64_tr_b16 a[202:203], v35 offset:51200
    s_add_u32 m0, s58, 16384
    v_accvgpr_write_b32 a253, 0
    v_mfma_f32_16x16x32_bf16 v[202:205], a[212:215], a[96:99], v[202:205]
    ds_read_b64_tr_b16 a[204:205], v37 offset:49152
    s_add_u32 s0, s0, 458752
    v_mfma_f32_16x16x32_bf16 v[210:213], a[212:215], a[100:103], v[210:213]
    ds_read_b64_tr_b16 a[206:207], v37 offset:51200
    s_waitcnt lgkmcnt(8)
    v_mfma_f32_16x16x32_bf16 v[182:185], a[216:219], a[104:107], v[182:185]
    ds_read_b64_tr_b16 a[208:209], v36 offset:49152
    s_cmp_eq_u32 s0, 3670016
    v_mfma_f32_16x16x32_bf16 v[190:193], a[216:219], a[108:111], v[190:193]
    ds_read_b64_tr_b16 a[210:211], v36 offset:51200
    s_cselect_b32 s0, 0, s0
    buffer_load_dwordx4 v55, s[20:23], s0 offen lds
    v_cndmask_b32 v15, 0, v14, vcc
    v_mfma_f32_16x16x32_bf16 v[198:201], a[220:223], a[104:107], v[198:201]
    ds_read_b64_tr_b16 a[212:213], v38 offset:49152
    v_accvgpr_write_b32 a251, v15
    v_mfma_f32_16x16x32_bf16 v[206:209], a[220:223], a[108:111], v[206:209]
    ds_read_b64_tr_b16 a[214:215], v38 offset:51200
    s_waitcnt lgkmcnt(8)
    v_mfma_f32_16x16x32_bf16 v[186:189], a[224:227], a[104:107], v[186:189]
    ds_read_b64_tr_b16 a[216:217], v35 offset:53248
    buffer_load_dwordx4 v56, s[20:23], s0 offen offset:1024 lds
    v_mfma_f32_16x16x32_bf16 v[194:197], a[224:227], a[108:111], v[194:197]
    ds_read_b64_tr_b16 a[218:219], v35 offset:55296
    v_mfma_f32_16x16x32_bf16 v[202:205], a[228:231], a[104:107], v[202:205]
    ds_read_b64_tr_b16 a[220:221], v37 offset:53248
    buffer_load_dwordx4 v57, s[20:23], s0 offen offset:2048 lds
    v_mfma_f32_16x16x32_bf16 v[210:213], a[228:231], a[108:111], v[210:213]
    ds_read_b64_tr_b16 a[222:223], v37 offset:55296
    s_waitcnt vmcnt(9) lgkmcnt(8)
    v_mfma_f32_16x16x32_bf16 v[182:185], a[200:203], a[112:115], v[182:185]
    ds_read_b64_tr_b16 a[224:225], v36 offset:53248
    v_mfma_f32_16x16x32_bf16 v[190:193], a[200:203], a[116:119], v[190:193]
    ds_read_b64_tr_b16 a[226:227], v36 offset:55296
    buffer_load_dwordx4 v58, s[20:23], s0 offen offset:3072 lds
    v_mfma_f32_16x16x32_bf16 v[198:201], a[204:207], a[112:115], v[198:201]
    ds_read_b64_tr_b16 a[228:229], v38 offset:53248
    s_add_u32 m0, s58, 32768
    v_mfma_f32_16x16x32_bf16 v[206:209], a[204:207], a[116:119], v[206:209]
    ds_read_b64_tr_b16 a[230:231], v38 offset:55296
    s_waitcnt lgkmcnt(8)
    v_mfma_f32_16x16x32_bf16 v[186:189], a[208:211], a[112:115], v[186:189]
    s_waitcnt lgkmcnt(0)
    s_cmp_ge_u32 s14, 14
    s_cbranch_scc0 L_pollin1
L_pollok1:
    ds_read_b64_tr_b16 a[200:201], v39 offset:0
    s_add_u32 s0, s0, 458752
    v_mfma_f32_16x16x32_bf16 v[194:197], a[208:211], a[116:119], v[194:197]
    ds_read_b64_tr_b16 a[202:203], v39 offset:2048
    s_cmp_eq_u32 s0, 3670016
    s_cselect_b32 s0, 0, s0
    buffer_load_dwordx4 v55, s[20:23], s0 offen lds
    v_mfma_f32_16x16x32_bf16 v[202:205], a[212:215], a[112:115], v[202:205]
    ds_read_b64_tr_b16 a[204:205], v41 offset:0
    v_mfma_f32_16x16x32_bf16 v[210:213], a[212:215], a[116:119], v[210:213]
    ds_read_b64_tr_b16 a[206:207], v41 offset:2048
    s_waitcnt vmcnt(9)
    v_mfma_f32_16x16x32_bf16 v[182:185], a[216:219], a[120:123], v[182:185]
    ds_read_b64_tr_b16 a[208:209], v40 offset:0
    buffer_load_dwordx4 v56, s[20:23], s0 offen offset:1024 lds
    v_mfma_f32_16x16x32_bf16 v[190:193], a[216:219], a[124:127], v[190:193]
    ds_read_b64_tr_b16 a[210:211], v40 offset:2048
    v_mfma_f32_16x16x32_bf16 v[198:201], a[220:223], a[120:123], v[198:201]
    ds_read_b64_tr_b16 a[212:213], v42 offset:0
    buffer_load_dwordx4 v57, s[20:23], s0 offen offset:2048 lds
    v_mfma_f32_16x16x32_bf16 v[206:209], a[220:223], a[124:127], v[206:209]
    ds_read_b64_tr_b16 a[214:215], v42 offset:2048
    v_mfma_f32_16x16x32_bf16 v[186:189], a[224:227], a[120:123], v[186:189]
    ds_read_b64_tr_b16 a[216:217], v39 offset:4096
    v_mfma_f32_16x16x32_bf16 v[194:197], a[224:227], a[124:127], v[194:197]
    ds_read_b64_tr_b16 a[218:219], v39 offset:6144
    v_mfma_f32_16x16x32_bf16 v[202:205], a[228:231], a[120:123], v[202:205]
    ds_read_b64_tr_b16 a[220:221], v41 offset:4096
    buffer_load_dwordx4 v58, s[20:23], s0 offen offset:3072 lds
    v_mfma_f32_16x16x32_bf16 v[210:213], a[228:231], a[124:127], v[210:213]
    ds_read_b64_tr_b16 a[222:223], v41 offset:6144
    s_waitcnt lgkmcnt(8)
    v_mfma_f32_16x16x32_bf16 v[150:153], a[200:203], a[0:3], v[150:153]
    ds_read_b64_tr_b16 a[224:225], v40 offset:4096
    s_add_u32 m0, s58, 49152
    v_mfma_f32_16x16x32_bf16 v[158:161], a[200:203], a[4:7], v[158:161]
    ds_read_b64_tr_b16 a[226:227], v40 offset:6144
    s_add_u32 s0, s0, 458752
    v_mfma_f32_16x16x32_bf16 v[166:169], a[204:207], a[0:3], 0
    ds_read_b64_tr_b16 a[228:229], v42 offset:4096
    s_cmp_eq_u32 s0, 3670016
    s_cselect_b32 s0, 0, s0
    buffer_load_dwordx4 v55, s[20:23], s0 offen lds
    v_mfma_f32_16x16x32_bf16 v[174:177], a[204:207], a[4:7], 0
    ds_read_b64_tr_b16 a[230:231], v42 offset:6144
    v_cvt_pk_bf16_f32 v182, v182, v183
    v_cvt_pk_bf16_f32 v183, v184, v185
    v_cvt_pk_bf16_f32 v184, v186, v187
    s_waitcnt lgkmcnt(8)
    v_mfma_f32_16x16x32_bf16 v[154:157], a[208:211], a[0:3], v[154:157]
    s_waitcnt vmcnt(5)
    s_barrier
    ds_read_b64_tr_b16 a[200:201], v39 offset:16384
    buffer_load_dwordx4 v56, s[20:23], s0 offen offset:1024 lds
    v_mfma_f32_16x16x32_bf16 v[162:165], a[208:211], a[4:7], v[162:165]
    ds_read_b64_tr_b16 a[202:203], v39 offset:18432
    v_cvt_pk_bf16_f32 v185, v188, v189
    buffer_store_dwordx4 v[182:185], v23, s[28:31], 0 offen offset:0 sc1
    v_cvt_pk_bf16_f32 v190, v190, v191
    v_cvt_pk_bf16_f32 v191, v192, v193
    v_cvt_pk_bf16_f32 v192, v194, v195
    v_mfma_f32_16x16x32_bf16 v[170:173], a[212:215], a[0:3], 0
    ds_read_b64_tr_b16 a[204:205], v41 offset:16384
    v_cvt_pk_bf16_f32 v193, v196, v197
    v_mfma_f32_16x16x32_bf16 v[178:181], a[212:215], a[4:7], 0
    ds_read_b64_tr_b16 a[206:207], v41 offset:18432
    buffer_store_dwordx4 v[190:193], v23, s[28:31], 0 offen offset:1024 sc1
    v_cvt_pk_bf16_f32 v198, v198, v199
    v_cvt_pk_bf16_f32 v199, v200, v201
    v_cvt_pk_bf16_f32 v200, v202, v203
    s_waitcnt lgkmcnt(8)
    v_mfma_f32_16x16x32_bf16 v[150:153], a[216:219], a[8:11], v[150:153]
    ds_read_b64_tr_b16 a[208:209], v40 offset:16384
    buffer_load_dwordx4 v57, s[20:23], s0 offen offset:2048 lds
    v_mfma_f32_16x16x32_bf16 v[158:161], a[216:219], a[12:15], v[158:161]
    ds_read_b64_tr_b16 a[210:211], v40 offset:18432
    v_cvt_pk_bf16_f32 v201, v204, v205
    buffer_store_dwordx4 v[198:201], v23, s[28:31], 0 offen offset:2048 sc1
    v_cvt_pk_bf16_f32 v206, v206, v207
    v_cvt_pk_bf16_f32 v207, v208, v209
    v_cvt_pk_bf16_f32 v208, v210, v211
    v_mfma_f32_16x16x32_bf16 v[166:169], a[220:223], a[8:11], v[166:169]
    ds_read_b64_tr_b16 a[212:213], v42 offset:16384
    v_cvt_pk_bf16_f32 v209, v212, v213
    v_mfma_f32_16x16x32_bf16 v[174:177], a[220:223], a[12:15], v[174:177]
    ds_read_b64_tr_b16 a[214:215], v42 offset:18432
    s_waitcnt lgkmcnt(8)
    v_mfma_f32_16x16x32_bf16 v[154:157], a[224:227], a[8:11], v[154:157]
    ds_read_b64_tr_b16 a[216:217], v39 offset:20480
    buffer_load_dwordx4 v58, s[20:23], s0 offen offset:3072 lds
    v_mfma_f32_16x16x32_bf16 v[162:165], a[224:227], a[12:15], v[162:165]
    ds_read_b64_tr_b16 a[218:219], v39 offset:22528
    s_add_u32 m0, s58, 65536
    buffer_store_dwordx4 v[206:209], v23, s[28:31], 0 offen offset:3072 sc1
    v_mfma_f32_16x16x32_bf16 v[170:173], a[228:231], a[8:11], v[170:173]
    ds_read_b64_tr_b16 a[220:221], v41 offset:20480
    s_add_u32 s0, s0, 458752
    v_mfma_f32_16x16x32_bf16 v[178:181], a[228:231], a[12:15], v[178:181]
    ds_read_b64_tr_b16 a[222:223], v41 offset:22528
    s_waitcnt lgkmcnt(8)
    v_mfma_f32_16x16x32_bf16 v[150:153], a[200:203], a[16:19], v[150:153]
    ds_read_b64_tr_b16 a[224:225], v40 offset:20480
    s_cmp_eq_u32 s0, 3670016
    v_mfma_f32_16x16x32_bf16 v[158:161], a[200:203], a[20:23], v[158:161]
    ds_read_b64_tr_b16 a[226:227], v40 offset:22528
    s_cselect_b32 s0, 0, s0
    buffer_load_dwordx4 v55, s[20:23], s0 offen lds
    v_mfma_f32_16x16x32_bf16 v[166:169], a[204:207], a[16:19], v[166:169]
    ds_read_b64_tr_b16 a[228:229], v42 offset:20480
    v_mfma_f32_16x16x32_bf16 v[174:177], a[204:207], a[20:23], v[174:177]
    ds_read_b64_tr_b16 a[230:231], v42 offset:22528
    s_waitcnt lgkmcnt(8)
    v_mfma_f32_16x16x32_bf16 v[154:157], a[208:211], a[16:19], v[154:157]
    ds_read_b64_tr_b16 a[200:201], v31 offset:0
    buffer_load_dwordx4 v56, s[20:23], s0 offen offset:1024 lds
    v_mfma_f32_16x16x32_bf16 v[162:165], a[208:211], a[20:23], v[162:165]
    ds_read_b64_tr_b16 a[202:203], v31 offset:2048
    v_mfma_f32_16x16x32_bf16 v[170:173], a[212:215], a[16:19], v[170:173]
    ds_read_b64_tr_b16 a[204:205], v33 offset:0
    buffer_load_dwordx4 v57, s[20:23], s0 offen offset:2048 lds
    v_mfma_f32_16x16x32_bf16 v[178:181], a[212:215], a[20:23], v[178:181]
    ds_read_b64_tr_b16 a[206:207], v33 offset:2048
    s_waitcnt lgkmcnt(8)
    v_mfma_f32_16x16x32_bf16 v[150:153], a[216:219], a[24:27], v[150:153]
    ds_read_b64_tr_b16 a[208:209], v32 offset:0
    v_mfma_f32_16x16x32_bf16 v[158:161], a[216:219], a[28:31], v[158:161]
    ds_read_b64_tr_b16 a[210:211], v32 offset:2048
    buffer_load_dwordx4 v58, s[20:23], s0 offen offset:3072 lds
    v_mfma_f32_16x16x32_bf16 v[166:169], a[220:223], a[24:27], v[166:169]
    ds_read_b64_tr_b16 a[212:213], v34 offset:0
    s_add_u32 m0, s58, 81920
    v_mfma_f32_16x16x32_bf16 v[174:177], a[220:223], a[28:31], v[174:177]
    ds_read_b64_tr_b16 a[214:215], v34 offset:2048
    s_waitcnt lgkmcnt(8)
    v_mfma_f32_16x16x32_bf16 v[154:157], a[224:227], a[24:27], v[154:157]
    ds_read_b64_tr_b16 a[216:217], v31 offset:4096
    s_add_u32 s0, s0, 458752
    v_mfma_f32_16x16x32_bf16 v[162:165], a[224:227], a[28:31], v[162:165]
    ds_read_b64_tr_b16 a[218:219], v31 offset:6144
    s_cmp_eq_u32 s0, 3670016
    v_mfma_f32_16x16x32_bf16 v[170:173], a[228:231], a[24:27], v[170:173]
    ds_read_b64_tr_b16 a[220:221], v33 offset:4096
    s_cselect_b32 s0, 0, s0
    buffer_load_dwordx4 v55, s[20:23], s0 offen lds
    v_mfma_f32_16x16x32_bf16 v[178:181], a[228:231], a[28:31], v[178:181]
    ds_read_b64_tr_b16 a[222:223], v33 offset:6144
    s_waitcnt lgkmcnt(8)
    v_mfma_f32_16x16x32_bf16 v[150:153], a[200:203], a[32:35], v[150:153]
    ds_read_b64_tr_b16 a[224:225], v32 offset:4096
    buffer_load_dwordx4 v56, s[20:23], s0 offen offset:1024 lds
    v_mfma_f32_16x16x32_bf16 v[158:161], a[200:203], a[36:39], v[158:161]
    ds_read_b64_tr_b16 a[226:227], v32 offset:6144
    v_mfma_f32_16x16x32_bf16 v[166:169], a[204:207], a[32:35], v[166:169]
    ds_read_b64_tr_b16 a[228:229], v34 offset:4096
    v_mfma_f32_16x16x32_bf16 v[174:177], a[204:207], a[36:39], v[174:177]
    ds_read_b64_tr_b16 a[230:231], v34 offset:6144
    s_waitcnt lgkmcnt(8)
    v_mfma_f32_16x16x32_bf16 v[154:157], a[208:211], a[32:35], v[154:157]
    s_waitcnt vmcnt(7)
    s_barrier
    s_waitcnt vmcnt(6)
    s_atomic_add s36, s[28:29], s37
    ds_read_b64_tr_b16 a[200:201], v31 offset:16384
    buffer_load_dwordx4 v57, s[20:23], s0 offen offset:2048 lds
    v_mfma_f32_16x16x32_bf16 v[162:165], a[208:211], a[36:39], v[162:165]
    ds_read_b64_tr_b16 a[202:203], v31 offset:18432
    v_mfma_f32_16x16x32_bf16 v[170:173], a[212:215], a[32:35], v[170:173]
    ds_read_b64_tr_b16 a[204:205], v33 offset:16384
    buffer_load_dwordx4 v58, s[20:23], s0 offen offset:3072 lds
    v_mfma_f32_16x16x32_bf16 v[178:181], a[212:215], a[36:39], v[178:181]
    ds_read_b64_tr_b16 a[206:207], v33 offset:18432
    s_waitcnt lgkmcnt(8)
    v_mfma_f32_16x16x32_bf16 v[150:153], a[216:219], a[40:43], v[150:153]
    ds_read_b64_tr_b16 a[208:209], v32 offset:16384
    s_add_u32 m0, s59, 98304
    v_mfma_f32_16x16x32_bf16 v[158:161], a[216:219], a[44:47], v[158:161]
    ds_read_b64_tr_b16 a[210:211], v32 offset:18432
    buffer_load_dwordx4 v80, s[28:31], s63 offen sc1 lds
    v_mfma_f32_16x16x32_bf16 v[166:169], a[220:223], a[40:43], v[166:169]
    ds_read_b64_tr_b16 a[212:213], v34 offset:16384
    v_mfma_f32_16x16x32_bf16 v[174:177], a[220:223], a[44:47], v[174:177]
    ds_read_b64_tr_b16 a[214:215], v34 offset:18432
    s_waitcnt lgkmcnt(8)
    v_mfma_f32_16x16x32_bf16 v[154:157], a[224:227], a[40:43], v[154:157]
    ds_read_b64_tr_b16 a[216:217], v31 offset:20480
    v_mfma_f32_16x16x32_bf16 v[162:165], a[224:227], a[44:47], v[162:165]
    ds_read_b64_tr_b16 a[218:219], v31 offset:22528
    buffer_load_dwordx4 v80, s[28:31], s63 offen offset:1024 sc1 lds
    v_mfma_f32_16x16x32_bf16 v[170:173], a[228:231], a[40:43], v[170:173]
    ds_read_b64_tr_b16 a[220:221], v33 offset:20480
    v_mfma_f32_16x16x32_bf16 v[178:181], a[228:231], a[44:47], v[178:181]
    ds_read_b64_tr_b16 a[222:223], v33 offset:22528
    s_waitcnt lgkmcnt(8)
    v_mfma_f32_16x16x32_bf16 v[150:153], a[200:203], a[48:51], v[150:153]
    ds_read_b64_tr_b16 a[224:225], v32 offset:20480
    buffer_load_dwordx4 v80, s[28:31], s63 offen offset:2048 sc1 lds
    v_mfma_f32_16x16x32_bf16 v[158:161], a[200:203], a[52:55], v[158:161]
    ds_read_b64_tr_b16 a[226:227], v32 offset:22528
    s_add_u32 m0, s100, 126976
    v_mfma_f32_16x16x32_bf16 v[166:169], a[204:207], a[48:51], v[166:169]
    ds_read_b64_tr_b16 a[228:229], v34 offset:20480
    v_mfma_f32_16x16x32_bf16 v[174:177], a[204:207], a[52:55], v[174:177]
    ds_read_b64_tr_b16 a[230:231], v34 offset:22528
    s_waitcnt lgkmcnt(8)
    v_mfma_f32_16x16x32_bf16 v[154:157], a[208:211], a[48:51], v[154:157]
    ds_read_b64_tr_b16 a[200:201], v31 offset:32768
    buffer_load_dwordx4 v69, s[28:31], s62 offen sc1 lds
    v_mfma_f32_16x16x32_bf16 v[162:165], a[208:211], a[52:55], v[162:165]
    ds_read_b64_tr_b16 a[202:203], v31 offset:34816
    s_add_u32 m0, s58, 110592
    v_mfma_f32_16x16x32_bf16 v[170:173], a[212:215], a[48:51], v[170:173]
    ds_read_b64_tr_b16 a[204:205], v33 offset:32768
    v_mfma_f32_16x16x32_bf16 v[178:181], a[212:215], a[52:55], v[178:181]
    ds_read_b64_tr_b16 a[206:207], v33 offset:34816
    s_waitcnt lgkmcnt(8)
    v_mfma_f32_16x16x32_bf16 v[150:153], a[216:219], a[56:59], v[150:153]
    ds_read_b64_tr_b16 a[208:209], v32 offset:32768
    buffer_load_dwordx4 v67, s[28:31], s62 offen sc1 lds
    v_mfma_f32_16x16x32_bf16 v[158:161], a[216:219], a[60:63], v[158:161]
    ds_read_b64_tr_b16 a[210:211], v32 offset:34816
    v_mfma_f32_16x16x32_bf16 v[166:169], a[220:223], a[56:59], v[166:169]
    ds_read_b64_tr_b16 a[212:213], v34 offset:32768
    v_mfma_f32_16x16x32_bf16 v[174:177], a[220:223], a[60:63], v[174:177]
    ds_read_b64_tr_b16 a[214:215], v34 offset:34816
    s_waitcnt lgkmcnt(8)
    v_mfma_f32_16x16x32_bf16 v[154:157], a[224:227], a[56:59], v[154:157]
    ds_read_b64_tr_b16 a[216:217], v31 offset:36864
    buffer_load_dwordx4 v67, s[28:31], s62 offen offset:1024 sc1 lds
    v_mfma_f32_16x16x32_bf16 v[162:165], a[224:227], a[60:63], v[162:165]
    ds_read_b64_tr_b16 a[218:219], v31 offset:38912
    v_mfma_f32_16x16x32_bf16 v[170:173], a[228:231], a[56:59], v[170:173]
    ds_read_b64_tr_b16 a[220:221], v33 offset:36864
    buffer_load_dwordx4 v68, s[28:31], s62 offen offset:2048 sc1 lds
    v_mfma_f32_16x16x32_bf16 v[178:181], a[228:231], a[60:63], v[178:181]
    ds_read_b64_tr_b16 a[222:223], v33 offset:38912
    s_waitcnt lgkmcnt(8)
    v_mfma_f32_16x16x32_bf16 v[150:153], a[200:203], a[64:67], v[150:153]
    ds_read_b64_tr_b16 a[224:225], v32 offset:36864
    v_mfma_f32_16x16x32_bf16 v[158:161], a[200:203], a[68:71], v[158:161]
    ds_read_b64_tr_b16 a[226:227], v32 offset:38912
    v_mfma_f32_16x16x32_bf16 v[166:169], a[204:207], a[64:67], v[166:169]
    ds_read_b64_tr_b16 a[228:229], v34 offset:36864
    buffer_load_dwordx4 v68, s[28:31], s62 offen offset:3072 sc1 lds
    v_mfma_f32_16x16x32_bf16 v[174:177], a[204:207], a[68:71], v[174:177]
    ds_read_b64_tr_b16 a[230:231], v34 offset:38912
    s_waitcnt lgkmcnt(8)
    v_mfma_f32_16x16x32_bf16 v[154:157], a[208:211], a[64:67], v[154:157]
    s_waitcnt vmcnt(8)
    s_barrier
    s_xor_b32 s37, s37, 1024
    s_load_dword s14, s[28:29], s37
    ds_read_b64_tr_b16 a[200:201], v31 offset:49152
    s_add_u32 m0, s59, 131072
    v_mfma_f32_16x16x32_bf16 v[162:165], a[208:211], a[68:71], v[162:165]
    ds_read_b64_tr_b16 a[202:203], v31 offset:51200
    s_add_u32 s63, s63, 12288
    v_mfma_f32_16x16x32_bf16 v[170:173], a[212:215], a[64:67], v[170:173]
    ds_read_b64_tr_b16 a[204:205], v33 offset:49152
    s_cmp_eq_u32 s63, 86016
    s_cselect_b32 s63, 0, s63
    buffer_load_dwordx4 v80, s[28:31], s63 offen sc1 lds
    v_mfma_f32_16x16x32_bf16 v[178:181], a[212:215], a[68:71], v[178:181]
    ds_read_b64_tr_b16 a[206:207], v33 offset:51200
    s_waitcnt lgkmcnt(8)
    v_mfma_f32_16x16x32_bf16 v[150:153], a[216:219], a[72:75], v[150:153]
    ds_read_b64_tr_b16 a[208:209], v32 offset:49152
    buffer_load_dwordx4 v80, s[28:31], s63 offen offset:1024 sc1 lds
    v_mfma_f32_16x16x32_bf16 v[158:161], a[216:219], a[76:79], v[158:161]
    ds_read_b64_tr_b16 a[210:211], v32 offset:51200
    v_mfma_f32_16x16x32_bf16 v[166:169], a[220:223], a[72:75], v[166:169]
    ds_read_b64_tr_b16 a[212:213], v34 offset:49152
    v_mfma_f32_16x16x32_bf16 v[174:177], a[220:223], a[76:79], v[174:177]
    ds_read_b64_tr_b16 a[214:215], v34 offset:51200
    s_waitcnt lgkmcnt(8)
    v_mfma_f32_16x16x32_bf16 v[154:157], a[224:227], a[72:75], v[154:157]
    ds_read_b64_tr_b16 a[216:217], v31 offset:53248
    buffer_load_dwordx4 v80, s[28:31], s63 offen offset:2048 sc1 lds
    v_mfma_f32_16x16x32_bf16 v[162:165], a[224:227], a[76:79], v[162:165]
    ds_read_b64_tr_b16 a[218:219], v31 offset:55296
    s_add_u32 m0, s100, 159744
    v_mfma_f32_16x16x32_bf16 v[170:173], a[228:231], a[72:75], v[170:173]
    ds_read_b64_tr_b16 a[220:221], v33 offset:53248
    s_add_u32 s62, s62, 262144
    v_mfma_f32_16x16x32_bf16 v[178:181], a[228:231], a[76:79], v[178:181]
    ds_read_b64_tr_b16 a[222:223], v33 offset:55296
    s_waitcnt lgkmcnt(8)
    v_mfma_f32_16x16x32_bf16 v[150:153], a[200:203], a[80:83], v[150:153]
    ds_read_b64_tr_b16 a[224:225], v32 offset:53248
    s_cmp_eq_u32 s62, 1835008
    v_mfma_f32_16x16x32_bf16 v[158:161], a[200:203], a[84:87], v[158:161]
    ds_read_b64_tr_b16 a[226:227], v32 offset:55296
    s_cselect_b32 s62, 0, s62
    buffer_load_dwordx4 v69, s[28:31], s62 offen sc1 lds
    v_mfma_f32_16x16x32_bf16 v[166:169], a[204:207], a[80:83], v[166:169]
    ds_read_b64_tr_b16 a[228:229], v34 offset:53248
    s_add_u32 m0, s58, 143360
    v_mfma_f32_16x16x32_bf16 v[174:177], a[204:207], a[84:87], v[174:177]
    ds_read_b64_tr_b16 a[230:231], v34 offset:55296
    s_waitcnt lgkmcnt(8)
    v_mfma_f32_16x16x32_bf16 v[154:157], a[208:211], a[80:83], v[154:157]
    s_barrier
    ds_read_b64_tr_b16 a[200:201], v37 offset:0
    buffer_load_dwordx4 v67, s[28:31], s62 offen sc1 lds
    v_mfma_f32_16x16x32_bf16 v[162:165], a[208:211], a[84:87], v[162:165]
    ds_read_b64_tr_b16 a[202:203], v37 offset:2048
    v_mfma_f32_16x16x32_bf16 v[170:173], a[212:215], a[80:83], v[170:173]
    ds_read_b64_tr_b16 a[204:205], v38 offset:0
    buffer_load_dwordx4 v67, s[28:31], s62 offen offset:1024 sc1 lds
    v_mfma_f32_16x16x32_bf16 v[178:181], a[212:215], a[84:87], v[178:181]
    ds_read_b64_tr_b16 a[206:207], v38 offset:2048
    s_waitcnt lgkmcnt(8)
    v_mfma_f32_16x16x32_bf16 v[150:153], a[216:219], a[88:91], v[150:153]
    ds_read_b64_tr_b16 a[208:209], v37 offset:4096
    v_mfma_f32_16x16x32_bf16 v[158:161], a[216:219], a[92:95], v[158:161]
    ds_read_b64_tr_b16 a[210:211], v37 offset:6144
    v_mfma_f32_16x16x32_bf16 v[166:169], a[220:223], a[88:91], v[166:169]
    ds_read_b64_tr_b16 a[212:213], v38 offset:4096
    buffer_load_dwordx4 v68, s[28:31], s62 offen offset:2048 sc1 lds
    v_mfma_f32_16x16x32_bf16 v[174:177], a[220:223], a[92:95], v[174:177]
    ds_read_b64_tr_b16 a[214:215], v38 offset:6144
    s_waitcnt lgkmcnt(8)
    v_mfma_f32_16x16x32_bf16 v[154:157], a[224:227], a[88:91], v[154:157]
    ds_read_b64_tr_b16 a[216:217], v37 offset:16384
    v_mfma_f32_16x16x32_bf16 v[162:165], a[224:227], a[92:95], v[162:165]
    ds_read_b64_tr_b16 a[218:219], v37 offset:18432
    buffer_load_dwordx4 v68, s[28:31], s62 offen offset:3072 sc1 lds
    v_mfma_f32_16x16x32_bf16 v[170:173], a[228:231], a[88:91], v[170:173]
    ds_read_b64_tr_b16 a[220:221], v38 offset:16384
    s_add_u32 m0, s59, 0
    v_mfma_f32_16x16x32_bf16 v[178:181], a[228:231], a[92:95], v[178:181]
    ds_read_b64_tr_b16 a[222:223], v38 offset:18432
    s_waitcnt lgkmcnt(8)
    v_mfma_f32_16x16x32_bf16 v[166:169], a[200:203], a[96:99], v[166:169]
    s_waitcnt lgkmcnt(0)
    s_cmp_ge_u32 s14, 2
    s_cbranch_scc0 L_pollin2
L_pollok2:
    v_xor_b32 v23, 131072, v23
    v_xor_b32 v22, 8192, v23
    ds_read_b64_tr_b16 a[224:225], v37 offset:20480
    buffer_load_dwordx4 v[214:217], v23, s[28:31], 0 offen offset:0 sc1
    v_mfma_f32_16x16x32_bf16 v[174:177], a[200:203], a[100:103], v[174:177]
    ds_read_b64_tr_b16 a[226:227], v37 offset:22528
    v_mfma_f32_16x16x32_bf16 v[170:173], a[204:207], a[96:99], v[170:173]
    ds_read_b64_tr_b16 a[228:229], v38 offset:20480
    buffer_load_dwordx4 v[218:221], v23, s[28:31], 0 offen offset:1024 sc1
    v_mfma_f32_16x16x32_bf16 v[178:181], a[204:207], a[100:103], v[178:181]
    ds_read_b64_tr_b16 a[230:231], v38 offset:22528
    v_mfma_f32_16x16x32_bf16 v[166:169], a[208:211], a[104:107], v[166:169]
    ds_read_b64_tr_b16 a[200:201], v35 offset:0
    buffer_load_dwordx4 v[222:225], v22, s[28:31], 0 offen offset:2048 sc1
    v_mfma_f32_16x16x32_bf16 v[174:177], a[208:211], a[108:111], v[174:177]
    ds_read_b64_tr_b16 a[202:203], v35 offset:2048
    v_mfma_f32_16x16x32_bf16 v[170:173], a[212:215], a[104:107], v[170:173]
    ds_read_b64_tr_b16 a[204:205], v36 offset:0
    buffer_load_dwordx4 v[226:229], v22, s[28:31], 0 offen offset:3072 sc1
    v_mfma_f32_16x16x32_bf16 v[178:181], a[212:215], a[108:111], v[178:181]
    ds_read_b64_tr_b16 a[206:207], v36 offset:2048
    v_mfma_f32_16x16x32_bf16 v[166:169], a[216:219], a[112:115], v[166:169]
    ds_read_b64_tr_b16 a[208:209], v35 offset:4096
    s_add_u32 s63, s63, 12288
    v_mfma_f32_16x16x32_bf16 v[174:177], a[216:219], a[116:119], v[174:177]
    ds_read_b64_tr_b16 a[210:211], v35 offset:6144
    s_cmp_eq_u32 s63, 86016
    s_cselect_b32 s63, 0, s63
    buffer_load_dwordx4 v80, s[28:31], s63 offen sc1 lds
    v_mfma_f32_16x16x32_bf16 v[170:173], a[220:223], a[112:115], v[170:173]
    ds_read_b64_tr_b16 a[212:213], v36 offset:4096
    v_mfma_f32_16x16x32_bf16 v[178:181], a[220:223], a[116:119], v[178:181]
    ds_read_b64_tr_b16 a[214:215], v36 offset:6144
    s_waitcnt lgkmcnt(8)
    v_mfma_f32_16x16x32_bf16 v[166:169], a[224:227], a[120:123], v[166:169]
    ds_read_b64_tr_b16 a[216:217], v35 offset:16384
    buffer_load_dwordx4 v80, s[28:31], s63 offen offset:1024 sc1 lds
    v_mfma_f32_16x16x32_bf16 v[174:177], a[224:227], a[124:127], v[174:177]
    ds_read_b64_tr_b16 a[218:219], v35 offset:18432
    v_mfma_f32_16x16x32_bf16 v[170:173], a[228:231], a[120:123], v[170:173]
    ds_read_b64_tr_b16 a[220:221], v36 offset:16384
    v_mfma_f32_16x16x32_bf16 v[178:181], a[228:231], a[124:127], v[178:181]
    ds_read_b64_tr_b16 a[222:223], v36 offset:18432
    s_waitcnt lgkmcnt(8)
    v_mfma_f32_16x16x32_bf16 v[150:153], a[200:203], a[96:99], v[150:153]
    ds_read_b64_tr_b16 a[224:225], v35 offset:20480
    buffer_load_dwordx4 v80, s[28:31], s63 offen offset:2048 sc1 lds
    v_mfma_f32_16x16x32_bf16 v[158:161], a[200:203], a[100:103], v[158:161]
    ds_read_b64_tr_b16 a[226:227], v35 offset:22528
    s_add_u32 m0, s100, 28672
    v_mfma_f32_16x16x32_bf16 v[154:157], a[204:207], a[96:99], v[154:157]
    ds_read_b64_tr_b16 a[228:229], v36 offset:20480
    s_add_u32 s62, s62, 262144
    v_mfma_f32_16x16x32_bf16 v[162:165], a[204:207], a[100:103], v[162:165]
    ds_read_b64_tr_b16 a[230:231], v36 offset:22528
    ds_write_b128 v81, v[166:169] offset:32768
    s_waitcnt lgkmcnt(9)
    v_mfma_f32_16x16x32_bf16 v[150:153], a[208:211], a[104:107], v[150:153]
    s_cmp_eq_u32 s62, 1835008
    s_cselect_b32 s62, 0, s62
    buffer_load_dwordx4 v69, s[28:31], s62 offen sc1 lds
    v_mfma_f32_16x16x32_bf16 v[158:161], a[208:211], a[108:111], v[158:161]
    s_add_u32 m0, s58, 12288
    ds_write_b128 v81, v[170:173] offset:33792
    v_mfma_f32_16x16x32_bf16 v[154:157], a[212:215], a[104:107], v[154:157]
    buffer_load_dwordx4 v67, s[28:31], s62 offen sc1 lds
    ds_write_b128 v81, v[174:177] offset:34816
    v_mfma_f32_16x16x32_bf16 v[162:165], a[212:215], a[108:111], v[162:165]
    s_waitcnt lgkmcnt(7)
    v_mfma_f32_16x16x32_bf16 v[150:153], a[216:219], a[112:115], v[150:153]
    ds_write_b128 v81, v[178:181] offset:35840
    v_mfma_f32_16x16x32_bf16 v[158:161], a[216:219], a[116:119], v[158:161]
    v_mfma_f32_16x16x32_bf16 v[154:157], a[220:223], a[112:115], v[154:157]
    buffer_load_dwordx4 v67, s[28:31], s62 offen offset:1024 sc1 lds
    v_mfma_f32_16x16x32_bf16 v[162:165], a[220:223], a[116:119], v[162:165]
    s_waitcnt lgkmcnt(4)
    v_mfma_f32_16x16x32_bf16 v[150:153], a[224:227], a[120:123], v[150:153]
    v_mfma_f32_16x16x32_bf16 v[158:161], a[224:227], a[124:127], v[158:161]
    buffer_load_dwordx4 v68, s[28:31], s62 offen offset:2048 sc1 lds
    v_mfma_f32_16x16x32_bf16 v[154:157], a[228:231], a[120:123], v[154:157]
    v_mfma_f32_16x16x32_bf16 v[162:165], a[228:231], a[124:127], v[162:165]
    s_waitcnt vmcnt(10)
    v_mfma_f32_16x16x32_bf16 v[150:153], a[250:253], v[214:217], v[150:153]
    v_xor_b32 v81, 8192, v81
    s_waitcnt lgkmcnt(0)
    s_barrier
    ds_read_b128 v[182:185], v81 offset:32768
    ds_read_b128 v[186:189], v81 offset:33792
    ds_read_b128 v[190:193], v81 offset:34816
    ds_read_b128 v[194:197], v81 offset:35840
    v_mfma_f32_16x16x32_bf16 v[154:157], a[248:251], v[214:217], v[154:157]
    buffer_load_dwordx4 v68, s[28:31], s62 offen offset:3072 sc1 lds
    s_add_u32 m0, s59, 65536
    s_waitcnt vmcnt(10)
    v_mfma_f32_16x16x32_bf16 v[158:161], a[250:253], v[218:221], v[158:161]
    s_add_u32 s63, s63, 12288
    s_cmp_eq_u32 s63, 86016
    v_mfma_f32_16x16x32_bf16 v[162:165], a[248:251], v[218:221], v[162:165]
L_pad1:
    s_cbranch_execz L_warm
    s_cselect_b32 s63, 0, s63
    s_waitcnt vmcnt(9)
    v_mfma_f32_16x16x32_bf16 v[150:153], a[250:253], v[222:225], v[150:153]
    buffer_load_dwordx4 v80, s[28:31], s63 offen sc1 lds
    v_mfma_f32_16x16x32_bf16 v[154:157], a[248:251], v[222:225], v[154:157]
    s_waitcnt vmcnt(9)
    v_mfma_f32_16x16x32_bf16 v[158:161], a[250:253], v[226:229], v[158:161]
    v_mfma_f32_16x16x32_bf16 v[162:165], a[248:251], v[226:229], v[162:165]
    buffer_load_dwordx4 v80, s[28:31], s63 offen offset:1024 sc1 lds
    s_waitcnt lgkmcnt(3)
    s_nop 0
    v_pk_add_f32 v[150:151], v[150:151], v[182:183]
    v_pk_add_f32 v[152:153], v[152:153], v[184:185]
    s_waitcnt lgkmcnt(2)
    v_pk_add_f32 v[154:155], v[154:155], v[186:187]
    v_pk_add_f32 v[156:157], v[156:157], v[188:189]
    v_pk_mul_f32 v[182:183], v[150:151], v[150:151]
    v_pk_mul_f32 v[184:185], v[152:153], v[152:153]
    v_pk_mul_f32 v[186:187], v[154:155], v[154:155]
    v_pk_mul_f32 v[188:189], v[156:157], v[156:157]
    v_pk_fma_f32 v[182:183], v[182:183], s[78:79], v[108:109]
    v_pk_fma_f32 v[184:185], v[184:185], s[78:79], v[108:109]
    v_pk_fma_f32 v[186:187], v[186:187], s[78:79], v[108:109]
    v_pk_fma_f32 v[188:189], v[188:189], s[78:79], v[108:109]
    v_pk_mul_f32 v[182:183], v[182:183], v[150:151]
    buffer_load_dwordx4 v80, s[28:31], s63 offen offset:2048 sc1 lds
    v_pk_mul_f32 v[184:185], v[184:185], v[152:153]
    v_pk_mul_f32 v[186:187], v[186:187], v[154:155]
    v_pk_mul_f32 v[188:189], v[188:189], v[156:157]
    v_exp_f32 v182, v182
    v_exp_f32 v183, v183
    v_exp_f32 v184, v184
    v_exp_f32 v185, v185
    v_exp_f32 v186, v186
    v_exp_f32 v187, v187
    s_add_u32 m0, s100, 94208
    s_add_u32 s62, s62, 262144
    s_cmp_eq_u32 s62, 1835008
    s_cselect_b32 s62, 0, s62
    buffer_load_dwordx4 v69, s[28:31], s62 offen sc1 lds
    v_exp_f32 v188, v188
    v_exp_f32 v189, v189
    v_pk_add_f32 v[182:183], v[182:183], s[80:81]
    v_pk_add_f32 v[184:185], v[184:185], s[80:81]
    v_pk_add_f32 v[186:187], v[186:187], s[80:81]
    v_pk_add_f32 v[188:189], v[188:189], s[80:81]
    v_rcp_f32 v182, v182
    v_rcp_f32 v183, v183
    v_rcp_f32 v184, v184
    s_add_u32 m0, s58, 77824
    s_nop 0
    buffer_load_dwordx4 v67, s[28:31], s62 offen sc1 lds
    v_rcp_f32 v185, v185
    v_rcp_f32 v186, v186
    v_rcp_f32 v187, v187
    v_rcp_f32 v188, v188
    v_rcp_f32 v189, v189
    v_pk_mul_f32 v[182:183], v[182:183], v[150:151]
    v_pk_mul_f32 v[184:185], v[184:185], v[152:153]
    v_pk_mul_f32 v[186:187], v[186:187], v[154:155]
    buffer_load_dwordx4 v67, s[28:31], s62 offen offset:1024 sc1 lds
    v_pk_mul_f32 v[188:189], v[188:189], v[156:157]
    v_cvt_pk_bf16_f32 v110, v182, v183
    v_cvt_pk_bf16_f32 v111, v184, v185
    v_cvt_pk_bf16_f32 v112, v186, v187
    v_cvt_pk_bf16_f32 v113, v188, v189
    s_waitcnt lgkmcnt(1)
    v_pk_add_f32 v[158:159], v[158:159], v[190:191]
    v_pk_add_f32 v[160:161], v[160:161], v[192:193]
    s_waitcnt lgkmcnt(0)
    v_pk_add_f32 v[162:163], v[162:163], v[194:195]
    v_pk_add_f32 v[164:165], v[164:165], v[196:197]
    v_pk_mul_f32 v[190:191], v[158:159], v[158:159]
    v_pk_mul_f32 v[192:193], v[160:161], v[160:161]
    v_pk_mul_f32 v[194:195], v[162:163], v[162:163]
    v_pk_mul_f32 v[196:197], v[164:165], v[164:165]
    v_pk_fma_f32 v[190:191], v[190:191], s[78:79], v[108:109]
    buffer_load_dwordx4 v68, s[28:31], s62 offen offset:2048 sc1 lds
    v_pk_fma_f32 v[192:193], v[192:193], s[78:79], v[108:109]
    v_pk_fma_f32 v[194:195], v[194:195], s[78:79], v[108:109]
    v_pk_fma_f32 v[196:197], v[196:197], s[78:79], v[108:109]
    v_pk_mul_f32 v[190:191], v[190:191], v[158:159]
    v_pk_mul_f32 v[192:193], v[192:193], v[160:161]
    v_pk_mul_f32 v[194:195], v[194:195], v[162:163]
    v_pk_mul_f32 v[196:197], v[196:197], v[164:165]
    v_exp_f32 v190, v190
    v_exp_f32 v191, v191
    v_exp_f32 v192, v192
    v_exp_f32 v193, v193
    buffer_load_dwordx4 v68, s[28:31], s62 offen offset:3072 sc1 lds
    v_exp_f32 v194, v194
    v_exp_f32 v195, v195
    v_exp_f32 v196, v196
    v_exp_f32 v197, v197
    v_pk_add_f32 v[190:191], v[190:191], s[80:81]
    v_pk_add_f32 v[192:193], v[192:193], s[80:81]
    v_pk_add_f32 v[194:195], v[194:195], s[80:81]
    v_pk_add_f32 v[196:197], v[196:197], s[80:81]
    v_rcp_f32 v190, v190
    v_rcp_f32 v191, v191
    v_rcp_f32 v192, v192
    v_rcp_f32 v193, v193
    v_rcp_f32 v194, v194
    v_rcp_f32 v195, v195
    v_rcp_f32 v196, v196
    v_rcp_f32 v197, v197
    v_pk_mul_f32 v[190:191], v[190:191], v[158:159]
    v_pk_mul_f32 v[192:193], v[192:193], v[160:161]
    v_pk_mul_f32 v[194:195], v[194:195], v[162:163]
    v_pk_mul_f32 v[196:197], v[196:197], v[164:165]
    v_cvt_pk_bf16_f32 v114, v190, v191
    v_cvt_pk_bf16_f32 v115, v192, v193
    v_cvt_pk_bf16_f32 v116, v194, v195
    v_cvt_pk_bf16_f32 v117, v196, v197
    ds_read_b64_tr_b16 a[180:181], v72 offset:32768
    ds_read_b64_tr_b16 a[182:183], v72 offset:33024
    ds_read_b128 a[128:131], v53 offset:32768
    ds_read_b64_tr_b16 a[184:185], v72 offset:33792
    ds_read_b64_tr_b16 a[186:187], v72 offset:34048
    ds_read_b128 a[132:135], v53 offset:33792
    ds_read_b128 a[136:139], v53 offset:34816
    ds_read_b64_tr_b16 a[176:177], v73 offset:32768
    ds_read_b64_tr_b16 a[178:179], v73 offset:33024
    ds_read_b128 a[140:143], v53 offset:35840
    ds_read_b128 a[144:147], v53 offset:36864
    ds_read_b128 a[148:151], v53 offset:37888
    buffer_store_dwordx4 v[110:113], v4, s[28:31], s67 offen offset:0 sc1
    buffer_store_dwordx4 v[114:117], v4, s[28:31], s67 offen offset:1024 sc1
L_q:
    s_waitcnt lgkmcnt(6)
    v_mfma_f32_16x16x32_bf16 v[182:185], a[128:131], a[180:183], 0
    ds_read_b64_tr_b16 a[192:193], v72 offset:34816
    v_mfma_f32_16x16x32_bf16 v[190:193], a[128:131], a[184:187], 0
    ds_read_b64_tr_b16 a[194:195], v72 offset:35072
    v_mfma_f32_16x16x32_bf16 v[186:189], a[132:135], a[180:183], 0
    ds_read_b128 a[152:155], v53 offset:38912
    v_mfma_f32_16x16x32_bf16 v[194:197], a[132:135], a[184:187], 0
    ds_read_b64_tr_b16 a[196:197], v72 offset:35840
    s_waitcnt lgkmcnt(4)
    v_mfma_f32_16x16x32_bf16 v[206:209], a[136:139], a[180:183], 0
    ds_read_b64_tr_b16 a[198:199], v72 offset:36096
    v_mfma_f32_16x16x32_bf16 v[214:217], a[136:139], a[184:187], 0
    ds_read_b128 a[156:159], v53 offset:39936
    v_mfma_f32_16x16x32_bf16 v[198:201], a[136:139], a[176:179], 0
    ds_read_b128 a[160:163], v53 offset:40960
    v_mfma_f32_16x16x32_bf16 v[210:213], a[140:143], a[180:183], 0
    ds_read_b64_tr_b16 a[188:189], v73 offset:34816
    v_mfma_f32_16x16x32_bf16 v[218:221], a[140:143], a[184:187], 0
    ds_read_b64_tr_b16 a[190:191], v73 offset:35072
    v_mfma_f32_16x16x32_bf16 v[202:205], a[140:143], a[176:179], 0
    ds_read_b128 a[164:167], v53 offset:41984
    v_mfma_f32_16x16x32_bf16 v[230:233], a[180:183], a[144:147], 0
    ds_read_b128 a[168:171], v53 offset:43008
    v_mfma_f32_16x16x32_bf16 v[238:241], a[184:187], a[144:147], 0
    ds_read_b128 a[172:175], v53 offset:44032
    v_mfma_f32_16x16x32_bf16 v[222:225], a[176:179], a[144:147], 0
    v_mfma_f32_16x16x32_bf16 v[234:237], a[180:183], a[148:151], 0
    v_mfma_f32_16x16x32_bf16 v[242:245], a[184:187], a[148:151], 0
    v_mfma_f32_16x16x32_bf16 v[226:229], a[176:179], a[148:151], 0
    s_waitcnt lgkmcnt(0)
    s_barrier
    v_mfma_f32_16x16x32_bf16 v[182:185], a[152:155], a[192:195], v[182:185]
    ds_read_b64_tr_b16 a[180:181], v74 offset:0
    s_add_u32 m0, s59, 32768
    v_mfma_f32_16x16x32_bf16 v[190:193], a[152:155], a[196:199], v[190:193]
    ds_read_b64_tr_b16 a[182:183], v74 offset:256
    s_add_u32 s63, s63, 12288
    v_mfma_f32_16x16x32_bf16 v[186:189], a[156:159], a[192:195], v[186:189]
    ds_read_b128 a[128:131], v54 offset:0
    s_cmp_eq_u32 s63, 86016
    v_mfma_f32_16x16x32_bf16 v[194:197], a[156:159], a[196:199], v[194:197]
    ds_read_b64_tr_b16 a[184:185], v74 offset:1024
    v_mfma_f32_16x16x32_bf16 v[206:209], a[160:163], a[192:195], v[206:209]
    ds_read_b64_tr_b16 a[186:187], v74 offset:1280
    s_cselect_b32 s63, 0, s63
    v_mfma_f32_16x16x32_bf16 v[214:217], a[160:163], a[196:199], v[214:217]
    ds_read_b128 a[132:135], v54 offset:1024
    buffer_load_dwordx4 v80, s[28:31], s63 offen sc1 lds
    v_mfma_f32_16x16x32_bf16 v[198:201], a[160:163], a[188:191], v[198:201]
    ds_read_b128 a[136:139], v54 offset:2048
    v_mfma_f32_16x16x32_bf16 v[210:213], a[164:167], a[192:195], v[210:213]
    ds_read_b64_tr_b16 a[176:177], v75 offset:0
    buffer_load_dwordx4 v80, s[28:31], s63 offen offset:1024 sc1 lds
    v_mfma_f32_16x16x32_bf16 v[218:221], a[164:167], a[196:199], v[218:221]
    ds_read_b64_tr_b16 a[178:179], v75 offset:256
    v_mfma_f32_16x16x32_bf16 v[202:205], a[164:167], a[188:191], v[202:205]
    ds_read_b128 a[140:143], v54 offset:3072
    v_mfma_f32_16x16x32_bf16 v[230:233], a[192:195], a[168:171], v[230:233]
    ds_read_b128 a[144:147], v54 offset:4096
    buffer_load_dwordx4 v80, s[28:31], s63 offen offset:2048 sc1 lds
    v_mfma_f32_16x16x32_bf16 v[238:241], a[196:199], a[168:171], v[238:241]
    ds_read_b128 a[148:151], v54 offset:5120
    s_add_u32 m0, s100, 61440
    v_mfma_f32_16x16x32_bf16 v[222:225], a[188:191], a[168:171], v[222:225]
    s_add_u32 s62, s62, 262144
    s_cmp_eq_u32 s62, 1835008
    v_mfma_f32_16x16x32_bf16 v[234:237], a[192:195], a[172:175], v[234:237]
    s_cselect_b32 s62, 0, s62
    buffer_load_dwordx4 v69, s[28:31], s62 offen sc1 lds
    v_mfma_f32_16x16x32_bf16 v[242:245], a[196:199], a[172:175], v[242:245]
    s_add_u32 m0, s58, 45056
    v_mfma_f32_16x16x32_bf16 v[226:229], a[188:191], a[172:175], v[226:229]
    s_waitcnt lgkmcnt(6)
    v_mfma_f32_16x16x32_bf16 v[182:185], a[128:131], a[180:183], v[182:185]
    ds_read_b64_tr_b16 a[192:193], v74 offset:2048
    buffer_load_dwordx4 v67, s[28:31], s62 offen sc1 lds
    v_mfma_f32_16x16x32_bf16 v[190:193], a[128:131], a[184:187], v[190:193]
    ds_read_b64_tr_b16 a[194:195], v74 offset:2304
    v_mfma_f32_16x16x32_bf16 v[186:189], a[132:135], a[180:183], v[186:189]
    ds_read_b128 a[152:155], v54 offset:6144
    v_mfma_f32_16x16x32_bf16 v[194:197], a[132:135], a[184:187], v[194:197]
    ds_read_b64_tr_b16 a[196:197], v74 offset:3072
    s_waitcnt lgkmcnt(4)
    v_mfma_f32_16x16x32_bf16 v[206:209], a[136:139], a[180:183], v[206:209]
    ds_read_b64_tr_b16 a[198:199], v74 offset:3328
    buffer_load_dwordx4 v67, s[28:31], s62 offen offset:1024 sc1 lds
    v_mfma_f32_16x16x32_bf16 v[214:217], a[136:139], a[184:187], v[214:217]
    ds_read_b128 a[156:159], v54 offset:7168
    v_mfma_f32_16x16x32_bf16 v[198:201], a[136:139], a[176:179], v[198:201]
    ds_read_b128 a[160:163], v54 offset:8192
    buffer_load_dwordx4 v68, s[28:31], s62 offen offset:2048 sc1 lds
    v_mfma_f32_16x16x32_bf16 v[210:213], a[140:143], a[180:183], v[210:213]
    ds_read_b64_tr_b16 a[188:189], v75 offset:2048
    v_mfma_f32_16x16x32_bf16 v[218:221], a[140:143], a[184:187], v[218:221]
    ds_read_b64_tr_b16 a[190:191], v75 offset:2304
    v_mfma_f32_16x16x32_bf16 v[202:205], a[140:143], a[176:179], v[202:205]
    ds_read_b128 a[164:167], v54 offset:9216
    buffer_load_dwordx4 v68, s[28:31], s62 offen offset:3072 sc1 lds
    v_mfma_f32_16x16x32_bf16 v[230:233], a[180:183], a[144:147], v[230:233]
    ds_read_b128 a[168:171], v54 offset:10240
    s_add_u32 m0, s59, 98304
    v_mfma_f32_16x16x32_bf16 v[238:241], a[184:187], a[144:147], v[238:241]
    ds_read_b128 a[172:175], v54 offset:11264
    s_add_u32 s63, s63, 12288
    v_mfma_f32_16x16x32_bf16 v[222:225], a[176:179], a[144:147], v[222:225]
    s_cmp_eq_u32 s63, 86016
    s_cselect_b32 s63, 0, s63
    v_mfma_f32_16x16x32_bf16 v[234:237], a[180:183], a[148:151], v[234:237]
    buffer_load_dwordx4 v80, s[28:31], s63 offen sc1 lds
    v_mfma_f32_16x16x32_bf16 v[242:245], a[184:187], a[148:151], v[242:245]
    v_mfma_f32_16x16x32_bf16 v[226:229], a[176:179], a[148:151], v[226:229]
    s_waitcnt vmcnt(9) lgkmcnt(0)
    s_barrier
    s_cmp_lg_u32 s48, 0
    s_cbranch_scc1 L_sig2
    s_atomic_add s36, s[28:29], s68
L_sig2:
    v_mfma_f32_16x16x32_bf16 v[182:185], a[152:155], a[192:195], v[182:185]
    ds_read_b64_tr_b16 a[180:181], v70 offset:0
    buffer_load_dwordx4 v80, s[28:31], s63 offen offset:1024 sc1 lds
    v_mfma_f32_16x16x32_bf16 v[190:193], a[152:155], a[196:199], v[190:193]
    ds_read_b64_tr_b16 a[182:183], v70 offset:256
    v_mfma_f32_16x16x32_bf16 v[186:189], a[156:159], a[192:195], v[186:189]
    ds_read_b128 a[128:131], v4 offset:0
    buffer_load_dwordx4 v80, s[28:31], s63 offen offset:2048 sc1 lds
    v_mfma_f32_16x16x32_bf16 v[194:197], a[156:159], a[196:199], v[194:197]
    ds_read_b64_tr_b16 a[184:185], v70 offset:1024
    v_mfma_f32_16x16x32_bf16 v[206:209], a[160:163], a[192:195], v[206:209]
    ds_read_b64_tr_b16 a[186:187], v70 offset:1280
    s_add_u32 m0, s100, 126976
    v_mfma_f32_16x16x32_bf16 v[214:217], a[160:163], a[196:199], v[214:217]
    ds_read_b128 a[132:135], v4 offset:1024
    s_add_u32 s62, s62, 262144
    v_mfma_f32_16x16x32_bf16 v[198:201], a[160:163], a[188:191], v[198:201]
    ds_read_b128 a[136:139], v4 offset:2048
    s_cmp_eq_u32 s62, 1835008
    v_mfma_f32_16x16x32_bf16 v[210:213], a[164:167], a[192:195], v[210:213]
    ds_read_b64_tr_b16 a[176:177], v71 offset:0
    s_cselect_b32 s62, 0, s62
    v_mfma_f32_16x16x32_bf16 v[218:221], a[164:167], a[196:199], v[218:221]
    ds_read_b64_tr_b16 a[178:179], v71 offset:256
    buffer_load_dwordx4 v69, s[28:31], s62 offen sc1 lds
    v_mfma_f32_16x16x32_bf16 v[202:205], a[164:167], a[188:191], v[202:205]
    ds_read_b128 a[140:143], v4 offset:3072
    s_add_u32 m0, s58, 110592
    v_mfma_f32_16x16x32_bf16 v[230:233], a[192:195], a[168:171], v[230:233]
    ds_read_b128 a[144:147], v4 offset:4096
    buffer_load_dwordx4 v67, s[28:31], s62 offen sc1 lds
    v_mfma_f32_16x16x32_bf16 v[238:241], a[196:199], a[168:171], v[238:241]
    ds_read_b128 a[148:151], v4 offset:5120
    v_mfma_f32_16x16x32_bf16 v[222:225], a[188:191], a[168:171], v[222:225]
    v_mfma_f32_16x16x32_bf16 v[234:237], a[192:195], a[172:175], v[234:237]
    buffer_load_dwordx4 v67, s[28:31], s62 offen offset:1024 sc1 lds
    v_mfma_f32_16x16x32_bf16 v[242:245], a[196:199], a[172:175], v[242:245]
    v_mfma_f32_16x16x32_bf16 v[226:229], a[188:191], a[172:175], v[226:229]
    s_waitcnt lgkmcnt(6)
    v_mfma_f32_16x16x32_bf16 v[182:185], a[128:131], a[180:183], v[182:185]
    ds_read_b64_tr_b16 a[192:193], v70 offset:2048
    buffer_load_dwordx4 v68, s[28:31], s62 offen offset:2048 sc1 lds
    v_mfma_f32_16x16x32_bf16 v[190:193], a[128:131], a[184:187], v[190:193]
    ds_read_b64_tr_b16 a[194:195], v70 offset:2304
    v_mfma_f32_16x16x32_bf16 v[186:189], a[132:135], a[180:183], v[186:189]
    ds_read_b128 a[152:155], v4 offset:6144
    v_mfma_f32_16x16x32_bf16 v[194:197], a[132:135], a[184:187], v[194:197]
    ds_read_b64_tr_b16 a[196:197], v70 offset:3072
    s_waitcnt lgkmcnt(4)
    v_mfma_f32_16x16x32_bf16 v[206:209], a[136:139], a[180:183], v[206:209]
    ds_read_b64_tr_b16 a[198:199], v70 offset:3328
    buffer_load_dwordx4 v68, s[28:31], s62 offen offset:3072 sc1 lds
    v_mfma_f32_16x16x32_bf16 v[214:217], a[136:139], a[184:187], v[214:217]
    ds_read_b128 a[156:159], v4 offset:7168
    s_add_u32 m0, s59, 131072
    v_mfma_f32_16x16x32_bf16 v[198:201], a[136:139], a[176:179], v[198:201]
    ds_read_b128 a[160:163], v4 offset:8192
    s_add_u32 s63, s63, 12288
    v_mfma_f32_16x16x32_bf16 v[210:213], a[140:143], a[180:183], v[210:213]
    ds_read_b64_tr_b16 a[188:189], v71 offset:2048
    s_cmp_eq_u32 s63, 86016
    v_mfma_f32_16x16x32_bf16 v[218:221], a[140:143], a[184:187], v[218:221]
    ds_read_b64_tr_b16 a[190:191], v71 offset:2304
    s_cselect_b32 s63, 0, s63
    v_mfma_f32_16x16x32_bf16 v[202:205], a[140:143], a[176:179], v[202:205]
    ds_read_b128 a[164:167], v4 offset:9216
    buffer_load_dwordx4 v80, s[28:31], s63 offen sc1 lds
    v_mfma_f32_16x16x32_bf16 v[230:233], a[180:183], a[144:147], v[230:233]
    ds_read_b128 a[168:171], v4 offset:10240
    v_mfma_f32_16x16x32_bf16 v[238:241], a[184:187], a[144:147], v[238:241]
    ds_read_b128 a[172:175], v4 offset:11264
    buffer_load_dwordx4 v80, s[28:31], s63 offen offset:1024 sc1 lds
    v_mfma_f32_16x16x32_bf16 v[222:225], a[176:179], a[144:147], v[222:225]
    v_mfma_f32_16x16x32_bf16 v[234:237], a[180:183], a[148:151], v[234:237]
    v_mfma_f32_16x16x32_bf16 v[242:245], a[184:187], a[148:151], v[242:245]
    buffer_load_dwordx4 v80, s[28:31], s63 offen offset:2048 sc1 lds
    s_add_u32 m0, s100, 159744
    v_mfma_f32_16x16x32_bf16 v[226:229], a[176:179], a[148:151], v[226:229]
    s_add_u32 s62, s62, 262144
    ds_read_b32 v24, v4
    s_waitcnt lgkmcnt(1)
    s_barrier
    v_mfma_f32_16x16x32_bf16 v[182:185], a[152:155], a[192:195], v[182:185]
    ds_read_b64_tr_b16 a[180:181], v72 offset:0
    s_cmp_eq_u32 s62, 1835008
    v_mfma_f32_16x16x32_bf16 v[190:193], a[152:155], a[196:199], v[190:193]
    ds_read_b64_tr_b16 a[182:183], v72 offset:256
    s_cselect_b32 s62, 0, s62
    v_mfma_f32_16x16x32_bf16 v[186:189], a[156:159], a[192:195], v[186:189]
    ds_read_b128 a[128:131], v53 offset:0
    buffer_load_dwordx4 v69, s[28:31], s62 offen sc1 lds
    v_mfma_f32_16x16x32_bf16 v[194:197], a[156:159], a[196:199], v[194:197]
    ds_read_b64_tr_b16 a[184:185], v72 offset:1024
    v_mfma_f32_16x16x32_bf16 v[206:209], a[160:163], a[192:195], v[206:209]
    ds_read_b64_tr_b16 a[186:187], v72 offset:1280
    s_add_u32 m0, s58, 143360
    v_mfma_f32_16x16x32_bf16 v[214:217], a[160:163], a[196:199], v[214:217]
    ds_read_b128 a[132:135], v53 offset:1024
    buffer_load_dwordx4 v67, s[28:31], s62 offen sc1 lds
    v_mfma_f32_16x16x32_bf16 v[198:201], a[160:163], a[188:191], v[198:201]
    ds_read_b128 a[136:139], v53 offset:2048
    v_mfma_f32_16x16x32_bf16 v[210:213], a[164:167], a[192:195], v[210:213]
    ds_read_b64_tr_b16 a[176:177], v73 offset:0
    buffer_load_dwordx4 v67, s[28:31], s62 offen offset:1024 sc1 lds
    v_mfma_f32_16x16x32_bf16 v[218:221], a[164:167], a[196:199], v[218:221]
    ds_read_b64_tr_b16 a[178:179], v73 offset:256
    v_mfma_f32_16x16x32_bf16 v[202:205], a[164:167], a[188:191], v[202:205]
    ds_read_b128 a[140:143], v53 offset:3072
    v_mfma_f32_16x16x32_bf16 v[230:233], a[192:195], a[168:171], v[230:233]
    ds_read_b128 a[144:147], v53 offset:4096
    buffer_load_dwordx4 v68, s[28:31], s62 offen offset:2048 sc1 lds
    v_mfma_f32_16x16x32_bf16 v[238:241], a[196:199], a[168:171], v[238:241]
    ds_read_b128 a[148:151], v53 offset:5120
    v_mfma_f32_16x16x32_bf16 v[222:225], a[188:191], a[168:171], v[222:225]
    v_mfma_f32_16x16x32_bf16 v[234:237], a[192:195], a[172:175], v[234:237]
    buffer_load_dwordx4 v68, s[28:31], s62 offen offset:3072 sc1 lds
    s_add_u32 m0, s58, 0
    v_mfma_f32_16x16x32_bf16 v[242:245], a[196:199], a[172:175], v[242:245]
    v_mfma_f32_16x16x32_bf16 v[226:229], a[188:191], a[172:175], v[226:229]
    s_waitcnt lgkmcnt(6)
    v_mfma_f32_16x16x32_bf16 v[182:185], a[128:131], a[180:183], v[182:185]
    ds_read_b64_tr_b16 a[192:193], v72 offset:2048
    buffer_load_dwordx4 v59, s[24:27], s64 offen lds
    v_mfma_f32_16x16x32_bf16 v[190:193], a[128:131], a[184:187], v[190:193]
    ds_read_b64_tr_b16 a[194:195], v72 offset:2304
    v_mfma_f32_16x16x32_bf16 v[186:189], a[132:135], a[180:183], v[186:189]
    ds_read_b128 a[152:155], v53 offset:6144
    v_mfma_f32_16x16x32_bf16 v[194:197], a[132:135], a[184:187], v[194:197]
    ds_read_b64_tr_b16 a[196:197], v72 offset:3072
    s_waitcnt lgkmcnt(4)
    v_mfma_f32_16x16x32_bf16 v[206:209], a[136:139], a[180:183], v[206:209]
    ds_read_b64_tr_b16 a[198:199], v72 offset:3328
    buffer_load_dwordx4 v60, s[24:27], s64 offen offset:1024 lds
    v_mfma_f32_16x16x32_bf16 v[214:217], a[136:139], a[184:187], v[214:217]
    ds_read_b128 a[156:159], v53 offset:7168
    v_mfma_f32_16x16x32_bf16 v[198:201], a[136:139], a[176:179], v[198:201]
    ds_read_b128 a[160:163], v53 offset:8192
    v_mfma_f32_16x16x32_bf16 v[210:213], a[140:143], a[180:183], v[210:213]
    ds_read_b64_tr_b16 a[188:189], v73 offset:2048
    buffer_load_dwordx4 v61, s[24:27], s64 offen offset:2048 lds
    v_mfma_f32_16x16x32_bf16 v[218:221], a[140:143], a[184:187], v[218:221]
    ds_read_b64_tr_b16 a[190:191], v73 offset:2304
    v_mfma_f32_16x16x32_bf16 v[202:205], a[140:143], a[176:179], v[202:205]
    ds_read_b128 a[164:167], v53 offset:9216
    v_mfma_f32_16x16x32_bf16 v[230:233], a[180:183], a[144:147], v[230:233]
    ds_read_b128 a[168:171], v53 offset:10240
    buffer_load_dwordx4 v62, s[24:27], s64 offen offset:3072 lds
    v_mfma_f32_16x16x32_bf16 v[238:241], a[184:187], a[144:147], v[238:241]
    ds_read_b128 a[172:175], v53 offset:11264
    s_add_u32 m0, s58, 16384
    v_mfma_f32_16x16x32_bf16 v[222:225], a[176:179], a[144:147], v[222:225]
    v_xor_b32 v59, 128, v59
    v_mfma_f32_16x16x32_bf16 v[234:237], a[180:183], a[148:151], v[234:237]
    buffer_load_dwordx4 v59, s[24:27], s64 offen lds
    v_xor_b32 v60, 128, v60
    v_mfma_f32_16x16x32_bf16 v[242:245], a[184:187], a[148:151], v[242:245]
    v_mfma_f32_16x16x32_bf16 v[226:229], a[176:179], a[148:151], v[226:229]
    ds_read_b32 v24, v4
    s_waitcnt vmcnt(21) lgkmcnt(1)
    s_barrier
    v_mfma_f32_16x16x32_bf16 v[182:185], a[152:155], a[192:195], v[182:185]
    ds_read_b64_tr_b16 a[180:181], v70 offset:32768
    buffer_load_dwordx4 v60, s[24:27], s64 offen offset:1024 lds
    v_mfma_f32_16x16x32_bf16 v[190:193], a[152:155], a[196:199], v[190:193]
    ds_read_b64_tr_b16 a[182:183], v70 offset:33024
    v_xor_b32 v61, 128, v61
    v_mfma_f32_16x16x32_bf16 v[186:189], a[156:159], a[192:195], v[186:189]
    ds_read_b128 a[128:131], v4 offset:32768
    v_mfma_f32_16x16x32_bf16 v[194:197], a[156:159], a[196:199], v[194:197]
    ds_read_b64_tr_b16 a[184:185], v70 offset:33792
    v_mfma_f32_16x16x32_bf16 v[206:209], a[160:163], a[192:195], v[206:209]
    ds_read_b64_tr_b16 a[186:187], v70 offset:34048
    buffer_load_dwordx4 v61, s[24:27], s64 offen offset:2048 lds
    v_mfma_f32_16x16x32_bf16 v[214:217], a[160:163], a[196:199], v[214:217]
    ds_read_b128 a[132:135], v4 offset:33792
    v_xor_b32 v62, 128, v62
    v_mfma_f32_16x16x32_bf16 v[198:201], a[160:163], a[188:191], v[198:201]
    ds_read_b128 a[136:139], v4 offset:34816
    buffer_load_dwordx4 v62, s[24:27], s64 offen offset:3072 lds
    v_mfma_f32_16x16x32_bf16 v[210:213], a[164:167], a[192:195], v[210:213]
    ds_read_b64_tr_b16 a[176:177], v71 offset:32768
    s_add_u32 m0, s58, 65536
    v_mfma_f32_16x16x32_bf16 v[218:221], a[164:167], a[196:199], v[218:221]
    ds_read_b64_tr_b16 a[178:179], v71 offset:33024
    s_add_u32 s64, s64, 524288
    v_mfma_f32_16x16x32_bf16 v[202:205], a[164:167], a[188:191], v[202:205]
    ds_read_b128 a[140:143], v4 offset:35840
    s_cmp_eq_u32 s64, 3670016
    v_mfma_f32_16x16x32_bf16 v[230:233], a[192:195], a[168:171], v[230:233]
    ds_read_b128 a[144:147], v4 offset:36864
    s_cselect_b32 s64, 0, s64
    v_mfma_f32_16x16x32_bf16 v[238:241], a[196:199], a[168:171], v[238:241]
    ds_read_b128 a[148:151], v4 offset:37888
    buffer_load_dwordx4 v59, s[24:27], s64 offen lds
    v_mfma_f32_16x16x32_bf16 v[222:225], a[188:191], a[168:171], v[222:225]
    v_mfma_f32_16x16x32_bf16 v[234:237], a[192:195], a[172:175], v[234:237]
    buffer_load_dwordx4 v60, s[24:27], s64 offen offset:1024 lds
    v_mfma_f32_16x16x32_bf16 v[242:245], a[196:199], a[172:175], v[242:245]
    v_mfma_f32_16x16x32_bf16 v[226:229], a[188:191], a[172:175], v[226:229]
    s_waitcnt lgkmcnt(6)
    v_mfma_f32_16x16x32_bf16 v[182:185], a[128:131], a[180:183], v[182:185]
    ds_read_b64_tr_b16 a[192:193], v70 offset:34816
    buffer_load_dwordx4 v61, s[24:27], s64 offen offset:2048 lds
    v_mfma_f32_16x16x32_bf16 v[190:193], a[128:131], a[184:187], v[190:193]
    ds_read_b64_tr_b16 a[194:195], v70 offset:35072
    v_mfma_f32_16x16x32_bf16 v[186:189], a[132:135], a[180:183], v[186:189]
    ds_read_b128 a[152:155], v4 offset:38912
    v_mfma_f32_16x16x32_bf16 v[194:197], a[132:135], a[184:187], v[194:197]
    ds_read_b64_tr_b16 a[196:197], v70 offset:35840
    s_waitcnt lgkmcnt(4)
    v_mfma_f32_16x16x32_bf16 v[206:209], a[136:139], a[180:183], v[206:209]
    ds_read_b64_tr_b16 a[198:199], v70 offset:36096
    buffer_load_dwordx4 v62, s[24:27], s64 offen offset:3072 lds
    v_mfma_f32_16x16x32_bf16 v[214:217], a[136:139], a[184:187], v[214:217]
    ds_read_b128 a[156:159], v4 offset:39936
    s_add_u32 m0, s58, 81920
    v_mfma_f32_16x16x32_bf16 v[198:201], a[136:139], a[176:179], v[198:201]
    ds_read_b128 a[160:163], v4 offset:40960
    s_add_u32 s64, s64, 524288
    v_mfma_f32_16x16x32_bf16 v[210:213], a[140:143], a[180:183], v[210:213]
    ds_read_b64_tr_b16 a[188:189], v71 offset:34816
    s_cmp_eq_u32 s64, 3670016
    v_mfma_f32_16x16x32_bf16 v[218:221], a[140:143], a[184:187], v[218:221]
    ds_read_b64_tr_b16 a[190:191], v71 offset:35072
    s_cselect_b32 s64, 0, s64
    v_mfma_f32_16x16x32_bf16 v[202:205], a[140:143], a[176:179], v[202:205]
    ds_read_b128 a[164:167], v4 offset:41984
    buffer_load_dwordx4 v59, s[24:27], s64 offen lds
    v_mfma_f32_16x16x32_bf16 v[230:233], a[180:183], a[144:147], v[230:233]
    ds_read_b128 a[168:171], v4 offset:43008
    v_mfma_f32_16x16x32_bf16 v[238:241], a[184:187], a[144:147], v[238:241]
    ds_read_b128 a[172:175], v4 offset:44032
    buffer_load_dwordx4 v60, s[24:27], s64 offen offset:1024 lds
    v_mfma_f32_16x16x32_bf16 v[222:225], a[176:179], a[144:147], v[222:225]
    v_mfma_f32_16x16x32_bf16 v[234:237], a[180:183], a[148:151], v[234:237]
    v_mfma_f32_16x16x32_bf16 v[242:245], a[184:187], a[148:151], v[242:245]
    buffer_load_dwordx4 v61, s[24:27], s64 offen offset:2048 lds
    v_mfma_f32_16x16x32_bf16 v[226:229], a[176:179], a[148:151], v[226:229]
    ds_read_b32 v24, v4
    s_waitcnt vmcnt(23) lgkmcnt(1)
    s_barrier
    v_mfma_f32_16x16x32_bf16 v[182:185], a[152:155], a[192:195], v[182:185]
    ds_read_b64_tr_b16 a[180:181], v72 offset:32768
    v_mfma_f32_16x16x32_bf16 v[190:193], a[152:155], a[196:199], v[190:193]
    ds_read_b64_tr_b16 a[182:183], v72 offset:33024
    buffer_load_dwordx4 v62, s[24:27], s64 offen offset:3072 lds
    v_mfma_f32_16x16x32_bf16 v[186:189], a[156:159], a[192:195], v[186:189]
    ds_read_b128 a[128:131], v53 offset:32768
    s_add_u32 m0, s58, 32768
    v_mfma_f32_16x16x32_bf16 v[194:197], a[156:159], a[196:199], v[194:197]
    ds_read_b64_tr_b16 a[184:185], v72 offset:33792
    v_mfma_f32_16x16x32_bf16 v[206:209], a[160:163], a[192:195], v[206:209]
    ds_read_b64_tr_b16 a[186:187], v72 offset:34048
    s_add_u32 s64, s64, 524288
    v_mfma_f32_16x16x32_bf16 v[214:217], a[160:163], a[196:199], v[214:217]
    ds_read_b128 a[132:135], v53 offset:33792
    s_cmp_eq_u32 s64, 3670016
    v_mfma_f32_16x16x32_bf16 v[198:201], a[160:163], a[188:191], v[198:201]
    ds_read_b128 a[136:139], v53 offset:34816
    s_cselect_b32 s64, 0, s64
    v_mfma_f32_16x16x32_bf16 v[210:213], a[164:167], a[192:195], v[210:213]
    ds_read_b64_tr_b16 a[176:177], v73 offset:32768
    buffer_load_dwordx4 v59, s[24:27], s64 offen lds
    v_mfma_f32_16x16x32_bf16 v[218:221], a[164:167], a[196:199], v[218:221]
    ds_read_b64_tr_b16 a[178:179], v73 offset:33024
    v_mfma_f32_16x16x32_bf16 v[202:205], a[164:167], a[188:191], v[202:205]
    ds_read_b128 a[140:143], v53 offset:35840
    buffer_load_dwordx4 v60, s[24:27], s64 offen offset:1024 lds
    v_mfma_f32_16x16x32_bf16 v[230:233], a[192:195], a[168:171], v[230:233]
    ds_read_b128 a[144:147], v53 offset:36864
    v_mfma_f32_16x16x32_bf16 v[238:241], a[196:199], a[168:171], v[238:241]
    ds_read_b128 a[148:151], v53 offset:37888
    v_mfma_f32_16x16x32_bf16 v[222:225], a[188:191], a[168:171], v[222:225]
    buffer_load_dwordx4 v61, s[24:27], s64 offen offset:2048 lds
    v_mfma_f32_16x16x32_bf16 v[234:237], a[192:195], a[172:175], v[234:237]
    v_mfma_f32_16x16x32_bf16 v[242:245], a[196:199], a[172:175], v[242:245]
    v_mfma_f32_16x16x32_bf16 v[226:229], a[188:191], a[172:175], v[226:229]
    buffer_load_dwordx4 v62, s[24:27], s64 offen offset:3072 lds
    s_load_dword s14, s[28:29], s38
    s_waitcnt lgkmcnt(6)
    v_mfma_f32_16x16x32_bf16 v[182:185], a[128:131], a[180:183], v[182:185]
    ds_read_b64_tr_b16 a[192:193], v72 offset:34816
    s_add_u32 m0, s58, 49152
    v_mfma_f32_16x16x32_bf16 v[190:193], a[128:131], a[184:187], v[190:193]
    ds_read_b64_tr_b16 a[194:195], v72 offset:35072
    s_add_u32 s64, s64, 524288
    v_mfma_f32_16x16x32_bf16 v[186:189], a[132:135], a[180:183], v[186:189]
    ds_read_b128 a[152:155], v53 offset:38912
    s_cmp_eq_u32 s64, 3670016
    v_mfma_f32_16x16x32_bf16 v[194:197], a[132:135], a[184:187], v[194:197]
    ds_read_b64_tr_b16 a[196:197], v72 offset:35840
    s_waitcnt lgkmcnt(4)
    v_mfma_f32_16x16x32_bf16 v[206:209], a[136:139], a[180:183], v[206:209]
    ds_read_b64_tr_b16 a[198:199], v72 offset:36096
    s_cselect_b32 s64, 0, s64
    v_mfma_f32_16x16x32_bf16 v[214:217], a[136:139], a[184:187], v[214:217]
    ds_read_b128 a[156:159], v53 offset:39936
    buffer_load_dwordx4 v59, s[24:27], s64 offen lds
    v_mfma_f32_16x16x32_bf16 v[198:201], a[136:139], a[176:179], v[198:201]
    ds_read_b128 a[160:163], v53 offset:40960
    v_mfma_f32_16x16x32_bf16 v[210:213], a[140:143], a[180:183], v[210:213]
    ds_read_b64_tr_b16 a[188:189], v73 offset:34816
    buffer_load_dwordx4 v60, s[24:27], s64 offen offset:1024 lds
    v_mfma_f32_16x16x32_bf16 v[218:221], a[140:143], a[184:187], v[218:221]
    ds_read_b64_tr_b16 a[190:191], v73 offset:35072
L_pad2:
    s_cbranch_execz L_warm
    v_mfma_f32_16x16x32_bf16 v[202:205], a[140:143], a[176:179], v[202:205]
    ds_read_b128 a[164:167], v53 offset:41984
    v_mfma_f32_16x16x32_bf16 v[230:233], a[180:183], a[144:147], v[230:233]
    ds_read_b128 a[168:171], v53 offset:43008
    buffer_load_dwordx4 v61, s[24:27], s64 offen offset:2048 lds
    v_mfma_f32_16x16x32_bf16 v[238:241], a[184:187], a[144:147], v[238:241]
    ds_read_b128 a[172:175], v53 offset:44032
    v_mfma_f32_16x16x32_bf16 v[222:225], a[176:179], a[144:147], v[222:225]
    v_mfma_f32_16x16x32_bf16 v[234:237], a[180:183], a[148:151], v[234:237]
    buffer_load_dwordx4 v62, s[24:27], s64 offen offset:3072 lds
    v_mfma_f32_16x16x32_bf16 v[242:245], a[184:187], a[148:151], v[242:245]
    v_mfma_f32_16x16x32_bf16 v[226:229], a[176:179], a[148:151], v[226:229]
    ds_read_b32 v24, v4
    s_waitcnt vmcnt(24) lgkmcnt(1)
    s_barrier
    v_mfma_f32_16x16x32_bf16 v[182:185], a[152:155], a[192:195], v[182:185]
    ds_read_b64_tr_b16 a[180:181], v74 offset:0
    s_add_u32 m0, s58, 98304
    v_mfma_f32_16x16x32_bf16 v[190:193], a[152:155], a[196:199], v[190:193]
    ds_read_b64_tr_b16 a[182:183], v74 offset:256
    s_add_u32 s64, s64, 524288
    v_mfma_f32_16x16x32_bf16 v[186:189], a[156:159], a[192:195], v[186:189]
    ds_read_b128 a[128:131], v54 offset:0
    s_cmp_eq_u32 s64, 3670016
    v_mfma_f32_16x16x32_bf16 v[194:197], a[156:159], a[196:199], v[194:197]
    ds_read_b64_tr_b16 a[184:185], v74 offset:1024
    v_mfma_f32_16x16x32_bf16 v[206:209], a[160:163], a[192:195], v[206:209]
    ds_read_b64_tr_b16 a[186:187], v74 offset:1280
    s_cselect_b32 s64, 0, s64
    v_mfma_f32_16x16x32_bf16 v[214:217], a[160:163], a[196:199], v[214:217]
    ds_read_b128 a[132:135], v54 offset:1024
    buffer_load_dwordx4 v59, s[24:27], s64 offen lds
    v_mfma_f32_16x16x32_bf16 v[198:201], a[160:163], a[188:191], v[198:201]
    ds_read_b128 a[136:139], v54 offset:2048
    v_mfma_f32_16x16x32_bf16 v[210:213], a[164:167], a[192:195], v[210:213]
    ds_read_b64_tr_b16 a[176:177], v75 offset:0
    buffer_load_dwordx4 v60, s[24:27], s64 offen offset:1024 lds
    v_mfma_f32_16x16x32_bf16 v[218:221], a[164:167], a[196:199], v[218:221]
    ds_read_b64_tr_b16 a[178:179], v75 offset:256
    v_mfma_f32_16x16x32_bf16 v[202:205], a[164:167], a[188:191], v[202:205]
    ds_read_b128 a[140:143], v54 offset:3072
    v_mfma_f32_16x16x32_bf16 v[230:233], a[192:195], a[168:171], v[230:233]
    ds_read_b128 a[144:147], v54 offset:4096
    buffer_load_dwordx4 v61, s[24:27], s64 offen offset:2048 lds
    v_mfma_f32_16x16x32_bf16 v[238:241], a[196:199], a[168:171], v[238:241]
    ds_read_b128 a[148:151], v54 offset:5120
    v_mfma_f32_16x16x32_bf16 v[222:225], a[188:191], a[168:171], v[222:225]
    v_mfma_f32_16x16x32_bf16 v[234:237], a[192:195], a[172:175], v[234:237]
    buffer_load_dwordx4 v62, s[24:27], s64 offen offset:3072 lds
    s_add_u32 m0, s58, 114688
    v_mfma_f32_16x16x32_bf16 v[242:245], a[196:199], a[172:175], v[242:245]
    s_add_u32 s64, s64, 524288
    s_cmp_eq_u32 s64, 3670016
    v_mfma_f32_16x16x32_bf16 v[226:229], a[188:191], a[172:175], v[226:229]
    s_cselect_b32 s64, 0, s64
    s_waitcnt lgkmcnt(6)
    v_mfma_f32_16x16x32_bf16 v[182:185], a[128:131], a[180:183], v[182:185]
    ds_read_b64_tr_b16 a[192:193], v74 offset:2048
    buffer_load_dwordx4 v59, s[24:27], s64 offen lds
    v_mfma_f32_16x16x32_bf16 v[190:193], a[128:131], a[184:187], v[190:193]
    ds_read_b64_tr_b16 a[194:195], v74 offset:2304
    v_mfma_f32_16x16x32_bf16 v[186:189], a[132:135], a[180:183], v[186:189]
    ds_read_b128 a[152:155], v54 offset:6144
    v_mfma_f32_16x16x32_bf16 v[194:197], a[132:135], a[184:187], v[194:197]
    ds_read_b64_tr_b16 a[196:197], v74 offset:3072
    s_waitcnt lgkmcnt(4)
    v_mfma_f32_16x16x32_bf16 v[206:209], a[136:139], a[180:183], v[206:209]
    ds_read_b64_tr_b16 a[198:199], v74 offset:3328
    buffer_load_dwordx4 v60, s[24:27], s64 offen offset:1024 lds
    v_mfma_f32_16x16x32_bf16 v[214:217], a[136:139], a[184:187], v[214:217]
    ds_read_b128 a[156:159], v54 offset:7168
    v_mfma_f32_16x16x32_bf16 v[198:201], a[136:139], a[176:179], v[198:201]
    ds_read_b128 a[160:163], v54 offset:8192
    buffer_load_dwordx4 v61, s[24:27], s64 offen offset:2048 lds
    v_mfma_f32_16x16x32_bf16 v[210:213], a[140:143], a[180:183], v[210:213]
    ds_read_b64_tr_b16 a[188:189], v75 offset:2048
    v_mfma_f32_16x16x32_bf16 v[218:221], a[140:143], a[184:187], v[218:221]
    ds_read_b64_tr_b16 a[190:191], v75 offset:2304
    v_mfma_f32_16x16x32_bf16 v[202:205], a[140:143], a[176:179], v[202:205]
    ds_read_b128 a[164:167], v54 offset:9216
    buffer_load_dwordx4 v62, s[24:27], s64 offen offset:3072 lds
    v_mfma_f32_16x16x32_bf16 v[230:233], a[180:183], a[144:147], v[230:233]
    ds_read_b128 a[168:171], v54 offset:10240
    v_mfma_f32_16x16x32_bf16 v[238:241], a[184:187], a[144:147], v[238:241]
    ds_read_b128 a[172:175], v54 offset:11264
    v_mfma_f32_16x16x32_bf16 v[222:225], a[176:179], a[144:147], v[222:225]
    v_mfma_f32_16x16x32_bf16 v[234:237], a[180:183], a[148:151], v[234:237]
    v_mfma_f32_16x16x32_bf16 v[242:245], a[184:187], a[148:151], v[242:245]
    v_mfma_f32_16x16x32_bf16 v[226:229], a[176:179], a[148:151], v[226:229]
    s_waitcnt lgkmcnt(0)
    s_cmp_ge_u32 s14, 7
    s_cbranch_scc0 L_pollin5
L_pollok5:
    s_waitcnt vmcnt(16)
    s_barrier
    v_mfma_f32_16x16x32_bf16 v[182:185], a[152:155], a[192:195], v[182:185]
    ds_read_b64_tr_b16 a[200:201], v31 offset:16384
    buffer_load_dwordx4 a[0:3], v79, s[28:31], s65 offen offset:0 sc1
    v_mfma_f32_16x16x32_bf16 v[190:193], a[152:155], a[196:199], v[190:193]
    ds_read_b64_tr_b16 a[202:203], v31 offset:18432
    v_mfma_f32_16x16x32_bf16 v[186:189], a[156:159], a[192:195], v[186:189]
    ds_read_b64_tr_b16 a[204:205], v33 offset:16384
    buffer_load_dwordx4 a[4:7], v79, s[28:31], s65 offen offset:1024 sc1
    v_mfma_f32_16x16x32_bf16 v[194:197], a[156:159], a[196:199], v[194:197]
    ds_read_b64_tr_b16 a[206:207], v33 offset:18432
    v_mfma_f32_16x16x32_bf16 v[206:209], a[160:163], a[192:195], v[206:209]
    ds_read_b64_tr_b16 a[208:209], v32 offset:16384
    v_mfma_f32_16x16x32_bf16 v[214:217], a[160:163], a[196:199], v[214:217]
    ds_read_b64_tr_b16 a[210:211], v32 offset:18432
    v_mfma_f32_16x16x32_bf16 v[198:201], a[160:163], a[188:191], v[198:201]
    ds_read_b64_tr_b16 a[212:213], v34 offset:16384
    buffer_load_dwordx4 a[8:11], v79, s[28:31], s65 offen offset:2048 sc1
    v_mfma_f32_16x16x32_bf16 v[210:213], a[164:167], a[192:195], v[210:213]
    ds_read_b64_tr_b16 a[214:215], v34 offset:18432
    v_mfma_f32_16x16x32_bf16 v[218:221], a[164:167], a[196:199], v[218:221]
    ds_read_b64_tr_b16 a[216:217], v31 offset:20480
    v_mfma_f32_16x16x32_bf16 v[202:205], a[164:167], a[188:191], v[202:205]
    ds_read_b64_tr_b16 a[218:219], v31 offset:22528
    buffer_load_dwordx4 a[12:15], v79, s[28:31], s65 offen offset:3072 sc1
    v_mfma_f32_16x16x32_bf16 v[230:233], a[192:195], a[168:171], v[230:233]
    ds_read_b64_tr_b16 a[220:221], v33 offset:20480
    s_add_u32 s65, s65, 8192
    v_mfma_f32_16x16x32_bf16 v[238:241], a[196:199], a[168:171], v[238:241]
    ds_read_b64_tr_b16 a[222:223], v33 offset:22528
    s_cmp_eq_u32 s65, 57344
    v_mfma_f32_16x16x32_bf16 v[222:225], a[188:191], a[168:171], v[222:225]
    s_cselect_b32 s65, 0, s65
    v_mfma_f32_16x16x32_bf16 v[234:237], a[192:195], a[172:175], v[234:237]
    buffer_load_dwordx4 a[16:19], v79, s[28:31], s65 offen offset:0 sc1
    v_mfma_f32_16x16x32_bf16 v[242:245], a[196:199], a[172:175], v[242:245]
    v_mfma_f32_16x16x32_bf16 v[226:229], a[188:191], a[172:175], v[226:229]
    v_cvt_pk_bf16_f32 v118, v182, v183
    v_cvt_pk_bf16_f32 v119, v184, v185
    v_cvt_pk_bf16_f32 v120, v186, v187
    buffer_load_dwordx4 a[20:23], v79, s[28:31], s65 offen offset:1024 sc1
    v_cvt_pk_bf16_f32 v121, v188, v189
    v_cvt_pk_bf16_f32 v122, v190, v191
    v_cvt_pk_bf16_f32 v123, v192, v193
    v_cvt_pk_bf16_f32 v124, v194, v195
    v_cvt_pk_bf16_f32 v125, v196, v197
    v_cvt_pk_bf16_f32 v130, v206, v207
    v_cvt_pk_bf16_f32 v131, v208, v209
    v_cvt_pk_bf16_f32 v132, v210, v211
    v_cvt_pk_bf16_f32 v133, v212, v213
    v_cvt_pk_bf16_f32 v134, v214, v215
    v_cvt_pk_bf16_f32 v135, v216, v217
    v_cvt_pk_bf16_f32 v136, v218, v219
    v_cvt_pk_bf16_f32 v137, v220, v221
    v_cvt_pk_bf16_f32 v126, v198, v199
    buffer_load_dwordx4 a[24:27], v79, s[28:31], s65 offen offset:2048 sc1
    v_cvt_pk_bf16_f32 v127, v200, v201
    v_cvt_pk_bf16_f32 v128, v202, v203
    v_cvt_pk_bf16_f32 v129, v204, v205
    v_mfma_f32_16x16x32_bf16 v[154:157], v[130:133], v[118:121], 0
    v_mfma_f32_16x16x32_bf16 v[158:161], v[130:133], v[122:125], 0
    v_mfma_f32_16x16x32_bf16 v[162:165], v[134:137], v[122:125], 0
    buffer_load_dwordx4 a[28:31], v79, s[28:31], s65 offen offset:3072 sc1
    v_mfma_f32_16x16x32_bf16 v[150:153], v[126:129], v[118:121], 0
    v_cvt_pk_bf16_f32 v166, v222, v223
    v_cvt_pk_bf16_f32 v167, v224, v225
    v_cvt_pk_bf16_f32 v168, v230, v231
    v_cvt_pk_bf16_f32 v169, v232, v233
    v_cvt_pk_bf16_f32 v170, v238, v239
    v_cvt_pk_bf16_f32 v171, v240, v241
    v_cndmask_b32 v250, v158, v159, s[70:71]
    v_cndmask_b32 v253, v162, v163, s[70:71]
    v_cndmask_b32 v250, v250, v253, s[72:73]
    s_add_u32 s65, s65, 8192
    s_cmp_eq_u32 s65, 57344
    s_cselect_b32 s65, 0, s65
    buffer_load_dwordx4 a[32:35], v79, s[28:31], s65 offen offset:0 sc1
    v_mul_f32 v250, v250, v29
    v_cndmask_b32 v251, v160, v161, s[70:71]
    v_cndmask_b32 v253, v164, v165, s[70:71]
    v_cndmask_b32 v251, v251, v253, s[74:75]
    v_mul_f32 v251, v251, v30
    v_cndmask_b32 v246, v150, v151, s[70:71]
    v_cndmask_b32 v246, v84, v246, s[76:77]
    v_cndmask_b32 v249, v154, v155, s[70:71]
    v_cndmask_b32 v246, v246, v249, s[72:73]
    v_mul_f32 v246, v246, v27
    v_cndmask_b32 v247, v152, v153, s[70:71]
    v_cndmask_b32 v247, v84, v247, s[76:77]
    v_cndmask_b32 v249, v156, v157, s[70:71]
    v_cndmask_b32 v247, v247, v249, s[74:75]
    buffer_load_dwordx4 a[36:39], v79, s[28:31], s65 offen offset:1024 sc1
    v_mul_f32 v247, v247, v28
    v_max_f32 v248, v246, v247
    v_max_f32 v252, v250, v251
    v_mov_b32 v249, v248
    v_mov_b32 v253, v252
    v_cvt_pk_bf16_f32 v172, v226, v227
    v_permlane16_swap_b32 v248, v249
    v_permlane16_swap_b32 v252, v253
    v_max_f32 v248, v248, v249
    v_max_f32 v252, v252, v253
    v_mov_b32 v249, v248
    v_mov_b32 v253, v252
    v_cvt_pk_bf16_f32 v173, v228, v229
    v_permlane32_swap_b32 v248, v249
    buffer_load_dwordx4 a[40:43], v79, s[28:31], s65 offen offset:2048 sc1
    v_permlane32_swap_b32 v252, v253
    v_max_f32 v248, v248, v249
    v_max_f32 v252, v252, v253
    v_mul_f32 v248, v25, v248
    v_mul_f32 v252, v26, v252
    v_fma_f32 v246, v246, v25, -v248
    v_fma_f32 v247, v247, v25, -v248
    v_fma_f32 v250, v250, v26, -v252
    v_fma_f32 v251, v251, v26, -v252
    v_exp_f32 v246, v246
    v_exp_f32 v247, v247
    v_exp_f32 v250, v250
    buffer_load_dwordx4 a[44:47], v79, s[28:31], s65 offen offset:3072 sc1
    v_exp_f32 v251, v251
    v_add_f32 v248, v246, v247
    v_add_f32 v252, v250, v251
    v_mov_b32 v249, v248
    v_mov_b32 v253, v252
    v_cvt_pk_bf16_f32 v174, v234, v235
    v_permlane16_swap_b32 v248, v249
    v_permlane16_swap_b32 v252, v253
    v_add_f32 v248, v248, v249
    v_add_f32 v252, v252, v253
    v_mov_b32 v249, v248
    v_mov_b32 v253, v252
    s_add_u32 m0, s58, 131072
    s_add_u32 s64, s64, 524288
    s_cmp_eq_u32 s64, 3670016
    s_cselect_b32 s64, 0, s64
    s_add_u32 s64, s64, 524288
    s_cmp_eq_u32 s64, 3670016
    s_cselect_b32 s64, 0, s64
    v_xor_b32 v59, 128, v59
    buffer_load_dwordx4 v59, s[24:27], s64 offen lds
    v_cvt_pk_bf16_f32 v175, v236, v237
    v_permlane32_swap_b32 v248, v249
    v_permlane32_swap_b32 v252, v253
    v_add_f32 v248, v248, v249
    v_add_f32 v252, v252, v253
    v_rcp_f32 v248, v248
    v_rcp_f32 v252, v252
    v_cvt_pk_bf16_f32 v176, v242, v243
    v_cvt_pk_bf16_f32 v177, v244, v245
    v_mul_f32 v246, v246, v27
    v_xor_b32 v60, 128, v60
    buffer_load_dwordx4 v60, s[24:27], s64 offen offset:1024 lds
    v_mul_f32 v247, v247, v28
    v_mul_f32 v250, v250, v29
    v_mul_f32 v251, v251, v30
    v_mul_f32 v246, v246, v248
    v_mul_f32 v247, v247, v248
    v_mul_f32 v250, v250, v252
    v_mul_f32 v251, v251, v252
    v_cvt_pk_bf16_f32 v246, v246, v246
    v_cvt_pk_bf16_f32 v247, v247, v247
    v_cvt_pk_bf16_f32 v250, v250, v250
    v_cvt_pk_bf16_f32 v251, v251, v251
    v_and_b32 v138, v246, v104
    v_and_b32 v139, v247, v105
    v_xor_b32 v61, 128, v61
    buffer_load_dwordx4 v61, s[24:27], s64 offen offset:2048 lds
    v_and_b32 v140, v246, v106
    v_and_b32 v141, v247, v107
    v_and_b32 v142, v250, v104
    v_and_b32 v143, v251, v105
    v_and_b32 v144, v250, v106
    v_and_b32 v145, v251, v107
    v_mfma_f32_16x16x32_bf16 v[182:185], v[166:169], v[138:141], 0
    v_mfma_f32_16x16x32_bf16 v[186:189], v[172:175], v[138:141], 0
    v_xor_b32 v62, 128, v62
    buffer_load_dwordx4 v62, s[24:27], s64 offen offset:3072 lds
    v_mfma_f32_16x16x32_bf16 v[190:193], v[168:171], v[142:145], 0
    v_mfma_f32_16x16x32_bf16 v[194:197], v[174:177], v[142:145], 0
    s_add_u32 s83, s82, 16384
    s_nop 1
    v_cvt_pk_bf16_f32 v110, v182, v183
    v_cvt_pk_bf16_f32 v111, v184, v185
    s_add_u32 m0, s58, 147456
    s_add_u32 s64, s64, 524288
    s_cmp_eq_u32 s64, 3670016
    s_cselect_b32 s64, 0, s64
    buffer_load_dwordx4 v59, s[24:27], s64 offen lds
    v_cvt_pk_bf16_f32 v112, v186, v187
    v_cvt_pk_bf16_f32 v113, v188, v189
    v_cvt_pk_bf16_f32 v114, v190, v191
    v_cvt_pk_bf16_f32 v115, v192, v193
    v_cvt_pk_bf16_f32 v116, v194, v195
    v_cvt_pk_bf16_f32 v117, v196, v197
    buffer_store_dwordx4 v[110:113], v4, s[28:31], s82 offen sc1
    buffer_store_dwordx4 v[114:117], v4, s[28:31], s83 offen sc1
    s_cmp_lg_u32 s56, 0
    s_cbranch_scc0 L_nof
L_f:
    s_waitcnt vmcnt(17) lgkmcnt(8)
    v_mfma_f32_16x16x32_bf16 v[182:185], a[0:3], a[200:203], 0
    ds_read_b64_tr_b16 a[224:225], v32 offset:20480
    s_add_u32 s65, s65, 8192
    s_cmp_eq_u32 s65, 57344
    s_cselect_b32 s65, 0, s65
    buffer_load_dwordx4 a[48:51], v79, s[28:31], s65 offen offset:0 sc1
    v_mfma_f32_16x16x32_bf16 v[186:189], a[4:7], a[200:203], 0
    ds_read_b64_tr_b16 a[226:227], v32 offset:22528
    v_lshlrev_b32 v93, 16, v93
    v_mfma_f32_16x16x32_bf16 v[238:241], a[0:3], a[204:207], 0
    ds_read_b64_tr_b16 a[228:229], v34 offset:20480
    buffer_load_dwordx4 a[52:55], v79, s[28:31], s65 offen offset:1024 sc1
    v_mfma_f32_16x16x32_bf16 v[242:245], a[4:7], a[204:207], 0
    ds_read_b64_tr_b16 a[230:231], v34 offset:22528
    s_waitcnt lgkmcnt(8)
    v_mfma_f32_16x16x32_bf16 v[190:193], a[0:3], a[208:211], 0
    ds_read_b64_tr_b16 a[200:201], v35 offset:0
    v_lshlrev_b32 v222, 16, v96
    v_mfma_f32_16x16x32_bf16 v[194:197], a[4:7], a[208:211], 0
    ds_read_b64_tr_b16 a[202:203], v35 offset:2048
    v_and_b32 v223, 0xffff0000, v96
    v_mfma_f32_16x16x32_bf16 v[246:249], a[0:3], a[212:215], 0
    ds_read_b64_tr_b16 a[204:205], v37 offset:0
    buffer_load_dwordx4 a[56:59], v79, s[28:31], s65 offen offset:2048 sc1
    v_mfma_f32_16x16x32_bf16 v[250:253], a[4:7], a[212:215], 0
    ds_read_b64_tr_b16 a[206:207], v37 offset:2048
    s_waitcnt vmcnt(18) lgkmcnt(8)
    v_mfma_f32_16x16x32_bf16 v[182:185], a[8:11], a[216:219], v[182:185]
    ds_read_b64_tr_b16 a[208:209], v36 offset:0
    v_add_f32 v222, v222, v93
    v_mfma_f32_16x16x32_bf16 v[186:189], a[12:15], a[216:219], v[186:189]
    ds_read_b64_tr_b16 a[210:211], v36 offset:2048
    buffer_load_dwordx4 a[60:63], v79, s[28:31], s65 offen offset:3072 sc1
    v_add_f32 v223, v223, v93
    v_mfma_f32_16x16x32_bf16 v[238:241], a[8:11], a[220:223], v[238:241]
    ds_read_b64_tr_b16 a[212:213], v38 offset:0
    s_add_u32 s65, s65, 8192
    v_mfma_f32_16x16x32_bf16 v[242:245], a[12:15], a[220:223], v[242:245]
    ds_read_b64_tr_b16 a[214:215], v38 offset:2048
    s_waitcnt lgkmcnt(8)
    v_mfma_f32_16x16x32_bf16 v[190:193], a[8:11], a[224:227], v[190:193]
    ds_read_b64_tr_b16 a[216:217], v35 offset:4096
    s_cmp_eq_u32 s65, 57344
    v_mfma_f32_16x16x32_bf16 v[194:197], a[12:15], a[224:227], v[194:197]
    ds_read_b64_tr_b16 a[218:219], v35 offset:6144
    s_cselect_b32 s65, 0, s65
    v_lshlrev_b32 v224, 16, v97
    v_mfma_f32_16x16x32_bf16 v[246:249], a[8:11], a[228:231], v[246:249]
    ds_read_b64_tr_b16 a[220:221], v37 offset:4096
    buffer_load_dwordx4 a[64:67], v79, s[28:31], s65 offen offset:0 sc1
    v_mfma_f32_16x16x32_bf16 v[250:253], a[12:15], a[228:231], v[250:253]
    ds_read_b64_tr_b16 a[222:223], v37 offset:6144
    s_waitcnt vmcnt(18) lgkmcnt(8)
    v_mfma_f32_16x16x32_bf16 v[182:185], a[16:19], a[200:203], v[182:185]
    ds_read_b64_tr_b16 a[224:225], v36 offset:4096
    buffer_load_dwordx4 a[68:71], v79, s[28:31], s65 offen offset:1024 sc1
    v_mfma_f32_16x16x32_bf16 v[186:189], a[20:23], a[200:203], v[186:189]
    ds_read_b64_tr_b16 a[226:227], v36 offset:6144
    v_and_b32 v225, 0xffff0000, v97
    v_mfma_f32_16x16x32_bf16 v[238:241], a[16:19], a[204:207], v[238:241]
    ds_read_b64_tr_b16 a[228:229], v38 offset:4096
    v_add_f32 v224, v224, v93
    v_mfma_f32_16x16x32_bf16 v[242:245], a[20:23], a[204:207], v[242:245]
    ds_read_b64_tr_b16 a[230:231], v38 offset:6144
    s_waitcnt lgkmcnt(8)
    v_mfma_f32_16x16x32_bf16 v[190:193], a[16:19], a[208:211], v[190:193]
    ds_read_b64_tr_b16 a[200:201], v35 offset:16384
    buffer_load_dwordx4 a[72:75], v79, s[28:31], s65 offen offset:2048 sc1
    v_mfma_f32_16x16x32_bf16 v[194:197], a[20:23], a[208:211], v[194:197]
    ds_read_b64_tr_b16 a[202:203], v35 offset:18432
    v_add_f32 v225, v225, v93
    v_mfma_f32_16x16x32_bf16 v[246:249], a[16:19], a[212:215], v[246:249]
    ds_read_b64_tr_b16 a[204:205], v37 offset:16384
    v_lshlrev_b32 v226, 16, v98
    v_mfma_f32_16x16x32_bf16 v[250:253], a[20:23], a[212:215], v[250:253]
    ds_read_b64_tr_b16 a[206:207], v37 offset:18432
    s_waitcnt vmcnt(18) lgkmcnt(8)
    v_mfma_f32_16x16x32_bf16 v[182:185], a[24:27], a[216:219], v[182:185]
    ds_read_b64_tr_b16 a[208:209], v36 offset:16384
    buffer_load_dwordx4 a[76:79], v79, s[28:31], s65 offen offset:3072 sc1
    v_mfma_f32_16x16x32_bf16 v[186:189], a[28:31], a[216:219], v[186:189]
    ds_read_b64_tr_b16 a[210:211], v36 offset:18432
    s_add_u32 s65, s65, 8192
    v_and_b32 v227, 0xffff0000, v98
    v_mfma_f32_16x16x32_bf16 v[238:241], a[24:27], a[220:223], v[238:241]
    ds_read_b64_tr_b16 a[212:213], v38 offset:16384
    s_cmp_eq_u32 s65, 57344
    v_mfma_f32_16x16x32_bf16 v[242:245], a[28:31], a[220:223], v[242:245]
    ds_read_b64_tr_b16 a[214:215], v38 offset:18432
    v_add_f32 v226, v226, v93
    s_waitcnt lgkmcnt(8)
    v_mfma_f32_16x16x32_bf16 v[190:193], a[24:27], a[224:227], v[190:193]
    ds_read_b64_tr_b16 a[216:217], v35 offset:20480
    s_cselect_b32 s65, 0, s65
    buffer_load_dwordx4 a[80:83], v79, s[28:31], s65 offen offset:0 sc1
    v_mfma_f32_16x16x32_bf16 v[194:197], a[28:31], a[224:227], v[194:197]
    ds_read_b64_tr_b16 a[218:219], v35 offset:22528
    v_add_f32 v227, v227, v93
    v_mfma_f32_16x16x32_bf16 v[246:249], a[24:27], a[228:231], v[246:249]
    ds_read_b64_tr_b16 a[220:221], v37 offset:20480
    buffer_load_dwordx4 a[84:87], v79, s[28:31], s65 offen offset:1024 sc1
    v_mfma_f32_16x16x32_bf16 v[250:253], a[28:31], a[228:231], v[250:253]
    ds_read_b64_tr_b16 a[222:223], v37 offset:22528
    v_lshlrev_b32 v228, 16, v99
    s_waitcnt vmcnt(19) lgkmcnt(8)
    v_mfma_f32_16x16x32_bf16 v[182:185], a[32:35], a[200:203], v[182:185]
    ds_read_b64_tr_b16 a[224:225], v36 offset:20480
    v_and_b32 v229, 0xffff0000, v99
    v_mfma_f32_16x16x32_bf16 v[186:189], a[36:39], a[200:203], v[186:189]
    ds_read_b64_tr_b16 a[226:227], v36 offset:22528
    buffer_load_dwordx4 a[88:91], v79, s[28:31], s65 offen offset:2048 sc1
    v_add_f32 v228, v228, v93
    v_mfma_f32_16x16x32_bf16 v[238:241], a[32:35], a[204:207], v[238:241]
    ds_read_b64_tr_b16 a[228:229], v38 offset:20480
    v_add_f32 v229, v229, v93
    v_mfma_f32_16x16x32_bf16 v[242:245], a[36:39], a[204:207], v[242:245]
    ds_read_b64_tr_b16 a[230:231], v38 offset:22528
    s_waitcnt lgkmcnt(8)
    v_mfma_f32_16x16x32_bf16 v[190:193], a[32:35], a[208:211], v[190:193]
    s_waitcnt vmcnt(11)
    s_barrier
    s_cmp_lg_u32 s48, 0
    s_cbranch_scc1 L_sig4
    s_atomic_add s36, s[28:29], s69
L_sig4:
    ds_read_b64_tr_b16 a[200:201], v31 offset:32768
    buffer_load_dwordx4 a[92:95], v79, s[28:31], s65 offen offset:3072 sc1
    v_mfma_f32_16x16x32_bf16 v[194:197], a[36:39], a[208:211], v[194:197]
    ds_read_b64_tr_b16 a[202:203], v31 offset:34816
    s_add_u32 s65, s65, 8192
    v_lshlrev_b32 v94, 16, v94
    v_mfma_f32_16x16x32_bf16 v[246:249], a[32:35], a[212:215], v[246:249]
    ds_read_b64_tr_b16 a[204:205], v33 offset:32768
    s_cmp_eq_u32 s65, 57344
    v_mfma_f32_16x16x32_bf16 v[250:253], a[36:39], a[212:215], v[250:253]
    ds_read_b64_tr_b16 a[206:207], v33 offset:34816
    s_waitcnt lgkmcnt(8)
    v_mfma_f32_16x16x32_bf16 v[182:185], a[40:43], a[216:219], v[182:185]
    ds_read_b64_tr_b16 a[208:209], v32 offset:32768
    s_cselect_b32 s65, 0, s65
    v_mfma_f32_16x16x32_bf16 v[186:189], a[44:47], a[216:219], v[186:189]
    ds_read_b64_tr_b16 a[210:211], v32 offset:34816
    buffer_load_dwordx4 a[96:99], v79, s[28:31], s65 offen offset:0 sc1
    v_lshlrev_b32 v230, 16, v100
    v_mfma_f32_16x16x32_bf16 v[238:241], a[40:43], a[220:223], v[238:241]
    ds_read_b64_tr_b16 a[212:213], v34 offset:32768
    v_and_b32 v231, 0xffff0000, v100
    v_mfma_f32_16x16x32_bf16 v[242:245], a[44:47], a[220:223], v[242:245]
    ds_read_b64_tr_b16 a[214:215], v34 offset:34816
    s_waitcnt lgkmcnt(8)
    v_mfma_f32_16x16x32_bf16 v[190:193], a[40:43], a[224:227], v[190:193]
    ds_read_b64_tr_b16 a[216:217], v31 offset:36864
    buffer_load_dwordx4 a[100:103], v79, s[28:31], s65 offen offset:1024 sc1
    v_mfma_f32_16x16x32_bf16 v[194:197], a[44:47], a[224:227], v[194:197]
    ds_read_b64_tr_b16 a[218:219], v31 offset:38912
    v_add_f32 v230, v230, v94
    v_mfma_f32_16x16x32_bf16 v[246:249], a[40:43], a[228:231], v[246:249]
    ds_read_b64_tr_b16 a[220:221], v33 offset:36864
    buffer_load_dwordx4 a[104:107], v79, s[28:31], s65 offen offset:2048 sc1
    v_mfma_f32_16x16x32_bf16 v[250:253], a[44:47], a[228:231], v[250:253]
    ds_read_b64_tr_b16 a[222:223], v33 offset:38912
    v_add_f32 v231, v231, v94
    s_waitcnt vmcnt(13) lgkmcnt(8)
    v_mfma_f32_16x16x32_bf16 v[182:185], a[48:51], a[200:203], v[182:185]
    ds_read_b64_tr_b16 a[224:225], v32 offset:36864
    v_lshlrev_b32 v232, 16, v101
    v_mfma_f32_16x16x32_bf16 v[186:189], a[52:55], a[200:203], v[186:189]
    ds_read_b64_tr_b16 a[226:227], v32 offset:38912
    v_and_b32 v233, 0xffff0000, v101
    v_mfma_f32_16x16x32_bf16 v[238:241], a[48:51], a[204:207], v[238:241]
    ds_read_b64_tr_b16 a[228:229], v34 offset:36864
    buffer_load_dwordx4 a[108:111], v79, s[28:31], s65 offen offset:3072 sc1
    v_mfma_f32_16x16x32_bf16 v[242:245], a[52:55], a[204:207], v[242:245]
    ds_read_b64_tr_b16 a[230:231], v34 offset:38912
    s_waitcnt lgkmcnt(8)
    v_mfma_f32_16x16x32_bf16 v[190:193], a[48:51], a[208:211], v[190:193]
    ds_read_b64_tr_b16 a[200:201], v31 offset:49152
    v_add_f32 v232, v232, v94
    v_mfma_f32_16x16x32_bf16 v[194:197], a[52:55], a[208:211], v[194:197]
    ds_read_b64_tr_b16 a[202:203], v31 offset:51200
    buffer_load_dwordx4 v60, s[24:27], s64 offen offset:1024 lds
    v_add_f32 v233, v233, v94
    v_mfma_f32_16x16x32_bf16 v[246:249], a[48:51], a[212:215], v[246:249]
    ds_read_b64_tr_b16 a[204:205], v33 offset:49152
    v_lshlrev_b32 v234, 16, v102
    v_mfma_f32_16x16x32_bf16 v[250:253], a[52:55], a[212:215], v[250:253]
    ds_read_b64_tr_b16 a[206:207], v33 offset:51200
    s_waitcnt vmcnt(13) lgkmcnt(8)
    v_mfma_f32_16x16x32_bf16 v[182:185], a[56:59], a[216:219], v[182:185]
    ds_read_b64_tr_b16 a[208:209], v32 offset:49152
    buffer_load_dwordx4 v61, s[24:27], s64 offen offset:2048 lds
    v_mfma_f32_16x16x32_bf16 v[186:189], a[60:63], a[216:219], v[186:189]
    ds_read_b64_tr_b16 a[210:211], v32 offset:51200
    v_and_b32 v235, 0xffff0000, v102
    v_mfma_f32_16x16x32_bf16 v[238:241], a[56:59], a[220:223], v[238:241]
    ds_read_b64_tr_b16 a[212:213], v34 offset:49152
    buffer_load_dwordx4 v62, s[24:27], s64 offen offset:3072 lds
    v_mfma_f32_16x16x32_bf16 v[242:245], a[60:63], a[220:223], v[242:245]
    ds_read_b64_tr_b16 a[214:215], v34 offset:51200
    s_waitcnt lgkmcnt(8)
    v_mfma_f32_16x16x32_bf16 v[190:193], a[56:59], a[224:227], v[190:193]
    ds_read_b64_tr_b16 a[216:217], v31 offset:53248
    s_add_u32 m0, s58, 16384
    v_mfma_f32_16x16x32_bf16 v[194:197], a[60:63], a[224:227], v[194:197]
    ds_read_b64_tr_b16 a[218:219], v31 offset:55296
    s_add_u32 s64, s64, 524288
    v_add_f32 v234, v234, v94
    v_mfma_f32_16x16x32_bf16 v[246:249], a[56:59], a[228:231], v[246:249]
    ds_read_b64_tr_b16 a[220:221], v33 offset:53248
    s_cmp_eq_u32 s64, 3670016
    v_mfma_f32_16x16x32_bf16 v[250:253], a[60:63], a[228:231], v[250:253]
    ds_read_b64_tr_b16 a[222:223], v33 offset:55296
    s_cselect_b32 s64, 0, s64
    buffer_load_dwordx4 v59, s[24:27], s64 offen lds
    v_add_f32 v235, v235, v94
    s_waitcnt vmcnt(14) lgkmcnt(8)
    v_mfma_f32_16x16x32_bf16 v[182:185], a[64:67], a[200:203], v[182:185]
    ds_read_b64_tr_b16 a[224:225], v32 offset:53248
    v_lshlrev_b32 v236, 16, v103
    v_mfma_f32_16x16x32_bf16 v[186:189], a[68:71], a[200:203], v[186:189]
    ds_read_b64_tr_b16 a[226:227], v32 offset:55296
    buffer_load_dwordx4 v60, s[24:27], s64 offen offset:1024 lds
    v_and_b32 v237, 0xffff0000, v103
    v_mfma_f32_16x16x32_bf16 v[238:241], a[64:67], a[204:207], v[238:241]
    ds_read_b64_tr_b16 a[228:229], v34 offset:53248
    v_add_f32 v236, v236, v94
    v_mfma_f32_16x16x32_bf16 v[242:245], a[68:71], a[204:207], v[242:245]
    ds_read_b64_tr_b16 a[230:231], v34 offset:55296
    s_waitcnt lgkmcnt(8)
    v_mfma_f32_16x16x32_bf16 v[190:193], a[64:67], a[208:211], v[190:193]
    s_barrier
    ds_read_b64_tr_b16 a[200:201], v35 offset:32768
    buffer_load_dwordx4 v61, s[24:27], s64 offen offset:2048 lds
    v_mfma_f32_16x16x32_bf16 v[194:197], a[68:71], a[208:211], v[194:197]
    ds_read_b64_tr_b16 a[202:203], v35 offset:34816
    v_add_f32 v237, v237, v94
    v_mfma_f32_16x16x32_bf16 v[246:249], a[64:67], a[212:215], v[246:249]
    ds_read_b64_tr_b16 a[204:205], v37 offset:32768
    v_mfma_f32_16x16x32_bf16 v[250:253], a[68:71], a[212:215], v[250:253]
    ds_read_b64_tr_b16 a[206:207], v37 offset:34816
    s_waitcnt vmcnt(14) lgkmcnt(8)
    v_mfma_f32_16x16x32_bf16 v[182:185], a[72:75], a[216:219], v[182:185]
    ds_read_b64_tr_b16 a[208:209], v36 offset:32768
    buffer_load_dwordx4 v62, s[24:27], s64 offen offset:3072 lds
    v_mfma_f32_16x16x32_bf16 v[186:189], a[76:79], a[216:219], v[186:189]
    ds_read_b64_tr_b16 a[210:211], v36 offset:34816
    s_add_u32 m0, s58, 65536
    v_mfma_f32_16x16x32_bf16 v[238:241], a[72:75], a[220:223], v[238:241]
    ds_read_b64_tr_b16 a[212:213], v38 offset:32768
    s_add_u32 s64, s64, 524288
    v_mfma_f32_16x16x32_bf16 v[242:245], a[76:79], a[220:223], v[242:245]
    ds_read_b64_tr_b16 a[214:215], v38 offset:34816
    s_waitcnt lgkmcnt(8)
    v_mfma_f32_16x16x32_bf16 v[190:193], a[72:75], a[224:227], v[190:193]
    ds_read_b64_tr_b16 a[216:217], v35 offset:36864
    s_cmp_eq_u32 s64, 3670016
    v_mfma_f32_16x16x32_bf16 v[194:197], a[76:79], a[224:227], v[194:197]
    ds_read_b64_tr_b16 a[218:219], v35 offset:38912
    s_cselect_b32 s64, 0, s64
    buffer_load_dwordx4 v59, s[24:27], s64 offen lds
    v_mfma_f32_16x16x32_bf16 v[246:249], a[72:75], a[228:231], v[246:249]
    ds_read_b64_tr_b16 a[220:221], v37 offset:36864
    v_mfma_f32_16x16x32_bf16 v[250:253], a[76:79], a[228:231], v[250:253]
    ds_read_b64_tr_b16 a[222:223], v37 offset:38912
    s_waitcnt vmcnt(14) lgkmcnt(8)
    v_mfma_f32_16x16x32_bf16 v[182:185], a[80:83], a[200:203], v[182:185]
    ds_read_b64_tr_b16 a[224:225], v36 offset:36864
    buffer_load_dwordx4 v60, s[24:27], s64 offen offset:1024 lds
    v_mfma_f32_16x16x32_bf16 v[186:189], a[84:87], a[200:203], v[186:189]
    ds_read_b64_tr_b16 a[226:227], v36 offset:38912
    v_mfma_f32_16x16x32_bf16 v[238:241], a[80:83], a[204:207], v[238:241]
    ds_read_b64_tr_b16 a[228:229], v38 offset:36864
    v_mfma_f32_16x16x32_bf16 v[242:245], a[84:87], a[204:207], v[242:245]
    ds_read_b64_tr_b16 a[230:231], v38 offset:38912
    s_waitcnt lgkmcnt(8)
    v_mfma_f32_16x16x32_bf16 v[190:193], a[80:83], a[208:211], v[190:193]
    ds_read_b64_tr_b16 a[200:201], v35 offset:49152
    buffer_load_dwordx4 v61, s[24:27], s64 offen offset:2048 lds
    v_mfma_f32_16x16x32_bf16 v[194:197], a[84:87], a[208:211], v[194:197]
    ds_read_b64_tr_b16 a[202:203], v35 offset:51200
    v_mfma_f32_16x16x32_bf16 v[246:249], a[80:83], a[212:215], v[246:249]
    ds_read_b64_tr_b16 a[204:205], v37 offset:49152
    v_mfma_f32_16x16x32_bf16 v[250:253], a[84:87], a[212:215], v[250:253]
    ds_read_b64_tr_b16 a[206:207], v37 offset:51200
    s_waitcnt vmcnt(14) lgkmcnt(8)
    v_mfma_f32_16x16x32_bf16 v[182:185], a[88:91], a[216:219], v[182:185]
    ds_read_b64_tr_b16 a[208:209], v36 offset:49152
L_pad3:
    s_cbranch_execz L_warm
    buffer_load_dwordx4 v62, s[24:27], s64 offen offset:3072 lds
    v_mfma_f32_16x16x32_bf16 v[186:189], a[92:95], a[216:219], v[186:189]
    ds_read_b64_tr_b16 a[210:211], v36 offset:51200
    s_add_u32 m0, s58, 81920
    v_mfma_f32_16x16x32_bf16 v[238:241], a[88:91], a[220:223], v[238:241]
    ds_read_b64_tr_b16 a[212:213], v38 offset:49152
    s_add_u32 s64, s64, 524288
    v_mfma_f32_16x16x32_bf16 v[242:245], a[92:95], a[220:223], v[242:245]
    ds_read_b64_tr_b16 a[214:215], v38 offset:51200
    s_waitcnt lgkmcnt(8)
    v_mfma_f32_16x16x32_bf16 v[190:193], a[88:91], a[224:227], v[190:193]
    ds_read_b64_tr_b16 a[216:217], v35 offset:53248
    s_cmp_eq_u32 s64, 3670016
    s_cselect_b32 s64, 0, s64
    buffer_load_dwordx4 v59, s[24:27], s64 offen lds
    v_mfma_f32_16x16x32_bf16 v[194:197], a[92:95], a[224:227], v[194:197]
    ds_read_b64_tr_b16 a[218:219], v35 offset:55296
    v_mfma_f32_16x16x32_bf16 v[246:249], a[88:91], a[228:231], v[246:249]
    ds_read_b64_tr_b16 a[220:221], v37 offset:53248
    buffer_load_dwordx4 v60, s[24:27], s64 offen offset:1024 lds
    v_mfma_f32_16x16x32_bf16 v[250:253], a[92:95], a[228:231], v[250:253]
    ds_read_b64_tr_b16 a[222:223], v37 offset:55296
    s_waitcnt vmcnt(15) lgkmcnt(8)
    v_mfma_f32_16x16x32_bf16 v[182:185], a[96:99], a[200:203], v[182:185]
    ds_read_b64_tr_b16 a[224:225], v36 offset:53248
    v_mfma_f32_16x16x32_bf16 v[186:189], a[100:103], a[200:203], v[186:189]
    ds_read_b64_tr_b16 a[226:227], v36 offset:55296
    v_mfma_f32_16x16x32_bf16 v[238:241], a[96:99], a[204:207], v[238:241]
    ds_read_b64_tr_b16 a[228:229], v38 offset:53248
    buffer_load_dwordx4 v61, s[24:27], s64 offen offset:2048 lds
    v_mfma_f32_16x16x32_bf16 v[242:245], a[100:103], a[204:207], v[242:245]
    ds_read_b64_tr_b16 a[230:231], v38 offset:55296
    s_waitcnt lgkmcnt(8)
    v_mfma_f32_16x16x32_bf16 v[190:193], a[96:99], a[208:211], v[190:193]
    ds_read_b64_tr_b16 a[200:201], v31 offset:0
    v_mfma_f32_16x16x32_bf16 v[194:197], a[100:103], a[208:211], v[194:197]
    ds_read_b64_tr_b16 a[202:203], v31 offset:2048
    v_mfma_f32_16x16x32_bf16 v[246:249], a[96:99], a[212:215], v[246:249]
    ds_read_b64_tr_b16 a[204:205], v33 offset:0
    buffer_load_dwordx4 v62, s[24:27], s64 offen offset:3072 lds
    v_mfma_f32_16x16x32_bf16 v[250:253], a[100:103], a[212:215], v[250:253]
    ds_read_b64_tr_b16 a[206:207], v33 offset:2048
    s_waitcnt vmcnt(15) lgkmcnt(8)
    v_mfma_f32_16x16x32_bf16 v[182:185], a[104:107], a[216:219], v[182:185]
    ds_read_b64_tr_b16 a[208:209], v32 offset:0
    s_add_u32 m0, s58, 32768
    v_mfma_f32_16x16x32_bf16 v[186:189], a[108:111], a[216:219], v[186:189]
    ds_read_b64_tr_b16 a[210:211], v32 offset:2048
    s_add_u32 s64, s64, 524288
    v_mfma_f32_16x16x32_bf16 v[238:241], a[104:107], a[220:223], v[238:241]
    ds_read_b64_tr_b16 a[212:213], v34 offset:0
    s_cmp_eq_u32 s64, 3670016
    v_mfma_f32_16x16x32_bf16 v[242:245], a[108:111], a[220:223], v[242:245]
    ds_read_b64_tr_b16 a[214:215], v34 offset:2048
    s_cselect_b32 s64, 0, s64
    buffer_load_dwordx4 v59, s[24:27], s64 offen lds
    s_waitcnt lgkmcnt(8)
    v_mfma_f32_16x16x32_bf16 v[190:193], a[104:107], a[224:227], v[190:193]
    ds_read_b64_tr_b16 a[216:217], v31 offset:4096
    v_mfma_f32_16x16x32_bf16 v[194:197], a[108:111], a[224:227], v[194:197]
    ds_read_b64_tr_b16 a[218:219], v31 offset:6144
    buffer_load_dwordx4 v60, s[24:27], s64 offen offset:1024 lds
    v_mfma_f32_16x16x32_bf16 v[246:249], a[104:107], a[228:231], v[246:249]
    ds_read_b64_tr_b16 a[220:221], v33 offset:4096
    v_mfma_f32_16x16x32_bf16 v[250:253], a[108:111], a[228:231], v[250:253]
    ds_read_b64_tr_b16 a[222:223], v33 offset:6144
    s_waitcnt lgkmcnt(8)
    v_mfma_f32_16x16x32_bf16 v[150:153], a[0:3], a[200:203], 0
    ds_read_b64_tr_b16 a[224:225], v32 offset:4096
    v_mfma_f32_16x16x32_bf16 v[154:157], a[4:7], a[200:203], 0
    ds_read_b64_tr_b16 a[226:227], v32 offset:6144
    buffer_load_dwordx4 v61, s[24:27], s64 offen offset:2048 lds
    v_mfma_f32_16x16x32_bf16 v[166:169], a[0:3], a[204:207], 0
    ds_read_b64_tr_b16 a[228:229], v34 offset:4096
    v_cvt_pk_bf16_f32 v182, v182, v183
    v_mfma_f32_16x16x32_bf16 v[170:173], a[4:7], a[204:207], 0
    ds_read_b64_tr_b16 a[230:231], v34 offset:6144
    v_cvt_pk_bf16_f32 v183, v184, v185
    v_cvt_pk_bf16_f32 v184, v186, v187
    s_waitcnt lgkmcnt(8)
    v_mfma_f32_16x16x32_bf16 v[158:161], a[0:3], a[208:211], 0
    s_waitcnt vmcnt(15)
    s_barrier
    ds_read_b64_tr_b16 a[200:201], v39 offset:0
    buffer_load_dwordx4 v62, s[24:27], s64 offen offset:3072 lds
    v_mfma_f32_16x16x32_bf16 v[162:165], a[4:7], a[208:211], 0
    ds_read_b64_tr_b16 a[202:203], v39 offset:2048
    s_add_u32 m0, s58, 49152
    v_cvt_pk_bf16_f32 v185, v188, v189
    buffer_store_dwordx4 v[182:185], v21, s[28:31], 0 offen offset:0 sc1
    v_cvt_pk_bf16_f32 v190, v190, v191
    v_cvt_pk_bf16_f32 v191, v192, v193
    v_cvt_pk_bf16_f32 v192, v194, v195
    v_mfma_f32_16x16x32_bf16 v[174:177], a[0:3], a[212:215], 0
    ds_read_b64_tr_b16 a[204:205], v41 offset:0
    s_add_u32 s66, s66, 1
    v_mfma_f32_16x16x32_bf16 v[178:181], a[4:7], a[212:215], 0
    ds_read_b64_tr_b16 a[206:207], v41 offset:2048
    v_cvt_pk_bf16_f32 v193, v196, v197
    buffer_store_dwordx4 v[190:193], v21, s[28:31], 0 offen offset:1024 sc1
    v_cvt_pk_bf16_f32 v238, v238, v239
    v_cvt_pk_bf16_f32 v239, v240, v241
    v_cvt_pk_bf16_f32 v240, v242, v243
    s_waitcnt lgkmcnt(8)
    v_mfma_f32_16x16x32_bf16 v[150:153], a[8:11], a[216:219], v[150:153]
    ds_read_b64_tr_b16 a[208:209], v40 offset:0
    s_and_b32 s66, s66, 3
    v_mfma_f32_16x16x32_bf16 v[154:157], a[12:15], a[216:219], v[154:157]
    ds_read_b64_tr_b16 a[210:211], v40 offset:2048
    s_mul_i32 s61, s66, 100352
    buffer_load_dwordx4 v63, s[16:19], s61 offen lds
    v_cvt_pk_bf16_f32 v241, v244, v245
    buffer_store_dwordx4 v[238:241], v21, s[28:31], 0 offen offset:2048 sc1
    v_cvt_pk_bf16_f32 v246, v246, v247
    v_cvt_pk_bf16_f32 v247, v248, v249
    v_cvt_pk_bf16_f32 v248, v250, v251
    v_mfma_f32_16x16x32_bf16 v[166:169], a[8:11], a[220:223], v[166:169]
    ds_read_b64_tr_b16 a[212:213], v42 offset:0
    v_cvt_pk_bf16_f32 v249, v252, v253
    v_mfma_f32_16x16x32_bf16 v[170:173], a[12:15], a[220:223], v[170:173]
    ds_read_b64_tr_b16 a[214:215], v42 offset:2048
    s_waitcnt lgkmcnt(8)
    v_mfma_f32_16x16x32_bf16 v[158:161], a[8:11], a[224:227], v[158:161]
    ds_read_b64_tr_b16 a[216:217], v39 offset:4096
    buffer_load_dwordx4 v64, s[16:19], s61 offen offset:1024 lds
    v_mfma_f32_16x16x32_bf16 v[162:165], a[12:15], a[224:227], v[162:165]
    ds_read_b64_tr_b16 a[218:219], v39 offset:6144
    s_add_u32 s61, s61, 48128
    buffer_store_dwordx4 v[246:249], v21, s[28:31], 0 offen offset:3072 sc1
    v_mfma_f32_16x16x32_bf16 v[174:177], a[8:11], a[228:231], v[174:177]
    ds_read_b64_tr_b16 a[220:221], v41 offset:4096
    v_mfma_f32_16x16x32_bf16 v[178:181], a[12:15], a[228:231], v[178:181]
    ds_read_b64_tr_b16 a[222:223], v41 offset:6144
    s_waitcnt lgkmcnt(8)
    v_mfma_f32_16x16x32_bf16 v[150:153], a[16:19], a[200:203], v[150:153]
    ds_read_b64_tr_b16 a[224:225], v40 offset:4096
    buffer_load_dwordx4 v63, s[16:19], s61 offen offset:2048 lds
    v_mfma_f32_16x16x32_bf16 v[154:157], a[20:23], a[200:203], v[154:157]
    ds_read_b64_tr_b16 a[226:227], v40 offset:6144
    v_mfma_f32_16x16x32_bf16 v[166:169], a[16:19], a[204:207], v[166:169]
    ds_read_b64_tr_b16 a[228:229], v42 offset:4096
    v_mfma_f32_16x16x32_bf16 v[170:173], a[20:23], a[204:207], v[170:173]
    ds_read_b64_tr_b16 a[230:231], v42 offset:6144
    s_waitcnt lgkmcnt(8)
    v_mfma_f32_16x16x32_bf16 v[158:161], a[16:19], a[208:211], v[158:161]
    s_load_dword s14, s[28:29], s39
    ds_read_b64_tr_b16 a[200:201], v39 offset:16384
    buffer_load_dwordx4 v64, s[16:19], s61 offen offset:3072 lds
    v_mfma_f32_16x16x32_bf16 v[162:165], a[20:23], a[208:211], v[162:165]
    ds_read_b64_tr_b16 a[202:203], v39 offset:18432
    s_add_u32 m0, s58, 98304
    v_mfma_f32_16x16x32_bf16 v[174:177], a[16:19], a[212:215], v[174:177]
    ds_read_b64_tr_b16 a[204:205], v41 offset:16384
    s_add_u32 s66, s66, 1
    v_mfma_f32_16x16x32_bf16 v[178:181], a[20:23], a[212:215], v[178:181]
    ds_read_b64_tr_b16 a[206:207], v41 offset:18432
    s_waitcnt lgkmcnt(8)
    v_mfma_f32_16x16x32_bf16 v[150:153], a[24:27], a[216:219], v[150:153]
    ds_read_b64_tr_b16 a[208:209], v40 offset:16384
    s_and_b32 s66, s66, 3
    s_mul_i32 s61, s66, 100352
    buffer_load_dwordx4 v63, s[16:19], s61 offen lds
    v_mfma_f32_16x16x32_bf16 v[154:157], a[28:31], a[216:219], v[154:157]
    ds_read_b64_tr_b16 a[210:211], v40 offset:18432
    v_mfma_f32_16x16x32_bf16 v[166:169], a[24:27], a[220:223], v[166:169]
    ds_read_b64_tr_b16 a[212:213], v42 offset:16384
    buffer_load_dwordx4 v64, s[16:19], s61 offen offset:1024 lds
    v_mfma_f32_16x16x32_bf16 v[170:173], a[28:31], a[220:223], v[170:173]
    ds_read_b64_tr_b16 a[214:215], v42 offset:18432
    s_waitcnt lgkmcnt(8)
    v_mfma_f32_16x16x32_bf16 v[158:161], a[24:27], a[224:227], v[158:161]
    ds_read_b64_tr_b16 a[216:217], v39 offset:20480
    s_add_u32 s61, s61, 48128
    v_mfma_f32_16x16x32_bf16 v[162:165], a[28:31], a[224:227], v[162:165]
    ds_read_b64_tr_b16 a[218:219], v39 offset:22528
    v_mfma_f32_16x16x32_bf16 v[174:177], a[24:27], a[228:231], v[174:177]
    ds_read_b64_tr_b16 a[220:221], v41 offset:20480
    buffer_load_dwordx4 v63, s[16:19], s61 offen offset:2048 lds
    v_mfma_f32_16x16x32_bf16 v[178:181], a[28:31], a[228:231], v[178:181]
    ds_read_b64_tr_b16 a[222:223], v41 offset:22528
    s_waitcnt lgkmcnt(8)
    v_mfma_f32_16x16x32_bf16 v[150:153], a[32:35], a[200:203], v[150:153]
    ds_read_b64_tr_b16 a[224:225], v40 offset:20480
    v_mfma_f32_16x16x32_bf16 v[154:157], a[36:39], a[200:203], v[154:157]
    ds_read_b64_tr_b16 a[226:227], v40 offset:22528
    v_mfma_f32_16x16x32_bf16 v[166:169], a[32:35], a[204:207], v[166:169]
    ds_read_b64_tr_b16 a[228:229], v42 offset:20480
    buffer_load_dwordx4 v64, s[16:19], s61 offen offset:3072 lds
    v_mfma_f32_16x16x32_bf16 v[170:173], a[36:39], a[204:207], v[170:173]
    ds_read_b64_tr_b16 a[230:231], v42 offset:22528
    s_waitcnt lgkmcnt(8)
    v_mfma_f32_16x16x32_bf16 v[158:161], a[32:35], a[208:211], v[158:161]
    s_waitcnt vmcnt(20)
    s_barrier
    ds_read_b64_tr_b16 a[200:201], v31 offset:16384
    s_add_u32 m0, s58, 114688
    v_mfma_f32_16x16x32_bf16 v[162:165], a[36:39], a[208:211], v[162:165]
    ds_read_b64_tr_b16 a[202:203], v31 offset:18432
    s_add_u32 s66, s66, 1
    v_mfma_f32_16x16x32_bf16 v[174:177], a[32:35], a[212:215], v[174:177]
    ds_read_b64_tr_b16 a[204:205], v33 offset:16384
    s_and_b32 s66, s66, 3
    v_mfma_f32_16x16x32_bf16 v[178:181], a[36:39], a[212:215], v[178:181]
    ds_read_b64_tr_b16 a[206:207], v33 offset:18432
    s_mul_i32 s61, s66, 100352
    buffer_load_dwordx4 v63, s[16:19], s61 offen lds
    s_waitcnt lgkmcnt(8)
    v_mfma_f32_16x16x32_bf16 v[150:153], a[40:43], a[216:219], v[150:153]
    ds_read_b64_tr_b16 a[208:209], v32 offset:16384
    v_mfma_f32_16x16x32_bf16 v[154:157], a[44:47], a[216:219], v[154:157]
    ds_read_b64_tr_b16 a[210:211], v32 offset:18432
    buffer_load_dwordx4 v64, s[16:19], s61 offen offset:1024 lds
    v_mfma_f32_16x16x32_bf16 v[166:169], a[40:43], a[220:223], v[166:169]
    ds_read_b64_tr_b16 a[212:213], v34 offset:16384
    s_add_u32 s61, s61, 48128
    v_mfma_f32_16x16x32_bf16 v[170:173], a[44:47], a[220:223], v[170:173]
    ds_read_b64_tr_b16 a[214:215], v34 offset:18432
    s_waitcnt lgkmcnt(8)
    v_mfma_f32_16x16x32_bf16 v[158:161], a[40:43], a[224:227], v[158:161]
    ds_read_b64_tr_b16 a[216:217], v31 offset:20480
    v_mfma_f32_16x16x32_bf16 v[162:165], a[44:47], a[224:227], v[162:165]
    ds_read_b64_tr_b16 a[218:219], v31 offset:22528
    buffer_load_dwordx4 v63, s[16:19], s61 offen offset:2048 lds
    v_mfma_f32_16x16x32_bf16 v[174:177], a[40:43], a[228:231], v[174:177]
    ds_read_b64_tr_b16 a[220:221], v33 offset:20480
    v_mfma_f32_16x16x32_bf16 v[178:181], a[44:47], a[228:231], v[178:181]
    ds_read_b64_tr_b16 a[222:223], v33 offset:22528
    s_waitcnt lgkmcnt(8)
    v_mfma_f32_16x16x32_bf16 v[150:153], a[48:51], a[200:203], v[150:153]
    ds_read_b64_tr_b16 a[224:225], v32 offset:20480
    v_mfma_f32_16x16x32_bf16 v[154:157], a[52:55], a[200:203], v[154:157]
    ds_read_b64_tr_b16 a[226:227], v32 offset:22528
    buffer_load_dwordx4 v64, s[16:19], s61 offen offset:3072 lds
    v_mfma_f32_16x16x32_bf16 v[166:169], a[48:51], a[204:207], v[166:169]
    ds_read_b64_tr_b16 a[228:229], v34 offset:20480
    v_mfma_f32_16x16x32_bf16 v[170:173], a[52:55], a[204:207], v[170:173]
    ds_read_b64_tr_b16 a[230:231], v34 offset:22528
    s_waitcnt lgkmcnt(8)
    v_mfma_f32_16x16x32_bf16 v[158:161], a[48:51], a[208:211], v[158:161]
    s_waitcnt vmcnt(10)
    s_atomic_add s36, s[28:29], s55
    ds_read_b64_tr_b16 a[200:201], v35 offset:0
    v_mfma_f32_16x16x32_bf16 v[162:165], a[52:55], a[208:211], v[162:165]
    ds_read_b64_tr_b16 a[202:203], v35 offset:2048
    v_mfma_f32_16x16x32_bf16 v[174:177], a[48:51], a[212:215], v[174:177]
    ds_read_b64_tr_b16 a[204:205], v37 offset:0
    v_mfma_f32_16x16x32_bf16 v[178:181], a[52:55], a[212:215], v[178:181]
    ds_read_b64_tr_b16 a[206:207], v37 offset:2048
    s_waitcnt lgkmcnt(8)
    v_mfma_f32_16x16x32_bf16 v[150:153], a[56:59], a[216:219], v[150:153]
    ds_read_b64_tr_b16 a[208:209], v36 offset:0
    v_mfma_f32_16x16x32_bf16 v[154:157], a[60:63], a[216:219], v[154:157]
    ds_read_b64_tr_b16 a[210:211], v36 offset:2048
    v_mfma_f32_16x16x32_bf16 v[166:169], a[56:59], a[220:223], v[166:169]
    ds_read_b64_tr_b16 a[212:213], v38 offset:0
    v_mfma_f32_16x16x32_bf16 v[170:173], a[60:63], a[220:223], v[170:173]
    ds_read_b64_tr_b16 a[214:215], v38 offset:2048
    s_waitcnt lgkmcnt(8)
    v_mfma_f32_16x16x32_bf16 v[158:161], a[56:59], a[224:227], v[158:161]
    ds_read_b64_tr_b16 a[216:217], v35 offset:4096
    v_mfma_f32_16x16x32_bf16 v[162:165], a[60:63], a[224:227], v[162:165]
    ds_read_b64_tr_b16 a[218:219], v35 offset:6144
    v_mfma_f32_16x16x32_bf16 v[174:177], a[56:59], a[228:231], v[174:177]
    ds_read_b64_tr_b16 a[220:221], v37 offset:4096
    v_mfma_f32_16x16x32_bf16 v[178:181], a[60:63], a[228:231], v[178:181]
    ds_read_b64_tr_b16 a[222:223], v37 offset:6144
    s_waitcnt lgkmcnt(8)
    v_mfma_f32_16x16x32_bf16 v[150:153], a[64:67], a[200:203], v[150:153]
    s_waitcnt lgkmcnt(0)
    s_cmp_ge_u32 s14, 8
    s_cbranch_scc0 L_pollin6
L_pollok6:
    ds_read_b64_tr_b16 a[224:225], v36 offset:4096
    s_add_u32 m0, s58, 0
    s_add_u32 s51, s51, 1
    s_and_b32 s51, s51, 3
    s_lshl_b32 s61, s51, 12
    buffer_load_dwordx4 v65, s[28:31], s61 offen sc1 lds
    v_mfma_f32_16x16x32_bf16 v[154:157], a[68:71], a[200:203], v[154:157]
    ds_read_b64_tr_b16 a[226:227], v36 offset:6144
    v_mfma_f32_16x16x32_bf16 v[166:169], a[64:67], a[204:207], v[166:169]
    ds_read_b64_tr_b16 a[228:229], v38 offset:4096
    buffer_load_dwordx4 v66, s[28:31], s61 offen offset:1024 sc1 lds
    v_mfma_f32_16x16x32_bf16 v[170:173], a[68:71], a[204:207], v[170:173]
    ds_read_b64_tr_b16 a[230:231], v38 offset:6144
    v_mfma_f32_16x16x32_bf16 v[158:161], a[64:67], a[208:211], v[158:161]
    s_barrier
    ds_read_b64_tr_b16 a[200:201], v35 offset:16384
    buffer_load_dwordx4 v65, s[28:31], s61 offen offset:2048 sc1 lds
    v_mfma_f32_16x16x32_bf16 v[162:165], a[68:71], a[208:211], v[162:165]
    ds_read_b64_tr_b16 a[202:203], v35 offset:18432
    v_mfma_f32_16x16x32_bf16 v[174:177], a[64:67], a[212:215], v[174:177]
    ds_read_b64_tr_b16 a[204:205], v37 offset:16384
    v_mfma_f32_16x16x32_bf16 v[178:181], a[68:71], a[212:215], v[178:181]
    ds_read_b64_tr_b16 a[206:207], v37 offset:18432
    v_mfma_f32_16x16x32_bf16 v[150:153], a[72:75], a[216:219], v[150:153]
    ds_read_b64_tr_b16 a[208:209], v36 offset:16384
    buffer_load_dwordx4 v66, s[28:31], s61 offen offset:3072 sc1 lds
    v_mfma_f32_16x16x32_bf16 v[154:157], a[76:79], a[216:219], v[154:157]
    ds_read_b64_tr_b16 a[210:211], v36 offset:18432
    s_add_u32 m0, s58, 131072
    v_mfma_f32_16x16x32_bf16 v[166:169], a[72:75], a[220:223], v[166:169]
    ds_read_b64_tr_b16 a[212:213], v38 offset:16384
    s_add_u32 s51, s51, 1
    v_mfma_f32_16x16x32_bf16 v[170:173], a[76:79], a[220:223], v[170:173]
    ds_read_b64_tr_b16 a[214:215], v38 offset:18432
    s_waitcnt lgkmcnt(8)
    v_mfma_f32_16x16x32_bf16 v[158:161], a[72:75], a[224:227], v[158:161]
    ds_read_b64_tr_b16 a[216:217], v35 offset:20480
    s_and_b32 s51, s51, 3
    s_lshl_b32 s61, s51, 12
    buffer_load_dwordx4 v65, s[28:31], s61 offen sc1 lds
    v_mfma_f32_16x16x32_bf16 v[162:165], a[76:79], a[224:227], v[162:165]
    ds_read_b64_tr_b16 a[218:219], v35 offset:22528
    v_mfma_f32_16x16x32_bf16 v[174:177], a[72:75], a[228:231], v[174:177]
    ds_read_b64_tr_b16 a[220:221], v37 offset:20480
    buffer_load_dwordx4 v66, s[28:31], s61 offen offset:1024 sc1 lds
    v_mfma_f32_16x16x32_bf16 v[178:181], a[76:79], a[228:231], v[178:181]
    ds_read_b64_tr_b16 a[222:223], v37 offset:22528
    s_waitcnt lgkmcnt(8)
    v_mfma_f32_16x16x32_bf16 v[150:153], a[80:83], a[200:203], v[150:153]
    ds_read_b64_tr_b16 a[224:225], v36 offset:20480
    v_mfma_f32_16x16x32_bf16 v[154:157], a[84:87], a[200:203], v[154:157]
    ds_read_b64_tr_b16 a[226:227], v36 offset:22528
    buffer_load_dwordx4 v65, s[28:31], s61 offen offset:2048 sc1 lds
    v_mfma_f32_16x16x32_bf16 v[166:169], a[80:83], a[204:207], v[166:169]
    ds_read_b64_tr_b16 a[228:229], v38 offset:20480
    v_mfma_f32_16x16x32_bf16 v[170:173], a[84:87], a[204:207], v[170:173]
    ds_read_b64_tr_b16 a[230:231], v38 offset:22528
    s_waitcnt lgkmcnt(8)
    v_mfma_f32_16x16x32_bf16 v[158:161], a[80:83], a[208:211], v[158:161]
    s_barrier
    ds_read_b64_tr_b16 a[200:201], v31 offset:32768
    buffer_load_dwordx4 v66, s[28:31], s61 offen offset:3072 sc1 lds
    v_mfma_f32_16x16x32_bf16 v[162:165], a[84:87], a[208:211], v[162:165]
    ds_read_b64_tr_b16 a[202:203], v31 offset:34816
    s_add_u32 m0, s58, 147456
    v_mfma_f32_16x16x32_bf16 v[174:177], a[80:83], a[212:215], v[174:177]
    ds_read_b64_tr_b16 a[204:205], v33 offset:32768
    s_add_u32 s51, s51, 1
    v_mfma_f32_16x16x32_bf16 v[178:181], a[84:87], a[212:215], v[178:181]
    ds_read_b64_tr_b16 a[206:207], v33 offset:34816
    s_waitcnt lgkmcnt(8)
    v_mfma_f32_16x16x32_bf16 v[150:153], a[88:91], a[216:219], v[150:153]
    ds_read_b64_tr_b16 a[208:209], v32 offset:32768
    s_and_b32 s51, s51, 3
    s_lshl_b32 s61, s51, 12
    buffer_load_dwordx4 v65, s[28:31], s61 offen sc1 lds
    v_mfma_f32_16x16x32_bf16 v[154:157], a[92:95], a[216:219], v[154:157]
    ds_read_b64_tr_b16 a[210:211], v32 offset:34816
    v_mfma_f32_16x16x32_bf16 v[166:169], a[88:91], a[220:223], v[166:169]
    ds_read_b64_tr_b16 a[212:213], v34 offset:32768
    buffer_load_dwordx4 v66, s[28:31], s61 offen offset:1024 sc1 lds
    v_mfma_f32_16x16x32_bf16 v[170:173], a[92:95], a[220:223], v[170:173]
    ds_read_b64_tr_b16 a[214:215], v34 offset:34816
    s_waitcnt lgkmcnt(8)
    v_mfma_f32_16x16x32_bf16 v[158:161], a[88:91], a[224:227], v[158:161]
    ds_read_b64_tr_b16 a[216:217], v31 offset:36864
    v_mfma_f32_16x16x32_bf16 v[162:165], a[92:95], a[224:227], v[162:165]
    ds_read_b64_tr_b16 a[218:219], v31 offset:38912
    buffer_load_dwordx4 v65, s[28:31], s61 offen offset:2048 sc1 lds
    v_mfma_f32_16x16x32_bf16 v[174:177], a[88:91], a[228:231], v[174:177]
    ds_read_b64_tr_b16 a[220:221], v33 offset:36864
    v_mfma_f32_16x16x32_bf16 v[178:181], a[92:95], a[228:231], v[178:181]
    ds_read_b64_tr_b16 a[222:223], v33 offset:38912
    s_waitcnt lgkmcnt(8)
    v_mfma_f32_16x16x32_bf16 v[150:153], a[96:99], a[200:203], v[150:153]
    ds_read_b64_tr_b16 a[224:225], v32 offset:36864
    buffer_load_dwordx4 v66, s[28:31], s61 offen offset:3072 sc1 lds
    v_mfma_f32_16x16x32_bf16 v[154:157], a[100:103], a[200:203], v[154:157]
    ds_read_b64_tr_b16 a[226:227], v32 offset:38912
    s_add_u32 m0, s58, 16384
    v_mfma_f32_16x16x32_bf16 v[166:169], a[96:99], a[204:207], v[166:169]
    ds_read_b64_tr_b16 a[228:229], v34 offset:36864
    s_add_u32 s66, s66, 1
    v_mfma_f32_16x16x32_bf16 v[170:173], a[100:103], a[204:207], v[170:173]
    ds_read_b64_tr_b16 a[230:231], v34 offset:38912
    s_waitcnt lgkmcnt(8)
    v_mfma_f32_16x16x32_bf16 v[158:161], a[96:99], a[208:211], v[158:161]
    s_waitcnt vmcnt(8)
    s_barrier
    s_xor_b32 s55, s55, 1024
    s_load_dword s14, s[28:29], s55
    ds_read_b64_tr_b16 v[198:199], v43 offset:49152
    ds_read_b64_tr_b16 v[200:201], v43 offset:53248
    s_and_b32 s66, s66, 3
    s_mul_i32 s61, s66, 100352
    buffer_load_dwordx4 v63, s[16:19], s61 offen lds
    v_mfma_f32_16x16x32_bf16 v[162:165], a[100:103], a[208:211], v[162:165]
    ds_read_b64_tr_b16 v[202:203], v44 offset:49152
    v_mfma_f32_16x16x32_bf16 v[174:177], a[96:99], a[212:215], v[174:177]
    ds_read_b64_tr_b16 v[204:205], v44 offset:53248
    buffer_load_dwordx4 v64, s[16:19], s61 offen offset:1024 lds
    v_mfma_f32_16x16x32_bf16 v[178:181], a[100:103], a[212:215], v[178:181]
    ds_read_b128 a[200:203], v47 offset:0
    s_waitcnt lgkmcnt(9)
    v_mfma_f32_16x16x32_bf16 v[150:153], a[104:107], a[216:219], v[150:153]
    ds_read_b128 a[204:207], v48 offset:0
    s_add_u32 s61, s61, 48128
    v_mfma_f32_16x16x32_bf16 v[154:157], a[108:111], a[216:219], v[154:157]
    ds_read_b128 a[208:211], v47 offset:1024
    buffer_load_dwordx4 v63, s[16:19], s61 offen offset:2048 lds
    v_mfma_f32_16x16x32_bf16 v[166:169], a[104:107], a[220:223], v[166:169]
    ds_read_b128 a[212:215], v48 offset:1024
    v_mfma_f32_16x16x32_bf16 v[170:173], a[108:111], a[220:223], v[170:173]
    s_waitcnt lgkmcnt(8)
    v_mfma_f32_16x16x32_bf16 v[158:161], a[104:107], a[224:227], v[158:161]
    ds_read_b64_tr_b16 v[206:207], v43 offset:51200
    ds_read_b64_tr_b16 v[208:209], v43 offset:55296
    v_mfma_f32_16x16x32_bf16 v[162:165], a[108:111], a[224:227], v[162:165]
    ds_read_b64_tr_b16 v[210:211], v44 offset:51200
    buffer_load_dwordx4 v64, s[16:19], s61 offen offset:3072 lds
    v_mfma_f32_16x16x32_bf16 v[174:177], a[104:107], a[228:231], v[174:177]
    ds_read_b64_tr_b16 v[212:213], v44 offset:55296
    s_add_u32 m0, s58, 65536
    v_mfma_f32_16x16x32_bf16 v[178:181], a[108:111], a[228:231], v[178:181]
    ds_read_b128 a[216:219], v47 offset:2048
    s_waitcnt lgkmcnt(7)
    v_mfma_f32_16x16x32_bf16 v[150:153], v[198:201], a[200:203], v[150:153]
    ds_read_b128 a[220:223], v48 offset:2048
    s_add_u32 s51, s51, 1
    s_and_b32 s51, s51, 3
    s_lshl_b32 s61, s51, 12
    buffer_load_dwordx4 v65, s[28:31], s61 offen sc1 lds
    v_mfma_f32_16x16x32_bf16 v[154:157], v[202:205], a[200:203], v[154:157]
    ds_read_b128 a[224:227], v47 offset:3072
    v_mfma_f32_16x16x32_bf16 v[166:169], v[198:201], a[204:207], v[166:169]
    ds_read_b128 a[228:231], v48 offset:3072
    buffer_load_dwordx4 v66, s[28:31], s61 offen offset:1024 sc1 lds
    v_mfma_f32_16x16x32_bf16 v[170:173], v[202:205], a[204:207], v[170:173]
    s_waitcnt lgkmcnt(8)
    v_mfma_f32_16x16x32_bf16 v[158:161], v[198:201], a[208:211], v[158:161]
    s_waitcnt vmcnt(10)
    s_barrier
    ds_read_b64_tr_b16 v[214:215], v45 offset:32768
    ds_read_b64_tr_b16 v[216:217], v45 offset:36864
    v_mfma_f32_16x16x32_bf16 v[162:165], v[202:205], a[208:211], v[162:165]
    ds_read_b64_tr_b16 v[218:219], v46 offset:32768
    buffer_load_dwordx4 v65, s[28:31], s61 offen offset:2048 sc1 lds
    v_mfma_f32_16x16x32_bf16 v[174:177], v[198:201], a[212:215], v[174:177]
    ds_read_b64_tr_b16 v[220:221], v46 offset:36864
    v_mfma_f32_16x16x32_bf16 v[178:181], v[202:205], a[212:215], v[178:181]
    ds_read_b128 a[200:203], v51 offset:0
    s_waitcnt lgkmcnt(7)
    v_mfma_f32_16x16x32_bf16 v[150:153], v[206:209], a[216:219], v[150:153]
    ds_read_b128 a[204:207], v52 offset:0
    buffer_load_dwordx4 v66, s[28:31], s61 offen offset:3072 sc1 lds
    v_mfma_f32_16x16x32_bf16 v[154:157], v[210:213], a[216:219], v[154:157]
    ds_read_b128 a[208:211], v51 offset:1024
    v_mfma_f32_16x16x32_bf16 v[166:169], v[206:209], a[220:223], v[166:169]
    ds_read_b128 a[212:215], v52 offset:1024
    v_mfma_f32_16x16x32_bf16 v[170:173], v[210:213], a[220:223], v[170:173]
    s_waitcnt lgkmcnt(8)
    v_mfma_f32_16x16x32_bf16 v[158:161], v[206:209], a[224:227], v[158:161]
    s_waitcnt lgkmcnt(0)
    s_cmp_ge_u32 s14, 1
    s_cbranch_scc0 L_pollin7
L_pollok7:
    v_xor_b32 v21, 131072, v21
    ds_read_b64_tr_b16 v[198:199], v45 offset:34816
    ds_read_b64_tr_b16 v[200:201], v45 offset:38912
    buffer_load_dwordx4 v[246:249], v21, s[28:31], 0 offen offset:2048 sc1
    v_mfma_f32_16x16x32_bf16 v[162:165], v[210:213], a[224:227], v[162:165]
    ds_read_b64_tr_b16 v[202:203], v46 offset:34816
    buffer_load_dwordx4 v[250:253], v21, s[28:31], 0 offen offset:3072 sc1
    v_mfma_f32_16x16x32_bf16 v[174:177], v[206:209], a[228:231], v[174:177]
    ds_read_b64_tr_b16 v[204:205], v46 offset:38912
    v_mfma_f32_16x16x32_bf16 v[178:181], v[210:213], a[228:231], v[178:181]
    ds_read_b128 a[216:219], v51 offset:2048
    v_mfma_f32_16x16x32_bf16 v[150:153], v[214:217], a[200:203], v[150:153]
    ds_read_b128 a[220:223], v52 offset:2048
    buffer_load_dwordx4 v[238:241], v21, s[28:31], 0 offen offset:0 sc1
    v_mfma_f32_16x16x32_bf16 v[154:157], v[218:221], a[200:203], v[154:157]
    ds_read_b128 a[224:227], v51 offset:3072
    buffer_load_dwordx4 v[242:245], v21, s[28:31], 0 offen offset:1024 sc1
    v_mfma_f32_16x16x32_bf16 v[166:169], v[214:217], a[204:207], v[166:169]
    ds_read_b128 a[228:231], v52 offset:3072
    v_mfma_f32_16x16x32_bf16 v[170:173], v[218:221], a[204:207], v[170:173]
    v_mfma_f32_16x16x32_bf16 v[158:161], v[214:217], a[208:211], v[158:161]
    s_waitcnt vmcnt(12)
    s_barrier
    ds_read_b64_tr_b16 v[206:207], v45 offset:49152
    ds_read_b64_tr_b16 v[208:209], v45 offset:53248
    v_mfma_f32_16x16x32_bf16 v[162:165], v[218:221], a[208:211], v[162:165]
    ds_read_b64_tr_b16 v[210:211], v46 offset:49152
    v_mfma_f32_16x16x32_bf16 v[174:177], v[214:217], a[212:215], v[174:177]
    ds_read_b64_tr_b16 v[212:213], v46 offset:53248
    v_mfma_f32_16x16x32_bf16 v[178:181], v[218:221], a[212:215], v[178:181]
    ds_read_b128 a[200:203], v51 offset:16384
    s_waitcnt lgkmcnt(7)
    v_mfma_f32_16x16x32_bf16 v[150:153], v[198:201], a[216:219], v[150:153]
    ds_read_b128 a[204:207], v52 offset:16384
    v_mfma_f32_16x16x32_bf16 v[154:157], v[202:205], a[216:219], v[154:157]
    ds_read_b128 a[208:211], v51 offset:17408
    v_mfma_f32_16x16x32_bf16 v[166:169], v[198:201], a[220:223], v[166:169]
    ds_read_b128 a[212:215], v52 offset:17408
    v_mfma_f32_16x16x32_bf16 v[170:173], v[202:205], a[220:223], v[170:173]
    s_waitcnt lgkmcnt(8)
    v_mfma_f32_16x16x32_bf16 v[158:161], v[198:201], a[224:227], v[158:161]
    ds_read_b64_tr_b16 v[214:215], v45 offset:51200
    ds_read_b64_tr_b16 v[216:217], v45 offset:55296
    v_mfma_f32_16x16x32_bf16 v[162:165], v[202:205], a[224:227], v[162:165]
    ds_read_b64_tr_b16 v[218:219], v46 offset:51200
    v_mfma_f32_16x16x32_bf16 v[174:177], v[198:201], a[228:231], v[174:177]
    ds_read_b64_tr_b16 v[220:221], v46 offset:55296
    v_mfma_f32_16x16x32_bf16 v[178:181], v[202:205], a[228:231], v[178:181]
    ds_read_b128 a[216:219], v51 offset:18432
    s_waitcnt lgkmcnt(7)
    v_mfma_f32_16x16x32_bf16 v[150:153], v[206:209], a[200:203], v[150:153]
    ds_read_b128 a[220:223], v52 offset:18432
    v_mfma_f32_16x16x32_bf16 v[154:157], v[210:213], a[200:203], v[154:157]
    ds_read_b128 a[224:227], v51 offset:19456
    v_mfma_f32_16x16x32_bf16 v[166:169], v[206:209], a[204:207], v[166:169]
    ds_read_b128 a[228:231], v52 offset:19456
    v_mfma_f32_16x16x32_bf16 v[170:173], v[210:213], a[204:207], v[170:173]
    s_waitcnt lgkmcnt(8)
    v_mfma_f32_16x16x32_bf16 v[158:161], v[206:209], a[208:211], v[158:161]
    s_waitcnt vmcnt(4)
    s_barrier
    ds_read_b64_tr_b16 v[198:199], v43 offset:16384
    ds_read_b64_tr_b16 v[200:201], v43 offset:20480
    v_mfma_f32_16x16x32_bf16 v[162:165], v[210:213], a[208:211], v[162:165]
    ds_read_b64_tr_b16 v[202:203], v44 offset:16384
    v_mfma_f32_16x16x32_bf16 v[174:177], v[206:209], a[212:215], v[174:177]
    ds_read_b64_tr_b16 v[204:205], v44 offset:20480
    v_mfma_f32_16x16x32_bf16 v[178:181], v[210:213], a[212:215], v[178:181]
    ds_read_b128 a[200:203], v50 offset:0
    s_waitcnt lgkmcnt(7)
    v_mfma_f32_16x16x32_bf16 v[150:153], v[214:217], a[216:219], v[150:153]
    ds_read_b128 a[204:207], v50 offset:1024
    ds_read_b64_tr_b16 v[206:207], v43 offset:18432
    v_mfma_f32_16x16x32_bf16 v[154:157], v[218:221], a[216:219], v[154:157]
    ds_read_b64_tr_b16 v[208:209], v43 offset:22528
    ds_read_b64_tr_b16 v[210:211], v44 offset:18432
    v_mfma_f32_16x16x32_bf16 v[166:169], v[214:217], a[220:223], v[166:169]
    ds_read_b64_tr_b16 v[212:213], v44 offset:22528
    v_mfma_f32_16x16x32_bf16 v[170:173], v[218:221], a[220:223], v[170:173]
    ds_read_b128 a[208:211], v50 offset:2048
    s_waitcnt lgkmcnt(11)
    v_mfma_f32_16x16x32_bf16 v[158:161], v[214:217], a[224:227], v[158:161]
    ds_read_b128 a[212:215], v50 offset:3072
    v_mfma_f32_16x16x32_bf16 v[162:165], v[218:221], a[224:227], v[162:165]
    v_mfma_f32_16x16x32_bf16 v[174:177], v[214:217], a[228:231], v[174:177]
    v_mfma_f32_16x16x32_bf16 v[178:181], v[218:221], a[228:231], v[178:181]
    s_waitcnt lgkmcnt(6)
    v_mfma_f32_16x16x32_bf16 v[166:169], v[198:201], a[200:203], v[166:169]
    ds_read_b128 a[224:227], v49 offset:0
    v_mfma_f32_16x16x32_bf16 v[170:173], v[202:205], a[200:203], v[170:173]
    v_mfma_f32_16x16x32_bf16 v[174:177], v[198:201], a[204:207], v[174:177]
    ds_read_b128 a[228:231], v49 offset:1024
    v_mfma_f32_16x16x32_bf16 v[178:181], v[202:205], a[204:207], v[178:181]
    s_waitcnt lgkmcnt(2)
    v_mfma_f32_16x16x32_bf16 v[166:169], v[206:209], a[208:211], v[166:169]
    ds_read_b128 a[200:203], v49 offset:2048
    v_mfma_f32_16x16x32_bf16 v[170:173], v[210:213], a[208:211], v[170:173]
    v_mfma_f32_16x16x32_bf16 v[174:177], v[206:209], a[212:215], v[174:177]
    ds_read_b128 a[204:207], v49 offset:3072
L_pad4:
    s_cbranch_execz L_warm
    v_mfma_f32_16x16x32_bf16 v[178:181], v[210:213], a[212:215], v[178:181]
    s_waitcnt vmcnt(3)
    v_mfma_f32_16x16x32_bf16 v[166:169], a[250:253], v[246:249], v[166:169]
    v_mfma_f32_16x16x32_bf16 v[170:173], a[248:251], v[246:249], v[170:173]
    s_waitcnt vmcnt(2)
    v_mfma_f32_16x16x32_bf16 v[174:177], a[250:253], v[250:253], v[174:177]
    v_mfma_f32_16x16x32_bf16 v[178:181], a[248:251], v[250:253], v[178:181]
    s_waitcnt lgkmcnt(2)
    v_mfma_f32_16x16x32_bf16 v[150:153], v[198:201], a[224:227], v[150:153]
    v_mfma_f32_16x16x32_bf16 v[154:157], v[202:205], a[224:227], v[154:157]
    v_mfma_f32_16x16x32_bf16 v[158:161], v[198:201], a[228:231], v[158:161]
    ds_write_b128 v87, v[166:169] offset:8192
    v_mfma_f32_16x16x32_bf16 v[162:165], v[202:205], a[228:231], v[162:165]
    s_waitcnt lgkmcnt(1)
    v_mfma_f32_16x16x32_bf16 v[150:153], v[206:209], a[200:203], v[150:153]
    ds_write_b128 v88, v[170:173] offset:8192
    v_mfma_f32_16x16x32_bf16 v[154:157], v[210:213], a[200:203], v[154:157]
    v_mfma_f32_16x16x32_bf16 v[158:161], v[206:209], a[204:207], v[158:161]
    ds_write_b128 v87, v[174:177] offset:12288
    v_mfma_f32_16x16x32_bf16 v[162:165], v[210:213], a[204:207], v[162:165]
    s_waitcnt vmcnt(1)
    v_mfma_f32_16x16x32_bf16 v[150:153], a[250:253], v[238:241], v[150:153]
    ds_write_b128 v88, v[178:181] offset:12288
    v_mfma_f32_16x16x32_bf16 v[154:157], a[248:251], v[238:241], v[154:157]
    s_waitcnt vmcnt(0)
    v_mfma_f32_16x16x32_bf16 v[158:161], a[250:253], v[242:245], v[158:161]
    v_mfma_f32_16x16x32_bf16 v[162:165], a[248:251], v[242:245], v[162:165]
    s_nop 2
    ds_write_b128 v87, v[150:153] offset:0
    s_nop 0
    ds_write_b128 v88, v[154:157] offset:0
    s_nop 0
    ds_write_b128 v87, v[158:161] offset:4096
    ds_write_b128 v88, v[162:165] offset:4096
    s_waitcnt lgkmcnt(0)
    s_barrier
    ds_read_b128 v[118:121], v89 offset:0
    ds_read_b128 v[122:125], v90 offset:0
    ds_read_b128 v[126:129], v91 offset:0
    ds_read_b128 v[130:133], v92 offset:0
    ds_read_b128 v[134:137], v89 offset:2048
    ds_read_b128 v[138:141], v90 offset:2048
    ds_read_b128 v[142:145], v91 offset:2048
    ds_read_b128 v[146:149], v92 offset:2048
    s_waitcnt lgkmcnt(7)
    v_pk_add_f32 v[222:223], v[222:223], v[118:119]
    v_pk_add_f32 v[224:225], v[224:225], v[120:121]
    s_waitcnt lgkmcnt(6)
    v_pk_add_f32 v[226:227], v[226:227], v[122:123]
    v_pk_add_f32 v[228:229], v[228:229], v[124:125]
    s_waitcnt lgkmcnt(5)
    v_pk_add_f32 v[222:223], v[222:223], v[126:127]
    v_pk_add_f32 v[224:225], v[224:225], v[128:129]
    s_waitcnt lgkmcnt(4)
    v_pk_add_f32 v[226:227], v[226:227], v[130:131]
    v_pk_add_f32 v[228:229], v[228:229], v[132:133]
    v_cvt_pk_bf16_f32 v110, v222, v223
    v_cvt_pk_bf16_f32 v111, v224, v225
    v_cvt_pk_bf16_f32 v112, v226, v227
    v_cvt_pk_bf16_f32 v113, v228, v229
    buffer_store_dwordx4 v[110:113], v85, s[32:35], 0 offen
    s_waitcnt lgkmcnt(3)
    v_pk_add_f32 v[230:231], v[230:231], v[134:135]
    v_pk_add_f32 v[232:233], v[232:233], v[136:137]
    s_waitcnt lgkmcnt(2)
    v_pk_add_f32 v[234:235], v[234:235], v[138:139]
    v_pk_add_f32 v[236:237], v[236:237], v[140:141]
    s_waitcnt lgkmcnt(1)
    v_pk_add_f32 v[230:231], v[230:231], v[142:143]
    v_pk_add_f32 v[232:233], v[232:233], v[144:145]
    s_waitcnt lgkmcnt(0)
    v_pk_add_f32 v[234:235], v[234:235], v[146:147]
    v_pk_add_f32 v[236:237], v[236:237], v[148:149]
    v_cvt_pk_bf16_f32 v114, v230, v231
    v_cvt_pk_bf16_f32 v115, v232, v233
    v_cvt_pk_bf16_f32 v116, v234, v235
    v_cvt_pk_bf16_f32 v117, v236, v237
    buffer_store_dwordx4 v[114:117], v86, s[32:35], 0 offen
L_fin:
L_end:
    s_endpgm
L_nonce:
    buffer_load_dword v12, v16, s[44:47], 0 offen sc1
    s_add_u32 s60, s60, 1
    s_waitcnt vmcnt(0)
    v_readfirstlane_b32 s57, v12
    s_cmp_ge_u32 s60, 20000
    s_cbranch_scc1 L_nonce_ok
    s_cmp_eq_u32 s57, 0
    s_cbranch_scc1 L_nonce
    s_branch L_nonce_ok
L_pollin0:
    s_mov_b32 s60, 0
L_poll0:
    s_sleep 4
    buffer_load_dword v18, v20, s[28:31], 0 offen sc1
    s_add_u32 s60, s60, 1
    s_waitcnt vmcnt(0)
    v_cmp_ne_u32 vcc, s57, v18
    s_cbranch_vccz L_pollok0
    s_cmp_lt_u32 s60, 20000
    s_cbranch_scc1 L_poll0
    s_branch L_pollok0
L_pollin1:
    s_mov_b32 s60, 0
    s_branch L_poll1a
L_poll1:
    s_sleep 8
L_poll1a:
    buffer_load_dword v18, off, s[44:47], s15 sc1
    s_add_u32 s60, s60, 1
    s_waitcnt vmcnt(0)
    v_readfirstlane_b32 s14, v18
    s_nop 0
    s_cmp_ge_u32 s14, 14
    s_cbranch_scc1 L_pollok1
    s_cmp_lt_u32 s60, 20000
    s_cbranch_scc1 L_poll1
    s_branch L_pollok1
L_pollin2:
    s_mov_b32 s60, 0
    s_branch L_poll2a
L_poll2:
    s_sleep 4
L_poll2a:
    buffer_load_dword v18, off, s[28:31], s37 sc1
    s_add_u32 s60, s60, 1
    s_waitcnt vmcnt(0)
    v_readfirstlane_b32 s14, v18
    s_nop 0
    s_cmp_ge_u32 s14, 2
    s_cbranch_scc1 L_pollok2
    s_cmp_lt_u32 s60, 20000
    s_cbranch_scc1 L_poll2
    s_branch L_pollok2
L_nonceh:
    buffer_load_dword v12, v16, s[44:47], 0 offen sc1
    s_add_u32 s60, s60, 1
    s_waitcnt vmcnt(0)
    v_readfirstlane_b32 s57, v12
    s_cmp_ge_u32 s60, 20000
    s_cbranch_scc1 L_nonce_okh
    s_cmp_eq_u32 s57, 0
    s_cbranch_scc1 L_nonceh
    s_branch L_nonce_okh
L_pollin3:
    s_mov_b32 s60, 0
L_poll3:
    s_sleep 8
    buffer_load_dword v18, v20, s[28:31], 0 offen sc1
    s_add_u32 s60, s60, 1
    s_waitcnt vmcnt(0)
    v_cmp_ne_u32 vcc, s57, v18
    s_cbranch_vccz L_pollok3
    s_cmp_lt_u32 s60, 20000
    s_cbranch_scc1 L_poll3
    s_branch L_pollok3
L_pollin4:
    s_mov_b32 s60, 0
    s_branch L_poll4a
L_poll4:
    s_sleep 16
L_poll4a:
    buffer_load_dword v18, off, s[44:47], s15 sc1
    s_add_u32 s60, s60, 1
    s_waitcnt vmcnt(0)
    v_readfirstlane_b32 s14, v18
    s_nop 0
    s_cmp_ge_u32 s14, 14
    s_cbranch_scc1 L_pollok4
    s_cmp_lt_u32 s60, 20000
    s_cbranch_scc1 L_poll4
    s_branch L_pollok4
L_nog1:
    s_nop 1
    s_mov_b32 s14, 1204224
    s_mov_b32 s15, 0x20000
    s_sub_u32 s3, s2, 200
    s_cmp_lt_u32 s3, 42
    s_cselect_b32 s81, 0, 268435456
    s_cselect_b32 s3, s3, 0
    s_mul_i32 s79, s3, 43
    s_lshr_b32 s79, s79, 7
    s_mul_i32 s80, s79, 3
    s_sub_u32 s80, s3, s80
    v_min_u32 v13, 55, v1
    s_lshl_b32 s3, s79, 2
    s_add_u32 s3, s3, s48
    s_mul_i32 s3, s3, 21504
    s_mul_i32 s60, s80, 896
    s_add_u32 s3, s3, s60
    s_add_u32 s3, s3, s81
    v_lshl_add_u32 v242, v13, 4, s3
    s_mul_i32 s60, s48, 8448
    s_add_u32 m0, s60, 0
    s_mov_b32 s3, 0
    buffer_load_dwordx4 v242, s[12:15], s3 offen lds
    s_add_u32 m0, s60, 1056
    s_mov_b32 s3, 2688
    buffer_load_dwordx4 v242, s[12:15], s3 offen lds
    s_add_u32 m0, s60, 2112
    s_mov_b32 s3, 5376
    buffer_load_dwordx4 v242, s[12:15], s3 offen lds
    s_add_u32 m0, s60, 3168
    s_mov_b32 s3, 8064
    buffer_load_dwordx4 v242, s[12:15], s3 offen lds
    s_add_u32 m0, s60, 4224
    s_mov_b32 s3, 10752
    buffer_load_dwordx4 v242, s[12:15], s3 offen lds
    s_add_u32 m0, s60, 5280
    s_mov_b32 s3, 13440
    buffer_load_dwordx4 v242, s[12:15], s3 offen lds
    s_add_u32 m0, s60, 6336
    s_mov_b32 s3, 16128
    buffer_load_dwordx4 v242, s[12:15], s3 offen lds
    s_add_u32 m0, s60, 7392
    s_mov_b32 s3, 18816
    buffer_load_dwordx4 v242, s[12:15], s3 offen lds
    s_mul_i32 s53, s101, 37
    s_lshr_b32 s53, s53, 8
    s_mul_i32 s54, s53, 7
    s_sub_u32 s54, s101, s54
    s_and_b32 s53, s53, 3
    s_xor_b32 s53, s53, 0
    s_lshl_b32 s3, s6, 2
    s_add_u32 s53, s53, s3
    s_lshl_b32 s53, s53, 1
    s_add_u32 s53, s53, s7
    s_mov_b32 s42, 4096
    s_mov_b32 s43, 0x20000
    s_lshl_b32 s3, s53, 2
    s_add_u32 s3, s3, s48
    s_lshl_b32 s60, s3, 5
    v_lshl_add_u32 v82, v5, 1, s60
    s_mul_i32 s3, s3, 14336
    s_lshl_b32 s60, s54, 7
    s_add_u32 s3, s3, s60
    v_mul_u32_u24 v14, 896, v5
    v_lshl_add_u32 v14, v6, 4, v14
    v_add_u32 v85, s3, v14
    v_add_u32 v86, 7168, v85
    s_cmp_lt_u32 s101, 28
    s_cselect_b32 s56, 1, 0
    s_lshl_b32 s50, s7, 3
    s_and_b32 s3, s101, 7
    s_add_u32 s50, s50, s3
    s_lshr_b32 s60, s101, 3
    s_lshl_b32 s49, s6, 2
    s_add_u32 s49, s49, s60
    s_lshl_b32 s49, s49, 2
    s_add_u32 s49, s49, s48
    s_mul_i32 s60, s60, 0
    s_add_u32 s3, s3, s60
    s_sub_u32 s60, s3, 7
    s_cmp_ge_u32 s3, 7
    s_cselect_b32 s3, s60, s3
    s_lshl_b32 s62, s3, 18
    s_mul_i32 s63, s3, 12288
    s_mov_b32 s30, 20971520
    s_mov_b32 s31, 0x20000
    s_mov_b32 s75, 0x3727c5ac
    s_mov_b32 s76, 0x3b124925
    s_mov_b32 s77, 0x3f803f80
    v_lshlrev_b32 v4, 4, v1
    v_bfe_u32 v7, v1, 2, 2
    v_and_b32 v8, 3, v1
    v_mul_u32_u24 v13, 960, v9
    v_lshl_add_u32 v13, v10, 4, v13
    s_mul_i32 s3, s48, 1920
    s_add_u32 s3, s3, 147456
    v_add_u32 v230, s3, v13
    v_mul_u32_u24 v13, 960, v7
    v_lshl_add_u32 v13, v3, 5, v13
    v_lshl_add_u32 v13, v8, 3, v13
    s_lshl_b32 s3, s48, 8
    s_add_u32 s3, s3, 147456
    v_add_u32 v231, s3, v13
    s_lshl_b32 s3, s48, 3
    s_add_u32 s3, s3, 155648
    v_lshl_add_u32 v232, v9, 2, s3
    v_lshlrev_b32 v237, 2, v6
    v_and_b32 v2, 15, v1
    v_lshlrev_b32 v238, 14, v3
    v_add_lshl_u32 v238, v238, v2, 2
    v_add_u32 v237, 155648, v237
    v_lshlrev_b32 v13, 17, v9
    v_lshl_add_u32 v233, v10, 4, v13
    s_cmp_eq_u32 s48, 3
    s_cselect_b32 s60, 268435456, 0
    s_lshl_b32 s70, s48, 10
    s_add_u32 s70, s70, s2
    s_lshl_b32 s70, s70, 9
    s_add_u32 s71, s70, 262144
    s_add_u32 s71, s71, s60
    s_xor_b32 s60, s60, 268435456
    s_lshl_b32 s72, s2, 7
    s_add_u32 s72, s72, s60
    s_add_u32 s72, s72, 6291456
    s_lshr_b32 s74, s2, 2
    s_lshl_b32 s74, s74, 5
    s_and_b32 s3, s2, 3
    s_add_u32 s74, s74, s3
    s_lshl_b32 s74, s74, 2
    s_add_u32 s74, s74, 10485760
    v_cmp_gt_u32 vcc, 8, v0
    v_lshlrev_b32 v236, 13, v0
    v_mov_b32 v13, 268435456
    s_and_b32 s3, s2, 7
    s_lshl_b32 s3, s3, 13
    s_add_u32 s3, s3, 10485760
    v_lshrrev_b32 v14, 2, v0
    v_lshl_add_u32 v14, v14, 7, s3
    v_lshl_add_u32 v20, v8, 2, v14
    v_cndmask_b32 v236, v13, v236, vcc
    v_mov_b32 v16, 0
    s_lshl_b32 s3, s48, 14
    s_add_u32 s74, s74, s3
    s_add_u32 s73, s74, 8192
    s_waitcnt vmcnt(10)
    v_dot2_f32_bf16 v226, v182, s77, 0
    v_dot2_f32_bf16 v227, v182, v182, 0
    v_dot2_f32_bf16 v226, v183, s77, v226
    v_dot2_f32_bf16 v227, v183, v183, v227
    v_dot2_f32_bf16 v226, v184, s77, v226
    v_dot2_f32_bf16 v227, v184, v184, v227
    v_dot2_f32_bf16 v226, v185, s77, v226
    v_dot2_f32_bf16 v227, v185, v185, v227
    s_waitcnt vmcnt(9)
    v_dot2_f32_bf16 v226, v186, s77, v226
    v_dot2_f32_bf16 v227, v186, v186, v227
    v_dot2_f32_bf16 v226, v187, s77, v226
    v_dot2_f32_bf16 v227, v187, v187, v227
    v_dot2_f32_bf16 v226, v188, s77, v226
    v_dot2_f32_bf16 v227, v188, v188, v227
    v_dot2_f32_bf16 v226, v189, s77, v226
    v_dot2_f32_bf16 v227, v189, v189, v227
    buffer_load_dword v12, v16, s[44:47], 0 offen sc1
    v_lshlrev_b32 v190, 16, v182
    v_and_b32 v191, 0xffff0000, v182
    v_add_f32_dpp v226, v226, v226 quad_perm:[1,0,3,2] row_mask:0xf bank_mask:0xf
    v_add_f32_dpp v227, v227, v227 quad_perm:[1,0,3,2] row_mask:0xf bank_mask:0xf
    v_lshlrev_b32 v192, 16, v183
    v_add_f32_dpp v226, v226, v226 quad_perm:[2,3,0,1] row_mask:0xf bank_mask:0xf
    v_add_f32_dpp v227, v227, v227 quad_perm:[2,3,0,1] row_mask:0xf bank_mask:0xf
    v_and_b32 v193, 0xffff0000, v183
    v_add_f32_dpp v226, v226, v226 row_half_mirror row_mask:0xf bank_mask:0xf
    v_add_f32_dpp v227, v227, v227 row_half_mirror row_mask:0xf bank_mask:0xf
    v_lshlrev_b32 v194, 16, v184
    v_add_f32_dpp v226, v226, v226 row_mirror row_mask:0xf bank_mask:0xf
    v_add_f32_dpp v227, v227, v227 row_mirror row_mask:0xf bank_mask:0xf
    v_and_b32 v195, 0xffff0000, v184
    v_mov_b32 v228, v226
    v_mov_b32 v229, v227
    v_lshlrev_b32 v196, 16, v185
    v_permlane16_swap_b32 v226, v228
    v_permlane16_swap_b32 v227, v229
    v_add_f32 v226, v226, v228
    v_add_f32 v227, v227, v229
    v_mul_f32_e64 v226, -v226, s76
    v_mul_f32 v228, v226, v226
    v_fma_f32 v227, v227, s76, -v228
    v_max_f32 v227, 0, v227
    v_add_f32 v228, s75, v227
    v_rsq_f32 v222, v228
    v_and_b32 v197, 0xffff0000, v185
    v_mul_f32 v228, v222, v222
    v_fma_f32 v229, v228, v227, s75
    v_rsq_f32 v228, v229
    v_mul_f32 v223, v226, v222
    v_mul_f32 v224, v222, v228
    v_mul_f32 v225, v223, v228
    v_mul_f32 v229, v229, v228
    ds_write_b32 v232, v229
    v_lshlrev_b32 v198, 16, v186
    v_and_b32 v199, 0xffff0000, v186
    v_lshlrev_b32 v200, 16, v187
    v_and_b32 v201, 0xffff0000, v187
    v_lshlrev_b32 v202, 16, v188
    v_and_b32 v203, 0xffff0000, v188
    v_lshlrev_b32 v204, 16, v189
    v_and_b32 v205, 0xffff0000, v189
    v_pk_fma_f32 v[206:207], v[190:191], v[224:225], v[224:225] op_sel:[0,0,1] op_sel_hi:[1,0,1]
    v_pk_fma_f32 v[208:209], v[192:193], v[224:225], v[224:225] op_sel:[0,0,1] op_sel_hi:[1,0,1]
    v_pk_fma_f32 v[210:211], v[194:195], v[224:225], v[224:225] op_sel:[0,0,1] op_sel_hi:[1,0,1]
    v_pk_fma_f32 v[212:213], v[196:197], v[224:225], v[224:225] op_sel:[0,0,1] op_sel_hi:[1,0,1]
    v_cvt_pk_bf16_f32 v182, v206, v207
    v_cvt_pk_bf16_f32 v183, v208, v209
    v_cvt_pk_bf16_f32 v184, v210, v211
    v_cvt_pk_bf16_f32 v185, v212, v213
    ds_write_b128 v230, v[182:185] offset:0
    v_pk_fma_f32 v[214:215], v[198:199], v[224:225], v[224:225] op_sel:[0,0,1] op_sel_hi:[1,0,1]
    v_pk_fma_f32 v[216:217], v[200:201], v[224:225], v[224:225] op_sel:[0,0,1] op_sel_hi:[1,0,1]
    v_pk_fma_f32 v[218:219], v[202:203], v[224:225], v[224:225] op_sel:[0,0,1] op_sel_hi:[1,0,1]
    v_pk_fma_f32 v[220:221], v[204:205], v[224:225], v[224:225] op_sel:[0,0,1] op_sel_hi:[1,0,1]
    v_cvt_pk_bf16_f32 v186, v214, v215
    v_cvt_pk_bf16_f32 v187, v216, v217
    v_cvt_pk_bf16_f32 v188, v218, v219
    v_cvt_pk_bf16_f32 v189, v220, v221
    ds_write_b128 v230, v[186:189] offset:448
    s_waitcnt lgkmcnt(0)
    s_barrier
    ds_read_b64_tr_b16 v[110:111], v231 offset:0
    ds_read_b64_tr_b16 v[112:113], v231 offset:3840
    ds_read_b64_tr_b16 v[114:115], v231 offset:128
    ds_read_b64_tr_b16 v[116:117], v231 offset:3968
    ds_read_b32 v229, v237
    s_waitcnt lgkmcnt(3)
    buffer_store_dwordx4 v[110:113], v233, s[28:31], s70 offen sc1
    s_waitcnt lgkmcnt(1)
    buffer_store_dwordx4 v[114:117], v233, s[28:31], s71 offen sc1
    v_cmp_gt_u32 vcc, 16, v1
    s_waitcnt lgkmcnt(0)
    s_nop 0
    v_cndmask_b32 v229, 0, v229, vcc
    buffer_store_dword v229, v238, s[28:31], s72 offen sc1
    v_lshrrev_b32 v13, 2, v1
    v_mul_u32_u24 v13, 1056, v13
    v_lshl_add_u32 v13, v8, 3, v13
    s_mul_i32 s3, s48, 224
    v_add_u32 v243, s3, v13
    s_mov_b32 s18, 401408
    s_mov_b32 s19, 0x20000
    s_mov_b32 s26, 7340032
    s_mov_b32 s27, 0x20000
    s_mov_b32 s34, 1835008
    s_mov_b32 s35, 0x20000
    s_mov_b32 s36, 1
    v_lshrrev_b32 v14, 2, v1
    v_lshlrev_b32 v14, 7, v14
    v_lshl_add_u32 v14, v8, 3, v14
    v_and_b32 v15, 3, v5
    v_lshl_add_u32 v14, v15, 5, v14
    s_mul_i32 s3, s4, 8256
    v_xor_b32 v31, s3, v14
    v_xor_b32 v32, 32, v31
    v_xor_b32 v33, 64, v31
    v_xor_b32 v34, 96, v31
    v_add_u32 v35, 65536, v31
    v_add_u32 v36, 65536, v32
    v_add_u32 v37, 65536, v33
    v_add_u32 v38, 65536, v34
    v_add_u32 v39, 131072, v31
    v_add_u32 v40, 131072, v32
    v_add_u32 v41, 131072, v33
    v_add_u32 v42, 131072, v34
    s_lshl_b32 s6, s52, 1
    s_add_u32 s6, s6, s5
    s_lshl_b32 s3, s6, 1
    s_add_u32 s3, s3, s59
    s_lshl_b32 s3, s3, 4
    s_add_u32 s3, s3, s4
    s_lshl_b32 s3, s3, 12
    v_lshl_add_u32 v78, v3, 8, v4
    v_add_u32 v78, s3, v78
    s_xor_b32 s37, s51, 1
    s_lshl_b32 s37, s37, 3
    s_add_u32 s37, s37, s52
    s_lshl_b32 s3, s37, 14
    s_add_u32 s3, s3, s58
    s_add_u32 s3, s3, 16777216
    v_add_u32 v23, s3, v4
    s_lshl_b32 s37, s37, 5
    s_add_u32 s37, s37, s5
    s_lshl_b32 s37, s37, 2
    s_add_u32 s37, s37, 6422528
    s_mul_i32 s67, s6, 56
    s_lshl_b32 s3, s51, 1
    s_add_u32 s3, s3, s4
    s_add_u32 s67, s67, s3
    s_lshl_b32 s67, s67, 11
    s_add_u32 s67, s67, 2097152
    v_add_u32 v81, s58, v4
    s_lshl_b32 s68, s52, 2
    s_and_b32 s3, s51, 1
    s_add_u32 s68, s68, s3
    s_cmp_ge_u32 s51, 14
    s_cselect_b32 s3, 2, 0
    s_add_u32 s68, s68, s3
    s_lshl_b32 s68, s68, 7
    s_add_u32 s68, s68, 6356992
    s_waitcnt vmcnt(3)
    v_readfirstlane_b32 s57, v12
    s_mov_b32 s60, 0
    s_cmp_lg_u32 s57, 0
    s_cbranch_scc0 L_nonceh
L_nonce_okh:
    s_waitcnt vmcnt(0)
    s_barrier
    s_atomic_swap s57, s[28:29], s74
    s_atomic_swap s57, s[28:29], s73
    buffer_load_dwordx4 v[96:99], v85, s[8:11], 0 offen
    buffer_load_ushort v93, v82, s[40:43], 0 offen offset:0
    buffer_load_dwordx4 v[100:103], v86, s[8:11], 0 offen
    buffer_load_ushort v94, v82, s[40:43], 0 offen offset:16
    v_cmp_gt_u32 vcc, 12, v2
    s_mul_i32 s3, s48, 56
    s_add_u32 s3, s3, s79
    s_mul_i32 s3, s3, 3
    s_add_u32 s3, s3, s80
    s_lshl_b32 s3, s3, 11
    s_add_u32 s3, s3, 8388608
    s_add_u32 s3, s3, s81
    ds_read_b64_tr_b16 v[182:183], v243 offset:0
    ds_read_b64_tr_b16 v[184:185], v243 offset:16896
    ds_read_b64_tr_b16 v[186:187], v243 offset:32
    ds_read_b64_tr_b16 v[188:189], v243 offset:16928
    ds_read_b64_tr_b16 v[190:191], v243 offset:56
    ds_read_b64_tr_b16 v[192:193], v243 offset:16952
    ds_read_b64_tr_b16 v[194:195], v243 offset:88
    ds_read_b64_tr_b16 v[196:197], v243 offset:16984
    ds_read_b64_tr_b16 v[198:199], v243 offset:112
    ds_read_b64_tr_b16 v[200:201], v243 offset:17008
    ds_read_b64_tr_b16 v[202:203], v243 offset:144
    ds_read_b64_tr_b16 v[204:205], v243 offset:17040
    ds_read_b64_tr_b16 v[206:207], v243 offset:168
    ds_read_b64_tr_b16 v[208:209], v243 offset:17064
    ds_read_b64_tr_b16 v[210:211], v243 offset:200
    ds_read_b64_tr_b16 v[212:213], v243 offset:17096
    s_waitcnt lgkmcnt(13)
    v_cndmask_b32 v186, 0, v186, vcc
    v_cndmask_b32 v187, 0, v187, vcc
    s_waitcnt lgkmcnt(12)
    v_cndmask_b32 v188, 0, v188, vcc
    v_cndmask_b32 v189, 0, v189, vcc
    buffer_store_dwordx4 v[182:185], v4, s[28:31], s3 offen offset:0 sc1
    buffer_store_dwordx4 v[186:189], v4, s[28:31], s3 offen offset:1024 sc1
    s_add_u32 s3, s3, 86016
    s_waitcnt lgkmcnt(9)
    v_cndmask_b32 v194, 0, v194, vcc
    v_cndmask_b32 v195, 0, v195, vcc
    s_waitcnt lgkmcnt(8)
    v_cndmask_b32 v196, 0, v196, vcc
    v_cndmask_b32 v197, 0, v197, vcc
    buffer_store_dwordx4 v[190:193], v4, s[28:31], s3 offen offset:0 sc1
    buffer_store_dwordx4 v[194:197], v4, s[28:31], s3 offen offset:1024 sc1
    s_add_u32 s3, s3, 86016
    s_waitcnt lgkmcnt(5)
    v_cndmask_b32 v202, 0, v202, vcc
    v_cndmask_b32 v203, 0, v203, vcc
    s_waitcnt lgkmcnt(4)
    v_cndmask_b32 v204, 0, v204, vcc
    v_cndmask_b32 v205, 0, v205, vcc
    buffer_store_dwordx4 v[198:201], v4, s[28:31], s3 offen offset:0 sc1
    buffer_store_dwordx4 v[202:205], v4, s[28:31], s3 offen offset:1024 sc1
    s_add_u32 s3, s3, 86016
    ds_read_b32 v24, v4
    s_waitcnt lgkmcnt(2)
    v_cndmask_b32 v210, 0, v210, vcc
    v_cndmask_b32 v211, 0, v211, vcc
    ds_read_b32 v24, v4
    s_waitcnt lgkmcnt(2)
    v_cndmask_b32 v212, 0, v212, vcc
    v_cndmask_b32 v213, 0, v213, vcc
    buffer_store_dwordx4 v[206:209], v4, s[28:31], s3 offen offset:0 sc1
    buffer_store_dwordx4 v[210:213], v4, s[28:31], s3 offen offset:1024 sc1
    s_add_u32 s3, s3, 86016
    s_lshl_b32 s67, s80, 6
    s_add_u32 s67, s67, 64
    s_cmp_eq_u32 s81, 0
    s_cselect_b32 s37, s48, 1
    s_mov_b32 s68, 6369792
    s_and_b32 s3, s2, 1
    s_mul_i32 s3, s3, 3
    s_bfe_u32 s6, s2, 0x10001
    s_mul_i32 s7, s6, 6
    s_add_u32 s3, s3, s7
    s_add_u32 s3, s3, 1
    v_add_u32 v14, s3, v8
    s_mul_i32 s6, s6, 64
    s_add_u32 s6, s6, 7
    v_cmp_ne_u32 vcc, s6, v14
    v_lshrrev_b32 v15, 2, v1
    v_mul_u32_u24 v15, 3584, v15
    v_cndmask_b32 v14, 0, v14, vcc
    v_lshl_add_u32 v14, v14, 8, v15
    s_lshl_b32 s3, s52, 2
    s_add_u32 s3, s3, s48
    s_mul_i32 s3, s3, 37
    s_min_u32 s3, s3, 987
    s_mul_i32 s3, s3, 3584
    s_mul_i32 s6, s59, 3670144
    s_add_u32 s3, s3, s6
    buffer_load_dword v226, v14, s[20:23], s3 offen
    s_add_u32 s3, s3, 57344
    buffer_load_dword v227, v14, s[20:23], s3 offen
    s_add_u32 s3, s3, 57344
    v_cmp_gt_u32 vcc, 20, v1
    v_mov_b32 v15, 268435456
    s_nop 0
    v_cndmask_b32 v14, v15, v14, vcc
    buffer_load_dword v228, v14, s[20:23], s3 offen
    s_add_u32 s3, s3, 57344
    v_add_u32 v53, 65536, v4
    v_add_u32 v54, 131072, v4
    s_mul_i32 s59, s48, 3072
    s_mul_i32 s3, s50, 86016
    s_add_u32 s3, s3, s59
    s_add_u32 s3, s3, 8388608
    v_add_u32 v80, s3, v4
    v_lshlrev_b32 v14, 7, v9
    v_xor_b32 v14, v14, v4
    s_lshl_b32 s3, s49, 11
    v_add_u32 v67, s3, v14
    v_add_u32 v68, 129024, v67
    s_lshr_b32 s3, s49, 2
    s_lshl_b32 s3, s3, 3
    s_max_u32 s3, s3, 1
    s_sub_u32 s3, s3, 1
    s_lshl_b32 s3, s3, 10
    s_lshl_b32 s6, s5, 17
    s_add_u32 s3, s3, s6
    s_lshl_b32 s6, s4, 28
    s_add_u32 s3, s3, s6
    v_add_u32 v69, s3, v14
    s_lshl_b32 s100, s5, 1
    s_add_u32 s100, s100, s4
    s_lshl_b32 s100, s100, 10
    v_and_b32 v14, 1, v1
    v_mul_u32_u24 v14, 640, v14
    v_lshrrev_b32 v15, 2, v1
    v_lshlrev_b32 v15, 4, v15
    v_xor_b32 v14, v14, v15
    v_bfe_u32 v15, v1, 1, 1
    v_lshl_add_u32 v14, v15, 3, v14
    s_add_u32 s3, s58, 12288
    v_add_u32 v70, s3, v14
    s_sub_u32 s3, s3, 3072
    s_cmp_eq_u32 s48, 0
    s_cselect_b32 s3, 28672, s3
    v_add_u32 v71, s3, v14
    v_add_u32 v72, 65536, v70
    v_add_u32 v73, 65536, v71
    v_add_u32 v74, 131072, v70
    v_add_u32 v75, 131072, v71
    s_lshl_b32 s3, s49, 1
    v_min_u32 v14, 2, v3
    v_add_u32 v14, s3, v14
    v_max_u32 v14, 1, v14
    v_lshlrev_b32 v14, 1, v14
    v_and_b32 v15, 1, v7
    v_add_lshl_u32 v14, v14, v15, 7
    v_lshrrev_b32 v15, 1, v7
    v_lshl_add_u32 v15, v15, 2, v8
    v_lshl_add_u32 v14, v15, 2, v14
    v_add_u32 v77, 6291200, v14
    s_min_u32 s15, s48, 2
    s_lshl_b32 s15, s15, 6
    s_add_u32 s15, s15, 64
    s_lshl_b32 s82, s49, 5
    s_add_u32 s82, s82, s50
    s_lshl_b32 s82, s82, 10
    s_add_u32 s82, s82, 4194304
    s_lshr_b32 s69, s49, 2
    s_lshl_b32 s69, s69, 1
    s_and_b32 s3, s50, 1
    s_add_u32 s69, s69, s3
    s_lshl_b32 s69, s69, 7
    s_add_u32 s69, s69, 6361088
    s_and_b32 s7, s53, 1
    s_mul_i32 s3, s7, 28
    s_add_u32 s3, s3, s48
    s_lshl_b32 s3, s3, 17
    s_xor_b32 s6, s53, 1
    s_lshl_b32 s55, s6, 3
    s_lshl_b32 s6, s53, 7
    s_add_u32 s3, s3, s6
    v_lshlrev_b32 v14, 12, v5
    v_add3_u32 v59, v14, v83, s3
    v_add_u32 v60, 31744, v59
    v_add_u32 v61, 63488, v59
    v_add_u32 v62, 95232, v59
    v_mul_u32_u24 v14, 896, v5
    s_mul_i32 s3, s4, 25088
    s_mul_i32 s6, s5, 14336
    s_add_u32 s3, s3, s6
    s_lshl_b32 s6, s54, 7
    s_add_u32 s3, s3, s6
    v_add3_u32 v63, v14, v83, s3
    v_add_u32 v64, 6144, v63
    s_lshl_b32 s6, s53, 1
    s_add_u32 s6, s6, s5
    s_and_b32 s3, s53, 30
    s_add_u32 s3, s3, s4
    s_lshl_b32 s3, s3, 7
    s_add_u32 s39, s3, 6361088
    s_lshl_b32 s3, s6, 5
    s_add_u32 s3, s3, s4
    s_lshl_b32 s3, s3, 10
    s_add_u32 s3, s3, 4194304
    v_add_u32 v65, s3, v4
    v_add_u32 v66, 15360, v65
    s_xor_b32 s3, s4, s5
    s_lshl_b32 s3, s3, 6
    v_xor_b32 v43, s3, v31
    v_xor_b32 v44, 32, v43
    v_add_u32 v45, 65536, v43
    v_add_u32 v46, 65536, v44
    s_mul_i32 s3, s4, 12288
    v_add_u32 v47, s3, v4
    v_xor_b32 v48, 4096, v47
    v_add_u32 v49, 65536, v47
    v_add_u32 v50, 65536, v48
    v_add_u32 v51, 131072, v47
    v_add_u32 v52, 131072, v48
    s_lshl_b32 s6, s54, 1
    s_add_u32 s6, s6, s5
    s_lshl_b32 s3, s6, 1
    s_add_u32 s3, s3, s7
    s_mul_i32 s3, s3, 14
    s_add_u32 s3, s3, s4
    s_lshl_b32 s3, s3, 12
    s_add_u32 s3, s3, 2097152
    v_add_u32 v79, s3, v4
    s_lshl_b32 s3, s54, 1
    s_add_u32 s3, s3, s7
    s_lshl_b32 s3, s3, 1
    s_add_u32 s3, s3, s4
    s_lshl_b32 s3, s3, 7
    s_add_u32 s38, s3, 6356992
    s_and_b32 s3, s2, 6
    s_add_u32 s3, s3, s54
    s_sub_u32 s6, s3, 7
    s_cmp_ge_u32 s3, 7
    s_cselect_b32 s3, s6, s3
    s_lshl_b32 s64, s3, 19
    s_lshl_b32 s65, s3, 13
    s_add_u32 s55, s55, s54
    s_lshl_b32 s3, s55, 14
    s_add_u32 s3, s3, s58
    s_add_u32 s3, s3, 12582912
    v_add_u32 v21, s3, v4
    s_lshl_b32 s55, s55, 5
    s_add_u32 s55, s55, s48
    s_lshl_b32 s55, s55, 2
    s_add_u32 s55, s55, 6488064
    s_lshl_b32 s3, s5, 3
    v_add_u32 v13, s3, v3
    v_xor_b32 v13, v13, v6
    v_lshlrev_b32 v13, 4, v13
    v_lshl_add_u32 v13, v2, 8, v13
    s_lshl_b32 s3, s4, 14
    s_add_u32 s3, s3, 32768
    v_add_u32 v87, s3, v13
    v_xor_b32 v88, 64, v87
    s_lshr_b32 s3, s53, 1
    s_add_u32 s66, s3, s54
    s_mov_b32 s51, s66
    v_lshlrev_b32 v13, 1, v6
    v_xor_b32 v13, v13, v5
    v_lshlrev_b32 v13, 4, v13
    v_lshl_add_u32 v13, v5, 8, v13
    s_add_u32 s3, s58, 32768
    v_add_u32 v89, s3, v13
    v_xor_b32 v90, 16, v89
    v_xor_b32 v91, 24576, v89
    v_xor_b32 v92, 24592, v89
    s_mov_b32 s70, 0xaaaaaaaa
    s_mov_b32 s71, 0xaaaaaaaa
    s_mov_b32 s72, 0xfff0ffff
    s_mov_b32 s73, 0xf000ff00
    s_mov_b32 s74, 0xffc0fffc
    s_mov_b32 s75, 0xc000fc00
    s_cmp_eq_u32 s49, 0
    s_cselect_b64 s[76:77], 0, -1
    v_mov_b32 v13, 0xffff
    v_mov_b32 v14, 0xffff0000
    v_cndmask_b32 v13, v13, v14, s[70:71]
    v_cndmask_b32 v104, v13, 0, s[72:73]
    v_cndmask_b32 v106, 0, v13, s[72:73]
    v_cndmask_b32 v105, v13, 0, s[74:75]
    v_cndmask_b32 v107, 0, v13, s[74:75]
    v_mov_b32 v84, 0xf149f2ca
    s_mov_b32 s83, 0x3e8b97f6
    s_mov_b32 s78, 0xbdd2d3e8
    s_mov_b32 s79, 0xbdd2d3e8
    s_mov_b32 s80, 1.0
    s_mov_b32 s81, 1.0
    v_mov_b32 v108, 0xc0135761
    v_mov_b32 v109, 0xc0135761
    v_lshrrev_b32 v13, 1, v2
    v_lshlrev_b32 v14, 1, v3
    v_sub_u32 v13, v13, v14
    v_mov_b32 v14, 0x3f80
    v_cndmask_b32 v14, v14, 1.0, s[70:71]
    v_cmp_eq_i32 vcc, 0, v13
    v_accvgpr_write_b32 a248, 0
    v_accvgpr_write_b32 a252, 0
    v_cndmask_b32 v15, 0, v14, vcc
    v_accvgpr_write_b32 a250, v15
    v_cmp_eq_i32 vcc, 1, v13
    v_accvgpr_write_b32 a249, 0
    v_accvgpr_write_b32 a253, 0
    v_cndmask_b32 v15, 0, v14, vcc
    v_accvgpr_write_b32 a251, v15
    s_waitcnt vmcnt(3)
    s_barrier
    s_cmp_lg_u32 s37, 0
    s_cbranch_scc1 L_nowsig
    s_atomic_add s36, s[44:45], s67
L_nowsig:
    buffer_load_dword v18, v20, s[28:31], 0 offen sc1
    s_mov_b32 s26, 7340032
    s_and_b32 s3, s2, 1
    s_mul_i32 s3, s3, 7
    s_add_u32 s3, s3, s52
    s_lshl_b32 s3, s3, 2
    s_add_u32 s3, s3, s48
    s_lshl_b32 s3, s3, 17
    s_and_b32 s6, s2, 6
    s_lshl_b32 s6, s6, 9
    s_add_u32 s3, s3, s6
    v_lshlrev_b32 v242, 12, v10
    v_mul_u32_u24 v243, 512, v9
    v_add_u32 v243, v242, v243
    buffer_load_dword v232, v243, s[24:27], s3 offen offset:384
    v_mul_u32_u24 v243, 512, v9
    v_add_u32 v243, v242, v243
    buffer_load_dword v233, v243, s[24:27], s3 offen offset:256
    s_cmp_eq_u32 s56, 0
    s_cselect_b32 s26, 0, s26
    s_cmp_eq_u32 s56, 0
    s_cselect_b32 s26, 0, s26
    v_and_b32 v13, 0xfffff000, v78
    v_lshl_add_u32 v13, v10, 7, v13
    s_add_u32 s3, s1, 8192
    v_lshl_add_u32 v14, v9, 13, s3
    s_waitcnt vmcnt(2)
    v_cmp_ne_u32 vcc, s57, v18
    s_cbranch_vccnz L_pollin3
L_pollok3:
    s_load_dword s14, s[44:45], s15
    s_barrier
    buffer_load_dword v76, v77, s[28:31], 0 offen sc1
    s_waitcnt lgkmcnt(0)
    s_cmp_ge_u32 s14, 14
    s_cbranch_scc0 L_pollin4
L_pollok4:
    s_barrier
    s_cmp_eq_u32 s56, 0
    s_cselect_b32 s3, 268435456, 0
    v_add_u32 v79, s3, v79
    s_mov_b32 s26, 7340032
    s_and_b32 s3, s54, 1
    s_lshl_b32 s3, s3, 2
    s_lshr_b32 s6, s54, 1
    s_add_u32 s3, s3, s6
    s_lshl_b32 s3, s3, 7
    s_cmp_eq_u32 s56, 0
    s_cselect_b32 s3, s3, 0
    v_xor_b32 v59, s3, v59
    v_xor_b32 v60, s3, v60
    v_xor_b32 v61, s3, v61
    v_xor_b32 v62, s3, v62
    s_add_u32 m0, s59, 98304
    s_nop 0
    buffer_load_dwordx4 v80, s[28:31], s63 offen sc1 lds
    buffer_load_dwordx4 v80, s[28:31], s63 offen offset:1024 sc1 lds
    buffer_load_dwordx4 v80, s[28:31], s63 offen offset:2048 sc1 lds
    s_add_u32 m0, s100, 126976
    s_nop 0
    buffer_load_dwordx4 v69, s[28:31], s62 offen sc1 lds
    s_add_u32 m0, s58, 110592
    s_nop 0
    buffer_load_dwordx4 v67, s[28:31], s62 offen sc1 lds
    buffer_load_dwordx4 v67, s[28:31], s62 offen offset:1024 sc1 lds
    buffer_load_dwordx4 v68, s[28:31], s62 offen offset:2048 sc1 lds
    buffer_load_dwordx4 v68, s[28:31], s62 offen offset:3072 sc1 lds
    s_add_u32 m0, s59, 131072
    s_add_u32 s63, s63, 12288
    s_cmp_eq_u32 s63, 86016
    s_cselect_b32 s63, 0, s63
    buffer_load_dwordx4 v80, s[28:31], s63 offen sc1 lds
    buffer_load_dwordx4 v80, s[28:31], s63 offen offset:1024 sc1 lds
    buffer_load_dwordx4 v80, s[28:31], s63 offen offset:2048 sc1 lds
    s_add_u32 m0, s100, 159744
    s_add_u32 s62, s62, 262144
    s_cmp_eq_u32 s62, 1835008
    s_cselect_b32 s62, 0, s62
    buffer_load_dwordx4 v69, s[28:31], s62 offen sc1 lds
    s_add_u32 m0, s58, 143360
    s_nop 0
    buffer_load_dwordx4 v67, s[28:31], s62 offen sc1 lds
    buffer_load_dwordx4 v67, s[28:31], s62 offen offset:1024 sc1 lds
    buffer_load_dwordx4 v68, s[28:31], s62 offen offset:2048 sc1 lds
    buffer_load_dwordx4 v68, s[28:31], s62 offen offset:3072 sc1 lds
    s_add_u32 m0, s59, 0
    s_add_u32 s63, s63, 12288
    s_cmp_eq_u32 s63, 86016
    s_cselect_b32 s63, 0, s63
    buffer_load_dwordx4 v80, s[28:31], s63 offen sc1 lds
    buffer_load_dwordx4 v80, s[28:31], s63 offen offset:1024 sc1 lds
    buffer_load_dwordx4 v80, s[28:31], s63 offen offset:2048 sc1 lds
    s_add_u32 m0, s100, 28672
    s_add_u32 s62, s62, 262144
    s_cmp_eq_u32 s62, 1835008
    s_cselect_b32 s62, 0, s62
    buffer_load_dwordx4 v69, s[28:31], s62 offen sc1 lds
    s_add_u32 m0, s58, 12288
    s_nop 0
    buffer_load_dwordx4 v67, s[28:31], s62 offen sc1 lds
    buffer_load_dwordx4 v67, s[28:31], s62 offen offset:1024 sc1 lds
    buffer_load_dwordx4 v68, s[28:31], s62 offen offset:2048 sc1 lds
    buffer_load_dwordx4 v68, s[28:31], s62 offen offset:3072 sc1 lds
    s_add_u32 m0, s59, 65536
    s_add_u32 s63, s63, 12288
    s_cmp_eq_u32 s63, 86016
    s_cselect_b32 s63, 0, s63
    buffer_load_dwordx4 v80, s[28:31], s63 offen sc1 lds
    buffer_load_dwordx4 v80, s[28:31], s63 offen offset:1024 sc1 lds
    buffer_load_dwordx4 v80, s[28:31], s63 offen offset:2048 sc1 lds
    s_add_u32 m0, s100, 94208
    s_add_u32 s62, s62, 262144
    s_cmp_eq_u32 s62, 1835008
    s_cselect_b32 s62, 0, s62
    buffer_load_dwordx4 v69, s[28:31], s62 offen sc1 lds
    s_add_u32 m0, s58, 77824
    s_nop 0
    buffer_load_dwordx4 v67, s[28:31], s62 offen sc1 lds
    buffer_load_dwordx4 v67, s[28:31], s62 offen offset:1024 sc1 lds
    buffer_load_dwordx4 v68, s[28:31], s62 offen offset:2048 sc1 lds
    buffer_load_dwordx4 v68, s[28:31], s62 offen offset:3072 sc1 lds
    s_mov_b32 s3, 268435456
    buffer_store_dword v12, v11, s[28:31], s3 offen
    buffer_store_dword v12, v11, s[28:31], s3 offen
    v_lshlrev_b32 v13, 2, v2
    v_and_b32 v14, 1, v1
    v_lshl_add_u32 v14, v3, 2, v14
    v_lshlrev_b32 v14, 2, v14
    v_add_u32 v15, 64, v14
    v_cndmask_b32 v16, v14, v15, s[72:73]
    v_cndmask_b32 v14, v14, v15, s[74:75]
    s_waitcnt vmcnt(34)
    ds_bpermute_b32 v25, v13, v76 offset:64
    ds_bpermute_b32 v27, v16, v76 offset:0
    ds_bpermute_b32 v28, v14, v76 offset:8
    ds_bpermute_b32 v26, v13, v76 offset:128
    ds_bpermute_b32 v29, v16, v76 offset:64
    ds_bpermute_b32 v30, v14, v76 offset:72
    s_waitcnt lgkmcnt(5)
    v_mul_f32 v25, s83, v25
    s_waitcnt lgkmcnt(2)
    v_mul_f32 v26, s83, v26
    s_waitcnt vmcnt(18) lgkmcnt(0)
    s_barrier
    ds_read_b64_tr_b16 a[180:181], v72 offset:32768
    ds_read_b64_tr_b16 a[182:183], v72 offset:33024
    ds_read_b128 a[128:131], v53 offset:32768
    ds_read_b64_tr_b16 a[184:185], v72 offset:33792
    ds_read_b64_tr_b16 a[186:187], v72 offset:34048
    ds_read_b128 a[132:135], v53 offset:33792
    ds_read_b128 a[136:139], v53 offset:34816
    ds_read_b64_tr_b16 a[176:177], v73 offset:32768
    ds_read_b64_tr_b16 a[178:179], v73 offset:33024
    ds_read_b128 a[140:143], v53 offset:35840
    ds_read_b128 a[144:147], v53 offset:36864
    ds_read_b128 a[148:151], v53 offset:37888
    s_waitcnt lgkmcnt(0)
    s_nop 3
    s_branch L_q
L_pollin5:
    s_cmp_eq_u32 s56, 0
    s_cbranch_scc1 L_pollok5
    s_mov_b32 s60, 0
    s_branch L_poll5a
L_poll5:
    s_sleep 8
L_poll5a:
    buffer_load_dword v18, off, s[28:31], s38 sc1
    s_add_u32 s60, s60, 1
    s_waitcnt vmcnt(0)
    v_readfirstlane_b32 s14, v18
    s_nop 0
    s_cmp_ge_u32 s14, 7
    s_cbranch_scc1 L_pollok5
    s_cmp_lt_u32 s60, 20000
    s_cbranch_scc1 L_poll5
    s_branch L_pollok5
L_nof:
    v_min_u32 v14, 48, v1
    s_lshl_b32 s3, s54, 2
    s_add_u32 s3, s3, s48
    s_mul_i32 s3, s3, 25088
    v_lshl_add_u32 v14, v14, 7, s3
    s_add_u32 s3, s2, 0
    s_and_b32 s3, s3, 3
    s_mul_i32 s3, s3, 6272
    buffer_load_dword v182, v14, s[16:19], s3 offen
    s_waitcnt vmcnt(1)
    s_barrier
    s_cmp_lg_u32 s48, 0
    s_cbranch_scc1 L_sig3
    s_atomic_add s36, s[28:29], s69
L_sig3:
    s_add_u32 s3, s2, 1
    s_and_b32 s3, s3, 3
    s_mul_i32 s3, s3, 6272
    buffer_load_dword v183, v14, s[16:19], s3 offen
    s_add_u32 s3, s2, 2
    s_and_b32 s3, s3, 3
    s_mul_i32 s3, s3, 6272
    buffer_load_dword v184, v14, s[16:19], s3 offen
    s_add_u32 s3, s2, 3
    s_and_b32 s3, s3, 3
    s_mul_i32 s3, s3, 6272
    buffer_load_dword v185, v14, s[16:19], s3 offen
    s_branch L_fin
L_pollin6:
    s_mov_b32 s60, 0
    s_branch L_poll6a
L_poll6:
    s_sleep 8
L_poll6a:
    buffer_load_dword v18, off, s[28:31], s39 sc1
    s_add_u32 s60, s60, 1
    s_waitcnt vmcnt(0)
    v_readfirstlane_b32 s14, v18
    s_nop 0
    s_cmp_ge_u32 s14, 8
    s_cbranch_scc1 L_pollok6
    s_cmp_lt_u32 s60, 20000
    s_cbranch_scc1 L_poll6
    s_branch L_pollok6
L_pollin7:
    s_mov_b32 s60, 0
    s_branch L_poll7a
L_poll7:
    s_sleep 4
L_poll7a:
    buffer_load_dword v18, off, s[28:31], s55 sc1
    s_add_u32 s60, s60, 1
    s_waitcnt vmcnt(0)
    v_readfirstlane_b32 s14, v18
    s_nop 0
    s_cmp_ge_u32 s14, 1
    s_cbranch_scc1 L_pollok7
    s_cmp_lt_u32 s60, 20000
    s_cbranch_scc1 L_poll7
    s_branch L_pollok7
L_last:
    s_endpgm
.section .rodata,"a"
.p2align 6
.amdhsa_kernel parallel_sum__sliding_local_dilated__mixer_token_mlp__prompt_kernel
  .amdhsa_next_free_vgpr 512
  .amdhsa_next_free_sgpr 102
  .amdhsa_accum_offset 256
  .amdhsa_group_segment_fixed_size 0
  .amdhsa_kernarg_size 88
  .amdhsa_user_sgpr_count 2
  .amdhsa_user_sgpr_kernarg_segment_ptr 1
  .amdhsa_system_sgpr_workgroup_id_x 1
.end_amdhsa_kernel
```

```asm
; @launch grid=(256,1,1) block=(256,1,1) lds=163840
.amdgcn_target "amdgcn-amd-amdhsa--gfx950"
.text
.globl parallel_sum__sliding_local_dilated__mixer_token_mlp__prompt_kernel
.p2align 8
.type parallel_sum__sliding_local_dilated__mixer_token_mlp__prompt_kernel,@function
parallel_sum__sliding_local_dilated__mixer_token_mlp__prompt_kernel:
    s_cmp_ge_u32 s2, 256
    s_cbranch_scc1 L_end
    s_load_dwordx2 s[8:9], s[0:1], 0
    s_load_dwordx2 s[20:21], s[0:1], 32
    s_load_dwordx2 s[28:29], s[0:1], 80
    s_load_dwordx2 s[44:45], s[0:1], 72
    s_load_dwordx2 s[12:13], s[0:1], 8
    s_load_dwordx2 s[16:17], s[0:1], 16
    s_load_dwordx2 s[24:25], s[0:1], 48
    s_load_dwordx2 s[32:33], s[0:1], 64
    s_load_dwordx2 s[36:37], s[0:1], 40
    s_load_dwordx2 s[40:41], s[0:1], 56
    s_memrealtime s[78:79]
    s_getpc_b64 s[6:7]
L_pc:
    s_and_b32 s3, s2, 0xf8
    v_lshrrev_b32 v13, 5, v0
    v_add_lshl_u32 v13, s3, v13, 7
    v_min_u32 v13, L_last-L_pc, v13
    global_load_dword v18, v13, s[6:7]
    v_lshrrev_b32 v13, 6, v0
    v_and_b32 v10, 31, v0
    v_readfirstlane_b32 s48, v13
    v_bfe_u32 v9, v0, 5, 1
    v_mul_u32_u24 v14, 896, v9
    v_lshl_add_u32 v14, v10, 4, v14
    v_cmp_gt_u32 vcc, 28, v10
    v_mov_b32 v15, 268435456
    s_mov_b32 s10, 1835008
    s_mov_b32 s11, 0x20000
    v_cndmask_b32 v14, v15, v14, vcc
    s_lshr_b32 s4, s48, 1
    s_and_b32 s5, s48, 1
    s_and_b32 s3, s2, 0xfe
    s_add_u32 s3, s3, s4
    s_lshl_b32 s3, s3, 1
    s_and_b32 s60, s2, 1
    s_add_u32 s3, s3, s60
    s_lshl_b32 s3, s3, 1
    s_add_u32 s3, s3, s5
    s_mul_i32 s3, s3, 1792
    s_waitcnt lgkmcnt(0)
    buffer_load_dwordx4 v[182:185], v14, s[8:11], s3 offen
    buffer_load_dwordx4 v[186:189], v14, s[8:11], s3 offen offset:448
    v_and_b32 v1, 63, v0
    s_mov_b32 s46, 256
    s_mov_b32 s47, 0x20000
    s_lshl_b32 s3, s48, 8
    s_add_u32 s3, s3, s2
    s_cmp_lt_u32 s3, 8
    s_cselect_b32 s3, 0, 268435456
    s_or_b32 s78, s78, 1
    v_mov_b32 v234, s78
    v_mov_b32 v235, 0
    v_lshlrev_b32 v11, 25, v1
    buffer_atomic_cmpswap v[234:235], v11, s[44:47], s3 offen sc1
    s_bfe_u32 s6, s2, 0x20001
    s_and_b32 s7, s2, 1
    s_and_b32 s61, s2, 7
    s_lshr_b32 s101, s2, 3
    s_mul_i32 s52, s7, 25
    s_add_u32 s52, s52, s101
    s_mul_i32 s51, s52, 37
    s_lshr_b32 s51, s51, 8
    s_mul_i32 s3, s51, 7
    s_sub_u32 s52, s52, s3
    s_and_b32 s3, s6, 1
    s_mul_i32 s3, s3, 6
    s_add_u32 s51, s51, s3
    s_add_u32 s51, s51, 1
    s_add_u32 s3, s3, s51
    s_cmp_eq_u32 s3, 7
    s_cselect_b32 s51, 0, s51
    s_lshr_b32 s59, s6, 1
    s_lshl_b32 s51, s51, 1
    s_add_u32 s51, s51, s59
    s_max_u32 s60, s101, 25
    s_sub_u32 s60, s60, 25
    s_add_u32 s3, s101, s7
    s_cmp_lt_u32 s3, 25
    s_cselect_b32 s55, 1, 0
    s_cselect_b32 s52, s52, s60
    s_mov_b32 s22, 7340032
    s_mov_b32 s23, 0x20000
    s_lshl_b32 s3, s52, 1
    s_sub_u32 s60, s3, 7
    s_cmp_ge_u32 s3, 7
    s_cselect_b32 s3, s60, s3
    s_and_b32 s3, s3, 7
    s_mul_i32 s60, s61, 2
    s_add_u32 s3, s3, s60
    s_and_b32 s3, s3, 7
    s_mul_i32 s0, s3, 458752
    s_lshl_b32 s1, s3, 13
    s_lshl_b32 s58, s48, 12
    v_lshrrev_b32 v3, 4, v1
    v_lshrrev_b32 v5, 3, v1
    v_and_b32 v6, 7, v1
    v_lshlrev_b32 v14, 1, v3
    v_xor_b32 v14, v14, v6
    v_lshlrev_b32 v83, 4, v14
    s_cmp_eq_u32 s55, 0
    s_cbranch_scc1 L_nog1
    v_mul_u32_u24 v14, 3584, v5
    s_lshl_b32 s3, s59, 5
    s_add_u32 s3, s3, s48
    s_mul_i32 s3, s3, 114688
    s_lshl_b32 s60, s51, 7
    s_add_u32 s3, s3, s60
    v_add3_u32 v55, v14, v83, s3
    v_add_u32 v56, 56320, v55
    v_add_u32 v57, 26624, v55
    v_add_u32 v58, 82944, v55
    s_mov_b32 s38, 3584
    s_mov_b32 s39, 0x20000
    v_lshlrev_b32 v13, 3, v3
    s_lshl_b32 s3, s51, 1
    s_add_u32 s3, s3, s4
    s_lshl_b32 s3, s3, 6
    buffer_load_dwordx2 v[246:247], v13, s[36:39], s3 offen offset:0
    buffer_load_dwordx2 v[248:249], v13, s[36:39], s3 offen offset:32
    s_add_u32 m0, s58, 0
    v_xor_b32 v55, 128, v55
    buffer_load_dwordx4 v55, s[20:23], s0 offen lds
    v_xor_b32 v56, 128, v56
    buffer_load_dwordx4 v56, s[20:23], s0 offen offset:1024 lds
    v_xor_b32 v57, 128, v57
    buffer_load_dwordx4 v57, s[20:23], s0 offen offset:2048 lds
    v_xor_b32 v58, 128, v58
    buffer_load_dwordx4 v58, s[20:23], s0 offen offset:3072 lds
    s_mul_i32 s53, s101, 37
    s_lshr_b32 s53, s53, 8
    s_mul_i32 s54, s53, 7
    s_sub_u32 s54, s101, s54
    s_and_b32 s53, s53, 3
    s_xor_b32 s53, s53, 0
    s_lshl_b32 s3, s6, 2
    s_add_u32 s53, s53, s3
    s_lshl_b32 s53, s53, 1
    s_add_u32 s53, s53, s7
    s_mov_b32 s42, 4096
    s_mov_b32 s43, 0x20000
    s_lshl_b32 s3, s53, 2
    s_add_u32 s3, s3, s48
    s_lshl_b32 s60, s3, 5
    v_lshl_add_u32 v82, v5, 1, s60
    s_mul_i32 s3, s3, 14336
    s_lshl_b32 s60, s54, 7
    s_add_u32 s3, s3, s60
    v_mul_u32_u24 v14, 896, v5
    v_lshl_add_u32 v14, v6, 4, v14
    v_add_u32 v85, s3, v14
    v_add_u32 v86, 7168, v85
    s_cmp_lt_u32 s101, 28
    s_cselect_b32 s56, 1, 0
    s_lshl_b32 s50, s7, 3
    s_and_b32 s3, s101, 7
    s_add_u32 s50, s50, s3
    s_lshr_b32 s60, s101, 3
    s_lshl_b32 s49, s6, 2
    s_add_u32 s49, s49, s60
    s_lshl_b32 s49, s49, 2
    s_add_u32 s49, s49, s48
    s_mul_i32 s60, s60, 0
    s_add_u32 s3, s3, s60
    s_sub_u32 s60, s3, 7
    s_cmp_ge_u32 s3, 7
    s_cselect_b32 s3, s60, s3
    s_lshl_b32 s62, s3, 18
    s_mul_i32 s63, s3, 12288
    s_mov_b32 s30, 20971520
    s_mov_b32 s31, 0x20000
    s_mov_b32 s75, 0x3727c5ac
    s_mov_b32 s76, 0x3b124925
    s_mov_b32 s77, 0x3f803f80
    v_lshlrev_b32 v4, 4, v1
    v_bfe_u32 v7, v1, 2, 2
    v_and_b32 v8, 3, v1
    v_mul_u32_u24 v13, 960, v9
    v_lshl_add_u32 v13, v10, 4, v13
    s_mul_i32 s3, s48, 1920
    s_add_u32 s3, s3, 147456
    v_add_u32 v230, s3, v13
    v_mul_u32_u24 v13, 960, v7
    v_lshl_add_u32 v13, v3, 5, v13
    v_lshl_add_u32 v13, v8, 3, v13
    s_lshl_b32 s3, s48, 8
    s_add_u32 s3, s3, 147456
    v_add_u32 v231, s3, v13
    s_lshl_b32 s3, s48, 3
    s_add_u32 s3, s3, 155648
    v_lshl_add_u32 v232, v9, 2, s3
    v_lshlrev_b32 v237, 2, v6
    v_and_b32 v2, 15, v1
    v_lshlrev_b32 v238, 14, v3
    v_add_lshl_u32 v238, v238, v2, 2
    v_add_u32 v237, 155648, v237
    v_lshlrev_b32 v13, 17, v9
    v_lshl_add_u32 v233, v10, 4, v13
    s_cmp_eq_u32 s48, 3
    s_cselect_b32 s60, 268435456, 0
    s_lshl_b32 s70, s48, 10
    s_add_u32 s70, s70, s2
    s_lshl_b32 s70, s70, 9
    s_add_u32 s71, s70, 262144
    s_add_u32 s71, s71, s60
    s_xor_b32 s60, s60, 268435456
    s_lshl_b32 s72, s2, 7
    s_add_u32 s72, s72, s60
    s_add_u32 s72, s72, 6291456
    s_lshr_b32 s74, s2, 2
    s_lshl_b32 s74, s74, 5
    s_and_b32 s3, s2, 3
    s_add_u32 s74, s74, s3
    s_lshl_b32 s74, s74, 2
    s_add_u32 s74, s74, 10485760
    v_cmp_gt_u32 vcc, 8, v0
    v_lshlrev_b32 v236, 13, v0
    v_mov_b32 v13, 268435456
    s_and_b32 s3, s2, 7
    s_lshl_b32 s3, s3, 13
    s_add_u32 s3, s3, 10485760
    v_lshrrev_b32 v14, 2, v0
    v_lshl_add_u32 v14, v14, 7, s3
    v_lshl_add_u32 v20, v8, 2, v14
    v_cndmask_b32 v236, v13, v236, vcc
    v_mov_b32 v16, 0
    s_lshl_b32 s3, s48, 14
    s_add_u32 s74, s74, s3
    s_add_u32 s73, s74, 8192
    s_waitcnt vmcnt(8)
    v_dot2_f32_bf16 v226, v182, s77, 0
    v_dot2_f32_bf16 v227, v182, v182, 0
    v_dot2_f32_bf16 v226, v183, s77, v226
    v_dot2_f32_bf16 v227, v183, v183, v227
    v_dot2_f32_bf16 v226, v184, s77, v226
    v_dot2_f32_bf16 v227, v184, v184, v227
    v_dot2_f32_bf16 v226, v185, s77, v226
    v_dot2_f32_bf16 v227, v185, v185, v227
    s_waitcnt vmcnt(7)
    v_dot2_f32_bf16 v226, v186, s77, v226
    v_dot2_f32_bf16 v227, v186, v186, v227
    v_dot2_f32_bf16 v226, v187, s77, v226
    v_dot2_f32_bf16 v227, v187, v187, v227
    v_dot2_f32_bf16 v226, v188, s77, v226
    v_dot2_f32_bf16 v227, v188, v188, v227
    v_dot2_f32_bf16 v226, v189, s77, v226
    v_dot2_f32_bf16 v227, v189, v189, v227
    buffer_load_dword v12, v16, s[44:47], 0 offen sc1
    v_lshlrev_b32 v190, 16, v182
    v_and_b32 v191, 0xffff0000, v182
    v_add_f32_dpp v226, v226, v226 quad_perm:[1,0,3,2] row_mask:0xf bank_mask:0xf
    v_add_f32_dpp v227, v227, v227 quad_perm:[1,0,3,2] row_mask:0xf bank_mask:0xf
    v_lshlrev_b32 v192, 16, v183
    v_add_f32_dpp v226, v226, v226 quad_perm:[2,3,0,1] row_mask:0xf bank_mask:0xf
    v_add_f32_dpp v227, v227, v227 quad_perm:[2,3,0,1] row_mask:0xf bank_mask:0xf
    v_and_b32 v193, 0xffff0000, v183
    v_add_f32_dpp v226, v226, v226 row_half_mirror row_mask:0xf bank_mask:0xf
    v_add_f32_dpp v227, v227, v227 row_half_mirror row_mask:0xf bank_mask:0xf
    v_lshlrev_b32 v194, 16, v184
    v_add_f32_dpp v226, v226, v226 row_mirror row_mask:0xf bank_mask:0xf
    v_add_f32_dpp v227, v227, v227 row_mirror row_mask:0xf bank_mask:0xf
    v_and_b32 v195, 0xffff0000, v184
    v_mov_b32 v228, v226
    v_mov_b32 v229, v227
    v_lshlrev_b32 v196, 16, v185
    v_permlane16_swap_b32 v226, v228
    v_permlane16_swap_b32 v227, v229
    v_add_f32 v226, v226, v228
    v_add_f32 v227, v227, v229
    v_mul_f32_e64 v226, -v226, s76
    v_mul_f32 v228, v226, v226
    v_fma_f32 v227, v227, s76, -v228
    v_max_f32 v227, 0, v227
    v_add_f32 v228, s75, v227
    v_rsq_f32 v222, v228
    v_and_b32 v197, 0xffff0000, v185
    v_mul_f32 v228, v222, v222
    v_fma_f32 v229, v228, v227, s75
    v_rsq_f32 v228, v229
    v_mul_f32 v223, v226, v222
    v_mul_f32 v224, v222, v228
    v_mul_f32 v225, v223, v228
    v_mul_f32 v229, v229, v228
    ds_write_b32 v232, v229
    v_lshlrev_b32 v198, 16, v186
    v_and_b32 v199, 0xffff0000, v186
    v_lshlrev_b32 v200, 16, v187
    v_and_b32 v201, 0xffff0000, v187
    v_lshlrev_b32 v202, 16, v188
    v_and_b32 v203, 0xffff0000, v188
    v_lshlrev_b32 v204, 16, v189
    v_and_b32 v205, 0xffff0000, v189
    v_pk_fma_f32 v[206:207], v[190:191], v[224:225], v[224:225] op_sel:[0,0,1] op_sel_hi:[1,0,1]
    v_pk_fma_f32 v[208:209], v[192:193], v[224:225], v[224:225] op_sel:[0,0,1] op_sel_hi:[1,0,1]
    v_pk_fma_f32 v[210:211], v[194:195], v[224:225], v[224:225] op_sel:[0,0,1] op_sel_hi:[1,0,1]
    v_pk_fma_f32 v[212:213], v[196:197], v[224:225], v[224:225] op_sel:[0,0,1] op_sel_hi:[1,0,1]
    v_cvt_pk_bf16_f32 v182, v206, v207
    v_cvt_pk_bf16_f32 v183, v208, v209
    v_cvt_pk_bf16_f32 v184, v210, v211
    v_cvt_pk_bf16_f32 v185, v212, v213
    ds_write_b128 v230, v[182:185] offset:0
    v_pk_fma_f32 v[214:215], v[198:199], v[224:225], v[224:225] op_sel:[0,0,1] op_sel_hi:[1,0,1]
    v_pk_fma_f32 v[216:217], v[200:201], v[224:225], v[224:225] op_sel:[0,0,1] op_sel_hi:[1,0,1]
    v_pk_fma_f32 v[218:219], v[202:203], v[224:225], v[224:225] op_sel:[0,0,1] op_sel_hi:[1,0,1]
    v_pk_fma_f32 v[220:221], v[204:205], v[224:225], v[224:225] op_sel:[0,0,1] op_sel_hi:[1,0,1]
    v_cvt_pk_bf16_f32 v186, v214, v215
    v_cvt_pk_bf16_f32 v187, v216, v217
    v_cvt_pk_bf16_f32 v188, v218, v219
    v_cvt_pk_bf16_f32 v189, v220, v221
    ds_write_b128 v230, v[186:189] offset:448
    s_waitcnt lgkmcnt(0)
    s_barrier
    ds_read_b64_tr_b16 v[110:111], v231 offset:0
    ds_read_b64_tr_b16 v[112:113], v231 offset:3840
    ds_read_b64_tr_b16 v[114:115], v231 offset:128
    ds_read_b64_tr_b16 v[116:117], v231 offset:3968
    ds_read_b32 v229, v237
    s_waitcnt lgkmcnt(3)
    buffer_store_dwordx4 v[110:113], v233, s[28:31], s70 offen sc1
    s_waitcnt lgkmcnt(1)
    buffer_store_dwordx4 v[114:117], v233, s[28:31], s71 offen sc1
    v_cmp_gt_u32 vcc, 16, v1
    s_waitcnt lgkmcnt(0)
    s_nop 0
    v_cndmask_b32 v229, 0, v229, vcc
    buffer_store_dword v229, v238, s[28:31], s72 offen sc1
    s_add_u32 m0, s58, 16384
    s_add_u32 s0, s0, 458752
    s_cmp_eq_u32 s0, 3670016
    s_cselect_b32 s0, 0, s0
    buffer_load_dwordx4 v55, s[20:23], s0 offen lds
    buffer_load_dwordx4 v56, s[20:23], s0 offen offset:1024 lds
    buffer_load_dwordx4 v57, s[20:23], s0 offen offset:2048 lds
    buffer_load_dwordx4 v58, s[20:23], s0 offen offset:3072 lds
    s_branch L_anchor
.p2align 12
L_anchor:
    s_mov_b32 s18, 401408
    s_mov_b32 s19, 0x20000
    s_mov_b32 s26, 7340032
    s_mov_b32 s27, 0x20000
    s_mov_b32 s34, 1835008
    s_mov_b32 s35, 0x20000
    s_mov_b32 s36, 1
    v_lshrrev_b32 v14, 2, v1
    v_lshlrev_b32 v14, 7, v14
    v_lshl_add_u32 v14, v8, 3, v14
    v_and_b32 v15, 3, v5
    v_lshl_add_u32 v14, v15, 5, v14
    s_mul_i32 s3, s4, 8256
    v_xor_b32 v31, s3, v14
    v_xor_b32 v32, 32, v31
    v_xor_b32 v33, 64, v31
    v_xor_b32 v34, 96, v31
    v_add_u32 v35, 65536, v31
    v_add_u32 v36, 65536, v32
    v_add_u32 v37, 65536, v33
    v_add_u32 v38, 65536, v34
    v_add_u32 v39, 131072, v31
    v_add_u32 v40, 131072, v32
    v_add_u32 v41, 131072, v33
    v_add_u32 v42, 131072, v34
    s_lshl_b32 s6, s52, 1
    s_add_u32 s6, s6, s5
    s_lshl_b32 s3, s6, 1
    s_add_u32 s3, s3, s59
    s_lshl_b32 s3, s3, 4
    s_add_u32 s3, s3, s4
    s_lshl_b32 s3, s3, 12
    v_lshl_add_u32 v78, v3, 8, v4
    v_add_u32 v78, s3, v78
    s_xor_b32 s37, s51, 1
    s_lshl_b32 s37, s37, 3
    s_add_u32 s37, s37, s52
    s_lshl_b32 s3, s37, 14
    s_add_u32 s3, s3, s58
    s_add_u32 s3, s3, 16777216
    v_add_u32 v23, s3, v4
    s_lshl_b32 s37, s37, 5
    s_add_u32 s37, s37, s5
    s_lshl_b32 s37, s37, 2
    s_add_u32 s37, s37, 6422528
    s_mul_i32 s67, s6, 56
    s_lshl_b32 s3, s51, 1
    s_add_u32 s3, s3, s4
    s_add_u32 s67, s67, s3
    s_lshl_b32 s67, s67, 11
    s_add_u32 s67, s67, 2097152
    v_add_u32 v81, s58, v4
    s_lshl_b32 s68, s52, 2
    s_and_b32 s3, s51, 1
    s_add_u32 s68, s68, s3
    s_cmp_ge_u32 s51, 14
    s_cselect_b32 s3, 2, 0
    s_add_u32 s68, s68, s3
    s_lshl_b32 s68, s68, 7
    s_add_u32 s68, s68, 6356992
    s_waitcnt vmcnt(7)
    v_readfirstlane_b32 s57, v12
    s_mov_b32 s60, 0
    s_cmp_lg_u32 s57, 0
    s_cbranch_scc0 L_nonce
L_nonce_ok:
    s_waitcnt vmcnt(4)
    s_barrier
    s_atomic_swap s57, s[28:29], s74
    s_atomic_swap s57, s[28:29], s73
    buffer_load_dwordx4 v[96:99], v85, s[8:11], 0 offen
    buffer_load_ushort v93, v82, s[40:43], 0 offen offset:0
    buffer_load_dwordx4 v[100:103], v86, s[8:11], 0 offen
    buffer_load_ushort v94, v82, s[40:43], 0 offen offset:16
    v_add_u32 v53, 65536, v4
    s_add_u32 m0, s58, 32768
    s_add_u32 s0, s0, 458752
    s_cmp_eq_u32 s0, 3670016
    s_cselect_b32 s0, 0, s0
    buffer_load_dwordx4 v55, s[20:23], s0 offen lds
    v_add_u32 v54, 131072, v4
    s_mul_i32 s59, s48, 3072
    s_mul_i32 s3, s50, 86016
    s_add_u32 s3, s3, s59
    s_add_u32 s3, s3, 8388608
    v_add_u32 v80, s3, v4
    v_lshlrev_b32 v14, 7, v9
    v_xor_b32 v14, v14, v4
    s_lshl_b32 s3, s49, 11
    v_add_u32 v67, s3, v14
    v_add_u32 v68, 129024, v67
    s_lshr_b32 s3, s49, 2
    s_lshl_b32 s3, s3, 3
    s_max_u32 s3, s3, 1
    s_sub_u32 s3, s3, 1
    s_lshl_b32 s3, s3, 10
    s_lshl_b32 s6, s5, 17
    s_add_u32 s3, s3, s6
    s_lshl_b32 s6, s4, 28
    s_add_u32 s3, s3, s6
    v_add_u32 v69, s3, v14
    buffer_load_dwordx4 v56, s[20:23], s0 offen offset:1024 lds
    s_lshl_b32 s100, s5, 1
    s_add_u32 s100, s100, s4
    s_lshl_b32 s100, s100, 10
    v_and_b32 v14, 1, v1
    v_mul_u32_u24 v14, 640, v14
    v_lshrrev_b32 v15, 2, v1
    v_lshlrev_b32 v15, 4, v15
    v_xor_b32 v14, v14, v15
    v_bfe_u32 v15, v1, 1, 1
    v_lshl_add_u32 v14, v15, 3, v14
    buffer_load_dwordx4 v57, s[20:23], s0 offen offset:2048 lds
    s_add_u32 s3, s58, 12288
    v_add_u32 v70, s3, v14
    s_sub_u32 s3, s3, 3072
    s_cmp_eq_u32 s48, 0
    s_cselect_b32 s3, 28672, s3
    v_add_u32 v71, s3, v14
    v_add_u32 v72, 65536, v70
    v_add_u32 v73, 65536, v71
    v_add_u32 v74, 131072, v70
    v_add_u32 v75, 131072, v71
    s_lshl_b32 s3, s49, 1
    v_min_u32 v14, 2, v3
    v_add_u32 v14, s3, v14
    v_max_u32 v14, 1, v14
    v_lshlrev_b32 v14, 1, v14
    v_and_b32 v15, 1, v7
    buffer_load_dwordx4 v58, s[20:23], s0 offen offset:3072 lds
    v_add_lshl_u32 v14, v14, v15, 7
    v_lshrrev_b32 v15, 1, v7
    v_lshl_add_u32 v15, v15, 2, v8
    v_lshl_add_u32 v14, v15, 2, v14
    v_add_u32 v77, 6291200, v14
    s_min_u32 s15, s48, 2
    s_lshl_b32 s15, s15, 6
    s_add_u32 s15, s15, 64
    s_lshl_b32 s82, s49, 5
    s_add_u32 s82, s82, s50
    s_lshl_b32 s82, s82, 10
    s_add_u32 s82, s82, 4194304
    s_lshr_b32 s69, s49, 2
    s_lshl_b32 s69, s69, 1
    s_and_b32 s3, s50, 1
    s_add_u32 s69, s69, s3
    s_lshl_b32 s69, s69, 7
    s_add_u32 s69, s69, 6361088
    s_and_b32 s7, s53, 1
    s_mul_i32 s3, s7, 28
    s_add_u32 s3, s3, s48
    s_lshl_b32 s3, s3, 17
    s_xor_b32 s6, s53, 1
    s_lshl_b32 s55, s6, 3
    s_lshl_b32 s6, s53, 7
    s_add_u32 s3, s3, s6
    v_lshlrev_b32 v14, 12, v5
    s_add_u32 m0, s58, 49152
    s_add_u32 s0, s0, 458752
    s_cmp_eq_u32 s0, 3670016
    s_cselect_b32 s0, 0, s0
    buffer_load_dwordx4 v55, s[20:23], s0 offen lds
    v_add3_u32 v59, v14, v83, s3
    v_add_u32 v60, 31744, v59
    v_add_u32 v61, 63488, v59
    v_add_u32 v62, 95232, v59
    v_mul_u32_u24 v14, 896, v5
    s_mul_i32 s3, s4, 25088
    s_mul_i32 s6, s5, 14336
    s_add_u32 s3, s3, s6
    s_lshl_b32 s6, s54, 7
    s_add_u32 s3, s3, s6
    v_add3_u32 v63, v14, v83, s3
    buffer_load_dwordx4 v56, s[20:23], s0 offen offset:1024 lds
    v_add_u32 v64, 6144, v63
    s_lshl_b32 s6, s53, 1
    s_add_u32 s6, s6, s5
    s_and_b32 s3, s53, 30
    s_add_u32 s3, s3, s4
    s_lshl_b32 s3, s3, 7
    s_add_u32 s39, s3, 6361088
    s_lshl_b32 s3, s6, 5
    s_add_u32 s3, s3, s4
    s_lshl_b32 s3, s3, 10
    s_add_u32 s3, s3, 4194304
    v_add_u32 v65, s3, v4
    v_add_u32 v66, 15360, v65
    s_xor_b32 s3, s4, s5
    s_lshl_b32 s3, s3, 6
    v_xor_b32 v43, s3, v31
    buffer_load_dwordx4 v57, s[20:23], s0 offen offset:2048 lds
    v_xor_b32 v44, 32, v43
    v_add_u32 v45, 65536, v43
    v_add_u32 v46, 65536, v44
    s_mul_i32 s3, s4, 12288
    v_add_u32 v47, s3, v4
    v_xor_b32 v48, 4096, v47
    v_add_u32 v49, 65536, v47
    v_add_u32 v50, 65536, v48
    v_add_u32 v51, 131072, v47
    v_add_u32 v52, 131072, v48
    s_lshl_b32 s6, s54, 1
    s_add_u32 s6, s6, s5
    s_lshl_b32 s3, s6, 1
    s_add_u32 s3, s3, s7
    s_mul_i32 s3, s3, 14
    s_add_u32 s3, s3, s4
    s_lshl_b32 s3, s3, 12
    s_add_u32 s3, s3, 2097152
    v_add_u32 v79, s3, v4
    buffer_load_dwordx4 v58, s[20:23], s0 offen offset:3072 lds
    s_lshl_b32 s3, s54, 1
    s_add_u32 s3, s3, s7
    s_lshl_b32 s3, s3, 1
    s_add_u32 s3, s3, s4
    s_lshl_b32 s3, s3, 7
    s_add_u32 s38, s3, 6356992
    s_and_b32 s3, s2, 6
    s_add_u32 s3, s3, s54
    s_sub_u32 s6, s3, 7
    s_cmp_ge_u32 s3, 7
    s_cselect_b32 s3, s6, s3
    s_lshl_b32 s64, s3, 19
    s_lshl_b32 s65, s3, 13
    s_add_u32 s55, s55, s54
    s_lshl_b32 s3, s55, 14
    s_add_u32 s3, s3, s58
    s_add_u32 s3, s3, 12582912
    v_add_u32 v21, s3, v4
    s_add_u32 m0, s58, 65536
    s_add_u32 s0, s0, 458752
    s_cmp_eq_u32 s0, 3670016
    s_cselect_b32 s0, 0, s0
    buffer_load_dwordx4 v55, s[20:23], s0 offen lds
    s_lshl_b32 s55, s55, 5
    s_add_u32 s55, s55, s48
    s_lshl_b32 s55, s55, 2
    s_add_u32 s55, s55, 6488064
    s_lshl_b32 s3, s5, 3
    v_add_u32 v13, s3, v3
    v_xor_b32 v13, v13, v6
    v_lshlrev_b32 v13, 4, v13
    v_lshl_add_u32 v13, v2, 8, v13
    buffer_load_dwordx4 v56, s[20:23], s0 offen offset:1024 lds
    s_lshl_b32 s3, s4, 14
    s_add_u32 s3, s3, 32768
    v_add_u32 v87, s3, v13
    v_xor_b32 v88, 64, v87
    s_lshr_b32 s3, s53, 1
    s_add_u32 s66, s3, s54
    s_mov_b32 s51, s66
    v_lshlrev_b32 v13, 1, v6
    v_xor_b32 v13, v13, v5
    v_lshlrev_b32 v13, 4, v13
    v_lshl_add_u32 v13, v5, 8, v13
    s_add_u32 s3, s58, 32768
    v_add_u32 v89, s3, v13
    v_xor_b32 v90, 16, v89
    v_xor_b32 v91, 24576, v89
    v_xor_b32 v92, 24592, v89
    buffer_load_dwordx4 v57, s[20:23], s0 offen offset:2048 lds
    v_lshlrev_b32 v150, 16, v246
    v_and_b32 v151, 0xffff0000, v246
    v_lshlrev_b32 v152, 16, v247
    v_and_b32 v153, 0xffff0000, v247
    v_lshlrev_b32 v154, 16, v248
    v_and_b32 v155, 0xffff0000, v248
    v_lshlrev_b32 v156, 16, v249
    v_and_b32 v157, 0xffff0000, v249
    v_lshlrev_b32 v158, 16, v246
    v_and_b32 v159, 0xffff0000, v246
    v_lshlrev_b32 v160, 16, v247
    v_and_b32 v161, 0xffff0000, v247
    v_lshlrev_b32 v162, 16, v248
    v_and_b32 v163, 0xffff0000, v248
    v_lshlrev_b32 v164, 16, v249
    v_and_b32 v165, 0xffff0000, v249
    buffer_load_dwordx4 v58, s[20:23], s0 offen offset:3072 lds
    s_add_u32 m0, s58, 81920
    s_add_u32 s0, s0, 458752
    s_cmp_eq_u32 s0, 3670016
    s_cselect_b32 s0, 0, s0
    buffer_load_dwordx4 v55, s[20:23], s0 offen lds
    buffer_load_dwordx4 v56, s[20:23], s0 offen offset:1024 lds
    buffer_load_dwordx4 v57, s[20:23], s0 offen offset:2048 lds
    buffer_load_dwordx4 v58, s[20:23], s0 offen offset:3072 lds
    s_add_u32 m0, s58, 98304
    s_add_u32 s0, s0, 458752
    s_cmp_eq_u32 s0, 3670016
    s_cselect_b32 s0, 0, s0
    buffer_load_dwordx4 v55, s[20:23], s0 offen lds
    buffer_load_dwordx4 v56, s[20:23], s0 offen offset:1024 lds
    buffer_load_dwordx4 v57, s[20:23], s0 offen offset:2048 lds
    buffer_load_dwordx4 v58, s[20:23], s0 offen offset:3072 lds
    buffer_load_dword v18, v20, s[28:31], 0 offen sc1
    s_add_u32 m0, s58, 114688
    s_add_u32 s0, s0, 458752
    s_cmp_eq_u32 s0, 3670016
    s_cselect_b32 s0, 0, s0
    buffer_load_dwordx4 v55, s[20:23], s0 offen lds
    buffer_load_dwordx4 v56, s[20:23], s0 offen offset:1024 lds
    buffer_load_dwordx4 v57, s[20:23], s0 offen offset:2048 lds
    buffer_load_dwordx4 v58, s[20:23], s0 offen offset:3072 lds
    s_mov_b32 s3, s48
    s_mov_b64 exec, 0
L_warm:
    s_add_u32 s3, s3, 4
    s_cmp_eq_u32 s3, 4
    s_cbranch_scc1 L_pad0
    s_cmp_eq_u32 s3, 5
    s_cbranch_scc1 L_pad1
    s_cmp_eq_u32 s3, 6
    s_cbranch_scc1 L_pad2
    s_cmp_eq_u32 s3, 7
    s_cbranch_scc1 L_pad3
    s_cmp_eq_u32 s3, 8
    s_cbranch_scc1 L_pad4
    s_mov_b64 exec, -1
    s_waitcnt vmcnt(4)
    v_cmp_ne_u32 vcc, s57, v18
    s_cbranch_vccnz L_pollin0
L_pollok0:
    s_barrier
    buffer_load_dwordx4 a[0:3], v78, s[28:31], s1 offen offset:0 sc1
    buffer_load_dwordx4 a[4:7], v78, s[28:31], s1 offen offset:256 sc1
    buffer_load_dwordx4 a[8:11], v78, s[28:31], s1 offen offset:2048 sc1
    buffer_load_dwordx4 a[12:15], v78, s[28:31], s1 offen offset:2304 sc1
    buffer_load_dword v76, v77, s[28:31], 0 offen sc1
    s_add_u32 s1, s1, 8192
    s_and_b32 s1, s1, 0xffff
    buffer_load_dwordx4 a[16:19], v78, s[28:31], s1 offen offset:0 sc1
    buffer_load_dwordx4 a[20:23], v78, s[28:31], s1 offen offset:256 sc1
    buffer_load_dwordx4 a[24:27], v78, s[28:31], s1 offen offset:2048 sc1
    buffer_load_dwordx4 a[28:31], v78, s[28:31], s1 offen offset:2304 sc1
    s_add_u32 s1, s1, 8192
    s_and_b32 s1, s1, 0xffff
    buffer_load_dwordx4 a[32:35], v78, s[28:31], s1 offen offset:0 sc1
    buffer_load_dwordx4 a[36:39], v78, s[28:31], s1 offen offset:256 sc1
    buffer_load_dwordx4 a[40:43], v78, s[28:31], s1 offen offset:2048 sc1
    buffer_load_dwordx4 a[44:47], v78, s[28:31], s1 offen offset:2304 sc1
    ds_read_b64_tr_b16 a[200:201], v31 offset:0
    ds_read_b64_tr_b16 a[202:203], v31 offset:2048
    ds_read_b64_tr_b16 a[204:205], v33 offset:0
    ds_read_b64_tr_b16 a[206:207], v33 offset:2048
    ds_read_b64_tr_b16 a[208:209], v32 offset:0
    ds_read_b64_tr_b16 a[210:211], v32 offset:2048
    ds_read_b64_tr_b16 a[212:213], v34 offset:0
    ds_read_b64_tr_b16 a[214:215], v34 offset:2048
    ds_read_b64_tr_b16 a[216:217], v31 offset:4096
    ds_read_b64_tr_b16 a[218:219], v31 offset:6144
    ds_read_b64_tr_b16 a[220:221], v33 offset:4096
    ds_read_b64_tr_b16 a[222:223], v33 offset:6144
    s_waitcnt vmcnt(11) lgkmcnt(8)
    v_mfma_f32_16x16x32_bf16 v[182:185], a[200:203], a[0:3], 0
    ds_read_b64_tr_b16 a[224:225], v32 offset:4096
    s_add_u32 s1, s1, 8192
    v_mfma_f32_16x16x32_bf16 v[190:193], a[200:203], a[4:7], 0
    ds_read_b64_tr_b16 a[226:227], v32 offset:6144
    s_and_b32 s1, s1, 0xffff
    s_mov_b32 s70, 0xaaaaaaaa
    s_mov_b32 s71, 0xaaaaaaaa
    s_mov_b32 s72, 0xfff0ffff
    s_mov_b32 s73, 0xf000ff00
    s_mov_b32 s74, 0xffc0fffc
    v_mfma_f32_16x16x32_bf16 v[198:201], a[204:207], a[0:3], 0
    ds_read_b64_tr_b16 a[228:229], v34 offset:4096
    buffer_load_dwordx4 a[48:51], v78, s[28:31], s1 offen offset:0 sc1
    v_mfma_f32_16x16x32_bf16 v[206:209], a[204:207], a[4:7], 0
    ds_read_b64_tr_b16 a[230:231], v34 offset:6144
    s_mov_b32 s75, 0xc000fc00
    s_waitcnt lgkmcnt(8)
    v_mfma_f32_16x16x32_bf16 v[186:189], a[208:211], a[0:3], 0
    ds_read_b64_tr_b16 a[200:201], v31 offset:16384
    s_mov_b32 s83, 0x3e8b97f6
    v_mfma_f32_16x16x32_bf16 v[194:197], a[208:211], a[4:7], 0
    ds_read_b64_tr_b16 a[202:203], v31 offset:18432
    buffer_load_dwordx4 a[52:55], v78, s[28:31], s1 offen offset:256 sc1
    v_lshlrev_b32 v13, 2, v2
    v_mfma_f32_16x16x32_bf16 v[202:205], a[212:215], a[0:3], 0
    ds_read_b64_tr_b16 a[204:205], v33 offset:16384
    v_and_b32 v14, 1, v1
    v_mfma_f32_16x16x32_bf16 v[210:213], a[212:215], a[4:7], 0
    ds_read_b64_tr_b16 a[206:207], v33 offset:18432
    s_waitcnt vmcnt(11) lgkmcnt(8)
    v_mfma_f32_16x16x32_bf16 v[182:185], a[216:219], a[8:11], v[182:185]
    ds_read_b64_tr_b16 a[208:209], v32 offset:16384
    buffer_load_dwordx4 a[56:59], v78, s[28:31], s1 offen offset:2048 sc1
    v_mfma_f32_16x16x32_bf16 v[190:193], a[216:219], a[12:15], v[190:193]
    ds_read_b64_tr_b16 a[210:211], v32 offset:18432
    v_lshl_add_u32 v14, v3, 2, v14
    v_mfma_f32_16x16x32_bf16 v[198:201], a[220:223], a[8:11], v[198:201]
    ds_read_b64_tr_b16 a[212:213], v34 offset:16384
    v_lshlrev_b32 v14, 2, v14
    v_mfma_f32_16x16x32_bf16 v[206:209], a[220:223], a[12:15], v[206:209]
    ds_read_b64_tr_b16 a[214:215], v34 offset:18432
    s_waitcnt lgkmcnt(8)
    v_mfma_f32_16x16x32_bf16 v[186:189], a[224:227], a[8:11], v[186:189]
    ds_read_b64_tr_b16 a[216:217], v31 offset:20480
    buffer_load_dwordx4 a[60:63], v78, s[28:31], s1 offen offset:2304 sc1
    v_mfma_f32_16x16x32_bf16 v[194:197], a[224:227], a[12:15], v[194:197]
    ds_read_b64_tr_b16 a[218:219], v31 offset:22528
    s_add_u32 s1, s1, 8192
    v_add_u32 v15, 64, v14
    v_mfma_f32_16x16x32_bf16 v[202:205], a[228:231], a[8:11], v[202:205]
    ds_read_b64_tr_b16 a[220:221], v33 offset:20480
    s_and_b32 s1, s1, 0xffff
    v_mfma_f32_16x16x32_bf16 v[210:213], a[228:231], a[12:15], v[210:213]
    ds_read_b64_tr_b16 a[222:223], v33 offset:22528
    s_waitcnt vmcnt(10) lgkmcnt(8)
    v_mfma_f32_16x16x32_bf16 v[182:185], a[200:203], a[16:19], v[182:185]
    ds_read_b64_tr_b16 a[224:225], v32 offset:20480
    buffer_load_dwordx4 a[64:67], v78, s[28:31], s1 offen offset:0 sc1
    v_mfma_f32_16x16x32_bf16 v[190:193], a[200:203], a[20:23], v[190:193]
    ds_read_b64_tr_b16 a[226:227], v32 offset:22528
    v_cndmask_b32 v16, v14, v15, s[72:73]
    v_mfma_f32_16x16x32_bf16 v[198:201], a[204:207], a[16:19], v[198:201]
    ds_read_b64_tr_b16 a[228:229], v34 offset:20480
    buffer_load_dwordx4 a[68:71], v78, s[28:31], s1 offen offset:256 sc1
    v_mfma_f32_16x16x32_bf16 v[206:209], a[204:207], a[20:23], v[206:209]
    ds_read_b64_tr_b16 a[230:231], v34 offset:22528
    v_cndmask_b32 v14, v14, v15, s[74:75]
    s_waitcnt lgkmcnt(8)
    v_mfma_f32_16x16x32_bf16 v[186:189], a[208:211], a[16:19], v[186:189]
    ds_read_b64_tr_b16 a[200:201], v31 offset:32768
    ds_bpermute_b32 v25, v13, v76 offset:64
    v_mfma_f32_16x16x32_bf16 v[194:197], a[208:211], a[20:23], v[194:197]
    ds_read_b64_tr_b16 a[202:203], v31 offset:34816
    buffer_load_dwordx4 a[72:75], v78, s[28:31], s1 offen offset:2048 sc1
    ds_bpermute_b32 v27, v16, v76 offset:0
    v_mfma_f32_16x16x32_bf16 v[202:205], a[212:215], a[16:19], v[202:205]
    ds_read_b64_tr_b16 a[204:205], v33 offset:32768
    ds_bpermute_b32 v28, v14, v76 offset:8
    v_mfma_f32_16x16x32_bf16 v[210:213], a[212:215], a[20:23], v[210:213]
    ds_read_b64_tr_b16 a[206:207], v33 offset:34816
    s_waitcnt vmcnt(11) lgkmcnt(11)
    v_mfma_f32_16x16x32_bf16 v[182:185], a[216:219], a[24:27], v[182:185]
    ds_read_b64_tr_b16 a[208:209], v32 offset:32768
    ds_bpermute_b32 v26, v13, v76 offset:128
    v_mfma_f32_16x16x32_bf16 v[190:193], a[216:219], a[28:31], v[190:193]
    ds_read_b64_tr_b16 a[210:211], v32 offset:34816
    buffer_load_dwordx4 a[76:79], v78, s[28:31], s1 offen offset:2304 sc1
    ds_bpermute_b32 v29, v16, v76 offset:64
    v_mfma_f32_16x16x32_bf16 v[198:201], a[220:223], a[24:27], v[198:201]
    ds_read_b64_tr_b16 a[212:213], v34 offset:32768
    s_add_u32 s1, s1, 8192
    v_mfma_f32_16x16x32_bf16 v[206:209], a[220:223], a[28:31], v[206:209]
    ds_read_b64_tr_b16 a[214:215], v34 offset:34816
    s_waitcnt lgkmcnt(13)
    v_mfma_f32_16x16x32_bf16 v[186:189], a[224:227], a[24:27], v[186:189]
    ds_read_b64_tr_b16 a[216:217], v31 offset:36864
    s_and_b32 s1, s1, 0xffff
    v_mfma_f32_16x16x32_bf16 v[194:197], a[224:227], a[28:31], v[194:197]
    ds_read_b64_tr_b16 a[218:219], v31 offset:38912
    buffer_load_dwordx4 a[80:83], v78, s[28:31], s1 offen offset:0 sc1
    ds_bpermute_b32 v30, v14, v76 offset:72
    v_mfma_f32_16x16x32_bf16 v[202:205], a[228:231], a[24:27], v[202:205]
    ds_read_b64_tr_b16 a[220:221], v33 offset:36864
    v_mfma_f32_16x16x32_bf16 v[210:213], a[228:231], a[28:31], v[210:213]
    ds_read_b64_tr_b16 a[222:223], v33 offset:38912
    s_waitcnt vmcnt(11) lgkmcnt(11)
    v_mfma_f32_16x16x32_bf16 v[182:185], a[200:203], a[32:35], v[182:185]
    ds_read_b64_tr_b16 a[224:225], v32 offset:36864
    buffer_load_dwordx4 a[84:87], v78, s[28:31], s1 offen offset:256 sc1
    v_mfma_f32_16x16x32_bf16 v[190:193], a[200:203], a[36:39], v[190:193]
    ds_read_b64_tr_b16 a[226:227], v32 offset:38912
    v_mfma_f32_16x16x32_bf16 v[198:201], a[204:207], a[32:35], v[198:201]
    ds_read_b64_tr_b16 a[228:229], v34 offset:36864
    v_mfma_f32_16x16x32_bf16 v[206:209], a[204:207], a[36:39], v[206:209]
    ds_read_b64_tr_b16 a[230:231], v34 offset:38912
    s_waitcnt lgkmcnt(9)
    v_mfma_f32_16x16x32_bf16 v[186:189], a[208:211], a[32:35], v[186:189]
    s_barrier
    ds_read_b64_tr_b16 a[200:201], v31 offset:49152
    buffer_load_dwordx4 a[88:91], v78, s[28:31], s1 offen offset:2048 sc1
    v_mfma_f32_16x16x32_bf16 v[194:197], a[208:211], a[36:39], v[194:197]
    ds_read_b64_tr_b16 a[202:203], v31 offset:51200
    v_mfma_f32_16x16x32_bf16 v[202:205], a[212:215], a[32:35], v[202:205]
    ds_read_b64_tr_b16 a[204:205], v33 offset:49152
    buffer_load_dwordx4 a[92:95], v78, s[28:31], s1 offen offset:2304 sc1
    v_mfma_f32_16x16x32_bf16 v[210:213], a[212:215], a[36:39], v[210:213]
    ds_read_b64_tr_b16 a[206:207], v33 offset:51200
    s_waitcnt vmcnt(12) lgkmcnt(8)
    v_mfma_f32_16x16x32_bf16 v[182:185], a[216:219], a[40:43], v[182:185]
    ds_read_b64_tr_b16 a[208:209], v32 offset:49152
    s_add_u32 m0, s58, 131072
    v_mfma_f32_16x16x32_bf16 v[190:193], a[216:219], a[44:47], v[190:193]
    ds_read_b64_tr_b16 a[210:211], v32 offset:51200
    s_add_u32 s0, s0, 458752
    v_mul_f32 v25, s83, v25
    v_mfma_f32_16x16x32_bf16 v[198:201], a[220:223], a[40:43], v[198:201]
    ds_read_b64_tr_b16 a[212:213], v34 offset:49152
    s_cmp_eq_u32 s0, 3670016
    v_mfma_f32_16x16x32_bf16 v[206:209], a[220:223], a[44:47], v[206:209]
    ds_read_b64_tr_b16 a[214:215], v34 offset:51200
    s_cselect_b32 s0, 0, s0
    v_xor_b32 v55, 128, v55
    buffer_load_dwordx4 v55, s[20:23], s0 offen lds
    s_waitcnt lgkmcnt(8)
    v_mfma_f32_16x16x32_bf16 v[186:189], a[224:227], a[40:43], v[186:189]
    ds_read_b64_tr_b16 a[216:217], v31 offset:53248
    v_xor_b32 v56, 128, v56
    v_mfma_f32_16x16x32_bf16 v[194:197], a[224:227], a[44:47], v[194:197]
    ds_read_b64_tr_b16 a[218:219], v31 offset:55296
    buffer_load_dwordx4 v56, s[20:23], s0 offen offset:1024 lds
    v_mul_f32 v26, s83, v26
    v_mfma_f32_16x16x32_bf16 v[202:205], a[228:231], a[40:43], v[202:205]
    ds_read_b64_tr_b16 a[220:221], v33 offset:53248
    v_xor_b32 v57, 128, v57
    v_mfma_f32_16x16x32_bf16 v[210:213], a[228:231], a[44:47], v[210:213]
    ds_read_b64_tr_b16 a[222:223], v33 offset:55296
    s_waitcnt vmcnt(12) lgkmcnt(8)
    v_mfma_f32_16x16x32_bf16 v[182:185], a[200:203], a[48:51], v[182:185]
    ds_read_b64_tr_b16 a[224:225], v32 offset:53248
    buffer_load_dwordx4 v57, s[20:23], s0 offen offset:2048 lds
    v_mfma_f32_16x16x32_bf16 v[190:193], a[200:203], a[52:55], v[190:193]
    ds_read_b64_tr_b16 a[226:227], v32 offset:55296
    v_xor_b32 v58, 128, v58
    s_cmp_eq_u32 s49, 0
    s_cselect_b64 s[76:77], 0, -1
    v_mfma_f32_16x16x32_bf16 v[198:201], a[204:207], a[48:51], v[198:201]
    ds_read_b64_tr_b16 a[228:229], v34 offset:53248
    v_mov_b32 v13, 0xffff
    v_mfma_f32_16x16x32_bf16 v[206:209], a[204:207], a[52:55], v[206:209]
    ds_read_b64_tr_b16 a[230:231], v34 offset:55296
    s_waitcnt lgkmcnt(8)
    v_mfma_f32_16x16x32_bf16 v[186:189], a[208:211], a[48:51], v[186:189]
    ds_read_b64_tr_b16 a[200:201], v35 offset:0
    buffer_load_dwordx4 v58, s[20:23], s0 offen offset:3072 lds
    v_mfma_f32_16x16x32_bf16 v[194:197], a[208:211], a[52:55], v[194:197]
    ds_read_b64_tr_b16 a[202:203], v35 offset:2048
    s_add_u32 s1, s1, 8192
    v_mov_b32 v14, 0xffff0000
    v_mfma_f32_16x16x32_bf16 v[202:205], a[212:215], a[48:51], v[202:205]
    ds_read_b64_tr_b16 a[204:205], v37 offset:0
    s_and_b32 s1, s1, 0xffff
    v_mfma_f32_16x16x32_bf16 v[210:213], a[212:215], a[52:55], v[210:213]
    ds_read_b64_tr_b16 a[206:207], v37 offset:2048
    v_cndmask_b32 v13, v13, v14, s[70:71]
    s_waitcnt vmcnt(12) lgkmcnt(8)
    v_mfma_f32_16x16x32_bf16 v[182:185], a[216:219], a[56:59], v[182:185]
    ds_read_b64_tr_b16 a[208:209], v36 offset:0
    buffer_load_dwordx4 a[96:99], v78, s[28:31], s1 offen offset:0 sc1
    v_mfma_f32_16x16x32_bf16 v[190:193], a[216:219], a[60:63], v[190:193]
    ds_read_b64_tr_b16 a[210:211], v36 offset:2048
    v_cndmask_b32 v104, v13, 0, s[72:73]
    v_mfma_f32_16x16x32_bf16 v[198:201], a[220:223], a[56:59], v[198:201]
    ds_read_b64_tr_b16 a[212:213], v38 offset:0
    buffer_load_dwordx4 a[100:103], v78, s[28:31], s1 offen offset:256 sc1
    v_mfma_f32_16x16x32_bf16 v[206:209], a[220:223], a[60:63], v[206:209]
    ds_read_b64_tr_b16 a[214:215], v38 offset:2048
    v_cndmask_b32 v106, 0, v13, s[72:73]
    s_waitcnt lgkmcnt(8)
    v_mfma_f32_16x16x32_bf16 v[186:189], a[224:227], a[56:59], v[186:189]
    ds_read_b64_tr_b16 a[216:217], v35 offset:4096
    v_cndmask_b32 v105, v13, 0, s[74:75]
    v_mfma_f32_16x16x32_bf16 v[194:197], a[224:227], a[60:63], v[194:197]
    ds_read_b64_tr_b16 a[218:219], v35 offset:6144
    buffer_load_dwordx4 a[104:107], v78, s[28:31], s1 offen offset:2048 sc1
    v_cndmask_b32 v107, 0, v13, s[74:75]
    v_mfma_f32_16x16x32_bf16 v[202:205], a[228:231], a[56:59], v[202:205]
    ds_read_b64_tr_b16 a[220:221], v37 offset:4096
    v_mov_b32 v84, 0xf149f2ca
    v_mfma_f32_16x16x32_bf16 v[210:213], a[228:231], a[60:63], v[210:213]
    ds_read_b64_tr_b16 a[222:223], v37 offset:6144
    s_waitcnt vmcnt(13) lgkmcnt(8)
    v_mfma_f32_16x16x32_bf16 v[182:185], a[200:203], a[64:67], v[182:185]
    ds_read_b64_tr_b16 a[224:225], v36 offset:4096
    buffer_load_dwordx4 a[108:111], v78, s[28:31], s1 offen offset:2304 sc1
    v_mfma_f32_16x16x32_bf16 v[190:193], a[200:203], a[68:71], v[190:193]
    ds_read_b64_tr_b16 a[226:227], v36 offset:6144
    s_add_u32 m0, s58, 147456
    s_mov_b32 s83, 0x3e8b97f6
    v_mfma_f32_16x16x32_bf16 v[198:201], a[204:207], a[64:67], v[198:201]
    ds_read_b64_tr_b16 a[228:229], v38 offset:4096
    s_add_u32 s0, s0, 458752
    v_mfma_f32_16x16x32_bf16 v[206:209], a[204:207], a[68:71], v[206:209]
    ds_read_b64_tr_b16 a[230:231], v38 offset:6144
    s_mov_b32 s78, 0xbdd2d3e8
    s_mov_b32 s79, 0xbdd2d3e8
    s_waitcnt lgkmcnt(8)
    v_mfma_f32_16x16x32_bf16 v[186:189], a[208:211], a[64:67], v[186:189]
    s_barrier
    s_mov_b32 s14, 0
    s_load_dword s14, s[44:45], s15
    ds_read_b64_tr_b16 a[200:201], v35 offset:16384
    s_cmp_eq_u32 s0, 3670016
    s_cselect_b32 s0, 0, s0
    buffer_load_dwordx4 v55, s[20:23], s0 offen lds
    v_mfma_f32_16x16x32_bf16 v[194:197], a[208:211], a[68:71], v[194:197]
    ds_read_b64_tr_b16 a[202:203], v35 offset:18432
    s_mov_b32 s80, 1.0
    v_mfma_f32_16x16x32_bf16 v[202:205], a[212:215], a[64:67], v[202:205]
    ds_read_b64_tr_b16 a[204:205], v37 offset:16384
    buffer_load_dwordx4 v56, s[20:23], s0 offen offset:1024 lds
    v_mfma_f32_16x16x32_bf16 v[210:213], a[212:215], a[68:71], v[210:213]
    ds_read_b64_tr_b16 a[206:207], v37 offset:18432
    s_mov_b32 s81, 1.0
    s_waitcnt vmcnt(14) lgkmcnt(8)
    v_mfma_f32_16x16x32_bf16 v[182:185], a[216:219], a[72:75], v[182:185]
    ds_read_b64_tr_b16 a[208:209], v36 offset:16384
    v_mov_b32 v108, 0xc0135761
    v_mfma_f32_16x16x32_bf16 v[190:193], a[216:219], a[76:79], v[190:193]
    ds_read_b64_tr_b16 a[210:211], v36 offset:18432
    buffer_load_dwordx4 v57, s[20:23], s0 offen offset:2048 lds
    v_mov_b32 v109, 0xc0135761
    v_mfma_f32_16x16x32_bf16 v[198:201], a[220:223], a[72:75], v[198:201]
    ds_read_b64_tr_b16 a[212:213], v38 offset:16384
    v_lshrrev_b32 v13, 1, v2
    v_mfma_f32_16x16x32_bf16 v[206:209], a[220:223], a[76:79], v[206:209]
    ds_read_b64_tr_b16 a[214:215], v38 offset:18432
    s_waitcnt lgkmcnt(8)
    v_mfma_f32_16x16x32_bf16 v[186:189], a[224:227], a[72:75], v[186:189]
    ds_read_b64_tr_b16 a[216:217], v35 offset:20480
    buffer_load_dwordx4 v58, s[20:23], s0 offen offset:3072 lds
    v_mfma_f32_16x16x32_bf16 v[194:197], a[224:227], a[76:79], v[194:197]
    ds_read_b64_tr_b16 a[218:219], v35 offset:22528
    s_add_u32 s1, s1, 8192
    v_lshlrev_b32 v14, 1, v3
    v_mfma_f32_16x16x32_bf16 v[202:205], a[228:231], a[72:75], v[202:205]
    ds_read_b64_tr_b16 a[220:221], v37 offset:20480
    s_and_b32 s1, s1, 0xffff
    v_mfma_f32_16x16x32_bf16 v[210:213], a[228:231], a[76:79], v[210:213]
    ds_read_b64_tr_b16 a[222:223], v37 offset:22528
    s_waitcnt vmcnt(14) lgkmcnt(8)
    v_mfma_f32_16x16x32_bf16 v[182:185], a[200:203], a[80:83], v[182:185]
    ds_read_b64_tr_b16 a[224:225], v36 offset:20480
    buffer_load_dwordx4 a[112:115], v78, s[28:31], s1 offen offset:0 sc1
    v_mfma_f32_16x16x32_bf16 v[190:193], a[200:203], a[84:87], v[190:193]
L_pad0:
    s_cbranch_execz L_warm
    ds_read_b64_tr_b16 a[226:227], v36 offset:22528
    v_sub_u32 v13, v13, v14
    v_mfma_f32_16x16x32_bf16 v[198:201], a[204:207], a[80:83], v[198:201]
    ds_read_b64_tr_b16 a[228:229], v38 offset:20480
    buffer_load_dwordx4 a[116:119], v78, s[28:31], s1 offen offset:256 sc1
    v_mfma_f32_16x16x32_bf16 v[206:209], a[204:207], a[84:87], v[206:209]
    ds_read_b64_tr_b16 a[230:231], v38 offset:22528
    v_mov_b32 v14, 0x3f80
    s_waitcnt lgkmcnt(8)
    v_mfma_f32_16x16x32_bf16 v[186:189], a[208:211], a[80:83], v[186:189]
    ds_read_b64_tr_b16 a[200:201], v35 offset:32768
    v_cndmask_b32 v14, v14, 1.0, s[70:71]
    v_mfma_f32_16x16x32_bf16 v[194:197], a[208:211], a[84:87], v[194:197]
    ds_read_b64_tr_b16 a[202:203], v35 offset:34816
    buffer_load_dwordx4 a[120:123], v78, s[28:31], s1 offen offset:2048 sc1
    v_cmp_eq_i32 vcc, 0, v13
    v_mfma_f32_16x16x32_bf16 v[202:205], a[212:215], a[80:83], v[202:205]
    ds_read_b64_tr_b16 a[204:205], v37 offset:32768
    v_accvgpr_write_b32 a248, 0
    v_mfma_f32_16x16x32_bf16 v[210:213], a[212:215], a[84:87], v[210:213]
    ds_read_b64_tr_b16 a[206:207], v37 offset:34816
    s_waitcnt vmcnt(15) lgkmcnt(8)
    v_mfma_f32_16x16x32_bf16 v[182:185], a[216:219], a[88:91], v[182:185]
    ds_read_b64_tr_b16 a[208:209], v36 offset:32768
    buffer_load_dwordx4 a[124:127], v78, s[28:31], s1 offen offset:2304 sc1
    v_mfma_f32_16x16x32_bf16 v[190:193], a[216:219], a[92:95], v[190:193]
    ds_read_b64_tr_b16 a[210:211], v36 offset:34816
    s_add_u32 m0, s58, 0
    v_accvgpr_write_b32 a252, 0
    v_mfma_f32_16x16x32_bf16 v[198:201], a[220:223], a[88:91], v[198:201]
    ds_read_b64_tr_b16 a[212:213], v38 offset:32768
    s_add_u32 s0, s0, 458752
    v_mfma_f32_16x16x32_bf16 v[206:209], a[220:223], a[92:95], v[206:209]
    ds_read_b64_tr_b16 a[214:215], v38 offset:34816
    s_waitcnt lgkmcnt(8)
    v_mfma_f32_16x16x32_bf16 v[186:189], a[224:227], a[88:91], v[186:189]
    ds_read_b64_tr_b16 a[216:217], v35 offset:36864
    s_cmp_eq_u32 s0, 3670016
    v_mfma_f32_16x16x32_bf16 v[194:197], a[224:227], a[92:95], v[194:197]
    ds_read_b64_tr_b16 a[218:219], v35 offset:38912
    s_cselect_b32 s0, 0, s0
    buffer_load_dwordx4 v55, s[20:23], s0 offen lds
    v_cndmask_b32 v15, 0, v14, vcc
    v_mfma_f32_16x16x32_bf16 v[202:205], a[228:231], a[88:91], v[202:205]
    ds_read_b64_tr_b16 a[220:221], v37 offset:36864
    v_accvgpr_write_b32 a250, v15
    v_mfma_f32_16x16x32_bf16 v[210:213], a[228:231], a[92:95], v[210:213]
    ds_read_b64_tr_b16 a[222:223], v37 offset:38912
    s_waitcnt vmcnt(11) lgkmcnt(8)
    v_mfma_f32_16x16x32_bf16 v[182:185], a[200:203], a[96:99], v[182:185]
    ds_read_b64_tr_b16 a[224:225], v36 offset:36864
    buffer_load_dwordx4 v56, s[20:23], s0 offen offset:1024 lds
    v_mfma_f32_16x16x32_bf16 v[190:193], a[200:203], a[100:103], v[190:193]
    ds_read_b64_tr_b16 a[226:227], v36 offset:38912
    v_cmp_eq_i32 vcc, 1, v13
    v_mfma_f32_16x16x32_bf16 v[198:201], a[204:207], a[96:99], v[198:201]
    ds_read_b64_tr_b16 a[228:229], v38 offset:36864
    buffer_load_dwordx4 v57, s[20:23], s0 offen offset:2048 lds
    v_mfma_f32_16x16x32_bf16 v[206:209], a[204:207], a[100:103], v[206:209]
    ds_read_b64_tr_b16 a[230:231], v38 offset:38912
    v_accvgpr_write_b32 a249, 0
    s_waitcnt lgkmcnt(8)
    v_mfma_f32_16x16x32_bf16 v[186:189], a[208:211], a[96:99], v[186:189]
    s_waitcnt vmcnt(7)
    s_barrier
    ds_read_b64_tr_b16 a[200:201], v35 offset:49152
    buffer_load_dwordx4 v58, s[20:23], s0 offen offset:3072 lds
    v_mfma_f32_16x16x32_bf16 v[194:197], a[208:211], a[100:103], v[194:197]
    ds_read_b64_tr_b16 a[202:203], v35 offset:51200
    s_add_u32 m0, s58, 16384
    v_accvgpr_write_b32 a253, 0
    v_mfma_f32_16x16x32_bf16 v[202:205], a[212:215], a[96:99], v[202:205]
    ds_read_b64_tr_b16 a[204:205], v37 offset:49152
    s_add_u32 s0, s0, 458752
    v_mfma_f32_16x16x32_bf16 v[210:213], a[212:215], a[100:103], v[210:213]
    ds_read_b64_tr_b16 a[206:207], v37 offset:51200
    s_waitcnt lgkmcnt(8)
    v_mfma_f32_16x16x32_bf16 v[182:185], a[216:219], a[104:107], v[182:185]
    ds_read_b64_tr_b16 a[208:209], v36 offset:49152
    s_cmp_eq_u32 s0, 3670016
    v_mfma_f32_16x16x32_bf16 v[190:193], a[216:219], a[108:111], v[190:193]
    ds_read_b64_tr_b16 a[210:211], v36 offset:51200
    s_cselect_b32 s0, 0, s0
    buffer_load_dwordx4 v55, s[20:23], s0 offen lds
    v_cndmask_b32 v15, 0, v14, vcc
    v_mfma_f32_16x16x32_bf16 v[198:201], a[220:223], a[104:107], v[198:201]
    ds_read_b64_tr_b16 a[212:213], v38 offset:49152
    v_accvgpr_write_b32 a251, v15
    v_mfma_f32_16x16x32_bf16 v[206:209], a[220:223], a[108:111], v[206:209]
    ds_read_b64_tr_b16 a[214:215], v38 offset:51200
    s_waitcnt lgkmcnt(8)
    v_mfma_f32_16x16x32_bf16 v[186:189], a[224:227], a[104:107], v[186:189]
    ds_read_b64_tr_b16 a[216:217], v35 offset:53248
    buffer_load_dwordx4 v56, s[20:23], s0 offen offset:1024 lds
    v_mfma_f32_16x16x32_bf16 v[194:197], a[224:227], a[108:111], v[194:197]
    ds_read_b64_tr_b16 a[218:219], v35 offset:55296
    v_mfma_f32_16x16x32_bf16 v[202:205], a[228:231], a[104:107], v[202:205]
    ds_read_b64_tr_b16 a[220:221], v37 offset:53248
    buffer_load_dwordx4 v57, s[20:23], s0 offen offset:2048 lds
    v_mfma_f32_16x16x32_bf16 v[210:213], a[228:231], a[108:111], v[210:213]
    ds_read_b64_tr_b16 a[222:223], v37 offset:55296
    s_waitcnt vmcnt(9) lgkmcnt(8)
    v_mfma_f32_16x16x32_bf16 v[182:185], a[200:203], a[112:115], v[182:185]
    ds_read_b64_tr_b16 a[224:225], v36 offset:53248
    v_mfma_f32_16x16x32_bf16 v[190:193], a[200:203], a[116:119], v[190:193]
    ds_read_b64_tr_b16 a[226:227], v36 offset:55296
    buffer_load_dwordx4 v58, s[20:23], s0 offen offset:3072 lds
    v_mfma_f32_16x16x32_bf16 v[198:201], a[204:207], a[112:115], v[198:201]
    ds_read_b64_tr_b16 a[228:229], v38 offset:53248
    s_add_u32 m0, s58, 32768
    v_mfma_f32_16x16x32_bf16 v[206:209], a[204:207], a[116:119], v[206:209]
    ds_read_b64_tr_b16 a[230:231], v38 offset:55296
    s_waitcnt lgkmcnt(8)
    v_mfma_f32_16x16x32_bf16 v[186:189], a[208:211], a[112:115], v[186:189]
    s_cmp_ge_u32 s14, 14
    s_cbranch_scc0 L_pollin1
L_pollok1:
    ds_read_b64_tr_b16 a[200:201], v39 offset:0
    s_add_u32 s0, s0, 458752
    v_mfma_f32_16x16x32_bf16 v[194:197], a[208:211], a[116:119], v[194:197]
    ds_read_b64_tr_b16 a[202:203], v39 offset:2048
    s_cmp_eq_u32 s0, 3670016
    s_cselect_b32 s0, 0, s0
    buffer_load_dwordx4 v55, s[20:23], s0 offen lds
    v_mfma_f32_16x16x32_bf16 v[202:205], a[212:215], a[112:115], v[202:205]
    ds_read_b64_tr_b16 a[204:205], v41 offset:0
    v_mfma_f32_16x16x32_bf16 v[210:213], a[212:215], a[116:119], v[210:213]
    ds_read_b64_tr_b16 a[206:207], v41 offset:2048
    s_waitcnt vmcnt(9) lgkmcnt(8)
    v_mfma_f32_16x16x32_bf16 v[182:185], a[216:219], a[120:123], v[182:185]
    ds_read_b64_tr_b16 a[208:209], v40 offset:0
    buffer_load_dwordx4 v56, s[20:23], s0 offen offset:1024 lds
    v_mfma_f32_16x16x32_bf16 v[190:193], a[216:219], a[124:127], v[190:193]
    ds_read_b64_tr_b16 a[210:211], v40 offset:2048
    v_mfma_f32_16x16x32_bf16 v[198:201], a[220:223], a[120:123], v[198:201]
    ds_read_b64_tr_b16 a[212:213], v42 offset:0
    buffer_load_dwordx4 v57, s[20:23], s0 offen offset:2048 lds
    v_mfma_f32_16x16x32_bf16 v[206:209], a[220:223], a[124:127], v[206:209]
    ds_read_b64_tr_b16 a[214:215], v42 offset:2048
    s_waitcnt lgkmcnt(8)
    v_mfma_f32_16x16x32_bf16 v[186:189], a[224:227], a[120:123], v[186:189]
    ds_read_b64_tr_b16 a[216:217], v39 offset:4096
    v_mfma_f32_16x16x32_bf16 v[194:197], a[224:227], a[124:127], v[194:197]
    ds_read_b64_tr_b16 a[218:219], v39 offset:6144
    v_mfma_f32_16x16x32_bf16 v[202:205], a[228:231], a[120:123], v[202:205]
    ds_read_b64_tr_b16 a[220:221], v41 offset:4096
    buffer_load_dwordx4 v58, s[20:23], s0 offen offset:3072 lds
    v_mfma_f32_16x16x32_bf16 v[210:213], a[228:231], a[124:127], v[210:213]
    ds_read_b64_tr_b16 a[222:223], v41 offset:6144
    s_waitcnt lgkmcnt(8)
    v_mfma_f32_16x16x32_bf16 v[150:153], a[200:203], a[0:3], v[150:153]
    ds_read_b64_tr_b16 a[224:225], v40 offset:4096
    s_add_u32 m0, s58, 49152
    v_mfma_f32_16x16x32_bf16 v[158:161], a[200:203], a[4:7], v[158:161]
    ds_read_b64_tr_b16 a[226:227], v40 offset:6144
    s_add_u32 s0, s0, 458752
    v_mfma_f32_16x16x32_bf16 v[166:169], a[204:207], a[0:3], 0
    ds_read_b64_tr_b16 a[228:229], v42 offset:4096
    s_cmp_eq_u32 s0, 3670016
    s_cselect_b32 s0, 0, s0
    buffer_load_dwordx4 v55, s[20:23], s0 offen lds
    v_mfma_f32_16x16x32_bf16 v[174:177], a[204:207], a[4:7], 0
    ds_read_b64_tr_b16 a[230:231], v42 offset:6144
    v_cvt_pk_bf16_f32 v182, v182, v183
    v_cvt_pk_bf16_f32 v183, v184, v185
    v_cvt_pk_bf16_f32 v184, v186, v187
    s_waitcnt lgkmcnt(8)
    v_mfma_f32_16x16x32_bf16 v[154:157], a[208:211], a[0:3], v[154:157]
    s_waitcnt vmcnt(5)
    s_barrier
    ds_read_b64_tr_b16 a[200:201], v39 offset:16384
    buffer_load_dwordx4 v56, s[20:23], s0 offen offset:1024 lds
    v_mfma_f32_16x16x32_bf16 v[162:165], a[208:211], a[4:7], v[162:165]
    ds_read_b64_tr_b16 a[202:203], v39 offset:18432
    v_cvt_pk_bf16_f32 v185, v188, v189
    buffer_store_dwordx4 v[182:185], v23, s[28:31], 0 offen offset:0 sc1
    v_cvt_pk_bf16_f32 v190, v190, v191
    v_cvt_pk_bf16_f32 v191, v192, v193
    v_cvt_pk_bf16_f32 v192, v194, v195
    v_mfma_f32_16x16x32_bf16 v[170:173], a[212:215], a[0:3], 0
    ds_read_b64_tr_b16 a[204:205], v41 offset:16384
    v_cvt_pk_bf16_f32 v193, v196, v197
    v_mfma_f32_16x16x32_bf16 v[178:181], a[212:215], a[4:7], 0
    ds_read_b64_tr_b16 a[206:207], v41 offset:18432
    buffer_store_dwordx4 v[190:193], v23, s[28:31], 0 offen offset:1024 sc1
    v_cvt_pk_bf16_f32 v198, v198, v199
    v_cvt_pk_bf16_f32 v199, v200, v201
    v_cvt_pk_bf16_f32 v200, v202, v203
    s_waitcnt lgkmcnt(8)
    v_mfma_f32_16x16x32_bf16 v[150:153], a[216:219], a[8:11], v[150:153]
    ds_read_b64_tr_b16 a[208:209], v40 offset:16384
    buffer_load_dwordx4 v57, s[20:23], s0 offen offset:2048 lds
    v_mfma_f32_16x16x32_bf16 v[158:161], a[216:219], a[12:15], v[158:161]
    ds_read_b64_tr_b16 a[210:211], v40 offset:18432
    v_cvt_pk_bf16_f32 v201, v204, v205
    buffer_store_dwordx4 v[198:201], v23, s[28:31], 0 offen offset:2048 sc1
    v_cvt_pk_bf16_f32 v206, v206, v207
    v_cvt_pk_bf16_f32 v207, v208, v209
    v_cvt_pk_bf16_f32 v208, v210, v211
    v_mfma_f32_16x16x32_bf16 v[166:169], a[220:223], a[8:11], v[166:169]
    ds_read_b64_tr_b16 a[212:213], v42 offset:16384
    v_cvt_pk_bf16_f32 v209, v212, v213
    v_mfma_f32_16x16x32_bf16 v[174:177], a[220:223], a[12:15], v[174:177]
    ds_read_b64_tr_b16 a[214:215], v42 offset:18432
    s_waitcnt lgkmcnt(8)
    v_mfma_f32_16x16x32_bf16 v[154:157], a[224:227], a[8:11], v[154:157]
    ds_read_b64_tr_b16 a[216:217], v39 offset:20480
    buffer_load_dwordx4 v58, s[20:23], s0 offen offset:3072 lds
    v_mfma_f32_16x16x32_bf16 v[162:165], a[224:227], a[12:15], v[162:165]
    ds_read_b64_tr_b16 a[218:219], v39 offset:22528
    s_add_u32 m0, s58, 65536
    buffer_store_dwordx4 v[206:209], v23, s[28:31], 0 offen offset:3072 sc1
    v_mfma_f32_16x16x32_bf16 v[170:173], a[228:231], a[8:11], v[170:173]
    ds_read_b64_tr_b16 a[220:221], v41 offset:20480
    s_add_u32 s0, s0, 458752
    v_mfma_f32_16x16x32_bf16 v[178:181], a[228:231], a[12:15], v[178:181]
    ds_read_b64_tr_b16 a[222:223], v41 offset:22528
    s_waitcnt lgkmcnt(8)
    v_mfma_f32_16x16x32_bf16 v[150:153], a[200:203], a[16:19], v[150:153]
    ds_read_b64_tr_b16 a[224:225], v40 offset:20480
    s_cmp_eq_u32 s0, 3670016
    v_mfma_f32_16x16x32_bf16 v[158:161], a[200:203], a[20:23], v[158:161]
    ds_read_b64_tr_b16 a[226:227], v40 offset:22528
    s_cselect_b32 s0, 0, s0
    buffer_load_dwordx4 v55, s[20:23], s0 offen lds
    v_mfma_f32_16x16x32_bf16 v[166:169], a[204:207], a[16:19], v[166:169]
    ds_read_b64_tr_b16 a[228:229], v42 offset:20480
    v_mfma_f32_16x16x32_bf16 v[174:177], a[204:207], a[20:23], v[174:177]
    ds_read_b64_tr_b16 a[230:231], v42 offset:22528
    s_waitcnt lgkmcnt(8)
    v_mfma_f32_16x16x32_bf16 v[154:157], a[208:211], a[16:19], v[154:157]
    ds_read_b64_tr_b16 a[200:201], v31 offset:0
    buffer_load_dwordx4 v56, s[20:23], s0 offen offset:1024 lds
    v_mfma_f32_16x16x32_bf16 v[162:165], a[208:211], a[20:23], v[162:165]
    ds_read_b64_tr_b16 a[202:203], v31 offset:2048
    v_mfma_f32_16x16x32_bf16 v[170:173], a[212:215], a[16:19], v[170:173]
    ds_read_b64_tr_b16 a[204:205], v33 offset:0
    buffer_load_dwordx4 v57, s[20:23], s0 offen offset:2048 lds
    v_mfma_f32_16x16x32_bf16 v[178:181], a[212:215], a[20:23], v[178:181]
    ds_read_b64_tr_b16 a[206:207], v33 offset:2048
    s_waitcnt lgkmcnt(8)
    v_mfma_f32_16x16x32_bf16 v[150:153], a[216:219], a[24:27], v[150:153]
    ds_read_b64_tr_b16 a[208:209], v32 offset:0
    v_mfma_f32_16x16x32_bf16 v[158:161], a[216:219], a[28:31], v[158:161]
    ds_read_b64_tr_b16 a[210:211], v32 offset:2048
    buffer_load_dwordx4 v58, s[20:23], s0 offen offset:3072 lds
    v_mfma_f32_16x16x32_bf16 v[166:169], a[220:223], a[24:27], v[166:169]
    ds_read_b64_tr_b16 a[212:213], v34 offset:0
    s_add_u32 m0, s58, 81920
    v_mfma_f32_16x16x32_bf16 v[174:177], a[220:223], a[28:31], v[174:177]
    ds_read_b64_tr_b16 a[214:215], v34 offset:2048
    s_waitcnt lgkmcnt(8)
    v_mfma_f32_16x16x32_bf16 v[154:157], a[224:227], a[24:27], v[154:157]
    ds_read_b64_tr_b16 a[216:217], v31 offset:4096
    s_add_u32 s0, s0, 458752
    v_mfma_f32_16x16x32_bf16 v[162:165], a[224:227], a[28:31], v[162:165]
    ds_read_b64_tr_b16 a[218:219], v31 offset:6144
    s_cmp_eq_u32 s0, 3670016
    v_mfma_f32_16x16x32_bf16 v[170:173], a[228:231], a[24:27], v[170:173]
    ds_read_b64_tr_b16 a[220:221], v33 offset:4096
    s_cselect_b32 s0, 0, s0
    buffer_load_dwordx4 v55, s[20:23], s0 offen lds
    v_mfma_f32_16x16x32_bf16 v[178:181], a[228:231], a[28:31], v[178:181]
    ds_read_b64_tr_b16 a[222:223], v33 offset:6144
    s_waitcnt lgkmcnt(8)
    v_mfma_f32_16x16x32_bf16 v[150:153], a[200:203], a[32:35], v[150:153]
    ds_read_b64_tr_b16 a[224:225], v32 offset:4096
    buffer_load_dwordx4 v56, s[20:23], s0 offen offset:1024 lds
    v_mfma_f32_16x16x32_bf16 v[158:161], a[200:203], a[36:39], v[158:161]
    ds_read_b64_tr_b16 a[226:227], v32 offset:6144
    v_mfma_f32_16x16x32_bf16 v[166:169], a[204:207], a[32:35], v[166:169]
    ds_read_b64_tr_b16 a[228:229], v34 offset:4096
    v_mfma_f32_16x16x32_bf16 v[174:177], a[204:207], a[36:39], v[174:177]
    ds_read_b64_tr_b16 a[230:231], v34 offset:6144
    s_waitcnt lgkmcnt(8)
    v_mfma_f32_16x16x32_bf16 v[154:157], a[208:211], a[32:35], v[154:157]
    s_waitcnt vmcnt(7)
    s_barrier
    s_waitcnt vmcnt(6)
    s_atomic_add s36, s[28:29], s37
    ds_read_b64_tr_b16 a[200:201], v31 offset:16384
    buffer_load_dwordx4 v57, s[20:23], s0 offen offset:2048 lds
    v_mfma_f32_16x16x32_bf16 v[162:165], a[208:211], a[36:39], v[162:165]
    ds_read_b64_tr_b16 a[202:203], v31 offset:18432
    v_mfma_f32_16x16x32_bf16 v[170:173], a[212:215], a[32:35], v[170:173]
    ds_read_b64_tr_b16 a[204:205], v33 offset:16384
    buffer_load_dwordx4 v58, s[20:23], s0 offen offset:3072 lds
    v_mfma_f32_16x16x32_bf16 v[178:181], a[212:215], a[36:39], v[178:181]
    ds_read_b64_tr_b16 a[206:207], v33 offset:18432
    s_waitcnt lgkmcnt(8)
    v_mfma_f32_16x16x32_bf16 v[150:153], a[216:219], a[40:43], v[150:153]
    ds_read_b64_tr_b16 a[208:209], v32 offset:16384
    s_add_u32 m0, s59, 98304
    v_mfma_f32_16x16x32_bf16 v[158:161], a[216:219], a[44:47], v[158:161]
    ds_read_b64_tr_b16 a[210:211], v32 offset:18432
    buffer_load_dwordx4 v80, s[28:31], s63 offen sc1 lds
    v_mfma_f32_16x16x32_bf16 v[166:169], a[220:223], a[40:43], v[166:169]
    ds_read_b64_tr_b16 a[212:213], v34 offset:16384
    v_mfma_f32_16x16x32_bf16 v[174:177], a[220:223], a[44:47], v[174:177]
    ds_read_b64_tr_b16 a[214:215], v34 offset:18432
    s_waitcnt lgkmcnt(8)
    v_mfma_f32_16x16x32_bf16 v[154:157], a[224:227], a[40:43], v[154:157]
    ds_read_b64_tr_b16 a[216:217], v31 offset:20480
    v_mfma_f32_16x16x32_bf16 v[162:165], a[224:227], a[44:47], v[162:165]
    ds_read_b64_tr_b16 a[218:219], v31 offset:22528
    buffer_load_dwordx4 v80, s[28:31], s63 offen offset:1024 sc1 lds
    v_mfma_f32_16x16x32_bf16 v[170:173], a[228:231], a[40:43], v[170:173]
    ds_read_b64_tr_b16 a[220:221], v33 offset:20480
    v_mfma_f32_16x16x32_bf16 v[178:181], a[228:231], a[44:47], v[178:181]
    ds_read_b64_tr_b16 a[222:223], v33 offset:22528
    s_waitcnt lgkmcnt(8)
    v_mfma_f32_16x16x32_bf16 v[150:153], a[200:203], a[48:51], v[150:153]
    ds_read_b64_tr_b16 a[224:225], v32 offset:20480
    buffer_load_dwordx4 v80, s[28:31], s63 offen offset:2048 sc1 lds
    v_mfma_f32_16x16x32_bf16 v[158:161], a[200:203], a[52:55], v[158:161]
    ds_read_b64_tr_b16 a[226:227], v32 offset:22528
    s_add_u32 m0, s100, 126976
    v_mfma_f32_16x16x32_bf16 v[166:169], a[204:207], a[48:51], v[166:169]
    ds_read_b64_tr_b16 a[228:229], v34 offset:20480
    v_mfma_f32_16x16x32_bf16 v[174:177], a[204:207], a[52:55], v[174:177]
    ds_read_b64_tr_b16 a[230:231], v34 offset:22528
    s_waitcnt lgkmcnt(8)
    v_mfma_f32_16x16x32_bf16 v[154:157], a[208:211], a[48:51], v[154:157]
    ds_read_b64_tr_b16 a[200:201], v31 offset:32768
    buffer_load_dwordx4 v69, s[28:31], s62 offen sc1 lds
    v_mfma_f32_16x16x32_bf16 v[162:165], a[208:211], a[52:55], v[162:165]
    ds_read_b64_tr_b16 a[202:203], v31 offset:34816
    s_add_u32 m0, s58, 110592
    v_mfma_f32_16x16x32_bf16 v[170:173], a[212:215], a[48:51], v[170:173]
    ds_read_b64_tr_b16 a[204:205], v33 offset:32768
    v_mfma_f32_16x16x32_bf16 v[178:181], a[212:215], a[52:55], v[178:181]
    ds_read_b64_tr_b16 a[206:207], v33 offset:34816
    s_waitcnt lgkmcnt(8)
    v_mfma_f32_16x16x32_bf16 v[150:153], a[216:219], a[56:59], v[150:153]
    ds_read_b64_tr_b16 a[208:209], v32 offset:32768
    buffer_load_dwordx4 v67, s[28:31], s62 offen sc1 lds
    v_mfma_f32_16x16x32_bf16 v[158:161], a[216:219], a[60:63], v[158:161]
    ds_read_b64_tr_b16 a[210:211], v32 offset:34816
    v_mfma_f32_16x16x32_bf16 v[166:169], a[220:223], a[56:59], v[166:169]
    ds_read_b64_tr_b16 a[212:213], v34 offset:32768
    v_mfma_f32_16x16x32_bf16 v[174:177], a[220:223], a[60:63], v[174:177]
    ds_read_b64_tr_b16 a[214:215], v34 offset:34816
    s_waitcnt lgkmcnt(8)
    v_mfma_f32_16x16x32_bf16 v[154:157], a[224:227], a[56:59], v[154:157]
    ds_read_b64_tr_b16 a[216:217], v31 offset:36864
    buffer_load_dwordx4 v67, s[28:31], s62 offen offset:1024 sc1 lds
    v_mfma_f32_16x16x32_bf16 v[162:165], a[224:227], a[60:63], v[162:165]
    ds_read_b64_tr_b16 a[218:219], v31 offset:38912
    v_mfma_f32_16x16x32_bf16 v[170:173], a[228:231], a[56:59], v[170:173]
    ds_read_b64_tr_b16 a[220:221], v33 offset:36864
    buffer_load_dwordx4 v68, s[28:31], s62 offen offset:2048 sc1 lds
    v_mfma_f32_16x16x32_bf16 v[178:181], a[228:231], a[60:63], v[178:181]
    ds_read_b64_tr_b16 a[222:223], v33 offset:38912
    s_waitcnt lgkmcnt(8)
    v_mfma_f32_16x16x32_bf16 v[150:153], a[200:203], a[64:67], v[150:153]
    ds_read_b64_tr_b16 a[224:225], v32 offset:36864
    v_mfma_f32_16x16x32_bf16 v[158:161], a[200:203], a[68:71], v[158:161]
    ds_read_b64_tr_b16 a[226:227], v32 offset:38912
    v_mfma_f32_16x16x32_bf16 v[166:169], a[204:207], a[64:67], v[166:169]
    ds_read_b64_tr_b16 a[228:229], v34 offset:36864
    buffer_load_dwordx4 v68, s[28:31], s62 offen offset:3072 sc1 lds
    v_mfma_f32_16x16x32_bf16 v[174:177], a[204:207], a[68:71], v[174:177]
    ds_read_b64_tr_b16 a[230:231], v34 offset:38912
    s_waitcnt lgkmcnt(8)
    v_mfma_f32_16x16x32_bf16 v[154:157], a[208:211], a[64:67], v[154:157]
    s_waitcnt vmcnt(8)
    s_barrier
    s_xor_b32 s37, s37, 1024
    s_mov_b32 s14, 0
    s_load_dword s14, s[28:29], s37
    ds_read_b64_tr_b16 a[200:201], v31 offset:49152
    s_add_u32 m0, s59, 131072
    v_mfma_f32_16x16x32_bf16 v[162:165], a[208:211], a[68:71], v[162:165]
    ds_read_b64_tr_b16 a[202:203], v31 offset:51200
    s_add_u32 s63, s63, 12288
    v_mfma_f32_16x16x32_bf16 v[170:173], a[212:215], a[64:67], v[170:173]
    ds_read_b64_tr_b16 a[204:205], v33 offset:49152
    s_cmp_eq_u32 s63, 86016
    s_cselect_b32 s63, 0, s63
    buffer_load_dwordx4 v80, s[28:31], s63 offen sc1 lds
    v_mfma_f32_16x16x32_bf16 v[178:181], a[212:215], a[68:71], v[178:181]
    ds_read_b64_tr_b16 a[206:207], v33 offset:51200
    s_waitcnt lgkmcnt(8)
    v_mfma_f32_16x16x32_bf16 v[150:153], a[216:219], a[72:75], v[150:153]
    ds_read_b64_tr_b16 a[208:209], v32 offset:49152
    buffer_load_dwordx4 v80, s[28:31], s63 offen offset:1024 sc1 lds
    v_mfma_f32_16x16x32_bf16 v[158:161], a[216:219], a[76:79], v[158:161]
    ds_read_b64_tr_b16 a[210:211], v32 offset:51200
    v_mfma_f32_16x16x32_bf16 v[166:169], a[220:223], a[72:75], v[166:169]
    ds_read_b64_tr_b16 a[212:213], v34 offset:49152
    v_mfma_f32_16x16x32_bf16 v[174:177], a[220:223], a[76:79], v[174:177]
    ds_read_b64_tr_b16 a[214:215], v34 offset:51200
    s_waitcnt lgkmcnt(8)
    v_mfma_f32_16x16x32_bf16 v[154:157], a[224:227], a[72:75], v[154:157]
    ds_read_b64_tr_b16 a[216:217], v31 offset:53248
    buffer_load_dwordx4 v80, s[28:31], s63 offen offset:2048 sc1 lds
    v_mfma_f32_16x16x32_bf16 v[162:165], a[224:227], a[76:79], v[162:165]
    ds_read_b64_tr_b16 a[218:219], v31 offset:55296
    s_add_u32 m0, s100, 159744
    v_mfma_f32_16x16x32_bf16 v[170:173], a[228:231], a[72:75], v[170:173]
    ds_read_b64_tr_b16 a[220:221], v33 offset:53248
    s_add_u32 s62, s62, 262144
    v_mfma_f32_16x16x32_bf16 v[178:181], a[228:231], a[76:79], v[178:181]
    ds_read_b64_tr_b16 a[222:223], v33 offset:55296
    s_waitcnt lgkmcnt(8)
    v_mfma_f32_16x16x32_bf16 v[150:153], a[200:203], a[80:83], v[150:153]
    ds_read_b64_tr_b16 a[224:225], v32 offset:53248
    s_cmp_eq_u32 s62, 1835008
    v_mfma_f32_16x16x32_bf16 v[158:161], a[200:203], a[84:87], v[158:161]
    ds_read_b64_tr_b16 a[226:227], v32 offset:55296
    s_cselect_b32 s62, 0, s62
    buffer_load_dwordx4 v69, s[28:31], s62 offen sc1 lds
    v_mfma_f32_16x16x32_bf16 v[166:169], a[204:207], a[80:83], v[166:169]
    ds_read_b64_tr_b16 a[228:229], v34 offset:53248
    s_add_u32 m0, s58, 143360
    v_mfma_f32_16x16x32_bf16 v[174:177], a[204:207], a[84:87], v[174:177]
    ds_read_b64_tr_b16 a[230:231], v34 offset:55296
    s_waitcnt lgkmcnt(8)
    v_mfma_f32_16x16x32_bf16 v[154:157], a[208:211], a[80:83], v[154:157]
    s_barrier
    ds_read_b64_tr_b16 a[200:201], v37 offset:0
    buffer_load_dwordx4 v67, s[28:31], s62 offen sc1 lds
    v_mfma_f32_16x16x32_bf16 v[162:165], a[208:211], a[84:87], v[162:165]
    ds_read_b64_tr_b16 a[202:203], v37 offset:2048
    v_mfma_f32_16x16x32_bf16 v[170:173], a[212:215], a[80:83], v[170:173]
    ds_read_b64_tr_b16 a[204:205], v38 offset:0
    buffer_load_dwordx4 v67, s[28:31], s62 offen offset:1024 sc1 lds
    v_mfma_f32_16x16x32_bf16 v[178:181], a[212:215], a[84:87], v[178:181]
    ds_read_b64_tr_b16 a[206:207], v38 offset:2048
    s_waitcnt lgkmcnt(8)
    v_mfma_f32_16x16x32_bf16 v[150:153], a[216:219], a[88:91], v[150:153]
    ds_read_b64_tr_b16 a[208:209], v37 offset:4096
    v_mfma_f32_16x16x32_bf16 v[158:161], a[216:219], a[92:95], v[158:161]
    ds_read_b64_tr_b16 a[210:211], v37 offset:6144
    v_mfma_f32_16x16x32_bf16 v[166:169], a[220:223], a[88:91], v[166:169]
    ds_read_b64_tr_b16 a[212:213], v38 offset:4096
    buffer_load_dwordx4 v68, s[28:31], s62 offen offset:2048 sc1 lds
    v_mfma_f32_16x16x32_bf16 v[174:177], a[220:223], a[92:95], v[174:177]
    ds_read_b64_tr_b16 a[214:215], v38 offset:6144
    s_waitcnt lgkmcnt(8)
    v_mfma_f32_16x16x32_bf16 v[154:157], a[224:227], a[88:91], v[154:157]
    ds_read_b64_tr_b16 a[216:217], v37 offset:16384
    v_mfma_f32_16x16x32_bf16 v[162:165], a[224:227], a[92:95], v[162:165]
    ds_read_b64_tr_b16 a[218:219], v37 offset:18432
    buffer_load_dwordx4 v68, s[28:31], s62 offen offset:3072 sc1 lds
    v_mfma_f32_16x16x32_bf16 v[170:173], a[228:231], a[88:91], v[170:173]
    ds_read_b64_tr_b16 a[220:221], v38 offset:16384
    s_add_u32 m0, s59, 0
    v_mfma_f32_16x16x32_bf16 v[178:181], a[228:231], a[92:95], v[178:181]
    ds_read_b64_tr_b16 a[222:223], v38 offset:18432
    s_waitcnt lgkmcnt(8)
    v_mfma_f32_16x16x32_bf16 v[166:169], a[200:203], a[96:99], v[166:169]
    s_cmp_ge_u32 s14, 2
    s_cbranch_scc0 L_pollin2
L_pollok2:
    v_xor_b32 v23, 131072, v23
    v_xor_b32 v22, 8192, v23
    ds_read_b64_tr_b16 a[224:225], v37 offset:20480
    buffer_load_dwordx4 v[214:217], v23, s[28:31], 0 offen offset:0 sc1
    v_mfma_f32_16x16x32_bf16 v[174:177], a[200:203], a[100:103], v[174:177]
    ds_read_b64_tr_b16 a[226:227], v37 offset:22528
    v_mfma_f32_16x16x32_bf16 v[170:173], a[204:207], a[96:99], v[170:173]
    ds_read_b64_tr_b16 a[228:229], v38 offset:20480
    buffer_load_dwordx4 v[218:221], v23, s[28:31], 0 offen offset:1024 sc1
    v_mfma_f32_16x16x32_bf16 v[178:181], a[204:207], a[100:103], v[178:181]
    ds_read_b64_tr_b16 a[230:231], v38 offset:22528
    s_waitcnt lgkmcnt(8)
    v_mfma_f32_16x16x32_bf16 v[166:169], a[208:211], a[104:107], v[166:169]
    ds_read_b64_tr_b16 a[200:201], v35 offset:0
    buffer_load_dwordx4 v[222:225], v22, s[28:31], 0 offen offset:2048 sc1
    v_mfma_f32_16x16x32_bf16 v[174:177], a[208:211], a[108:111], v[174:177]
    ds_read_b64_tr_b16 a[202:203], v35 offset:2048
    v_mfma_f32_16x16x32_bf16 v[170:173], a[212:215], a[104:107], v[170:173]
    ds_read_b64_tr_b16 a[204:205], v36 offset:0
    buffer_load_dwordx4 v[226:229], v22, s[28:31], 0 offen offset:3072 sc1
    v_mfma_f32_16x16x32_bf16 v[178:181], a[212:215], a[108:111], v[178:181]
    ds_read_b64_tr_b16 a[206:207], v36 offset:2048
    s_waitcnt lgkmcnt(8)
    v_mfma_f32_16x16x32_bf16 v[166:169], a[216:219], a[112:115], v[166:169]
    ds_read_b64_tr_b16 a[208:209], v35 offset:4096
    s_add_u32 s63, s63, 12288
    v_mfma_f32_16x16x32_bf16 v[174:177], a[216:219], a[116:119], v[174:177]
    ds_read_b64_tr_b16 a[210:211], v35 offset:6144
    s_cmp_eq_u32 s63, 86016
    s_cselect_b32 s63, 0, s63
    buffer_load_dwordx4 v80, s[28:31], s63 offen sc1 lds
    v_mfma_f32_16x16x32_bf16 v[170:173], a[220:223], a[112:115], v[170:173]
    ds_read_b64_tr_b16 a[212:213], v36 offset:4096
    v_mfma_f32_16x16x32_bf16 v[178:181], a[220:223], a[116:119], v[178:181]
    ds_read_b64_tr_b16 a[214:215], v36 offset:6144
    s_waitcnt lgkmcnt(8)
    v_mfma_f32_16x16x32_bf16 v[166:169], a[224:227], a[120:123], v[166:169]
    ds_read_b64_tr_b16 a[216:217], v35 offset:16384
    buffer_load_dwordx4 v80, s[28:31], s63 offen offset:1024 sc1 lds
    v_mfma_f32_16x16x32_bf16 v[174:177], a[224:227], a[124:127], v[174:177]
    ds_read_b64_tr_b16 a[218:219], v35 offset:18432
    v_mfma_f32_16x16x32_bf16 v[170:173], a[228:231], a[120:123], v[170:173]
    ds_read_b64_tr_b16 a[220:221], v36 offset:16384
    v_mfma_f32_16x16x32_bf16 v[178:181], a[228:231], a[124:127], v[178:181]
    ds_read_b64_tr_b16 a[222:223], v36 offset:18432
    s_waitcnt lgkmcnt(8)
    v_mfma_f32_16x16x32_bf16 v[150:153], a[200:203], a[96:99], v[150:153]
    ds_read_b64_tr_b16 a[224:225], v35 offset:20480
    buffer_load_dwordx4 v80, s[28:31], s63 offen offset:2048 sc1 lds
    v_mfma_f32_16x16x32_bf16 v[158:161], a[200:203], a[100:103], v[158:161]
    ds_read_b64_tr_b16 a[226:227], v35 offset:22528
    s_add_u32 m0, s100, 28672
    v_mfma_f32_16x16x32_bf16 v[154:157], a[204:207], a[96:99], v[154:157]
    ds_read_b64_tr_b16 a[228:229], v36 offset:20480
    s_add_u32 s62, s62, 262144
    v_mfma_f32_16x16x32_bf16 v[162:165], a[204:207], a[100:103], v[162:165]
    ds_read_b64_tr_b16 a[230:231], v36 offset:22528
    v_cvt_pk_bf16_f32 v166, v166, v167
    v_cvt_pk_bf16_f32 v167, v168, v169
    s_waitcnt lgkmcnt(8)
    v_mfma_f32_16x16x32_bf16 v[150:153], a[208:211], a[104:107], v[150:153]
    s_cmp_eq_u32 s62, 1835008
    s_cselect_b32 s62, 0, s62
    buffer_load_dwordx4 v69, s[28:31], s62 offen sc1 lds
    v_mfma_f32_16x16x32_bf16 v[158:161], a[208:211], a[108:111], v[158:161]
    s_add_u32 m0, s58, 12288
    v_cvt_pk_bf16_f32 v168, v170, v171
    v_cvt_pk_bf16_f32 v169, v172, v173
    ds_write_b128 v81, v[166:169] offset:32768
    v_mfma_f32_16x16x32_bf16 v[154:157], a[212:215], a[104:107], v[154:157]
    buffer_load_dwordx4 v67, s[28:31], s62 offen sc1 lds
    v_cvt_pk_bf16_f32 v174, v174, v175
    v_mfma_f32_16x16x32_bf16 v[162:165], a[212:215], a[108:111], v[162:165]
    v_cvt_pk_bf16_f32 v175, v176, v177
    s_waitcnt lgkmcnt(5)
    v_mfma_f32_16x16x32_bf16 v[150:153], a[216:219], a[112:115], v[150:153]
    v_cvt_pk_bf16_f32 v176, v178, v179
    v_cvt_pk_bf16_f32 v177, v180, v181
    v_mfma_f32_16x16x32_bf16 v[158:161], a[216:219], a[116:119], v[158:161]
    buffer_load_dwordx4 v67, s[28:31], s62 offen offset:1024 sc1 lds
    ds_write_b128 v81, v[174:177] offset:33792
    v_mfma_f32_16x16x32_bf16 v[154:157], a[220:223], a[112:115], v[154:157]
    v_mfma_f32_16x16x32_bf16 v[162:165], a[220:223], a[116:119], v[162:165]
    s_waitcnt lgkmcnt(2)
    v_mfma_f32_16x16x32_bf16 v[150:153], a[224:227], a[120:123], v[150:153]
    buffer_load_dwordx4 v68, s[28:31], s62 offen offset:2048 sc1 lds
    v_mfma_f32_16x16x32_bf16 v[158:161], a[224:227], a[124:127], v[158:161]
    v_mfma_f32_16x16x32_bf16 v[154:157], a[228:231], a[120:123], v[154:157]
    v_xor_b32 v81, 8192, v81
    s_waitcnt vmcnt(19) lgkmcnt(0)
    s_barrier
    ds_read_b128 v[182:185], v81 offset:32768
    ds_read_b128 v[186:189], v81 offset:33792
    v_mfma_f32_16x16x32_bf16 v[162:165], a[228:231], a[124:127], v[162:165]
    buffer_load_dwordx4 v68, s[28:31], s62 offen offset:3072 sc1 lds
    s_waitcnt vmcnt(11)
    v_mfma_f32_16x16x32_bf16 v[150:153], a[250:253], v[214:217], v[150:153]
    s_add_u32 m0, s59, 65536
L_pad1:
    s_cbranch_execz L_warm
    s_add_u32 s63, s63, 12288
    v_mfma_f32_16x16x32_bf16 v[154:157], a[248:251], v[214:217], v[154:157]
    s_cmp_eq_u32 s63, 86016
    s_cselect_b32 s63, 0, s63
    s_waitcnt vmcnt(10)
    v_mfma_f32_16x16x32_bf16 v[158:161], a[250:253], v[218:221], v[158:161]
    buffer_load_dwordx4 v80, s[28:31], s63 offen sc1 lds
    v_mfma_f32_16x16x32_bf16 v[162:165], a[248:251], v[218:221], v[162:165]
    s_waitcnt vmcnt(10)
    v_mfma_f32_16x16x32_bf16 v[150:153], a[250:253], v[222:225], v[150:153]
    v_mfma_f32_16x16x32_bf16 v[154:157], a[248:251], v[222:225], v[154:157]
    s_waitcnt vmcnt(9)
    v_mfma_f32_16x16x32_bf16 v[158:161], a[250:253], v[226:229], v[158:161]
    buffer_load_dwordx4 v80, s[28:31], s63 offen offset:1024 sc1 lds
    v_mfma_f32_16x16x32_bf16 v[162:165], a[248:251], v[226:229], v[162:165]
    s_waitcnt lgkmcnt(1)
    v_mfma_f32_16x16x32_bf16 v[150:153], a[250:253], v[182:185], v[150:153]
    v_mfma_f32_16x16x32_bf16 v[154:157], a[248:251], v[182:185], v[154:157]
    buffer_load_dwordx4 v80, s[28:31], s63 offen offset:2048 sc1 lds
    s_add_u32 m0, s100, 94208
    s_waitcnt lgkmcnt(0)
    v_mfma_f32_16x16x32_bf16 v[158:161], a[250:253], v[186:189], v[158:161]
    s_add_u32 s62, s62, 262144
    s_cmp_eq_u32 s62, 1835008
    v_mfma_f32_16x16x32_bf16 v[162:165], a[248:251], v[186:189], v[162:165]
    s_cselect_b32 s62, 0, s62
    v_pk_mul_f32 v[182:183], v[150:151], v[150:151]
    v_pk_mul_f32 v[184:185], v[152:153], v[152:153]
    v_pk_mul_f32 v[186:187], v[154:155], v[154:155]
    v_pk_mul_f32 v[188:189], v[156:157], v[156:157]
    v_pk_fma_f32 v[182:183], v[182:183], s[78:79], v[108:109]
    buffer_load_dwordx4 v69, s[28:31], s62 offen sc1 lds
    v_pk_fma_f32 v[184:185], v[184:185], s[78:79], v[108:109]
    v_pk_fma_f32 v[186:187], v[186:187], s[78:79], v[108:109]
    v_pk_fma_f32 v[188:189], v[188:189], s[78:79], v[108:109]
    v_pk_mul_f32 v[182:183], v[182:183], v[150:151]
    v_pk_mul_f32 v[184:185], v[184:185], v[152:153]
    v_pk_mul_f32 v[186:187], v[186:187], v[154:155]
    v_pk_mul_f32 v[188:189], v[188:189], v[156:157]
    v_exp_f32 v182, v182
    v_exp_f32 v183, v183
    v_exp_f32 v184, v184
    v_exp_f32 v185, v185
    s_add_u32 m0, s58, 77824
    s_nop 0
    buffer_load_dwordx4 v67, s[28:31], s62 offen sc1 lds
    v_exp_f32 v186, v186
    v_exp_f32 v187, v187
    v_exp_f32 v188, v188
    v_exp_f32 v189, v189
    v_pk_add_f32 v[182:183], v[182:183], s[80:81]
    v_pk_add_f32 v[184:185], v[184:185], s[80:81]
    v_pk_add_f32 v[186:187], v[186:187], s[80:81]
    v_pk_add_f32 v[188:189], v[188:189], s[80:81]
    v_rcp_f32 v182, v182
    buffer_load_dwordx4 v67, s[28:31], s62 offen offset:1024 sc1 lds
    v_rcp_f32 v183, v183
    v_rcp_f32 v184, v184
    v_rcp_f32 v185, v185
    v_rcp_f32 v186, v186
    v_rcp_f32 v187, v187
    v_rcp_f32 v188, v188
    v_rcp_f32 v189, v189
    buffer_load_dwordx4 v68, s[28:31], s62 offen offset:2048 sc1 lds
    v_pk_mul_f32 v[182:183], v[182:183], v[150:151]
    v_pk_mul_f32 v[184:185], v[184:185], v[152:153]
    v_pk_mul_f32 v[186:187], v[186:187], v[154:155]
    v_pk_mul_f32 v[188:189], v[188:189], v[156:157]
    v_cvt_pk_bf16_f32 v110, v182, v183
    v_cvt_pk_bf16_f32 v111, v184, v185
    v_cvt_pk_bf16_f32 v112, v186, v187
    v_cvt_pk_bf16_f32 v113, v188, v189
    v_pk_mul_f32 v[190:191], v[158:159], v[158:159]
    v_pk_mul_f32 v[192:193], v[160:161], v[160:161]
    v_pk_mul_f32 v[194:195], v[162:163], v[162:163]
    v_pk_mul_f32 v[196:197], v[164:165], v[164:165]
    v_pk_fma_f32 v[190:191], v[190:191], s[78:79], v[108:109]
    buffer_load_dwordx4 v68, s[28:31], s62 offen offset:3072 sc1 lds
    v_pk_fma_f32 v[192:193], v[192:193], s[78:79], v[108:109]
    v_pk_fma_f32 v[194:195], v[194:195], s[78:79], v[108:109]
    v_pk_fma_f32 v[196:197], v[196:197], s[78:79], v[108:109]
    v_pk_mul_f32 v[190:191], v[190:191], v[158:159]
    v_pk_mul_f32 v[192:193], v[192:193], v[160:161]
    v_pk_mul_f32 v[194:195], v[194:195], v[162:163]
    v_pk_mul_f32 v[196:197], v[196:197], v[164:165]
    v_exp_f32 v190, v190
    v_exp_f32 v191, v191
    v_exp_f32 v192, v192
    v_exp_f32 v193, v193
    v_exp_f32 v194, v194
    v_exp_f32 v195, v195
    v_exp_f32 v196, v196
    v_exp_f32 v197, v197
    v_pk_add_f32 v[190:191], v[190:191], s[80:81]
    v_pk_add_f32 v[192:193], v[192:193], s[80:81]
    v_pk_add_f32 v[194:195], v[194:195], s[80:81]
    v_pk_add_f32 v[196:197], v[196:197], s[80:81]
    v_rcp_f32 v190, v190
    v_rcp_f32 v191, v191
    v_rcp_f32 v192, v192
    v_rcp_f32 v193, v193
    v_rcp_f32 v194, v194
    v_rcp_f32 v195, v195
    v_rcp_f32 v196, v196
    v_rcp_f32 v197, v197
    v_pk_mul_f32 v[190:191], v[190:191], v[158:159]
    v_pk_mul_f32 v[192:193], v[192:193], v[160:161]
    v_pk_mul_f32 v[194:195], v[194:195], v[162:163]
    v_pk_mul_f32 v[196:197], v[196:197], v[164:165]
    v_cvt_pk_bf16_f32 v114, v190, v191
    v_cvt_pk_bf16_f32 v115, v192, v193
    v_cvt_pk_bf16_f32 v116, v194, v195
    v_cvt_pk_bf16_f32 v117, v196, v197
    ds_read_b64_tr_b16 a[180:181], v72 offset:32768
    ds_read_b64_tr_b16 a[182:183], v72 offset:33024
    ds_read_b128 a[128:131], v53 offset:32768
    ds_read_b64_tr_b16 a[184:185], v72 offset:33792
    ds_read_b64_tr_b16 a[186:187], v72 offset:34048
    ds_read_b128 a[132:135], v53 offset:33792
    ds_read_b128 a[136:139], v53 offset:34816
    ds_read_b64_tr_b16 a[176:177], v73 offset:32768
    ds_read_b64_tr_b16 a[178:179], v73 offset:33024
    ds_read_b128 a[140:143], v53 offset:35840
    ds_read_b128 a[144:147], v53 offset:36864
    ds_read_b128 a[148:151], v53 offset:37888
    buffer_store_dwordx4 v[110:113], v4, s[28:31], s67 offen offset:0 sc1
    buffer_store_dwordx4 v[114:117], v4, s[28:31], s67 offen offset:1024 sc1
L_q:
    s_waitcnt lgkmcnt(6)
    v_mfma_f32_16x16x32_bf16 v[182:185], a[128:131], a[180:183], 0
    ds_read_b64_tr_b16 a[192:193], v72 offset:34816
    v_mfma_f32_16x16x32_bf16 v[190:193], a[128:131], a[184:187], 0
    ds_read_b64_tr_b16 a[194:195], v72 offset:35072
    v_mfma_f32_16x16x32_bf16 v[186:189], a[132:135], a[180:183], 0
    ds_read_b128 a[152:155], v53 offset:38912
    v_mfma_f32_16x16x32_bf16 v[194:197], a[132:135], a[184:187], 0
    ds_read_b64_tr_b16 a[196:197], v72 offset:35840
    s_waitcnt lgkmcnt(4)
    v_mfma_f32_16x16x32_bf16 v[206:209], a[136:139], a[180:183], 0
    ds_read_b64_tr_b16 a[198:199], v72 offset:36096
    v_mfma_f32_16x16x32_bf16 v[214:217], a[136:139], a[184:187], 0
    ds_read_b128 a[156:159], v53 offset:39936
    v_mfma_f32_16x16x32_bf16 v[198:201], a[136:139], a[176:179], 0
    ds_read_b128 a[160:163], v53 offset:40960
    v_mfma_f32_16x16x32_bf16 v[210:213], a[140:143], a[180:183], 0
    ds_read_b64_tr_b16 a[188:189], v73 offset:34816
    v_mfma_f32_16x16x32_bf16 v[218:221], a[140:143], a[184:187], 0
    ds_read_b64_tr_b16 a[190:191], v73 offset:35072
    v_mfma_f32_16x16x32_bf16 v[202:205], a[140:143], a[176:179], 0
    ds_read_b128 a[164:167], v53 offset:41984
    v_mfma_f32_16x16x32_bf16 v[230:233], a[180:183], a[144:147], 0
    ds_read_b128 a[168:171], v53 offset:43008
    v_mfma_f32_16x16x32_bf16 v[238:241], a[184:187], a[144:147], 0
    ds_read_b128 a[172:175], v53 offset:44032
    v_mfma_f32_16x16x32_bf16 v[222:225], a[176:179], a[144:147], 0
    v_mfma_f32_16x16x32_bf16 v[234:237], a[180:183], a[148:151], 0
    v_mfma_f32_16x16x32_bf16 v[242:245], a[184:187], a[148:151], 0
    v_mfma_f32_16x16x32_bf16 v[226:229], a[176:179], a[148:151], 0
    s_waitcnt lgkmcnt(0)
    s_barrier
    v_mfma_f32_16x16x32_bf16 v[182:185], a[152:155], a[192:195], v[182:185]
    ds_read_b64_tr_b16 a[180:181], v74 offset:0
    s_add_u32 m0, s59, 32768
    v_mfma_f32_16x16x32_bf16 v[190:193], a[152:155], a[196:199], v[190:193]
    ds_read_b64_tr_b16 a[182:183], v74 offset:256
    s_add_u32 s63, s63, 12288
    v_mfma_f32_16x16x32_bf16 v[186:189], a[156:159], a[192:195], v[186:189]
    ds_read_b128 a[128:131], v54 offset:0
    s_cmp_eq_u32 s63, 86016
    v_mfma_f32_16x16x32_bf16 v[194:197], a[156:159], a[196:199], v[194:197]
    ds_read_b64_tr_b16 a[184:185], v74 offset:1024
    v_mfma_f32_16x16x32_bf16 v[206:209], a[160:163], a[192:195], v[206:209]
    ds_read_b64_tr_b16 a[186:187], v74 offset:1280
    s_cselect_b32 s63, 0, s63
    v_mfma_f32_16x16x32_bf16 v[214:217], a[160:163], a[196:199], v[214:217]
    ds_read_b128 a[132:135], v54 offset:1024
    buffer_load_dwordx4 v80, s[28:31], s63 offen sc1 lds
    v_mfma_f32_16x16x32_bf16 v[198:201], a[160:163], a[188:191], v[198:201]
    ds_read_b128 a[136:139], v54 offset:2048
    v_mfma_f32_16x16x32_bf16 v[210:213], a[164:167], a[192:195], v[210:213]
    ds_read_b64_tr_b16 a[176:177], v75 offset:0
    buffer_load_dwordx4 v80, s[28:31], s63 offen offset:1024 sc1 lds
    v_mfma_f32_16x16x32_bf16 v[218:221], a[164:167], a[196:199], v[218:221]
    ds_read_b64_tr_b16 a[178:179], v75 offset:256
    v_mfma_f32_16x16x32_bf16 v[202:205], a[164:167], a[188:191], v[202:205]
    ds_read_b128 a[140:143], v54 offset:3072
    v_mfma_f32_16x16x32_bf16 v[230:233], a[192:195], a[168:171], v[230:233]
    ds_read_b128 a[144:147], v54 offset:4096
    buffer_load_dwordx4 v80, s[28:31], s63 offen offset:2048 sc1 lds
    v_mfma_f32_16x16x32_bf16 v[238:241], a[196:199], a[168:171], v[238:241]
    ds_read_b128 a[148:151], v54 offset:5120
    s_add_u32 m0, s100, 61440
    v_mfma_f32_16x16x32_bf16 v[222:225], a[188:191], a[168:171], v[222:225]
    s_add_u32 s62, s62, 262144
    s_cmp_eq_u32 s62, 1835008
    v_mfma_f32_16x16x32_bf16 v[234:237], a[192:195], a[172:175], v[234:237]
    s_cselect_b32 s62, 0, s62
    buffer_load_dwordx4 v69, s[28:31], s62 offen sc1 lds
    v_mfma_f32_16x16x32_bf16 v[242:245], a[196:199], a[172:175], v[242:245]
    s_add_u32 m0, s58, 45056
    v_mfma_f32_16x16x32_bf16 v[226:229], a[188:191], a[172:175], v[226:229]
    s_waitcnt lgkmcnt(6)
    v_mfma_f32_16x16x32_bf16 v[182:185], a[128:131], a[180:183], v[182:185]
    ds_read_b64_tr_b16 a[192:193], v74 offset:2048
    buffer_load_dwordx4 v67, s[28:31], s62 offen sc1 lds
    v_mfma_f32_16x16x32_bf16 v[190:193], a[128:131], a[184:187], v[190:193]
    ds_read_b64_tr_b16 a[194:195], v74 offset:2304
    v_mfma_f32_16x16x32_bf16 v[186:189], a[132:135], a[180:183], v[186:189]
    ds_read_b128 a[152:155], v54 offset:6144
    v_mfma_f32_16x16x32_bf16 v[194:197], a[132:135], a[184:187], v[194:197]
    ds_read_b64_tr_b16 a[196:197], v74 offset:3072
    s_waitcnt lgkmcnt(4)
    v_mfma_f32_16x16x32_bf16 v[206:209], a[136:139], a[180:183], v[206:209]
    ds_read_b64_tr_b16 a[198:199], v74 offset:3328
    buffer_load_dwordx4 v67, s[28:31], s62 offen offset:1024 sc1 lds
    v_mfma_f32_16x16x32_bf16 v[214:217], a[136:139], a[184:187], v[214:217]
    ds_read_b128 a[156:159], v54 offset:7168
    v_mfma_f32_16x16x32_bf16 v[198:201], a[136:139], a[176:179], v[198:201]
    ds_read_b128 a[160:163], v54 offset:8192
    buffer_load_dwordx4 v68, s[28:31], s62 offen offset:2048 sc1 lds
    v_mfma_f32_16x16x32_bf16 v[210:213], a[140:143], a[180:183], v[210:213]
    ds_read_b64_tr_b16 a[188:189], v75 offset:2048
    v_mfma_f32_16x16x32_bf16 v[218:221], a[140:143], a[184:187], v[218:221]
    ds_read_b64_tr_b16 a[190:191], v75 offset:2304
    v_mfma_f32_16x16x32_bf16 v[202:205], a[140:143], a[176:179], v[202:205]
    ds_read_b128 a[164:167], v54 offset:9216
    buffer_load_dwordx4 v68, s[28:31], s62 offen offset:3072 sc1 lds
    v_mfma_f32_16x16x32_bf16 v[230:233], a[180:183], a[144:147], v[230:233]
    ds_read_b128 a[168:171], v54 offset:10240
    s_add_u32 m0, s59, 98304
    v_mfma_f32_16x16x32_bf16 v[238:241], a[184:187], a[144:147], v[238:241]
    ds_read_b128 a[172:175], v54 offset:11264
    s_add_u32 s63, s63, 12288
    v_mfma_f32_16x16x32_bf16 v[222:225], a[176:179], a[144:147], v[222:225]
    s_cmp_eq_u32 s63, 86016
    s_cselect_b32 s63, 0, s63
    v_mfma_f32_16x16x32_bf16 v[234:237], a[180:183], a[148:151], v[234:237]
    buffer_load_dwordx4 v80, s[28:31], s63 offen sc1 lds
    v_mfma_f32_16x16x32_bf16 v[242:245], a[184:187], a[148:151], v[242:245]
    v_mfma_f32_16x16x32_bf16 v[226:229], a[176:179], a[148:151], v[226:229]
    s_waitcnt vmcnt(9) lgkmcnt(0)
    s_barrier
    s_cmp_lg_u32 s48, 0
    s_cbranch_scc1 L_sig2
    s_atomic_add s36, s[28:29], s68
L_sig2:
    v_mfma_f32_16x16x32_bf16 v[182:185], a[152:155], a[192:195], v[182:185]
    ds_read_b64_tr_b16 a[180:181], v70 offset:0
    buffer_load_dwordx4 v80, s[28:31], s63 offen offset:1024 sc1 lds
    v_mfma_f32_16x16x32_bf16 v[190:193], a[152:155], a[196:199], v[190:193]
    ds_read_b64_tr_b16 a[182:183], v70 offset:256
    v_mfma_f32_16x16x32_bf16 v[186:189], a[156:159], a[192:195], v[186:189]
    ds_read_b128 a[128:131], v4 offset:0
    buffer_load_dwordx4 v80, s[28:31], s63 offen offset:2048 sc1 lds
    v_mfma_f32_16x16x32_bf16 v[194:197], a[156:159], a[196:199], v[194:197]
    ds_read_b64_tr_b16 a[184:185], v70 offset:1024
    v_mfma_f32_16x16x32_bf16 v[206:209], a[160:163], a[192:195], v[206:209]
    ds_read_b64_tr_b16 a[186:187], v70 offset:1280
    s_add_u32 m0, s100, 126976
    v_mfma_f32_16x16x32_bf16 v[214:217], a[160:163], a[196:199], v[214:217]
    ds_read_b128 a[132:135], v4 offset:1024
    s_add_u32 s62, s62, 262144
    v_mfma_f32_16x16x32_bf16 v[198:201], a[160:163], a[188:191], v[198:201]
    ds_read_b128 a[136:139], v4 offset:2048
    s_cmp_eq_u32 s62, 1835008
    v_mfma_f32_16x16x32_bf16 v[210:213], a[164:167], a[192:195], v[210:213]
    ds_read_b64_tr_b16 a[176:177], v71 offset:0
    s_cselect_b32 s62, 0, s62
    v_mfma_f32_16x16x32_bf16 v[218:221], a[164:167], a[196:199], v[218:221]
    ds_read_b64_tr_b16 a[178:179], v71 offset:256
    buffer_load_dwordx4 v69, s[28:31], s62 offen sc1 lds
    v_mfma_f32_16x16x32_bf16 v[202:205], a[164:167], a[188:191], v[202:205]
    ds_read_b128 a[140:143], v4 offset:3072
    s_add_u32 m0, s58, 110592
    v_mfma_f32_16x16x32_bf16 v[230:233], a[192:195], a[168:171], v[230:233]
    ds_read_b128 a[144:147], v4 offset:4096
    buffer_load_dwordx4 v67, s[28:31], s62 offen sc1 lds
    v_mfma_f32_16x16x32_bf16 v[238:241], a[196:199], a[168:171], v[238:241]
    ds_read_b128 a[148:151], v4 offset:5120
    v_mfma_f32_16x16x32_bf16 v[222:225], a[188:191], a[168:171], v[222:225]
    v_mfma_f32_16x16x32_bf16 v[234:237], a[192:195], a[172:175], v[234:237]
    buffer_load_dwordx4 v67, s[28:31], s62 offen offset:1024 sc1 lds
    v_mfma_f32_16x16x32_bf16 v[242:245], a[196:199], a[172:175], v[242:245]
    v_mfma_f32_16x16x32_bf16 v[226:229], a[188:191], a[172:175], v[226:229]
    s_waitcnt lgkmcnt(6)
    v_mfma_f32_16x16x32_bf16 v[182:185], a[128:131], a[180:183], v[182:185]
    ds_read_b64_tr_b16 a[192:193], v70 offset:2048
    buffer_load_dwordx4 v68, s[28:31], s62 offen offset:2048 sc1 lds
    v_mfma_f32_16x16x32_bf16 v[190:193], a[128:131], a[184:187], v[190:193]
    ds_read_b64_tr_b16 a[194:195], v70 offset:2304
    v_mfma_f32_16x16x32_bf16 v[186:189], a[132:135], a[180:183], v[186:189]
    ds_read_b128 a[152:155], v4 offset:6144
    v_mfma_f32_16x16x32_bf16 v[194:197], a[132:135], a[184:187], v[194:197]
    ds_read_b64_tr_b16 a[196:197], v70 offset:3072
    s_waitcnt lgkmcnt(4)
    v_mfma_f32_16x16x32_bf16 v[206:209], a[136:139], a[180:183], v[206:209]
    ds_read_b64_tr_b16 a[198:199], v70 offset:3328
    buffer_load_dwordx4 v68, s[28:31], s62 offen offset:3072 sc1 lds
    v_mfma_f32_16x16x32_bf16 v[214:217], a[136:139], a[184:187], v[214:217]
    ds_read_b128 a[156:159], v4 offset:7168
    s_add_u32 m0, s59, 131072
    v_mfma_f32_16x16x32_bf16 v[198:201], a[136:139], a[176:179], v[198:201]
    ds_read_b128 a[160:163], v4 offset:8192
    s_add_u32 s63, s63, 12288
    v_mfma_f32_16x16x32_bf16 v[210:213], a[140:143], a[180:183], v[210:213]
    ds_read_b64_tr_b16 a[188:189], v71 offset:2048
    s_cmp_eq_u32 s63, 86016
    v_mfma_f32_16x16x32_bf16 v[218:221], a[140:143], a[184:187], v[218:221]
    ds_read_b64_tr_b16 a[190:191], v71 offset:2304
    s_cselect_b32 s63, 0, s63
    v_mfma_f32_16x16x32_bf16 v[202:205], a[140:143], a[176:179], v[202:205]
    ds_read_b128 a[164:167], v4 offset:9216
    buffer_load_dwordx4 v80, s[28:31], s63 offen sc1 lds
    v_mfma_f32_16x16x32_bf16 v[230:233], a[180:183], a[144:147], v[230:233]
    ds_read_b128 a[168:171], v4 offset:10240
    v_mfma_f32_16x16x32_bf16 v[238:241], a[184:187], a[144:147], v[238:241]
    ds_read_b128 a[172:175], v4 offset:11264
    buffer_load_dwordx4 v80, s[28:31], s63 offen offset:1024 sc1 lds
    v_mfma_f32_16x16x32_bf16 v[222:225], a[176:179], a[144:147], v[222:225]
    v_mfma_f32_16x16x32_bf16 v[234:237], a[180:183], a[148:151], v[234:237]
    v_mfma_f32_16x16x32_bf16 v[242:245], a[184:187], a[148:151], v[242:245]
    buffer_load_dwordx4 v80, s[28:31], s63 offen offset:2048 sc1 lds
    s_add_u32 m0, s100, 159744
    v_mfma_f32_16x16x32_bf16 v[226:229], a[176:179], a[148:151], v[226:229]
    s_add_u32 s62, s62, 262144
    ds_read_b32 v24, v4
    s_waitcnt lgkmcnt(1)
    s_barrier
    v_mfma_f32_16x16x32_bf16 v[182:185], a[152:155], a[192:195], v[182:185]
    ds_read_b64_tr_b16 a[180:181], v72 offset:0
    s_cmp_eq_u32 s62, 1835008
    v_mfma_f32_16x16x32_bf16 v[190:193], a[152:155], a[196:199], v[190:193]
    ds_read_b64_tr_b16 a[182:183], v72 offset:256
    s_cselect_b32 s62, 0, s62
    v_mfma_f32_16x16x32_bf16 v[186:189], a[156:159], a[192:195], v[186:189]
    ds_read_b128 a[128:131], v53 offset:0
    buffer_load_dwordx4 v69, s[28:31], s62 offen sc1 lds
    v_mfma_f32_16x16x32_bf16 v[194:197], a[156:159], a[196:199], v[194:197]
    ds_read_b64_tr_b16 a[184:185], v72 offset:1024
    v_mfma_f32_16x16x32_bf16 v[206:209], a[160:163], a[192:195], v[206:209]
    ds_read_b64_tr_b16 a[186:187], v72 offset:1280
    s_add_u32 m0, s58, 143360
    v_mfma_f32_16x16x32_bf16 v[214:217], a[160:163], a[196:199], v[214:217]
    ds_read_b128 a[132:135], v53 offset:1024
    buffer_load_dwordx4 v67, s[28:31], s62 offen sc1 lds
    v_mfma_f32_16x16x32_bf16 v[198:201], a[160:163], a[188:191], v[198:201]
    ds_read_b128 a[136:139], v53 offset:2048
    v_mfma_f32_16x16x32_bf16 v[210:213], a[164:167], a[192:195], v[210:213]
    ds_read_b64_tr_b16 a[176:177], v73 offset:0
    buffer_load_dwordx4 v67, s[28:31], s62 offen offset:1024 sc1 lds
    v_mfma_f32_16x16x32_bf16 v[218:221], a[164:167], a[196:199], v[218:221]
    ds_read_b64_tr_b16 a[178:179], v73 offset:256
    v_mfma_f32_16x16x32_bf16 v[202:205], a[164:167], a[188:191], v[202:205]
    ds_read_b128 a[140:143], v53 offset:3072
    v_mfma_f32_16x16x32_bf16 v[230:233], a[192:195], a[168:171], v[230:233]
    ds_read_b128 a[144:147], v53 offset:4096
    buffer_load_dwordx4 v68, s[28:31], s62 offen offset:2048 sc1 lds
    v_mfma_f32_16x16x32_bf16 v[238:241], a[196:199], a[168:171], v[238:241]
    ds_read_b128 a[148:151], v53 offset:5120
    v_mfma_f32_16x16x32_bf16 v[222:225], a[188:191], a[168:171], v[222:225]
    v_mfma_f32_16x16x32_bf16 v[234:237], a[192:195], a[172:175], v[234:237]
    buffer_load_dwordx4 v68, s[28:31], s62 offen offset:3072 sc1 lds
    s_add_u32 m0, s58, 0
    v_mfma_f32_16x16x32_bf16 v[242:245], a[196:199], a[172:175], v[242:245]
    v_mfma_f32_16x16x32_bf16 v[226:229], a[188:191], a[172:175], v[226:229]
    s_waitcnt lgkmcnt(6)
    v_mfma_f32_16x16x32_bf16 v[182:185], a[128:131], a[180:183], v[182:185]
    ds_read_b64_tr_b16 a[192:193], v72 offset:2048
    buffer_load_dwordx4 v59, s[24:27], s64 offen lds
    v_mfma_f32_16x16x32_bf16 v[190:193], a[128:131], a[184:187], v[190:193]
    ds_read_b64_tr_b16 a[194:195], v72 offset:2304
    v_mfma_f32_16x16x32_bf16 v[186:189], a[132:135], a[180:183], v[186:189]
    ds_read_b128 a[152:155], v53 offset:6144
    v_mfma_f32_16x16x32_bf16 v[194:197], a[132:135], a[184:187], v[194:197]
    ds_read_b64_tr_b16 a[196:197], v72 offset:3072
    s_waitcnt lgkmcnt(4)
    v_mfma_f32_16x16x32_bf16 v[206:209], a[136:139], a[180:183], v[206:209]
    ds_read_b64_tr_b16 a[198:199], v72 offset:3328
    buffer_load_dwordx4 v60, s[24:27], s64 offen offset:1024 lds
    v_mfma_f32_16x16x32_bf16 v[214:217], a[136:139], a[184:187], v[214:217]
    ds_read_b128 a[156:159], v53 offset:7168
    v_mfma_f32_16x16x32_bf16 v[198:201], a[136:139], a[176:179], v[198:201]
    ds_read_b128 a[160:163], v53 offset:8192
    v_mfma_f32_16x16x32_bf16 v[210:213], a[140:143], a[180:183], v[210:213]
    ds_read_b64_tr_b16 a[188:189], v73 offset:2048
    buffer_load_dwordx4 v61, s[24:27], s64 offen offset:2048 lds
    v_mfma_f32_16x16x32_bf16 v[218:221], a[140:143], a[184:187], v[218:221]
    ds_read_b64_tr_b16 a[190:191], v73 offset:2304
    v_mfma_f32_16x16x32_bf16 v[202:205], a[140:143], a[176:179], v[202:205]
    ds_read_b128 a[164:167], v53 offset:9216
    v_mfma_f32_16x16x32_bf16 v[230:233], a[180:183], a[144:147], v[230:233]
    ds_read_b128 a[168:171], v53 offset:10240
    buffer_load_dwordx4 v62, s[24:27], s64 offen offset:3072 lds
    v_mfma_f32_16x16x32_bf16 v[238:241], a[184:187], a[144:147], v[238:241]
    ds_read_b128 a[172:175], v53 offset:11264
    s_add_u32 m0, s58, 16384
    v_mfma_f32_16x16x32_bf16 v[222:225], a[176:179], a[144:147], v[222:225]
    v_xor_b32 v59, 128, v59
    v_mfma_f32_16x16x32_bf16 v[234:237], a[180:183], a[148:151], v[234:237]
    buffer_load_dwordx4 v59, s[24:27], s64 offen lds
    v_xor_b32 v60, 128, v60
    v_mfma_f32_16x16x32_bf16 v[242:245], a[184:187], a[148:151], v[242:245]
    v_mfma_f32_16x16x32_bf16 v[226:229], a[176:179], a[148:151], v[226:229]
    ds_read_b32 v24, v4
    s_waitcnt vmcnt(21) lgkmcnt(1)
    s_barrier
    v_mfma_f32_16x16x32_bf16 v[182:185], a[152:155], a[192:195], v[182:185]
    ds_read_b64_tr_b16 a[180:181], v70 offset:32768
    buffer_load_dwordx4 v60, s[24:27], s64 offen offset:1024 lds
    v_mfma_f32_16x16x32_bf16 v[190:193], a[152:155], a[196:199], v[190:193]
    ds_read_b64_tr_b16 a[182:183], v70 offset:33024
    v_xor_b32 v61, 128, v61
    v_mfma_f32_16x16x32_bf16 v[186:189], a[156:159], a[192:195], v[186:189]
    ds_read_b128 a[128:131], v4 offset:32768
    v_mfma_f32_16x16x32_bf16 v[194:197], a[156:159], a[196:199], v[194:197]
    ds_read_b64_tr_b16 a[184:185], v70 offset:33792
    v_mfma_f32_16x16x32_bf16 v[206:209], a[160:163], a[192:195], v[206:209]
    ds_read_b64_tr_b16 a[186:187], v70 offset:34048
    buffer_load_dwordx4 v61, s[24:27], s64 offen offset:2048 lds
    v_mfma_f32_16x16x32_bf16 v[214:217], a[160:163], a[196:199], v[214:217]
    ds_read_b128 a[132:135], v4 offset:33792
    v_xor_b32 v62, 128, v62
    v_mfma_f32_16x16x32_bf16 v[198:201], a[160:163], a[188:191], v[198:201]
    ds_read_b128 a[136:139], v4 offset:34816
    buffer_load_dwordx4 v62, s[24:27], s64 offen offset:3072 lds
    v_mfma_f32_16x16x32_bf16 v[210:213], a[164:167], a[192:195], v[210:213]
    ds_read_b64_tr_b16 a[176:177], v71 offset:32768
    s_add_u32 m0, s58, 65536
    v_mfma_f32_16x16x32_bf16 v[218:221], a[164:167], a[196:199], v[218:221]
    ds_read_b64_tr_b16 a[178:179], v71 offset:33024
    s_add_u32 s64, s64, 524288
    v_mfma_f32_16x16x32_bf16 v[202:205], a[164:167], a[188:191], v[202:205]
    ds_read_b128 a[140:143], v4 offset:35840
    s_cmp_eq_u32 s64, 3670016
    v_mfma_f32_16x16x32_bf16 v[230:233], a[192:195], a[168:171], v[230:233]
    ds_read_b128 a[144:147], v4 offset:36864
    s_cselect_b32 s64, 0, s64
    v_mfma_f32_16x16x32_bf16 v[238:241], a[196:199], a[168:171], v[238:241]
    ds_read_b128 a[148:151], v4 offset:37888
    buffer_load_dwordx4 v59, s[24:27], s64 offen lds
    v_mfma_f32_16x16x32_bf16 v[222:225], a[188:191], a[168:171], v[222:225]
    v_mfma_f32_16x16x32_bf16 v[234:237], a[192:195], a[172:175], v[234:237]
    buffer_load_dwordx4 v60, s[24:27], s64 offen offset:1024 lds
    v_mfma_f32_16x16x32_bf16 v[242:245], a[196:199], a[172:175], v[242:245]
    v_mfma_f32_16x16x32_bf16 v[226:229], a[188:191], a[172:175], v[226:229]
    s_waitcnt lgkmcnt(6)
    v_mfma_f32_16x16x32_bf16 v[182:185], a[128:131], a[180:183], v[182:185]
    ds_read_b64_tr_b16 a[192:193], v70 offset:34816
    buffer_load_dwordx4 v61, s[24:27], s64 offen offset:2048 lds
    v_mfma_f32_16x16x32_bf16 v[190:193], a[128:131], a[184:187], v[190:193]
    ds_read_b64_tr_b16 a[194:195], v70 offset:35072
    v_mfma_f32_16x16x32_bf16 v[186:189], a[132:135], a[180:183], v[186:189]
    ds_read_b128 a[152:155], v4 offset:38912
    v_mfma_f32_16x16x32_bf16 v[194:197], a[132:135], a[184:187], v[194:197]
    ds_read_b64_tr_b16 a[196:197], v70 offset:35840
    s_waitcnt lgkmcnt(4)
    v_mfma_f32_16x16x32_bf16 v[206:209], a[136:139], a[180:183], v[206:209]
    ds_read_b64_tr_b16 a[198:199], v70 offset:36096
    buffer_load_dwordx4 v62, s[24:27], s64 offen offset:3072 lds
    v_mfma_f32_16x16x32_bf16 v[214:217], a[136:139], a[184:187], v[214:217]
    ds_read_b128 a[156:159], v4 offset:39936
    s_add_u32 m0, s58, 81920
    v_mfma_f32_16x16x32_bf16 v[198:201], a[136:139], a[176:179], v[198:201]
    ds_read_b128 a[160:163], v4 offset:40960
    s_add_u32 s64, s64, 524288
    v_mfma_f32_16x16x32_bf16 v[210:213], a[140:143], a[180:183], v[210:213]
    ds_read_b64_tr_b16 a[188:189], v71 offset:34816
    s_cmp_eq_u32 s64, 3670016
    v_mfma_f32_16x16x32_bf16 v[218:221], a[140:143], a[184:187], v[218:221]
    ds_read_b64_tr_b16 a[190:191], v71 offset:35072
    s_cselect_b32 s64, 0, s64
    v_mfma_f32_16x16x32_bf16 v[202:205], a[140:143], a[176:179], v[202:205]
    ds_read_b128 a[164:167], v4 offset:41984
    buffer_load_dwordx4 v59, s[24:27], s64 offen lds
    v_mfma_f32_16x16x32_bf16 v[230:233], a[180:183], a[144:147], v[230:233]
    ds_read_b128 a[168:171], v4 offset:43008
    v_mfma_f32_16x16x32_bf16 v[238:241], a[184:187], a[144:147], v[238:241]
    ds_read_b128 a[172:175], v4 offset:44032
    buffer_load_dwordx4 v60, s[24:27], s64 offen offset:1024 lds
    v_mfma_f32_16x16x32_bf16 v[222:225], a[176:179], a[144:147], v[222:225]
    v_mfma_f32_16x16x32_bf16 v[234:237], a[180:183], a[148:151], v[234:237]
    v_mfma_f32_16x16x32_bf16 v[242:245], a[184:187], a[148:151], v[242:245]
    buffer_load_dwordx4 v61, s[24:27], s64 offen offset:2048 lds
    v_mfma_f32_16x16x32_bf16 v[226:229], a[176:179], a[148:151], v[226:229]
    ds_read_b32 v24, v4
    s_waitcnt vmcnt(23) lgkmcnt(1)
    s_barrier
    v_mfma_f32_16x16x32_bf16 v[182:185], a[152:155], a[192:195], v[182:185]
    ds_read_b64_tr_b16 a[180:181], v72 offset:32768
    v_mfma_f32_16x16x32_bf16 v[190:193], a[152:155], a[196:199], v[190:193]
    ds_read_b64_tr_b16 a[182:183], v72 offset:33024
    buffer_load_dwordx4 v62, s[24:27], s64 offen offset:3072 lds
    v_mfma_f32_16x16x32_bf16 v[186:189], a[156:159], a[192:195], v[186:189]
    ds_read_b128 a[128:131], v53 offset:32768
    s_add_u32 m0, s58, 32768
    v_mfma_f32_16x16x32_bf16 v[194:197], a[156:159], a[196:199], v[194:197]
    ds_read_b64_tr_b16 a[184:185], v72 offset:33792
    v_mfma_f32_16x16x32_bf16 v[206:209], a[160:163], a[192:195], v[206:209]
    ds_read_b64_tr_b16 a[186:187], v72 offset:34048
    s_add_u32 s64, s64, 524288
    v_mfma_f32_16x16x32_bf16 v[214:217], a[160:163], a[196:199], v[214:217]
    ds_read_b128 a[132:135], v53 offset:33792
    s_cmp_eq_u32 s64, 3670016
    v_mfma_f32_16x16x32_bf16 v[198:201], a[160:163], a[188:191], v[198:201]
    ds_read_b128 a[136:139], v53 offset:34816
    s_cselect_b32 s64, 0, s64
    v_mfma_f32_16x16x32_bf16 v[210:213], a[164:167], a[192:195], v[210:213]
    ds_read_b64_tr_b16 a[176:177], v73 offset:32768
    buffer_load_dwordx4 v59, s[24:27], s64 offen lds
    v_mfma_f32_16x16x32_bf16 v[218:221], a[164:167], a[196:199], v[218:221]
    ds_read_b64_tr_b16 a[178:179], v73 offset:33024
    v_mfma_f32_16x16x32_bf16 v[202:205], a[164:167], a[188:191], v[202:205]
    ds_read_b128 a[140:143], v53 offset:35840
    buffer_load_dwordx4 v60, s[24:27], s64 offen offset:1024 lds
    v_mfma_f32_16x16x32_bf16 v[230:233], a[192:195], a[168:171], v[230:233]
    ds_read_b128 a[144:147], v53 offset:36864
    v_mfma_f32_16x16x32_bf16 v[238:241], a[196:199], a[168:171], v[238:241]
    ds_read_b128 a[148:151], v53 offset:37888
    v_mfma_f32_16x16x32_bf16 v[222:225], a[188:191], a[168:171], v[222:225]
    buffer_load_dwordx4 v61, s[24:27], s64 offen offset:2048 lds
    v_mfma_f32_16x16x32_bf16 v[234:237], a[192:195], a[172:175], v[234:237]
    v_mfma_f32_16x16x32_bf16 v[242:245], a[196:199], a[172:175], v[242:245]
    v_mfma_f32_16x16x32_bf16 v[226:229], a[188:191], a[172:175], v[226:229]
    buffer_load_dwordx4 v62, s[24:27], s64 offen offset:3072 lds
    s_waitcnt lgkmcnt(6)
    v_mfma_f32_16x16x32_bf16 v[182:185], a[128:131], a[180:183], v[182:185]
    ds_read_b64_tr_b16 a[192:193], v72 offset:34816
    s_add_u32 m0, s58, 49152
    v_mfma_f32_16x16x32_bf16 v[190:193], a[128:131], a[184:187], v[190:193]
    ds_read_b64_tr_b16 a[194:195], v72 offset:35072
    s_add_u32 s64, s64, 524288
    v_mfma_f32_16x16x32_bf16 v[186:189], a[132:135], a[180:183], v[186:189]
    ds_read_b128 a[152:155], v53 offset:38912
    s_cmp_eq_u32 s64, 3670016
    v_mfma_f32_16x16x32_bf16 v[194:197], a[132:135], a[184:187], v[194:197]
    ds_read_b64_tr_b16 a[196:197], v72 offset:35840
    s_waitcnt lgkmcnt(4)
    v_mfma_f32_16x16x32_bf16 v[206:209], a[136:139], a[180:183], v[206:209]
    ds_read_b64_tr_b16 a[198:199], v72 offset:36096
    s_cselect_b32 s64, 0, s64
    v_mfma_f32_16x16x32_bf16 v[214:217], a[136:139], a[184:187], v[214:217]
    ds_read_b128 a[156:159], v53 offset:39936
    buffer_load_dwordx4 v59, s[24:27], s64 offen lds
    v_mfma_f32_16x16x32_bf16 v[198:201], a[136:139], a[176:179], v[198:201]
    ds_read_b128 a[160:163], v53 offset:40960
    v_mfma_f32_16x16x32_bf16 v[210:213], a[140:143], a[180:183], v[210:213]
    ds_read_b64_tr_b16 a[188:189], v73 offset:34816
    buffer_load_dwordx4 v60, s[24:27], s64 offen offset:1024 lds
    v_mfma_f32_16x16x32_bf16 v[218:221], a[140:143], a[184:187], v[218:221]
    ds_read_b64_tr_b16 a[190:191], v73 offset:35072
    v_mfma_f32_16x16x32_bf16 v[202:205], a[140:143], a[176:179], v[202:205]
L_pad2:
    s_cbranch_execz L_warm
    ds_read_b128 a[164:167], v53 offset:41984
    v_mfma_f32_16x16x32_bf16 v[230:233], a[180:183], a[144:147], v[230:233]
    ds_read_b128 a[168:171], v53 offset:43008
    buffer_load_dwordx4 v61, s[24:27], s64 offen offset:2048 lds
    v_mfma_f32_16x16x32_bf16 v[238:241], a[184:187], a[144:147], v[238:241]
    ds_read_b128 a[172:175], v53 offset:44032
    v_mfma_f32_16x16x32_bf16 v[222:225], a[176:179], a[144:147], v[222:225]
    v_mfma_f32_16x16x32_bf16 v[234:237], a[180:183], a[148:151], v[234:237]
    buffer_load_dwordx4 v62, s[24:27], s64 offen offset:3072 lds
    v_mfma_f32_16x16x32_bf16 v[242:245], a[184:187], a[148:151], v[242:245]
    v_mfma_f32_16x16x32_bf16 v[226:229], a[176:179], a[148:151], v[226:229]
    ds_read_b32 v24, v4
    s_waitcnt vmcnt(24) lgkmcnt(1)
    s_barrier
    s_mov_b32 s14, 0
    s_load_dword s14, s[28:29], s38
    v_mfma_f32_16x16x32_bf16 v[182:185], a[152:155], a[192:195], v[182:185]
    ds_read_b64_tr_b16 a[180:181], v74 offset:0
    s_add_u32 m0, s58, 98304
    v_mfma_f32_16x16x32_bf16 v[190:193], a[152:155], a[196:199], v[190:193]
    ds_read_b64_tr_b16 a[182:183], v74 offset:256
    s_add_u32 s64, s64, 524288
    v_mfma_f32_16x16x32_bf16 v[186:189], a[156:159], a[192:195], v[186:189]
    ds_read_b128 a[128:131], v54 offset:0
    s_cmp_eq_u32 s64, 3670016
    v_mfma_f32_16x16x32_bf16 v[194:197], a[156:159], a[196:199], v[194:197]
    ds_read_b64_tr_b16 a[184:185], v74 offset:1024
    v_mfma_f32_16x16x32_bf16 v[206:209], a[160:163], a[192:195], v[206:209]
    ds_read_b64_tr_b16 a[186:187], v74 offset:1280
    s_cselect_b32 s64, 0, s64
    v_mfma_f32_16x16x32_bf16 v[214:217], a[160:163], a[196:199], v[214:217]
    ds_read_b128 a[132:135], v54 offset:1024
    buffer_load_dwordx4 v59, s[24:27], s64 offen lds
    v_mfma_f32_16x16x32_bf16 v[198:201], a[160:163], a[188:191], v[198:201]
    ds_read_b128 a[136:139], v54 offset:2048
    v_mfma_f32_16x16x32_bf16 v[210:213], a[164:167], a[192:195], v[210:213]
    ds_read_b64_tr_b16 a[176:177], v75 offset:0
    buffer_load_dwordx4 v60, s[24:27], s64 offen offset:1024 lds
    v_mfma_f32_16x16x32_bf16 v[218:221], a[164:167], a[196:199], v[218:221]
    ds_read_b64_tr_b16 a[178:179], v75 offset:256
    v_mfma_f32_16x16x32_bf16 v[202:205], a[164:167], a[188:191], v[202:205]
    ds_read_b128 a[140:143], v54 offset:3072
    v_mfma_f32_16x16x32_bf16 v[230:233], a[192:195], a[168:171], v[230:233]
    ds_read_b128 a[144:147], v54 offset:4096
    buffer_load_dwordx4 v61, s[24:27], s64 offen offset:2048 lds
    v_mfma_f32_16x16x32_bf16 v[238:241], a[196:199], a[168:171], v[238:241]
    ds_read_b128 a[148:151], v54 offset:5120
    v_mfma_f32_16x16x32_bf16 v[222:225], a[188:191], a[168:171], v[222:225]
    v_mfma_f32_16x16x32_bf16 v[234:237], a[192:195], a[172:175], v[234:237]
    buffer_load_dwordx4 v62, s[24:27], s64 offen offset:3072 lds
    s_add_u32 m0, s58, 114688
    v_mfma_f32_16x16x32_bf16 v[242:245], a[196:199], a[172:175], v[242:245]
    s_add_u32 s64, s64, 524288
    s_cmp_eq_u32 s64, 3670016
    v_mfma_f32_16x16x32_bf16 v[226:229], a[188:191], a[172:175], v[226:229]
    s_cselect_b32 s64, 0, s64
    s_waitcnt lgkmcnt(6)
    v_mfma_f32_16x16x32_bf16 v[182:185], a[128:131], a[180:183], v[182:185]
    ds_read_b64_tr_b16 a[192:193], v74 offset:2048
    buffer_load_dwordx4 v59, s[24:27], s64 offen lds
    v_mfma_f32_16x16x32_bf16 v[190:193], a[128:131], a[184:187], v[190:193]
    ds_read_b64_tr_b16 a[194:195], v74 offset:2304
    v_mfma_f32_16x16x32_bf16 v[186:189], a[132:135], a[180:183], v[186:189]
    ds_read_b128 a[152:155], v54 offset:6144
    v_mfma_f32_16x16x32_bf16 v[194:197], a[132:135], a[184:187], v[194:197]
    ds_read_b64_tr_b16 a[196:197], v74 offset:3072
    s_waitcnt lgkmcnt(4)
    v_mfma_f32_16x16x32_bf16 v[206:209], a[136:139], a[180:183], v[206:209]
    ds_read_b64_tr_b16 a[198:199], v74 offset:3328
    buffer_load_dwordx4 v60, s[24:27], s64 offen offset:1024 lds
    v_mfma_f32_16x16x32_bf16 v[214:217], a[136:139], a[184:187], v[214:217]
    ds_read_b128 a[156:159], v54 offset:7168
    v_mfma_f32_16x16x32_bf16 v[198:201], a[136:139], a[176:179], v[198:201]
    ds_read_b128 a[160:163], v54 offset:8192
    buffer_load_dwordx4 v61, s[24:27], s64 offen offset:2048 lds
    v_mfma_f32_16x16x32_bf16 v[210:213], a[140:143], a[180:183], v[210:213]
    ds_read_b64_tr_b16 a[188:189], v75 offset:2048
    v_mfma_f32_16x16x32_bf16 v[218:221], a[140:143], a[184:187], v[218:221]
    ds_read_b64_tr_b16 a[190:191], v75 offset:2304
    v_mfma_f32_16x16x32_bf16 v[202:205], a[140:143], a[176:179], v[202:205]
    ds_read_b128 a[164:167], v54 offset:9216
    buffer_load_dwordx4 v62, s[24:27], s64 offen offset:3072 lds
    v_mfma_f32_16x16x32_bf16 v[230:233], a[180:183], a[144:147], v[230:233]
    ds_read_b128 a[168:171], v54 offset:10240
    v_mfma_f32_16x16x32_bf16 v[238:241], a[184:187], a[144:147], v[238:241]
    ds_read_b128 a[172:175], v54 offset:11264
    v_mfma_f32_16x16x32_bf16 v[222:225], a[176:179], a[144:147], v[222:225]
    v_mfma_f32_16x16x32_bf16 v[234:237], a[180:183], a[148:151], v[234:237]
    v_mfma_f32_16x16x32_bf16 v[242:245], a[184:187], a[148:151], v[242:245]
    v_mfma_f32_16x16x32_bf16 v[226:229], a[176:179], a[148:151], v[226:229]
    s_cmp_ge_u32 s14, 7
    s_cbranch_scc0 L_pollin5
L_pollok5:
    s_waitcnt vmcnt(16) lgkmcnt(0)
    s_barrier
    v_mfma_f32_16x16x32_bf16 v[182:185], a[152:155], a[192:195], v[182:185]
    ds_read_b64_tr_b16 a[200:201], v31 offset:16384
    buffer_load_dwordx4 a[0:3], v79, s[28:31], s65 offen offset:0 sc1
    v_mfma_f32_16x16x32_bf16 v[190:193], a[152:155], a[196:199], v[190:193]
    ds_read_b64_tr_b16 a[202:203], v31 offset:18432
    v_mfma_f32_16x16x32_bf16 v[186:189], a[156:159], a[192:195], v[186:189]
    ds_read_b64_tr_b16 a[204:205], v33 offset:16384
    buffer_load_dwordx4 a[4:7], v79, s[28:31], s65 offen offset:1024 sc1
    v_mfma_f32_16x16x32_bf16 v[194:197], a[156:159], a[196:199], v[194:197]
    ds_read_b64_tr_b16 a[206:207], v33 offset:18432
    v_mfma_f32_16x16x32_bf16 v[206:209], a[160:163], a[192:195], v[206:209]
    ds_read_b64_tr_b16 a[208:209], v32 offset:16384
    v_mfma_f32_16x16x32_bf16 v[214:217], a[160:163], a[196:199], v[214:217]
    ds_read_b64_tr_b16 a[210:211], v32 offset:18432
    v_mfma_f32_16x16x32_bf16 v[198:201], a[160:163], a[188:191], v[198:201]
    ds_read_b64_tr_b16 a[212:213], v34 offset:16384
    buffer_load_dwordx4 a[8:11], v79, s[28:31], s65 offen offset:2048 sc1
    v_mfma_f32_16x16x32_bf16 v[210:213], a[164:167], a[192:195], v[210:213]
    ds_read_b64_tr_b16 a[214:215], v34 offset:18432
    v_mfma_f32_16x16x32_bf16 v[218:221], a[164:167], a[196:199], v[218:221]
    ds_read_b64_tr_b16 a[216:217], v31 offset:20480
    v_mfma_f32_16x16x32_bf16 v[202:205], a[164:167], a[188:191], v[202:205]
    ds_read_b64_tr_b16 a[218:219], v31 offset:22528
    buffer_load_dwordx4 a[12:15], v79, s[28:31], s65 offen offset:3072 sc1
    v_mfma_f32_16x16x32_bf16 v[230:233], a[192:195], a[168:171], v[230:233]
    ds_read_b64_tr_b16 a[220:221], v33 offset:20480
    s_add_u32 s65, s65, 8192
    v_mfma_f32_16x16x32_bf16 v[238:241], a[196:199], a[168:171], v[238:241]
    ds_read_b64_tr_b16 a[222:223], v33 offset:22528
    s_cmp_eq_u32 s65, 57344
    v_mfma_f32_16x16x32_bf16 v[222:225], a[188:191], a[168:171], v[222:225]
    s_cselect_b32 s65, 0, s65
    v_mfma_f32_16x16x32_bf16 v[234:237], a[192:195], a[172:175], v[234:237]
    buffer_load_dwordx4 a[16:19], v79, s[28:31], s65 offen offset:0 sc1
    v_mfma_f32_16x16x32_bf16 v[242:245], a[196:199], a[172:175], v[242:245]
    v_mfma_f32_16x16x32_bf16 v[226:229], a[188:191], a[172:175], v[226:229]
    v_cvt_pk_bf16_f32 v118, v182, v183
    v_cvt_pk_bf16_f32 v119, v184, v185
    v_cvt_pk_bf16_f32 v120, v186, v187
    buffer_load_dwordx4 a[20:23], v79, s[28:31], s65 offen offset:1024 sc1
    v_cvt_pk_bf16_f32 v121, v188, v189
    v_cvt_pk_bf16_f32 v122, v190, v191
    v_cvt_pk_bf16_f32 v123, v192, v193
    v_cvt_pk_bf16_f32 v124, v194, v195
    v_cvt_pk_bf16_f32 v125, v196, v197
    v_cvt_pk_bf16_f32 v130, v206, v207
    v_cvt_pk_bf16_f32 v131, v208, v209
    v_cvt_pk_bf16_f32 v132, v210, v211
    v_cvt_pk_bf16_f32 v133, v212, v213
    v_cvt_pk_bf16_f32 v134, v214, v215
    v_cvt_pk_bf16_f32 v135, v216, v217
    v_cvt_pk_bf16_f32 v136, v218, v219
    v_cvt_pk_bf16_f32 v137, v220, v221
    v_cvt_pk_bf16_f32 v126, v198, v199
    buffer_load_dwordx4 a[24:27], v79, s[28:31], s65 offen offset:2048 sc1
    v_cvt_pk_bf16_f32 v127, v200, v201
    v_cvt_pk_bf16_f32 v128, v202, v203
    v_cvt_pk_bf16_f32 v129, v204, v205
    v_mfma_f32_16x16x32_bf16 v[154:157], v[130:133], v[118:121], 0
    v_mfma_f32_16x16x32_bf16 v[158:161], v[130:133], v[122:125], 0
    v_mfma_f32_16x16x32_bf16 v[162:165], v[134:137], v[122:125], 0
    buffer_load_dwordx4 a[28:31], v79, s[28:31], s65 offen offset:3072 sc1
    v_mfma_f32_16x16x32_bf16 v[150:153], v[126:129], v[118:121], 0
    v_cvt_pk_bf16_f32 v166, v222, v223
    v_cvt_pk_bf16_f32 v167, v224, v225
    v_cvt_pk_bf16_f32 v168, v230, v231
    v_cvt_pk_bf16_f32 v169, v232, v233
    v_cvt_pk_bf16_f32 v170, v238, v239
    v_cvt_pk_bf16_f32 v171, v240, v241
    v_cndmask_b32 v250, v158, v159, s[70:71]
    v_cndmask_b32 v253, v162, v163, s[70:71]
    v_cndmask_b32 v250, v250, v253, s[72:73]
    s_add_u32 s65, s65, 8192
    s_cmp_eq_u32 s65, 57344
    s_cselect_b32 s65, 0, s65
    buffer_load_dwordx4 a[32:35], v79, s[28:31], s65 offen offset:0 sc1
    v_mul_f32 v250, v250, v29
    v_cndmask_b32 v251, v160, v161, s[70:71]
    v_cndmask_b32 v253, v164, v165, s[70:71]
    v_cndmask_b32 v251, v251, v253, s[74:75]
    v_mul_f32 v251, v251, v30
    v_cndmask_b32 v246, v150, v151, s[70:71]
    v_cndmask_b32 v246, v84, v246, s[76:77]
    v_cndmask_b32 v249, v154, v155, s[70:71]
    v_cndmask_b32 v246, v246, v249, s[72:73]
    v_mul_f32 v246, v246, v27
    v_cndmask_b32 v247, v152, v153, s[70:71]
    v_cndmask_b32 v247, v84, v247, s[76:77]
    v_cndmask_b32 v249, v156, v157, s[70:71]
    v_cndmask_b32 v247, v247, v249, s[74:75]
    buffer_load_dwordx4 a[36:39], v79, s[28:31], s65 offen offset:1024 sc1
    v_mul_f32 v247, v247, v28
    v_max_f32 v248, v246, v247
    v_max_f32 v252, v250, v251
    v_mov_b32 v249, v248
    v_mov_b32 v253, v252
    v_cvt_pk_bf16_f32 v172, v226, v227
    v_permlane16_swap_b32 v248, v249
    v_permlane16_swap_b32 v252, v253
    v_max_f32 v248, v248, v249
    v_max_f32 v252, v252, v253
    v_mov_b32 v249, v248
    v_mov_b32 v253, v252
    v_cvt_pk_bf16_f32 v173, v228, v229
    v_permlane32_swap_b32 v248, v249
    buffer_load_dwordx4 a[40:43], v79, s[28:31], s65 offen offset:2048 sc1
    v_permlane32_swap_b32 v252, v253
    v_max_f32 v248, v248, v249
    v_max_f32 v252, v252, v253
    v_mul_f32 v248, v25, v248
    v_mul_f32 v252, v26, v252
    v_fma_f32 v246, v246, v25, -v248
    v_fma_f32 v247, v247, v25, -v248
    v_fma_f32 v250, v250, v26, -v252
    v_fma_f32 v251, v251, v26, -v252
    v_exp_f32 v246, v246
    v_exp_f32 v247, v247
    v_exp_f32 v250, v250
    buffer_load_dwordx4 a[44:47], v79, s[28:31], s65 offen offset:3072 sc1
    v_exp_f32 v251, v251
    v_add_f32 v248, v246, v247
    v_add_f32 v252, v250, v251
    v_mov_b32 v249, v248
    v_mov_b32 v253, v252
    v_cvt_pk_bf16_f32 v174, v234, v235
    v_permlane16_swap_b32 v248, v249
    v_permlane16_swap_b32 v252, v253
    v_add_f32 v248, v248, v249
    v_add_f32 v252, v252, v253
    v_mov_b32 v249, v248
    v_mov_b32 v253, v252
    s_add_u32 m0, s58, 131072
    s_add_u32 s64, s64, 524288
    s_cmp_eq_u32 s64, 3670016
    s_cselect_b32 s64, 0, s64
    s_add_u32 s64, s64, 524288
    s_cmp_eq_u32 s64, 3670016
    s_cselect_b32 s64, 0, s64
    v_xor_b32 v59, 128, v59
    buffer_load_dwordx4 v59, s[24:27], s64 offen lds
    v_cvt_pk_bf16_f32 v175, v236, v237
    v_permlane32_swap_b32 v248, v249
    v_permlane32_swap_b32 v252, v253
    v_add_f32 v248, v248, v249
    v_add_f32 v252, v252, v253
    v_rcp_f32 v248, v248
    v_rcp_f32 v252, v252
    v_cvt_pk_bf16_f32 v176, v242, v243
    v_cvt_pk_bf16_f32 v177, v244, v245
    v_mul_f32 v246, v246, v27
    v_xor_b32 v60, 128, v60
    buffer_load_dwordx4 v60, s[24:27], s64 offen offset:1024 lds
    v_mul_f32 v247, v247, v28
    v_mul_f32 v250, v250, v29
    v_mul_f32 v251, v251, v30
    v_mul_f32 v246, v246, v248
    v_mul_f32 v247, v247, v248
    v_mul_f32 v250, v250, v252
    v_mul_f32 v251, v251, v252
    v_cvt_pk_bf16_f32 v246, v246, v246
    v_cvt_pk_bf16_f32 v247, v247, v247
    v_cvt_pk_bf16_f32 v250, v250, v250
    v_cvt_pk_bf16_f32 v251, v251, v251
    v_and_b32 v138, v246, v104
    v_and_b32 v139, v247, v105
    v_xor_b32 v61, 128, v61
    buffer_load_dwordx4 v61, s[24:27], s64 offen offset:2048 lds
    v_and_b32 v140, v246, v106
    v_and_b32 v141, v247, v107
    v_and_b32 v142, v250, v104
    v_and_b32 v143, v251, v105
    v_and_b32 v144, v250, v106
    v_and_b32 v145, v251, v107
    v_mfma_f32_16x16x32_bf16 v[182:185], v[166:169], v[138:141], 0
    v_mfma_f32_16x16x32_bf16 v[186:189], v[172:175], v[138:141], 0
    v_xor_b32 v62, 128, v62
    buffer_load_dwordx4 v62, s[24:27], s64 offen offset:3072 lds
    v_mfma_f32_16x16x32_bf16 v[190:193], v[168:171], v[142:145], 0
    v_mfma_f32_16x16x32_bf16 v[194:197], v[174:177], v[142:145], 0
    s_add_u32 s83, s82, 16384
    s_nop 1
    v_cvt_pk_bf16_f32 v110, v182, v183
    v_cvt_pk_bf16_f32 v111, v184, v185
    s_add_u32 m0, s58, 147456
    s_add_u32 s64, s64, 524288
    s_cmp_eq_u32 s64, 3670016
    s_cselect_b32 s64, 0, s64
    buffer_load_dwordx4 v59, s[24:27], s64 offen lds
    v_cvt_pk_bf16_f32 v112, v186, v187
    v_cvt_pk_bf16_f32 v113, v188, v189
    v_cvt_pk_bf16_f32 v114, v190, v191
    v_cvt_pk_bf16_f32 v115, v192, v193
    v_cvt_pk_bf16_f32 v116, v194, v195
    v_cvt_pk_bf16_f32 v117, v196, v197
    buffer_store_dwordx4 v[110:113], v4, s[28:31], s82 offen sc1
    buffer_store_dwordx4 v[114:117], v4, s[28:31], s83 offen sc1
    s_cmp_lg_u32 s56, 0
    s_cbranch_scc0 L_nof
L_f:
    s_waitcnt vmcnt(17) lgkmcnt(8)
    v_mfma_f32_16x16x32_bf16 v[182:185], a[0:3], a[200:203], 0
    ds_read_b64_tr_b16 a[224:225], v32 offset:20480
    s_add_u32 s65, s65, 8192
    s_cmp_eq_u32 s65, 57344
    s_cselect_b32 s65, 0, s65
    buffer_load_dwordx4 a[48:51], v79, s[28:31], s65 offen offset:0 sc1
    v_mfma_f32_16x16x32_bf16 v[186:189], a[4:7], a[200:203], 0
    ds_read_b64_tr_b16 a[226:227], v32 offset:22528
    v_lshlrev_b32 v93, 16, v93
    v_mfma_f32_16x16x32_bf16 v[238:241], a[0:3], a[204:207], 0
    ds_read_b64_tr_b16 a[228:229], v34 offset:20480
    buffer_load_dwordx4 a[52:55], v79, s[28:31], s65 offen offset:1024 sc1
    v_mfma_f32_16x16x32_bf16 v[242:245], a[4:7], a[204:207], 0
    ds_read_b64_tr_b16 a[230:231], v34 offset:22528
    s_waitcnt lgkmcnt(8)
    v_mfma_f32_16x16x32_bf16 v[190:193], a[0:3], a[208:211], 0
    ds_read_b64_tr_b16 a[200:201], v35 offset:0
    v_lshlrev_b32 v222, 16, v96
    v_mfma_f32_16x16x32_bf16 v[194:197], a[4:7], a[208:211], 0
    ds_read_b64_tr_b16 a[202:203], v35 offset:2048
    v_and_b32 v223, 0xffff0000, v96
    v_mfma_f32_16x16x32_bf16 v[246:249], a[0:3], a[212:215], 0
    ds_read_b64_tr_b16 a[204:205], v37 offset:0
    buffer_load_dwordx4 a[56:59], v79, s[28:31], s65 offen offset:2048 sc1
    v_mfma_f32_16x16x32_bf16 v[250:253], a[4:7], a[212:215], 0
    ds_read_b64_tr_b16 a[206:207], v37 offset:2048
    s_waitcnt vmcnt(18) lgkmcnt(8)
    v_mfma_f32_16x16x32_bf16 v[182:185], a[8:11], a[216:219], v[182:185]
    ds_read_b64_tr_b16 a[208:209], v36 offset:0
    v_add_f32 v222, v222, v93
    v_mfma_f32_16x16x32_bf16 v[186:189], a[12:15], a[216:219], v[186:189]
    ds_read_b64_tr_b16 a[210:211], v36 offset:2048
    buffer_load_dwordx4 a[60:63], v79, s[28:31], s65 offen offset:3072 sc1
    v_add_f32 v223, v223, v93
    v_mfma_f32_16x16x32_bf16 v[238:241], a[8:11], a[220:223], v[238:241]
    ds_read_b64_tr_b16 a[212:213], v38 offset:0
    s_add_u32 s65, s65, 8192
    v_mfma_f32_16x16x32_bf16 v[242:245], a[12:15], a[220:223], v[242:245]
    ds_read_b64_tr_b16 a[214:215], v38 offset:2048
    s_waitcnt lgkmcnt(8)
    v_mfma_f32_16x16x32_bf16 v[190:193], a[8:11], a[224:227], v[190:193]
    ds_read_b64_tr_b16 a[216:217], v35 offset:4096
    s_cmp_eq_u32 s65, 57344
    v_mfma_f32_16x16x32_bf16 v[194:197], a[12:15], a[224:227], v[194:197]
    ds_read_b64_tr_b16 a[218:219], v35 offset:6144
    s_cselect_b32 s65, 0, s65
    v_lshlrev_b32 v224, 16, v97
    v_mfma_f32_16x16x32_bf16 v[246:249], a[8:11], a[228:231], v[246:249]
    ds_read_b64_tr_b16 a[220:221], v37 offset:4096
    buffer_load_dwordx4 a[64:67], v79, s[28:31], s65 offen offset:0 sc1
    v_mfma_f32_16x16x32_bf16 v[250:253], a[12:15], a[228:231], v[250:253]
    ds_read_b64_tr_b16 a[222:223], v37 offset:6144
    s_waitcnt vmcnt(18) lgkmcnt(8)
    v_mfma_f32_16x16x32_bf16 v[182:185], a[16:19], a[200:203], v[182:185]
    ds_read_b64_tr_b16 a[224:225], v36 offset:4096
    buffer_load_dwordx4 a[68:71], v79, s[28:31], s65 offen offset:1024 sc1
    v_mfma_f32_16x16x32_bf16 v[186:189], a[20:23], a[200:203], v[186:189]
    ds_read_b64_tr_b16 a[226:227], v36 offset:6144
    v_and_b32 v225, 0xffff0000, v97
    v_mfma_f32_16x16x32_bf16 v[238:241], a[16:19], a[204:207], v[238:241]
    ds_read_b64_tr_b16 a[228:229], v38 offset:4096
    v_add_f32 v224, v224, v93
    v_mfma_f32_16x16x32_bf16 v[242:245], a[20:23], a[204:207], v[242:245]
    ds_read_b64_tr_b16 a[230:231], v38 offset:6144
    s_waitcnt lgkmcnt(8)
    v_mfma_f32_16x16x32_bf16 v[190:193], a[16:19], a[208:211], v[190:193]
    ds_read_b64_tr_b16 a[200:201], v35 offset:16384
    buffer_load_dwordx4 a[72:75], v79, s[28:31], s65 offen offset:2048 sc1
    v_mfma_f32_16x16x32_bf16 v[194:197], a[20:23], a[208:211], v[194:197]
    ds_read_b64_tr_b16 a[202:203], v35 offset:18432
    v_add_f32 v225, v225, v93
    v_mfma_f32_16x16x32_bf16 v[246:249], a[16:19], a[212:215], v[246:249]
    ds_read_b64_tr_b16 a[204:205], v37 offset:16384
    v_lshlrev_b32 v226, 16, v98
    v_mfma_f32_16x16x32_bf16 v[250:253], a[20:23], a[212:215], v[250:253]
    ds_read_b64_tr_b16 a[206:207], v37 offset:18432
    s_waitcnt vmcnt(18) lgkmcnt(8)
    v_mfma_f32_16x16x32_bf16 v[182:185], a[24:27], a[216:219], v[182:185]
    ds_read_b64_tr_b16 a[208:209], v36 offset:16384
    buffer_load_dwordx4 a[76:79], v79, s[28:31], s65 offen offset:3072 sc1
    v_mfma_f32_16x16x32_bf16 v[186:189], a[28:31], a[216:219], v[186:189]
    ds_read_b64_tr_b16 a[210:211], v36 offset:18432
    s_add_u32 s65, s65, 8192
    v_and_b32 v227, 0xffff0000, v98
    v_mfma_f32_16x16x32_bf16 v[238:241], a[24:27], a[220:223], v[238:241]
    ds_read_b64_tr_b16 a[212:213], v38 offset:16384
    s_cmp_eq_u32 s65, 57344
    v_mfma_f32_16x16x32_bf16 v[242:245], a[28:31], a[220:223], v[242:245]
    ds_read_b64_tr_b16 a[214:215], v38 offset:18432
    v_add_f32 v226, v226, v93
    s_waitcnt lgkmcnt(8)
    v_mfma_f32_16x16x32_bf16 v[190:193], a[24:27], a[224:227], v[190:193]
    ds_read_b64_tr_b16 a[216:217], v35 offset:20480
    s_cselect_b32 s65, 0, s65
    buffer_load_dwordx4 a[80:83], v79, s[28:31], s65 offen offset:0 sc1
    v_mfma_f32_16x16x32_bf16 v[194:197], a[28:31], a[224:227], v[194:197]
    ds_read_b64_tr_b16 a[218:219], v35 offset:22528
    v_add_f32 v227, v227, v93
    v_mfma_f32_16x16x32_bf16 v[246:249], a[24:27], a[228:231], v[246:249]
    ds_read_b64_tr_b16 a[220:221], v37 offset:20480
    buffer_load_dwordx4 a[84:87], v79, s[28:31], s65 offen offset:1024 sc1
    v_mfma_f32_16x16x32_bf16 v[250:253], a[28:31], a[228:231], v[250:253]
    ds_read_b64_tr_b16 a[222:223], v37 offset:22528
    v_lshlrev_b32 v228, 16, v99
    s_waitcnt vmcnt(19) lgkmcnt(8)
    v_mfma_f32_16x16x32_bf16 v[182:185], a[32:35], a[200:203], v[182:185]
    ds_read_b64_tr_b16 a[224:225], v36 offset:20480
    v_and_b32 v229, 0xffff0000, v99
    v_mfma_f32_16x16x32_bf16 v[186:189], a[36:39], a[200:203], v[186:189]
    ds_read_b64_tr_b16 a[226:227], v36 offset:22528
    buffer_load_dwordx4 a[88:91], v79, s[28:31], s65 offen offset:2048 sc1
    v_add_f32 v228, v228, v93
    v_mfma_f32_16x16x32_bf16 v[238:241], a[32:35], a[204:207], v[238:241]
    ds_read_b64_tr_b16 a[228:229], v38 offset:20480
    v_add_f32 v229, v229, v93
    v_mfma_f32_16x16x32_bf16 v[242:245], a[36:39], a[204:207], v[242:245]
    ds_read_b64_tr_b16 a[230:231], v38 offset:22528
    s_waitcnt lgkmcnt(8)
    v_mfma_f32_16x16x32_bf16 v[190:193], a[32:35], a[208:211], v[190:193]
    s_waitcnt vmcnt(11)
    s_barrier
    s_cmp_lg_u32 s48, 0
    s_cbranch_scc1 L_sig4
    s_atomic_add s36, s[28:29], s69
L_sig4:
    ds_read_b64_tr_b16 a[200:201], v31 offset:32768
    buffer_load_dwordx4 a[92:95], v79, s[28:31], s65 offen offset:3072 sc1
    v_mfma_f32_16x16x32_bf16 v[194:197], a[36:39], a[208:211], v[194:197]
    ds_read_b64_tr_b16 a[202:203], v31 offset:34816
    s_add_u32 s65, s65, 8192
    v_lshlrev_b32 v94, 16, v94
    v_mfma_f32_16x16x32_bf16 v[246:249], a[32:35], a[212:215], v[246:249]
    ds_read_b64_tr_b16 a[204:205], v33 offset:32768
    s_cmp_eq_u32 s65, 57344
    v_mfma_f32_16x16x32_bf16 v[250:253], a[36:39], a[212:215], v[250:253]
    ds_read_b64_tr_b16 a[206:207], v33 offset:34816
    s_waitcnt lgkmcnt(8)
    v_mfma_f32_16x16x32_bf16 v[182:185], a[40:43], a[216:219], v[182:185]
    ds_read_b64_tr_b16 a[208:209], v32 offset:32768
    s_cselect_b32 s65, 0, s65
    v_mfma_f32_16x16x32_bf16 v[186:189], a[44:47], a[216:219], v[186:189]
    ds_read_b64_tr_b16 a[210:211], v32 offset:34816
    buffer_load_dwordx4 a[96:99], v79, s[28:31], s65 offen offset:0 sc1
    v_lshlrev_b32 v230, 16, v100
    v_mfma_f32_16x16x32_bf16 v[238:241], a[40:43], a[220:223], v[238:241]
    ds_read_b64_tr_b16 a[212:213], v34 offset:32768
    v_and_b32 v231, 0xffff0000, v100
    v_mfma_f32_16x16x32_bf16 v[242:245], a[44:47], a[220:223], v[242:245]
    ds_read_b64_tr_b16 a[214:215], v34 offset:34816
    s_waitcnt lgkmcnt(8)
    v_mfma_f32_16x16x32_bf16 v[190:193], a[40:43], a[224:227], v[190:193]
    ds_read_b64_tr_b16 a[216:217], v31 offset:36864
    buffer_load_dwordx4 a[100:103], v79, s[28:31], s65 offen offset:1024 sc1
    v_mfma_f32_16x16x32_bf16 v[194:197], a[44:47], a[224:227], v[194:197]
    ds_read_b64_tr_b16 a[218:219], v31 offset:38912
    v_add_f32 v230, v230, v94
    v_mfma_f32_16x16x32_bf16 v[246:249], a[40:43], a[228:231], v[246:249]
    ds_read_b64_tr_b16 a[220:221], v33 offset:36864
    buffer_load_dwordx4 a[104:107], v79, s[28:31], s65 offen offset:2048 sc1
    v_mfma_f32_16x16x32_bf16 v[250:253], a[44:47], a[228:231], v[250:253]
    ds_read_b64_tr_b16 a[222:223], v33 offset:38912
    v_add_f32 v231, v231, v94
    s_waitcnt vmcnt(13) lgkmcnt(8)
    v_mfma_f32_16x16x32_bf16 v[182:185], a[48:51], a[200:203], v[182:185]
    ds_read_b64_tr_b16 a[224:225], v32 offset:36864
    v_lshlrev_b32 v232, 16, v101
    v_mfma_f32_16x16x32_bf16 v[186:189], a[52:55], a[200:203], v[186:189]
    ds_read_b64_tr_b16 a[226:227], v32 offset:38912
    v_and_b32 v233, 0xffff0000, v101
    v_mfma_f32_16x16x32_bf16 v[238:241], a[48:51], a[204:207], v[238:241]
    ds_read_b64_tr_b16 a[228:229], v34 offset:36864
    buffer_load_dwordx4 a[108:111], v79, s[28:31], s65 offen offset:3072 sc1
    v_mfma_f32_16x16x32_bf16 v[242:245], a[52:55], a[204:207], v[242:245]
    ds_read_b64_tr_b16 a[230:231], v34 offset:38912
    s_waitcnt lgkmcnt(8)
    v_mfma_f32_16x16x32_bf16 v[190:193], a[48:51], a[208:211], v[190:193]
    ds_read_b64_tr_b16 a[200:201], v31 offset:49152
    v_add_f32 v232, v232, v94
    v_mfma_f32_16x16x32_bf16 v[194:197], a[52:55], a[208:211], v[194:197]
    ds_read_b64_tr_b16 a[202:203], v31 offset:51200
    buffer_load_dwordx4 v60, s[24:27], s64 offen offset:1024 lds
    v_add_f32 v233, v233, v94
    v_mfma_f32_16x16x32_bf16 v[246:249], a[48:51], a[212:215], v[246:249]
    ds_read_b64_tr_b16 a[204:205], v33 offset:49152
    v_lshlrev_b32 v234, 16, v102
    v_mfma_f32_16x16x32_bf16 v[250:253], a[52:55], a[212:215], v[250:253]
    ds_read_b64_tr_b16 a[206:207], v33 offset:51200
    s_waitcnt vmcnt(13) lgkmcnt(8)
    v_mfma_f32_16x16x32_bf16 v[182:185], a[56:59], a[216:219], v[182:185]
    ds_read_b64_tr_b16 a[208:209], v32 offset:49152
    buffer_load_dwordx4 v61, s[24:27], s64 offen offset:2048 lds
    v_mfma_f32_16x16x32_bf16 v[186:189], a[60:63], a[216:219], v[186:189]
    ds_read_b64_tr_b16 a[210:211], v32 offset:51200
    v_and_b32 v235, 0xffff0000, v102
    v_mfma_f32_16x16x32_bf16 v[238:241], a[56:59], a[220:223], v[238:241]
    ds_read_b64_tr_b16 a[212:213], v34 offset:49152
    buffer_load_dwordx4 v62, s[24:27], s64 offen offset:3072 lds
    v_mfma_f32_16x16x32_bf16 v[242:245], a[60:63], a[220:223], v[242:245]
    ds_read_b64_tr_b16 a[214:215], v34 offset:51200
    s_waitcnt lgkmcnt(8)
    v_mfma_f32_16x16x32_bf16 v[190:193], a[56:59], a[224:227], v[190:193]
    ds_read_b64_tr_b16 a[216:217], v31 offset:53248
    s_add_u32 m0, s58, 16384
    v_mfma_f32_16x16x32_bf16 v[194:197], a[60:63], a[224:227], v[194:197]
    ds_read_b64_tr_b16 a[218:219], v31 offset:55296
    s_add_u32 s64, s64, 524288
    v_add_f32 v234, v234, v94
    v_mfma_f32_16x16x32_bf16 v[246:249], a[56:59], a[228:231], v[246:249]
    ds_read_b64_tr_b16 a[220:221], v33 offset:53248
    s_cmp_eq_u32 s64, 3670016
    v_mfma_f32_16x16x32_bf16 v[250:253], a[60:63], a[228:231], v[250:253]
    ds_read_b64_tr_b16 a[222:223], v33 offset:55296
    s_cselect_b32 s64, 0, s64
    buffer_load_dwordx4 v59, s[24:27], s64 offen lds
    v_add_f32 v235, v235, v94
    s_waitcnt vmcnt(14) lgkmcnt(8)
    v_mfma_f32_16x16x32_bf16 v[182:185], a[64:67], a[200:203], v[182:185]
    ds_read_b64_tr_b16 a[224:225], v32 offset:53248
    v_lshlrev_b32 v236, 16, v103
    v_mfma_f32_16x16x32_bf16 v[186:189], a[68:71], a[200:203], v[186:189]
    ds_read_b64_tr_b16 a[226:227], v32 offset:55296
    buffer_load_dwordx4 v60, s[24:27], s64 offen offset:1024 lds
    v_and_b32 v237, 0xffff0000, v103
    v_mfma_f32_16x16x32_bf16 v[238:241], a[64:67], a[204:207], v[238:241]
    ds_read_b64_tr_b16 a[228:229], v34 offset:53248
    v_add_f32 v236, v236, v94
    v_mfma_f32_16x16x32_bf16 v[242:245], a[68:71], a[204:207], v[242:245]
    ds_read_b64_tr_b16 a[230:231], v34 offset:55296
    s_waitcnt lgkmcnt(8)
    v_mfma_f32_16x16x32_bf16 v[190:193], a[64:67], a[208:211], v[190:193]
    s_barrier
    ds_read_b64_tr_b16 a[200:201], v35 offset:32768
    buffer_load_dwordx4 v61, s[24:27], s64 offen offset:2048 lds
    v_mfma_f32_16x16x32_bf16 v[194:197], a[68:71], a[208:211], v[194:197]
    ds_read_b64_tr_b16 a[202:203], v35 offset:34816
    v_add_f32 v237, v237, v94
    v_mfma_f32_16x16x32_bf16 v[246:249], a[64:67], a[212:215], v[246:249]
    ds_read_b64_tr_b16 a[204:205], v37 offset:32768
    v_mfma_f32_16x16x32_bf16 v[250:253], a[68:71], a[212:215], v[250:253]
    ds_read_b64_tr_b16 a[206:207], v37 offset:34816
    s_waitcnt vmcnt(14) lgkmcnt(8)
    v_mfma_f32_16x16x32_bf16 v[182:185], a[72:75], a[216:219], v[182:185]
    ds_read_b64_tr_b16 a[208:209], v36 offset:32768
    buffer_load_dwordx4 v62, s[24:27], s64 offen offset:3072 lds
    v_mfma_f32_16x16x32_bf16 v[186:189], a[76:79], a[216:219], v[186:189]
    ds_read_b64_tr_b16 a[210:211], v36 offset:34816
    s_add_u32 m0, s58, 65536
    v_mfma_f32_16x16x32_bf16 v[238:241], a[72:75], a[220:223], v[238:241]
    ds_read_b64_tr_b16 a[212:213], v38 offset:32768
    s_add_u32 s64, s64, 524288
    v_mfma_f32_16x16x32_bf16 v[242:245], a[76:79], a[220:223], v[242:245]
    ds_read_b64_tr_b16 a[214:215], v38 offset:34816
    s_waitcnt lgkmcnt(8)
    v_mfma_f32_16x16x32_bf16 v[190:193], a[72:75], a[224:227], v[190:193]
    ds_read_b64_tr_b16 a[216:217], v35 offset:36864
    s_cmp_eq_u32 s64, 3670016
    v_mfma_f32_16x16x32_bf16 v[194:197], a[76:79], a[224:227], v[194:197]
    ds_read_b64_tr_b16 a[218:219], v35 offset:38912
    s_cselect_b32 s64, 0, s64
    buffer_load_dwordx4 v59, s[24:27], s64 offen lds
    v_mfma_f32_16x16x32_bf16 v[246:249], a[72:75], a[228:231], v[246:249]
    ds_read_b64_tr_b16 a[220:221], v37 offset:36864
    v_mfma_f32_16x16x32_bf16 v[250:253], a[76:79], a[228:231], v[250:253]
    ds_read_b64_tr_b16 a[222:223], v37 offset:38912
    s_waitcnt vmcnt(14) lgkmcnt(8)
    v_mfma_f32_16x16x32_bf16 v[182:185], a[80:83], a[200:203], v[182:185]
    ds_read_b64_tr_b16 a[224:225], v36 offset:36864
    buffer_load_dwordx4 v60, s[24:27], s64 offen offset:1024 lds
    v_mfma_f32_16x16x32_bf16 v[186:189], a[84:87], a[200:203], v[186:189]
    ds_read_b64_tr_b16 a[226:227], v36 offset:38912
    v_mfma_f32_16x16x32_bf16 v[238:241], a[80:83], a[204:207], v[238:241]
    ds_read_b64_tr_b16 a[228:229], v38 offset:36864
    v_mfma_f32_16x16x32_bf16 v[242:245], a[84:87], a[204:207], v[242:245]
    ds_read_b64_tr_b16 a[230:231], v38 offset:38912
    s_waitcnt lgkmcnt(8)
    v_mfma_f32_16x16x32_bf16 v[190:193], a[80:83], a[208:211], v[190:193]
    ds_read_b64_tr_b16 a[200:201], v35 offset:49152
    buffer_load_dwordx4 v61, s[24:27], s64 offen offset:2048 lds
    v_mfma_f32_16x16x32_bf16 v[194:197], a[84:87], a[208:211], v[194:197]
    ds_read_b64_tr_b16 a[202:203], v35 offset:51200
    v_mfma_f32_16x16x32_bf16 v[246:249], a[80:83], a[212:215], v[246:249]
    ds_read_b64_tr_b16 a[204:205], v37 offset:49152
    v_mfma_f32_16x16x32_bf16 v[250:253], a[84:87], a[212:215], v[250:253]
    ds_read_b64_tr_b16 a[206:207], v37 offset:51200
    s_waitcnt vmcnt(14) lgkmcnt(8)
    v_mfma_f32_16x16x32_bf16 v[182:185], a[88:91], a[216:219], v[182:185]
    ds_read_b64_tr_b16 a[208:209], v36 offset:49152
L_pad3:
    s_cbranch_execz L_warm
    buffer_load_dwordx4 v62, s[24:27], s64 offen offset:3072 lds
    v_mfma_f32_16x16x32_bf16 v[186:189], a[92:95], a[216:219], v[186:189]
    ds_read_b64_tr_b16 a[210:211], v36 offset:51200
    s_add_u32 m0, s58, 81920
    v_mfma_f32_16x16x32_bf16 v[238:241], a[88:91], a[220:223], v[238:241]
    ds_read_b64_tr_b16 a[212:213], v38 offset:49152
    s_add_u32 s64, s64, 524288
    v_mfma_f32_16x16x32_bf16 v[242:245], a[92:95], a[220:223], v[242:245]
    ds_read_b64_tr_b16 a[214:215], v38 offset:51200
    s_waitcnt lgkmcnt(8)
    v_mfma_f32_16x16x32_bf16 v[190:193], a[88:91], a[224:227], v[190:193]
    ds_read_b64_tr_b16 a[216:217], v35 offset:53248
    s_cmp_eq_u32 s64, 3670016
    s_cselect_b32 s64, 0, s64
    buffer_load_dwordx4 v59, s[24:27], s64 offen lds
    v_mfma_f32_16x16x32_bf16 v[194:197], a[92:95], a[224:227], v[194:197]
    ds_read_b64_tr_b16 a[218:219], v35 offset:55296
    v_mfma_f32_16x16x32_bf16 v[246:249], a[88:91], a[228:231], v[246:249]
    ds_read_b64_tr_b16 a[220:221], v37 offset:53248
    buffer_load_dwordx4 v60, s[24:27], s64 offen offset:1024 lds
    v_mfma_f32_16x16x32_bf16 v[250:253], a[92:95], a[228:231], v[250:253]
    ds_read_b64_tr_b16 a[222:223], v37 offset:55296
    s_waitcnt vmcnt(15) lgkmcnt(8)
    v_mfma_f32_16x16x32_bf16 v[182:185], a[96:99], a[200:203], v[182:185]
    ds_read_b64_tr_b16 a[224:225], v36 offset:53248
    v_mfma_f32_16x16x32_bf16 v[186:189], a[100:103], a[200:203], v[186:189]
    ds_read_b64_tr_b16 a[226:227], v36 offset:55296
    v_mfma_f32_16x16x32_bf16 v[238:241], a[96:99], a[204:207], v[238:241]
    ds_read_b64_tr_b16 a[228:229], v38 offset:53248
    buffer_load_dwordx4 v61, s[24:27], s64 offen offset:2048 lds
    v_mfma_f32_16x16x32_bf16 v[242:245], a[100:103], a[204:207], v[242:245]
    ds_read_b64_tr_b16 a[230:231], v38 offset:55296
    s_waitcnt lgkmcnt(8)
    v_mfma_f32_16x16x32_bf16 v[190:193], a[96:99], a[208:211], v[190:193]
    ds_read_b64_tr_b16 a[200:201], v31 offset:0
    v_mfma_f32_16x16x32_bf16 v[194:197], a[100:103], a[208:211], v[194:197]
    ds_read_b64_tr_b16 a[202:203], v31 offset:2048
    v_mfma_f32_16x16x32_bf16 v[246:249], a[96:99], a[212:215], v[246:249]
    ds_read_b64_tr_b16 a[204:205], v33 offset:0
    buffer_load_dwordx4 v62, s[24:27], s64 offen offset:3072 lds
    v_mfma_f32_16x16x32_bf16 v[250:253], a[100:103], a[212:215], v[250:253]
    ds_read_b64_tr_b16 a[206:207], v33 offset:2048
    s_waitcnt vmcnt(15) lgkmcnt(8)
    v_mfma_f32_16x16x32_bf16 v[182:185], a[104:107], a[216:219], v[182:185]
    ds_read_b64_tr_b16 a[208:209], v32 offset:0
    s_add_u32 m0, s58, 32768
    v_mfma_f32_16x16x32_bf16 v[186:189], a[108:111], a[216:219], v[186:189]
    ds_read_b64_tr_b16 a[210:211], v32 offset:2048
    s_add_u32 s64, s64, 524288
    v_mfma_f32_16x16x32_bf16 v[238:241], a[104:107], a[220:223], v[238:241]
    ds_read_b64_tr_b16 a[212:213], v34 offset:0
    s_cmp_eq_u32 s64, 3670016
    v_mfma_f32_16x16x32_bf16 v[242:245], a[108:111], a[220:223], v[242:245]
    ds_read_b64_tr_b16 a[214:215], v34 offset:2048
    s_cselect_b32 s64, 0, s64
    buffer_load_dwordx4 v59, s[24:27], s64 offen lds
    s_waitcnt lgkmcnt(8)
    v_mfma_f32_16x16x32_bf16 v[190:193], a[104:107], a[224:227], v[190:193]
    ds_read_b64_tr_b16 a[216:217], v31 offset:4096
    v_mfma_f32_16x16x32_bf16 v[194:197], a[108:111], a[224:227], v[194:197]
    ds_read_b64_tr_b16 a[218:219], v31 offset:6144
    buffer_load_dwordx4 v60, s[24:27], s64 offen offset:1024 lds
    v_mfma_f32_16x16x32_bf16 v[246:249], a[104:107], a[228:231], v[246:249]
    ds_read_b64_tr_b16 a[220:221], v33 offset:4096
    v_mfma_f32_16x16x32_bf16 v[250:253], a[108:111], a[228:231], v[250:253]
    ds_read_b64_tr_b16 a[222:223], v33 offset:6144
    s_waitcnt lgkmcnt(8)
    v_mfma_f32_16x16x32_bf16 v[150:153], a[0:3], a[200:203], 0
    ds_read_b64_tr_b16 a[224:225], v32 offset:4096
    v_mfma_f32_16x16x32_bf16 v[154:157], a[4:7], a[200:203], 0
    ds_read_b64_tr_b16 a[226:227], v32 offset:6144
    buffer_load_dwordx4 v61, s[24:27], s64 offen offset:2048 lds
    v_mfma_f32_16x16x32_bf16 v[166:169], a[0:3], a[204:207], 0
    ds_read_b64_tr_b16 a[228:229], v34 offset:4096
    v_cvt_pk_bf16_f32 v182, v182, v183
    v_mfma_f32_16x16x32_bf16 v[170:173], a[4:7], a[204:207], 0
    ds_read_b64_tr_b16 a[230:231], v34 offset:6144
    v_cvt_pk_bf16_f32 v183, v184, v185
    v_cvt_pk_bf16_f32 v184, v186, v187
    s_waitcnt lgkmcnt(8)
    v_mfma_f32_16x16x32_bf16 v[158:161], a[0:3], a[208:211], 0
    s_waitcnt vmcnt(15)
    s_barrier
    ds_read_b64_tr_b16 a[200:201], v39 offset:0
    buffer_load_dwordx4 v62, s[24:27], s64 offen offset:3072 lds
    v_mfma_f32_16x16x32_bf16 v[162:165], a[4:7], a[208:211], 0
    ds_read_b64_tr_b16 a[202:203], v39 offset:2048
    s_add_u32 m0, s58, 49152
    v_cvt_pk_bf16_f32 v185, v188, v189
    buffer_store_dwordx4 v[182:185], v21, s[28:31], 0 offen offset:0 sc1
    v_cvt_pk_bf16_f32 v190, v190, v191
    v_cvt_pk_bf16_f32 v191, v192, v193
    v_cvt_pk_bf16_f32 v192, v194, v195
    v_mfma_f32_16x16x32_bf16 v[174:177], a[0:3], a[212:215], 0
    ds_read_b64_tr_b16 a[204:205], v41 offset:0
    s_add_u32 s66, s66, 1
    v_mfma_f32_16x16x32_bf16 v[178:181], a[4:7], a[212:215], 0
    ds_read_b64_tr_b16 a[206:207], v41 offset:2048
    v_cvt_pk_bf16_f32 v193, v196, v197
    buffer_store_dwordx4 v[190:193], v21, s[28:31], 0 offen offset:1024 sc1
    v_cvt_pk_bf16_f32 v238, v238, v239
    v_cvt_pk_bf16_f32 v239, v240, v241
    v_cvt_pk_bf16_f32 v240, v242, v243
    s_waitcnt lgkmcnt(8)
    v_mfma_f32_16x16x32_bf16 v[150:153], a[8:11], a[216:219], v[150:153]
    ds_read_b64_tr_b16 a[208:209], v40 offset:0
    s_and_b32 s66, s66, 3
    v_mfma_f32_16x16x32_bf16 v[154:157], a[12:15], a[216:219], v[154:157]
    ds_read_b64_tr_b16 a[210:211], v40 offset:2048
    s_mul_i32 s61, s66, 100352
    buffer_load_dwordx4 v63, s[16:19], s61 offen lds
    v_cvt_pk_bf16_f32 v241, v244, v245
    buffer_store_dwordx4 v[238:241], v21, s[28:31], 0 offen offset:2048 sc1
    v_cvt_pk_bf16_f32 v246, v246, v247
    v_cvt_pk_bf16_f32 v247, v248, v249
    v_cvt_pk_bf16_f32 v248, v250, v251
    v_mfma_f32_16x16x32_bf16 v[166:169], a[8:11], a[220:223], v[166:169]
    ds_read_b64_tr_b16 a[212:213], v42 offset:0
    v_cvt_pk_bf16_f32 v249, v252, v253
    v_mfma_f32_16x16x32_bf16 v[170:173], a[12:15], a[220:223], v[170:173]
    ds_read_b64_tr_b16 a[214:215], v42 offset:2048
    s_waitcnt lgkmcnt(8)
    v_mfma_f32_16x16x32_bf16 v[158:161], a[8:11], a[224:227], v[158:161]
    ds_read_b64_tr_b16 a[216:217], v39 offset:4096
    buffer_load_dwordx4 v64, s[16:19], s61 offen offset:1024 lds
    v_mfma_f32_16x16x32_bf16 v[162:165], a[12:15], a[224:227], v[162:165]
    ds_read_b64_tr_b16 a[218:219], v39 offset:6144
    s_add_u32 s61, s61, 48128
    buffer_store_dwordx4 v[246:249], v21, s[28:31], 0 offen offset:3072 sc1
    v_mfma_f32_16x16x32_bf16 v[174:177], a[8:11], a[228:231], v[174:177]
    ds_read_b64_tr_b16 a[220:221], v41 offset:4096
    v_mfma_f32_16x16x32_bf16 v[178:181], a[12:15], a[228:231], v[178:181]
    ds_read_b64_tr_b16 a[222:223], v41 offset:6144
    s_waitcnt lgkmcnt(8)
    v_mfma_f32_16x16x32_bf16 v[150:153], a[16:19], a[200:203], v[150:153]
    ds_read_b64_tr_b16 a[224:225], v40 offset:4096
    buffer_load_dwordx4 v63, s[16:19], s61 offen offset:2048 lds
    v_mfma_f32_16x16x32_bf16 v[154:157], a[20:23], a[200:203], v[154:157]
    ds_read_b64_tr_b16 a[226:227], v40 offset:6144
    v_mfma_f32_16x16x32_bf16 v[166:169], a[16:19], a[204:207], v[166:169]
    ds_read_b64_tr_b16 a[228:229], v42 offset:4096
    v_mfma_f32_16x16x32_bf16 v[170:173], a[20:23], a[204:207], v[170:173]
    ds_read_b64_tr_b16 a[230:231], v42 offset:6144
    s_waitcnt lgkmcnt(8)
    v_mfma_f32_16x16x32_bf16 v[158:161], a[16:19], a[208:211], v[158:161]
    s_mov_b32 s14, 0
    s_load_dword s14, s[28:29], s39
    ds_read_b64_tr_b16 a[200:201], v39 offset:16384
    buffer_load_dwordx4 v64, s[16:19], s61 offen offset:3072 lds
    v_mfma_f32_16x16x32_bf16 v[162:165], a[20:23], a[208:211], v[162:165]
    ds_read_b64_tr_b16 a[202:203], v39 offset:18432
    s_add_u32 m0, s58, 98304
    v_mfma_f32_16x16x32_bf16 v[174:177], a[16:19], a[212:215], v[174:177]
    ds_read_b64_tr_b16 a[204:205], v41 offset:16384
    s_add_u32 s66, s66, 1
    v_mfma_f32_16x16x32_bf16 v[178:181], a[20:23], a[212:215], v[178:181]
    ds_read_b64_tr_b16 a[206:207], v41 offset:18432
    s_waitcnt lgkmcnt(8)
    v_mfma_f32_16x16x32_bf16 v[150:153], a[24:27], a[216:219], v[150:153]
    ds_read_b64_tr_b16 a[208:209], v40 offset:16384
    s_and_b32 s66, s66, 3
    s_mul_i32 s61, s66, 100352
    buffer_load_dwordx4 v63, s[16:19], s61 offen lds
    v_mfma_f32_16x16x32_bf16 v[154:157], a[28:31], a[216:219], v[154:157]
    ds_read_b64_tr_b16 a[210:211], v40 offset:18432
    v_mfma_f32_16x16x32_bf16 v[166:169], a[24:27], a[220:223], v[166:169]
    ds_read_b64_tr_b16 a[212:213], v42 offset:16384
    buffer_load_dwordx4 v64, s[16:19], s61 offen offset:1024 lds
    v_mfma_f32_16x16x32_bf16 v[170:173], a[28:31], a[220:223], v[170:173]
    ds_read_b64_tr_b16 a[214:215], v42 offset:18432
    s_waitcnt lgkmcnt(8)
    v_mfma_f32_16x16x32_bf16 v[158:161], a[24:27], a[224:227], v[158:161]
    ds_read_b64_tr_b16 a[216:217], v39 offset:20480
    s_add_u32 s61, s61, 48128
    v_mfma_f32_16x16x32_bf16 v[162:165], a[28:31], a[224:227], v[162:165]
    ds_read_b64_tr_b16 a[218:219], v39 offset:22528
    v_mfma_f32_16x16x32_bf16 v[174:177], a[24:27], a[228:231], v[174:177]
    ds_read_b64_tr_b16 a[220:221], v41 offset:20480
    buffer_load_dwordx4 v63, s[16:19], s61 offen offset:2048 lds
    v_mfma_f32_16x16x32_bf16 v[178:181], a[28:31], a[228:231], v[178:181]
    ds_read_b64_tr_b16 a[222:223], v41 offset:22528
    s_waitcnt lgkmcnt(8)
    v_mfma_f32_16x16x32_bf16 v[150:153], a[32:35], a[200:203], v[150:153]
    ds_read_b64_tr_b16 a[224:225], v40 offset:20480
    v_mfma_f32_16x16x32_bf16 v[154:157], a[36:39], a[200:203], v[154:157]
    ds_read_b64_tr_b16 a[226:227], v40 offset:22528
    v_mfma_f32_16x16x32_bf16 v[166:169], a[32:35], a[204:207], v[166:169]
    ds_read_b64_tr_b16 a[228:229], v42 offset:20480
    buffer_load_dwordx4 v64, s[16:19], s61 offen offset:3072 lds
    v_mfma_f32_16x16x32_bf16 v[170:173], a[36:39], a[204:207], v[170:173]
    ds_read_b64_tr_b16 a[230:231], v42 offset:22528
    s_waitcnt lgkmcnt(8)
    v_mfma_f32_16x16x32_bf16 v[158:161], a[32:35], a[208:211], v[158:161]
    s_waitcnt vmcnt(20)
    s_barrier
    ds_read_b64_tr_b16 a[200:201], v31 offset:16384
    s_add_u32 m0, s58, 114688
    v_mfma_f32_16x16x32_bf16 v[162:165], a[36:39], a[208:211], v[162:165]
    ds_read_b64_tr_b16 a[202:203], v31 offset:18432
    s_add_u32 s66, s66, 1
    v_mfma_f32_16x16x32_bf16 v[174:177], a[32:35], a[212:215], v[174:177]
    ds_read_b64_tr_b16 a[204:205], v33 offset:16384
    s_and_b32 s66, s66, 3
    v_mfma_f32_16x16x32_bf16 v[178:181], a[36:39], a[212:215], v[178:181]
    ds_read_b64_tr_b16 a[206:207], v33 offset:18432
    s_mul_i32 s61, s66, 100352
    buffer_load_dwordx4 v63, s[16:19], s61 offen lds
    s_waitcnt lgkmcnt(8)
    v_mfma_f32_16x16x32_bf16 v[150:153], a[40:43], a[216:219], v[150:153]
    ds_read_b64_tr_b16 a[208:209], v32 offset:16384
    v_mfma_f32_16x16x32_bf16 v[154:157], a[44:47], a[216:219], v[154:157]
    ds_read_b64_tr_b16 a[210:211], v32 offset:18432
    buffer_load_dwordx4 v64, s[16:19], s61 offen offset:1024 lds
    v_mfma_f32_16x16x32_bf16 v[166:169], a[40:43], a[220:223], v[166:169]
    ds_read_b64_tr_b16 a[212:213], v34 offset:16384
    s_add_u32 s61, s61, 48128
    v_mfma_f32_16x16x32_bf16 v[170:173], a[44:47], a[220:223], v[170:173]
    ds_read_b64_tr_b16 a[214:215], v34 offset:18432
    s_waitcnt lgkmcnt(8)
    v_mfma_f32_16x16x32_bf16 v[158:161], a[40:43], a[224:227], v[158:161]
    ds_read_b64_tr_b16 a[216:217], v31 offset:20480
    v_mfma_f32_16x16x32_bf16 v[162:165], a[44:47], a[224:227], v[162:165]
    ds_read_b64_tr_b16 a[218:219], v31 offset:22528
    buffer_load_dwordx4 v63, s[16:19], s61 offen offset:2048 lds
    v_mfma_f32_16x16x32_bf16 v[174:177], a[40:43], a[228:231], v[174:177]
    ds_read_b64_tr_b16 a[220:221], v33 offset:20480
    v_mfma_f32_16x16x32_bf16 v[178:181], a[44:47], a[228:231], v[178:181]
    ds_read_b64_tr_b16 a[222:223], v33 offset:22528
    s_waitcnt lgkmcnt(8)
    v_mfma_f32_16x16x32_bf16 v[150:153], a[48:51], a[200:203], v[150:153]
    ds_read_b64_tr_b16 a[224:225], v32 offset:20480
    v_mfma_f32_16x16x32_bf16 v[154:157], a[52:55], a[200:203], v[154:157]
    ds_read_b64_tr_b16 a[226:227], v32 offset:22528
    buffer_load_dwordx4 v64, s[16:19], s61 offen offset:3072 lds
    v_mfma_f32_16x16x32_bf16 v[166:169], a[48:51], a[204:207], v[166:169]
    ds_read_b64_tr_b16 a[228:229], v34 offset:20480
    v_mfma_f32_16x16x32_bf16 v[170:173], a[52:55], a[204:207], v[170:173]
    ds_read_b64_tr_b16 a[230:231], v34 offset:22528
    s_waitcnt lgkmcnt(8)
    v_mfma_f32_16x16x32_bf16 v[158:161], a[48:51], a[208:211], v[158:161]
    s_waitcnt vmcnt(10)
    s_atomic_add s36, s[28:29], s55
    ds_read_b64_tr_b16 a[200:201], v35 offset:0
    v_mfma_f32_16x16x32_bf16 v[162:165], a[52:55], a[208:211], v[162:165]
    ds_read_b64_tr_b16 a[202:203], v35 offset:2048
    v_mfma_f32_16x16x32_bf16 v[174:177], a[48:51], a[212:215], v[174:177]
    ds_read_b64_tr_b16 a[204:205], v37 offset:0
    v_mfma_f32_16x16x32_bf16 v[178:181], a[52:55], a[212:215], v[178:181]
    ds_read_b64_tr_b16 a[206:207], v37 offset:2048
    s_waitcnt lgkmcnt(8)
    v_mfma_f32_16x16x32_bf16 v[150:153], a[56:59], a[216:219], v[150:153]
    ds_read_b64_tr_b16 a[208:209], v36 offset:0
    v_mfma_f32_16x16x32_bf16 v[154:157], a[60:63], a[216:219], v[154:157]
    ds_read_b64_tr_b16 a[210:211], v36 offset:2048
    v_mfma_f32_16x16x32_bf16 v[166:169], a[56:59], a[220:223], v[166:169]
    ds_read_b64_tr_b16 a[212:213], v38 offset:0
    v_mfma_f32_16x16x32_bf16 v[170:173], a[60:63], a[220:223], v[170:173]
    ds_read_b64_tr_b16 a[214:215], v38 offset:2048
    s_waitcnt lgkmcnt(8)
    v_mfma_f32_16x16x32_bf16 v[158:161], a[56:59], a[224:227], v[158:161]
    ds_read_b64_tr_b16 a[216:217], v35 offset:4096
    v_mfma_f32_16x16x32_bf16 v[162:165], a[60:63], a[224:227], v[162:165]
    ds_read_b64_tr_b16 a[218:219], v35 offset:6144
    v_mfma_f32_16x16x32_bf16 v[174:177], a[56:59], a[228:231], v[174:177]
    ds_read_b64_tr_b16 a[220:221], v37 offset:4096
    v_mfma_f32_16x16x32_bf16 v[178:181], a[60:63], a[228:231], v[178:181]
    ds_read_b64_tr_b16 a[222:223], v37 offset:6144
    s_waitcnt lgkmcnt(8)
    v_mfma_f32_16x16x32_bf16 v[150:153], a[64:67], a[200:203], v[150:153]
    s_cmp_ge_u32 s14, 8
    s_cbranch_scc0 L_pollin6
L_pollok6:
    ds_read_b64_tr_b16 a[224:225], v36 offset:4096
    s_add_u32 m0, s58, 0
    s_add_u32 s51, s51, 1
    s_and_b32 s51, s51, 3
    s_lshl_b32 s61, s51, 12
    buffer_load_dwordx4 v65, s[28:31], s61 offen sc1 lds
    v_mfma_f32_16x16x32_bf16 v[154:157], a[68:71], a[200:203], v[154:157]
    ds_read_b64_tr_b16 a[226:227], v36 offset:6144
    v_mfma_f32_16x16x32_bf16 v[166:169], a[64:67], a[204:207], v[166:169]
    ds_read_b64_tr_b16 a[228:229], v38 offset:4096
    buffer_load_dwordx4 v66, s[28:31], s61 offen offset:1024 sc1 lds
    v_mfma_f32_16x16x32_bf16 v[170:173], a[68:71], a[204:207], v[170:173]
    ds_read_b64_tr_b16 a[230:231], v38 offset:6144
    s_waitcnt lgkmcnt(8)
    v_mfma_f32_16x16x32_bf16 v[158:161], a[64:67], a[208:211], v[158:161]
    s_barrier
    ds_read_b64_tr_b16 a[200:201], v35 offset:16384
    buffer_load_dwordx4 v65, s[28:31], s61 offen offset:2048 sc1 lds
    v_mfma_f32_16x16x32_bf16 v[162:165], a[68:71], a[208:211], v[162:165]
    ds_read_b64_tr_b16 a[202:203], v35 offset:18432
    v_mfma_f32_16x16x32_bf16 v[174:177], a[64:67], a[212:215], v[174:177]
    ds_read_b64_tr_b16 a[204:205], v37 offset:16384
    v_mfma_f32_16x16x32_bf16 v[178:181], a[68:71], a[212:215], v[178:181]
    ds_read_b64_tr_b16 a[206:207], v37 offset:18432
    s_waitcnt lgkmcnt(8)
    v_mfma_f32_16x16x32_bf16 v[150:153], a[72:75], a[216:219], v[150:153]
    ds_read_b64_tr_b16 a[208:209], v36 offset:16384
    buffer_load_dwordx4 v66, s[28:31], s61 offen offset:3072 sc1 lds
    v_mfma_f32_16x16x32_bf16 v[154:157], a[76:79], a[216:219], v[154:157]
    ds_read_b64_tr_b16 a[210:211], v36 offset:18432
    s_add_u32 m0, s58, 131072
    v_mfma_f32_16x16x32_bf16 v[166:169], a[72:75], a[220:223], v[166:169]
    ds_read_b64_tr_b16 a[212:213], v38 offset:16384
    s_add_u32 s51, s51, 1
    v_mfma_f32_16x16x32_bf16 v[170:173], a[76:79], a[220:223], v[170:173]
    ds_read_b64_tr_b16 a[214:215], v38 offset:18432
    s_waitcnt lgkmcnt(8)
    v_mfma_f32_16x16x32_bf16 v[158:161], a[72:75], a[224:227], v[158:161]
    ds_read_b64_tr_b16 a[216:217], v35 offset:20480
    s_and_b32 s51, s51, 3
    s_lshl_b32 s61, s51, 12
    buffer_load_dwordx4 v65, s[28:31], s61 offen sc1 lds
    v_mfma_f32_16x16x32_bf16 v[162:165], a[76:79], a[224:227], v[162:165]
    ds_read_b64_tr_b16 a[218:219], v35 offset:22528
    v_mfma_f32_16x16x32_bf16 v[174:177], a[72:75], a[228:231], v[174:177]
    ds_read_b64_tr_b16 a[220:221], v37 offset:20480
    buffer_load_dwordx4 v66, s[28:31], s61 offen offset:1024 sc1 lds
    v_mfma_f32_16x16x32_bf16 v[178:181], a[76:79], a[228:231], v[178:181]
    ds_read_b64_tr_b16 a[222:223], v37 offset:22528
    s_waitcnt lgkmcnt(8)
    v_mfma_f32_16x16x32_bf16 v[150:153], a[80:83], a[200:203], v[150:153]
    ds_read_b64_tr_b16 a[224:225], v36 offset:20480
    v_mfma_f32_16x16x32_bf16 v[154:157], a[84:87], a[200:203], v[154:157]
    ds_read_b64_tr_b16 a[226:227], v36 offset:22528
    buffer_load_dwordx4 v65, s[28:31], s61 offen offset:2048 sc1 lds
    v_mfma_f32_16x16x32_bf16 v[166:169], a[80:83], a[204:207], v[166:169]
    ds_read_b64_tr_b16 a[228:229], v38 offset:20480
    v_mfma_f32_16x16x32_bf16 v[170:173], a[84:87], a[204:207], v[170:173]
    ds_read_b64_tr_b16 a[230:231], v38 offset:22528
    s_waitcnt lgkmcnt(8)
    v_mfma_f32_16x16x32_bf16 v[158:161], a[80:83], a[208:211], v[158:161]
    s_barrier
    ds_read_b64_tr_b16 a[200:201], v31 offset:32768
    buffer_load_dwordx4 v66, s[28:31], s61 offen offset:3072 sc1 lds
    v_mfma_f32_16x16x32_bf16 v[162:165], a[84:87], a[208:211], v[162:165]
    ds_read_b64_tr_b16 a[202:203], v31 offset:34816
    s_add_u32 m0, s58, 147456
    v_mfma_f32_16x16x32_bf16 v[174:177], a[80:83], a[212:215], v[174:177]
    ds_read_b64_tr_b16 a[204:205], v33 offset:32768
    s_add_u32 s51, s51, 1
    v_mfma_f32_16x16x32_bf16 v[178:181], a[84:87], a[212:215], v[178:181]
    ds_read_b64_tr_b16 a[206:207], v33 offset:34816
    s_waitcnt lgkmcnt(8)
    v_mfma_f32_16x16x32_bf16 v[150:153], a[88:91], a[216:219], v[150:153]
    ds_read_b64_tr_b16 a[208:209], v32 offset:32768
    s_and_b32 s51, s51, 3
    s_lshl_b32 s61, s51, 12
    buffer_load_dwordx4 v65, s[28:31], s61 offen sc1 lds
    v_mfma_f32_16x16x32_bf16 v[154:157], a[92:95], a[216:219], v[154:157]
    ds_read_b64_tr_b16 a[210:211], v32 offset:34816
    v_mfma_f32_16x16x32_bf16 v[166:169], a[88:91], a[220:223], v[166:169]
    ds_read_b64_tr_b16 a[212:213], v34 offset:32768
    buffer_load_dwordx4 v66, s[28:31], s61 offen offset:1024 sc1 lds
    v_mfma_f32_16x16x32_bf16 v[170:173], a[92:95], a[220:223], v[170:173]
    ds_read_b64_tr_b16 a[214:215], v34 offset:34816
    s_waitcnt lgkmcnt(8)
    v_mfma_f32_16x16x32_bf16 v[158:161], a[88:91], a[224:227], v[158:161]
    ds_read_b64_tr_b16 a[216:217], v31 offset:36864
    v_mfma_f32_16x16x32_bf16 v[162:165], a[92:95], a[224:227], v[162:165]
    ds_read_b64_tr_b16 a[218:219], v31 offset:38912
    buffer_load_dwordx4 v65, s[28:31], s61 offen offset:2048 sc1 lds
    v_mfma_f32_16x16x32_bf16 v[174:177], a[88:91], a[228:231], v[174:177]
    ds_read_b64_tr_b16 a[220:221], v33 offset:36864
    v_mfma_f32_16x16x32_bf16 v[178:181], a[92:95], a[228:231], v[178:181]
    ds_read_b64_tr_b16 a[222:223], v33 offset:38912
    s_waitcnt lgkmcnt(8)
    v_mfma_f32_16x16x32_bf16 v[150:153], a[96:99], a[200:203], v[150:153]
    ds_read_b64_tr_b16 a[224:225], v32 offset:36864
    buffer_load_dwordx4 v66, s[28:31], s61 offen offset:3072 sc1 lds
    v_mfma_f32_16x16x32_bf16 v[154:157], a[100:103], a[200:203], v[154:157]
    ds_read_b64_tr_b16 a[226:227], v32 offset:38912
    s_add_u32 m0, s58, 16384
    v_mfma_f32_16x16x32_bf16 v[166:169], a[96:99], a[204:207], v[166:169]
    ds_read_b64_tr_b16 a[228:229], v34 offset:36864
    s_add_u32 s66, s66, 1
    v_mfma_f32_16x16x32_bf16 v[170:173], a[100:103], a[204:207], v[170:173]
    ds_read_b64_tr_b16 a[230:231], v34 offset:38912
    s_waitcnt lgkmcnt(8)
    v_mfma_f32_16x16x32_bf16 v[158:161], a[96:99], a[208:211], v[158:161]
    s_waitcnt vmcnt(8)
    s_barrier
    s_xor_b32 s55, s55, 1024
    s_mov_b32 s14, 0
    s_load_dword s14, s[28:29], s55
    ds_read_b64_tr_b16 v[198:199], v43 offset:49152
    ds_read_b64_tr_b16 v[200:201], v43 offset:53248
    s_and_b32 s66, s66, 3
    s_mul_i32 s61, s66, 100352
    buffer_load_dwordx4 v63, s[16:19], s61 offen lds
    v_mfma_f32_16x16x32_bf16 v[162:165], a[100:103], a[208:211], v[162:165]
    ds_read_b64_tr_b16 v[202:203], v44 offset:49152
    v_mfma_f32_16x16x32_bf16 v[174:177], a[96:99], a[212:215], v[174:177]
    ds_read_b64_tr_b16 v[204:205], v44 offset:53248
    buffer_load_dwordx4 v64, s[16:19], s61 offen offset:1024 lds
    v_mfma_f32_16x16x32_bf16 v[178:181], a[100:103], a[212:215], v[178:181]
    ds_read_b128 a[200:203], v47 offset:0
    s_waitcnt lgkmcnt(9)
    v_mfma_f32_16x16x32_bf16 v[150:153], a[104:107], a[216:219], v[150:153]
    ds_read_b128 a[204:207], v48 offset:0
    s_add_u32 s61, s61, 48128
    v_mfma_f32_16x16x32_bf16 v[154:157], a[108:111], a[216:219], v[154:157]
    ds_read_b128 a[208:211], v47 offset:1024
    buffer_load_dwordx4 v63, s[16:19], s61 offen offset:2048 lds
    v_mfma_f32_16x16x32_bf16 v[166:169], a[104:107], a[220:223], v[166:169]
    ds_read_b128 a[212:215], v48 offset:1024
    v_mfma_f32_16x16x32_bf16 v[170:173], a[108:111], a[220:223], v[170:173]
    s_waitcnt lgkmcnt(8)
    v_mfma_f32_16x16x32_bf16 v[158:161], a[104:107], a[224:227], v[158:161]
    ds_read_b64_tr_b16 v[206:207], v43 offset:51200
    ds_read_b64_tr_b16 v[208:209], v43 offset:55296
    v_mfma_f32_16x16x32_bf16 v[162:165], a[108:111], a[224:227], v[162:165]
    ds_read_b64_tr_b16 v[210:211], v44 offset:51200
    buffer_load_dwordx4 v64, s[16:19], s61 offen offset:3072 lds
    v_mfma_f32_16x16x32_bf16 v[174:177], a[104:107], a[228:231], v[174:177]
    ds_read_b64_tr_b16 v[212:213], v44 offset:55296
    s_add_u32 m0, s58, 65536
    v_mfma_f32_16x16x32_bf16 v[178:181], a[108:111], a[228:231], v[178:181]
    ds_read_b128 a[216:219], v47 offset:2048
    s_waitcnt lgkmcnt(7)
    v_mfma_f32_16x16x32_bf16 v[150:153], v[198:201], a[200:203], v[150:153]
    ds_read_b128 a[220:223], v48 offset:2048
    s_add_u32 s51, s51, 1
    s_and_b32 s51, s51, 3
    s_lshl_b32 s61, s51, 12
    buffer_load_dwordx4 v65, s[28:31], s61 offen sc1 lds
    v_mfma_f32_16x16x32_bf16 v[154:157], v[202:205], a[200:203], v[154:157]
    ds_read_b128 a[224:227], v47 offset:3072
    v_mfma_f32_16x16x32_bf16 v[166:169], v[198:201], a[204:207], v[166:169]
    ds_read_b128 a[228:231], v48 offset:3072
    buffer_load_dwordx4 v66, s[28:31], s61 offen offset:1024 sc1 lds
    v_mfma_f32_16x16x32_bf16 v[170:173], v[202:205], a[204:207], v[170:173]
    s_waitcnt lgkmcnt(8)
    v_mfma_f32_16x16x32_bf16 v[158:161], v[198:201], a[208:211], v[158:161]
    s_waitcnt vmcnt(10)
    s_barrier
    ds_read_b64_tr_b16 v[214:215], v45 offset:32768
    ds_read_b64_tr_b16 v[216:217], v45 offset:36864
    v_mfma_f32_16x16x32_bf16 v[162:165], v[202:205], a[208:211], v[162:165]
    ds_read_b64_tr_b16 v[218:219], v46 offset:32768
    buffer_load_dwordx4 v65, s[28:31], s61 offen offset:2048 sc1 lds
    v_mfma_f32_16x16x32_bf16 v[174:177], v[198:201], a[212:215], v[174:177]
    ds_read_b64_tr_b16 v[220:221], v46 offset:36864
    v_mfma_f32_16x16x32_bf16 v[178:181], v[202:205], a[212:215], v[178:181]
    ds_read_b128 a[200:203], v51 offset:0
    s_waitcnt lgkmcnt(7)
    v_mfma_f32_16x16x32_bf16 v[150:153], v[206:209], a[216:219], v[150:153]
    ds_read_b128 a[204:207], v52 offset:0
    buffer_load_dwordx4 v66, s[28:31], s61 offen offset:3072 sc1 lds
    v_mfma_f32_16x16x32_bf16 v[154:157], v[210:213], a[216:219], v[154:157]
    ds_read_b128 a[208:211], v51 offset:1024
    v_mfma_f32_16x16x32_bf16 v[166:169], v[206:209], a[220:223], v[166:169]
    ds_read_b128 a[212:215], v52 offset:1024
    v_mfma_f32_16x16x32_bf16 v[170:173], v[210:213], a[220:223], v[170:173]
    s_waitcnt lgkmcnt(8)
    v_mfma_f32_16x16x32_bf16 v[158:161], v[206:209], a[224:227], v[158:161]
    s_cmp_ge_u32 s14, 1
    s_cbranch_scc0 L_pollin7
L_pollok7:
    v_xor_b32 v21, 131072, v21
    ds_read_b64_tr_b16 v[198:199], v45 offset:34816
    ds_read_b64_tr_b16 v[200:201], v45 offset:38912
    buffer_load_dwordx4 v[246:249], v21, s[28:31], 0 offen offset:2048 sc1
    v_mfma_f32_16x16x32_bf16 v[162:165], v[210:213], a[224:227], v[162:165]
    ds_read_b64_tr_b16 v[202:203], v46 offset:34816
    buffer_load_dwordx4 v[250:253], v21, s[28:31], 0 offen offset:3072 sc1
    v_mfma_f32_16x16x32_bf16 v[174:177], v[206:209], a[228:231], v[174:177]
    ds_read_b64_tr_b16 v[204:205], v46 offset:38912
    v_mfma_f32_16x16x32_bf16 v[178:181], v[210:213], a[228:231], v[178:181]
    ds_read_b128 a[216:219], v51 offset:2048
    s_waitcnt lgkmcnt(7)
    v_mfma_f32_16x16x32_bf16 v[150:153], v[214:217], a[200:203], v[150:153]
    ds_read_b128 a[220:223], v52 offset:2048
    buffer_load_dwordx4 v[238:241], v21, s[28:31], 0 offen offset:0 sc1
    v_mfma_f32_16x16x32_bf16 v[154:157], v[218:221], a[200:203], v[154:157]
    ds_read_b128 a[224:227], v51 offset:3072
    buffer_load_dwordx4 v[242:245], v21, s[28:31], 0 offen offset:1024 sc1
    v_mfma_f32_16x16x32_bf16 v[166:169], v[214:217], a[204:207], v[166:169]
    ds_read_b128 a[228:231], v52 offset:3072
    v_mfma_f32_16x16x32_bf16 v[170:173], v[218:221], a[204:207], v[170:173]
    s_waitcnt lgkmcnt(8)
    v_mfma_f32_16x16x32_bf16 v[158:161], v[214:217], a[208:211], v[158:161]
    s_waitcnt vmcnt(12)
    s_barrier
    ds_read_b64_tr_b16 v[206:207], v45 offset:49152
    ds_read_b64_tr_b16 v[208:209], v45 offset:53248
    v_mfma_f32_16x16x32_bf16 v[162:165], v[218:221], a[208:211], v[162:165]
    ds_read_b64_tr_b16 v[210:211], v46 offset:49152
    v_mfma_f32_16x16x32_bf16 v[174:177], v[214:217], a[212:215], v[174:177]
    ds_read_b64_tr_b16 v[212:213], v46 offset:53248
    v_mfma_f32_16x16x32_bf16 v[178:181], v[218:221], a[212:215], v[178:181]
    ds_read_b128 a[200:203], v51 offset:16384
    s_waitcnt lgkmcnt(7)
    v_mfma_f32_16x16x32_bf16 v[150:153], v[198:201], a[216:219], v[150:153]
    ds_read_b128 a[204:207], v52 offset:16384
    v_mfma_f32_16x16x32_bf16 v[154:157], v[202:205], a[216:219], v[154:157]
    ds_read_b128 a[208:211], v51 offset:17408
    v_mfma_f32_16x16x32_bf16 v[166:169], v[198:201], a[220:223], v[166:169]
    ds_read_b128 a[212:215], v52 offset:17408
    v_mfma_f32_16x16x32_bf16 v[170:173], v[202:205], a[220:223], v[170:173]
    s_waitcnt lgkmcnt(8)
    v_mfma_f32_16x16x32_bf16 v[158:161], v[198:201], a[224:227], v[158:161]
    ds_read_b64_tr_b16 v[214:215], v45 offset:51200
    ds_read_b64_tr_b16 v[216:217], v45 offset:55296
    v_mfma_f32_16x16x32_bf16 v[162:165], v[202:205], a[224:227], v[162:165]
    ds_read_b64_tr_b16 v[218:219], v46 offset:51200
    v_mfma_f32_16x16x32_bf16 v[174:177], v[198:201], a[228:231], v[174:177]
    ds_read_b64_tr_b16 v[220:221], v46 offset:55296
    v_mfma_f32_16x16x32_bf16 v[178:181], v[202:205], a[228:231], v[178:181]
    ds_read_b128 a[216:219], v51 offset:18432
    s_waitcnt lgkmcnt(7)
    v_mfma_f32_16x16x32_bf16 v[150:153], v[206:209], a[200:203], v[150:153]
    ds_read_b128 a[220:223], v52 offset:18432
    v_mfma_f32_16x16x32_bf16 v[154:157], v[210:213], a[200:203], v[154:157]
    ds_read_b128 a[224:227], v51 offset:19456
    v_mfma_f32_16x16x32_bf16 v[166:169], v[206:209], a[204:207], v[166:169]
    ds_read_b128 a[228:231], v52 offset:19456
    v_mfma_f32_16x16x32_bf16 v[170:173], v[210:213], a[204:207], v[170:173]
    s_waitcnt lgkmcnt(8)
    v_mfma_f32_16x16x32_bf16 v[158:161], v[206:209], a[208:211], v[158:161]
    s_waitcnt vmcnt(4)
    s_barrier
    ds_read_b64_tr_b16 v[198:199], v43 offset:16384
    ds_read_b64_tr_b16 v[200:201], v43 offset:20480
    v_mfma_f32_16x16x32_bf16 v[162:165], v[210:213], a[208:211], v[162:165]
    ds_read_b64_tr_b16 v[202:203], v44 offset:16384
    v_mfma_f32_16x16x32_bf16 v[174:177], v[206:209], a[212:215], v[174:177]
    ds_read_b64_tr_b16 v[204:205], v44 offset:20480
    v_mfma_f32_16x16x32_bf16 v[178:181], v[210:213], a[212:215], v[178:181]
    ds_read_b128 a[200:203], v50 offset:0
    s_waitcnt lgkmcnt(7)
    v_mfma_f32_16x16x32_bf16 v[150:153], v[214:217], a[216:219], v[150:153]
    ds_read_b128 a[204:207], v50 offset:1024
    ds_read_b64_tr_b16 v[206:207], v43 offset:18432
    v_mfma_f32_16x16x32_bf16 v[154:157], v[218:221], a[216:219], v[154:157]
    ds_read_b64_tr_b16 v[208:209], v43 offset:22528
    ds_read_b64_tr_b16 v[210:211], v44 offset:18432
    v_mfma_f32_16x16x32_bf16 v[166:169], v[214:217], a[220:223], v[166:169]
    ds_read_b64_tr_b16 v[212:213], v44 offset:22528
    v_mfma_f32_16x16x32_bf16 v[170:173], v[218:221], a[220:223], v[170:173]
    ds_read_b128 a[208:211], v50 offset:2048
    s_waitcnt lgkmcnt(11)
    v_mfma_f32_16x16x32_bf16 v[158:161], v[214:217], a[224:227], v[158:161]
    ds_read_b128 a[212:215], v50 offset:3072
    v_mfma_f32_16x16x32_bf16 v[162:165], v[218:221], a[224:227], v[162:165]
    v_mfma_f32_16x16x32_bf16 v[174:177], v[214:217], a[228:231], v[174:177]
    v_mfma_f32_16x16x32_bf16 v[178:181], v[218:221], a[228:231], v[178:181]
    s_waitcnt lgkmcnt(6)
    v_mfma_f32_16x16x32_bf16 v[166:169], v[198:201], a[200:203], v[166:169]
    ds_read_b128 a[224:227], v49 offset:0
    v_mfma_f32_16x16x32_bf16 v[170:173], v[202:205], a[200:203], v[170:173]
    v_mfma_f32_16x16x32_bf16 v[174:177], v[198:201], a[204:207], v[174:177]
    ds_read_b128 a[228:231], v49 offset:1024
    v_mfma_f32_16x16x32_bf16 v[178:181], v[202:205], a[204:207], v[178:181]
    s_waitcnt lgkmcnt(2)
    v_mfma_f32_16x16x32_bf16 v[166:169], v[206:209], a[208:211], v[166:169]
    ds_read_b128 a[200:203], v49 offset:2048
    v_mfma_f32_16x16x32_bf16 v[170:173], v[210:213], a[208:211], v[170:173]
L_pad4:
    s_cbranch_execz L_warm
    v_mfma_f32_16x16x32_bf16 v[174:177], v[206:209], a[212:215], v[174:177]
    ds_read_b128 a[204:207], v49 offset:3072
    v_mfma_f32_16x16x32_bf16 v[178:181], v[210:213], a[212:215], v[178:181]
    s_waitcnt vmcnt(3)
    v_mfma_f32_16x16x32_bf16 v[166:169], a[250:253], v[246:249], v[166:169]
    v_mfma_f32_16x16x32_bf16 v[170:173], a[248:251], v[246:249], v[170:173]
    s_waitcnt vmcnt(2)
    v_mfma_f32_16x16x32_bf16 v[174:177], a[250:253], v[250:253], v[174:177]
    v_mfma_f32_16x16x32_bf16 v[178:181], a[248:251], v[250:253], v[178:181]
    s_waitcnt lgkmcnt(2)
    v_mfma_f32_16x16x32_bf16 v[150:153], v[198:201], a[224:227], v[150:153]
    v_mfma_f32_16x16x32_bf16 v[154:157], v[202:205], a[224:227], v[154:157]
    v_mfma_f32_16x16x32_bf16 v[158:161], v[198:201], a[228:231], v[158:161]
    ds_write_b128 v87, v[166:169] offset:8192
    v_mfma_f32_16x16x32_bf16 v[162:165], v[202:205], a[228:231], v[162:165]
    s_waitcnt lgkmcnt(1)
    v_mfma_f32_16x16x32_bf16 v[150:153], v[206:209], a[200:203], v[150:153]
    ds_write_b128 v88, v[170:173] offset:8192
    v_mfma_f32_16x16x32_bf16 v[154:157], v[210:213], a[200:203], v[154:157]
    v_mfma_f32_16x16x32_bf16 v[158:161], v[206:209], a[204:207], v[158:161]
    ds_write_b128 v87, v[174:177] offset:12288
    v_mfma_f32_16x16x32_bf16 v[162:165], v[210:213], a[204:207], v[162:165]
    s_waitcnt vmcnt(1)
    v_mfma_f32_16x16x32_bf16 v[150:153], a[250:253], v[238:241], v[150:153]
    ds_write_b128 v88, v[178:181] offset:12288
    v_mfma_f32_16x16x32_bf16 v[154:157], a[248:251], v[238:241], v[154:157]
    s_waitcnt vmcnt(0)
    v_mfma_f32_16x16x32_bf16 v[158:161], a[250:253], v[242:245], v[158:161]
    v_mfma_f32_16x16x32_bf16 v[162:165], a[248:251], v[242:245], v[162:165]
    s_nop 2
    ds_write_b128 v87, v[150:153] offset:0
    s_nop 0
    ds_write_b128 v88, v[154:157] offset:0
    s_nop 0
    ds_write_b128 v87, v[158:161] offset:4096
    ds_write_b128 v88, v[162:165] offset:4096
    s_waitcnt lgkmcnt(0)
    s_barrier
    ds_read_b128 v[118:121], v89 offset:0
    ds_read_b128 v[122:125], v90 offset:0
    ds_read_b128 v[126:129], v91 offset:0
    ds_read_b128 v[130:133], v92 offset:0
    ds_read_b128 v[134:137], v89 offset:2048
    ds_read_b128 v[138:141], v90 offset:2048
    ds_read_b128 v[142:145], v91 offset:2048
    ds_read_b128 v[146:149], v92 offset:2048
    s_waitcnt lgkmcnt(7)
    v_pk_add_f32 v[222:223], v[222:223], v[118:119]
    v_pk_add_f32 v[224:225], v[224:225], v[120:121]
    s_waitcnt lgkmcnt(6)
    v_pk_add_f32 v[226:227], v[226:227], v[122:123]
    v_pk_add_f32 v[228:229], v[228:229], v[124:125]
    s_waitcnt lgkmcnt(5)
    v_pk_add_f32 v[222:223], v[222:223], v[126:127]
    v_pk_add_f32 v[224:225], v[224:225], v[128:129]
    s_waitcnt lgkmcnt(4)
    v_pk_add_f32 v[226:227], v[226:227], v[130:131]
    v_pk_add_f32 v[228:229], v[228:229], v[132:133]
    v_cvt_pk_bf16_f32 v110, v222, v223
    v_cvt_pk_bf16_f32 v111, v224, v225
    v_cvt_pk_bf16_f32 v112, v226, v227
    v_cvt_pk_bf16_f32 v113, v228, v229
    buffer_store_dwordx4 v[110:113], v85, s[32:35], 0 offen
    s_waitcnt lgkmcnt(3)
    v_pk_add_f32 v[230:231], v[230:231], v[134:135]
    v_pk_add_f32 v[232:233], v[232:233], v[136:137]
    s_waitcnt lgkmcnt(2)
    v_pk_add_f32 v[234:235], v[234:235], v[138:139]
    v_pk_add_f32 v[236:237], v[236:237], v[140:141]
    s_waitcnt lgkmcnt(1)
    v_pk_add_f32 v[230:231], v[230:231], v[142:143]
    v_pk_add_f32 v[232:233], v[232:233], v[144:145]
    s_waitcnt lgkmcnt(0)
    v_pk_add_f32 v[234:235], v[234:235], v[146:147]
    v_pk_add_f32 v[236:237], v[236:237], v[148:149]
    v_cvt_pk_bf16_f32 v114, v230, v231
    v_cvt_pk_bf16_f32 v115, v232, v233
    v_cvt_pk_bf16_f32 v116, v234, v235
    v_cvt_pk_bf16_f32 v117, v236, v237
    buffer_store_dwordx4 v[114:117], v86, s[32:35], 0 offen
L_fin:
L_end:
    s_endpgm
L_nonce:
    buffer_load_dword v12, v16, s[44:47], 0 offen sc1
    s_add_u32 s60, s60, 1
    s_waitcnt vmcnt(0)
    v_readfirstlane_b32 s57, v12
    s_cmp_ge_u32 s60, 20000
    s_cbranch_scc1 L_nonce_ok
    s_cmp_eq_u32 s57, 0
    s_cbranch_scc1 L_nonce
    s_branch L_nonce_ok
L_pollin0:
    s_mov_b32 s60, 0
L_poll0:
    s_sleep 4
    buffer_load_dword v18, v20, s[28:31], 0 offen sc1
    s_add_u32 s60, s60, 1
    s_waitcnt vmcnt(0)
    v_cmp_ne_u32 vcc, s57, v18
    s_cbranch_vccz L_pollok0
    s_cmp_lt_u32 s60, 20000
    s_cbranch_scc1 L_poll0
    s_branch L_pollok0
L_pollin1:
    s_waitcnt lgkmcnt(0)
    s_cmp_ge_u32 s14, 14
    s_cbranch_scc1 L_pollok1
    s_mov_b32 s60, 0
    s_branch L_poll1a
L_poll1:
    s_sleep 8
L_poll1a:
    buffer_load_dword v18, off, s[44:47], s15 sc1
    s_add_u32 s60, s60, 1
    s_waitcnt vmcnt(0)
    v_readfirstlane_b32 s14, v18
    s_nop 0
    s_cmp_ge_u32 s14, 14
    s_cbranch_scc1 L_pollok1
    s_cmp_lt_u32 s60, 20000
    s_cbranch_scc1 L_poll1
    s_branch L_pollok1
L_pollin2:
    s_waitcnt lgkmcnt(0)
    s_cmp_ge_u32 s14, 2
    s_cbranch_scc1 L_pollok2
    s_mov_b32 s60, 0
    s_branch L_poll2a
L_poll2:
    s_sleep 4
L_poll2a:
    buffer_load_dword v18, off, s[28:31], s37 sc1
    s_add_u32 s60, s60, 1
    s_waitcnt vmcnt(0)
    v_readfirstlane_b32 s14, v18
    s_nop 0
    s_cmp_ge_u32 s14, 2
    s_cbranch_scc1 L_pollok2
    s_cmp_lt_u32 s60, 20000
    s_cbranch_scc1 L_poll2
    s_branch L_pollok2
L_nonceh:
    buffer_load_dword v12, v16, s[44:47], 0 offen sc1
    s_add_u32 s60, s60, 1
    s_waitcnt vmcnt(0)
    v_readfirstlane_b32 s57, v12
    s_cmp_ge_u32 s60, 20000
    s_cbranch_scc1 L_nonce_okh
    s_cmp_eq_u32 s57, 0
    s_cbranch_scc1 L_nonceh
    s_branch L_nonce_okh
L_pollin3:
    s_mov_b32 s60, 0
L_poll3:
    s_sleep 8
    buffer_load_dword v18, v20, s[28:31], 0 offen sc1
    s_add_u32 s60, s60, 1
    s_waitcnt vmcnt(0)
    v_cmp_ne_u32 vcc, s57, v18
    s_cbranch_vccz L_pollok3
    s_cmp_lt_u32 s60, 20000
    s_cbranch_scc1 L_poll3
    s_branch L_pollok3
L_pollin4:
    s_waitcnt lgkmcnt(0)
    s_cmp_ge_u32 s14, 14
    s_cbranch_scc1 L_pollok4
    s_mov_b32 s60, 0
    s_branch L_poll4a
L_poll4:
    s_sleep 16
L_poll4a:
    buffer_load_dword v18, off, s[44:47], s15 sc1
    s_add_u32 s60, s60, 1
    s_waitcnt vmcnt(0)
    v_readfirstlane_b32 s14, v18
    s_nop 0
    s_cmp_ge_u32 s14, 14
    s_cbranch_scc1 L_pollok4
    s_cmp_lt_u32 s60, 20000
    s_cbranch_scc1 L_poll4
    s_branch L_pollok4
L_nog1:
    s_nop 1
    s_mov_b32 s14, 1204224
    s_mov_b32 s15, 0x20000
    s_sub_u32 s3, s2, 200
    s_cmp_lt_u32 s3, 42
    s_cselect_b32 s81, 0, 268435456
    s_cselect_b32 s3, s3, 0
    s_mul_i32 s79, s3, 43
    s_lshr_b32 s79, s79, 7
    s_mul_i32 s80, s79, 3
    s_sub_u32 s80, s3, s80
    v_min_u32 v13, 55, v1
    s_lshl_b32 s3, s79, 2
    s_add_u32 s3, s3, s48
    s_mul_i32 s3, s3, 21504
    s_mul_i32 s60, s80, 896
    s_add_u32 s3, s3, s60
    s_add_u32 s3, s3, s81
    v_lshl_add_u32 v242, v13, 4, s3
    s_mul_i32 s60, s48, 8448
    s_add_u32 m0, s60, 0
    s_mov_b32 s3, 0
    buffer_load_dwordx4 v242, s[12:15], s3 offen lds
    s_add_u32 m0, s60, 1056
    s_mov_b32 s3, 2688
    buffer_load_dwordx4 v242, s[12:15], s3 offen lds
    s_add_u32 m0, s60, 2112
    s_mov_b32 s3, 5376
    buffer_load_dwordx4 v242, s[12:15], s3 offen lds
    s_add_u32 m0, s60, 3168
    s_mov_b32 s3, 8064
    buffer_load_dwordx4 v242, s[12:15], s3 offen lds
    s_add_u32 m0, s60, 4224
    s_mov_b32 s3, 10752
    buffer_load_dwordx4 v242, s[12:15], s3 offen lds
    s_add_u32 m0, s60, 5280
    s_mov_b32 s3, 13440
    buffer_load_dwordx4 v242, s[12:15], s3 offen lds
    s_add_u32 m0, s60, 6336
    s_mov_b32 s3, 16128
    buffer_load_dwordx4 v242, s[12:15], s3 offen lds
    s_add_u32 m0, s60, 7392
    s_mov_b32 s3, 18816
    buffer_load_dwordx4 v242, s[12:15], s3 offen lds
    s_mul_i32 s53, s101, 37
    s_lshr_b32 s53, s53, 8
    s_mul_i32 s54, s53, 7
    s_sub_u32 s54, s101, s54
    s_and_b32 s53, s53, 3
    s_xor_b32 s53, s53, 0
    s_lshl_b32 s3, s6, 2
    s_add_u32 s53, s53, s3
    s_lshl_b32 s53, s53, 1
    s_add_u32 s53, s53, s7
    s_mov_b32 s42, 4096
    s_mov_b32 s43, 0x20000
    s_lshl_b32 s3, s53, 2
    s_add_u32 s3, s3, s48
    s_lshl_b32 s60, s3, 5
    v_lshl_add_u32 v82, v5, 1, s60
    s_mul_i32 s3, s3, 14336
    s_lshl_b32 s60, s54, 7
    s_add_u32 s3, s3, s60
    v_mul_u32_u24 v14, 896, v5
    v_lshl_add_u32 v14, v6, 4, v14
    v_add_u32 v85, s3, v14
    v_add_u32 v86, 7168, v85
    s_cmp_lt_u32 s101, 28
    s_cselect_b32 s56, 1, 0
    s_lshl_b32 s50, s7, 3
    s_and_b32 s3, s101, 7
    s_add_u32 s50, s50, s3
    s_lshr_b32 s60, s101, 3
    s_lshl_b32 s49, s6, 2
    s_add_u32 s49, s49, s60
    s_lshl_b32 s49, s49, 2
    s_add_u32 s49, s49, s48
    s_mul_i32 s60, s60, 0
    s_add_u32 s3, s3, s60
    s_sub_u32 s60, s3, 7
    s_cmp_ge_u32 s3, 7
    s_cselect_b32 s3, s60, s3
    s_lshl_b32 s62, s3, 18
    s_mul_i32 s63, s3, 12288
    s_mov_b32 s30, 20971520
    s_mov_b32 s31, 0x20000
    s_mov_b32 s75, 0x3727c5ac
    s_mov_b32 s76, 0x3b124925
    s_mov_b32 s77, 0x3f803f80
    v_lshlrev_b32 v4, 4, v1
    v_bfe_u32 v7, v1, 2, 2
    v_and_b32 v8, 3, v1
    v_mul_u32_u24 v13, 960, v9
    v_lshl_add_u32 v13, v10, 4, v13
    s_mul_i32 s3, s48, 1920
    s_add_u32 s3, s3, 147456
    v_add_u32 v230, s3, v13
    v_mul_u32_u24 v13, 960, v7
    v_lshl_add_u32 v13, v3, 5, v13
    v_lshl_add_u32 v13, v8, 3, v13
    s_lshl_b32 s3, s48, 8
    s_add_u32 s3, s3, 147456
    v_add_u32 v231, s3, v13
    s_lshl_b32 s3, s48, 3
    s_add_u32 s3, s3, 155648
    v_lshl_add_u32 v232, v9, 2, s3
    v_lshlrev_b32 v237, 2, v6
    v_and_b32 v2, 15, v1
    v_lshlrev_b32 v238, 14, v3
    v_add_lshl_u32 v238, v238, v2, 2
    v_add_u32 v237, 155648, v237
    v_lshlrev_b32 v13, 17, v9
    v_lshl_add_u32 v233, v10, 4, v13
    s_cmp_eq_u32 s48, 3
    s_cselect_b32 s60, 268435456, 0
    s_lshl_b32 s70, s48, 10
    s_add_u32 s70, s70, s2
    s_lshl_b32 s70, s70, 9
    s_add_u32 s71, s70, 262144
    s_add_u32 s71, s71, s60
    s_xor_b32 s60, s60, 268435456
    s_lshl_b32 s72, s2, 7
    s_add_u32 s72, s72, s60
    s_add_u32 s72, s72, 6291456
    s_lshr_b32 s74, s2, 2
    s_lshl_b32 s74, s74, 5
    s_and_b32 s3, s2, 3
    s_add_u32 s74, s74, s3
    s_lshl_b32 s74, s74, 2
    s_add_u32 s74, s74, 10485760
    v_cmp_gt_u32 vcc, 8, v0
    v_lshlrev_b32 v236, 13, v0
    v_mov_b32 v13, 268435456
    s_and_b32 s3, s2, 7
    s_lshl_b32 s3, s3, 13
    s_add_u32 s3, s3, 10485760
    v_lshrrev_b32 v14, 2, v0
    v_lshl_add_u32 v14, v14, 7, s3
    v_lshl_add_u32 v20, v8, 2, v14
    v_cndmask_b32 v236, v13, v236, vcc
    v_mov_b32 v16, 0
    s_lshl_b32 s3, s48, 14
    s_add_u32 s74, s74, s3
    s_add_u32 s73, s74, 8192
    s_waitcnt vmcnt(10)
    v_dot2_f32_bf16 v226, v182, s77, 0
    v_dot2_f32_bf16 v227, v182, v182, 0
    v_dot2_f32_bf16 v226, v183, s77, v226
    v_dot2_f32_bf16 v227, v183, v183, v227
    v_dot2_f32_bf16 v226, v184, s77, v226
    v_dot2_f32_bf16 v227, v184, v184, v227
    v_dot2_f32_bf16 v226, v185, s77, v226
    v_dot2_f32_bf16 v227, v185, v185, v227
    s_waitcnt vmcnt(9)
    v_dot2_f32_bf16 v226, v186, s77, v226
    v_dot2_f32_bf16 v227, v186, v186, v227
    v_dot2_f32_bf16 v226, v187, s77, v226
    v_dot2_f32_bf16 v227, v187, v187, v227
    v_dot2_f32_bf16 v226, v188, s77, v226
    v_dot2_f32_bf16 v227, v188, v188, v227
    v_dot2_f32_bf16 v226, v189, s77, v226
    v_dot2_f32_bf16 v227, v189, v189, v227
    buffer_load_dword v12, v16, s[44:47], 0 offen sc1
    v_lshlrev_b32 v190, 16, v182
    v_and_b32 v191, 0xffff0000, v182
    v_add_f32_dpp v226, v226, v226 quad_perm:[1,0,3,2] row_mask:0xf bank_mask:0xf
    v_add_f32_dpp v227, v227, v227 quad_perm:[1,0,3,2] row_mask:0xf bank_mask:0xf
    v_lshlrev_b32 v192, 16, v183
    v_add_f32_dpp v226, v226, v226 quad_perm:[2,3,0,1] row_mask:0xf bank_mask:0xf
    v_add_f32_dpp v227, v227, v227 quad_perm:[2,3,0,1] row_mask:0xf bank_mask:0xf
    v_and_b32 v193, 0xffff0000, v183
    v_add_f32_dpp v226, v226, v226 row_half_mirror row_mask:0xf bank_mask:0xf
    v_add_f32_dpp v227, v227, v227 row_half_mirror row_mask:0xf bank_mask:0xf
    v_lshlrev_b32 v194, 16, v184
    v_add_f32_dpp v226, v226, v226 row_mirror row_mask:0xf bank_mask:0xf
    v_add_f32_dpp v227, v227, v227 row_mirror row_mask:0xf bank_mask:0xf
    v_and_b32 v195, 0xffff0000, v184
    v_mov_b32 v228, v226
    v_mov_b32 v229, v227
    v_lshlrev_b32 v196, 16, v185
    v_permlane16_swap_b32 v226, v228
    v_permlane16_swap_b32 v227, v229
    v_add_f32 v226, v226, v228
    v_add_f32 v227, v227, v229
    v_mul_f32_e64 v226, -v226, s76
    v_mul_f32 v228, v226, v226
    v_fma_f32 v227, v227, s76, -v228
    v_max_f32 v227, 0, v227
    v_add_f32 v228, s75, v227
    v_rsq_f32 v222, v228
    v_and_b32 v197, 0xffff0000, v185
    v_mul_f32 v228, v222, v222
    v_fma_f32 v229, v228, v227, s75
    v_rsq_f32 v228, v229
    v_mul_f32 v223, v226, v222
    v_mul_f32 v224, v222, v228
    v_mul_f32 v225, v223, v228
    v_mul_f32 v229, v229, v228
    ds_write_b32 v232, v229
    v_lshlrev_b32 v198, 16, v186
    v_and_b32 v199, 0xffff0000, v186
    v_lshlrev_b32 v200, 16, v187
    v_and_b32 v201, 0xffff0000, v187
    v_lshlrev_b32 v202, 16, v188
    v_and_b32 v203, 0xffff0000, v188
    v_lshlrev_b32 v204, 16, v189
    v_and_b32 v205, 0xffff0000, v189
    v_pk_fma_f32 v[206:207], v[190:191], v[224:225], v[224:225] op_sel:[0,0,1] op_sel_hi:[1,0,1]
    v_pk_fma_f32 v[208:209], v[192:193], v[224:225], v[224:225] op_sel:[0,0,1] op_sel_hi:[1,0,1]
    v_pk_fma_f32 v[210:211], v[194:195], v[224:225], v[224:225] op_sel:[0,0,1] op_sel_hi:[1,0,1]
    v_pk_fma_f32 v[212:213], v[196:197], v[224:225], v[224:225] op_sel:[0,0,1] op_sel_hi:[1,0,1]
    v_cvt_pk_bf16_f32 v182, v206, v207
    v_cvt_pk_bf16_f32 v183, v208, v209
    v_cvt_pk_bf16_f32 v184, v210, v211
    v_cvt_pk_bf16_f32 v185, v212, v213
    ds_write_b128 v230, v[182:185] offset:0
    v_pk_fma_f32 v[214:215], v[198:199], v[224:225], v[224:225] op_sel:[0,0,1] op_sel_hi:[1,0,1]
    v_pk_fma_f32 v[216:217], v[200:201], v[224:225], v[224:225] op_sel:[0,0,1] op_sel_hi:[1,0,1]
    v_pk_fma_f32 v[218:219], v[202:203], v[224:225], v[224:225] op_sel:[0,0,1] op_sel_hi:[1,0,1]
    v_pk_fma_f32 v[220:221], v[204:205], v[224:225], v[224:225] op_sel:[0,0,1] op_sel_hi:[1,0,1]
    v_cvt_pk_bf16_f32 v186, v214, v215
    v_cvt_pk_bf16_f32 v187, v216, v217
    v_cvt_pk_bf16_f32 v188, v218, v219
    v_cvt_pk_bf16_f32 v189, v220, v221
    ds_write_b128 v230, v[186:189] offset:448
    s_waitcnt lgkmcnt(0)
    s_barrier
    ds_read_b64_tr_b16 v[110:111], v231 offset:0
    ds_read_b64_tr_b16 v[112:113], v231 offset:3840
    ds_read_b64_tr_b16 v[114:115], v231 offset:128
    ds_read_b64_tr_b16 v[116:117], v231 offset:3968
    ds_read_b32 v229, v237
    s_waitcnt lgkmcnt(3)
    buffer_store_dwordx4 v[110:113], v233, s[28:31], s70 offen sc1
    s_waitcnt lgkmcnt(1)
    buffer_store_dwordx4 v[114:117], v233, s[28:31], s71 offen sc1
    v_cmp_gt_u32 vcc, 16, v1
    s_waitcnt lgkmcnt(0)
    s_nop 0
    v_cndmask_b32 v229, 0, v229, vcc
    buffer_store_dword v229, v238, s[28:31], s72 offen sc1
    v_lshrrev_b32 v13, 2, v1
    v_mul_u32_u24 v13, 1056, v13
    v_lshl_add_u32 v13, v8, 3, v13
    s_mul_i32 s3, s48, 224
    v_add_u32 v243, s3, v13
    s_mov_b32 s18, 401408
    s_mov_b32 s19, 0x20000
    s_mov_b32 s26, 7340032
    s_mov_b32 s27, 0x20000
    s_mov_b32 s34, 1835008
    s_mov_b32 s35, 0x20000
    s_mov_b32 s36, 1
    v_lshrrev_b32 v14, 2, v1
    v_lshlrev_b32 v14, 7, v14
    v_lshl_add_u32 v14, v8, 3, v14
    v_and_b32 v15, 3, v5
    v_lshl_add_u32 v14, v15, 5, v14
    s_mul_i32 s3, s4, 8256
    v_xor_b32 v31, s3, v14
    v_xor_b32 v32, 32, v31
    v_xor_b32 v33, 64, v31
    v_xor_b32 v34, 96, v31
    v_add_u32 v35, 65536, v31
    v_add_u32 v36, 65536, v32
    v_add_u32 v37, 65536, v33
    v_add_u32 v38, 65536, v34
    v_add_u32 v39, 131072, v31
    v_add_u32 v40, 131072, v32
    v_add_u32 v41, 131072, v33
    v_add_u32 v42, 131072, v34
    s_lshl_b32 s6, s52, 1
    s_add_u32 s6, s6, s5
    s_lshl_b32 s3, s6, 1
    s_add_u32 s3, s3, s59
    s_lshl_b32 s3, s3, 4
    s_add_u32 s3, s3, s4
    s_lshl_b32 s3, s3, 12
    v_lshl_add_u32 v78, v3, 8, v4
    v_add_u32 v78, s3, v78
    s_xor_b32 s37, s51, 1
    s_lshl_b32 s37, s37, 3
    s_add_u32 s37, s37, s52
    s_lshl_b32 s3, s37, 14
    s_add_u32 s3, s3, s58
    s_add_u32 s3, s3, 16777216
    v_add_u32 v23, s3, v4
    s_lshl_b32 s37, s37, 5
    s_add_u32 s37, s37, s5
    s_lshl_b32 s37, s37, 2
    s_add_u32 s37, s37, 6422528
    s_mul_i32 s67, s6, 56
    s_lshl_b32 s3, s51, 1
    s_add_u32 s3, s3, s4
    s_add_u32 s67, s67, s3
    s_lshl_b32 s67, s67, 11
    s_add_u32 s67, s67, 2097152
    v_add_u32 v81, s58, v4
    s_lshl_b32 s68, s52, 2
    s_and_b32 s3, s51, 1
    s_add_u32 s68, s68, s3
    s_cmp_ge_u32 s51, 14
    s_cselect_b32 s3, 2, 0
    s_add_u32 s68, s68, s3
    s_lshl_b32 s68, s68, 7
    s_add_u32 s68, s68, 6356992
    s_waitcnt vmcnt(3)
    v_readfirstlane_b32 s57, v12
    s_mov_b32 s60, 0
    s_cmp_lg_u32 s57, 0
    s_cbranch_scc0 L_nonceh
L_nonce_okh:
    s_waitcnt vmcnt(0)
    s_barrier
    s_atomic_swap s57, s[28:29], s74
    s_atomic_swap s57, s[28:29], s73
    buffer_load_dwordx4 v[96:99], v85, s[8:11], 0 offen
    buffer_load_ushort v93, v82, s[40:43], 0 offen offset:0
    buffer_load_dwordx4 v[100:103], v86, s[8:11], 0 offen
    buffer_load_ushort v94, v82, s[40:43], 0 offen offset:16
    v_cmp_gt_u32 vcc, 12, v2
    s_mul_i32 s3, s48, 56
    s_add_u32 s3, s3, s79
    s_mul_i32 s3, s3, 3
    s_add_u32 s3, s3, s80
    s_lshl_b32 s3, s3, 11
    s_add_u32 s3, s3, 8388608
    s_add_u32 s3, s3, s81
    ds_read_b64_tr_b16 v[182:183], v243 offset:0
    ds_read_b64_tr_b16 v[184:185], v243 offset:16896
    ds_read_b64_tr_b16 v[186:187], v243 offset:32
    ds_read_b64_tr_b16 v[188:189], v243 offset:16928
    ds_read_b64_tr_b16 v[190:191], v243 offset:56
    ds_read_b64_tr_b16 v[192:193], v243 offset:16952
    ds_read_b64_tr_b16 v[194:195], v243 offset:88
    ds_read_b64_tr_b16 v[196:197], v243 offset:16984
    ds_read_b64_tr_b16 v[198:199], v243 offset:112
    ds_read_b64_tr_b16 v[200:201], v243 offset:17008
    ds_read_b64_tr_b16 v[202:203], v243 offset:144
    ds_read_b64_tr_b16 v[204:205], v243 offset:17040
    ds_read_b64_tr_b16 v[206:207], v243 offset:168
    ds_read_b64_tr_b16 v[208:209], v243 offset:17064
    ds_read_b64_tr_b16 v[210:211], v243 offset:200
    ds_read_b64_tr_b16 v[212:213], v243 offset:17096
    s_waitcnt lgkmcnt(13)
    v_cndmask_b32 v186, 0, v186, vcc
    v_cndmask_b32 v187, 0, v187, vcc
    s_waitcnt lgkmcnt(12)
    v_cndmask_b32 v188, 0, v188, vcc
    v_cndmask_b32 v189, 0, v189, vcc
    buffer_store_dwordx4 v[182:185], v4, s[28:31], s3 offen offset:0 sc1
    buffer_store_dwordx4 v[186:189], v4, s[28:31], s3 offen offset:1024 sc1
    s_add_u32 s3, s3, 86016
    s_waitcnt lgkmcnt(9)
    v_cndmask_b32 v194, 0, v194, vcc
    v_cndmask_b32 v195, 0, v195, vcc
    s_waitcnt lgkmcnt(8)
    v_cndmask_b32 v196, 0, v196, vcc
    v_cndmask_b32 v197, 0, v197, vcc
    buffer_store_dwordx4 v[190:193], v4, s[28:31], s3 offen offset:0 sc1
    buffer_store_dwordx4 v[194:197], v4, s[28:31], s3 offen offset:1024 sc1
    s_add_u32 s3, s3, 86016
    s_waitcnt lgkmcnt(5)
    v_cndmask_b32 v202, 0, v202, vcc
    v_cndmask_b32 v203, 0, v203, vcc
    s_waitcnt lgkmcnt(4)
    v_cndmask_b32 v204, 0, v204, vcc
    v_cndmask_b32 v205, 0, v205, vcc
    buffer_store_dwordx4 v[198:201], v4, s[28:31], s3 offen offset:0 sc1
    buffer_store_dwordx4 v[202:205], v4, s[28:31], s3 offen offset:1024 sc1
    s_add_u32 s3, s3, 86016
    ds_read_b32 v24, v4
    s_waitcnt lgkmcnt(2)
    v_cndmask_b32 v210, 0, v210, vcc
    v_cndmask_b32 v211, 0, v211, vcc
    ds_read_b32 v24, v4
    s_waitcnt lgkmcnt(2)
    v_cndmask_b32 v212, 0, v212, vcc
    v_cndmask_b32 v213, 0, v213, vcc
    buffer_store_dwordx4 v[206:209], v4, s[28:31], s3 offen offset:0 sc1
    buffer_store_dwordx4 v[210:213], v4, s[28:31], s3 offen offset:1024 sc1
    s_add_u32 s3, s3, 86016
    s_lshl_b32 s67, s80, 6
    s_add_u32 s67, s67, 64
    s_cmp_eq_u32 s81, 0
    s_cselect_b32 s37, s48, 1
    s_mov_b32 s68, 6369792
    s_and_b32 s3, s2, 1
    s_mul_i32 s3, s3, 3
    s_bfe_u32 s6, s2, 0x10001
    s_mul_i32 s7, s6, 6
    s_add_u32 s3, s3, s7
    s_add_u32 s3, s3, 1
    v_add_u32 v14, s3, v8
    s_mul_i32 s6, s6, 64
    s_add_u32 s6, s6, 7
    v_cmp_ne_u32 vcc, s6, v14
    v_lshrrev_b32 v15, 2, v1
    v_mul_u32_u24 v15, 3584, v15
    v_cndmask_b32 v14, 0, v14, vcc
    v_lshl_add_u32 v14, v14, 8, v15
    s_lshl_b32 s3, s52, 2
    s_add_u32 s3, s3, s48
    s_mul_i32 s3, s3, 37
    s_min_u32 s3, s3, 987
    s_mul_i32 s3, s3, 3584
    s_mul_i32 s6, s59, 3670144
    s_add_u32 s3, s3, s6
    buffer_load_dword v226, v14, s[20:23], s3 offen
    s_add_u32 s3, s3, 57344
    buffer_load_dword v227, v14, s[20:23], s3 offen
    s_add_u32 s3, s3, 57344
    v_cmp_gt_u32 vcc, 20, v1
    v_mov_b32 v15, 268435456
    s_nop 0
    v_cndmask_b32 v14, v15, v14, vcc
    buffer_load_dword v228, v14, s[20:23], s3 offen
    s_add_u32 s3, s3, 57344
    v_add_u32 v53, 65536, v4
    v_add_u32 v54, 131072, v4
    s_mul_i32 s59, s48, 3072
    s_mul_i32 s3, s50, 86016
    s_add_u32 s3, s3, s59
    s_add_u32 s3, s3, 8388608
    v_add_u32 v80, s3, v4
    v_lshlrev_b32 v14, 7, v9
    v_xor_b32 v14, v14, v4
    s_lshl_b32 s3, s49, 11
    v_add_u32 v67, s3, v14
    v_add_u32 v68, 129024, v67
    s_lshr_b32 s3, s49, 2
    s_lshl_b32 s3, s3, 3
    s_max_u32 s3, s3, 1
    s_sub_u32 s3, s3, 1
    s_lshl_b32 s3, s3, 10
    s_lshl_b32 s6, s5, 17
    s_add_u32 s3, s3, s6
    s_lshl_b32 s6, s4, 28
    s_add_u32 s3, s3, s6
    v_add_u32 v69, s3, v14
    s_lshl_b32 s100, s5, 1
    s_add_u32 s100, s100, s4
    s_lshl_b32 s100, s100, 10
    v_and_b32 v14, 1, v1
    v_mul_u32_u24 v14, 640, v14
    v_lshrrev_b32 v15, 2, v1
    v_lshlrev_b32 v15, 4, v15
    v_xor_b32 v14, v14, v15
    v_bfe_u32 v15, v1, 1, 1
    v_lshl_add_u32 v14, v15, 3, v14
    s_add_u32 s3, s58, 12288
    v_add_u32 v70, s3, v14
    s_sub_u32 s3, s3, 3072
    s_cmp_eq_u32 s48, 0
    s_cselect_b32 s3, 28672, s3
    v_add_u32 v71, s3, v14
    v_add_u32 v72, 65536, v70
    v_add_u32 v73, 65536, v71
    v_add_u32 v74, 131072, v70
    v_add_u32 v75, 131072, v71
    s_lshl_b32 s3, s49, 1
    v_min_u32 v14, 2, v3
    v_add_u32 v14, s3, v14
    v_max_u32 v14, 1, v14
    v_lshlrev_b32 v14, 1, v14
    v_and_b32 v15, 1, v7
    v_add_lshl_u32 v14, v14, v15, 7
    v_lshrrev_b32 v15, 1, v7
    v_lshl_add_u32 v15, v15, 2, v8
    v_lshl_add_u32 v14, v15, 2, v14
    v_add_u32 v77, 6291200, v14
    s_min_u32 s15, s48, 2
    s_lshl_b32 s15, s15, 6
    s_add_u32 s15, s15, 64
    s_lshl_b32 s82, s49, 5
    s_add_u32 s82, s82, s50
    s_lshl_b32 s82, s82, 10
    s_add_u32 s82, s82, 4194304
    s_lshr_b32 s69, s49, 2
    s_lshl_b32 s69, s69, 1
    s_and_b32 s3, s50, 1
    s_add_u32 s69, s69, s3
    s_lshl_b32 s69, s69, 7
    s_add_u32 s69, s69, 6361088
    s_and_b32 s7, s53, 1
    s_mul_i32 s3, s7, 28
    s_add_u32 s3, s3, s48
    s_lshl_b32 s3, s3, 17
    s_xor_b32 s6, s53, 1
    s_lshl_b32 s55, s6, 3
    s_lshl_b32 s6, s53, 7
    s_add_u32 s3, s3, s6
    v_lshlrev_b32 v14, 12, v5
    v_add3_u32 v59, v14, v83, s3
    v_add_u32 v60, 31744, v59
    v_add_u32 v61, 63488, v59
    v_add_u32 v62, 95232, v59
    v_mul_u32_u24 v14, 896, v5
    s_mul_i32 s3, s4, 25088
    s_mul_i32 s6, s5, 14336
    s_add_u32 s3, s3, s6
    s_lshl_b32 s6, s54, 7
    s_add_u32 s3, s3, s6
    v_add3_u32 v63, v14, v83, s3
    v_add_u32 v64, 6144, v63
    s_lshl_b32 s6, s53, 1
    s_add_u32 s6, s6, s5
    s_and_b32 s3, s53, 30
    s_add_u32 s3, s3, s4
    s_lshl_b32 s3, s3, 7
    s_add_u32 s39, s3, 6361088
    s_lshl_b32 s3, s6, 5
    s_add_u32 s3, s3, s4
    s_lshl_b32 s3, s3, 10
    s_add_u32 s3, s3, 4194304
    v_add_u32 v65, s3, v4
    v_add_u32 v66, 15360, v65
    s_xor_b32 s3, s4, s5
    s_lshl_b32 s3, s3, 6
    v_xor_b32 v43, s3, v31
    v_xor_b32 v44, 32, v43
    v_add_u32 v45, 65536, v43
    v_add_u32 v46, 65536, v44
    s_mul_i32 s3, s4, 12288
    v_add_u32 v47, s3, v4
    v_xor_b32 v48, 4096, v47
    v_add_u32 v49, 65536, v47
    v_add_u32 v50, 65536, v48
    v_add_u32 v51, 131072, v47
    v_add_u32 v52, 131072, v48
    s_lshl_b32 s6, s54, 1
    s_add_u32 s6, s6, s5
    s_lshl_b32 s3, s6, 1
    s_add_u32 s3, s3, s7
    s_mul_i32 s3, s3, 14
    s_add_u32 s3, s3, s4
    s_lshl_b32 s3, s3, 12
    s_add_u32 s3, s3, 2097152
    v_add_u32 v79, s3, v4
    s_lshl_b32 s3, s54, 1
    s_add_u32 s3, s3, s7
    s_lshl_b32 s3, s3, 1
    s_add_u32 s3, s3, s4
    s_lshl_b32 s3, s3, 7
    s_add_u32 s38, s3, 6356992
    s_and_b32 s3, s2, 6
    s_add_u32 s3, s3, s54
    s_sub_u32 s6, s3, 7
    s_cmp_ge_u32 s3, 7
    s_cselect_b32 s3, s6, s3
    s_lshl_b32 s64, s3, 19
    s_lshl_b32 s65, s3, 13
    s_add_u32 s55, s55, s54
    s_lshl_b32 s3, s55, 14
    s_add_u32 s3, s3, s58
    s_add_u32 s3, s3, 12582912
    v_add_u32 v21, s3, v4
    s_lshl_b32 s55, s55, 5
    s_add_u32 s55, s55, s48
    s_lshl_b32 s55, s55, 2
    s_add_u32 s55, s55, 6488064
    s_lshl_b32 s3, s5, 3
    v_add_u32 v13, s3, v3
    v_xor_b32 v13, v13, v6
    v_lshlrev_b32 v13, 4, v13
    v_lshl_add_u32 v13, v2, 8, v13
    s_lshl_b32 s3, s4, 14
    s_add_u32 s3, s3, 32768
    v_add_u32 v87, s3, v13
    v_xor_b32 v88, 64, v87
    s_lshr_b32 s3, s53, 1
    s_add_u32 s66, s3, s54
    s_mov_b32 s51, s66
    v_lshlrev_b32 v13, 1, v6
    v_xor_b32 v13, v13, v5
    v_lshlrev_b32 v13, 4, v13
    v_lshl_add_u32 v13, v5, 8, v13
    s_add_u32 s3, s58, 32768
    v_add_u32 v89, s3, v13
    v_xor_b32 v90, 16, v89
    v_xor_b32 v91, 24576, v89
    v_xor_b32 v92, 24592, v89
    s_mov_b32 s70, 0xaaaaaaaa
    s_mov_b32 s71, 0xaaaaaaaa
    s_mov_b32 s72, 0xfff0ffff
    s_mov_b32 s73, 0xf000ff00
    s_mov_b32 s74, 0xffc0fffc
    s_mov_b32 s75, 0xc000fc00
    s_cmp_eq_u32 s49, 0
    s_cselect_b64 s[76:77], 0, -1
    v_mov_b32 v13, 0xffff
    v_mov_b32 v14, 0xffff0000
    v_cndmask_b32 v13, v13, v14, s[70:71]
    v_cndmask_b32 v104, v13, 0, s[72:73]
    v_cndmask_b32 v106, 0, v13, s[72:73]
    v_cndmask_b32 v105, v13, 0, s[74:75]
    v_cndmask_b32 v107, 0, v13, s[74:75]
    v_mov_b32 v84, 0xf149f2ca
    s_mov_b32 s83, 0x3e8b97f6
    s_mov_b32 s78, 0xbdd2d3e8
    s_mov_b32 s79, 0xbdd2d3e8
    s_mov_b32 s80, 1.0
    s_mov_b32 s81, 1.0
    v_mov_b32 v108, 0xc0135761
    v_mov_b32 v109, 0xc0135761
    v_lshrrev_b32 v13, 1, v2
    v_lshlrev_b32 v14, 1, v3
    v_sub_u32 v13, v13, v14
    v_mov_b32 v14, 0x3f80
    v_cndmask_b32 v14, v14, 1.0, s[70:71]
    v_cmp_eq_i32 vcc, 0, v13
    v_accvgpr_write_b32 a248, 0
    v_accvgpr_write_b32 a252, 0
    v_cndmask_b32 v15, 0, v14, vcc
    v_accvgpr_write_b32 a250, v15
    v_cmp_eq_i32 vcc, 1, v13
    v_accvgpr_write_b32 a249, 0
    v_accvgpr_write_b32 a253, 0
    v_cndmask_b32 v15, 0, v14, vcc
    v_accvgpr_write_b32 a251, v15
    s_waitcnt vmcnt(3)
    s_barrier
    s_cmp_lg_u32 s37, 0
    s_cbranch_scc1 L_nowsig
    s_atomic_add s36, s[44:45], s67
L_nowsig:
    buffer_load_dword v18, v20, s[28:31], 0 offen sc1
    s_mov_b32 s26, 7340032
    s_and_b32 s3, s2, 1
    s_mul_i32 s3, s3, 7
    s_add_u32 s3, s3, s52
    s_lshl_b32 s3, s3, 2
    s_add_u32 s3, s3, s48
    s_lshl_b32 s3, s3, 17
    s_and_b32 s6, s2, 6
    s_lshl_b32 s6, s6, 9
    s_add_u32 s3, s3, s6
    v_lshlrev_b32 v242, 12, v10
    v_mul_u32_u24 v243, 512, v9
    v_add_u32 v243, v242, v243
    buffer_load_dword v232, v243, s[24:27], s3 offen offset:384
    v_mul_u32_u24 v243, 512, v9
    v_add_u32 v243, v242, v243
    buffer_load_dword v233, v243, s[24:27], s3 offen offset:256
    s_cmp_eq_u32 s56, 0
    s_cselect_b32 s26, 0, s26
    s_cmp_eq_u32 s56, 0
    s_cselect_b32 s26, 0, s26
    v_and_b32 v13, 0xfffff000, v78
    v_lshl_add_u32 v13, v10, 7, v13
    s_add_u32 s3, s1, 8192
    v_lshl_add_u32 v14, v9, 13, s3
    s_waitcnt vmcnt(2)
    v_cmp_ne_u32 vcc, s57, v18
    s_cbranch_vccnz L_pollin3
L_pollok3:
    s_mov_b32 s14, 0
    s_load_dword s14, s[44:45], s15
    s_barrier
    buffer_load_dword v76, v77, s[28:31], 0 offen sc1
    s_cmp_ge_u32 s14, 14
    s_cbranch_scc0 L_pollin4
L_pollok4:
    s_barrier
    s_cmp_eq_u32 s56, 0
    s_cselect_b32 s3, 268435456, 0
    v_add_u32 v79, s3, v79
    s_mov_b32 s26, 7340032
    s_and_b32 s3, s54, 1
    s_lshl_b32 s3, s3, 2
    s_lshr_b32 s6, s54, 1
    s_add_u32 s3, s3, s6
    s_lshl_b32 s3, s3, 7
    s_cmp_eq_u32 s56, 0
    s_cselect_b32 s3, s3, 0
    v_xor_b32 v59, s3, v59
    v_xor_b32 v60, s3, v60
    v_xor_b32 v61, s3, v61
    v_xor_b32 v62, s3, v62
    s_add_u32 m0, s59, 98304
    s_nop 0
    buffer_load_dwordx4 v80, s[28:31], s63 offen sc1 lds
    buffer_load_dwordx4 v80, s[28:31], s63 offen offset:1024 sc1 lds
    buffer_load_dwordx4 v80, s[28:31], s63 offen offset:2048 sc1 lds
    s_add_u32 m0, s100, 126976
    s_nop 0
    buffer_load_dwordx4 v69, s[28:31], s62 offen sc1 lds
    s_add_u32 m0, s58, 110592
    s_nop 0
    buffer_load_dwordx4 v67, s[28:31], s62 offen sc1 lds
    buffer_load_dwordx4 v67, s[28:31], s62 offen offset:1024 sc1 lds
    buffer_load_dwordx4 v68, s[28:31], s62 offen offset:2048 sc1 lds
    buffer_load_dwordx4 v68, s[28:31], s62 offen offset:3072 sc1 lds
    s_add_u32 m0, s59, 131072
    s_add_u32 s63, s63, 12288
    s_cmp_eq_u32 s63, 86016
    s_cselect_b32 s63, 0, s63
    buffer_load_dwordx4 v80, s[28:31], s63 offen sc1 lds
    buffer_load_dwordx4 v80, s[28:31], s63 offen offset:1024 sc1 lds
    buffer_load_dwordx4 v80, s[28:31], s63 offen offset:2048 sc1 lds
    s_add_u32 m0, s100, 159744
    s_add_u32 s62, s62, 262144
    s_cmp_eq_u32 s62, 1835008
    s_cselect_b32 s62, 0, s62
    buffer_load_dwordx4 v69, s[28:31], s62 offen sc1 lds
    s_add_u32 m0, s58, 143360
    s_nop 0
    buffer_load_dwordx4 v67, s[28:31], s62 offen sc1 lds
    buffer_load_dwordx4 v67, s[28:31], s62 offen offset:1024 sc1 lds
    buffer_load_dwordx4 v68, s[28:31], s62 offen offset:2048 sc1 lds
    buffer_load_dwordx4 v68, s[28:31], s62 offen offset:3072 sc1 lds
    s_add_u32 m0, s59, 0
    s_add_u32 s63, s63, 12288
    s_cmp_eq_u32 s63, 86016
    s_cselect_b32 s63, 0, s63
    buffer_load_dwordx4 v80, s[28:31], s63 offen sc1 lds
    buffer_load_dwordx4 v80, s[28:31], s63 offen offset:1024 sc1 lds
    buffer_load_dwordx4 v80, s[28:31], s63 offen offset:2048 sc1 lds
    s_add_u32 m0, s100, 28672
    s_add_u32 s62, s62, 262144
    s_cmp_eq_u32 s62, 1835008
    s_cselect_b32 s62, 0, s62
    buffer_load_dwordx4 v69, s[28:31], s62 offen sc1 lds
    s_add_u32 m0, s58, 12288
    s_nop 0
    buffer_load_dwordx4 v67, s[28:31], s62 offen sc1 lds
    buffer_load_dwordx4 v67, s[28:31], s62 offen offset:1024 sc1 lds
    buffer_load_dwordx4 v68, s[28:31], s62 offen offset:2048 sc1 lds
    buffer_load_dwordx4 v68, s[28:31], s62 offen offset:3072 sc1 lds
    s_add_u32 m0, s59, 65536
    s_add_u32 s63, s63, 12288
    s_cmp_eq_u32 s63, 86016
    s_cselect_b32 s63, 0, s63
    buffer_load_dwordx4 v80, s[28:31], s63 offen sc1 lds
    buffer_load_dwordx4 v80, s[28:31], s63 offen offset:1024 sc1 lds
    buffer_load_dwordx4 v80, s[28:31], s63 offen offset:2048 sc1 lds
    s_add_u32 m0, s100, 94208
    s_add_u32 s62, s62, 262144
    s_cmp_eq_u32 s62, 1835008
    s_cselect_b32 s62, 0, s62
    buffer_load_dwordx4 v69, s[28:31], s62 offen sc1 lds
    s_add_u32 m0, s58, 77824
    s_nop 0
    buffer_load_dwordx4 v67, s[28:31], s62 offen sc1 lds
    buffer_load_dwordx4 v67, s[28:31], s62 offen offset:1024 sc1 lds
    buffer_load_dwordx4 v68, s[28:31], s62 offen offset:2048 sc1 lds
    buffer_load_dwordx4 v68, s[28:31], s62 offen offset:3072 sc1 lds
    s_mov_b32 s3, 268435456
    buffer_store_dword v12, v11, s[28:31], s3 offen
    buffer_store_dword v12, v11, s[28:31], s3 offen
    v_lshlrev_b32 v13, 2, v2
    v_and_b32 v14, 1, v1
    v_lshl_add_u32 v14, v3, 2, v14
    v_lshlrev_b32 v14, 2, v14
    v_add_u32 v15, 64, v14
    v_cndmask_b32 v16, v14, v15, s[72:73]
    v_cndmask_b32 v14, v14, v15, s[74:75]
    s_waitcnt vmcnt(34)
    ds_bpermute_b32 v25, v13, v76 offset:64
    ds_bpermute_b32 v27, v16, v76 offset:0
    ds_bpermute_b32 v28, v14, v76 offset:8
    ds_bpermute_b32 v26, v13, v76 offset:128
    ds_bpermute_b32 v29, v16, v76 offset:64
    ds_bpermute_b32 v30, v14, v76 offset:72
    s_waitcnt lgkmcnt(5)
    v_mul_f32 v25, s83, v25
    ds_read_b32 v24, v4
    s_waitcnt lgkmcnt(3)
    v_mul_f32 v26, s83, v26
    ds_read_b32 v24, v4
    ds_read_b32 v24, v4
    ds_read_b32 v24, v4
    s_waitcnt vmcnt(18) lgkmcnt(3)
    s_barrier
    ds_read_b64_tr_b16 a[180:181], v72 offset:32768
    ds_read_b64_tr_b16 a[182:183], v72 offset:33024
    ds_read_b128 a[128:131], v53 offset:32768
    ds_read_b64_tr_b16 a[184:185], v72 offset:33792
    ds_read_b64_tr_b16 a[186:187], v72 offset:34048
    ds_read_b128 a[132:135], v53 offset:33792
    ds_read_b128 a[136:139], v53 offset:34816
    ds_read_b64_tr_b16 a[176:177], v73 offset:32768
    ds_read_b64_tr_b16 a[178:179], v73 offset:33024
    ds_read_b128 a[140:143], v53 offset:35840
    ds_read_b128 a[144:147], v53 offset:36864
    ds_read_b128 a[148:151], v53 offset:37888
    s_waitcnt lgkmcnt(0)
    s_nop 3
    s_branch L_q
L_pollin5:
    s_waitcnt lgkmcnt(0)
    s_cmp_ge_u32 s14, 7
    s_cbranch_scc1 L_pollok5
    s_cmp_eq_u32 s56, 0
    s_cbranch_scc1 L_pollok5
    s_mov_b32 s60, 0
    s_branch L_poll5a
L_poll5:
    s_sleep 8
L_poll5a:
    buffer_load_dword v18, off, s[28:31], s38 sc1
    s_add_u32 s60, s60, 1
    s_waitcnt vmcnt(0)
    v_readfirstlane_b32 s14, v18
    s_nop 0
    s_cmp_ge_u32 s14, 7
    s_cbranch_scc1 L_pollok5
    s_cmp_lt_u32 s60, 20000
    s_cbranch_scc1 L_poll5
    s_branch L_pollok5
L_nof:
    v_min_u32 v14, 48, v1
    s_lshl_b32 s3, s54, 2
    s_add_u32 s3, s3, s48
    s_mul_i32 s3, s3, 25088
    v_lshl_add_u32 v14, v14, 7, s3
    s_add_u32 s3, s2, 0
    s_and_b32 s3, s3, 3
    s_mul_i32 s3, s3, 6272
    buffer_load_dword v182, v14, s[16:19], s3 offen
    s_waitcnt vmcnt(1)
    s_barrier
    s_cmp_lg_u32 s48, 0
    s_cbranch_scc1 L_sig3
    s_atomic_add s36, s[28:29], s69
L_sig3:
    s_add_u32 s3, s2, 1
    s_and_b32 s3, s3, 3
    s_mul_i32 s3, s3, 6272
    buffer_load_dword v183, v14, s[16:19], s3 offen
    s_add_u32 s3, s2, 2
    s_and_b32 s3, s3, 3
    s_mul_i32 s3, s3, 6272
    buffer_load_dword v184, v14, s[16:19], s3 offen
    s_add_u32 s3, s2, 3
    s_and_b32 s3, s3, 3
    s_mul_i32 s3, s3, 6272
    buffer_load_dword v185, v14, s[16:19], s3 offen
    s_branch L_fin
L_pollin6:
    s_waitcnt lgkmcnt(0)
    s_cmp_ge_u32 s14, 8
    s_cbranch_scc1 L_pollok6
    s_mov_b32 s60, 0
    s_branch L_poll6a
L_poll6:
    s_sleep 8
L_poll6a:
    buffer_load_dword v18, off, s[28:31], s39 sc1
    s_add_u32 s60, s60, 1
    s_waitcnt vmcnt(0)
    v_readfirstlane_b32 s14, v18
    s_nop 0
    s_cmp_ge_u32 s14, 8
    s_cbranch_scc1 L_pollok6
    s_cmp_lt_u32 s60, 20000
    s_cbranch_scc1 L_poll6
    s_branch L_pollok6
L_pollin7:
    s_waitcnt lgkmcnt(0)
    s_cmp_ge_u32 s14, 1
    s_cbranch_scc1 L_pollok7
    s_mov_b32 s60, 0
    s_branch L_poll7a
L_poll7:
    s_sleep 4
L_poll7a:
    buffer_load_dword v18, off, s[28:31], s55 sc1
    s_add_u32 s60, s60, 1
    s_waitcnt vmcnt(0)
    v_readfirstlane_b32 s14, v18
    s_nop 0
    s_cmp_ge_u32 s14, 1
    s_cbranch_scc1 L_pollok7
    s_cmp_lt_u32 s60, 20000
    s_cbranch_scc1 L_poll7
    s_branch L_pollok7
L_last:
    s_endpgm
.section .rodata,"a"
.p2align 6
.amdhsa_kernel parallel_sum__sliding_local_dilated__mixer_token_mlp__prompt_kernel
  .amdhsa_next_free_vgpr 512
  .amdhsa_next_free_sgpr 102
  .amdhsa_accum_offset 256
  .amdhsa_group_segment_fixed_size 0
  .amdhsa_kernarg_size 88
  .amdhsa_user_sgpr_count 2
  .amdhsa_user_sgpr_kernarg_segment_ptr 1
  .amdhsa_system_sgpr_workgroup_id_x 1
.end_amdhsa_kernel
```

```asm
; @launch grid=(256,1,1) block=(256,1,1) lds=163840
.amdgcn_target "amdgcn-amd-amdhsa--gfx950"
.text
.globl parallel_sum__sliding_local_dilated__mixer_token_mlp__prompt_kernel
.p2align 8
.type parallel_sum__sliding_local_dilated__mixer_token_mlp__prompt_kernel,@function
parallel_sum__sliding_local_dilated__mixer_token_mlp__prompt_kernel:
    s_cmp_ge_u32 s2, 256
    s_cbranch_scc1 L_end
    s_load_dwordx2 s[8:9], s[0:1], 0
    s_load_dwordx2 s[20:21], s[0:1], 32
    s_load_dwordx2 s[28:29], s[0:1], 80
    s_load_dwordx2 s[44:45], s[0:1], 72
    s_load_dwordx2 s[12:13], s[0:1], 8
    s_load_dwordx2 s[16:17], s[0:1], 16
    s_load_dwordx2 s[24:25], s[0:1], 48
    s_load_dwordx2 s[32:33], s[0:1], 64
    s_load_dwordx2 s[36:37], s[0:1], 40
    s_load_dwordx2 s[40:41], s[0:1], 56
    s_memrealtime s[78:79]
    s_getpc_b64 s[6:7]
L_pc:
    s_and_b32 s3, s2, 0xf8
    v_lshrrev_b32 v13, 5, v0
    v_add_lshl_u32 v13, s3, v13, 7
    v_min_u32 v13, L_last-L_pc, v13
    global_load_dword v18, v13, s[6:7]
    v_lshrrev_b32 v13, 6, v0
    v_and_b32 v10, 31, v0
    v_readfirstlane_b32 s48, v13
    v_bfe_u32 v9, v0, 5, 1
    v_mul_u32_u24 v14, 896, v9
    v_lshl_add_u32 v14, v10, 4, v14
    v_cmp_gt_u32 vcc, 28, v10
    v_mov_b32 v15, 268435456
    s_mov_b32 s10, 1835008
    s_mov_b32 s11, 0x20000
    v_cndmask_b32 v14, v15, v14, vcc
    s_lshr_b32 s4, s48, 1
    s_and_b32 s5, s48, 1
    s_and_b32 s3, s2, 0xfe
    s_add_u32 s3, s3, s4
    s_lshl_b32 s3, s3, 1
    s_and_b32 s60, s2, 1
    s_add_u32 s3, s3, s60
    s_lshl_b32 s3, s3, 1
    s_add_u32 s3, s3, s5
    s_mul_i32 s3, s3, 1792
    s_waitcnt lgkmcnt(0)
    buffer_load_dwordx4 v[182:185], v14, s[8:11], s3 offen
    buffer_load_dwordx4 v[186:189], v14, s[8:11], s3 offen offset:448
    v_and_b32 v1, 63, v0
    s_mov_b32 s46, 256
    s_mov_b32 s47, 0x20000
    s_lshl_b32 s3, s48, 8
    s_add_u32 s3, s3, s2
    s_cmp_lt_u32 s3, 8
    s_cselect_b32 s3, 0, 268435456
    s_or_b32 s78, s78, 1
    v_mov_b32 v234, s78
    v_mov_b32 v235, 0
    v_lshlrev_b32 v11, 25, v1
    buffer_atomic_cmpswap v[234:235], v11, s[44:47], s3 offen sc1
    s_bfe_u32 s6, s2, 0x20001
    s_and_b32 s7, s2, 1
    s_and_b32 s61, s2, 7
    s_lshr_b32 s101, s2, 3
    s_mul_i32 s52, s7, 25
    s_add_u32 s52, s52, s101
    s_mul_i32 s51, s52, 37
    s_lshr_b32 s51, s51, 8
    s_mul_i32 s3, s51, 7
    s_sub_u32 s52, s52, s3
    s_and_b32 s3, s6, 1
    s_mul_i32 s3, s3, 6
    s_add_u32 s51, s51, s3
    s_add_u32 s51, s51, 1
    s_add_u32 s3, s3, s51
    s_cmp_eq_u32 s3, 7
    s_cselect_b32 s51, 0, s51
    s_lshr_b32 s59, s6, 1
    s_lshl_b32 s51, s51, 1
    s_add_u32 s51, s51, s59
    s_max_u32 s60, s101, 25
    s_sub_u32 s60, s60, 25
    s_add_u32 s3, s101, s7
    s_cmp_lt_u32 s3, 25
    s_cselect_b32 s55, 1, 0
    s_cselect_b32 s52, s52, s60
    s_mov_b32 s22, 7340032
    s_mov_b32 s23, 0x20000
    s_lshl_b32 s3, s52, 1
    s_sub_u32 s60, s3, 7
    s_cmp_ge_u32 s3, 7
    s_cselect_b32 s3, s60, s3
    s_and_b32 s3, s3, 7
    s_mul_i32 s60, s61, 2
    s_add_u32 s3, s3, s60
    s_and_b32 s3, s3, 7
    s_mul_i32 s0, s3, 458752
    s_lshl_b32 s1, s3, 13
    s_lshl_b32 s58, s48, 12
    v_lshrrev_b32 v3, 4, v1
    v_lshrrev_b32 v5, 3, v1
    v_and_b32 v6, 7, v1
    v_lshlrev_b32 v14, 1, v3
    v_xor_b32 v14, v14, v6
    v_lshlrev_b32 v83, 4, v14
    s_cmp_eq_u32 s55, 0
    s_cbranch_scc1 L_nog1
    v_mul_u32_u24 v14, 3584, v5
    s_lshl_b32 s3, s59, 5
    s_add_u32 s3, s3, s48
    s_mul_i32 s3, s3, 114688
    s_lshl_b32 s60, s51, 7
    s_add_u32 s3, s3, s60
    v_add3_u32 v55, v14, v83, s3
    v_add_u32 v56, 56320, v55
    v_add_u32 v57, 26624, v55
    v_add_u32 v58, 82944, v55
    s_mov_b32 s38, 3584
    s_mov_b32 s39, 0x20000
    v_lshlrev_b32 v13, 3, v3
    s_lshl_b32 s3, s51, 1
    s_add_u32 s3, s3, s4
    s_lshl_b32 s3, s3, 6
    buffer_load_dwordx2 v[246:247], v13, s[36:39], s3 offen offset:0
    buffer_load_dwordx2 v[248:249], v13, s[36:39], s3 offen offset:32
    s_add_u32 m0, s58, 0
    v_xor_b32 v55, 128, v55
    buffer_load_dwordx4 v55, s[20:23], s0 offen lds
    v_xor_b32 v56, 128, v56
    buffer_load_dwordx4 v56, s[20:23], s0 offen offset:1024 lds
    v_xor_b32 v57, 128, v57
    buffer_load_dwordx4 v57, s[20:23], s0 offen offset:2048 lds
    v_xor_b32 v58, 128, v58
    buffer_load_dwordx4 v58, s[20:23], s0 offen offset:3072 lds
    s_mul_i32 s53, s101, 37
    s_lshr_b32 s53, s53, 8
    s_mul_i32 s54, s53, 7
    s_sub_u32 s54, s101, s54
    s_and_b32 s53, s53, 3
    s_xor_b32 s53, s53, 0
    s_lshl_b32 s3, s6, 2
    s_add_u32 s53, s53, s3
    s_lshl_b32 s53, s53, 1
    s_add_u32 s53, s53, s7
    s_mov_b32 s42, 4096
    s_mov_b32 s43, 0x20000
    s_lshl_b32 s3, s53, 2
    s_add_u32 s3, s3, s48
    s_lshl_b32 s60, s3, 5
    v_lshl_add_u32 v82, v5, 1, s60
    s_mul_i32 s3, s3, 14336
    s_lshl_b32 s60, s54, 7
    s_add_u32 s3, s3, s60
    v_mul_u32_u24 v14, 896, v5
    v_lshl_add_u32 v14, v6, 4, v14
    v_add_u32 v85, s3, v14
    v_add_u32 v86, 7168, v85
    s_cmp_lt_u32 s101, 28
    s_cselect_b32 s56, 1, 0
    s_lshl_b32 s50, s7, 3
    s_and_b32 s3, s101, 7
    s_add_u32 s50, s50, s3
    s_lshr_b32 s60, s101, 3
    s_lshl_b32 s49, s6, 2
    s_add_u32 s49, s49, s60
    s_lshl_b32 s49, s49, 2
    s_add_u32 s49, s49, s48
    s_mul_i32 s60, s60, 0
    s_add_u32 s3, s3, s60
    s_sub_u32 s60, s3, 7
    s_cmp_ge_u32 s3, 7
    s_cselect_b32 s3, s60, s3
    s_lshl_b32 s62, s3, 18
    s_mul_i32 s63, s3, 12288
    s_mov_b32 s30, 20971520
    s_mov_b32 s31, 0x20000
    s_mov_b32 s75, 0x3727c5ac
    s_mov_b32 s76, 0x3b124925
    s_mov_b32 s77, 0x3f803f80
    v_lshlrev_b32 v4, 4, v1
    v_bfe_u32 v7, v1, 2, 2
    v_and_b32 v8, 3, v1
    v_mul_u32_u24 v13, 960, v9
    v_lshl_add_u32 v13, v10, 4, v13
    s_mul_i32 s3, s48, 1920
    s_add_u32 s3, s3, 147456
    v_add_u32 v230, s3, v13
    v_mul_u32_u24 v13, 960, v7
    v_lshl_add_u32 v13, v3, 5, v13
    v_lshl_add_u32 v13, v8, 3, v13
    s_lshl_b32 s3, s48, 8
    s_add_u32 s3, s3, 147456
    v_add_u32 v231, s3, v13
    s_lshl_b32 s3, s48, 3
    s_add_u32 s3, s3, 155648
    v_lshl_add_u32 v232, v9, 2, s3
    v_lshlrev_b32 v237, 2, v6
    v_and_b32 v2, 15, v1
    v_lshlrev_b32 v238, 14, v3
    v_add_lshl_u32 v238, v238, v2, 2
    v_add_u32 v237, 155648, v237
    v_lshlrev_b32 v13, 17, v9
    v_lshl_add_u32 v233, v10, 4, v13
    s_cmp_eq_u32 s48, 3
    s_cselect_b32 s60, 268435456, 0
    s_lshl_b32 s70, s48, 10
    s_add_u32 s70, s70, s2
    s_lshl_b32 s70, s70, 9
    s_add_u32 s71, s70, 262144
    s_add_u32 s71, s71, s60
    s_xor_b32 s60, s60, 268435456
    s_lshl_b32 s72, s2, 7
    s_add_u32 s72, s72, s60
    s_add_u32 s72, s72, 6291456
    s_lshr_b32 s74, s2, 2
    s_lshl_b32 s74, s74, 5
    s_and_b32 s3, s2, 3
    s_add_u32 s74, s74, s3
    s_lshl_b32 s74, s74, 2
    s_add_u32 s74, s74, 10485760
    v_cmp_gt_u32 vcc, 8, v0
    v_lshlrev_b32 v236, 13, v0
    v_mov_b32 v13, 268435456
    s_and_b32 s3, s2, 7
    s_lshl_b32 s3, s3, 13
    s_add_u32 s3, s3, 10485760
    v_lshrrev_b32 v14, 2, v0
    v_lshl_add_u32 v14, v14, 7, s3
    v_lshl_add_u32 v20, v8, 2, v14
    v_cndmask_b32 v236, v13, v236, vcc
    v_mov_b32 v16, 0
    s_lshl_b32 s3, s48, 14
    s_add_u32 s74, s74, s3
    s_add_u32 s73, s74, 8192
    s_waitcnt vmcnt(8)
    v_dot2_f32_bf16 v226, v182, s77, 0
    v_dot2_f32_bf16 v227, v182, v182, 0
    v_dot2_f32_bf16 v226, v183, s77, v226
    v_dot2_f32_bf16 v227, v183, v183, v227
    v_dot2_f32_bf16 v226, v184, s77, v226
    v_dot2_f32_bf16 v227, v184, v184, v227
    v_dot2_f32_bf16 v226, v185, s77, v226
    v_dot2_f32_bf16 v227, v185, v185, v227
    s_waitcnt vmcnt(7)
    v_dot2_f32_bf16 v226, v186, s77, v226
    v_dot2_f32_bf16 v227, v186, v186, v227
    v_dot2_f32_bf16 v226, v187, s77, v226
    v_dot2_f32_bf16 v227, v187, v187, v227
    v_dot2_f32_bf16 v226, v188, s77, v226
    v_dot2_f32_bf16 v227, v188, v188, v227
    v_dot2_f32_bf16 v226, v189, s77, v226
    v_dot2_f32_bf16 v227, v189, v189, v227
    buffer_load_dword v12, v16, s[44:47], 0 offen sc1
    v_lshlrev_b32 v190, 16, v182
    v_and_b32 v191, 0xffff0000, v182
    v_add_f32_dpp v226, v226, v226 quad_perm:[1,0,3,2] row_mask:0xf bank_mask:0xf
    v_add_f32_dpp v227, v227, v227 quad_perm:[1,0,3,2] row_mask:0xf bank_mask:0xf
    v_lshlrev_b32 v192, 16, v183
    v_add_f32_dpp v226, v226, v226 quad_perm:[2,3,0,1] row_mask:0xf bank_mask:0xf
    v_add_f32_dpp v227, v227, v227 quad_perm:[2,3,0,1] row_mask:0xf bank_mask:0xf
    v_and_b32 v193, 0xffff0000, v183
    v_add_f32_dpp v226, v226, v226 row_half_mirror row_mask:0xf bank_mask:0xf
    v_add_f32_dpp v227, v227, v227 row_half_mirror row_mask:0xf bank_mask:0xf
    v_lshlrev_b32 v194, 16, v184
    v_add_f32_dpp v226, v226, v226 row_mirror row_mask:0xf bank_mask:0xf
    v_add_f32_dpp v227, v227, v227 row_mirror row_mask:0xf bank_mask:0xf
    v_and_b32 v195, 0xffff0000, v184
    v_mov_b32 v228, v226
    v_mov_b32 v229, v227
    v_lshlrev_b32 v196, 16, v185
    v_permlane16_swap_b32 v226, v228
    v_permlane16_swap_b32 v227, v229
    v_add_f32 v226, v226, v228
    v_add_f32 v227, v227, v229
    v_mul_f32_e64 v226, -v226, s76
    v_mul_f32 v228, v226, v226
    v_fma_f32 v227, v227, s76, -v228
    v_max_f32 v227, 0, v227
    v_add_f32 v228, s75, v227
    v_rsq_f32 v222, v228
    v_and_b32 v197, 0xffff0000, v185
    v_mul_f32 v228, v222, v222
    v_fma_f32 v229, v228, v227, s75
    v_rsq_f32 v228, v229
    v_mul_f32 v223, v226, v222
    v_mul_f32 v224, v222, v228
    v_mul_f32 v225, v223, v228
    v_mul_f32 v229, v229, v228
    ds_write_b32 v232, v229
    v_lshlrev_b32 v198, 16, v186
    v_and_b32 v199, 0xffff0000, v186
    v_lshlrev_b32 v200, 16, v187
    v_and_b32 v201, 0xffff0000, v187
    v_lshlrev_b32 v202, 16, v188
    v_and_b32 v203, 0xffff0000, v188
    v_lshlrev_b32 v204, 16, v189
    v_and_b32 v205, 0xffff0000, v189
    v_pk_fma_f32 v[206:207], v[190:191], v[224:225], v[224:225] op_sel:[0,0,1] op_sel_hi:[1,0,1]
    v_pk_fma_f32 v[208:209], v[192:193], v[224:225], v[224:225] op_sel:[0,0,1] op_sel_hi:[1,0,1]
    v_pk_fma_f32 v[210:211], v[194:195], v[224:225], v[224:225] op_sel:[0,0,1] op_sel_hi:[1,0,1]
    v_pk_fma_f32 v[212:213], v[196:197], v[224:225], v[224:225] op_sel:[0,0,1] op_sel_hi:[1,0,1]
    v_cvt_pk_bf16_f32 v182, v206, v207
    v_cvt_pk_bf16_f32 v183, v208, v209
    v_cvt_pk_bf16_f32 v184, v210, v211
    v_cvt_pk_bf16_f32 v185, v212, v213
    ds_write_b128 v230, v[182:185] offset:0
    v_pk_fma_f32 v[214:215], v[198:199], v[224:225], v[224:225] op_sel:[0,0,1] op_sel_hi:[1,0,1]
    v_pk_fma_f32 v[216:217], v[200:201], v[224:225], v[224:225] op_sel:[0,0,1] op_sel_hi:[1,0,1]
    v_pk_fma_f32 v[218:219], v[202:203], v[224:225], v[224:225] op_sel:[0,0,1] op_sel_hi:[1,0,1]
    v_pk_fma_f32 v[220:221], v[204:205], v[224:225], v[224:225] op_sel:[0,0,1] op_sel_hi:[1,0,1]
    v_cvt_pk_bf16_f32 v186, v214, v215
    v_cvt_pk_bf16_f32 v187, v216, v217
    v_cvt_pk_bf16_f32 v188, v218, v219
    v_cvt_pk_bf16_f32 v189, v220, v221
    ds_write_b128 v230, v[186:189] offset:448
    s_waitcnt lgkmcnt(0)
    s_barrier
    ds_read_b64_tr_b16 v[110:111], v231 offset:0
    ds_read_b64_tr_b16 v[112:113], v231 offset:3840
    ds_read_b64_tr_b16 v[114:115], v231 offset:128
    ds_read_b64_tr_b16 v[116:117], v231 offset:3968
    ds_read_b32 v229, v237
    s_waitcnt lgkmcnt(3)
    buffer_store_dwordx4 v[110:113], v233, s[28:31], s70 offen sc1
    s_waitcnt lgkmcnt(1)
    buffer_store_dwordx4 v[114:117], v233, s[28:31], s71 offen sc1
    v_cmp_gt_u32 vcc, 16, v1
    s_waitcnt lgkmcnt(0)
    s_nop 0
    v_cndmask_b32 v229, 0, v229, vcc
    buffer_store_dword v229, v238, s[28:31], s72 offen sc1
    s_add_u32 m0, s58, 16384
    s_add_u32 s0, s0, 458752
    s_cmp_eq_u32 s0, 3670016
    s_cselect_b32 s0, 0, s0
    buffer_load_dwordx4 v55, s[20:23], s0 offen lds
    buffer_load_dwordx4 v56, s[20:23], s0 offen offset:1024 lds
    buffer_load_dwordx4 v57, s[20:23], s0 offen offset:2048 lds
    buffer_load_dwordx4 v58, s[20:23], s0 offen offset:3072 lds
    s_branch L_anchor
.p2align 12
L_anchor:
    s_mov_b32 s18, 401408
    s_mov_b32 s19, 0x20000
    s_mov_b32 s26, 7340032
    s_mov_b32 s27, 0x20000
    s_mov_b32 s34, 1835008
    s_mov_b32 s35, 0x20000
    s_mov_b32 s36, 1
    v_lshrrev_b32 v14, 2, v1
    v_lshlrev_b32 v14, 7, v14
    v_lshl_add_u32 v14, v8, 3, v14
    v_and_b32 v15, 3, v5
    v_lshl_add_u32 v14, v15, 5, v14
    s_mul_i32 s3, s4, 8256
    v_xor_b32 v31, s3, v14
    v_xor_b32 v32, 32, v31
    v_xor_b32 v33, 64, v31
    v_xor_b32 v34, 96, v31
    v_add_u32 v35, 65536, v31
    v_add_u32 v36, 65536, v32
    v_add_u32 v37, 65536, v33
    v_add_u32 v38, 65536, v34
    v_add_u32 v39, 131072, v31
    v_add_u32 v40, 131072, v32
    v_add_u32 v41, 131072, v33
    v_add_u32 v42, 131072, v34
    s_lshl_b32 s6, s52, 1
    s_add_u32 s6, s6, s5
    s_lshl_b32 s3, s6, 1
    s_add_u32 s3, s3, s59
    s_lshl_b32 s3, s3, 4
    s_add_u32 s3, s3, s4
    s_lshl_b32 s3, s3, 12
    v_lshl_add_u32 v78, v3, 8, v4
    v_add_u32 v78, s3, v78
    s_xor_b32 s37, s51, 1
    s_lshl_b32 s37, s37, 3
    s_add_u32 s37, s37, s52
    s_lshl_b32 s3, s37, 14
    s_add_u32 s3, s3, s58
    s_add_u32 s3, s3, 16777216
    v_add_u32 v23, s3, v4
    s_lshl_b32 s37, s37, 5
    s_add_u32 s37, s37, s5
    s_lshl_b32 s37, s37, 2
    s_add_u32 s37, s37, 6422528
    s_mul_i32 s67, s6, 56
    s_lshl_b32 s3, s51, 1
    s_add_u32 s3, s3, s4
    s_add_u32 s67, s67, s3
    s_lshl_b32 s67, s67, 11
    s_add_u32 s67, s67, 2097152
    v_add_u32 v81, s58, v4
    s_lshl_b32 s68, s52, 2
    s_and_b32 s3, s51, 1
    s_add_u32 s68, s68, s3
    s_cmp_ge_u32 s51, 14
    s_cselect_b32 s3, 2, 0
    s_add_u32 s68, s68, s3
    s_lshl_b32 s68, s68, 7
    s_add_u32 s68, s68, 6356992
    s_waitcnt vmcnt(7)
    v_readfirstlane_b32 s57, v12
    s_mov_b32 s60, 0
    s_cmp_lg_u32 s57, 0
    s_cbranch_scc0 L_nonce
L_nonce_ok:
    s_waitcnt vmcnt(4)
    s_barrier
    s_atomic_swap s57, s[28:29], s74
    s_atomic_swap s57, s[28:29], s73
    buffer_load_dwordx4 v[96:99], v85, s[8:11], 0 offen
    buffer_load_ushort v93, v82, s[40:43], 0 offen offset:0
    buffer_load_dwordx4 v[100:103], v86, s[8:11], 0 offen
    buffer_load_ushort v94, v82, s[40:43], 0 offen offset:16
    v_add_u32 v53, 65536, v4
    s_add_u32 m0, s58, 32768
    s_add_u32 s0, s0, 458752
    s_cmp_eq_u32 s0, 3670016
    s_cselect_b32 s0, 0, s0
    buffer_load_dwordx4 v55, s[20:23], s0 offen lds
    v_add_u32 v54, 131072, v4
    s_mul_i32 s59, s48, 3072
    s_mul_i32 s3, s50, 86016
    s_add_u32 s3, s3, s59
    s_add_u32 s3, s3, 8388608
    v_add_u32 v80, s3, v4
    v_lshlrev_b32 v14, 7, v9
    v_xor_b32 v14, v14, v4
    s_lshl_b32 s3, s49, 11
    v_add_u32 v67, s3, v14
    v_add_u32 v68, 129024, v67
    s_lshr_b32 s3, s49, 2
    s_lshl_b32 s3, s3, 3
    s_max_u32 s3, s3, 1
    s_sub_u32 s3, s3, 1
    s_lshl_b32 s3, s3, 10
    s_lshl_b32 s6, s5, 17
    s_add_u32 s3, s3, s6
    s_lshl_b32 s6, s4, 28
    s_add_u32 s3, s3, s6
    v_add_u32 v69, s3, v14
    buffer_load_dwordx4 v56, s[20:23], s0 offen offset:1024 lds
    s_lshl_b32 s100, s5, 1
    s_add_u32 s100, s100, s4
    s_lshl_b32 s100, s100, 10
    v_and_b32 v14, 1, v1
    v_mul_u32_u24 v14, 640, v14
    v_lshrrev_b32 v15, 2, v1
    v_lshlrev_b32 v15, 4, v15
    v_xor_b32 v14, v14, v15
    v_bfe_u32 v15, v1, 1, 1
    v_lshl_add_u32 v14, v15, 3, v14
    buffer_load_dwordx4 v57, s[20:23], s0 offen offset:2048 lds
    s_add_u32 s3, s58, 12288
    v_add_u32 v70, s3, v14
    s_sub_u32 s3, s3, 3072
    s_cmp_eq_u32 s48, 0
    s_cselect_b32 s3, 28672, s3
    v_add_u32 v71, s3, v14
    v_add_u32 v72, 65536, v70
    v_add_u32 v73, 65536, v71
    v_add_u32 v74, 131072, v70
    v_add_u32 v75, 131072, v71
    s_lshl_b32 s3, s49, 1
    v_min_u32 v14, 2, v3
    v_add_u32 v14, s3, v14
    v_max_u32 v14, 1, v14
    v_lshlrev_b32 v14, 1, v14
    v_and_b32 v15, 1, v7
    buffer_load_dwordx4 v58, s[20:23], s0 offen offset:3072 lds
    v_add_lshl_u32 v14, v14, v15, 7
    v_lshrrev_b32 v15, 1, v7
    v_lshl_add_u32 v15, v15, 2, v8
    v_lshl_add_u32 v14, v15, 2, v14
    v_add_u32 v77, 6291200, v14
    s_min_u32 s15, s48, 2
    s_lshl_b32 s15, s15, 6
    s_add_u32 s15, s15, 64
    s_lshl_b32 s82, s49, 5
    s_add_u32 s82, s82, s50
    s_lshl_b32 s82, s82, 10
    s_add_u32 s82, s82, 4194304
    s_lshr_b32 s69, s49, 2
    s_lshl_b32 s69, s69, 1
    s_and_b32 s3, s50, 1
    s_add_u32 s69, s69, s3
    s_lshl_b32 s69, s69, 7
    s_add_u32 s69, s69, 6361088
    s_and_b32 s7, s53, 1
    s_mul_i32 s3, s7, 28
    s_add_u32 s3, s3, s48
    s_lshl_b32 s3, s3, 17
    s_xor_b32 s6, s53, 1
    s_lshl_b32 s55, s6, 3
    s_lshl_b32 s6, s53, 7
    s_add_u32 s3, s3, s6
    v_lshlrev_b32 v14, 12, v5
    s_add_u32 m0, s58, 49152
    s_add_u32 s0, s0, 458752
    s_cmp_eq_u32 s0, 3670016
    s_cselect_b32 s0, 0, s0
    buffer_load_dwordx4 v55, s[20:23], s0 offen lds
    v_add3_u32 v59, v14, v83, s3
    v_add_u32 v60, 31744, v59
    v_add_u32 v61, 63488, v59
    v_add_u32 v62, 95232, v59
    v_mul_u32_u24 v14, 896, v5
    s_mul_i32 s3, s4, 25088
    s_mul_i32 s6, s5, 14336
    s_add_u32 s3, s3, s6
    s_lshl_b32 s6, s54, 7
    s_add_u32 s3, s3, s6
    v_add3_u32 v63, v14, v83, s3
    buffer_load_dwordx4 v56, s[20:23], s0 offen offset:1024 lds
    v_add_u32 v64, 6144, v63
    s_lshl_b32 s6, s53, 1
    s_add_u32 s6, s6, s5
    s_and_b32 s3, s53, 30
    s_add_u32 s3, s3, s4
    s_lshl_b32 s3, s3, 7
    s_add_u32 s39, s3, 6361088
    s_lshl_b32 s3, s6, 5
    s_add_u32 s3, s3, s4
    s_lshl_b32 s3, s3, 10
    s_add_u32 s3, s3, 4194304
    v_add_u32 v65, s3, v4
    v_add_u32 v66, 15360, v65
    s_xor_b32 s3, s4, s5
    s_lshl_b32 s3, s3, 6
    v_xor_b32 v43, s3, v31
    buffer_load_dwordx4 v57, s[20:23], s0 offen offset:2048 lds
    v_xor_b32 v44, 32, v43
    v_add_u32 v45, 65536, v43
    v_add_u32 v46, 65536, v44
    s_mul_i32 s3, s4, 12288
    v_add_u32 v47, s3, v4
    v_xor_b32 v48, 4096, v47
    v_add_u32 v49, 65536, v47
    v_add_u32 v50, 65536, v48
    v_add_u32 v51, 131072, v47
    v_add_u32 v52, 131072, v48
    s_lshl_b32 s6, s54, 1
    s_add_u32 s6, s6, s5
    s_lshl_b32 s3, s6, 1
    s_add_u32 s3, s3, s7
    s_mul_i32 s3, s3, 14
    s_add_u32 s3, s3, s4
    s_lshl_b32 s3, s3, 12
    s_add_u32 s3, s3, 2097152
    v_add_u32 v79, s3, v4
    buffer_load_dwordx4 v58, s[20:23], s0 offen offset:3072 lds
    s_lshl_b32 s3, s54, 1
    s_add_u32 s3, s3, s7
    s_lshl_b32 s3, s3, 1
    s_add_u32 s3, s3, s4
    s_lshl_b32 s3, s3, 7
    s_add_u32 s38, s3, 6356992
    s_and_b32 s3, s2, 6
    s_add_u32 s3, s3, s54
    s_sub_u32 s6, s3, 7
    s_cmp_ge_u32 s3, 7
    s_cselect_b32 s3, s6, s3
    s_lshl_b32 s64, s3, 19
    s_lshl_b32 s65, s3, 13
    s_add_u32 s55, s55, s54
    s_lshl_b32 s3, s55, 14
    s_add_u32 s3, s3, s58
    s_add_u32 s3, s3, 12582912
    v_add_u32 v21, s3, v4
    s_add_u32 m0, s58, 65536
    s_add_u32 s0, s0, 458752
    s_cmp_eq_u32 s0, 3670016
    s_cselect_b32 s0, 0, s0
    buffer_load_dwordx4 v55, s[20:23], s0 offen lds
    s_lshl_b32 s55, s55, 5
    s_add_u32 s55, s55, s48
    s_lshl_b32 s55, s55, 2
    s_add_u32 s55, s55, 6488064
    s_lshl_b32 s3, s5, 3
    v_add_u32 v13, s3, v3
    v_xor_b32 v13, v13, v6
    v_lshlrev_b32 v13, 4, v13
    v_lshl_add_u32 v13, v2, 8, v13
    buffer_load_dwordx4 v56, s[20:23], s0 offen offset:1024 lds
    s_lshl_b32 s3, s4, 14
    s_add_u32 s3, s3, 32768
    v_add_u32 v87, s3, v13
    v_xor_b32 v88, 64, v87
    s_lshr_b32 s3, s53, 1
    s_add_u32 s66, s3, s54
    s_mov_b32 s51, s66
    v_lshlrev_b32 v13, 1, v6
    v_xor_b32 v13, v13, v5
    v_lshlrev_b32 v13, 4, v13
    v_lshl_add_u32 v13, v5, 8, v13
    s_add_u32 s3, s58, 32768
    v_add_u32 v89, s3, v13
    v_xor_b32 v90, 16, v89
    v_xor_b32 v91, 24576, v89
    v_xor_b32 v92, 24592, v89
    buffer_load_dwordx4 v57, s[20:23], s0 offen offset:2048 lds
    v_lshlrev_b32 v150, 16, v246
    v_and_b32 v151, 0xffff0000, v246
    v_lshlrev_b32 v152, 16, v247
    v_and_b32 v153, 0xffff0000, v247
    v_lshlrev_b32 v154, 16, v248
    v_and_b32 v155, 0xffff0000, v248
    v_lshlrev_b32 v156, 16, v249
    v_and_b32 v157, 0xffff0000, v249
    v_lshlrev_b32 v158, 16, v246
    v_and_b32 v159, 0xffff0000, v246
    v_lshlrev_b32 v160, 16, v247
    v_and_b32 v161, 0xffff0000, v247
    v_lshlrev_b32 v162, 16, v248
    v_and_b32 v163, 0xffff0000, v248
    v_lshlrev_b32 v164, 16, v249
    v_and_b32 v165, 0xffff0000, v249
    buffer_load_dwordx4 v58, s[20:23], s0 offen offset:3072 lds
    s_add_u32 m0, s58, 81920
    s_add_u32 s0, s0, 458752
    s_cmp_eq_u32 s0, 3670016
    s_cselect_b32 s0, 0, s0
    buffer_load_dwordx4 v55, s[20:23], s0 offen lds
    buffer_load_dwordx4 v56, s[20:23], s0 offen offset:1024 lds
    buffer_load_dwordx4 v57, s[20:23], s0 offen offset:2048 lds
    buffer_load_dwordx4 v58, s[20:23], s0 offen offset:3072 lds
    s_add_u32 m0, s58, 98304
    s_add_u32 s0, s0, 458752
    s_cmp_eq_u32 s0, 3670016
    s_cselect_b32 s0, 0, s0
    buffer_load_dwordx4 v55, s[20:23], s0 offen lds
    buffer_load_dwordx4 v56, s[20:23], s0 offen offset:1024 lds
    buffer_load_dwordx4 v57, s[20:23], s0 offen offset:2048 lds
    buffer_load_dwordx4 v58, s[20:23], s0 offen offset:3072 lds
    buffer_load_dword v18, v20, s[28:31], 0 offen sc1
    s_add_u32 m0, s58, 114688
    s_add_u32 s0, s0, 458752
    s_cmp_eq_u32 s0, 3670016
    s_cselect_b32 s0, 0, s0
    buffer_load_dwordx4 v55, s[20:23], s0 offen lds
    buffer_load_dwordx4 v56, s[20:23], s0 offen offset:1024 lds
    buffer_load_dwordx4 v57, s[20:23], s0 offen offset:2048 lds
    buffer_load_dwordx4 v58, s[20:23], s0 offen offset:3072 lds
    s_mov_b32 s3, s48
    s_mov_b64 exec, 0
L_warm:
    s_add_u32 s3, s3, 4
    s_cmp_eq_u32 s3, 4
    s_cbranch_scc1 L_pad0
    s_cmp_eq_u32 s3, 5
    s_cbranch_scc1 L_pad1
    s_cmp_eq_u32 s3, 6
    s_cbranch_scc1 L_pad2
    s_cmp_eq_u32 s3, 7
    s_cbranch_scc1 L_pad3
    s_cmp_eq_u32 s3, 8
    s_cbranch_scc1 L_pad4
    s_mov_b64 exec, -1
    s_waitcnt vmcnt(4)
    v_cmp_ne_u32 vcc, s57, v18
    s_cbranch_vccnz L_pollin0
L_pollok0:
    s_barrier
    buffer_load_dwordx4 a[0:3], v78, s[28:31], s1 offen offset:0 sc1
    buffer_load_dwordx4 a[4:7], v78, s[28:31], s1 offen offset:256 sc1
    buffer_load_dwordx4 a[8:11], v78, s[28:31], s1 offen offset:2048 sc1
    buffer_load_dwordx4 a[12:15], v78, s[28:31], s1 offen offset:2304 sc1
    buffer_load_dword v76, v77, s[28:31], 0 offen sc1
    s_add_u32 s1, s1, 8192
    s_and_b32 s1, s1, 0xffff
    buffer_load_dwordx4 a[16:19], v78, s[28:31], s1 offen offset:0 sc1
    buffer_load_dwordx4 a[20:23], v78, s[28:31], s1 offen offset:256 sc1
    buffer_load_dwordx4 a[24:27], v78, s[28:31], s1 offen offset:2048 sc1
    buffer_load_dwordx4 a[28:31], v78, s[28:31], s1 offen offset:2304 sc1
    s_add_u32 s1, s1, 8192
    s_and_b32 s1, s1, 0xffff
    buffer_load_dwordx4 a[32:35], v78, s[28:31], s1 offen offset:0 sc1
    buffer_load_dwordx4 a[36:39], v78, s[28:31], s1 offen offset:256 sc1
    buffer_load_dwordx4 a[40:43], v78, s[28:31], s1 offen offset:2048 sc1
    buffer_load_dwordx4 a[44:47], v78, s[28:31], s1 offen offset:2304 sc1
    ds_read_b64_tr_b16 a[200:201], v31 offset:0
    ds_read_b64_tr_b16 a[202:203], v31 offset:2048
    ds_read_b64_tr_b16 a[204:205], v33 offset:0
    ds_read_b64_tr_b16 a[206:207], v33 offset:2048
    ds_read_b64_tr_b16 a[208:209], v32 offset:0
    ds_read_b64_tr_b16 a[210:211], v32 offset:2048
    ds_read_b64_tr_b16 a[212:213], v34 offset:0
    ds_read_b64_tr_b16 a[214:215], v34 offset:2048
    ds_read_b64_tr_b16 a[216:217], v31 offset:4096
    ds_read_b64_tr_b16 a[218:219], v31 offset:6144
    ds_read_b64_tr_b16 a[220:221], v33 offset:4096
    ds_read_b64_tr_b16 a[222:223], v33 offset:6144
    s_waitcnt vmcnt(11) lgkmcnt(8)
    v_mfma_f32_16x16x32_bf16 v[182:185], a[200:203], a[0:3], 0
    ds_read_b64_tr_b16 a[224:225], v32 offset:4096
    s_add_u32 s1, s1, 8192
    v_mfma_f32_16x16x32_bf16 v[190:193], a[200:203], a[4:7], 0
    ds_read_b64_tr_b16 a[226:227], v32 offset:6144
    s_and_b32 s1, s1, 0xffff
    s_mov_b32 s70, 0xaaaaaaaa
    s_mov_b32 s71, 0xaaaaaaaa
    s_mov_b32 s72, 0xfff0ffff
    s_mov_b32 s73, 0xf000ff00
    s_mov_b32 s74, 0xffc0fffc
    v_mfma_f32_16x16x32_bf16 v[198:201], a[204:207], a[0:3], 0
    ds_read_b64_tr_b16 a[228:229], v34 offset:4096
    buffer_load_dwordx4 a[48:51], v78, s[28:31], s1 offen offset:0 sc1
    v_mfma_f32_16x16x32_bf16 v[206:209], a[204:207], a[4:7], 0
    ds_read_b64_tr_b16 a[230:231], v34 offset:6144
    s_mov_b32 s75, 0xc000fc00
    s_waitcnt lgkmcnt(8)
    v_mfma_f32_16x16x32_bf16 v[186:189], a[208:211], a[0:3], 0
    ds_read_b64_tr_b16 a[200:201], v31 offset:16384
    s_mov_b32 s83, 0x3e8b97f6
    v_mfma_f32_16x16x32_bf16 v[194:197], a[208:211], a[4:7], 0
    ds_read_b64_tr_b16 a[202:203], v31 offset:18432
    buffer_load_dwordx4 a[52:55], v78, s[28:31], s1 offen offset:256 sc1
    v_lshlrev_b32 v13, 2, v2
    v_mfma_f32_16x16x32_bf16 v[202:205], a[212:215], a[0:3], 0
    ds_read_b64_tr_b16 a[204:205], v33 offset:16384
    v_and_b32 v14, 1, v1
    v_mfma_f32_16x16x32_bf16 v[210:213], a[212:215], a[4:7], 0
    ds_read_b64_tr_b16 a[206:207], v33 offset:18432
    s_waitcnt vmcnt(11) lgkmcnt(8)
    v_mfma_f32_16x16x32_bf16 v[182:185], a[216:219], a[8:11], v[182:185]
    ds_read_b64_tr_b16 a[208:209], v32 offset:16384
    buffer_load_dwordx4 a[56:59], v78, s[28:31], s1 offen offset:2048 sc1
    v_mfma_f32_16x16x32_bf16 v[190:193], a[216:219], a[12:15], v[190:193]
    ds_read_b64_tr_b16 a[210:211], v32 offset:18432
    v_lshl_add_u32 v14, v3, 2, v14
    v_mfma_f32_16x16x32_bf16 v[198:201], a[220:223], a[8:11], v[198:201]
    ds_read_b64_tr_b16 a[212:213], v34 offset:16384
    v_lshlrev_b32 v14, 2, v14
    v_mfma_f32_16x16x32_bf16 v[206:209], a[220:223], a[12:15], v[206:209]
    ds_read_b64_tr_b16 a[214:215], v34 offset:18432
    s_waitcnt lgkmcnt(8)
    v_mfma_f32_16x16x32_bf16 v[186:189], a[224:227], a[8:11], v[186:189]
    ds_read_b64_tr_b16 a[216:217], v31 offset:20480
    buffer_load_dwordx4 a[60:63], v78, s[28:31], s1 offen offset:2304 sc1
    v_mfma_f32_16x16x32_bf16 v[194:197], a[224:227], a[12:15], v[194:197]
    ds_read_b64_tr_b16 a[218:219], v31 offset:22528
    s_add_u32 s1, s1, 8192
    v_add_u32 v15, 64, v14
    v_mfma_f32_16x16x32_bf16 v[202:205], a[228:231], a[8:11], v[202:205]
    ds_read_b64_tr_b16 a[220:221], v33 offset:20480
    s_and_b32 s1, s1, 0xffff
    v_mfma_f32_16x16x32_bf16 v[210:213], a[228:231], a[12:15], v[210:213]
    ds_read_b64_tr_b16 a[222:223], v33 offset:22528
    s_waitcnt vmcnt(10) lgkmcnt(8)
    v_mfma_f32_16x16x32_bf16 v[182:185], a[200:203], a[16:19], v[182:185]
    ds_read_b64_tr_b16 a[224:225], v32 offset:20480
    buffer_load_dwordx4 a[64:67], v78, s[28:31], s1 offen offset:0 sc1
    v_mfma_f32_16x16x32_bf16 v[190:193], a[200:203], a[20:23], v[190:193]
    ds_read_b64_tr_b16 a[226:227], v32 offset:22528
    v_cndmask_b32 v16, v14, v15, s[72:73]
    v_mfma_f32_16x16x32_bf16 v[198:201], a[204:207], a[16:19], v[198:201]
    ds_read_b64_tr_b16 a[228:229], v34 offset:20480
    buffer_load_dwordx4 a[68:71], v78, s[28:31], s1 offen offset:256 sc1
    v_mfma_f32_16x16x32_bf16 v[206:209], a[204:207], a[20:23], v[206:209]
    ds_read_b64_tr_b16 a[230:231], v34 offset:22528
    v_cndmask_b32 v14, v14, v15, s[74:75]
    s_waitcnt lgkmcnt(8)
    v_mfma_f32_16x16x32_bf16 v[186:189], a[208:211], a[16:19], v[186:189]
    ds_read_b64_tr_b16 a[200:201], v31 offset:32768
    ds_bpermute_b32 v25, v13, v76 offset:64
    v_mfma_f32_16x16x32_bf16 v[194:197], a[208:211], a[20:23], v[194:197]
    ds_read_b64_tr_b16 a[202:203], v31 offset:34816
    buffer_load_dwordx4 a[72:75], v78, s[28:31], s1 offen offset:2048 sc1
    ds_bpermute_b32 v27, v16, v76 offset:0
    v_mfma_f32_16x16x32_bf16 v[202:205], a[212:215], a[16:19], v[202:205]
    ds_read_b64_tr_b16 a[204:205], v33 offset:32768
    ds_bpermute_b32 v28, v14, v76 offset:8
    v_mfma_f32_16x16x32_bf16 v[210:213], a[212:215], a[20:23], v[210:213]
    ds_read_b64_tr_b16 a[206:207], v33 offset:34816
    s_waitcnt vmcnt(11) lgkmcnt(11)
    v_mfma_f32_16x16x32_bf16 v[182:185], a[216:219], a[24:27], v[182:185]
    ds_read_b64_tr_b16 a[208:209], v32 offset:32768
    ds_bpermute_b32 v26, v13, v76 offset:128
    v_mfma_f32_16x16x32_bf16 v[190:193], a[216:219], a[28:31], v[190:193]
    ds_read_b64_tr_b16 a[210:211], v32 offset:34816
    buffer_load_dwordx4 a[76:79], v78, s[28:31], s1 offen offset:2304 sc1
    ds_bpermute_b32 v29, v16, v76 offset:64
    v_mfma_f32_16x16x32_bf16 v[198:201], a[220:223], a[24:27], v[198:201]
    ds_read_b64_tr_b16 a[212:213], v34 offset:32768
    s_add_u32 s1, s1, 8192
    v_mfma_f32_16x16x32_bf16 v[206:209], a[220:223], a[28:31], v[206:209]
    ds_read_b64_tr_b16 a[214:215], v34 offset:34816
    s_waitcnt lgkmcnt(13)
    v_mfma_f32_16x16x32_bf16 v[186:189], a[224:227], a[24:27], v[186:189]
    ds_read_b64_tr_b16 a[216:217], v31 offset:36864
    s_and_b32 s1, s1, 0xffff
    v_mfma_f32_16x16x32_bf16 v[194:197], a[224:227], a[28:31], v[194:197]
    ds_read_b64_tr_b16 a[218:219], v31 offset:38912
    buffer_load_dwordx4 a[80:83], v78, s[28:31], s1 offen offset:0 sc1
    ds_bpermute_b32 v30, v14, v76 offset:72
    v_mfma_f32_16x16x32_bf16 v[202:205], a[228:231], a[24:27], v[202:205]
    ds_read_b64_tr_b16 a[220:221], v33 offset:36864
    v_mfma_f32_16x16x32_bf16 v[210:213], a[228:231], a[28:31], v[210:213]
    ds_read_b64_tr_b16 a[222:223], v33 offset:38912
    s_waitcnt vmcnt(11) lgkmcnt(11)
    v_mfma_f32_16x16x32_bf16 v[182:185], a[200:203], a[32:35], v[182:185]
    ds_read_b64_tr_b16 a[224:225], v32 offset:36864
    buffer_load_dwordx4 a[84:87], v78, s[28:31], s1 offen offset:256 sc1
    v_mfma_f32_16x16x32_bf16 v[190:193], a[200:203], a[36:39], v[190:193]
    ds_read_b64_tr_b16 a[226:227], v32 offset:38912
    v_mfma_f32_16x16x32_bf16 v[198:201], a[204:207], a[32:35], v[198:201]
    ds_read_b64_tr_b16 a[228:229], v34 offset:36864
    v_mfma_f32_16x16x32_bf16 v[206:209], a[204:207], a[36:39], v[206:209]
    ds_read_b64_tr_b16 a[230:231], v34 offset:38912
    s_waitcnt lgkmcnt(9)
    v_mfma_f32_16x16x32_bf16 v[186:189], a[208:211], a[32:35], v[186:189]
    s_barrier
    ds_read_b64_tr_b16 a[200:201], v31 offset:49152
    buffer_load_dwordx4 a[88:91], v78, s[28:31], s1 offen offset:2048 sc1
    v_mfma_f32_16x16x32_bf16 v[194:197], a[208:211], a[36:39], v[194:197]
    ds_read_b64_tr_b16 a[202:203], v31 offset:51200
    v_mfma_f32_16x16x32_bf16 v[202:205], a[212:215], a[32:35], v[202:205]
    ds_read_b64_tr_b16 a[204:205], v33 offset:49152
    buffer_load_dwordx4 a[92:95], v78, s[28:31], s1 offen offset:2304 sc1
    v_mfma_f32_16x16x32_bf16 v[210:213], a[212:215], a[36:39], v[210:213]
    ds_read_b64_tr_b16 a[206:207], v33 offset:51200
    s_waitcnt vmcnt(12) lgkmcnt(8)
    v_mfma_f32_16x16x32_bf16 v[182:185], a[216:219], a[40:43], v[182:185]
    ds_read_b64_tr_b16 a[208:209], v32 offset:49152
    s_add_u32 m0, s58, 131072
    v_mfma_f32_16x16x32_bf16 v[190:193], a[216:219], a[44:47], v[190:193]
    ds_read_b64_tr_b16 a[210:211], v32 offset:51200
    s_add_u32 s0, s0, 458752
    v_mul_f32 v25, s83, v25
    v_mfma_f32_16x16x32_bf16 v[198:201], a[220:223], a[40:43], v[198:201]
    ds_read_b64_tr_b16 a[212:213], v34 offset:49152
    s_cmp_eq_u32 s0, 3670016
    v_mfma_f32_16x16x32_bf16 v[206:209], a[220:223], a[44:47], v[206:209]
    ds_read_b64_tr_b16 a[214:215], v34 offset:51200
    s_cselect_b32 s0, 0, s0
    v_xor_b32 v55, 128, v55
    buffer_load_dwordx4 v55, s[20:23], s0 offen lds
    s_waitcnt lgkmcnt(8)
    v_mfma_f32_16x16x32_bf16 v[186:189], a[224:227], a[40:43], v[186:189]
    ds_read_b64_tr_b16 a[216:217], v31 offset:53248
    v_xor_b32 v56, 128, v56
    v_mfma_f32_16x16x32_bf16 v[194:197], a[224:227], a[44:47], v[194:197]
    ds_read_b64_tr_b16 a[218:219], v31 offset:55296
    buffer_load_dwordx4 v56, s[20:23], s0 offen offset:1024 lds
    v_mul_f32 v26, s83, v26
    v_mfma_f32_16x16x32_bf16 v[202:205], a[228:231], a[40:43], v[202:205]
    ds_read_b64_tr_b16 a[220:221], v33 offset:53248
    v_xor_b32 v57, 128, v57
    v_mfma_f32_16x16x32_bf16 v[210:213], a[228:231], a[44:47], v[210:213]
    ds_read_b64_tr_b16 a[222:223], v33 offset:55296
    s_waitcnt vmcnt(12) lgkmcnt(8)
    v_mfma_f32_16x16x32_bf16 v[182:185], a[200:203], a[48:51], v[182:185]
    ds_read_b64_tr_b16 a[224:225], v32 offset:53248
    buffer_load_dwordx4 v57, s[20:23], s0 offen offset:2048 lds
    v_mfma_f32_16x16x32_bf16 v[190:193], a[200:203], a[52:55], v[190:193]
    ds_read_b64_tr_b16 a[226:227], v32 offset:55296
    v_xor_b32 v58, 128, v58
    s_cmp_eq_u32 s49, 0
    s_cselect_b64 s[76:77], 0, -1
    v_mfma_f32_16x16x32_bf16 v[198:201], a[204:207], a[48:51], v[198:201]
    ds_read_b64_tr_b16 a[228:229], v34 offset:53248
    v_mov_b32 v13, 0xffff
    v_mfma_f32_16x16x32_bf16 v[206:209], a[204:207], a[52:55], v[206:209]
    ds_read_b64_tr_b16 a[230:231], v34 offset:55296
    s_waitcnt lgkmcnt(8)
    v_mfma_f32_16x16x32_bf16 v[186:189], a[208:211], a[48:51], v[186:189]
    ds_read_b64_tr_b16 a[200:201], v35 offset:0
    buffer_load_dwordx4 v58, s[20:23], s0 offen offset:3072 lds
    v_mfma_f32_16x16x32_bf16 v[194:197], a[208:211], a[52:55], v[194:197]
    ds_read_b64_tr_b16 a[202:203], v35 offset:2048
    s_add_u32 s1, s1, 8192
    v_mov_b32 v14, 0xffff0000
    v_mfma_f32_16x16x32_bf16 v[202:205], a[212:215], a[48:51], v[202:205]
    ds_read_b64_tr_b16 a[204:205], v37 offset:0
    s_and_b32 s1, s1, 0xffff
    v_mfma_f32_16x16x32_bf16 v[210:213], a[212:215], a[52:55], v[210:213]
    ds_read_b64_tr_b16 a[206:207], v37 offset:2048
    v_cndmask_b32 v13, v13, v14, s[70:71]
    s_waitcnt vmcnt(12) lgkmcnt(8)
    v_mfma_f32_16x16x32_bf16 v[182:185], a[216:219], a[56:59], v[182:185]
    ds_read_b64_tr_b16 a[208:209], v36 offset:0
    buffer_load_dwordx4 a[96:99], v78, s[28:31], s1 offen offset:0 sc1
    v_mfma_f32_16x16x32_bf16 v[190:193], a[216:219], a[60:63], v[190:193]
    ds_read_b64_tr_b16 a[210:211], v36 offset:2048
    v_cndmask_b32 v104, v13, 0, s[72:73]
    v_mfma_f32_16x16x32_bf16 v[198:201], a[220:223], a[56:59], v[198:201]
    ds_read_b64_tr_b16 a[212:213], v38 offset:0
    buffer_load_dwordx4 a[100:103], v78, s[28:31], s1 offen offset:256 sc1
    v_mfma_f32_16x16x32_bf16 v[206:209], a[220:223], a[60:63], v[206:209]
    ds_read_b64_tr_b16 a[214:215], v38 offset:2048
    v_cndmask_b32 v106, 0, v13, s[72:73]
    s_waitcnt lgkmcnt(8)
    v_mfma_f32_16x16x32_bf16 v[186:189], a[224:227], a[56:59], v[186:189]
    ds_read_b64_tr_b16 a[216:217], v35 offset:4096
    v_cndmask_b32 v105, v13, 0, s[74:75]
    v_mfma_f32_16x16x32_bf16 v[194:197], a[224:227], a[60:63], v[194:197]
    ds_read_b64_tr_b16 a[218:219], v35 offset:6144
    buffer_load_dwordx4 a[104:107], v78, s[28:31], s1 offen offset:2048 sc1
    v_cndmask_b32 v107, 0, v13, s[74:75]
    v_mfma_f32_16x16x32_bf16 v[202:205], a[228:231], a[56:59], v[202:205]
    ds_read_b64_tr_b16 a[220:221], v37 offset:4096
    v_mov_b32 v84, 0xf149f2ca
    v_mfma_f32_16x16x32_bf16 v[210:213], a[228:231], a[60:63], v[210:213]
    ds_read_b64_tr_b16 a[222:223], v37 offset:6144
    s_waitcnt vmcnt(13) lgkmcnt(8)
    v_mfma_f32_16x16x32_bf16 v[182:185], a[200:203], a[64:67], v[182:185]
    ds_read_b64_tr_b16 a[224:225], v36 offset:4096
    buffer_load_dwordx4 a[108:111], v78, s[28:31], s1 offen offset:2304 sc1
    v_mfma_f32_16x16x32_bf16 v[190:193], a[200:203], a[68:71], v[190:193]
    ds_read_b64_tr_b16 a[226:227], v36 offset:6144
    s_add_u32 m0, s58, 147456
    s_mov_b32 s83, 0x3e8b97f6
    v_mfma_f32_16x16x32_bf16 v[198:201], a[204:207], a[64:67], v[198:201]
    ds_read_b64_tr_b16 a[228:229], v38 offset:4096
    s_add_u32 s0, s0, 458752
    v_mfma_f32_16x16x32_bf16 v[206:209], a[204:207], a[68:71], v[206:209]
    ds_read_b64_tr_b16 a[230:231], v38 offset:6144
    s_mov_b32 s78, 0xbdd2d3e8
    s_mov_b32 s79, 0xbdd2d3e8
    s_waitcnt lgkmcnt(8)
    v_mfma_f32_16x16x32_bf16 v[186:189], a[208:211], a[64:67], v[186:189]
    s_barrier
    s_mov_b32 s14, 0
    s_load_dword s14, s[44:45], s15
    ds_read_b64_tr_b16 a[200:201], v35 offset:16384
    s_cmp_eq_u32 s0, 3670016
    s_cselect_b32 s0, 0, s0
    buffer_load_dwordx4 v55, s[20:23], s0 offen lds
    v_mfma_f32_16x16x32_bf16 v[194:197], a[208:211], a[68:71], v[194:197]
    ds_read_b64_tr_b16 a[202:203], v35 offset:18432
    s_mov_b32 s80, 1.0
    v_mfma_f32_16x16x32_bf16 v[202:205], a[212:215], a[64:67], v[202:205]
    ds_read_b64_tr_b16 a[204:205], v37 offset:16384
    buffer_load_dwordx4 v56, s[20:23], s0 offen offset:1024 lds
    v_mfma_f32_16x16x32_bf16 v[210:213], a[212:215], a[68:71], v[210:213]
    ds_read_b64_tr_b16 a[206:207], v37 offset:18432
    s_mov_b32 s81, 1.0
    s_waitcnt vmcnt(14) lgkmcnt(8)
    v_mfma_f32_16x16x32_bf16 v[182:185], a[216:219], a[72:75], v[182:185]
    ds_read_b64_tr_b16 a[208:209], v36 offset:16384
    v_mov_b32 v108, 0xc0135761
    v_mfma_f32_16x16x32_bf16 v[190:193], a[216:219], a[76:79], v[190:193]
    ds_read_b64_tr_b16 a[210:211], v36 offset:18432
    buffer_load_dwordx4 v57, s[20:23], s0 offen offset:2048 lds
    v_mov_b32 v109, 0xc0135761
    v_mfma_f32_16x16x32_bf16 v[198:201], a[220:223], a[72:75], v[198:201]
    ds_read_b64_tr_b16 a[212:213], v38 offset:16384
    v_lshrrev_b32 v13, 1, v2
    v_mfma_f32_16x16x32_bf16 v[206:209], a[220:223], a[76:79], v[206:209]
    ds_read_b64_tr_b16 a[214:215], v38 offset:18432
    s_waitcnt lgkmcnt(8)
    v_mfma_f32_16x16x32_bf16 v[186:189], a[224:227], a[72:75], v[186:189]
    ds_read_b64_tr_b16 a[216:217], v35 offset:20480
    buffer_load_dwordx4 v58, s[20:23], s0 offen offset:3072 lds
    v_mfma_f32_16x16x32_bf16 v[194:197], a[224:227], a[76:79], v[194:197]
    ds_read_b64_tr_b16 a[218:219], v35 offset:22528
    s_add_u32 s1, s1, 8192
    v_lshlrev_b32 v14, 1, v3
    v_mfma_f32_16x16x32_bf16 v[202:205], a[228:231], a[72:75], v[202:205]
    ds_read_b64_tr_b16 a[220:221], v37 offset:20480
    s_and_b32 s1, s1, 0xffff
    v_mfma_f32_16x16x32_bf16 v[210:213], a[228:231], a[76:79], v[210:213]
    ds_read_b64_tr_b16 a[222:223], v37 offset:22528
    s_waitcnt vmcnt(14) lgkmcnt(8)
    v_mfma_f32_16x16x32_bf16 v[182:185], a[200:203], a[80:83], v[182:185]
    ds_read_b64_tr_b16 a[224:225], v36 offset:20480
    buffer_load_dwordx4 a[112:115], v78, s[28:31], s1 offen offset:0 sc1
    v_mfma_f32_16x16x32_bf16 v[190:193], a[200:203], a[84:87], v[190:193]
L_pad0:
    s_cbranch_execz L_warm
    ds_read_b64_tr_b16 a[226:227], v36 offset:22528
    v_sub_u32 v13, v13, v14
    v_mfma_f32_16x16x32_bf16 v[198:201], a[204:207], a[80:83], v[198:201]
    ds_read_b64_tr_b16 a[228:229], v38 offset:20480
    buffer_load_dwordx4 a[116:119], v78, s[28:31], s1 offen offset:256 sc1
    v_mfma_f32_16x16x32_bf16 v[206:209], a[204:207], a[84:87], v[206:209]
    ds_read_b64_tr_b16 a[230:231], v38 offset:22528
    v_mov_b32 v14, 0x3f80
    s_waitcnt lgkmcnt(8)
    v_mfma_f32_16x16x32_bf16 v[186:189], a[208:211], a[80:83], v[186:189]
    ds_read_b64_tr_b16 a[200:201], v35 offset:32768
    v_cndmask_b32 v14, v14, 1.0, s[70:71]
    v_mfma_f32_16x16x32_bf16 v[194:197], a[208:211], a[84:87], v[194:197]
    ds_read_b64_tr_b16 a[202:203], v35 offset:34816
    buffer_load_dwordx4 a[120:123], v78, s[28:31], s1 offen offset:2048 sc1
    v_cmp_eq_i32 vcc, 0, v13
    v_mfma_f32_16x16x32_bf16 v[202:205], a[212:215], a[80:83], v[202:205]
    ds_read_b64_tr_b16 a[204:205], v37 offset:32768
    v_accvgpr_write_b32 a248, 0
    v_mfma_f32_16x16x32_bf16 v[210:213], a[212:215], a[84:87], v[210:213]
    ds_read_b64_tr_b16 a[206:207], v37 offset:34816
    s_waitcnt vmcnt(15) lgkmcnt(8)
    v_mfma_f32_16x16x32_bf16 v[182:185], a[216:219], a[88:91], v[182:185]
    ds_read_b64_tr_b16 a[208:209], v36 offset:32768
    buffer_load_dwordx4 a[124:127], v78, s[28:31], s1 offen offset:2304 sc1
    v_mfma_f32_16x16x32_bf16 v[190:193], a[216:219], a[92:95], v[190:193]
    ds_read_b64_tr_b16 a[210:211], v36 offset:34816
    s_add_u32 m0, s58, 0
    v_accvgpr_write_b32 a252, 0
    v_mfma_f32_16x16x32_bf16 v[198:201], a[220:223], a[88:91], v[198:201]
    ds_read_b64_tr_b16 a[212:213], v38 offset:32768
    s_add_u32 s0, s0, 458752
    v_mfma_f32_16x16x32_bf16 v[206:209], a[220:223], a[92:95], v[206:209]
    ds_read_b64_tr_b16 a[214:215], v38 offset:34816
    s_waitcnt lgkmcnt(8)
    v_mfma_f32_16x16x32_bf16 v[186:189], a[224:227], a[88:91], v[186:189]
    ds_read_b64_tr_b16 a[216:217], v35 offset:36864
    s_cmp_eq_u32 s0, 3670016
    v_mfma_f32_16x16x32_bf16 v[194:197], a[224:227], a[92:95], v[194:197]
    ds_read_b64_tr_b16 a[218:219], v35 offset:38912
    s_cselect_b32 s0, 0, s0
    buffer_load_dwordx4 v55, s[20:23], s0 offen lds
    v_cndmask_b32 v15, 0, v14, vcc
    v_mfma_f32_16x16x32_bf16 v[202:205], a[228:231], a[88:91], v[202:205]
    ds_read_b64_tr_b16 a[220:221], v37 offset:36864
    v_accvgpr_write_b32 a250, v15
    v_mfma_f32_16x16x32_bf16 v[210:213], a[228:231], a[92:95], v[210:213]
    ds_read_b64_tr_b16 a[222:223], v37 offset:38912
    s_waitcnt vmcnt(11) lgkmcnt(8)
    v_mfma_f32_16x16x32_bf16 v[182:185], a[200:203], a[96:99], v[182:185]
    ds_read_b64_tr_b16 a[224:225], v36 offset:36864
    buffer_load_dwordx4 v56, s[20:23], s0 offen offset:1024 lds
    v_mfma_f32_16x16x32_bf16 v[190:193], a[200:203], a[100:103], v[190:193]
    ds_read_b64_tr_b16 a[226:227], v36 offset:38912
    v_cmp_eq_i32 vcc, 1, v13
    v_mfma_f32_16x16x32_bf16 v[198:201], a[204:207], a[96:99], v[198:201]
    ds_read_b64_tr_b16 a[228:229], v38 offset:36864
    buffer_load_dwordx4 v57, s[20:23], s0 offen offset:2048 lds
    v_mfma_f32_16x16x32_bf16 v[206:209], a[204:207], a[100:103], v[206:209]
    ds_read_b64_tr_b16 a[230:231], v38 offset:38912
    v_accvgpr_write_b32 a249, 0
    s_waitcnt lgkmcnt(8)
    v_mfma_f32_16x16x32_bf16 v[186:189], a[208:211], a[96:99], v[186:189]
    s_waitcnt vmcnt(7)
    s_barrier
    ds_read_b64_tr_b16 a[200:201], v35 offset:49152
    buffer_load_dwordx4 v58, s[20:23], s0 offen offset:3072 lds
    v_mfma_f32_16x16x32_bf16 v[194:197], a[208:211], a[100:103], v[194:197]
    ds_read_b64_tr_b16 a[202:203], v35 offset:51200
    s_add_u32 m0, s58, 16384
    v_accvgpr_write_b32 a253, 0
    v_mfma_f32_16x16x32_bf16 v[202:205], a[212:215], a[96:99], v[202:205]
    ds_read_b64_tr_b16 a[204:205], v37 offset:49152
    s_add_u32 s0, s0, 458752
    v_mfma_f32_16x16x32_bf16 v[210:213], a[212:215], a[100:103], v[210:213]
    ds_read_b64_tr_b16 a[206:207], v37 offset:51200
    s_waitcnt lgkmcnt(8)
    v_mfma_f32_16x16x32_bf16 v[182:185], a[216:219], a[104:107], v[182:185]
    ds_read_b64_tr_b16 a[208:209], v36 offset:49152
    s_cmp_eq_u32 s0, 3670016
    v_mfma_f32_16x16x32_bf16 v[190:193], a[216:219], a[108:111], v[190:193]
    ds_read_b64_tr_b16 a[210:211], v36 offset:51200
    s_cselect_b32 s0, 0, s0
    buffer_load_dwordx4 v55, s[20:23], s0 offen lds
    v_cndmask_b32 v15, 0, v14, vcc
    v_mfma_f32_16x16x32_bf16 v[198:201], a[220:223], a[104:107], v[198:201]
    ds_read_b64_tr_b16 a[212:213], v38 offset:49152
    v_accvgpr_write_b32 a251, v15
    v_mfma_f32_16x16x32_bf16 v[206:209], a[220:223], a[108:111], v[206:209]
    ds_read_b64_tr_b16 a[214:215], v38 offset:51200
    s_waitcnt lgkmcnt(8)
    v_mfma_f32_16x16x32_bf16 v[186:189], a[224:227], a[104:107], v[186:189]
    ds_read_b64_tr_b16 a[216:217], v35 offset:53248
    buffer_load_dwordx4 v56, s[20:23], s0 offen offset:1024 lds
    v_mfma_f32_16x16x32_bf16 v[194:197], a[224:227], a[108:111], v[194:197]
    ds_read_b64_tr_b16 a[218:219], v35 offset:55296
    v_mfma_f32_16x16x32_bf16 v[202:205], a[228:231], a[104:107], v[202:205]
    ds_read_b64_tr_b16 a[220:221], v37 offset:53248
    buffer_load_dwordx4 v57, s[20:23], s0 offen offset:2048 lds
    v_mfma_f32_16x16x32_bf16 v[210:213], a[228:231], a[108:111], v[210:213]
    ds_read_b64_tr_b16 a[222:223], v37 offset:55296
    s_waitcnt vmcnt(9) lgkmcnt(8)
    v_mfma_f32_16x16x32_bf16 v[182:185], a[200:203], a[112:115], v[182:185]
    ds_read_b64_tr_b16 a[224:225], v36 offset:53248
    v_mfma_f32_16x16x32_bf16 v[190:193], a[200:203], a[116:119], v[190:193]
    ds_read_b64_tr_b16 a[226:227], v36 offset:55296
    buffer_load_dwordx4 v58, s[20:23], s0 offen offset:3072 lds
    v_mfma_f32_16x16x32_bf16 v[198:201], a[204:207], a[112:115], v[198:201]
    ds_read_b64_tr_b16 a[228:229], v38 offset:53248
    s_add_u32 m0, s58, 32768
    v_mfma_f32_16x16x32_bf16 v[206:209], a[204:207], a[116:119], v[206:209]
    ds_read_b64_tr_b16 a[230:231], v38 offset:55296
    s_waitcnt lgkmcnt(8)
    v_mfma_f32_16x16x32_bf16 v[186:189], a[208:211], a[112:115], v[186:189]
    s_cmp_ge_u32 s14, 14
    s_cbranch_scc0 L_pollin1
L_pollok1:
    ds_read_b64_tr_b16 a[200:201], v39 offset:0
    s_add_u32 s0, s0, 458752
    v_mfma_f32_16x16x32_bf16 v[194:197], a[208:211], a[116:119], v[194:197]
    ds_read_b64_tr_b16 a[202:203], v39 offset:2048
    s_cmp_eq_u32 s0, 3670016
    s_cselect_b32 s0, 0, s0
    buffer_load_dwordx4 v55, s[20:23], s0 offen lds
    v_mfma_f32_16x16x32_bf16 v[202:205], a[212:215], a[112:115], v[202:205]
    ds_read_b64_tr_b16 a[204:205], v41 offset:0
    v_mfma_f32_16x16x32_bf16 v[210:213], a[212:215], a[116:119], v[210:213]
    ds_read_b64_tr_b16 a[206:207], v41 offset:2048
    s_waitcnt vmcnt(9) lgkmcnt(8)
    v_mfma_f32_16x16x32_bf16 v[182:185], a[216:219], a[120:123], v[182:185]
    ds_read_b64_tr_b16 a[208:209], v40 offset:0
    buffer_load_dwordx4 v56, s[20:23], s0 offen offset:1024 lds
    v_mfma_f32_16x16x32_bf16 v[190:193], a[216:219], a[124:127], v[190:193]
    ds_read_b64_tr_b16 a[210:211], v40 offset:2048
    v_mfma_f32_16x16x32_bf16 v[198:201], a[220:223], a[120:123], v[198:201]
    ds_read_b64_tr_b16 a[212:213], v42 offset:0
    buffer_load_dwordx4 v57, s[20:23], s0 offen offset:2048 lds
    v_mfma_f32_16x16x32_bf16 v[206:209], a[220:223], a[124:127], v[206:209]
    ds_read_b64_tr_b16 a[214:215], v42 offset:2048
    s_waitcnt lgkmcnt(8)
    v_mfma_f32_16x16x32_bf16 v[186:189], a[224:227], a[120:123], v[186:189]
    ds_read_b64_tr_b16 a[216:217], v39 offset:4096
    v_mfma_f32_16x16x32_bf16 v[194:197], a[224:227], a[124:127], v[194:197]
    ds_read_b64_tr_b16 a[218:219], v39 offset:6144
    v_mfma_f32_16x16x32_bf16 v[202:205], a[228:231], a[120:123], v[202:205]
    ds_read_b64_tr_b16 a[220:221], v41 offset:4096
    buffer_load_dwordx4 v58, s[20:23], s0 offen offset:3072 lds
    v_mfma_f32_16x16x32_bf16 v[210:213], a[228:231], a[124:127], v[210:213]
    ds_read_b64_tr_b16 a[222:223], v41 offset:6144
    s_waitcnt lgkmcnt(8)
    v_mfma_f32_16x16x32_bf16 v[150:153], a[200:203], a[0:3], v[150:153]
    ds_read_b64_tr_b16 a[224:225], v40 offset:4096
    s_add_u32 m0, s58, 49152
    v_mfma_f32_16x16x32_bf16 v[158:161], a[200:203], a[4:7], v[158:161]
    ds_read_b64_tr_b16 a[226:227], v40 offset:6144
    s_add_u32 s0, s0, 458752
    v_mfma_f32_16x16x32_bf16 v[166:169], a[204:207], a[0:3], 0
    ds_read_b64_tr_b16 a[228:229], v42 offset:4096
    s_cmp_eq_u32 s0, 3670016
    s_cselect_b32 s0, 0, s0
    buffer_load_dwordx4 v55, s[20:23], s0 offen lds
    v_mfma_f32_16x16x32_bf16 v[174:177], a[204:207], a[4:7], 0
    ds_read_b64_tr_b16 a[230:231], v42 offset:6144
    v_cvt_pk_bf16_f32 v182, v182, v183
    v_cvt_pk_bf16_f32 v183, v184, v185
    v_cvt_pk_bf16_f32 v184, v186, v187
    s_waitcnt lgkmcnt(8)
    v_mfma_f32_16x16x32_bf16 v[154:157], a[208:211], a[0:3], v[154:157]
    s_waitcnt vmcnt(5)
    s_barrier
    ds_read_b64_tr_b16 a[200:201], v39 offset:16384
    buffer_load_dwordx4 v56, s[20:23], s0 offen offset:1024 lds
    v_mfma_f32_16x16x32_bf16 v[162:165], a[208:211], a[4:7], v[162:165]
    ds_read_b64_tr_b16 a[202:203], v39 offset:18432
    v_cvt_pk_bf16_f32 v185, v188, v189
    buffer_store_dwordx4 v[182:185], v23, s[28:31], 0 offen offset:0 sc1
    v_cvt_pk_bf16_f32 v190, v190, v191
    v_cvt_pk_bf16_f32 v191, v192, v193
    v_cvt_pk_bf16_f32 v192, v194, v195
    v_mfma_f32_16x16x32_bf16 v[170:173], a[212:215], a[0:3], 0
    ds_read_b64_tr_b16 a[204:205], v41 offset:16384
    v_cvt_pk_bf16_f32 v193, v196, v197
    v_mfma_f32_16x16x32_bf16 v[178:181], a[212:215], a[4:7], 0
    ds_read_b64_tr_b16 a[206:207], v41 offset:18432
    buffer_store_dwordx4 v[190:193], v23, s[28:31], 0 offen offset:1024 sc1
    v_cvt_pk_bf16_f32 v198, v198, v199
    v_cvt_pk_bf16_f32 v199, v200, v201
    v_cvt_pk_bf16_f32 v200, v202, v203
    s_waitcnt lgkmcnt(8)
    v_mfma_f32_16x16x32_bf16 v[150:153], a[216:219], a[8:11], v[150:153]
    ds_read_b64_tr_b16 a[208:209], v40 offset:16384
    buffer_load_dwordx4 v57, s[20:23], s0 offen offset:2048 lds
    v_mfma_f32_16x16x32_bf16 v[158:161], a[216:219], a[12:15], v[158:161]
    ds_read_b64_tr_b16 a[210:211], v40 offset:18432
    v_cvt_pk_bf16_f32 v201, v204, v205
    buffer_store_dwordx4 v[198:201], v23, s[28:31], 0 offen offset:2048 sc1
    v_cvt_pk_bf16_f32 v206, v206, v207
    v_cvt_pk_bf16_f32 v207, v208, v209
    v_cvt_pk_bf16_f32 v208, v210, v211
    v_mfma_f32_16x16x32_bf16 v[166:169], a[220:223], a[8:11], v[166:169]
    ds_read_b64_tr_b16 a[212:213], v42 offset:16384
    v_cvt_pk_bf16_f32 v209, v212, v213
    v_mfma_f32_16x16x32_bf16 v[174:177], a[220:223], a[12:15], v[174:177]
    ds_read_b64_tr_b16 a[214:215], v42 offset:18432
    s_waitcnt lgkmcnt(8)
    v_mfma_f32_16x16x32_bf16 v[154:157], a[224:227], a[8:11], v[154:157]
    ds_read_b64_tr_b16 a[216:217], v39 offset:20480
    buffer_load_dwordx4 v58, s[20:23], s0 offen offset:3072 lds
    v_mfma_f32_16x16x32_bf16 v[162:165], a[224:227], a[12:15], v[162:165]
    ds_read_b64_tr_b16 a[218:219], v39 offset:22528
    s_add_u32 m0, s58, 65536
    buffer_store_dwordx4 v[206:209], v23, s[28:31], 0 offen offset:3072 sc1
    v_mfma_f32_16x16x32_bf16 v[170:173], a[228:231], a[8:11], v[170:173]
    ds_read_b64_tr_b16 a[220:221], v41 offset:20480
    s_add_u32 s0, s0, 458752
    v_mfma_f32_16x16x32_bf16 v[178:181], a[228:231], a[12:15], v[178:181]
    ds_read_b64_tr_b16 a[222:223], v41 offset:22528
    s_waitcnt lgkmcnt(8)
    v_mfma_f32_16x16x32_bf16 v[150:153], a[200:203], a[16:19], v[150:153]
    ds_read_b64_tr_b16 a[224:225], v40 offset:20480
    s_cmp_eq_u32 s0, 3670016
    v_mfma_f32_16x16x32_bf16 v[158:161], a[200:203], a[20:23], v[158:161]
    ds_read_b64_tr_b16 a[226:227], v40 offset:22528
    s_cselect_b32 s0, 0, s0
    buffer_load_dwordx4 v55, s[20:23], s0 offen lds
    v_mfma_f32_16x16x32_bf16 v[166:169], a[204:207], a[16:19], v[166:169]
    ds_read_b64_tr_b16 a[228:229], v42 offset:20480
    v_mfma_f32_16x16x32_bf16 v[174:177], a[204:207], a[20:23], v[174:177]
    ds_read_b64_tr_b16 a[230:231], v42 offset:22528
    s_waitcnt lgkmcnt(8)
    v_mfma_f32_16x16x32_bf16 v[154:157], a[208:211], a[16:19], v[154:157]
    ds_read_b64_tr_b16 a[200:201], v31 offset:0
    buffer_load_dwordx4 v56, s[20:23], s0 offen offset:1024 lds
    v_mfma_f32_16x16x32_bf16 v[162:165], a[208:211], a[20:23], v[162:165]
    ds_read_b64_tr_b16 a[202:203], v31 offset:2048
    v_mfma_f32_16x16x32_bf16 v[170:173], a[212:215], a[16:19], v[170:173]
    ds_read_b64_tr_b16 a[204:205], v33 offset:0
    buffer_load_dwordx4 v57, s[20:23], s0 offen offset:2048 lds
    v_mfma_f32_16x16x32_bf16 v[178:181], a[212:215], a[20:23], v[178:181]
    ds_read_b64_tr_b16 a[206:207], v33 offset:2048
    s_waitcnt lgkmcnt(8)
    v_mfma_f32_16x16x32_bf16 v[150:153], a[216:219], a[24:27], v[150:153]
    ds_read_b64_tr_b16 a[208:209], v32 offset:0
    v_mfma_f32_16x16x32_bf16 v[158:161], a[216:219], a[28:31], v[158:161]
    ds_read_b64_tr_b16 a[210:211], v32 offset:2048
    buffer_load_dwordx4 v58, s[20:23], s0 offen offset:3072 lds
    v_mfma_f32_16x16x32_bf16 v[166:169], a[220:223], a[24:27], v[166:169]
    ds_read_b64_tr_b16 a[212:213], v34 offset:0
    s_add_u32 m0, s58, 81920
    v_mfma_f32_16x16x32_bf16 v[174:177], a[220:223], a[28:31], v[174:177]
    ds_read_b64_tr_b16 a[214:215], v34 offset:2048
    s_waitcnt lgkmcnt(8)
    v_mfma_f32_16x16x32_bf16 v[154:157], a[224:227], a[24:27], v[154:157]
    ds_read_b64_tr_b16 a[216:217], v31 offset:4096
    s_add_u32 s0, s0, 458752
    v_mfma_f32_16x16x32_bf16 v[162:165], a[224:227], a[28:31], v[162:165]
    ds_read_b64_tr_b16 a[218:219], v31 offset:6144
    s_cmp_eq_u32 s0, 3670016
    v_mfma_f32_16x16x32_bf16 v[170:173], a[228:231], a[24:27], v[170:173]
    ds_read_b64_tr_b16 a[220:221], v33 offset:4096
    s_cselect_b32 s0, 0, s0
    buffer_load_dwordx4 v55, s[20:23], s0 offen lds
    v_mfma_f32_16x16x32_bf16 v[178:181], a[228:231], a[28:31], v[178:181]
    ds_read_b64_tr_b16 a[222:223], v33 offset:6144
    s_waitcnt lgkmcnt(8)
    v_mfma_f32_16x16x32_bf16 v[150:153], a[200:203], a[32:35], v[150:153]
    ds_read_b64_tr_b16 a[224:225], v32 offset:4096
    buffer_load_dwordx4 v56, s[20:23], s0 offen offset:1024 lds
    v_mfma_f32_16x16x32_bf16 v[158:161], a[200:203], a[36:39], v[158:161]
    ds_read_b64_tr_b16 a[226:227], v32 offset:6144
    v_mfma_f32_16x16x32_bf16 v[166:169], a[204:207], a[32:35], v[166:169]
    ds_read_b64_tr_b16 a[228:229], v34 offset:4096
    v_mfma_f32_16x16x32_bf16 v[174:177], a[204:207], a[36:39], v[174:177]
    ds_read_b64_tr_b16 a[230:231], v34 offset:6144
    s_waitcnt lgkmcnt(8)
    v_mfma_f32_16x16x32_bf16 v[154:157], a[208:211], a[32:35], v[154:157]
    s_waitcnt vmcnt(7)
    s_barrier
    s_waitcnt vmcnt(6)
    s_atomic_add s36, s[28:29], s37
    ds_read_b64_tr_b16 a[200:201], v31 offset:16384
    buffer_load_dwordx4 v57, s[20:23], s0 offen offset:2048 lds
    v_mfma_f32_16x16x32_bf16 v[162:165], a[208:211], a[36:39], v[162:165]
    ds_read_b64_tr_b16 a[202:203], v31 offset:18432
    v_mfma_f32_16x16x32_bf16 v[170:173], a[212:215], a[32:35], v[170:173]
    ds_read_b64_tr_b16 a[204:205], v33 offset:16384
    buffer_load_dwordx4 v58, s[20:23], s0 offen offset:3072 lds
    v_mfma_f32_16x16x32_bf16 v[178:181], a[212:215], a[36:39], v[178:181]
    ds_read_b64_tr_b16 a[206:207], v33 offset:18432
    s_waitcnt lgkmcnt(8)
    v_mfma_f32_16x16x32_bf16 v[150:153], a[216:219], a[40:43], v[150:153]
    ds_read_b64_tr_b16 a[208:209], v32 offset:16384
    s_add_u32 m0, s59, 98304
    v_mfma_f32_16x16x32_bf16 v[158:161], a[216:219], a[44:47], v[158:161]
    ds_read_b64_tr_b16 a[210:211], v32 offset:18432
    buffer_load_dwordx4 v80, s[28:31], s63 offen sc1 lds
    v_mfma_f32_16x16x32_bf16 v[166:169], a[220:223], a[40:43], v[166:169]
    ds_read_b64_tr_b16 a[212:213], v34 offset:16384
    v_mfma_f32_16x16x32_bf16 v[174:177], a[220:223], a[44:47], v[174:177]
    ds_read_b64_tr_b16 a[214:215], v34 offset:18432
    s_waitcnt lgkmcnt(8)
    v_mfma_f32_16x16x32_bf16 v[154:157], a[224:227], a[40:43], v[154:157]
    ds_read_b64_tr_b16 a[216:217], v31 offset:20480
    v_mfma_f32_16x16x32_bf16 v[162:165], a[224:227], a[44:47], v[162:165]
    ds_read_b64_tr_b16 a[218:219], v31 offset:22528
    buffer_load_dwordx4 v80, s[28:31], s63 offen offset:1024 sc1 lds
    v_mfma_f32_16x16x32_bf16 v[170:173], a[228:231], a[40:43], v[170:173]
    ds_read_b64_tr_b16 a[220:221], v33 offset:20480
    v_mfma_f32_16x16x32_bf16 v[178:181], a[228:231], a[44:47], v[178:181]
    ds_read_b64_tr_b16 a[222:223], v33 offset:22528
    s_waitcnt lgkmcnt(8)
    v_mfma_f32_16x16x32_bf16 v[150:153], a[200:203], a[48:51], v[150:153]
    ds_read_b64_tr_b16 a[224:225], v32 offset:20480
    buffer_load_dwordx4 v80, s[28:31], s63 offen offset:2048 sc1 lds
    v_mfma_f32_16x16x32_bf16 v[158:161], a[200:203], a[52:55], v[158:161]
    ds_read_b64_tr_b16 a[226:227], v32 offset:22528
    s_add_u32 m0, s100, 126976
    v_mfma_f32_16x16x32_bf16 v[166:169], a[204:207], a[48:51], v[166:169]
    ds_read_b64_tr_b16 a[228:229], v34 offset:20480
    v_mfma_f32_16x16x32_bf16 v[174:177], a[204:207], a[52:55], v[174:177]
    ds_read_b64_tr_b16 a[230:231], v34 offset:22528
    s_waitcnt lgkmcnt(8)
    v_mfma_f32_16x16x32_bf16 v[154:157], a[208:211], a[48:51], v[154:157]
    ds_read_b64_tr_b16 a[200:201], v31 offset:32768
    buffer_load_dwordx4 v69, s[28:31], s62 offen sc1 lds
    v_mfma_f32_16x16x32_bf16 v[162:165], a[208:211], a[52:55], v[162:165]
    ds_read_b64_tr_b16 a[202:203], v31 offset:34816
    s_add_u32 m0, s58, 110592
    v_mfma_f32_16x16x32_bf16 v[170:173], a[212:215], a[48:51], v[170:173]
    ds_read_b64_tr_b16 a[204:205], v33 offset:32768
    v_mfma_f32_16x16x32_bf16 v[178:181], a[212:215], a[52:55], v[178:181]
    ds_read_b64_tr_b16 a[206:207], v33 offset:34816
    s_waitcnt lgkmcnt(8)
    v_mfma_f32_16x16x32_bf16 v[150:153], a[216:219], a[56:59], v[150:153]
    ds_read_b64_tr_b16 a[208:209], v32 offset:32768
    buffer_load_dwordx4 v67, s[28:31], s62 offen sc1 lds
    v_mfma_f32_16x16x32_bf16 v[158:161], a[216:219], a[60:63], v[158:161]
    ds_read_b64_tr_b16 a[210:211], v32 offset:34816
    v_mfma_f32_16x16x32_bf16 v[166:169], a[220:223], a[56:59], v[166:169]
    ds_read_b64_tr_b16 a[212:213], v34 offset:32768
    v_mfma_f32_16x16x32_bf16 v[174:177], a[220:223], a[60:63], v[174:177]
    ds_read_b64_tr_b16 a[214:215], v34 offset:34816
    s_waitcnt lgkmcnt(8)
    v_mfma_f32_16x16x32_bf16 v[154:157], a[224:227], a[56:59], v[154:157]
    ds_read_b64_tr_b16 a[216:217], v31 offset:36864
    buffer_load_dwordx4 v67, s[28:31], s62 offen offset:1024 sc1 lds
    v_mfma_f32_16x16x32_bf16 v[162:165], a[224:227], a[60:63], v[162:165]
    ds_read_b64_tr_b16 a[218:219], v31 offset:38912
    v_mfma_f32_16x16x32_bf16 v[170:173], a[228:231], a[56:59], v[170:173]
    ds_read_b64_tr_b16 a[220:221], v33 offset:36864
    buffer_load_dwordx4 v68, s[28:31], s62 offen offset:2048 sc1 lds
    v_mfma_f32_16x16x32_bf16 v[178:181], a[228:231], a[60:63], v[178:181]
    ds_read_b64_tr_b16 a[222:223], v33 offset:38912
    s_waitcnt lgkmcnt(8)
    v_mfma_f32_16x16x32_bf16 v[150:153], a[200:203], a[64:67], v[150:153]
    ds_read_b64_tr_b16 a[224:225], v32 offset:36864
    v_mfma_f32_16x16x32_bf16 v[158:161], a[200:203], a[68:71], v[158:161]
    ds_read_b64_tr_b16 a[226:227], v32 offset:38912
    v_mfma_f32_16x16x32_bf16 v[166:169], a[204:207], a[64:67], v[166:169]
    ds_read_b64_tr_b16 a[228:229], v34 offset:36864
    buffer_load_dwordx4 v68, s[28:31], s62 offen offset:3072 sc1 lds
    v_mfma_f32_16x16x32_bf16 v[174:177], a[204:207], a[68:71], v[174:177]
    ds_read_b64_tr_b16 a[230:231], v34 offset:38912
    s_waitcnt lgkmcnt(8)
    v_mfma_f32_16x16x32_bf16 v[154:157], a[208:211], a[64:67], v[154:157]
    s_waitcnt vmcnt(8)
    s_barrier
    s_xor_b32 s37, s37, 1024
    s_mov_b32 s14, 0
    s_load_dword s14, s[28:29], s37
    ds_read_b64_tr_b16 a[200:201], v31 offset:49152
    s_add_u32 m0, s59, 131072
    v_mfma_f32_16x16x32_bf16 v[162:165], a[208:211], a[68:71], v[162:165]
    ds_read_b64_tr_b16 a[202:203], v31 offset:51200
    s_add_u32 s63, s63, 12288
    v_mfma_f32_16x16x32_bf16 v[170:173], a[212:215], a[64:67], v[170:173]
    ds_read_b64_tr_b16 a[204:205], v33 offset:49152
    s_cmp_eq_u32 s63, 86016
    s_cselect_b32 s63, 0, s63
    buffer_load_dwordx4 v80, s[28:31], s63 offen sc1 lds
    v_mfma_f32_16x16x32_bf16 v[178:181], a[212:215], a[68:71], v[178:181]
    ds_read_b64_tr_b16 a[206:207], v33 offset:51200
    s_waitcnt lgkmcnt(8)
    v_mfma_f32_16x16x32_bf16 v[150:153], a[216:219], a[72:75], v[150:153]
    ds_read_b64_tr_b16 a[208:209], v32 offset:49152
    buffer_load_dwordx4 v80, s[28:31], s63 offen offset:1024 sc1 lds
    v_mfma_f32_16x16x32_bf16 v[158:161], a[216:219], a[76:79], v[158:161]
    ds_read_b64_tr_b16 a[210:211], v32 offset:51200
    v_mfma_f32_16x16x32_bf16 v[166:169], a[220:223], a[72:75], v[166:169]
    ds_read_b64_tr_b16 a[212:213], v34 offset:49152
    v_mfma_f32_16x16x32_bf16 v[174:177], a[220:223], a[76:79], v[174:177]
    ds_read_b64_tr_b16 a[214:215], v34 offset:51200
    s_waitcnt lgkmcnt(8)
    v_mfma_f32_16x16x32_bf16 v[154:157], a[224:227], a[72:75], v[154:157]
    ds_read_b64_tr_b16 a[216:217], v31 offset:53248
    buffer_load_dwordx4 v80, s[28:31], s63 offen offset:2048 sc1 lds
    v_mfma_f32_16x16x32_bf16 v[162:165], a[224:227], a[76:79], v[162:165]
    ds_read_b64_tr_b16 a[218:219], v31 offset:55296
    s_add_u32 m0, s100, 159744
    v_mfma_f32_16x16x32_bf16 v[170:173], a[228:231], a[72:75], v[170:173]
    ds_read_b64_tr_b16 a[220:221], v33 offset:53248
    s_add_u32 s62, s62, 262144
    v_mfma_f32_16x16x32_bf16 v[178:181], a[228:231], a[76:79], v[178:181]
    ds_read_b64_tr_b16 a[222:223], v33 offset:55296
    s_waitcnt lgkmcnt(8)
    v_mfma_f32_16x16x32_bf16 v[150:153], a[200:203], a[80:83], v[150:153]
    ds_read_b64_tr_b16 a[224:225], v32 offset:53248
    s_cmp_eq_u32 s62, 1835008
    v_mfma_f32_16x16x32_bf16 v[158:161], a[200:203], a[84:87], v[158:161]
    ds_read_b64_tr_b16 a[226:227], v32 offset:55296
    s_cselect_b32 s62, 0, s62
    buffer_load_dwordx4 v69, s[28:31], s62 offen sc1 lds
    v_mfma_f32_16x16x32_bf16 v[166:169], a[204:207], a[80:83], v[166:169]
    ds_read_b64_tr_b16 a[228:229], v34 offset:53248
    s_add_u32 m0, s58, 143360
    v_mfma_f32_16x16x32_bf16 v[174:177], a[204:207], a[84:87], v[174:177]
    ds_read_b64_tr_b16 a[230:231], v34 offset:55296
    s_waitcnt lgkmcnt(8)
    v_mfma_f32_16x16x32_bf16 v[154:157], a[208:211], a[80:83], v[154:157]
    s_barrier
    ds_read_b64_tr_b16 a[200:201], v37 offset:0
    buffer_load_dwordx4 v67, s[28:31], s62 offen sc1 lds
    v_mfma_f32_16x16x32_bf16 v[162:165], a[208:211], a[84:87], v[162:165]
    ds_read_b64_tr_b16 a[202:203], v37 offset:2048
    v_mfma_f32_16x16x32_bf16 v[170:173], a[212:215], a[80:83], v[170:173]
    ds_read_b64_tr_b16 a[204:205], v38 offset:0
    buffer_load_dwordx4 v67, s[28:31], s62 offen offset:1024 sc1 lds
    v_mfma_f32_16x16x32_bf16 v[178:181], a[212:215], a[84:87], v[178:181]
    ds_read_b64_tr_b16 a[206:207], v38 offset:2048
    s_waitcnt lgkmcnt(8)
    v_mfma_f32_16x16x32_bf16 v[150:153], a[216:219], a[88:91], v[150:153]
    ds_read_b64_tr_b16 a[208:209], v37 offset:4096
    v_mfma_f32_16x16x32_bf16 v[158:161], a[216:219], a[92:95], v[158:161]
    ds_read_b64_tr_b16 a[210:211], v37 offset:6144
    v_mfma_f32_16x16x32_bf16 v[166:169], a[220:223], a[88:91], v[166:169]
    ds_read_b64_tr_b16 a[212:213], v38 offset:4096
    buffer_load_dwordx4 v68, s[28:31], s62 offen offset:2048 sc1 lds
    v_mfma_f32_16x16x32_bf16 v[174:177], a[220:223], a[92:95], v[174:177]
    ds_read_b64_tr_b16 a[214:215], v38 offset:6144
    s_waitcnt lgkmcnt(8)
    v_mfma_f32_16x16x32_bf16 v[154:157], a[224:227], a[88:91], v[154:157]
    ds_read_b64_tr_b16 a[216:217], v37 offset:16384
    v_mfma_f32_16x16x32_bf16 v[162:165], a[224:227], a[92:95], v[162:165]
    ds_read_b64_tr_b16 a[218:219], v37 offset:18432
    buffer_load_dwordx4 v68, s[28:31], s62 offen offset:3072 sc1 lds
    v_mfma_f32_16x16x32_bf16 v[170:173], a[228:231], a[88:91], v[170:173]
    ds_read_b64_tr_b16 a[220:221], v38 offset:16384
    s_add_u32 m0, s59, 0
    v_mfma_f32_16x16x32_bf16 v[178:181], a[228:231], a[92:95], v[178:181]
    ds_read_b64_tr_b16 a[222:223], v38 offset:18432
    s_waitcnt lgkmcnt(8)
    v_mfma_f32_16x16x32_bf16 v[166:169], a[200:203], a[96:99], v[166:169]
    s_cmp_ge_u32 s14, 2
    s_cbranch_scc0 L_pollin2
L_pollok2:
    v_xor_b32 v23, 131072, v23
    v_xor_b32 v22, 8192, v23
    ds_read_b64_tr_b16 a[224:225], v37 offset:20480
    buffer_load_dwordx4 v[214:217], v23, s[28:31], 0 offen offset:0 sc1
    v_mfma_f32_16x16x32_bf16 v[174:177], a[200:203], a[100:103], v[174:177]
    ds_read_b64_tr_b16 a[226:227], v37 offset:22528
    v_mfma_f32_16x16x32_bf16 v[170:173], a[204:207], a[96:99], v[170:173]
    ds_read_b64_tr_b16 a[228:229], v38 offset:20480
    buffer_load_dwordx4 v[218:221], v23, s[28:31], 0 offen offset:1024 sc1
    v_mfma_f32_16x16x32_bf16 v[178:181], a[204:207], a[100:103], v[178:181]
    ds_read_b64_tr_b16 a[230:231], v38 offset:22528
    s_waitcnt lgkmcnt(8)
    v_mfma_f32_16x16x32_bf16 v[166:169], a[208:211], a[104:107], v[166:169]
    ds_read_b64_tr_b16 a[200:201], v35 offset:0
    buffer_load_dwordx4 v[222:225], v22, s[28:31], 0 offen offset:2048 sc1
    v_mfma_f32_16x16x32_bf16 v[174:177], a[208:211], a[108:111], v[174:177]
    ds_read_b64_tr_b16 a[202:203], v35 offset:2048
    v_mfma_f32_16x16x32_bf16 v[170:173], a[212:215], a[104:107], v[170:173]
    ds_read_b64_tr_b16 a[204:205], v36 offset:0
    buffer_load_dwordx4 v[226:229], v22, s[28:31], 0 offen offset:3072 sc1
    v_mfma_f32_16x16x32_bf16 v[178:181], a[212:215], a[108:111], v[178:181]
    ds_read_b64_tr_b16 a[206:207], v36 offset:2048
    s_waitcnt lgkmcnt(8)
    v_mfma_f32_16x16x32_bf16 v[166:169], a[216:219], a[112:115], v[166:169]
    ds_read_b64_tr_b16 a[208:209], v35 offset:4096
    s_add_u32 s63, s63, 12288
    v_mfma_f32_16x16x32_bf16 v[174:177], a[216:219], a[116:119], v[174:177]
    ds_read_b64_tr_b16 a[210:211], v35 offset:6144
    s_cmp_eq_u32 s63, 86016
    s_cselect_b32 s63, 0, s63
    buffer_load_dwordx4 v80, s[28:31], s63 offen sc1 lds
    v_mfma_f32_16x16x32_bf16 v[170:173], a[220:223], a[112:115], v[170:173]
    ds_read_b64_tr_b16 a[212:213], v36 offset:4096
    v_mfma_f32_16x16x32_bf16 v[178:181], a[220:223], a[116:119], v[178:181]
    ds_read_b64_tr_b16 a[214:215], v36 offset:6144
    s_waitcnt lgkmcnt(8)
    v_mfma_f32_16x16x32_bf16 v[166:169], a[224:227], a[120:123], v[166:169]
    ds_read_b64_tr_b16 a[216:217], v35 offset:16384
    buffer_load_dwordx4 v80, s[28:31], s63 offen offset:1024 sc1 lds
    v_mfma_f32_16x16x32_bf16 v[174:177], a[224:227], a[124:127], v[174:177]
    ds_read_b64_tr_b16 a[218:219], v35 offset:18432
    v_mfma_f32_16x16x32_bf16 v[170:173], a[228:231], a[120:123], v[170:173]
    ds_read_b64_tr_b16 a[220:221], v36 offset:16384
    v_mfma_f32_16x16x32_bf16 v[178:181], a[228:231], a[124:127], v[178:181]
    ds_read_b64_tr_b16 a[222:223], v36 offset:18432
    s_waitcnt lgkmcnt(8)
    v_mfma_f32_16x16x32_bf16 v[150:153], a[200:203], a[96:99], v[150:153]
    ds_read_b64_tr_b16 a[224:225], v35 offset:20480
    buffer_load_dwordx4 v80, s[28:31], s63 offen offset:2048 sc1 lds
    v_mfma_f32_16x16x32_bf16 v[158:161], a[200:203], a[100:103], v[158:161]
    ds_read_b64_tr_b16 a[226:227], v35 offset:22528
    s_add_u32 m0, s100, 28672
    v_mfma_f32_16x16x32_bf16 v[154:157], a[204:207], a[96:99], v[154:157]
    ds_read_b64_tr_b16 a[228:229], v36 offset:20480
    s_add_u32 s62, s62, 262144
    v_mfma_f32_16x16x32_bf16 v[162:165], a[204:207], a[100:103], v[162:165]
    ds_read_b64_tr_b16 a[230:231], v36 offset:22528
    v_cvt_pk_bf16_f32 v166, v166, v167
    v_cvt_pk_bf16_f32 v167, v168, v169
    s_waitcnt lgkmcnt(8)
    v_mfma_f32_16x16x32_bf16 v[150:153], a[208:211], a[104:107], v[150:153]
    s_cmp_eq_u32 s62, 1835008
    s_cselect_b32 s62, 0, s62
    buffer_load_dwordx4 v69, s[28:31], s62 offen sc1 lds
    v_mfma_f32_16x16x32_bf16 v[158:161], a[208:211], a[108:111], v[158:161]
    s_add_u32 m0, s58, 12288
    v_cvt_pk_bf16_f32 v168, v170, v171
    v_cvt_pk_bf16_f32 v169, v172, v173
    ds_write_b128 v81, v[166:169] offset:32768
    v_mfma_f32_16x16x32_bf16 v[154:157], a[212:215], a[104:107], v[154:157]
    buffer_load_dwordx4 v67, s[28:31], s62 offen sc1 lds
    v_cvt_pk_bf16_f32 v174, v174, v175
    v_mfma_f32_16x16x32_bf16 v[162:165], a[212:215], a[108:111], v[162:165]
    v_cvt_pk_bf16_f32 v175, v176, v177
    s_waitcnt lgkmcnt(5)
    v_mfma_f32_16x16x32_bf16 v[150:153], a[216:219], a[112:115], v[150:153]
    v_cvt_pk_bf16_f32 v176, v178, v179
    v_cvt_pk_bf16_f32 v177, v180, v181
    v_mfma_f32_16x16x32_bf16 v[158:161], a[216:219], a[116:119], v[158:161]
    buffer_load_dwordx4 v67, s[28:31], s62 offen offset:1024 sc1 lds
    ds_write_b128 v81, v[174:177] offset:33792
    v_mfma_f32_16x16x32_bf16 v[154:157], a[220:223], a[112:115], v[154:157]
    v_mfma_f32_16x16x32_bf16 v[162:165], a[220:223], a[116:119], v[162:165]
    s_waitcnt lgkmcnt(2)
    v_mfma_f32_16x16x32_bf16 v[150:153], a[224:227], a[120:123], v[150:153]
    buffer_load_dwordx4 v68, s[28:31], s62 offen offset:2048 sc1 lds
    v_mfma_f32_16x16x32_bf16 v[158:161], a[224:227], a[124:127], v[158:161]
    v_mfma_f32_16x16x32_bf16 v[154:157], a[228:231], a[120:123], v[154:157]
    v_xor_b32 v81, 8192, v81
    s_waitcnt vmcnt(19) lgkmcnt(0)
    s_barrier
    ds_read_b128 v[182:185], v81 offset:32768
    ds_read_b128 v[186:189], v81 offset:33792
    v_mfma_f32_16x16x32_bf16 v[162:165], a[228:231], a[124:127], v[162:165]
    buffer_load_dwordx4 v68, s[28:31], s62 offen offset:3072 sc1 lds
    s_waitcnt vmcnt(11)
    v_mfma_f32_16x16x32_bf16 v[150:153], a[250:253], v[214:217], v[150:153]
    s_add_u32 m0, s59, 65536
L_pad1:
    s_cbranch_execz L_warm
    s_add_u32 s63, s63, 12288
    v_mfma_f32_16x16x32_bf16 v[154:157], a[248:251], v[214:217], v[154:157]
    s_cmp_eq_u32 s63, 86016
    s_cselect_b32 s63, 0, s63
    s_waitcnt vmcnt(10)
    v_mfma_f32_16x16x32_bf16 v[158:161], a[250:253], v[218:221], v[158:161]
    buffer_load_dwordx4 v80, s[28:31], s63 offen sc1 lds
    v_mfma_f32_16x16x32_bf16 v[162:165], a[248:251], v[218:221], v[162:165]
    s_waitcnt vmcnt(10)
    v_mfma_f32_16x16x32_bf16 v[150:153], a[250:253], v[222:225], v[150:153]
    v_mfma_f32_16x16x32_bf16 v[154:157], a[248:251], v[222:225], v[154:157]
    s_waitcnt vmcnt(9)
    v_mfma_f32_16x16x32_bf16 v[158:161], a[250:253], v[226:229], v[158:161]
    buffer_load_dwordx4 v80, s[28:31], s63 offen offset:1024 sc1 lds
    v_mfma_f32_16x16x32_bf16 v[162:165], a[248:251], v[226:229], v[162:165]
    s_waitcnt lgkmcnt(1)
    v_mfma_f32_16x16x32_bf16 v[150:153], a[250:253], v[182:185], v[150:153]
    v_mfma_f32_16x16x32_bf16 v[154:157], a[248:251], v[182:185], v[154:157]
    buffer_load_dwordx4 v80, s[28:31], s63 offen offset:2048 sc1 lds
    s_add_u32 m0, s100, 94208
    s_waitcnt lgkmcnt(0)
    v_mfma_f32_16x16x32_bf16 v[158:161], a[250:253], v[186:189], v[158:161]
    s_add_u32 s62, s62, 262144
    s_cmp_eq_u32 s62, 1835008
    v_mfma_f32_16x16x32_bf16 v[162:165], a[248:251], v[186:189], v[162:165]
    s_cselect_b32 s62, 0, s62
    v_pk_mul_f32 v[182:183], v[150:151], v[150:151]
    v_pk_mul_f32 v[184:185], v[152:153], v[152:153]
    v_pk_mul_f32 v[186:187], v[154:155], v[154:155]
    v_pk_mul_f32 v[188:189], v[156:157], v[156:157]
    v_pk_fma_f32 v[182:183], v[182:183], s[78:79], v[108:109]
    buffer_load_dwordx4 v69, s[28:31], s62 offen sc1 lds
    v_pk_fma_f32 v[184:185], v[184:185], s[78:79], v[108:109]
    v_pk_fma_f32 v[186:187], v[186:187], s[78:79], v[108:109]
    v_pk_fma_f32 v[188:189], v[188:189], s[78:79], v[108:109]
    v_pk_mul_f32 v[182:183], v[182:183], v[150:151]
    v_pk_mul_f32 v[184:185], v[184:185], v[152:153]
    v_pk_mul_f32 v[186:187], v[186:187], v[154:155]
    v_pk_mul_f32 v[188:189], v[188:189], v[156:157]
    v_exp_f32 v182, v182
    v_exp_f32 v183, v183
    v_exp_f32 v184, v184
    v_exp_f32 v185, v185
    s_add_u32 m0, s58, 77824
    s_nop 0
    buffer_load_dwordx4 v67, s[28:31], s62 offen sc1 lds
    v_exp_f32 v186, v186
    v_exp_f32 v187, v187
    v_exp_f32 v188, v188
    v_exp_f32 v189, v189
    v_pk_add_f32 v[182:183], v[182:183], s[80:81]
    v_pk_add_f32 v[184:185], v[184:185], s[80:81]
    v_pk_add_f32 v[186:187], v[186:187], s[80:81]
    v_pk_add_f32 v[188:189], v[188:189], s[80:81]
    v_rcp_f32 v182, v182
    buffer_load_dwordx4 v67, s[28:31], s62 offen offset:1024 sc1 lds
    v_rcp_f32 v183, v183
    v_rcp_f32 v184, v184
    v_rcp_f32 v185, v185
    v_rcp_f32 v186, v186
    v_rcp_f32 v187, v187
    v_rcp_f32 v188, v188
    v_rcp_f32 v189, v189
    buffer_load_dwordx4 v68, s[28:31], s62 offen offset:2048 sc1 lds
    v_pk_mul_f32 v[182:183], v[182:183], v[150:151]
    v_pk_mul_f32 v[184:185], v[184:185], v[152:153]
    v_pk_mul_f32 v[186:187], v[186:187], v[154:155]
    v_pk_mul_f32 v[188:189], v[188:189], v[156:157]
    v_cvt_pk_bf16_f32 v110, v182, v183
    v_cvt_pk_bf16_f32 v111, v184, v185
    v_cvt_pk_bf16_f32 v112, v186, v187
    v_cvt_pk_bf16_f32 v113, v188, v189
    v_pk_mul_f32 v[190:191], v[158:159], v[158:159]
    v_pk_mul_f32 v[192:193], v[160:161], v[160:161]
    v_pk_mul_f32 v[194:195], v[162:163], v[162:163]
    v_pk_mul_f32 v[196:197], v[164:165], v[164:165]
    v_pk_fma_f32 v[190:191], v[190:191], s[78:79], v[108:109]
    buffer_load_dwordx4 v68, s[28:31], s62 offen offset:3072 sc1 lds
    v_pk_fma_f32 v[192:193], v[192:193], s[78:79], v[108:109]
    v_pk_fma_f32 v[194:195], v[194:195], s[78:79], v[108:109]
    v_pk_fma_f32 v[196:197], v[196:197], s[78:79], v[108:109]
    v_pk_mul_f32 v[190:191], v[190:191], v[158:159]
    v_pk_mul_f32 v[192:193], v[192:193], v[160:161]
    v_pk_mul_f32 v[194:195], v[194:195], v[162:163]
    v_pk_mul_f32 v[196:197], v[196:197], v[164:165]
    v_exp_f32 v190, v190
    v_exp_f32 v191, v191
    v_exp_f32 v192, v192
    v_exp_f32 v193, v193
    v_exp_f32 v194, v194
    v_exp_f32 v195, v195
    v_exp_f32 v196, v196
    v_exp_f32 v197, v197
    v_pk_add_f32 v[190:191], v[190:191], s[80:81]
    v_pk_add_f32 v[192:193], v[192:193], s[80:81]
    v_pk_add_f32 v[194:195], v[194:195], s[80:81]
    v_pk_add_f32 v[196:197], v[196:197], s[80:81]
    v_rcp_f32 v190, v190
    v_rcp_f32 v191, v191
    v_rcp_f32 v192, v192
    v_rcp_f32 v193, v193
    v_rcp_f32 v194, v194
    v_rcp_f32 v195, v195
    v_rcp_f32 v196, v196
    v_rcp_f32 v197, v197
    v_pk_mul_f32 v[190:191], v[190:191], v[158:159]
    v_pk_mul_f32 v[192:193], v[192:193], v[160:161]
    v_pk_mul_f32 v[194:195], v[194:195], v[162:163]
    v_pk_mul_f32 v[196:197], v[196:197], v[164:165]
    v_cvt_pk_bf16_f32 v114, v190, v191
    v_cvt_pk_bf16_f32 v115, v192, v193
    v_cvt_pk_bf16_f32 v116, v194, v195
    v_cvt_pk_bf16_f32 v117, v196, v197
    ds_read_b64_tr_b16 a[180:181], v72 offset:32768
    ds_read_b64_tr_b16 a[182:183], v72 offset:33024
    ds_read_b128 a[128:131], v53 offset:32768
    ds_read_b64_tr_b16 a[184:185], v72 offset:33792
    ds_read_b64_tr_b16 a[186:187], v72 offset:34048
    ds_read_b128 a[132:135], v53 offset:33792
    ds_read_b128 a[136:139], v53 offset:34816
    ds_read_b64_tr_b16 a[176:177], v73 offset:32768
    ds_read_b64_tr_b16 a[178:179], v73 offset:33024
    ds_read_b128 a[140:143], v53 offset:35840
    ds_read_b128 a[144:147], v53 offset:36864
    ds_read_b128 a[148:151], v53 offset:37888
    buffer_store_dwordx4 v[110:113], v4, s[28:31], s67 offen offset:0 sc1
    buffer_store_dwordx4 v[114:117], v4, s[28:31], s67 offen offset:1024 sc1
L_q:
    s_waitcnt lgkmcnt(6)
    v_mfma_f32_16x16x32_bf16 v[182:185], a[128:131], a[180:183], 0
    ds_read_b64_tr_b16 a[192:193], v72 offset:34816
    v_mfma_f32_16x16x32_bf16 v[190:193], a[128:131], a[184:187], 0
    ds_read_b64_tr_b16 a[194:195], v72 offset:35072
    v_mfma_f32_16x16x32_bf16 v[186:189], a[132:135], a[180:183], 0
    ds_read_b128 a[152:155], v53 offset:38912
    v_mfma_f32_16x16x32_bf16 v[194:197], a[132:135], a[184:187], 0
    ds_read_b64_tr_b16 a[196:197], v72 offset:35840
    s_waitcnt lgkmcnt(4)
    v_mfma_f32_16x16x32_bf16 v[206:209], a[136:139], a[180:183], 0
    ds_read_b64_tr_b16 a[198:199], v72 offset:36096
    v_mfma_f32_16x16x32_bf16 v[214:217], a[136:139], a[184:187], 0
    ds_read_b128 a[156:159], v53 offset:39936
    v_mfma_f32_16x16x32_bf16 v[198:201], a[136:139], a[176:179], 0
    ds_read_b128 a[160:163], v53 offset:40960
    v_mfma_f32_16x16x32_bf16 v[210:213], a[140:143], a[180:183], 0
    ds_read_b64_tr_b16 a[188:189], v73 offset:34816
    v_mfma_f32_16x16x32_bf16 v[218:221], a[140:143], a[184:187], 0
    ds_read_b64_tr_b16 a[190:191], v73 offset:35072
    v_mfma_f32_16x16x32_bf16 v[202:205], a[140:143], a[176:179], 0
    ds_read_b128 a[164:167], v53 offset:41984
    v_mfma_f32_16x16x32_bf16 v[230:233], a[180:183], a[144:147], 0
    ds_read_b128 a[168:171], v53 offset:43008
    v_mfma_f32_16x16x32_bf16 v[238:241], a[184:187], a[144:147], 0
    ds_read_b128 a[172:175], v53 offset:44032
    v_mfma_f32_16x16x32_bf16 v[222:225], a[176:179], a[144:147], 0
    v_mfma_f32_16x16x32_bf16 v[234:237], a[180:183], a[148:151], 0
    v_mfma_f32_16x16x32_bf16 v[242:245], a[184:187], a[148:151], 0
    v_mfma_f32_16x16x32_bf16 v[226:229], a[176:179], a[148:151], 0
    s_waitcnt lgkmcnt(0)
    s_barrier
    v_mfma_f32_16x16x32_bf16 v[182:185], a[152:155], a[192:195], v[182:185]
    ds_read_b64_tr_b16 a[180:181], v74 offset:0
    s_add_u32 m0, s59, 32768
    v_mfma_f32_16x16x32_bf16 v[190:193], a[152:155], a[196:199], v[190:193]
    ds_read_b64_tr_b16 a[182:183], v74 offset:256
    s_add_u32 s63, s63, 12288
    v_mfma_f32_16x16x32_bf16 v[186:189], a[156:159], a[192:195], v[186:189]
    ds_read_b128 a[128:131], v54 offset:0
    s_cmp_eq_u32 s63, 86016
    v_mfma_f32_16x16x32_bf16 v[194:197], a[156:159], a[196:199], v[194:197]
    ds_read_b64_tr_b16 a[184:185], v74 offset:1024
    v_mfma_f32_16x16x32_bf16 v[206:209], a[160:163], a[192:195], v[206:209]
    ds_read_b64_tr_b16 a[186:187], v74 offset:1280
    s_cselect_b32 s63, 0, s63
    v_mfma_f32_16x16x32_bf16 v[214:217], a[160:163], a[196:199], v[214:217]
    ds_read_b128 a[132:135], v54 offset:1024
    buffer_load_dwordx4 v80, s[28:31], s63 offen sc1 lds
    v_mfma_f32_16x16x32_bf16 v[198:201], a[160:163], a[188:191], v[198:201]
    ds_read_b128 a[136:139], v54 offset:2048
    v_mfma_f32_16x16x32_bf16 v[210:213], a[164:167], a[192:195], v[210:213]
    ds_read_b64_tr_b16 a[176:177], v75 offset:0
    buffer_load_dwordx4 v80, s[28:31], s63 offen offset:1024 sc1 lds
    v_mfma_f32_16x16x32_bf16 v[218:221], a[164:167], a[196:199], v[218:221]
    ds_read_b64_tr_b16 a[178:179], v75 offset:256
    v_mfma_f32_16x16x32_bf16 v[202:205], a[164:167], a[188:191], v[202:205]
    ds_read_b128 a[140:143], v54 offset:3072
    v_mfma_f32_16x16x32_bf16 v[230:233], a[192:195], a[168:171], v[230:233]
    ds_read_b128 a[144:147], v54 offset:4096
    buffer_load_dwordx4 v80, s[28:31], s63 offen offset:2048 sc1 lds
    v_mfma_f32_16x16x32_bf16 v[238:241], a[196:199], a[168:171], v[238:241]
    ds_read_b128 a[148:151], v54 offset:5120
    s_add_u32 m0, s100, 61440
    v_mfma_f32_16x16x32_bf16 v[222:225], a[188:191], a[168:171], v[222:225]
    s_add_u32 s62, s62, 262144
    s_cmp_eq_u32 s62, 1835008
    v_mfma_f32_16x16x32_bf16 v[234:237], a[192:195], a[172:175], v[234:237]
    s_cselect_b32 s62, 0, s62
    buffer_load_dwordx4 v69, s[28:31], s62 offen sc1 lds
    v_mfma_f32_16x16x32_bf16 v[242:245], a[196:199], a[172:175], v[242:245]
    s_add_u32 m0, s58, 45056
    v_mfma_f32_16x16x32_bf16 v[226:229], a[188:191], a[172:175], v[226:229]
    s_waitcnt lgkmcnt(6)
    v_mfma_f32_16x16x32_bf16 v[182:185], a[128:131], a[180:183], v[182:185]
    ds_read_b64_tr_b16 a[192:193], v74 offset:2048
    buffer_load_dwordx4 v67, s[28:31], s62 offen sc1 lds
    v_mfma_f32_16x16x32_bf16 v[190:193], a[128:131], a[184:187], v[190:193]
    ds_read_b64_tr_b16 a[194:195], v74 offset:2304
    v_mfma_f32_16x16x32_bf16 v[186:189], a[132:135], a[180:183], v[186:189]
    ds_read_b128 a[152:155], v54 offset:6144
    v_mfma_f32_16x16x32_bf16 v[194:197], a[132:135], a[184:187], v[194:197]
    ds_read_b64_tr_b16 a[196:197], v74 offset:3072
    s_waitcnt lgkmcnt(4)
    v_mfma_f32_16x16x32_bf16 v[206:209], a[136:139], a[180:183], v[206:209]
    ds_read_b64_tr_b16 a[198:199], v74 offset:3328
    buffer_load_dwordx4 v67, s[28:31], s62 offen offset:1024 sc1 lds
    v_mfma_f32_16x16x32_bf16 v[214:217], a[136:139], a[184:187], v[214:217]
    ds_read_b128 a[156:159], v54 offset:7168
    v_mfma_f32_16x16x32_bf16 v[198:201], a[136:139], a[176:179], v[198:201]
    ds_read_b128 a[160:163], v54 offset:8192
    buffer_load_dwordx4 v68, s[28:31], s62 offen offset:2048 sc1 lds
    v_mfma_f32_16x16x32_bf16 v[210:213], a[140:143], a[180:183], v[210:213]
    ds_read_b64_tr_b16 a[188:189], v75 offset:2048
    v_mfma_f32_16x16x32_bf16 v[218:221], a[140:143], a[184:187], v[218:221]
    ds_read_b64_tr_b16 a[190:191], v75 offset:2304
    v_mfma_f32_16x16x32_bf16 v[202:205], a[140:143], a[176:179], v[202:205]
    ds_read_b128 a[164:167], v54 offset:9216
    buffer_load_dwordx4 v68, s[28:31], s62 offen offset:3072 sc1 lds
    v_mfma_f32_16x16x32_bf16 v[230:233], a[180:183], a[144:147], v[230:233]
    ds_read_b128 a[168:171], v54 offset:10240
    s_add_u32 m0, s59, 98304
    v_mfma_f32_16x16x32_bf16 v[238:241], a[184:187], a[144:147], v[238:241]
    ds_read_b128 a[172:175], v54 offset:11264
    s_add_u32 s63, s63, 12288
    v_mfma_f32_16x16x32_bf16 v[222:225], a[176:179], a[144:147], v[222:225]
    s_cmp_eq_u32 s63, 86016
    s_cselect_b32 s63, 0, s63
    v_mfma_f32_16x16x32_bf16 v[234:237], a[180:183], a[148:151], v[234:237]
    buffer_load_dwordx4 v80, s[28:31], s63 offen sc1 lds
    v_mfma_f32_16x16x32_bf16 v[242:245], a[184:187], a[148:151], v[242:245]
    v_mfma_f32_16x16x32_bf16 v[226:229], a[176:179], a[148:151], v[226:229]
    s_waitcnt vmcnt(9) lgkmcnt(0)
    s_barrier
    s_cmp_lg_u32 s48, 0
    s_cbranch_scc1 L_sig2
    s_atomic_add s36, s[28:29], s68
L_sig2:
    v_mfma_f32_16x16x32_bf16 v[182:185], a[152:155], a[192:195], v[182:185]
    ds_read_b64_tr_b16 a[180:181], v70 offset:0
    buffer_load_dwordx4 v80, s[28:31], s63 offen offset:1024 sc1 lds
    v_mfma_f32_16x16x32_bf16 v[190:193], a[152:155], a[196:199], v[190:193]
    ds_read_b64_tr_b16 a[182:183], v70 offset:256
    v_mfma_f32_16x16x32_bf16 v[186:189], a[156:159], a[192:195], v[186:189]
    ds_read_b128 a[128:131], v4 offset:0
    buffer_load_dwordx4 v80, s[28:31], s63 offen offset:2048 sc1 lds
    v_mfma_f32_16x16x32_bf16 v[194:197], a[156:159], a[196:199], v[194:197]
    ds_read_b64_tr_b16 a[184:185], v70 offset:1024
    v_mfma_f32_16x16x32_bf16 v[206:209], a[160:163], a[192:195], v[206:209]
    ds_read_b64_tr_b16 a[186:187], v70 offset:1280
    s_add_u32 m0, s100, 126976
    v_mfma_f32_16x16x32_bf16 v[214:217], a[160:163], a[196:199], v[214:217]
    ds_read_b128 a[132:135], v4 offset:1024
    s_add_u32 s62, s62, 262144
    v_mfma_f32_16x16x32_bf16 v[198:201], a[160:163], a[188:191], v[198:201]
    ds_read_b128 a[136:139], v4 offset:2048
    s_cmp_eq_u32 s62, 1835008
    v_mfma_f32_16x16x32_bf16 v[210:213], a[164:167], a[192:195], v[210:213]
    ds_read_b64_tr_b16 a[176:177], v71 offset:0
    s_cselect_b32 s62, 0, s62
    v_mfma_f32_16x16x32_bf16 v[218:221], a[164:167], a[196:199], v[218:221]
    ds_read_b64_tr_b16 a[178:179], v71 offset:256
    buffer_load_dwordx4 v69, s[28:31], s62 offen sc1 lds
    v_mfma_f32_16x16x32_bf16 v[202:205], a[164:167], a[188:191], v[202:205]
    ds_read_b128 a[140:143], v4 offset:3072
    s_add_u32 m0, s58, 110592
    v_mfma_f32_16x16x32_bf16 v[230:233], a[192:195], a[168:171], v[230:233]
    ds_read_b128 a[144:147], v4 offset:4096
    buffer_load_dwordx4 v67, s[28:31], s62 offen sc1 lds
    v_mfma_f32_16x16x32_bf16 v[238:241], a[196:199], a[168:171], v[238:241]
    ds_read_b128 a[148:151], v4 offset:5120
    v_mfma_f32_16x16x32_bf16 v[222:225], a[188:191], a[168:171], v[222:225]
    v_mfma_f32_16x16x32_bf16 v[234:237], a[192:195], a[172:175], v[234:237]
    buffer_load_dwordx4 v67, s[28:31], s62 offen offset:1024 sc1 lds
    v_mfma_f32_16x16x32_bf16 v[242:245], a[196:199], a[172:175], v[242:245]
    v_mfma_f32_16x16x32_bf16 v[226:229], a[188:191], a[172:175], v[226:229]
    s_waitcnt lgkmcnt(6)
    v_mfma_f32_16x16x32_bf16 v[182:185], a[128:131], a[180:183], v[182:185]
    ds_read_b64_tr_b16 a[192:193], v70 offset:2048
    buffer_load_dwordx4 v68, s[28:31], s62 offen offset:2048 sc1 lds
    v_mfma_f32_16x16x32_bf16 v[190:193], a[128:131], a[184:187], v[190:193]
    ds_read_b64_tr_b16 a[194:195], v70 offset:2304
    v_mfma_f32_16x16x32_bf16 v[186:189], a[132:135], a[180:183], v[186:189]
    ds_read_b128 a[152:155], v4 offset:6144
    v_mfma_f32_16x16x32_bf16 v[194:197], a[132:135], a[184:187], v[194:197]
    ds_read_b64_tr_b16 a[196:197], v70 offset:3072
    s_waitcnt lgkmcnt(4)
    v_mfma_f32_16x16x32_bf16 v[206:209], a[136:139], a[180:183], v[206:209]
    ds_read_b64_tr_b16 a[198:199], v70 offset:3328
    buffer_load_dwordx4 v68, s[28:31], s62 offen offset:3072 sc1 lds
    v_mfma_f32_16x16x32_bf16 v[214:217], a[136:139], a[184:187], v[214:217]
    ds_read_b128 a[156:159], v4 offset:7168
    s_add_u32 m0, s59, 131072
    v_mfma_f32_16x16x32_bf16 v[198:201], a[136:139], a[176:179], v[198:201]
    ds_read_b128 a[160:163], v4 offset:8192
    s_add_u32 s63, s63, 12288
    v_mfma_f32_16x16x32_bf16 v[210:213], a[140:143], a[180:183], v[210:213]
    ds_read_b64_tr_b16 a[188:189], v71 offset:2048
    s_cmp_eq_u32 s63, 86016
    v_mfma_f32_16x16x32_bf16 v[218:221], a[140:143], a[184:187], v[218:221]
    ds_read_b64_tr_b16 a[190:191], v71 offset:2304
    s_cselect_b32 s63, 0, s63
    v_mfma_f32_16x16x32_bf16 v[202:205], a[140:143], a[176:179], v[202:205]
    ds_read_b128 a[164:167], v4 offset:9216
    buffer_load_dwordx4 v80, s[28:31], s63 offen sc1 lds
    v_mfma_f32_16x16x32_bf16 v[230:233], a[180:183], a[144:147], v[230:233]
    ds_read_b128 a[168:171], v4 offset:10240
    v_mfma_f32_16x16x32_bf16 v[238:241], a[184:187], a[144:147], v[238:241]
    ds_read_b128 a[172:175], v4 offset:11264
    buffer_load_dwordx4 v80, s[28:31], s63 offen offset:1024 sc1 lds
    v_mfma_f32_16x16x32_bf16 v[222:225], a[176:179], a[144:147], v[222:225]
    v_mfma_f32_16x16x32_bf16 v[234:237], a[180:183], a[148:151], v[234:237]
    v_mfma_f32_16x16x32_bf16 v[242:245], a[184:187], a[148:151], v[242:245]
    buffer_load_dwordx4 v80, s[28:31], s63 offen offset:2048 sc1 lds
    s_add_u32 m0, s100, 159744
    v_mfma_f32_16x16x32_bf16 v[226:229], a[176:179], a[148:151], v[226:229]
    s_add_u32 s62, s62, 262144
    ds_read_b32 v24, v4
    s_waitcnt lgkmcnt(1)
    s_barrier
    v_mfma_f32_16x16x32_bf16 v[182:185], a[152:155], a[192:195], v[182:185]
    ds_read_b64_tr_b16 a[180:181], v72 offset:0
    s_cmp_eq_u32 s62, 1835008
    v_mfma_f32_16x16x32_bf16 v[190:193], a[152:155], a[196:199], v[190:193]
    ds_read_b64_tr_b16 a[182:183], v72 offset:256
    s_cselect_b32 s62, 0, s62
    v_mfma_f32_16x16x32_bf16 v[186:189], a[156:159], a[192:195], v[186:189]
    ds_read_b128 a[128:131], v53 offset:0
    buffer_load_dwordx4 v69, s[28:31], s62 offen sc1 lds
    v_mfma_f32_16x16x32_bf16 v[194:197], a[156:159], a[196:199], v[194:197]
    ds_read_b64_tr_b16 a[184:185], v72 offset:1024
    v_mfma_f32_16x16x32_bf16 v[206:209], a[160:163], a[192:195], v[206:209]
    ds_read_b64_tr_b16 a[186:187], v72 offset:1280
    s_add_u32 m0, s58, 143360
    v_mfma_f32_16x16x32_bf16 v[214:217], a[160:163], a[196:199], v[214:217]
    ds_read_b128 a[132:135], v53 offset:1024
    buffer_load_dwordx4 v67, s[28:31], s62 offen sc1 lds
    v_mfma_f32_16x16x32_bf16 v[198:201], a[160:163], a[188:191], v[198:201]
    ds_read_b128 a[136:139], v53 offset:2048
    v_mfma_f32_16x16x32_bf16 v[210:213], a[164:167], a[192:195], v[210:213]
    ds_read_b64_tr_b16 a[176:177], v73 offset:0
    buffer_load_dwordx4 v67, s[28:31], s62 offen offset:1024 sc1 lds
    v_mfma_f32_16x16x32_bf16 v[218:221], a[164:167], a[196:199], v[218:221]
    ds_read_b64_tr_b16 a[178:179], v73 offset:256
    v_mfma_f32_16x16x32_bf16 v[202:205], a[164:167], a[188:191], v[202:205]
    ds_read_b128 a[140:143], v53 offset:3072
    v_mfma_f32_16x16x32_bf16 v[230:233], a[192:195], a[168:171], v[230:233]
    ds_read_b128 a[144:147], v53 offset:4096
    buffer_load_dwordx4 v68, s[28:31], s62 offen offset:2048 sc1 lds
    v_mfma_f32_16x16x32_bf16 v[238:241], a[196:199], a[168:171], v[238:241]
    ds_read_b128 a[148:151], v53 offset:5120
    v_mfma_f32_16x16x32_bf16 v[222:225], a[188:191], a[168:171], v[222:225]
    v_mfma_f32_16x16x32_bf16 v[234:237], a[192:195], a[172:175], v[234:237]
    buffer_load_dwordx4 v68, s[28:31], s62 offen offset:3072 sc1 lds
    s_add_u32 m0, s58, 0
    v_mfma_f32_16x16x32_bf16 v[242:245], a[196:199], a[172:175], v[242:245]
    v_mfma_f32_16x16x32_bf16 v[226:229], a[188:191], a[172:175], v[226:229]
    s_waitcnt lgkmcnt(6)
    v_mfma_f32_16x16x32_bf16 v[182:185], a[128:131], a[180:183], v[182:185]
    ds_read_b64_tr_b16 a[192:193], v72 offset:2048
    buffer_load_dwordx4 v59, s[24:27], s64 offen lds
    v_mfma_f32_16x16x32_bf16 v[190:193], a[128:131], a[184:187], v[190:193]
    ds_read_b64_tr_b16 a[194:195], v72 offset:2304
    v_mfma_f32_16x16x32_bf16 v[186:189], a[132:135], a[180:183], v[186:189]
    ds_read_b128 a[152:155], v53 offset:6144
    v_mfma_f32_16x16x32_bf16 v[194:197], a[132:135], a[184:187], v[194:197]
    ds_read_b64_tr_b16 a[196:197], v72 offset:3072
    s_waitcnt lgkmcnt(4)
    v_mfma_f32_16x16x32_bf16 v[206:209], a[136:139], a[180:183], v[206:209]
    ds_read_b64_tr_b16 a[198:199], v72 offset:3328
    buffer_load_dwordx4 v60, s[24:27], s64 offen offset:1024 lds
    v_mfma_f32_16x16x32_bf16 v[214:217], a[136:139], a[184:187], v[214:217]
    ds_read_b128 a[156:159], v53 offset:7168
    v_mfma_f32_16x16x32_bf16 v[198:201], a[136:139], a[176:179], v[198:201]
    ds_read_b128 a[160:163], v53 offset:8192
    v_mfma_f32_16x16x32_bf16 v[210:213], a[140:143], a[180:183], v[210:213]
    ds_read_b64_tr_b16 a[188:189], v73 offset:2048
    buffer_load_dwordx4 v61, s[24:27], s64 offen offset:2048 lds
    v_mfma_f32_16x16x32_bf16 v[218:221], a[140:143], a[184:187], v[218:221]
    ds_read_b64_tr_b16 a[190:191], v73 offset:2304
    v_mfma_f32_16x16x32_bf16 v[202:205], a[140:143], a[176:179], v[202:205]
    ds_read_b128 a[164:167], v53 offset:9216
    v_mfma_f32_16x16x32_bf16 v[230:233], a[180:183], a[144:147], v[230:233]
    ds_read_b128 a[168:171], v53 offset:10240
    buffer_load_dwordx4 v62, s[24:27], s64 offen offset:3072 lds
    v_mfma_f32_16x16x32_bf16 v[238:241], a[184:187], a[144:147], v[238:241]
    ds_read_b128 a[172:175], v53 offset:11264
    s_add_u32 m0, s58, 16384
    v_mfma_f32_16x16x32_bf16 v[222:225], a[176:179], a[144:147], v[222:225]
    v_xor_b32 v59, 128, v59
    v_mfma_f32_16x16x32_bf16 v[234:237], a[180:183], a[148:151], v[234:237]
    buffer_load_dwordx4 v59, s[24:27], s64 offen lds
    v_xor_b32 v60, 128, v60
    v_mfma_f32_16x16x32_bf16 v[242:245], a[184:187], a[148:151], v[242:245]
    v_mfma_f32_16x16x32_bf16 v[226:229], a[176:179], a[148:151], v[226:229]
    ds_read_b32 v24, v4
    s_waitcnt vmcnt(21) lgkmcnt(1)
    s_barrier
    v_mfma_f32_16x16x32_bf16 v[182:185], a[152:155], a[192:195], v[182:185]
    ds_read_b64_tr_b16 a[180:181], v70 offset:32768
    buffer_load_dwordx4 v60, s[24:27], s64 offen offset:1024 lds
    v_mfma_f32_16x16x32_bf16 v[190:193], a[152:155], a[196:199], v[190:193]
    ds_read_b64_tr_b16 a[182:183], v70 offset:33024
    v_xor_b32 v61, 128, v61
    v_mfma_f32_16x16x32_bf16 v[186:189], a[156:159], a[192:195], v[186:189]
    ds_read_b128 a[128:131], v4 offset:32768
    v_mfma_f32_16x16x32_bf16 v[194:197], a[156:159], a[196:199], v[194:197]
    ds_read_b64_tr_b16 a[184:185], v70 offset:33792
    v_mfma_f32_16x16x32_bf16 v[206:209], a[160:163], a[192:195], v[206:209]
    ds_read_b64_tr_b16 a[186:187], v70 offset:34048
    buffer_load_dwordx4 v61, s[24:27], s64 offen offset:2048 lds
    v_mfma_f32_16x16x32_bf16 v[214:217], a[160:163], a[196:199], v[214:217]
    ds_read_b128 a[132:135], v4 offset:33792
    v_xor_b32 v62, 128, v62
    v_mfma_f32_16x16x32_bf16 v[198:201], a[160:163], a[188:191], v[198:201]
    ds_read_b128 a[136:139], v4 offset:34816
    buffer_load_dwordx4 v62, s[24:27], s64 offen offset:3072 lds
    v_mfma_f32_16x16x32_bf16 v[210:213], a[164:167], a[192:195], v[210:213]
    ds_read_b64_tr_b16 a[176:177], v71 offset:32768
    s_add_u32 m0, s58, 65536
    v_mfma_f32_16x16x32_bf16 v[218:221], a[164:167], a[196:199], v[218:221]
    ds_read_b64_tr_b16 a[178:179], v71 offset:33024
    s_add_u32 s64, s64, 524288
    v_mfma_f32_16x16x32_bf16 v[202:205], a[164:167], a[188:191], v[202:205]
    ds_read_b128 a[140:143], v4 offset:35840
    s_cmp_eq_u32 s64, 3670016
    v_mfma_f32_16x16x32_bf16 v[230:233], a[192:195], a[168:171], v[230:233]
    ds_read_b128 a[144:147], v4 offset:36864
    s_cselect_b32 s64, 0, s64
    v_mfma_f32_16x16x32_bf16 v[238:241], a[196:199], a[168:171], v[238:241]
    ds_read_b128 a[148:151], v4 offset:37888
    buffer_load_dwordx4 v59, s[24:27], s64 offen lds
    v_mfma_f32_16x16x32_bf16 v[222:225], a[188:191], a[168:171], v[222:225]
    v_mfma_f32_16x16x32_bf16 v[234:237], a[192:195], a[172:175], v[234:237]
    buffer_load_dwordx4 v60, s[24:27], s64 offen offset:1024 lds
    v_mfma_f32_16x16x32_bf16 v[242:245], a[196:199], a[172:175], v[242:245]
    v_mfma_f32_16x16x32_bf16 v[226:229], a[188:191], a[172:175], v[226:229]
    s_waitcnt lgkmcnt(6)
    v_mfma_f32_16x16x32_bf16 v[182:185], a[128:131], a[180:183], v[182:185]
    ds_read_b64_tr_b16 a[192:193], v70 offset:34816
    buffer_load_dwordx4 v61, s[24:27], s64 offen offset:2048 lds
    v_mfma_f32_16x16x32_bf16 v[190:193], a[128:131], a[184:187], v[190:193]
    ds_read_b64_tr_b16 a[194:195], v70 offset:35072
    v_mfma_f32_16x16x32_bf16 v[186:189], a[132:135], a[180:183], v[186:189]
    ds_read_b128 a[152:155], v4 offset:38912
    v_mfma_f32_16x16x32_bf16 v[194:197], a[132:135], a[184:187], v[194:197]
    ds_read_b64_tr_b16 a[196:197], v70 offset:35840
    s_waitcnt lgkmcnt(4)
    v_mfma_f32_16x16x32_bf16 v[206:209], a[136:139], a[180:183], v[206:209]
    ds_read_b64_tr_b16 a[198:199], v70 offset:36096
    buffer_load_dwordx4 v62, s[24:27], s64 offen offset:3072 lds
    v_mfma_f32_16x16x32_bf16 v[214:217], a[136:139], a[184:187], v[214:217]
    ds_read_b128 a[156:159], v4 offset:39936
    s_add_u32 m0, s58, 81920
    v_mfma_f32_16x16x32_bf16 v[198:201], a[136:139], a[176:179], v[198:201]
    ds_read_b128 a[160:163], v4 offset:40960
    s_add_u32 s64, s64, 524288
    v_mfma_f32_16x16x32_bf16 v[210:213], a[140:143], a[180:183], v[210:213]
    ds_read_b64_tr_b16 a[188:189], v71 offset:34816
    s_cmp_eq_u32 s64, 3670016
    v_mfma_f32_16x16x32_bf16 v[218:221], a[140:143], a[184:187], v[218:221]
    ds_read_b64_tr_b16 a[190:191], v71 offset:35072
    s_cselect_b32 s64, 0, s64
    v_mfma_f32_16x16x32_bf16 v[202:205], a[140:143], a[176:179], v[202:205]
    ds_read_b128 a[164:167], v4 offset:41984
    buffer_load_dwordx4 v59, s[24:27], s64 offen lds
    v_mfma_f32_16x16x32_bf16 v[230:233], a[180:183], a[144:147], v[230:233]
    ds_read_b128 a[168:171], v4 offset:43008
    v_mfma_f32_16x16x32_bf16 v[238:241], a[184:187], a[144:147], v[238:241]
    ds_read_b128 a[172:175], v4 offset:44032
    buffer_load_dwordx4 v60, s[24:27], s64 offen offset:1024 lds
    v_mfma_f32_16x16x32_bf16 v[222:225], a[176:179], a[144:147], v[222:225]
    v_mfma_f32_16x16x32_bf16 v[234:237], a[180:183], a[148:151], v[234:237]
    v_mfma_f32_16x16x32_bf16 v[242:245], a[184:187], a[148:151], v[242:245]
    buffer_load_dwordx4 v61, s[24:27], s64 offen offset:2048 lds
    v_mfma_f32_16x16x32_bf16 v[226:229], a[176:179], a[148:151], v[226:229]
    ds_read_b32 v24, v4
    s_waitcnt vmcnt(23) lgkmcnt(1)
    s_barrier
    v_mfma_f32_16x16x32_bf16 v[182:185], a[152:155], a[192:195], v[182:185]
    ds_read_b64_tr_b16 a[180:181], v72 offset:32768
    v_mfma_f32_16x16x32_bf16 v[190:193], a[152:155], a[196:199], v[190:193]
    ds_read_b64_tr_b16 a[182:183], v72 offset:33024
    buffer_load_dwordx4 v62, s[24:27], s64 offen offset:3072 lds
    v_mfma_f32_16x16x32_bf16 v[186:189], a[156:159], a[192:195], v[186:189]
    ds_read_b128 a[128:131], v53 offset:32768
    s_add_u32 m0, s58, 32768
    v_mfma_f32_16x16x32_bf16 v[194:197], a[156:159], a[196:199], v[194:197]
    ds_read_b64_tr_b16 a[184:185], v72 offset:33792
    v_mfma_f32_16x16x32_bf16 v[206:209], a[160:163], a[192:195], v[206:209]
    ds_read_b64_tr_b16 a[186:187], v72 offset:34048
    s_add_u32 s64, s64, 524288
    v_mfma_f32_16x16x32_bf16 v[214:217], a[160:163], a[196:199], v[214:217]
    ds_read_b128 a[132:135], v53 offset:33792
    s_cmp_eq_u32 s64, 3670016
    v_mfma_f32_16x16x32_bf16 v[198:201], a[160:163], a[188:191], v[198:201]
    ds_read_b128 a[136:139], v53 offset:34816
    s_cselect_b32 s64, 0, s64
    v_mfma_f32_16x16x32_bf16 v[210:213], a[164:167], a[192:195], v[210:213]
    ds_read_b64_tr_b16 a[176:177], v73 offset:32768
    buffer_load_dwordx4 v59, s[24:27], s64 offen lds
    v_mfma_f32_16x16x32_bf16 v[218:221], a[164:167], a[196:199], v[218:221]
    ds_read_b64_tr_b16 a[178:179], v73 offset:33024
    v_mfma_f32_16x16x32_bf16 v[202:205], a[164:167], a[188:191], v[202:205]
    ds_read_b128 a[140:143], v53 offset:35840
    buffer_load_dwordx4 v60, s[24:27], s64 offen offset:1024 lds
    v_mfma_f32_16x16x32_bf16 v[230:233], a[192:195], a[168:171], v[230:233]
    ds_read_b128 a[144:147], v53 offset:36864
    v_mfma_f32_16x16x32_bf16 v[238:241], a[196:199], a[168:171], v[238:241]
    ds_read_b128 a[148:151], v53 offset:37888
    v_mfma_f32_16x16x32_bf16 v[222:225], a[188:191], a[168:171], v[222:225]
    buffer_load_dwordx4 v61, s[24:27], s64 offen offset:2048 lds
    v_mfma_f32_16x16x32_bf16 v[234:237], a[192:195], a[172:175], v[234:237]
    v_mfma_f32_16x16x32_bf16 v[242:245], a[196:199], a[172:175], v[242:245]
    v_mfma_f32_16x16x32_bf16 v[226:229], a[188:191], a[172:175], v[226:229]
    buffer_load_dwordx4 v62, s[24:27], s64 offen offset:3072 lds
    s_waitcnt lgkmcnt(6)
    v_mfma_f32_16x16x32_bf16 v[182:185], a[128:131], a[180:183], v[182:185]
    ds_read_b64_tr_b16 a[192:193], v72 offset:34816
    s_add_u32 m0, s58, 49152
    v_mfma_f32_16x16x32_bf16 v[190:193], a[128:131], a[184:187], v[190:193]
    ds_read_b64_tr_b16 a[194:195], v72 offset:35072
    s_add_u32 s64, s64, 524288
    v_mfma_f32_16x16x32_bf16 v[186:189], a[132:135], a[180:183], v[186:189]
    ds_read_b128 a[152:155], v53 offset:38912
    s_cmp_eq_u32 s64, 3670016
    v_mfma_f32_16x16x32_bf16 v[194:197], a[132:135], a[184:187], v[194:197]
    ds_read_b64_tr_b16 a[196:197], v72 offset:35840
    s_waitcnt lgkmcnt(4)
    v_mfma_f32_16x16x32_bf16 v[206:209], a[136:139], a[180:183], v[206:209]
    ds_read_b64_tr_b16 a[198:199], v72 offset:36096
    s_cselect_b32 s64, 0, s64
    v_mfma_f32_16x16x32_bf16 v[214:217], a[136:139], a[184:187], v[214:217]
    ds_read_b128 a[156:159], v53 offset:39936
    buffer_load_dwordx4 v59, s[24:27], s64 offen lds
    v_mfma_f32_16x16x32_bf16 v[198:201], a[136:139], a[176:179], v[198:201]
    ds_read_b128 a[160:163], v53 offset:40960
    v_mfma_f32_16x16x32_bf16 v[210:213], a[140:143], a[180:183], v[210:213]
    ds_read_b64_tr_b16 a[188:189], v73 offset:34816
    buffer_load_dwordx4 v60, s[24:27], s64 offen offset:1024 lds
    v_mfma_f32_16x16x32_bf16 v[218:221], a[140:143], a[184:187], v[218:221]
    ds_read_b64_tr_b16 a[190:191], v73 offset:35072
    v_mfma_f32_16x16x32_bf16 v[202:205], a[140:143], a[176:179], v[202:205]
L_pad2:
    s_cbranch_execz L_warm
    ds_read_b128 a[164:167], v53 offset:41984
    v_mfma_f32_16x16x32_bf16 v[230:233], a[180:183], a[144:147], v[230:233]
    ds_read_b128 a[168:171], v53 offset:43008
    buffer_load_dwordx4 v61, s[24:27], s64 offen offset:2048 lds
    v_mfma_f32_16x16x32_bf16 v[238:241], a[184:187], a[144:147], v[238:241]
    ds_read_b128 a[172:175], v53 offset:44032
    v_mfma_f32_16x16x32_bf16 v[222:225], a[176:179], a[144:147], v[222:225]
    v_mfma_f32_16x16x32_bf16 v[234:237], a[180:183], a[148:151], v[234:237]
    buffer_load_dwordx4 v62, s[24:27], s64 offen offset:3072 lds
    v_mfma_f32_16x16x32_bf16 v[242:245], a[184:187], a[148:151], v[242:245]
    v_mfma_f32_16x16x32_bf16 v[226:229], a[176:179], a[148:151], v[226:229]
    ds_read_b32 v24, v4
    s_waitcnt vmcnt(24) lgkmcnt(1)
    s_barrier
    s_mov_b32 s14, 0
    s_load_dword s14, s[28:29], s38
    v_mfma_f32_16x16x32_bf16 v[182:185], a[152:155], a[192:195], v[182:185]
    ds_read_b64_tr_b16 a[180:181], v74 offset:0
    s_add_u32 m0, s58, 98304
    v_mfma_f32_16x16x32_bf16 v[190:193], a[152:155], a[196:199], v[190:193]
    ds_read_b64_tr_b16 a[182:183], v74 offset:256
    s_add_u32 s64, s64, 524288
    v_mfma_f32_16x16x32_bf16 v[186:189], a[156:159], a[192:195], v[186:189]
    ds_read_b128 a[128:131], v54 offset:0
    s_cmp_eq_u32 s64, 3670016
    v_mfma_f32_16x16x32_bf16 v[194:197], a[156:159], a[196:199], v[194:197]
    ds_read_b64_tr_b16 a[184:185], v74 offset:1024
    v_mfma_f32_16x16x32_bf16 v[206:209], a[160:163], a[192:195], v[206:209]
    ds_read_b64_tr_b16 a[186:187], v74 offset:1280
    s_cselect_b32 s64, 0, s64
    v_mfma_f32_16x16x32_bf16 v[214:217], a[160:163], a[196:199], v[214:217]
    ds_read_b128 a[132:135], v54 offset:1024
    buffer_load_dwordx4 v59, s[24:27], s64 offen lds
    v_mfma_f32_16x16x32_bf16 v[198:201], a[160:163], a[188:191], v[198:201]
    ds_read_b128 a[136:139], v54 offset:2048
    v_mfma_f32_16x16x32_bf16 v[210:213], a[164:167], a[192:195], v[210:213]
    ds_read_b64_tr_b16 a[176:177], v75 offset:0
    buffer_load_dwordx4 v60, s[24:27], s64 offen offset:1024 lds
    v_mfma_f32_16x16x32_bf16 v[218:221], a[164:167], a[196:199], v[218:221]
    ds_read_b64_tr_b16 a[178:179], v75 offset:256
    v_mfma_f32_16x16x32_bf16 v[202:205], a[164:167], a[188:191], v[202:205]
    ds_read_b128 a[140:143], v54 offset:3072
    v_mfma_f32_16x16x32_bf16 v[230:233], a[192:195], a[168:171], v[230:233]
    ds_read_b128 a[144:147], v54 offset:4096
    buffer_load_dwordx4 v61, s[24:27], s64 offen offset:2048 lds
    v_mfma_f32_16x16x32_bf16 v[238:241], a[196:199], a[168:171], v[238:241]
    ds_read_b128 a[148:151], v54 offset:5120
    v_mfma_f32_16x16x32_bf16 v[222:225], a[188:191], a[168:171], v[222:225]
    v_mfma_f32_16x16x32_bf16 v[234:237], a[192:195], a[172:175], v[234:237]
    buffer_load_dwordx4 v62, s[24:27], s64 offen offset:3072 lds
    s_add_u32 m0, s58, 114688
    v_mfma_f32_16x16x32_bf16 v[242:245], a[196:199], a[172:175], v[242:245]
    s_add_u32 s64, s64, 524288
    s_cmp_eq_u32 s64, 3670016
    v_mfma_f32_16x16x32_bf16 v[226:229], a[188:191], a[172:175], v[226:229]
    s_cselect_b32 s64, 0, s64
    s_waitcnt lgkmcnt(6)
    v_mfma_f32_16x16x32_bf16 v[182:185], a[128:131], a[180:183], v[182:185]
    ds_read_b64_tr_b16 a[192:193], v74 offset:2048
    buffer_load_dwordx4 v59, s[24:27], s64 offen lds
    v_mfma_f32_16x16x32_bf16 v[190:193], a[128:131], a[184:187], v[190:193]
    ds_read_b64_tr_b16 a[194:195], v74 offset:2304
    v_mfma_f32_16x16x32_bf16 v[186:189], a[132:135], a[180:183], v[186:189]
    ds_read_b128 a[152:155], v54 offset:6144
    v_mfma_f32_16x16x32_bf16 v[194:197], a[132:135], a[184:187], v[194:197]
    ds_read_b64_tr_b16 a[196:197], v74 offset:3072
    s_waitcnt lgkmcnt(4)
    v_mfma_f32_16x16x32_bf16 v[206:209], a[136:139], a[180:183], v[206:209]
    ds_read_b64_tr_b16 a[198:199], v74 offset:3328
    buffer_load_dwordx4 v60, s[24:27], s64 offen offset:1024 lds
    v_mfma_f32_16x16x32_bf16 v[214:217], a[136:139], a[184:187], v[214:217]
    ds_read_b128 a[156:159], v54 offset:7168
    v_mfma_f32_16x16x32_bf16 v[198:201], a[136:139], a[176:179], v[198:201]
    ds_read_b128 a[160:163], v54 offset:8192
    buffer_load_dwordx4 v61, s[24:27], s64 offen offset:2048 lds
    v_mfma_f32_16x16x32_bf16 v[210:213], a[140:143], a[180:183], v[210:213]
    ds_read_b64_tr_b16 a[188:189], v75 offset:2048
    v_mfma_f32_16x16x32_bf16 v[218:221], a[140:143], a[184:187], v[218:221]
    ds_read_b64_tr_b16 a[190:191], v75 offset:2304
    v_mfma_f32_16x16x32_bf16 v[202:205], a[140:143], a[176:179], v[202:205]
    ds_read_b128 a[164:167], v54 offset:9216
    buffer_load_dwordx4 v62, s[24:27], s64 offen offset:3072 lds
    v_mfma_f32_16x16x32_bf16 v[230:233], a[180:183], a[144:147], v[230:233]
    ds_read_b128 a[168:171], v54 offset:10240
    v_mfma_f32_16x16x32_bf16 v[238:241], a[184:187], a[144:147], v[238:241]
    ds_read_b128 a[172:175], v54 offset:11264
    v_mfma_f32_16x16x32_bf16 v[222:225], a[176:179], a[144:147], v[222:225]
    v_mfma_f32_16x16x32_bf16 v[234:237], a[180:183], a[148:151], v[234:237]
    v_mfma_f32_16x16x32_bf16 v[242:245], a[184:187], a[148:151], v[242:245]
    v_mfma_f32_16x16x32_bf16 v[226:229], a[176:179], a[148:151], v[226:229]
    ds_read_b32 v24, v4
    s_waitcnt vmcnt(16) lgkmcnt(1)
    s_barrier
    s_cmp_ge_u32 s14, 7
    s_cbranch_scc0 L_pollin5
L_pollok5:
    v_mfma_f32_16x16x32_bf16 v[182:185], a[152:155], a[192:195], v[182:185]
    ds_read_b64_tr_b16 a[200:201], v31 offset:16384
    buffer_load_dwordx4 a[0:3], v79, s[28:31], s65 offen offset:0 sc1
    v_mfma_f32_16x16x32_bf16 v[190:193], a[152:155], a[196:199], v[190:193]
    ds_read_b64_tr_b16 a[202:203], v31 offset:18432
    v_mfma_f32_16x16x32_bf16 v[186:189], a[156:159], a[192:195], v[186:189]
    ds_read_b64_tr_b16 a[204:205], v33 offset:16384
    buffer_load_dwordx4 a[4:7], v79, s[28:31], s65 offen offset:1024 sc1
    v_mfma_f32_16x16x32_bf16 v[194:197], a[156:159], a[196:199], v[194:197]
    ds_read_b64_tr_b16 a[206:207], v33 offset:18432
    v_mfma_f32_16x16x32_bf16 v[206:209], a[160:163], a[192:195], v[206:209]
    ds_read_b64_tr_b16 a[208:209], v32 offset:16384
    v_mfma_f32_16x16x32_bf16 v[214:217], a[160:163], a[196:199], v[214:217]
    ds_read_b64_tr_b16 a[210:211], v32 offset:18432
    v_mfma_f32_16x16x32_bf16 v[198:201], a[160:163], a[188:191], v[198:201]
    ds_read_b64_tr_b16 a[212:213], v34 offset:16384
    buffer_load_dwordx4 a[8:11], v79, s[28:31], s65 offen offset:2048 sc1
    v_mfma_f32_16x16x32_bf16 v[210:213], a[164:167], a[192:195], v[210:213]
    ds_read_b64_tr_b16 a[214:215], v34 offset:18432
    v_mfma_f32_16x16x32_bf16 v[218:221], a[164:167], a[196:199], v[218:221]
    ds_read_b64_tr_b16 a[216:217], v31 offset:20480
    v_mfma_f32_16x16x32_bf16 v[202:205], a[164:167], a[188:191], v[202:205]
    ds_read_b64_tr_b16 a[218:219], v31 offset:22528
    buffer_load_dwordx4 a[12:15], v79, s[28:31], s65 offen offset:3072 sc1
    v_mfma_f32_16x16x32_bf16 v[230:233], a[192:195], a[168:171], v[230:233]
    ds_read_b64_tr_b16 a[220:221], v33 offset:20480
    s_add_u32 s65, s65, 8192
    v_mfma_f32_16x16x32_bf16 v[238:241], a[196:199], a[168:171], v[238:241]
    ds_read_b64_tr_b16 a[222:223], v33 offset:22528
    s_cmp_eq_u32 s65, 57344
    v_mfma_f32_16x16x32_bf16 v[222:225], a[188:191], a[168:171], v[222:225]
    s_cselect_b32 s65, 0, s65
    v_mfma_f32_16x16x32_bf16 v[234:237], a[192:195], a[172:175], v[234:237]
    buffer_load_dwordx4 a[16:19], v79, s[28:31], s65 offen offset:0 sc1
    v_mfma_f32_16x16x32_bf16 v[242:245], a[196:199], a[172:175], v[242:245]
    v_mfma_f32_16x16x32_bf16 v[226:229], a[188:191], a[172:175], v[226:229]
    v_cvt_pk_bf16_f32 v118, v182, v183
    v_cvt_pk_bf16_f32 v119, v184, v185
    v_cvt_pk_bf16_f32 v120, v186, v187
    buffer_load_dwordx4 a[20:23], v79, s[28:31], s65 offen offset:1024 sc1
    v_cvt_pk_bf16_f32 v121, v188, v189
    v_cvt_pk_bf16_f32 v122, v190, v191
    v_cvt_pk_bf16_f32 v123, v192, v193
    v_cvt_pk_bf16_f32 v124, v194, v195
    v_cvt_pk_bf16_f32 v125, v196, v197
    v_cvt_pk_bf16_f32 v130, v206, v207
    v_cvt_pk_bf16_f32 v131, v208, v209
    v_cvt_pk_bf16_f32 v132, v210, v211
    v_cvt_pk_bf16_f32 v133, v212, v213
    v_cvt_pk_bf16_f32 v134, v214, v215
    v_cvt_pk_bf16_f32 v135, v216, v217
    v_cvt_pk_bf16_f32 v136, v218, v219
    v_cvt_pk_bf16_f32 v137, v220, v221
    v_cvt_pk_bf16_f32 v126, v198, v199
    buffer_load_dwordx4 a[24:27], v79, s[28:31], s65 offen offset:2048 sc1
    v_cvt_pk_bf16_f32 v127, v200, v201
    v_cvt_pk_bf16_f32 v128, v202, v203
    v_cvt_pk_bf16_f32 v129, v204, v205
    v_mfma_f32_16x16x32_bf16 v[154:157], v[130:133], v[118:121], 0
    v_mfma_f32_16x16x32_bf16 v[158:161], v[130:133], v[122:125], 0
    v_mfma_f32_16x16x32_bf16 v[162:165], v[134:137], v[122:125], 0
    buffer_load_dwordx4 a[28:31], v79, s[28:31], s65 offen offset:3072 sc1
    v_mfma_f32_16x16x32_bf16 v[150:153], v[126:129], v[118:121], 0
    v_cvt_pk_bf16_f32 v166, v222, v223
    v_cvt_pk_bf16_f32 v167, v224, v225
    v_cvt_pk_bf16_f32 v168, v230, v231
    v_cvt_pk_bf16_f32 v169, v232, v233
    v_cvt_pk_bf16_f32 v170, v238, v239
    v_cvt_pk_bf16_f32 v171, v240, v241
    v_cndmask_b32 v250, v158, v159, s[70:71]
    v_cndmask_b32 v253, v162, v163, s[70:71]
    v_cndmask_b32 v250, v250, v253, s[72:73]
    s_add_u32 s65, s65, 8192
    s_cmp_eq_u32 s65, 57344
    s_cselect_b32 s65, 0, s65
    buffer_load_dwordx4 a[32:35], v79, s[28:31], s65 offen offset:0 sc1
    v_mul_f32 v250, v250, v29
    v_cndmask_b32 v251, v160, v161, s[70:71]
    v_cndmask_b32 v253, v164, v165, s[70:71]
    v_cndmask_b32 v251, v251, v253, s[74:75]
    v_mul_f32 v251, v251, v30
    v_cndmask_b32 v246, v150, v151, s[70:71]
    v_cndmask_b32 v246, v84, v246, s[76:77]
    v_cndmask_b32 v249, v154, v155, s[70:71]
    v_cndmask_b32 v246, v246, v249, s[72:73]
    v_mul_f32 v246, v246, v27
    v_cndmask_b32 v247, v152, v153, s[70:71]
    v_cndmask_b32 v247, v84, v247, s[76:77]
    v_cndmask_b32 v249, v156, v157, s[70:71]
    v_cndmask_b32 v247, v247, v249, s[74:75]
    buffer_load_dwordx4 a[36:39], v79, s[28:31], s65 offen offset:1024 sc1
    v_mul_f32 v247, v247, v28
    v_max_f32 v248, v246, v247
    v_max_f32 v252, v250, v251
    v_mov_b32 v249, v248
    v_mov_b32 v253, v252
    v_cvt_pk_bf16_f32 v172, v226, v227
    v_permlane16_swap_b32 v248, v249
    v_permlane16_swap_b32 v252, v253
    v_max_f32 v248, v248, v249
    v_max_f32 v252, v252, v253
    v_mov_b32 v249, v248
    v_mov_b32 v253, v252
    v_cvt_pk_bf16_f32 v173, v228, v229
    v_permlane32_swap_b32 v248, v249
    buffer_load_dwordx4 a[40:43], v79, s[28:31], s65 offen offset:2048 sc1
    v_permlane32_swap_b32 v252, v253
    v_max_f32 v248, v248, v249
    v_max_f32 v252, v252, v253
    v_mul_f32 v248, v25, v248
    v_mul_f32 v252, v26, v252
    v_fma_f32 v246, v246, v25, -v248
    v_fma_f32 v247, v247, v25, -v248
    v_fma_f32 v250, v250, v26, -v252
    v_fma_f32 v251, v251, v26, -v252
    v_exp_f32 v246, v246
    v_exp_f32 v247, v247
    v_exp_f32 v250, v250
    buffer_load_dwordx4 a[44:47], v79, s[28:31], s65 offen offset:3072 sc1
    v_exp_f32 v251, v251
    v_add_f32 v248, v246, v247
    v_add_f32 v252, v250, v251
    v_mov_b32 v249, v248
    v_mov_b32 v253, v252
    v_cvt_pk_bf16_f32 v174, v234, v235
    v_permlane16_swap_b32 v248, v249
    v_permlane16_swap_b32 v252, v253
    v_add_f32 v248, v248, v249
    v_add_f32 v252, v252, v253
    v_mov_b32 v249, v248
    v_mov_b32 v253, v252
    s_add_u32 m0, s58, 131072
    s_add_u32 s64, s64, 524288
    s_cmp_eq_u32 s64, 3670016
    s_cselect_b32 s64, 0, s64
    s_add_u32 s64, s64, 524288
    s_cmp_eq_u32 s64, 3670016
    s_cselect_b32 s64, 0, s64
    v_xor_b32 v59, 128, v59
    buffer_load_dwordx4 v59, s[24:27], s64 offen lds
    v_cvt_pk_bf16_f32 v175, v236, v237
    v_permlane32_swap_b32 v248, v249
    v_permlane32_swap_b32 v252, v253
    v_add_f32 v248, v248, v249
    v_add_f32 v252, v252, v253
    v_rcp_f32 v248, v248
    v_rcp_f32 v252, v252
    v_cvt_pk_bf16_f32 v176, v242, v243
    v_cvt_pk_bf16_f32 v177, v244, v245
    v_mul_f32 v246, v246, v27
    v_xor_b32 v60, 128, v60
    buffer_load_dwordx4 v60, s[24:27], s64 offen offset:1024 lds
    v_mul_f32 v247, v247, v28
    v_mul_f32 v250, v250, v29
    v_mul_f32 v251, v251, v30
    v_mul_f32 v246, v246, v248
    v_mul_f32 v247, v247, v248
    v_mul_f32 v250, v250, v252
    v_mul_f32 v251, v251, v252
    v_cvt_pk_bf16_f32 v246, v246, v246
    v_cvt_pk_bf16_f32 v247, v247, v247
    v_cvt_pk_bf16_f32 v250, v250, v250
    v_cvt_pk_bf16_f32 v251, v251, v251
    v_and_b32 v138, v246, v104
    v_and_b32 v139, v247, v105
    v_xor_b32 v61, 128, v61
    buffer_load_dwordx4 v61, s[24:27], s64 offen offset:2048 lds
    v_and_b32 v140, v246, v106
    v_and_b32 v141, v247, v107
    v_and_b32 v142, v250, v104
    v_and_b32 v143, v251, v105
    v_and_b32 v144, v250, v106
    v_and_b32 v145, v251, v107
    v_mfma_f32_16x16x32_bf16 v[182:185], v[166:169], v[138:141], 0
    v_mfma_f32_16x16x32_bf16 v[186:189], v[172:175], v[138:141], 0
    v_xor_b32 v62, 128, v62
    buffer_load_dwordx4 v62, s[24:27], s64 offen offset:3072 lds
    v_mfma_f32_16x16x32_bf16 v[190:193], v[168:171], v[142:145], 0
    v_mfma_f32_16x16x32_bf16 v[194:197], v[174:177], v[142:145], 0
    s_add_u32 s83, s82, 16384
    s_nop 1
    v_cvt_pk_bf16_f32 v110, v182, v183
    v_cvt_pk_bf16_f32 v111, v184, v185
    s_add_u32 m0, s58, 147456
    s_add_u32 s64, s64, 524288
    s_cmp_eq_u32 s64, 3670016
    s_cselect_b32 s64, 0, s64
    buffer_load_dwordx4 v59, s[24:27], s64 offen lds
    v_cvt_pk_bf16_f32 v112, v186, v187
    v_cvt_pk_bf16_f32 v113, v188, v189
    v_cvt_pk_bf16_f32 v114, v190, v191
    v_cvt_pk_bf16_f32 v115, v192, v193
    v_cvt_pk_bf16_f32 v116, v194, v195
    v_cvt_pk_bf16_f32 v117, v196, v197
    buffer_store_dwordx4 v[110:113], v4, s[28:31], s82 offen sc1
    buffer_store_dwordx4 v[114:117], v4, s[28:31], s83 offen sc1
    s_cmp_lg_u32 s56, 0
    s_cbranch_scc0 L_nof
L_f:
    s_waitcnt vmcnt(17) lgkmcnt(8)
    v_mfma_f32_16x16x32_bf16 v[182:185], a[0:3], a[200:203], 0
    ds_read_b64_tr_b16 a[224:225], v32 offset:20480
    s_add_u32 s65, s65, 8192
    s_cmp_eq_u32 s65, 57344
    s_cselect_b32 s65, 0, s65
    buffer_load_dwordx4 a[48:51], v79, s[28:31], s65 offen offset:0 sc1
    v_mfma_f32_16x16x32_bf16 v[186:189], a[4:7], a[200:203], 0
    ds_read_b64_tr_b16 a[226:227], v32 offset:22528
    v_lshlrev_b32 v93, 16, v93
    v_mfma_f32_16x16x32_bf16 v[238:241], a[0:3], a[204:207], 0
    ds_read_b64_tr_b16 a[228:229], v34 offset:20480
    buffer_load_dwordx4 a[52:55], v79, s[28:31], s65 offen offset:1024 sc1
    v_mfma_f32_16x16x32_bf16 v[242:245], a[4:7], a[204:207], 0
    ds_read_b64_tr_b16 a[230:231], v34 offset:22528
    s_waitcnt lgkmcnt(8)
    v_mfma_f32_16x16x32_bf16 v[190:193], a[0:3], a[208:211], 0
    ds_read_b64_tr_b16 a[200:201], v35 offset:0
    v_lshlrev_b32 v222, 16, v96
    v_mfma_f32_16x16x32_bf16 v[194:197], a[4:7], a[208:211], 0
    ds_read_b64_tr_b16 a[202:203], v35 offset:2048
    v_and_b32 v223, 0xffff0000, v96
    v_mfma_f32_16x16x32_bf16 v[246:249], a[0:3], a[212:215], 0
    ds_read_b64_tr_b16 a[204:205], v37 offset:0
    buffer_load_dwordx4 a[56:59], v79, s[28:31], s65 offen offset:2048 sc1
    v_mfma_f32_16x16x32_bf16 v[250:253], a[4:7], a[212:215], 0
    ds_read_b64_tr_b16 a[206:207], v37 offset:2048
    s_waitcnt vmcnt(18) lgkmcnt(8)
    v_mfma_f32_16x16x32_bf16 v[182:185], a[8:11], a[216:219], v[182:185]
    ds_read_b64_tr_b16 a[208:209], v36 offset:0
    v_add_f32 v222, v222, v93
    v_mfma_f32_16x16x32_bf16 v[186:189], a[12:15], a[216:219], v[186:189]
    ds_read_b64_tr_b16 a[210:211], v36 offset:2048
    buffer_load_dwordx4 a[60:63], v79, s[28:31], s65 offen offset:3072 sc1
    v_add_f32 v223, v223, v93
    v_mfma_f32_16x16x32_bf16 v[238:241], a[8:11], a[220:223], v[238:241]
    ds_read_b64_tr_b16 a[212:213], v38 offset:0
    s_add_u32 s65, s65, 8192
    v_mfma_f32_16x16x32_bf16 v[242:245], a[12:15], a[220:223], v[242:245]
    ds_read_b64_tr_b16 a[214:215], v38 offset:2048
    s_waitcnt lgkmcnt(8)
    v_mfma_f32_16x16x32_bf16 v[190:193], a[8:11], a[224:227], v[190:193]
    ds_read_b64_tr_b16 a[216:217], v35 offset:4096
    s_cmp_eq_u32 s65, 57344
    v_mfma_f32_16x16x32_bf16 v[194:197], a[12:15], a[224:227], v[194:197]
    ds_read_b64_tr_b16 a[218:219], v35 offset:6144
    s_cselect_b32 s65, 0, s65
    v_lshlrev_b32 v224, 16, v97
    v_mfma_f32_16x16x32_bf16 v[246:249], a[8:11], a[228:231], v[246:249]
    ds_read_b64_tr_b16 a[220:221], v37 offset:4096
    buffer_load_dwordx4 a[64:67], v79, s[28:31], s65 offen offset:0 sc1
    v_mfma_f32_16x16x32_bf16 v[250:253], a[12:15], a[228:231], v[250:253]
    ds_read_b64_tr_b16 a[222:223], v37 offset:6144
    s_waitcnt vmcnt(18) lgkmcnt(8)
    v_mfma_f32_16x16x32_bf16 v[182:185], a[16:19], a[200:203], v[182:185]
    ds_read_b64_tr_b16 a[224:225], v36 offset:4096
    buffer_load_dwordx4 a[68:71], v79, s[28:31], s65 offen offset:1024 sc1
    v_mfma_f32_16x16x32_bf16 v[186:189], a[20:23], a[200:203], v[186:189]
    ds_read_b64_tr_b16 a[226:227], v36 offset:6144
    v_and_b32 v225, 0xffff0000, v97
    v_mfma_f32_16x16x32_bf16 v[238:241], a[16:19], a[204:207], v[238:241]
    ds_read_b64_tr_b16 a[228:229], v38 offset:4096
    v_add_f32 v224, v224, v93
    v_mfma_f32_16x16x32_bf16 v[242:245], a[20:23], a[204:207], v[242:245]
    ds_read_b64_tr_b16 a[230:231], v38 offset:6144
    s_waitcnt lgkmcnt(8)
    v_mfma_f32_16x16x32_bf16 v[190:193], a[16:19], a[208:211], v[190:193]
    ds_read_b64_tr_b16 a[200:201], v35 offset:16384
    buffer_load_dwordx4 a[72:75], v79, s[28:31], s65 offen offset:2048 sc1
    v_mfma_f32_16x16x32_bf16 v[194:197], a[20:23], a[208:211], v[194:197]
    ds_read_b64_tr_b16 a[202:203], v35 offset:18432
    v_add_f32 v225, v225, v93
    v_mfma_f32_16x16x32_bf16 v[246:249], a[16:19], a[212:215], v[246:249]
    ds_read_b64_tr_b16 a[204:205], v37 offset:16384
    v_lshlrev_b32 v226, 16, v98
    v_mfma_f32_16x16x32_bf16 v[250:253], a[20:23], a[212:215], v[250:253]
    ds_read_b64_tr_b16 a[206:207], v37 offset:18432
    s_waitcnt vmcnt(18) lgkmcnt(8)
    v_mfma_f32_16x16x32_bf16 v[182:185], a[24:27], a[216:219], v[182:185]
    ds_read_b64_tr_b16 a[208:209], v36 offset:16384
    buffer_load_dwordx4 a[76:79], v79, s[28:31], s65 offen offset:3072 sc1
    v_mfma_f32_16x16x32_bf16 v[186:189], a[28:31], a[216:219], v[186:189]
    ds_read_b64_tr_b16 a[210:211], v36 offset:18432
    s_add_u32 s65, s65, 8192
    v_and_b32 v227, 0xffff0000, v98
    v_mfma_f32_16x16x32_bf16 v[238:241], a[24:27], a[220:223], v[238:241]
    ds_read_b64_tr_b16 a[212:213], v38 offset:16384
    s_cmp_eq_u32 s65, 57344
    v_mfma_f32_16x16x32_bf16 v[242:245], a[28:31], a[220:223], v[242:245]
    ds_read_b64_tr_b16 a[214:215], v38 offset:18432
    v_add_f32 v226, v226, v93
    s_waitcnt lgkmcnt(8)
    v_mfma_f32_16x16x32_bf16 v[190:193], a[24:27], a[224:227], v[190:193]
    ds_read_b64_tr_b16 a[216:217], v35 offset:20480
    s_cselect_b32 s65, 0, s65
    buffer_load_dwordx4 a[80:83], v79, s[28:31], s65 offen offset:0 sc1
    v_mfma_f32_16x16x32_bf16 v[194:197], a[28:31], a[224:227], v[194:197]
    ds_read_b64_tr_b16 a[218:219], v35 offset:22528
    v_add_f32 v227, v227, v93
    v_mfma_f32_16x16x32_bf16 v[246:249], a[24:27], a[228:231], v[246:249]
    ds_read_b64_tr_b16 a[220:221], v37 offset:20480
    buffer_load_dwordx4 a[84:87], v79, s[28:31], s65 offen offset:1024 sc1
    v_mfma_f32_16x16x32_bf16 v[250:253], a[28:31], a[228:231], v[250:253]
    ds_read_b64_tr_b16 a[222:223], v37 offset:22528
    v_lshlrev_b32 v228, 16, v99
    s_waitcnt vmcnt(19) lgkmcnt(8)
    v_mfma_f32_16x16x32_bf16 v[182:185], a[32:35], a[200:203], v[182:185]
    ds_read_b64_tr_b16 a[224:225], v36 offset:20480
    v_and_b32 v229, 0xffff0000, v99
    v_mfma_f32_16x16x32_bf16 v[186:189], a[36:39], a[200:203], v[186:189]
    ds_read_b64_tr_b16 a[226:227], v36 offset:22528
    buffer_load_dwordx4 a[88:91], v79, s[28:31], s65 offen offset:2048 sc1
    v_add_f32 v228, v228, v93
    v_mfma_f32_16x16x32_bf16 v[238:241], a[32:35], a[204:207], v[238:241]
    ds_read_b64_tr_b16 a[228:229], v38 offset:20480
    v_add_f32 v229, v229, v93
    v_mfma_f32_16x16x32_bf16 v[242:245], a[36:39], a[204:207], v[242:245]
    ds_read_b64_tr_b16 a[230:231], v38 offset:22528
    s_waitcnt lgkmcnt(8)
    v_mfma_f32_16x16x32_bf16 v[190:193], a[32:35], a[208:211], v[190:193]
    s_waitcnt vmcnt(11)
    s_barrier
    s_cmp_lg_u32 s48, 0
    s_cbranch_scc1 L_sig4
    s_atomic_add s36, s[28:29], s69
L_sig4:
    ds_read_b64_tr_b16 a[200:201], v31 offset:32768
    buffer_load_dwordx4 a[92:95], v79, s[28:31], s65 offen offset:3072 sc1
    v_mfma_f32_16x16x32_bf16 v[194:197], a[36:39], a[208:211], v[194:197]
    ds_read_b64_tr_b16 a[202:203], v31 offset:34816
    s_add_u32 s65, s65, 8192
    v_lshlrev_b32 v94, 16, v94
    v_mfma_f32_16x16x32_bf16 v[246:249], a[32:35], a[212:215], v[246:249]
    ds_read_b64_tr_b16 a[204:205], v33 offset:32768
    s_cmp_eq_u32 s65, 57344
    v_mfma_f32_16x16x32_bf16 v[250:253], a[36:39], a[212:215], v[250:253]
    ds_read_b64_tr_b16 a[206:207], v33 offset:34816
    s_waitcnt lgkmcnt(8)
    v_mfma_f32_16x16x32_bf16 v[182:185], a[40:43], a[216:219], v[182:185]
    ds_read_b64_tr_b16 a[208:209], v32 offset:32768
    s_cselect_b32 s65, 0, s65
    v_mfma_f32_16x16x32_bf16 v[186:189], a[44:47], a[216:219], v[186:189]
    ds_read_b64_tr_b16 a[210:211], v32 offset:34816
    buffer_load_dwordx4 a[96:99], v79, s[28:31], s65 offen offset:0 sc1
    v_lshlrev_b32 v230, 16, v100
    v_mfma_f32_16x16x32_bf16 v[238:241], a[40:43], a[220:223], v[238:241]
    ds_read_b64_tr_b16 a[212:213], v34 offset:32768
    v_and_b32 v231, 0xffff0000, v100
    v_mfma_f32_16x16x32_bf16 v[242:245], a[44:47], a[220:223], v[242:245]
    ds_read_b64_tr_b16 a[214:215], v34 offset:34816
    s_waitcnt lgkmcnt(8)
    v_mfma_f32_16x16x32_bf16 v[190:193], a[40:43], a[224:227], v[190:193]
    ds_read_b64_tr_b16 a[216:217], v31 offset:36864
    buffer_load_dwordx4 a[100:103], v79, s[28:31], s65 offen offset:1024 sc1
    v_mfma_f32_16x16x32_bf16 v[194:197], a[44:47], a[224:227], v[194:197]
    ds_read_b64_tr_b16 a[218:219], v31 offset:38912
    v_add_f32 v230, v230, v94
    v_mfma_f32_16x16x32_bf16 v[246:249], a[40:43], a[228:231], v[246:249]
    ds_read_b64_tr_b16 a[220:221], v33 offset:36864
    buffer_load_dwordx4 a[104:107], v79, s[28:31], s65 offen offset:2048 sc1
    v_mfma_f32_16x16x32_bf16 v[250:253], a[44:47], a[228:231], v[250:253]
    ds_read_b64_tr_b16 a[222:223], v33 offset:38912
    v_add_f32 v231, v231, v94
    s_waitcnt vmcnt(13) lgkmcnt(8)
    v_mfma_f32_16x16x32_bf16 v[182:185], a[48:51], a[200:203], v[182:185]
    ds_read_b64_tr_b16 a[224:225], v32 offset:36864
    v_lshlrev_b32 v232, 16, v101
    v_mfma_f32_16x16x32_bf16 v[186:189], a[52:55], a[200:203], v[186:189]
    ds_read_b64_tr_b16 a[226:227], v32 offset:38912
    v_and_b32 v233, 0xffff0000, v101
    v_mfma_f32_16x16x32_bf16 v[238:241], a[48:51], a[204:207], v[238:241]
    ds_read_b64_tr_b16 a[228:229], v34 offset:36864
    buffer_load_dwordx4 a[108:111], v79, s[28:31], s65 offen offset:3072 sc1
    v_mfma_f32_16x16x32_bf16 v[242:245], a[52:55], a[204:207], v[242:245]
    ds_read_b64_tr_b16 a[230:231], v34 offset:38912
    s_waitcnt lgkmcnt(8)
    v_mfma_f32_16x16x32_bf16 v[190:193], a[48:51], a[208:211], v[190:193]
    ds_read_b64_tr_b16 a[200:201], v31 offset:49152
    v_add_f32 v232, v232, v94
    v_mfma_f32_16x16x32_bf16 v[194:197], a[52:55], a[208:211], v[194:197]
    ds_read_b64_tr_b16 a[202:203], v31 offset:51200
    buffer_load_dwordx4 v60, s[24:27], s64 offen offset:1024 lds
    v_add_f32 v233, v233, v94
    v_mfma_f32_16x16x32_bf16 v[246:249], a[48:51], a[212:215], v[246:249]
    ds_read_b64_tr_b16 a[204:205], v33 offset:49152
    v_lshlrev_b32 v234, 16, v102
    v_mfma_f32_16x16x32_bf16 v[250:253], a[52:55], a[212:215], v[250:253]
    ds_read_b64_tr_b16 a[206:207], v33 offset:51200
    s_waitcnt vmcnt(13) lgkmcnt(8)
    v_mfma_f32_16x16x32_bf16 v[182:185], a[56:59], a[216:219], v[182:185]
    ds_read_b64_tr_b16 a[208:209], v32 offset:49152
    buffer_load_dwordx4 v61, s[24:27], s64 offen offset:2048 lds
    v_mfma_f32_16x16x32_bf16 v[186:189], a[60:63], a[216:219], v[186:189]
    ds_read_b64_tr_b16 a[210:211], v32 offset:51200
    v_and_b32 v235, 0xffff0000, v102
    v_mfma_f32_16x16x32_bf16 v[238:241], a[56:59], a[220:223], v[238:241]
    ds_read_b64_tr_b16 a[212:213], v34 offset:49152
    buffer_load_dwordx4 v62, s[24:27], s64 offen offset:3072 lds
    v_mfma_f32_16x16x32_bf16 v[242:245], a[60:63], a[220:223], v[242:245]
    ds_read_b64_tr_b16 a[214:215], v34 offset:51200
    s_waitcnt lgkmcnt(8)
    v_mfma_f32_16x16x32_bf16 v[190:193], a[56:59], a[224:227], v[190:193]
    ds_read_b64_tr_b16 a[216:217], v31 offset:53248
    s_add_u32 m0, s58, 16384
    v_mfma_f32_16x16x32_bf16 v[194:197], a[60:63], a[224:227], v[194:197]
    ds_read_b64_tr_b16 a[218:219], v31 offset:55296
    s_add_u32 s64, s64, 524288
    v_add_f32 v234, v234, v94
    v_mfma_f32_16x16x32_bf16 v[246:249], a[56:59], a[228:231], v[246:249]
    ds_read_b64_tr_b16 a[220:221], v33 offset:53248
    s_cmp_eq_u32 s64, 3670016
    v_mfma_f32_16x16x32_bf16 v[250:253], a[60:63], a[228:231], v[250:253]
    ds_read_b64_tr_b16 a[222:223], v33 offset:55296
    s_cselect_b32 s64, 0, s64
    buffer_load_dwordx4 v59, s[24:27], s64 offen lds
    v_add_f32 v235, v235, v94
    s_waitcnt vmcnt(14) lgkmcnt(8)
    v_mfma_f32_16x16x32_bf16 v[182:185], a[64:67], a[200:203], v[182:185]
    ds_read_b64_tr_b16 a[224:225], v32 offset:53248
    v_lshlrev_b32 v236, 16, v103
    v_mfma_f32_16x16x32_bf16 v[186:189], a[68:71], a[200:203], v[186:189]
    ds_read_b64_tr_b16 a[226:227], v32 offset:55296
    buffer_load_dwordx4 v60, s[24:27], s64 offen offset:1024 lds
    v_and_b32 v237, 0xffff0000, v103
    v_mfma_f32_16x16x32_bf16 v[238:241], a[64:67], a[204:207], v[238:241]
    ds_read_b64_tr_b16 a[228:229], v34 offset:53248
    v_add_f32 v236, v236, v94
    v_mfma_f32_16x16x32_bf16 v[242:245], a[68:71], a[204:207], v[242:245]
    ds_read_b64_tr_b16 a[230:231], v34 offset:55296
    s_waitcnt lgkmcnt(8)
    v_mfma_f32_16x16x32_bf16 v[190:193], a[64:67], a[208:211], v[190:193]
    s_barrier
    ds_read_b64_tr_b16 a[200:201], v35 offset:32768
    buffer_load_dwordx4 v61, s[24:27], s64 offen offset:2048 lds
    v_mfma_f32_16x16x32_bf16 v[194:197], a[68:71], a[208:211], v[194:197]
    ds_read_b64_tr_b16 a[202:203], v35 offset:34816
    v_add_f32 v237, v237, v94
    v_mfma_f32_16x16x32_bf16 v[246:249], a[64:67], a[212:215], v[246:249]
    ds_read_b64_tr_b16 a[204:205], v37 offset:32768
    v_mfma_f32_16x16x32_bf16 v[250:253], a[68:71], a[212:215], v[250:253]
    ds_read_b64_tr_b16 a[206:207], v37 offset:34816
    s_waitcnt vmcnt(14) lgkmcnt(8)
    v_mfma_f32_16x16x32_bf16 v[182:185], a[72:75], a[216:219], v[182:185]
    ds_read_b64_tr_b16 a[208:209], v36 offset:32768
    buffer_load_dwordx4 v62, s[24:27], s64 offen offset:3072 lds
    v_mfma_f32_16x16x32_bf16 v[186:189], a[76:79], a[216:219], v[186:189]
    ds_read_b64_tr_b16 a[210:211], v36 offset:34816
    s_add_u32 m0, s58, 65536
    v_mfma_f32_16x16x32_bf16 v[238:241], a[72:75], a[220:223], v[238:241]
    ds_read_b64_tr_b16 a[212:213], v38 offset:32768
    s_add_u32 s64, s64, 524288
    v_mfma_f32_16x16x32_bf16 v[242:245], a[76:79], a[220:223], v[242:245]
    ds_read_b64_tr_b16 a[214:215], v38 offset:34816
    s_waitcnt lgkmcnt(8)
    v_mfma_f32_16x16x32_bf16 v[190:193], a[72:75], a[224:227], v[190:193]
    ds_read_b64_tr_b16 a[216:217], v35 offset:36864
    s_cmp_eq_u32 s64, 3670016
    v_mfma_f32_16x16x32_bf16 v[194:197], a[76:79], a[224:227], v[194:197]
    ds_read_b64_tr_b16 a[218:219], v35 offset:38912
    s_cselect_b32 s64, 0, s64
    buffer_load_dwordx4 v59, s[24:27], s64 offen lds
    v_mfma_f32_16x16x32_bf16 v[246:249], a[72:75], a[228:231], v[246:249]
    ds_read_b64_tr_b16 a[220:221], v37 offset:36864
    v_mfma_f32_16x16x32_bf16 v[250:253], a[76:79], a[228:231], v[250:253]
    ds_read_b64_tr_b16 a[222:223], v37 offset:38912
    s_waitcnt vmcnt(14) lgkmcnt(8)
    v_mfma_f32_16x16x32_bf16 v[182:185], a[80:83], a[200:203], v[182:185]
    ds_read_b64_tr_b16 a[224:225], v36 offset:36864
    buffer_load_dwordx4 v60, s[24:27], s64 offen offset:1024 lds
    v_mfma_f32_16x16x32_bf16 v[186:189], a[84:87], a[200:203], v[186:189]
    ds_read_b64_tr_b16 a[226:227], v36 offset:38912
    v_mfma_f32_16x16x32_bf16 v[238:241], a[80:83], a[204:207], v[238:241]
    ds_read_b64_tr_b16 a[228:229], v38 offset:36864
    v_mfma_f32_16x16x32_bf16 v[242:245], a[84:87], a[204:207], v[242:245]
    ds_read_b64_tr_b16 a[230:231], v38 offset:38912
    s_waitcnt lgkmcnt(8)
    v_mfma_f32_16x16x32_bf16 v[190:193], a[80:83], a[208:211], v[190:193]
    ds_read_b64_tr_b16 a[200:201], v35 offset:49152
    buffer_load_dwordx4 v61, s[24:27], s64 offen offset:2048 lds
    v_mfma_f32_16x16x32_bf16 v[194:197], a[84:87], a[208:211], v[194:197]
    ds_read_b64_tr_b16 a[202:203], v35 offset:51200
    v_mfma_f32_16x16x32_bf16 v[246:249], a[80:83], a[212:215], v[246:249]
    ds_read_b64_tr_b16 a[204:205], v37 offset:49152
    v_mfma_f32_16x16x32_bf16 v[250:253], a[84:87], a[212:215], v[250:253]
    ds_read_b64_tr_b16 a[206:207], v37 offset:51200
    s_waitcnt vmcnt(14) lgkmcnt(8)
    v_mfma_f32_16x16x32_bf16 v[182:185], a[88:91], a[216:219], v[182:185]
L_pad3:
    s_cbranch_execz L_warm
    ds_read_b64_tr_b16 a[208:209], v36 offset:49152
    buffer_load_dwordx4 v62, s[24:27], s64 offen offset:3072 lds
    v_mfma_f32_16x16x32_bf16 v[186:189], a[92:95], a[216:219], v[186:189]
    ds_read_b64_tr_b16 a[210:211], v36 offset:51200
    s_add_u32 m0, s58, 81920
    v_mfma_f32_16x16x32_bf16 v[238:241], a[88:91], a[220:223], v[238:241]
    ds_read_b64_tr_b16 a[212:213], v38 offset:49152
    s_add_u32 s64, s64, 524288
    v_mfma_f32_16x16x32_bf16 v[242:245], a[92:95], a[220:223], v[242:245]
    ds_read_b64_tr_b16 a[214:215], v38 offset:51200
    s_waitcnt lgkmcnt(8)
    v_mfma_f32_16x16x32_bf16 v[190:193], a[88:91], a[224:227], v[190:193]
    ds_read_b64_tr_b16 a[216:217], v35 offset:53248
    s_cmp_eq_u32 s64, 3670016
    s_cselect_b32 s64, 0, s64
    buffer_load_dwordx4 v59, s[24:27], s64 offen lds
    v_mfma_f32_16x16x32_bf16 v[194:197], a[92:95], a[224:227], v[194:197]
    ds_read_b64_tr_b16 a[218:219], v35 offset:55296
    v_mfma_f32_16x16x32_bf16 v[246:249], a[88:91], a[228:231], v[246:249]
    ds_read_b64_tr_b16 a[220:221], v37 offset:53248
    buffer_load_dwordx4 v60, s[24:27], s64 offen offset:1024 lds
    v_mfma_f32_16x16x32_bf16 v[250:253], a[92:95], a[228:231], v[250:253]
    ds_read_b64_tr_b16 a[222:223], v37 offset:55296
    s_waitcnt vmcnt(15) lgkmcnt(8)
    v_mfma_f32_16x16x32_bf16 v[182:185], a[96:99], a[200:203], v[182:185]
    ds_read_b64_tr_b16 a[224:225], v36 offset:53248
    v_mfma_f32_16x16x32_bf16 v[186:189], a[100:103], a[200:203], v[186:189]
    ds_read_b64_tr_b16 a[226:227], v36 offset:55296
    v_mfma_f32_16x16x32_bf16 v[238:241], a[96:99], a[204:207], v[238:241]
    ds_read_b64_tr_b16 a[228:229], v38 offset:53248
    buffer_load_dwordx4 v61, s[24:27], s64 offen offset:2048 lds
    v_mfma_f32_16x16x32_bf16 v[242:245], a[100:103], a[204:207], v[242:245]
    ds_read_b64_tr_b16 a[230:231], v38 offset:55296
    s_waitcnt lgkmcnt(8)
    v_mfma_f32_16x16x32_bf16 v[190:193], a[96:99], a[208:211], v[190:193]
    ds_read_b64_tr_b16 a[200:201], v31 offset:0
    v_mfma_f32_16x16x32_bf16 v[194:197], a[100:103], a[208:211], v[194:197]
    ds_read_b64_tr_b16 a[202:203], v31 offset:2048
    v_mfma_f32_16x16x32_bf16 v[246:249], a[96:99], a[212:215], v[246:249]
    ds_read_b64_tr_b16 a[204:205], v33 offset:0
    buffer_load_dwordx4 v62, s[24:27], s64 offen offset:3072 lds
    v_mfma_f32_16x16x32_bf16 v[250:253], a[100:103], a[212:215], v[250:253]
    ds_read_b64_tr_b16 a[206:207], v33 offset:2048
    s_waitcnt vmcnt(15) lgkmcnt(8)
    v_mfma_f32_16x16x32_bf16 v[182:185], a[104:107], a[216:219], v[182:185]
    ds_read_b64_tr_b16 a[208:209], v32 offset:0
    s_add_u32 m0, s58, 32768
    v_mfma_f32_16x16x32_bf16 v[186:189], a[108:111], a[216:219], v[186:189]
    ds_read_b64_tr_b16 a[210:211], v32 offset:2048
    s_add_u32 s64, s64, 524288
    v_mfma_f32_16x16x32_bf16 v[238:241], a[104:107], a[220:223], v[238:241]
    ds_read_b64_tr_b16 a[212:213], v34 offset:0
    s_cmp_eq_u32 s64, 3670016
    v_mfma_f32_16x16x32_bf16 v[242:245], a[108:111], a[220:223], v[242:245]
    ds_read_b64_tr_b16 a[214:215], v34 offset:2048
    s_cselect_b32 s64, 0, s64
    buffer_load_dwordx4 v59, s[24:27], s64 offen lds
    s_waitcnt lgkmcnt(8)
    v_mfma_f32_16x16x32_bf16 v[190:193], a[104:107], a[224:227], v[190:193]
    ds_read_b64_tr_b16 a[216:217], v31 offset:4096
    v_mfma_f32_16x16x32_bf16 v[194:197], a[108:111], a[224:227], v[194:197]
    ds_read_b64_tr_b16 a[218:219], v31 offset:6144
    buffer_load_dwordx4 v60, s[24:27], s64 offen offset:1024 lds
    v_mfma_f32_16x16x32_bf16 v[246:249], a[104:107], a[228:231], v[246:249]
    ds_read_b64_tr_b16 a[220:221], v33 offset:4096
    v_mfma_f32_16x16x32_bf16 v[250:253], a[108:111], a[228:231], v[250:253]
    ds_read_b64_tr_b16 a[222:223], v33 offset:6144
    s_waitcnt lgkmcnt(8)
    v_mfma_f32_16x16x32_bf16 v[150:153], a[0:3], a[200:203], 0
    ds_read_b64_tr_b16 a[224:225], v32 offset:4096
    v_mfma_f32_16x16x32_bf16 v[154:157], a[4:7], a[200:203], 0
    ds_read_b64_tr_b16 a[226:227], v32 offset:6144
    buffer_load_dwordx4 v61, s[24:27], s64 offen offset:2048 lds
    v_mfma_f32_16x16x32_bf16 v[166:169], a[0:3], a[204:207], 0
    ds_read_b64_tr_b16 a[228:229], v34 offset:4096
    v_cvt_pk_bf16_f32 v182, v182, v183
    v_mfma_f32_16x16x32_bf16 v[170:173], a[4:7], a[204:207], 0
    ds_read_b64_tr_b16 a[230:231], v34 offset:6144
    v_cvt_pk_bf16_f32 v183, v184, v185
    v_cvt_pk_bf16_f32 v184, v186, v187
    s_waitcnt lgkmcnt(8)
    v_mfma_f32_16x16x32_bf16 v[158:161], a[0:3], a[208:211], 0
    s_waitcnt vmcnt(15)
    s_barrier
    ds_read_b64_tr_b16 a[200:201], v39 offset:0
    buffer_load_dwordx4 v62, s[24:27], s64 offen offset:3072 lds
    v_mfma_f32_16x16x32_bf16 v[162:165], a[4:7], a[208:211], 0
    ds_read_b64_tr_b16 a[202:203], v39 offset:2048
    s_add_u32 m0, s58, 49152
    v_cvt_pk_bf16_f32 v185, v188, v189
    buffer_store_dwordx4 v[182:185], v21, s[28:31], 0 offen offset:0 sc1
    v_cvt_pk_bf16_f32 v190, v190, v191
    v_cvt_pk_bf16_f32 v191, v192, v193
    v_cvt_pk_bf16_f32 v192, v194, v195
    v_mfma_f32_16x16x32_bf16 v[174:177], a[0:3], a[212:215], 0
    ds_read_b64_tr_b16 a[204:205], v41 offset:0
    s_add_u32 s66, s66, 1
    v_mfma_f32_16x16x32_bf16 v[178:181], a[4:7], a[212:215], 0
    ds_read_b64_tr_b16 a[206:207], v41 offset:2048
    v_cvt_pk_bf16_f32 v193, v196, v197
    buffer_store_dwordx4 v[190:193], v21, s[28:31], 0 offen offset:1024 sc1
    v_cvt_pk_bf16_f32 v238, v238, v239
    v_cvt_pk_bf16_f32 v239, v240, v241
    v_cvt_pk_bf16_f32 v240, v242, v243
    s_waitcnt lgkmcnt(8)
    v_mfma_f32_16x16x32_bf16 v[150:153], a[8:11], a[216:219], v[150:153]
    ds_read_b64_tr_b16 a[208:209], v40 offset:0
    s_and_b32 s66, s66, 3
    v_mfma_f32_16x16x32_bf16 v[154:157], a[12:15], a[216:219], v[154:157]
    ds_read_b64_tr_b16 a[210:211], v40 offset:2048
    s_mul_i32 s61, s66, 100352
    buffer_load_dwordx4 v63, s[16:19], s61 offen lds
    v_cvt_pk_bf16_f32 v241, v244, v245
    buffer_store_dwordx4 v[238:241], v21, s[28:31], 0 offen offset:2048 sc1
    v_cvt_pk_bf16_f32 v246, v246, v247
    v_cvt_pk_bf16_f32 v247, v248, v249
    v_cvt_pk_bf16_f32 v248, v250, v251
    v_mfma_f32_16x16x32_bf16 v[166:169], a[8:11], a[220:223], v[166:169]
    ds_read_b64_tr_b16 a[212:213], v42 offset:0
    v_cvt_pk_bf16_f32 v249, v252, v253
    v_mfma_f32_16x16x32_bf16 v[170:173], a[12:15], a[220:223], v[170:173]
    ds_read_b64_tr_b16 a[214:215], v42 offset:2048
    s_waitcnt lgkmcnt(8)
    v_mfma_f32_16x16x32_bf16 v[158:161], a[8:11], a[224:227], v[158:161]
    ds_read_b64_tr_b16 a[216:217], v39 offset:4096
    buffer_load_dwordx4 v64, s[16:19], s61 offen offset:1024 lds
    v_mfma_f32_16x16x32_bf16 v[162:165], a[12:15], a[224:227], v[162:165]
    ds_read_b64_tr_b16 a[218:219], v39 offset:6144
    s_add_u32 s61, s61, 48128
    buffer_store_dwordx4 v[246:249], v21, s[28:31], 0 offen offset:3072 sc1
    v_mfma_f32_16x16x32_bf16 v[174:177], a[8:11], a[228:231], v[174:177]
    ds_read_b64_tr_b16 a[220:221], v41 offset:4096
    v_mfma_f32_16x16x32_bf16 v[178:181], a[12:15], a[228:231], v[178:181]
    ds_read_b64_tr_b16 a[222:223], v41 offset:6144
    s_waitcnt lgkmcnt(8)
    v_mfma_f32_16x16x32_bf16 v[150:153], a[16:19], a[200:203], v[150:153]
    ds_read_b64_tr_b16 a[224:225], v40 offset:4096
    buffer_load_dwordx4 v63, s[16:19], s61 offen offset:2048 lds
    v_mfma_f32_16x16x32_bf16 v[154:157], a[20:23], a[200:203], v[154:157]
    ds_read_b64_tr_b16 a[226:227], v40 offset:6144
    v_mfma_f32_16x16x32_bf16 v[166:169], a[16:19], a[204:207], v[166:169]
    ds_read_b64_tr_b16 a[228:229], v42 offset:4096
    v_mfma_f32_16x16x32_bf16 v[170:173], a[20:23], a[204:207], v[170:173]
    ds_read_b64_tr_b16 a[230:231], v42 offset:6144
    s_waitcnt lgkmcnt(8)
    v_mfma_f32_16x16x32_bf16 v[158:161], a[16:19], a[208:211], v[158:161]
    s_mov_b32 s14, 0
    s_load_dword s14, s[28:29], s39
    ds_read_b64_tr_b16 a[200:201], v39 offset:16384
    buffer_load_dwordx4 v64, s[16:19], s61 offen offset:3072 lds
    v_mfma_f32_16x16x32_bf16 v[162:165], a[20:23], a[208:211], v[162:165]
    ds_read_b64_tr_b16 a[202:203], v39 offset:18432
    s_add_u32 m0, s58, 98304
    v_mfma_f32_16x16x32_bf16 v[174:177], a[16:19], a[212:215], v[174:177]
    ds_read_b64_tr_b16 a[204:205], v41 offset:16384
    s_add_u32 s66, s66, 1
    v_mfma_f32_16x16x32_bf16 v[178:181], a[20:23], a[212:215], v[178:181]
    ds_read_b64_tr_b16 a[206:207], v41 offset:18432
    s_waitcnt lgkmcnt(8)
    v_mfma_f32_16x16x32_bf16 v[150:153], a[24:27], a[216:219], v[150:153]
    ds_read_b64_tr_b16 a[208:209], v40 offset:16384
    s_and_b32 s66, s66, 3
    s_mul_i32 s61, s66, 100352
    buffer_load_dwordx4 v63, s[16:19], s61 offen lds
    v_mfma_f32_16x16x32_bf16 v[154:157], a[28:31], a[216:219], v[154:157]
    ds_read_b64_tr_b16 a[210:211], v40 offset:18432
    v_mfma_f32_16x16x32_bf16 v[166:169], a[24:27], a[220:223], v[166:169]
    ds_read_b64_tr_b16 a[212:213], v42 offset:16384
    buffer_load_dwordx4 v64, s[16:19], s61 offen offset:1024 lds
    v_mfma_f32_16x16x32_bf16 v[170:173], a[28:31], a[220:223], v[170:173]
    ds_read_b64_tr_b16 a[214:215], v42 offset:18432
    s_waitcnt lgkmcnt(8)
    v_mfma_f32_16x16x32_bf16 v[158:161], a[24:27], a[224:227], v[158:161]
    ds_read_b64_tr_b16 a[216:217], v39 offset:20480
    s_add_u32 s61, s61, 48128
    v_mfma_f32_16x16x32_bf16 v[162:165], a[28:31], a[224:227], v[162:165]
    ds_read_b64_tr_b16 a[218:219], v39 offset:22528
    v_mfma_f32_16x16x32_bf16 v[174:177], a[24:27], a[228:231], v[174:177]
    ds_read_b64_tr_b16 a[220:221], v41 offset:20480
    buffer_load_dwordx4 v63, s[16:19], s61 offen offset:2048 lds
    v_mfma_f32_16x16x32_bf16 v[178:181], a[28:31], a[228:231], v[178:181]
    ds_read_b64_tr_b16 a[222:223], v41 offset:22528
    s_waitcnt lgkmcnt(8)
    v_mfma_f32_16x16x32_bf16 v[150:153], a[32:35], a[200:203], v[150:153]
    ds_read_b64_tr_b16 a[224:225], v40 offset:20480
    v_mfma_f32_16x16x32_bf16 v[154:157], a[36:39], a[200:203], v[154:157]
    ds_read_b64_tr_b16 a[226:227], v40 offset:22528
    v_mfma_f32_16x16x32_bf16 v[166:169], a[32:35], a[204:207], v[166:169]
    ds_read_b64_tr_b16 a[228:229], v42 offset:20480
    buffer_load_dwordx4 v64, s[16:19], s61 offen offset:3072 lds
    v_mfma_f32_16x16x32_bf16 v[170:173], a[36:39], a[204:207], v[170:173]
    ds_read_b64_tr_b16 a[230:231], v42 offset:22528
    s_waitcnt lgkmcnt(8)
    v_mfma_f32_16x16x32_bf16 v[158:161], a[32:35], a[208:211], v[158:161]
    s_waitcnt vmcnt(20)
    s_barrier
    ds_read_b64_tr_b16 a[200:201], v31 offset:16384
    s_add_u32 m0, s58, 114688
    v_mfma_f32_16x16x32_bf16 v[162:165], a[36:39], a[208:211], v[162:165]
    ds_read_b64_tr_b16 a[202:203], v31 offset:18432
    s_add_u32 s66, s66, 1
    v_mfma_f32_16x16x32_bf16 v[174:177], a[32:35], a[212:215], v[174:177]
    ds_read_b64_tr_b16 a[204:205], v33 offset:16384
    s_and_b32 s66, s66, 3
    v_mfma_f32_16x16x32_bf16 v[178:181], a[36:39], a[212:215], v[178:181]
    ds_read_b64_tr_b16 a[206:207], v33 offset:18432
    s_mul_i32 s61, s66, 100352
    buffer_load_dwordx4 v63, s[16:19], s61 offen lds
    s_waitcnt lgkmcnt(8)
    v_mfma_f32_16x16x32_bf16 v[150:153], a[40:43], a[216:219], v[150:153]
    ds_read_b64_tr_b16 a[208:209], v32 offset:16384
    v_mfma_f32_16x16x32_bf16 v[154:157], a[44:47], a[216:219], v[154:157]
    ds_read_b64_tr_b16 a[210:211], v32 offset:18432
    buffer_load_dwordx4 v64, s[16:19], s61 offen offset:1024 lds
    v_mfma_f32_16x16x32_bf16 v[166:169], a[40:43], a[220:223], v[166:169]
    ds_read_b64_tr_b16 a[212:213], v34 offset:16384
    s_add_u32 s61, s61, 48128
    v_mfma_f32_16x16x32_bf16 v[170:173], a[44:47], a[220:223], v[170:173]
    ds_read_b64_tr_b16 a[214:215], v34 offset:18432
    s_waitcnt lgkmcnt(8)
    v_mfma_f32_16x16x32_bf16 v[158:161], a[40:43], a[224:227], v[158:161]
    ds_read_b64_tr_b16 a[216:217], v31 offset:20480
    v_mfma_f32_16x16x32_bf16 v[162:165], a[44:47], a[224:227], v[162:165]
    ds_read_b64_tr_b16 a[218:219], v31 offset:22528
    buffer_load_dwordx4 v63, s[16:19], s61 offen offset:2048 lds
    v_mfma_f32_16x16x32_bf16 v[174:177], a[40:43], a[228:231], v[174:177]
    ds_read_b64_tr_b16 a[220:221], v33 offset:20480
    v_mfma_f32_16x16x32_bf16 v[178:181], a[44:47], a[228:231], v[178:181]
    ds_read_b64_tr_b16 a[222:223], v33 offset:22528
    s_waitcnt lgkmcnt(8)
    v_mfma_f32_16x16x32_bf16 v[150:153], a[48:51], a[200:203], v[150:153]
    ds_read_b64_tr_b16 a[224:225], v32 offset:20480
    v_mfma_f32_16x16x32_bf16 v[154:157], a[52:55], a[200:203], v[154:157]
    ds_read_b64_tr_b16 a[226:227], v32 offset:22528
    buffer_load_dwordx4 v64, s[16:19], s61 offen offset:3072 lds
    v_mfma_f32_16x16x32_bf16 v[166:169], a[48:51], a[204:207], v[166:169]
    ds_read_b64_tr_b16 a[228:229], v34 offset:20480
    v_mfma_f32_16x16x32_bf16 v[170:173], a[52:55], a[204:207], v[170:173]
    ds_read_b64_tr_b16 a[230:231], v34 offset:22528
    s_waitcnt lgkmcnt(8)
    v_mfma_f32_16x16x32_bf16 v[158:161], a[48:51], a[208:211], v[158:161]
    s_waitcnt vmcnt(10)
    s_atomic_add s36, s[28:29], s55
    ds_read_b64_tr_b16 a[200:201], v35 offset:0
    v_mfma_f32_16x16x32_bf16 v[162:165], a[52:55], a[208:211], v[162:165]
    ds_read_b64_tr_b16 a[202:203], v35 offset:2048
    v_mfma_f32_16x16x32_bf16 v[174:177], a[48:51], a[212:215], v[174:177]
    ds_read_b64_tr_b16 a[204:205], v37 offset:0
    v_mfma_f32_16x16x32_bf16 v[178:181], a[52:55], a[212:215], v[178:181]
    ds_read_b64_tr_b16 a[206:207], v37 offset:2048
    s_waitcnt lgkmcnt(8)
    v_mfma_f32_16x16x32_bf16 v[150:153], a[56:59], a[216:219], v[150:153]
    ds_read_b64_tr_b16 a[208:209], v36 offset:0
    v_mfma_f32_16x16x32_bf16 v[154:157], a[60:63], a[216:219], v[154:157]
    ds_read_b64_tr_b16 a[210:211], v36 offset:2048
    v_mfma_f32_16x16x32_bf16 v[166:169], a[56:59], a[220:223], v[166:169]
    ds_read_b64_tr_b16 a[212:213], v38 offset:0
    v_mfma_f32_16x16x32_bf16 v[170:173], a[60:63], a[220:223], v[170:173]
    ds_read_b64_tr_b16 a[214:215], v38 offset:2048
    s_waitcnt lgkmcnt(8)
    v_mfma_f32_16x16x32_bf16 v[158:161], a[56:59], a[224:227], v[158:161]
    ds_read_b64_tr_b16 a[216:217], v35 offset:4096
    v_mfma_f32_16x16x32_bf16 v[162:165], a[60:63], a[224:227], v[162:165]
    ds_read_b64_tr_b16 a[218:219], v35 offset:6144
    v_mfma_f32_16x16x32_bf16 v[174:177], a[56:59], a[228:231], v[174:177]
    ds_read_b64_tr_b16 a[220:221], v37 offset:4096
    v_mfma_f32_16x16x32_bf16 v[178:181], a[60:63], a[228:231], v[178:181]
    ds_read_b64_tr_b16 a[222:223], v37 offset:6144
    s_waitcnt lgkmcnt(8)
    v_mfma_f32_16x16x32_bf16 v[150:153], a[64:67], a[200:203], v[150:153]
    s_cmp_ge_u32 s14, 8
    s_cbranch_scc0 L_pollin6
L_pollok6:
    ds_read_b64_tr_b16 a[224:225], v36 offset:4096
    s_add_u32 m0, s58, 0
    s_add_u32 s51, s51, 1
    s_and_b32 s51, s51, 3
    s_lshl_b32 s61, s51, 12
    buffer_load_dwordx4 v65, s[28:31], s61 offen sc1 lds
    v_mfma_f32_16x16x32_bf16 v[154:157], a[68:71], a[200:203], v[154:157]
    ds_read_b64_tr_b16 a[226:227], v36 offset:6144
    v_mfma_f32_16x16x32_bf16 v[166:169], a[64:67], a[204:207], v[166:169]
    ds_read_b64_tr_b16 a[228:229], v38 offset:4096
    buffer_load_dwordx4 v66, s[28:31], s61 offen offset:1024 sc1 lds
    v_mfma_f32_16x16x32_bf16 v[170:173], a[68:71], a[204:207], v[170:173]
    ds_read_b64_tr_b16 a[230:231], v38 offset:6144
    s_waitcnt lgkmcnt(8)
    v_mfma_f32_16x16x32_bf16 v[158:161], a[64:67], a[208:211], v[158:161]
    s_barrier
    ds_read_b64_tr_b16 a[200:201], v35 offset:16384
    buffer_load_dwordx4 v65, s[28:31], s61 offen offset:2048 sc1 lds
    v_mfma_f32_16x16x32_bf16 v[162:165], a[68:71], a[208:211], v[162:165]
    ds_read_b64_tr_b16 a[202:203], v35 offset:18432
    v_mfma_f32_16x16x32_bf16 v[174:177], a[64:67], a[212:215], v[174:177]
    ds_read_b64_tr_b16 a[204:205], v37 offset:16384
    v_mfma_f32_16x16x32_bf16 v[178:181], a[68:71], a[212:215], v[178:181]
    ds_read_b64_tr_b16 a[206:207], v37 offset:18432
    s_waitcnt lgkmcnt(8)
    v_mfma_f32_16x16x32_bf16 v[150:153], a[72:75], a[216:219], v[150:153]
    ds_read_b64_tr_b16 a[208:209], v36 offset:16384
    buffer_load_dwordx4 v66, s[28:31], s61 offen offset:3072 sc1 lds
    v_mfma_f32_16x16x32_bf16 v[154:157], a[76:79], a[216:219], v[154:157]
    ds_read_b64_tr_b16 a[210:211], v36 offset:18432
    s_add_u32 m0, s58, 131072
    v_mfma_f32_16x16x32_bf16 v[166:169], a[72:75], a[220:223], v[166:169]
    ds_read_b64_tr_b16 a[212:213], v38 offset:16384
    s_add_u32 s51, s51, 1
    v_mfma_f32_16x16x32_bf16 v[170:173], a[76:79], a[220:223], v[170:173]
    ds_read_b64_tr_b16 a[214:215], v38 offset:18432
    s_waitcnt lgkmcnt(8)
    v_mfma_f32_16x16x32_bf16 v[158:161], a[72:75], a[224:227], v[158:161]
    ds_read_b64_tr_b16 a[216:217], v35 offset:20480
    s_and_b32 s51, s51, 3
    s_lshl_b32 s61, s51, 12
    buffer_load_dwordx4 v65, s[28:31], s61 offen sc1 lds
    v_mfma_f32_16x16x32_bf16 v[162:165], a[76:79], a[224:227], v[162:165]
    ds_read_b64_tr_b16 a[218:219], v35 offset:22528
    v_mfma_f32_16x16x32_bf16 v[174:177], a[72:75], a[228:231], v[174:177]
    ds_read_b64_tr_b16 a[220:221], v37 offset:20480
    buffer_load_dwordx4 v66, s[28:31], s61 offen offset:1024 sc1 lds
    v_mfma_f32_16x16x32_bf16 v[178:181], a[76:79], a[228:231], v[178:181]
    ds_read_b64_tr_b16 a[222:223], v37 offset:22528
    s_waitcnt lgkmcnt(8)
    v_mfma_f32_16x16x32_bf16 v[150:153], a[80:83], a[200:203], v[150:153]
    ds_read_b64_tr_b16 a[224:225], v36 offset:20480
    v_mfma_f32_16x16x32_bf16 v[154:157], a[84:87], a[200:203], v[154:157]
    ds_read_b64_tr_b16 a[226:227], v36 offset:22528
    buffer_load_dwordx4 v65, s[28:31], s61 offen offset:2048 sc1 lds
    v_mfma_f32_16x16x32_bf16 v[166:169], a[80:83], a[204:207], v[166:169]
    ds_read_b64_tr_b16 a[228:229], v38 offset:20480
    v_mfma_f32_16x16x32_bf16 v[170:173], a[84:87], a[204:207], v[170:173]
    ds_read_b64_tr_b16 a[230:231], v38 offset:22528
    s_waitcnt lgkmcnt(8)
    v_mfma_f32_16x16x32_bf16 v[158:161], a[80:83], a[208:211], v[158:161]
    s_barrier
    ds_read_b64_tr_b16 a[200:201], v31 offset:32768
    buffer_load_dwordx4 v66, s[28:31], s61 offen offset:3072 sc1 lds
    v_mfma_f32_16x16x32_bf16 v[162:165], a[84:87], a[208:211], v[162:165]
    ds_read_b64_tr_b16 a[202:203], v31 offset:34816
    s_add_u32 m0, s58, 147456
    v_mfma_f32_16x16x32_bf16 v[174:177], a[80:83], a[212:215], v[174:177]
    ds_read_b64_tr_b16 a[204:205], v33 offset:32768
    s_add_u32 s51, s51, 1
    v_mfma_f32_16x16x32_bf16 v[178:181], a[84:87], a[212:215], v[178:181]
    ds_read_b64_tr_b16 a[206:207], v33 offset:34816
    s_waitcnt lgkmcnt(8)
    v_mfma_f32_16x16x32_bf16 v[150:153], a[88:91], a[216:219], v[150:153]
    ds_read_b64_tr_b16 a[208:209], v32 offset:32768
    s_and_b32 s51, s51, 3
    s_lshl_b32 s61, s51, 12
    buffer_load_dwordx4 v65, s[28:31], s61 offen sc1 lds
    v_mfma_f32_16x16x32_bf16 v[154:157], a[92:95], a[216:219], v[154:157]
    ds_read_b64_tr_b16 a[210:211], v32 offset:34816
    v_mfma_f32_16x16x32_bf16 v[166:169], a[88:91], a[220:223], v[166:169]
    ds_read_b64_tr_b16 a[212:213], v34 offset:32768
    buffer_load_dwordx4 v66, s[28:31], s61 offen offset:1024 sc1 lds
    v_mfma_f32_16x16x32_bf16 v[170:173], a[92:95], a[220:223], v[170:173]
    ds_read_b64_tr_b16 a[214:215], v34 offset:34816
    s_waitcnt lgkmcnt(8)
    v_mfma_f32_16x16x32_bf16 v[158:161], a[88:91], a[224:227], v[158:161]
    ds_read_b64_tr_b16 a[216:217], v31 offset:36864
    v_mfma_f32_16x16x32_bf16 v[162:165], a[92:95], a[224:227], v[162:165]
    ds_read_b64_tr_b16 a[218:219], v31 offset:38912
    buffer_load_dwordx4 v65, s[28:31], s61 offen offset:2048 sc1 lds
    v_mfma_f32_16x16x32_bf16 v[174:177], a[88:91], a[228:231], v[174:177]
    ds_read_b64_tr_b16 a[220:221], v33 offset:36864
    v_mfma_f32_16x16x32_bf16 v[178:181], a[92:95], a[228:231], v[178:181]
    ds_read_b64_tr_b16 a[222:223], v33 offset:38912
    s_waitcnt lgkmcnt(8)
    v_mfma_f32_16x16x32_bf16 v[150:153], a[96:99], a[200:203], v[150:153]
    ds_read_b64_tr_b16 a[224:225], v32 offset:36864
    buffer_load_dwordx4 v66, s[28:31], s61 offen offset:3072 sc1 lds
    v_mfma_f32_16x16x32_bf16 v[154:157], a[100:103], a[200:203], v[154:157]
    ds_read_b64_tr_b16 a[226:227], v32 offset:38912
    s_add_u32 m0, s58, 16384
    v_mfma_f32_16x16x32_bf16 v[166:169], a[96:99], a[204:207], v[166:169]
    ds_read_b64_tr_b16 a[228:229], v34 offset:36864
    s_add_u32 s66, s66, 1
    v_mfma_f32_16x16x32_bf16 v[170:173], a[100:103], a[204:207], v[170:173]
    ds_read_b64_tr_b16 a[230:231], v34 offset:38912
    s_waitcnt lgkmcnt(8)
    v_mfma_f32_16x16x32_bf16 v[158:161], a[96:99], a[208:211], v[158:161]
    s_waitcnt vmcnt(8)
    s_barrier
    s_xor_b32 s55, s55, 1024
    s_mov_b32 s14, 0
    s_load_dword s14, s[28:29], s55
    ds_read_b64_tr_b16 v[198:199], v43 offset:49152
    ds_read_b64_tr_b16 v[200:201], v43 offset:53248
    s_and_b32 s66, s66, 3
    s_mul_i32 s61, s66, 100352
    buffer_load_dwordx4 v63, s[16:19], s61 offen lds
    v_mfma_f32_16x16x32_bf16 v[162:165], a[100:103], a[208:211], v[162:165]
    ds_read_b64_tr_b16 v[202:203], v44 offset:49152
    v_mfma_f32_16x16x32_bf16 v[174:177], a[96:99], a[212:215], v[174:177]
    ds_read_b64_tr_b16 v[204:205], v44 offset:53248
    buffer_load_dwordx4 v64, s[16:19], s61 offen offset:1024 lds
    v_mfma_f32_16x16x32_bf16 v[178:181], a[100:103], a[212:215], v[178:181]
    ds_read_b128 a[200:203], v47 offset:0
    s_waitcnt lgkmcnt(9)
    v_mfma_f32_16x16x32_bf16 v[150:153], a[104:107], a[216:219], v[150:153]
    ds_read_b128 a[204:207], v48 offset:0
    s_add_u32 s61, s61, 48128
    v_mfma_f32_16x16x32_bf16 v[154:157], a[108:111], a[216:219], v[154:157]
    ds_read_b128 a[208:211], v47 offset:1024
    buffer_load_dwordx4 v63, s[16:19], s61 offen offset:2048 lds
    v_mfma_f32_16x16x32_bf16 v[166:169], a[104:107], a[220:223], v[166:169]
    ds_read_b128 a[212:215], v48 offset:1024
    v_mfma_f32_16x16x32_bf16 v[170:173], a[108:111], a[220:223], v[170:173]
    s_waitcnt lgkmcnt(8)
    v_mfma_f32_16x16x32_bf16 v[158:161], a[104:107], a[224:227], v[158:161]
    ds_read_b64_tr_b16 v[206:207], v43 offset:51200
    ds_read_b64_tr_b16 v[208:209], v43 offset:55296
    v_mfma_f32_16x16x32_bf16 v[162:165], a[108:111], a[224:227], v[162:165]
    ds_read_b64_tr_b16 v[210:211], v44 offset:51200
    buffer_load_dwordx4 v64, s[16:19], s61 offen offset:3072 lds
    v_mfma_f32_16x16x32_bf16 v[174:177], a[104:107], a[228:231], v[174:177]
    ds_read_b64_tr_b16 v[212:213], v44 offset:55296
    s_add_u32 m0, s58, 65536
    v_mfma_f32_16x16x32_bf16 v[178:181], a[108:111], a[228:231], v[178:181]
    ds_read_b128 a[216:219], v47 offset:2048
    s_waitcnt lgkmcnt(7)
    v_mfma_f32_16x16x32_bf16 v[150:153], v[198:201], a[200:203], v[150:153]
    ds_read_b128 a[220:223], v48 offset:2048
    s_add_u32 s51, s51, 1
    s_and_b32 s51, s51, 3
    s_lshl_b32 s61, s51, 12
    buffer_load_dwordx4 v65, s[28:31], s61 offen sc1 lds
    v_mfma_f32_16x16x32_bf16 v[154:157], v[202:205], a[200:203], v[154:157]
    ds_read_b128 a[224:227], v47 offset:3072
    v_mfma_f32_16x16x32_bf16 v[166:169], v[198:201], a[204:207], v[166:169]
    ds_read_b128 a[228:231], v48 offset:3072
    buffer_load_dwordx4 v66, s[28:31], s61 offen offset:1024 sc1 lds
    v_mfma_f32_16x16x32_bf16 v[170:173], v[202:205], a[204:207], v[170:173]
    s_waitcnt lgkmcnt(8)
    v_mfma_f32_16x16x32_bf16 v[158:161], v[198:201], a[208:211], v[158:161]
    s_waitcnt vmcnt(10)
    s_barrier
    ds_read_b64_tr_b16 v[214:215], v45 offset:32768
    ds_read_b64_tr_b16 v[216:217], v45 offset:36864
    v_mfma_f32_16x16x32_bf16 v[162:165], v[202:205], a[208:211], v[162:165]
    ds_read_b64_tr_b16 v[218:219], v46 offset:32768
    buffer_load_dwordx4 v65, s[28:31], s61 offen offset:2048 sc1 lds
    v_mfma_f32_16x16x32_bf16 v[174:177], v[198:201], a[212:215], v[174:177]
    ds_read_b64_tr_b16 v[220:221], v46 offset:36864
    v_mfma_f32_16x16x32_bf16 v[178:181], v[202:205], a[212:215], v[178:181]
    ds_read_b128 a[200:203], v51 offset:0
    s_waitcnt lgkmcnt(7)
    v_mfma_f32_16x16x32_bf16 v[150:153], v[206:209], a[216:219], v[150:153]
    ds_read_b128 a[204:207], v52 offset:0
    buffer_load_dwordx4 v66, s[28:31], s61 offen offset:3072 sc1 lds
    v_mfma_f32_16x16x32_bf16 v[154:157], v[210:213], a[216:219], v[154:157]
    ds_read_b128 a[208:211], v51 offset:1024
    v_mfma_f32_16x16x32_bf16 v[166:169], v[206:209], a[220:223], v[166:169]
    ds_read_b128 a[212:215], v52 offset:1024
    v_mfma_f32_16x16x32_bf16 v[170:173], v[210:213], a[220:223], v[170:173]
    s_waitcnt lgkmcnt(8)
    v_mfma_f32_16x16x32_bf16 v[158:161], v[206:209], a[224:227], v[158:161]
    s_cmp_ge_u32 s14, 1
    s_cbranch_scc0 L_pollin7
L_pollok7:
    v_xor_b32 v21, 131072, v21
    ds_read_b64_tr_b16 v[198:199], v45 offset:34816
    ds_read_b64_tr_b16 v[200:201], v45 offset:38912
    buffer_load_dwordx4 v[246:249], v21, s[28:31], 0 offen offset:2048 sc1
    v_mfma_f32_16x16x32_bf16 v[162:165], v[210:213], a[224:227], v[162:165]
    ds_read_b64_tr_b16 v[202:203], v46 offset:34816
    buffer_load_dwordx4 v[250:253], v21, s[28:31], 0 offen offset:3072 sc1
    v_mfma_f32_16x16x32_bf16 v[174:177], v[206:209], a[228:231], v[174:177]
    ds_read_b64_tr_b16 v[204:205], v46 offset:38912
    v_mfma_f32_16x16x32_bf16 v[178:181], v[210:213], a[228:231], v[178:181]
    ds_read_b128 a[216:219], v51 offset:2048
    s_waitcnt lgkmcnt(7)
    v_mfma_f32_16x16x32_bf16 v[150:153], v[214:217], a[200:203], v[150:153]
    ds_read_b128 a[220:223], v52 offset:2048
    buffer_load_dwordx4 v[238:241], v21, s[28:31], 0 offen offset:0 sc1
    v_mfma_f32_16x16x32_bf16 v[154:157], v[218:221], a[200:203], v[154:157]
    ds_read_b128 a[224:227], v51 offset:3072
    buffer_load_dwordx4 v[242:245], v21, s[28:31], 0 offen offset:1024 sc1
    v_mfma_f32_16x16x32_bf16 v[166:169], v[214:217], a[204:207], v[166:169]
    ds_read_b128 a[228:231], v52 offset:3072
    v_mfma_f32_16x16x32_bf16 v[170:173], v[218:221], a[204:207], v[170:173]
    s_waitcnt lgkmcnt(8)
    v_mfma_f32_16x16x32_bf16 v[158:161], v[214:217], a[208:211], v[158:161]
    s_waitcnt vmcnt(12)
    s_barrier
    ds_read_b64_tr_b16 v[206:207], v45 offset:49152
    ds_read_b64_tr_b16 v[208:209], v45 offset:53248
    v_mfma_f32_16x16x32_bf16 v[162:165], v[218:221], a[208:211], v[162:165]
    ds_read_b64_tr_b16 v[210:211], v46 offset:49152
    v_mfma_f32_16x16x32_bf16 v[174:177], v[214:217], a[212:215], v[174:177]
    ds_read_b64_tr_b16 v[212:213], v46 offset:53248
    v_mfma_f32_16x16x32_bf16 v[178:181], v[218:221], a[212:215], v[178:181]
    ds_read_b128 a[200:203], v51 offset:16384
    s_waitcnt lgkmcnt(7)
    v_mfma_f32_16x16x32_bf16 v[150:153], v[198:201], a[216:219], v[150:153]
    ds_read_b128 a[204:207], v52 offset:16384
    v_mfma_f32_16x16x32_bf16 v[154:157], v[202:205], a[216:219], v[154:157]
    ds_read_b128 a[208:211], v51 offset:17408
    v_mfma_f32_16x16x32_bf16 v[166:169], v[198:201], a[220:223], v[166:169]
    ds_read_b128 a[212:215], v52 offset:17408
    v_mfma_f32_16x16x32_bf16 v[170:173], v[202:205], a[220:223], v[170:173]
    s_waitcnt lgkmcnt(8)
    v_mfma_f32_16x16x32_bf16 v[158:161], v[198:201], a[224:227], v[158:161]
    ds_read_b64_tr_b16 v[214:215], v45 offset:51200
    ds_read_b64_tr_b16 v[216:217], v45 offset:55296
    v_mfma_f32_16x16x32_bf16 v[162:165], v[202:205], a[224:227], v[162:165]
    ds_read_b64_tr_b16 v[218:219], v46 offset:51200
    v_mfma_f32_16x16x32_bf16 v[174:177], v[198:201], a[228:231], v[174:177]
    ds_read_b64_tr_b16 v[220:221], v46 offset:55296
    v_mfma_f32_16x16x32_bf16 v[178:181], v[202:205], a[228:231], v[178:181]
    ds_read_b128 a[216:219], v51 offset:18432
    s_waitcnt lgkmcnt(7)
    v_mfma_f32_16x16x32_bf16 v[150:153], v[206:209], a[200:203], v[150:153]
    ds_read_b128 a[220:223], v52 offset:18432
    v_mfma_f32_16x16x32_bf16 v[154:157], v[210:213], a[200:203], v[154:157]
    ds_read_b128 a[224:227], v51 offset:19456
    v_mfma_f32_16x16x32_bf16 v[166:169], v[206:209], a[204:207], v[166:169]
    ds_read_b128 a[228:231], v52 offset:19456
    v_mfma_f32_16x16x32_bf16 v[170:173], v[210:213], a[204:207], v[170:173]
    s_waitcnt lgkmcnt(8)
    v_mfma_f32_16x16x32_bf16 v[158:161], v[206:209], a[208:211], v[158:161]
    s_waitcnt vmcnt(4)
    s_barrier
    ds_read_b64_tr_b16 v[198:199], v43 offset:16384
    ds_read_b64_tr_b16 v[200:201], v43 offset:20480
    v_mfma_f32_16x16x32_bf16 v[162:165], v[210:213], a[208:211], v[162:165]
    ds_read_b64_tr_b16 v[202:203], v44 offset:16384
    v_mfma_f32_16x16x32_bf16 v[174:177], v[206:209], a[212:215], v[174:177]
    ds_read_b64_tr_b16 v[204:205], v44 offset:20480
    v_mfma_f32_16x16x32_bf16 v[178:181], v[210:213], a[212:215], v[178:181]
    ds_read_b128 a[200:203], v50 offset:0
    s_waitcnt lgkmcnt(7)
    v_mfma_f32_16x16x32_bf16 v[150:153], v[214:217], a[216:219], v[150:153]
    ds_read_b128 a[204:207], v50 offset:1024
    ds_read_b64_tr_b16 v[206:207], v43 offset:18432
    v_mfma_f32_16x16x32_bf16 v[154:157], v[218:221], a[216:219], v[154:157]
    ds_read_b64_tr_b16 v[208:209], v43 offset:22528
    ds_read_b64_tr_b16 v[210:211], v44 offset:18432
    v_mfma_f32_16x16x32_bf16 v[166:169], v[214:217], a[220:223], v[166:169]
    ds_read_b64_tr_b16 v[212:213], v44 offset:22528
    v_mfma_f32_16x16x32_bf16 v[170:173], v[218:221], a[220:223], v[170:173]
    ds_read_b128 a[208:211], v50 offset:2048
    s_waitcnt lgkmcnt(11)
    v_mfma_f32_16x16x32_bf16 v[158:161], v[214:217], a[224:227], v[158:161]
    ds_read_b128 a[212:215], v50 offset:3072
    v_mfma_f32_16x16x32_bf16 v[162:165], v[218:221], a[224:227], v[162:165]
    v_mfma_f32_16x16x32_bf16 v[174:177], v[214:217], a[228:231], v[174:177]
    v_mfma_f32_16x16x32_bf16 v[178:181], v[218:221], a[228:231], v[178:181]
    s_waitcnt lgkmcnt(6)
    v_mfma_f32_16x16x32_bf16 v[166:169], v[198:201], a[200:203], v[166:169]
    ds_read_b128 a[224:227], v49 offset:0
    v_mfma_f32_16x16x32_bf16 v[170:173], v[202:205], a[200:203], v[170:173]
    v_mfma_f32_16x16x32_bf16 v[174:177], v[198:201], a[204:207], v[174:177]
    ds_read_b128 a[228:231], v49 offset:1024
    v_mfma_f32_16x16x32_bf16 v[178:181], v[202:205], a[204:207], v[178:181]
    s_waitcnt lgkmcnt(2)
    v_mfma_f32_16x16x32_bf16 v[166:169], v[206:209], a[208:211], v[166:169]
    ds_read_b128 a[200:203], v49 offset:2048
L_pad4:
    s_cbranch_execz L_warm
    v_mfma_f32_16x16x32_bf16 v[170:173], v[210:213], a[208:211], v[170:173]
    v_mfma_f32_16x16x32_bf16 v[174:177], v[206:209], a[212:215], v[174:177]
    ds_read_b128 a[204:207], v49 offset:3072
    v_mfma_f32_16x16x32_bf16 v[178:181], v[210:213], a[212:215], v[178:181]
    s_waitcnt vmcnt(3)
    v_mfma_f32_16x16x32_bf16 v[166:169], a[250:253], v[246:249], v[166:169]
    v_mfma_f32_16x16x32_bf16 v[170:173], a[248:251], v[246:249], v[170:173]
    s_waitcnt vmcnt(2)
    v_mfma_f32_16x16x32_bf16 v[174:177], a[250:253], v[250:253], v[174:177]
    v_mfma_f32_16x16x32_bf16 v[178:181], a[248:251], v[250:253], v[178:181]
    s_waitcnt lgkmcnt(2)
    v_mfma_f32_16x16x32_bf16 v[150:153], v[198:201], a[224:227], v[150:153]
    v_mfma_f32_16x16x32_bf16 v[154:157], v[202:205], a[224:227], v[154:157]
    v_mfma_f32_16x16x32_bf16 v[158:161], v[198:201], a[228:231], v[158:161]
    ds_write_b128 v87, v[166:169] offset:8192
    v_mfma_f32_16x16x32_bf16 v[162:165], v[202:205], a[228:231], v[162:165]
    s_waitcnt lgkmcnt(1)
    v_mfma_f32_16x16x32_bf16 v[150:153], v[206:209], a[200:203], v[150:153]
    ds_write_b128 v88, v[170:173] offset:8192
    v_mfma_f32_16x16x32_bf16 v[154:157], v[210:213], a[200:203], v[154:157]
    v_mfma_f32_16x16x32_bf16 v[158:161], v[206:209], a[204:207], v[158:161]
    ds_write_b128 v87, v[174:177] offset:12288
    v_mfma_f32_16x16x32_bf16 v[162:165], v[210:213], a[204:207], v[162:165]
    s_waitcnt vmcnt(1)
    v_mfma_f32_16x16x32_bf16 v[150:153], a[250:253], v[238:241], v[150:153]
    ds_write_b128 v88, v[178:181] offset:12288
    v_mfma_f32_16x16x32_bf16 v[154:157], a[248:251], v[238:241], v[154:157]
    s_waitcnt vmcnt(0)
    v_mfma_f32_16x16x32_bf16 v[158:161], a[250:253], v[242:245], v[158:161]
    v_mfma_f32_16x16x32_bf16 v[162:165], a[248:251], v[242:245], v[162:165]
    s_nop 2
    ds_write_b128 v87, v[150:153] offset:0
    s_nop 0
    ds_write_b128 v88, v[154:157] offset:0
    s_nop 0
    ds_write_b128 v87, v[158:161] offset:4096
    ds_write_b128 v88, v[162:165] offset:4096
    s_waitcnt lgkmcnt(0)
    s_barrier
    ds_read_b128 v[118:121], v89 offset:0
    ds_read_b128 v[122:125], v90 offset:0
    ds_read_b128 v[126:129], v91 offset:0
    ds_read_b128 v[130:133], v92 offset:0
    ds_read_b128 v[134:137], v89 offset:2048
    ds_read_b128 v[138:141], v90 offset:2048
    ds_read_b128 v[142:145], v91 offset:2048
    ds_read_b128 v[146:149], v92 offset:2048
    s_waitcnt lgkmcnt(7)
    v_pk_add_f32 v[222:223], v[222:223], v[118:119]
    v_pk_add_f32 v[224:225], v[224:225], v[120:121]
    s_waitcnt lgkmcnt(6)
    v_pk_add_f32 v[226:227], v[226:227], v[122:123]
    v_pk_add_f32 v[228:229], v[228:229], v[124:125]
    s_waitcnt lgkmcnt(5)
    v_pk_add_f32 v[222:223], v[222:223], v[126:127]
    v_pk_add_f32 v[224:225], v[224:225], v[128:129]
    s_waitcnt lgkmcnt(4)
    v_pk_add_f32 v[226:227], v[226:227], v[130:131]
    v_pk_add_f32 v[228:229], v[228:229], v[132:133]
    v_cvt_pk_bf16_f32 v110, v222, v223
    v_cvt_pk_bf16_f32 v111, v224, v225
    v_cvt_pk_bf16_f32 v112, v226, v227
    v_cvt_pk_bf16_f32 v113, v228, v229
    buffer_store_dwordx4 v[110:113], v85, s[32:35], 0 offen
    s_waitcnt lgkmcnt(3)
    v_pk_add_f32 v[230:231], v[230:231], v[134:135]
    v_pk_add_f32 v[232:233], v[232:233], v[136:137]
    s_waitcnt lgkmcnt(2)
    v_pk_add_f32 v[234:235], v[234:235], v[138:139]
    v_pk_add_f32 v[236:237], v[236:237], v[140:141]
    s_waitcnt lgkmcnt(1)
    v_pk_add_f32 v[230:231], v[230:231], v[142:143]
    v_pk_add_f32 v[232:233], v[232:233], v[144:145]
    s_waitcnt lgkmcnt(0)
    v_pk_add_f32 v[234:235], v[234:235], v[146:147]
    v_pk_add_f32 v[236:237], v[236:237], v[148:149]
    v_cvt_pk_bf16_f32 v114, v230, v231
    v_cvt_pk_bf16_f32 v115, v232, v233
    v_cvt_pk_bf16_f32 v116, v234, v235
    v_cvt_pk_bf16_f32 v117, v236, v237
    buffer_store_dwordx4 v[114:117], v86, s[32:35], 0 offen
L_fin:
L_end:
    s_endpgm
L_nonce:
    buffer_load_dword v12, v16, s[44:47], 0 offen sc1
    s_add_u32 s60, s60, 1
    s_waitcnt vmcnt(0)
    v_readfirstlane_b32 s57, v12
    s_cmp_ge_u32 s60, 20000
    s_cbranch_scc1 L_nonce_ok
    s_cmp_eq_u32 s57, 0
    s_cbranch_scc1 L_nonce
    s_branch L_nonce_ok
L_pollin0:
    s_mov_b32 s60, 0
L_poll0:
    s_sleep 4
    buffer_load_dword v18, v20, s[28:31], 0 offen sc1
    s_add_u32 s60, s60, 1
    s_waitcnt vmcnt(0)
    v_cmp_ne_u32 vcc, s57, v18
    s_cbranch_vccz L_pollok0
    s_cmp_lt_u32 s60, 20000
    s_cbranch_scc1 L_poll0
    s_branch L_pollok0
L_pollin1:
    s_waitcnt lgkmcnt(0)
    s_cmp_ge_u32 s14, 14
    s_cbranch_scc1 L_pollok1
    s_mov_b32 s60, 0
    s_branch L_poll1a
L_poll1:
    s_sleep 8
L_poll1a:
    buffer_load_dword v18, off, s[44:47], s15 sc1
    s_add_u32 s60, s60, 1
    s_waitcnt vmcnt(0)
    v_readfirstlane_b32 s14, v18
    s_nop 0
    s_cmp_ge_u32 s14, 14
    s_cbranch_scc1 L_pollok1
    s_cmp_lt_u32 s60, 20000
    s_cbranch_scc1 L_poll1
    s_branch L_pollok1
L_pollin2:
    s_waitcnt lgkmcnt(0)
    s_cmp_ge_u32 s14, 2
    s_cbranch_scc1 L_pollok2
    s_mov_b32 s60, 0
    s_branch L_poll2a
L_poll2:
    s_sleep 4
L_poll2a:
    buffer_load_dword v18, off, s[28:31], s37 sc1
    s_add_u32 s60, s60, 1
    s_waitcnt vmcnt(0)
    v_readfirstlane_b32 s14, v18
    s_nop 0
    s_cmp_ge_u32 s14, 2
    s_cbranch_scc1 L_pollok2
    s_cmp_lt_u32 s60, 20000
    s_cbranch_scc1 L_poll2
    s_branch L_pollok2
L_nonceh:
    buffer_load_dword v12, v16, s[44:47], 0 offen sc1
    s_add_u32 s60, s60, 1
    s_waitcnt vmcnt(0)
    v_readfirstlane_b32 s57, v12
    s_cmp_ge_u32 s60, 20000
    s_cbranch_scc1 L_nonce_okh
    s_cmp_eq_u32 s57, 0
    s_cbranch_scc1 L_nonceh
    s_branch L_nonce_okh
L_pollin3:
    s_mov_b32 s60, 0
L_poll3:
    s_sleep 8
    buffer_load_dword v18, v20, s[28:31], 0 offen sc1
    s_add_u32 s60, s60, 1
    s_waitcnt vmcnt(0)
    v_cmp_ne_u32 vcc, s57, v18
    s_cbranch_vccz L_pollok3
    s_cmp_lt_u32 s60, 20000
    s_cbranch_scc1 L_poll3
    s_branch L_pollok3
L_pollin4:
    s_waitcnt lgkmcnt(0)
    s_cmp_ge_u32 s14, 14
    s_cbranch_scc1 L_pollok4
    s_mov_b32 s60, 0
    s_branch L_poll4a
L_poll4:
    s_sleep 16
L_poll4a:
    buffer_load_dword v18, off, s[44:47], s15 sc1
    s_add_u32 s60, s60, 1
    s_waitcnt vmcnt(0)
    v_readfirstlane_b32 s14, v18
    s_nop 0
    s_cmp_ge_u32 s14, 14
    s_cbranch_scc1 L_pollok4
    s_cmp_lt_u32 s60, 20000
    s_cbranch_scc1 L_poll4
    s_branch L_pollok4
L_nog1:
    s_nop 1
    s_mov_b32 s14, 1204224
    s_mov_b32 s15, 0x20000
    s_sub_u32 s3, s2, 200
    s_cmp_lt_u32 s3, 42
    s_cselect_b32 s81, 0, 268435456
    s_cselect_b32 s3, s3, 0
    s_mul_i32 s79, s3, 43
    s_lshr_b32 s79, s79, 7
    s_mul_i32 s80, s79, 3
    s_sub_u32 s80, s3, s80
    v_min_u32 v13, 55, v1
    s_lshl_b32 s3, s79, 2
    s_add_u32 s3, s3, s48
    s_mul_i32 s3, s3, 21504
    s_mul_i32 s60, s80, 896
    s_add_u32 s3, s3, s60
    s_add_u32 s3, s3, s81
    v_lshl_add_u32 v242, v13, 4, s3
    s_mul_i32 s60, s48, 8448
    s_add_u32 m0, s60, 0
    s_mov_b32 s3, 0
    buffer_load_dwordx4 v242, s[12:15], s3 offen lds
    s_add_u32 m0, s60, 1056
    s_mov_b32 s3, 2688
    buffer_load_dwordx4 v242, s[12:15], s3 offen lds
    s_add_u32 m0, s60, 2112
    s_mov_b32 s3, 5376
    buffer_load_dwordx4 v242, s[12:15], s3 offen lds
    s_add_u32 m0, s60, 3168
    s_mov_b32 s3, 8064
    buffer_load_dwordx4 v242, s[12:15], s3 offen lds
    s_add_u32 m0, s60, 4224
    s_mov_b32 s3, 10752
    buffer_load_dwordx4 v242, s[12:15], s3 offen lds
    s_add_u32 m0, s60, 5280
    s_mov_b32 s3, 13440
    buffer_load_dwordx4 v242, s[12:15], s3 offen lds
    s_add_u32 m0, s60, 6336
    s_mov_b32 s3, 16128
    buffer_load_dwordx4 v242, s[12:15], s3 offen lds
    s_add_u32 m0, s60, 7392
    s_mov_b32 s3, 18816
    buffer_load_dwordx4 v242, s[12:15], s3 offen lds
    s_mul_i32 s53, s101, 37
    s_lshr_b32 s53, s53, 8
    s_mul_i32 s54, s53, 7
    s_sub_u32 s54, s101, s54
    s_and_b32 s53, s53, 3
    s_xor_b32 s53, s53, 0
    s_lshl_b32 s3, s6, 2
    s_add_u32 s53, s53, s3
    s_lshl_b32 s53, s53, 1
    s_add_u32 s53, s53, s7
    s_mov_b32 s42, 4096
    s_mov_b32 s43, 0x20000
    s_lshl_b32 s3, s53, 2
    s_add_u32 s3, s3, s48
    s_lshl_b32 s60, s3, 5
    v_lshl_add_u32 v82, v5, 1, s60
    s_mul_i32 s3, s3, 14336
    s_lshl_b32 s60, s54, 7
    s_add_u32 s3, s3, s60
    v_mul_u32_u24 v14, 896, v5
    v_lshl_add_u32 v14, v6, 4, v14
    v_add_u32 v85, s3, v14
    v_add_u32 v86, 7168, v85
    s_cmp_lt_u32 s101, 28
    s_cselect_b32 s56, 1, 0
    s_lshl_b32 s50, s7, 3
    s_and_b32 s3, s101, 7
    s_add_u32 s50, s50, s3
    s_lshr_b32 s60, s101, 3
    s_lshl_b32 s49, s6, 2
    s_add_u32 s49, s49, s60
    s_lshl_b32 s49, s49, 2
    s_add_u32 s49, s49, s48
    s_mul_i32 s60, s60, 0
    s_add_u32 s3, s3, s60
    s_sub_u32 s60, s3, 7
    s_cmp_ge_u32 s3, 7
    s_cselect_b32 s3, s60, s3
    s_lshl_b32 s62, s3, 18
    s_mul_i32 s63, s3, 12288
    s_mov_b32 s30, 20971520
    s_mov_b32 s31, 0x20000
    s_mov_b32 s75, 0x3727c5ac
    s_mov_b32 s76, 0x3b124925
    s_mov_b32 s77, 0x3f803f80
    v_lshlrev_b32 v4, 4, v1
    v_bfe_u32 v7, v1, 2, 2
    v_and_b32 v8, 3, v1
    v_mul_u32_u24 v13, 960, v9
    v_lshl_add_u32 v13, v10, 4, v13
    s_mul_i32 s3, s48, 1920
    s_add_u32 s3, s3, 147456
    v_add_u32 v230, s3, v13
    v_mul_u32_u24 v13, 960, v7
    v_lshl_add_u32 v13, v3, 5, v13
    v_lshl_add_u32 v13, v8, 3, v13
    s_lshl_b32 s3, s48, 8
    s_add_u32 s3, s3, 147456
    v_add_u32 v231, s3, v13
    s_lshl_b32 s3, s48, 3
    s_add_u32 s3, s3, 155648
    v_lshl_add_u32 v232, v9, 2, s3
    v_lshlrev_b32 v237, 2, v6
    v_and_b32 v2, 15, v1
    v_lshlrev_b32 v238, 14, v3
    v_add_lshl_u32 v238, v238, v2, 2
    v_add_u32 v237, 155648, v237
    v_lshlrev_b32 v13, 17, v9
    v_lshl_add_u32 v233, v10, 4, v13
    s_cmp_eq_u32 s48, 3
    s_cselect_b32 s60, 268435456, 0
    s_lshl_b32 s70, s48, 10
    s_add_u32 s70, s70, s2
    s_lshl_b32 s70, s70, 9
    s_add_u32 s71, s70, 262144
    s_add_u32 s71, s71, s60
    s_xor_b32 s60, s60, 268435456
    s_lshl_b32 s72, s2, 7
    s_add_u32 s72, s72, s60
    s_add_u32 s72, s72, 6291456
    s_lshr_b32 s74, s2, 2
    s_lshl_b32 s74, s74, 5
    s_and_b32 s3, s2, 3
    s_add_u32 s74, s74, s3
    s_lshl_b32 s74, s74, 2
    s_add_u32 s74, s74, 10485760
    v_cmp_gt_u32 vcc, 8, v0
    v_lshlrev_b32 v236, 13, v0
    v_mov_b32 v13, 268435456
    s_and_b32 s3, s2, 7
    s_lshl_b32 s3, s3, 13
    s_add_u32 s3, s3, 10485760
    v_lshrrev_b32 v14, 2, v0
    v_lshl_add_u32 v14, v14, 7, s3
    v_lshl_add_u32 v20, v8, 2, v14
    v_cndmask_b32 v236, v13, v236, vcc
    v_mov_b32 v16, 0
    s_lshl_b32 s3, s48, 14
    s_add_u32 s74, s74, s3
    s_add_u32 s73, s74, 8192
    s_waitcnt vmcnt(10)
    v_dot2_f32_bf16 v226, v182, s77, 0
    v_dot2_f32_bf16 v227, v182, v182, 0
    v_dot2_f32_bf16 v226, v183, s77, v226
    v_dot2_f32_bf16 v227, v183, v183, v227
    v_dot2_f32_bf16 v226, v184, s77, v226
    v_dot2_f32_bf16 v227, v184, v184, v227
    v_dot2_f32_bf16 v226, v185, s77, v226
    v_dot2_f32_bf16 v227, v185, v185, v227
    s_waitcnt vmcnt(9)
    v_dot2_f32_bf16 v226, v186, s77, v226
    v_dot2_f32_bf16 v227, v186, v186, v227
    v_dot2_f32_bf16 v226, v187, s77, v226
    v_dot2_f32_bf16 v227, v187, v187, v227
    v_dot2_f32_bf16 v226, v188, s77, v226
    v_dot2_f32_bf16 v227, v188, v188, v227
    v_dot2_f32_bf16 v226, v189, s77, v226
    v_dot2_f32_bf16 v227, v189, v189, v227
    buffer_load_dword v12, v16, s[44:47], 0 offen sc1
    v_lshlrev_b32 v190, 16, v182
    v_and_b32 v191, 0xffff0000, v182
    v_add_f32_dpp v226, v226, v226 quad_perm:[1,0,3,2] row_mask:0xf bank_mask:0xf
    v_add_f32_dpp v227, v227, v227 quad_perm:[1,0,3,2] row_mask:0xf bank_mask:0xf
    v_lshlrev_b32 v192, 16, v183
    v_add_f32_dpp v226, v226, v226 quad_perm:[2,3,0,1] row_mask:0xf bank_mask:0xf
    v_add_f32_dpp v227, v227, v227 quad_perm:[2,3,0,1] row_mask:0xf bank_mask:0xf
    v_and_b32 v193, 0xffff0000, v183
    v_add_f32_dpp v226, v226, v226 row_half_mirror row_mask:0xf bank_mask:0xf
    v_add_f32_dpp v227, v227, v227 row_half_mirror row_mask:0xf bank_mask:0xf
    v_lshlrev_b32 v194, 16, v184
    v_add_f32_dpp v226, v226, v226 row_mirror row_mask:0xf bank_mask:0xf
    v_add_f32_dpp v227, v227, v227 row_mirror row_mask:0xf bank_mask:0xf
    v_and_b32 v195, 0xffff0000, v184
    v_mov_b32 v228, v226
    v_mov_b32 v229, v227
    v_lshlrev_b32 v196, 16, v185
    v_permlane16_swap_b32 v226, v228
    v_permlane16_swap_b32 v227, v229
    v_add_f32 v226, v226, v228
    v_add_f32 v227, v227, v229
    v_mul_f32_e64 v226, -v226, s76
    v_mul_f32 v228, v226, v226
    v_fma_f32 v227, v227, s76, -v228
    v_max_f32 v227, 0, v227
    v_add_f32 v228, s75, v227
    v_rsq_f32 v222, v228
    v_and_b32 v197, 0xffff0000, v185
    v_mul_f32 v228, v222, v222
    v_fma_f32 v229, v228, v227, s75
    v_rsq_f32 v228, v229
    v_mul_f32 v223, v226, v222
    v_mul_f32 v224, v222, v228
    v_mul_f32 v225, v223, v228
    v_mul_f32 v229, v229, v228
    ds_write_b32 v232, v229
    v_lshlrev_b32 v198, 16, v186
    v_and_b32 v199, 0xffff0000, v186
    v_lshlrev_b32 v200, 16, v187
    v_and_b32 v201, 0xffff0000, v187
    v_lshlrev_b32 v202, 16, v188
    v_and_b32 v203, 0xffff0000, v188
    v_lshlrev_b32 v204, 16, v189
    v_and_b32 v205, 0xffff0000, v189
    v_pk_fma_f32 v[206:207], v[190:191], v[224:225], v[224:225] op_sel:[0,0,1] op_sel_hi:[1,0,1]
    v_pk_fma_f32 v[208:209], v[192:193], v[224:225], v[224:225] op_sel:[0,0,1] op_sel_hi:[1,0,1]
    v_pk_fma_f32 v[210:211], v[194:195], v[224:225], v[224:225] op_sel:[0,0,1] op_sel_hi:[1,0,1]
    v_pk_fma_f32 v[212:213], v[196:197], v[224:225], v[224:225] op_sel:[0,0,1] op_sel_hi:[1,0,1]
    v_cvt_pk_bf16_f32 v182, v206, v207
    v_cvt_pk_bf16_f32 v183, v208, v209
    v_cvt_pk_bf16_f32 v184, v210, v211
    v_cvt_pk_bf16_f32 v185, v212, v213
    ds_write_b128 v230, v[182:185] offset:0
    v_pk_fma_f32 v[214:215], v[198:199], v[224:225], v[224:225] op_sel:[0,0,1] op_sel_hi:[1,0,1]
    v_pk_fma_f32 v[216:217], v[200:201], v[224:225], v[224:225] op_sel:[0,0,1] op_sel_hi:[1,0,1]
    v_pk_fma_f32 v[218:219], v[202:203], v[224:225], v[224:225] op_sel:[0,0,1] op_sel_hi:[1,0,1]
    v_pk_fma_f32 v[220:221], v[204:205], v[224:225], v[224:225] op_sel:[0,0,1] op_sel_hi:[1,0,1]
    v_cvt_pk_bf16_f32 v186, v214, v215
    v_cvt_pk_bf16_f32 v187, v216, v217
    v_cvt_pk_bf16_f32 v188, v218, v219
    v_cvt_pk_bf16_f32 v189, v220, v221
    ds_write_b128 v230, v[186:189] offset:448
    s_waitcnt lgkmcnt(0)
    s_barrier
    ds_read_b64_tr_b16 v[110:111], v231 offset:0
    ds_read_b64_tr_b16 v[112:113], v231 offset:3840
    ds_read_b64_tr_b16 v[114:115], v231 offset:128
    ds_read_b64_tr_b16 v[116:117], v231 offset:3968
    ds_read_b32 v229, v237
    s_waitcnt lgkmcnt(3)
    buffer_store_dwordx4 v[110:113], v233, s[28:31], s70 offen sc1
    s_waitcnt lgkmcnt(1)
    buffer_store_dwordx4 v[114:117], v233, s[28:31], s71 offen sc1
    v_cmp_gt_u32 vcc, 16, v1
    s_waitcnt lgkmcnt(0)
    s_nop 0
    v_cndmask_b32 v229, 0, v229, vcc
    buffer_store_dword v229, v238, s[28:31], s72 offen sc1
    v_lshrrev_b32 v13, 2, v1
    v_mul_u32_u24 v13, 1056, v13
    v_lshl_add_u32 v13, v8, 3, v13
    s_mul_i32 s3, s48, 224
    v_add_u32 v243, s3, v13
    s_mov_b32 s18, 401408
    s_mov_b32 s19, 0x20000
    s_mov_b32 s26, 7340032
    s_mov_b32 s27, 0x20000
    s_mov_b32 s34, 1835008
    s_mov_b32 s35, 0x20000
    s_mov_b32 s36, 1
    v_lshrrev_b32 v14, 2, v1
    v_lshlrev_b32 v14, 7, v14
    v_lshl_add_u32 v14, v8, 3, v14
    v_and_b32 v15, 3, v5
    v_lshl_add_u32 v14, v15, 5, v14
    s_mul_i32 s3, s4, 8256
    v_xor_b32 v31, s3, v14
    v_xor_b32 v32, 32, v31
    v_xor_b32 v33, 64, v31
    v_xor_b32 v34, 96, v31
    v_add_u32 v35, 65536, v31
    v_add_u32 v36, 65536, v32
    v_add_u32 v37, 65536, v33
    v_add_u32 v38, 65536, v34
    v_add_u32 v39, 131072, v31
    v_add_u32 v40, 131072, v32
    v_add_u32 v41, 131072, v33
    v_add_u32 v42, 131072, v34
    s_lshl_b32 s6, s52, 1
    s_add_u32 s6, s6, s5
    s_lshl_b32 s3, s6, 1
    s_add_u32 s3, s3, s59
    s_lshl_b32 s3, s3, 4
    s_add_u32 s3, s3, s4
    s_lshl_b32 s3, s3, 12
    v_lshl_add_u32 v78, v3, 8, v4
    v_add_u32 v78, s3, v78
    s_xor_b32 s37, s51, 1
    s_lshl_b32 s37, s37, 3
    s_add_u32 s37, s37, s52
    s_lshl_b32 s3, s37, 14
    s_add_u32 s3, s3, s58
    s_add_u32 s3, s3, 16777216
    v_add_u32 v23, s3, v4
    s_lshl_b32 s37, s37, 5
    s_add_u32 s37, s37, s5
    s_lshl_b32 s37, s37, 2
    s_add_u32 s37, s37, 6422528
    s_mul_i32 s67, s6, 56
    s_lshl_b32 s3, s51, 1
    s_add_u32 s3, s3, s4
    s_add_u32 s67, s67, s3
    s_lshl_b32 s67, s67, 11
    s_add_u32 s67, s67, 2097152
    v_add_u32 v81, s58, v4
    s_lshl_b32 s68, s52, 2
    s_and_b32 s3, s51, 1
    s_add_u32 s68, s68, s3
    s_cmp_ge_u32 s51, 14
    s_cselect_b32 s3, 2, 0
    s_add_u32 s68, s68, s3
    s_lshl_b32 s68, s68, 7
    s_add_u32 s68, s68, 6356992
    s_waitcnt vmcnt(3)
    v_readfirstlane_b32 s57, v12
    s_mov_b32 s60, 0
    s_cmp_lg_u32 s57, 0
    s_cbranch_scc0 L_nonceh
L_nonce_okh:
    s_waitcnt vmcnt(0)
    s_barrier
    s_atomic_swap s57, s[28:29], s74
    s_atomic_swap s57, s[28:29], s73
    buffer_load_dwordx4 v[96:99], v85, s[8:11], 0 offen
    buffer_load_ushort v93, v82, s[40:43], 0 offen offset:0
    buffer_load_dwordx4 v[100:103], v86, s[8:11], 0 offen
    buffer_load_ushort v94, v82, s[40:43], 0 offen offset:16
    v_cmp_gt_u32 vcc, 12, v2
    s_mul_i32 s3, s48, 56
    s_add_u32 s3, s3, s79
    s_mul_i32 s3, s3, 3
    s_add_u32 s3, s3, s80
    s_lshl_b32 s3, s3, 11
    s_add_u32 s3, s3, 8388608
    s_add_u32 s3, s3, s81
    ds_read_b64_tr_b16 v[182:183], v243 offset:0
    ds_read_b64_tr_b16 v[184:185], v243 offset:16896
    ds_read_b64_tr_b16 v[186:187], v243 offset:32
    ds_read_b64_tr_b16 v[188:189], v243 offset:16928
    ds_read_b64_tr_b16 v[190:191], v243 offset:56
    ds_read_b64_tr_b16 v[192:193], v243 offset:16952
    ds_read_b64_tr_b16 v[194:195], v243 offset:88
    ds_read_b64_tr_b16 v[196:197], v243 offset:16984
    ds_read_b64_tr_b16 v[198:199], v243 offset:112
    ds_read_b64_tr_b16 v[200:201], v243 offset:17008
    ds_read_b64_tr_b16 v[202:203], v243 offset:144
    ds_read_b64_tr_b16 v[204:205], v243 offset:17040
    ds_read_b64_tr_b16 v[206:207], v243 offset:168
    ds_read_b64_tr_b16 v[208:209], v243 offset:17064
    ds_read_b64_tr_b16 v[210:211], v243 offset:200
    ds_read_b64_tr_b16 v[212:213], v243 offset:17096
    s_waitcnt lgkmcnt(13)
    v_cndmask_b32 v186, 0, v186, vcc
    v_cndmask_b32 v187, 0, v187, vcc
    s_waitcnt lgkmcnt(12)
    v_cndmask_b32 v188, 0, v188, vcc
    v_cndmask_b32 v189, 0, v189, vcc
    buffer_store_dwordx4 v[182:185], v4, s[28:31], s3 offen offset:0 sc1
    buffer_store_dwordx4 v[186:189], v4, s[28:31], s3 offen offset:1024 sc1
    s_add_u32 s3, s3, 86016
    s_waitcnt lgkmcnt(9)
    v_cndmask_b32 v194, 0, v194, vcc
    v_cndmask_b32 v195, 0, v195, vcc
    s_waitcnt lgkmcnt(8)
    v_cndmask_b32 v196, 0, v196, vcc
    v_cndmask_b32 v197, 0, v197, vcc
    buffer_store_dwordx4 v[190:193], v4, s[28:31], s3 offen offset:0 sc1
    buffer_store_dwordx4 v[194:197], v4, s[28:31], s3 offen offset:1024 sc1
    s_add_u32 s3, s3, 86016
    s_waitcnt lgkmcnt(5)
    v_cndmask_b32 v202, 0, v202, vcc
    v_cndmask_b32 v203, 0, v203, vcc
    s_waitcnt lgkmcnt(4)
    v_cndmask_b32 v204, 0, v204, vcc
    v_cndmask_b32 v205, 0, v205, vcc
    buffer_store_dwordx4 v[198:201], v4, s[28:31], s3 offen offset:0 sc1
    buffer_store_dwordx4 v[202:205], v4, s[28:31], s3 offen offset:1024 sc1
    s_add_u32 s3, s3, 86016
    ds_read_b32 v24, v4
    s_waitcnt lgkmcnt(2)
    v_cndmask_b32 v210, 0, v210, vcc
    v_cndmask_b32 v211, 0, v211, vcc
    ds_read_b32 v24, v4
    s_waitcnt lgkmcnt(2)
    v_cndmask_b32 v212, 0, v212, vcc
    v_cndmask_b32 v213, 0, v213, vcc
    buffer_store_dwordx4 v[206:209], v4, s[28:31], s3 offen offset:0 sc1
    buffer_store_dwordx4 v[210:213], v4, s[28:31], s3 offen offset:1024 sc1
    s_add_u32 s3, s3, 86016
    s_lshl_b32 s67, s80, 6
    s_add_u32 s67, s67, 64
    s_cmp_eq_u32 s81, 0
    s_cselect_b32 s37, s48, 1
    s_mov_b32 s68, 6369792
    s_and_b32 s3, s2, 1
    s_mul_i32 s3, s3, 3
    s_bfe_u32 s6, s2, 0x10001
    s_mul_i32 s7, s6, 6
    s_add_u32 s3, s3, s7
    s_add_u32 s3, s3, 1
    v_add_u32 v14, s3, v8
    s_mul_i32 s6, s6, 64
    s_add_u32 s6, s6, 7
    v_cmp_ne_u32 vcc, s6, v14
    v_lshrrev_b32 v15, 2, v1
    v_mul_u32_u24 v15, 3584, v15
    v_cndmask_b32 v14, 0, v14, vcc
    v_lshl_add_u32 v14, v14, 8, v15
    s_lshl_b32 s3, s52, 2
    s_add_u32 s3, s3, s48
    s_mul_i32 s3, s3, 37
    s_min_u32 s3, s3, 987
    s_mul_i32 s3, s3, 3584
    s_mul_i32 s6, s59, 3670144
    s_add_u32 s3, s3, s6
    buffer_load_dword v226, v14, s[20:23], s3 offen
    s_add_u32 s3, s3, 57344
    buffer_load_dword v227, v14, s[20:23], s3 offen
    s_add_u32 s3, s3, 57344
    v_cmp_gt_u32 vcc, 20, v1
    v_mov_b32 v15, 268435456
    s_nop 0
    v_cndmask_b32 v14, v15, v14, vcc
    buffer_load_dword v228, v14, s[20:23], s3 offen
    s_add_u32 s3, s3, 57344
    v_add_u32 v53, 65536, v4
    v_add_u32 v54, 131072, v4
    s_mul_i32 s59, s48, 3072
    s_mul_i32 s3, s50, 86016
    s_add_u32 s3, s3, s59
    s_add_u32 s3, s3, 8388608
    v_add_u32 v80, s3, v4
    v_lshlrev_b32 v14, 7, v9
    v_xor_b32 v14, v14, v4
    s_lshl_b32 s3, s49, 11
    v_add_u32 v67, s3, v14
    v_add_u32 v68, 129024, v67
    s_lshr_b32 s3, s49, 2
    s_lshl_b32 s3, s3, 3
    s_max_u32 s3, s3, 1
    s_sub_u32 s3, s3, 1
    s_lshl_b32 s3, s3, 10
    s_lshl_b32 s6, s5, 17
    s_add_u32 s3, s3, s6
    s_lshl_b32 s6, s4, 28
    s_add_u32 s3, s3, s6
    v_add_u32 v69, s3, v14
    s_lshl_b32 s100, s5, 1
    s_add_u32 s100, s100, s4
    s_lshl_b32 s100, s100, 10
    v_and_b32 v14, 1, v1
    v_mul_u32_u24 v14, 640, v14
    v_lshrrev_b32 v15, 2, v1
    v_lshlrev_b32 v15, 4, v15
    v_xor_b32 v14, v14, v15
    v_bfe_u32 v15, v1, 1, 1
    v_lshl_add_u32 v14, v15, 3, v14
    s_add_u32 s3, s58, 12288
    v_add_u32 v70, s3, v14
    s_sub_u32 s3, s3, 3072
    s_cmp_eq_u32 s48, 0
    s_cselect_b32 s3, 28672, s3
    v_add_u32 v71, s3, v14
    v_add_u32 v72, 65536, v70
    v_add_u32 v73, 65536, v71
    v_add_u32 v74, 131072, v70
    v_add_u32 v75, 131072, v71
    s_lshl_b32 s3, s49, 1
    v_min_u32 v14, 2, v3
    v_add_u32 v14, s3, v14
    v_max_u32 v14, 1, v14
    v_lshlrev_b32 v14, 1, v14
    v_and_b32 v15, 1, v7
    v_add_lshl_u32 v14, v14, v15, 7
    v_lshrrev_b32 v15, 1, v7
    v_lshl_add_u32 v15, v15, 2, v8
    v_lshl_add_u32 v14, v15, 2, v14
    v_add_u32 v77, 6291200, v14
    s_min_u32 s15, s48, 2
    s_lshl_b32 s15, s15, 6
    s_add_u32 s15, s15, 64
    s_lshl_b32 s82, s49, 5
    s_add_u32 s82, s82, s50
    s_lshl_b32 s82, s82, 10
    s_add_u32 s82, s82, 4194304
    s_lshr_b32 s69, s49, 2
    s_lshl_b32 s69, s69, 1
    s_and_b32 s3, s50, 1
    s_add_u32 s69, s69, s3
    s_lshl_b32 s69, s69, 7
    s_add_u32 s69, s69, 6361088
    s_and_b32 s7, s53, 1
    s_mul_i32 s3, s7, 28
    s_add_u32 s3, s3, s48
    s_lshl_b32 s3, s3, 17
    s_xor_b32 s6, s53, 1
    s_lshl_b32 s55, s6, 3
    s_lshl_b32 s6, s53, 7
    s_add_u32 s3, s3, s6
    v_lshlrev_b32 v14, 12, v5
    v_add3_u32 v59, v14, v83, s3
    v_add_u32 v60, 31744, v59
    v_add_u32 v61, 63488, v59
    v_add_u32 v62, 95232, v59
    v_mul_u32_u24 v14, 896, v5
    s_mul_i32 s3, s4, 25088
    s_mul_i32 s6, s5, 14336
    s_add_u32 s3, s3, s6
    s_lshl_b32 s6, s54, 7
    s_add_u32 s3, s3, s6
    v_add3_u32 v63, v14, v83, s3
    v_add_u32 v64, 6144, v63
    s_lshl_b32 s6, s53, 1
    s_add_u32 s6, s6, s5
    s_and_b32 s3, s53, 30
    s_add_u32 s3, s3, s4
    s_lshl_b32 s3, s3, 7
    s_add_u32 s39, s3, 6361088
    s_lshl_b32 s3, s6, 5
    s_add_u32 s3, s3, s4
    s_lshl_b32 s3, s3, 10
    s_add_u32 s3, s3, 4194304
    v_add_u32 v65, s3, v4
    v_add_u32 v66, 15360, v65
    s_xor_b32 s3, s4, s5
    s_lshl_b32 s3, s3, 6
    v_xor_b32 v43, s3, v31
    v_xor_b32 v44, 32, v43
    v_add_u32 v45, 65536, v43
    v_add_u32 v46, 65536, v44
    s_mul_i32 s3, s4, 12288
    v_add_u32 v47, s3, v4
    v_xor_b32 v48, 4096, v47
    v_add_u32 v49, 65536, v47
    v_add_u32 v50, 65536, v48
    v_add_u32 v51, 131072, v47
    v_add_u32 v52, 131072, v48
    s_lshl_b32 s6, s54, 1
    s_add_u32 s6, s6, s5
    s_lshl_b32 s3, s6, 1
    s_add_u32 s3, s3, s7
    s_mul_i32 s3, s3, 14
    s_add_u32 s3, s3, s4
    s_lshl_b32 s3, s3, 12
    s_add_u32 s3, s3, 2097152
    v_add_u32 v79, s3, v4
    s_lshl_b32 s3, s54, 1
    s_add_u32 s3, s3, s7
    s_lshl_b32 s3, s3, 1
    s_add_u32 s3, s3, s4
    s_lshl_b32 s3, s3, 7
    s_add_u32 s38, s3, 6356992
    s_and_b32 s3, s2, 6
    s_add_u32 s3, s3, s54
    s_sub_u32 s6, s3, 7
    s_cmp_ge_u32 s3, 7
    s_cselect_b32 s3, s6, s3
    s_lshl_b32 s64, s3, 19
    s_lshl_b32 s65, s3, 13
    s_add_u32 s55, s55, s54
    s_lshl_b32 s3, s55, 14
    s_add_u32 s3, s3, s58
    s_add_u32 s3, s3, 12582912
    v_add_u32 v21, s3, v4
    s_lshl_b32 s55, s55, 5
    s_add_u32 s55, s55, s48
    s_lshl_b32 s55, s55, 2
    s_add_u32 s55, s55, 6488064
    s_lshl_b32 s3, s5, 3
    v_add_u32 v13, s3, v3
    v_xor_b32 v13, v13, v6
    v_lshlrev_b32 v13, 4, v13
    v_lshl_add_u32 v13, v2, 8, v13
    s_lshl_b32 s3, s4, 14
    s_add_u32 s3, s3, 32768
    v_add_u32 v87, s3, v13
    v_xor_b32 v88, 64, v87
    s_lshr_b32 s3, s53, 1
    s_add_u32 s66, s3, s54
    s_mov_b32 s51, s66
    v_lshlrev_b32 v13, 1, v6
    v_xor_b32 v13, v13, v5
    v_lshlrev_b32 v13, 4, v13
    v_lshl_add_u32 v13, v5, 8, v13
    s_add_u32 s3, s58, 32768
    v_add_u32 v89, s3, v13
    v_xor_b32 v90, 16, v89
    v_xor_b32 v91, 24576, v89
    v_xor_b32 v92, 24592, v89
    s_mov_b32 s70, 0xaaaaaaaa
    s_mov_b32 s71, 0xaaaaaaaa
    s_mov_b32 s72, 0xfff0ffff
    s_mov_b32 s73, 0xf000ff00
    s_mov_b32 s74, 0xffc0fffc
    s_mov_b32 s75, 0xc000fc00
    s_cmp_eq_u32 s49, 0
    s_cselect_b64 s[76:77], 0, -1
    v_mov_b32 v13, 0xffff
    v_mov_b32 v14, 0xffff0000
    v_cndmask_b32 v13, v13, v14, s[70:71]
    v_cndmask_b32 v104, v13, 0, s[72:73]
    v_cndmask_b32 v106, 0, v13, s[72:73]
    v_cndmask_b32 v105, v13, 0, s[74:75]
    v_cndmask_b32 v107, 0, v13, s[74:75]
    v_mov_b32 v84, 0xf149f2ca
    s_mov_b32 s83, 0x3e8b97f6
    s_mov_b32 s78, 0xbdd2d3e8
    s_mov_b32 s79, 0xbdd2d3e8
    s_mov_b32 s80, 1.0
    s_mov_b32 s81, 1.0
    v_mov_b32 v108, 0xc0135761
    v_mov_b32 v109, 0xc0135761
    v_lshrrev_b32 v13, 1, v2
    v_lshlrev_b32 v14, 1, v3
    v_sub_u32 v13, v13, v14
    v_mov_b32 v14, 0x3f80
    v_cndmask_b32 v14, v14, 1.0, s[70:71]
    v_cmp_eq_i32 vcc, 0, v13
    v_accvgpr_write_b32 a248, 0
    v_accvgpr_write_b32 a252, 0
    v_cndmask_b32 v15, 0, v14, vcc
    v_accvgpr_write_b32 a250, v15
    v_cmp_eq_i32 vcc, 1, v13
    v_accvgpr_write_b32 a249, 0
    v_accvgpr_write_b32 a253, 0
    v_cndmask_b32 v15, 0, v14, vcc
    v_accvgpr_write_b32 a251, v15
    s_waitcnt vmcnt(3)
    s_barrier
    s_cmp_lg_u32 s37, 0
    s_cbranch_scc1 L_nowsig
    s_atomic_add s36, s[44:45], s67
L_nowsig:
    buffer_load_dword v18, v20, s[28:31], 0 offen sc1
    s_mov_b32 s26, 7340032
    s_and_b32 s3, s2, 1
    s_mul_i32 s3, s3, 7
    s_add_u32 s3, s3, s52
    s_lshl_b32 s3, s3, 2
    s_add_u32 s3, s3, s48
    s_lshl_b32 s3, s3, 17
    s_and_b32 s6, s2, 6
    s_lshl_b32 s6, s6, 9
    s_add_u32 s3, s3, s6
    v_lshlrev_b32 v242, 12, v10
    v_mul_u32_u24 v243, 512, v9
    v_add_u32 v243, v242, v243
    buffer_load_dword v232, v243, s[24:27], s3 offen offset:384
    v_mul_u32_u24 v243, 512, v9
    v_add_u32 v243, v242, v243
    buffer_load_dword v233, v243, s[24:27], s3 offen offset:256
    s_cmp_eq_u32 s56, 0
    s_cselect_b32 s26, 0, s26
    s_cmp_eq_u32 s56, 0
    s_cselect_b32 s26, 0, s26
    v_and_b32 v13, 0xfffff000, v78
    v_lshl_add_u32 v13, v10, 7, v13
    s_add_u32 s3, s1, 8192
    v_lshl_add_u32 v14, v9, 13, s3
    s_waitcnt vmcnt(2)
    v_cmp_ne_u32 vcc, s57, v18
    s_cbranch_vccnz L_pollin3
L_pollok3:
    s_mov_b32 s14, 0
    s_load_dword s14, s[44:45], s15
    s_barrier
    buffer_load_dword v76, v77, s[28:31], 0 offen sc1
    s_cmp_ge_u32 s14, 14
    s_cbranch_scc0 L_pollin4
L_pollok4:
    s_barrier
    s_cmp_eq_u32 s56, 0
    s_cselect_b32 s3, 268435456, 0
    v_add_u32 v79, s3, v79
    s_mov_b32 s26, 7340032
    s_and_b32 s3, s54, 1
    s_lshl_b32 s3, s3, 2
    s_lshr_b32 s6, s54, 1
    s_add_u32 s3, s3, s6
    s_lshl_b32 s3, s3, 7
    s_cmp_eq_u32 s56, 0
    s_cselect_b32 s3, s3, 0
    v_xor_b32 v59, s3, v59
    v_xor_b32 v60, s3, v60
    v_xor_b32 v61, s3, v61
    v_xor_b32 v62, s3, v62
    s_add_u32 m0, s59, 98304
    s_nop 0
    buffer_load_dwordx4 v80, s[28:31], s63 offen sc1 lds
    buffer_load_dwordx4 v80, s[28:31], s63 offen offset:1024 sc1 lds
    buffer_load_dwordx4 v80, s[28:31], s63 offen offset:2048 sc1 lds
    s_add_u32 m0, s100, 126976
    s_nop 0
    buffer_load_dwordx4 v69, s[28:31], s62 offen sc1 lds
    s_add_u32 m0, s58, 110592
    s_nop 0
    buffer_load_dwordx4 v67, s[28:31], s62 offen sc1 lds
    buffer_load_dwordx4 v67, s[28:31], s62 offen offset:1024 sc1 lds
    buffer_load_dwordx4 v68, s[28:31], s62 offen offset:2048 sc1 lds
    buffer_load_dwordx4 v68, s[28:31], s62 offen offset:3072 sc1 lds
    s_add_u32 m0, s59, 131072
    s_add_u32 s63, s63, 12288
    s_cmp_eq_u32 s63, 86016
    s_cselect_b32 s63, 0, s63
    buffer_load_dwordx4 v80, s[28:31], s63 offen sc1 lds
    buffer_load_dwordx4 v80, s[28:31], s63 offen offset:1024 sc1 lds
    buffer_load_dwordx4 v80, s[28:31], s63 offen offset:2048 sc1 lds
    s_add_u32 m0, s100, 159744
    s_add_u32 s62, s62, 262144
    s_cmp_eq_u32 s62, 1835008
    s_cselect_b32 s62, 0, s62
    buffer_load_dwordx4 v69, s[28:31], s62 offen sc1 lds
    s_add_u32 m0, s58, 143360
    s_nop 0
    buffer_load_dwordx4 v67, s[28:31], s62 offen sc1 lds
    buffer_load_dwordx4 v67, s[28:31], s62 offen offset:1024 sc1 lds
    buffer_load_dwordx4 v68, s[28:31], s62 offen offset:2048 sc1 lds
    buffer_load_dwordx4 v68, s[28:31], s62 offen offset:3072 sc1 lds
    s_add_u32 m0, s59, 0
    s_add_u32 s63, s63, 12288
    s_cmp_eq_u32 s63, 86016
    s_cselect_b32 s63, 0, s63
    buffer_load_dwordx4 v80, s[28:31], s63 offen sc1 lds
    buffer_load_dwordx4 v80, s[28:31], s63 offen offset:1024 sc1 lds
    buffer_load_dwordx4 v80, s[28:31], s63 offen offset:2048 sc1 lds
    s_add_u32 m0, s100, 28672
    s_add_u32 s62, s62, 262144
    s_cmp_eq_u32 s62, 1835008
    s_cselect_b32 s62, 0, s62
    buffer_load_dwordx4 v69, s[28:31], s62 offen sc1 lds
    s_add_u32 m0, s58, 12288
    s_nop 0
    buffer_load_dwordx4 v67, s[28:31], s62 offen sc1 lds
    buffer_load_dwordx4 v67, s[28:31], s62 offen offset:1024 sc1 lds
    buffer_load_dwordx4 v68, s[28:31], s62 offen offset:2048 sc1 lds
    buffer_load_dwordx4 v68, s[28:31], s62 offen offset:3072 sc1 lds
    s_add_u32 m0, s59, 65536
    s_add_u32 s63, s63, 12288
    s_cmp_eq_u32 s63, 86016
    s_cselect_b32 s63, 0, s63
    buffer_load_dwordx4 v80, s[28:31], s63 offen sc1 lds
    buffer_load_dwordx4 v80, s[28:31], s63 offen offset:1024 sc1 lds
    buffer_load_dwordx4 v80, s[28:31], s63 offen offset:2048 sc1 lds
    s_add_u32 m0, s100, 94208
    s_add_u32 s62, s62, 262144
    s_cmp_eq_u32 s62, 1835008
    s_cselect_b32 s62, 0, s62
    buffer_load_dwordx4 v69, s[28:31], s62 offen sc1 lds
    s_add_u32 m0, s58, 77824
    s_nop 0
    buffer_load_dwordx4 v67, s[28:31], s62 offen sc1 lds
    buffer_load_dwordx4 v67, s[28:31], s62 offen offset:1024 sc1 lds
    buffer_load_dwordx4 v68, s[28:31], s62 offen offset:2048 sc1 lds
    buffer_load_dwordx4 v68, s[28:31], s62 offen offset:3072 sc1 lds
    s_mov_b32 s3, 268435456
    buffer_store_dword v12, v11, s[28:31], s3 offen
    buffer_store_dword v12, v11, s[28:31], s3 offen
    v_lshlrev_b32 v13, 2, v2
    v_and_b32 v14, 1, v1
    v_lshl_add_u32 v14, v3, 2, v14
    v_lshlrev_b32 v14, 2, v14
    v_add_u32 v15, 64, v14
    v_cndmask_b32 v16, v14, v15, s[72:73]
    v_cndmask_b32 v14, v14, v15, s[74:75]
    s_waitcnt vmcnt(34)
    ds_bpermute_b32 v25, v13, v76 offset:64
    ds_bpermute_b32 v27, v16, v76 offset:0
    ds_bpermute_b32 v28, v14, v76 offset:8
    ds_bpermute_b32 v26, v13, v76 offset:128
    ds_bpermute_b32 v29, v16, v76 offset:64
    ds_bpermute_b32 v30, v14, v76 offset:72
    s_waitcnt lgkmcnt(5)
    v_mul_f32 v25, s83, v25
    ds_read_b32 v24, v4
    s_waitcnt lgkmcnt(3)
    v_mul_f32 v26, s83, v26
    ds_read_b32 v24, v4
    ds_read_b32 v24, v4
    ds_read_b32 v24, v4
    s_waitcnt vmcnt(18) lgkmcnt(3)
    s_barrier
    ds_read_b64_tr_b16 a[180:181], v72 offset:32768
    ds_read_b64_tr_b16 a[182:183], v72 offset:33024
    ds_read_b128 a[128:131], v53 offset:32768
    ds_read_b64_tr_b16 a[184:185], v72 offset:33792
    ds_read_b64_tr_b16 a[186:187], v72 offset:34048
    ds_read_b128 a[132:135], v53 offset:33792
    ds_read_b128 a[136:139], v53 offset:34816
    ds_read_b64_tr_b16 a[176:177], v73 offset:32768
    ds_read_b64_tr_b16 a[178:179], v73 offset:33024
    ds_read_b128 a[140:143], v53 offset:35840
    ds_read_b128 a[144:147], v53 offset:36864
    ds_read_b128 a[148:151], v53 offset:37888
    s_waitcnt lgkmcnt(0)
    s_nop 3
    s_branch L_q
L_pollin5:
    s_waitcnt lgkmcnt(0)
    s_cmp_ge_u32 s14, 7
    s_cbranch_scc1 L_pollok5
    s_cmp_eq_u32 s56, 0
    s_cbranch_scc1 L_pollok5
    s_mov_b32 s60, 0
    s_branch L_poll5a
L_poll5:
    s_sleep 8
L_poll5a:
    buffer_load_dword v18, off, s[28:31], s38 sc1
    s_add_u32 s60, s60, 1
    s_waitcnt vmcnt(0)
    v_readfirstlane_b32 s14, v18
    s_nop 0
    s_cmp_ge_u32 s14, 7
    s_cbranch_scc1 L_pollok5
    s_cmp_lt_u32 s60, 20000
    s_cbranch_scc1 L_poll5
    s_branch L_pollok5
L_nof:
    v_min_u32 v14, 48, v1
    s_lshl_b32 s3, s54, 2
    s_add_u32 s3, s3, s48
    s_mul_i32 s3, s3, 25088
    v_lshl_add_u32 v14, v14, 7, s3
    s_add_u32 s3, s2, 0
    s_and_b32 s3, s3, 3
    s_mul_i32 s3, s3, 6272
    buffer_load_dword v182, v14, s[16:19], s3 offen
    s_waitcnt vmcnt(1)
    s_barrier
    s_cmp_lg_u32 s48, 0
    s_cbranch_scc1 L_sig3
    s_atomic_add s36, s[28:29], s69
L_sig3:
    s_add_u32 s3, s2, 1
    s_and_b32 s3, s3, 3
    s_mul_i32 s3, s3, 6272
    buffer_load_dword v183, v14, s[16:19], s3 offen
    s_add_u32 s3, s2, 2
    s_and_b32 s3, s3, 3
    s_mul_i32 s3, s3, 6272
    buffer_load_dword v184, v14, s[16:19], s3 offen
    s_add_u32 s3, s2, 3
    s_and_b32 s3, s3, 3
    s_mul_i32 s3, s3, 6272
    buffer_load_dword v185, v14, s[16:19], s3 offen
    s_branch L_fin
L_pollin6:
    s_waitcnt lgkmcnt(0)
    s_cmp_ge_u32 s14, 8
    s_cbranch_scc1 L_pollok6
    s_mov_b32 s60, 0
    s_branch L_poll6a
L_poll6:
    s_sleep 8
L_poll6a:
    buffer_load_dword v18, off, s[28:31], s39 sc1
    s_add_u32 s60, s60, 1
    s_waitcnt vmcnt(0)
    v_readfirstlane_b32 s14, v18
    s_nop 0
    s_cmp_ge_u32 s14, 8
    s_cbranch_scc1 L_pollok6
    s_cmp_lt_u32 s60, 20000
    s_cbranch_scc1 L_poll6
    s_branch L_pollok6
L_pollin7:
    s_waitcnt lgkmcnt(0)
    s_cmp_ge_u32 s14, 1
    s_cbranch_scc1 L_pollok7
    s_mov_b32 s60, 0
    s_branch L_poll7a
L_poll7:
    s_sleep 4
L_poll7a:
    buffer_load_dword v18, off, s[28:31], s55 sc1
    s_add_u32 s60, s60, 1
    s_waitcnt vmcnt(0)
    v_readfirstlane_b32 s14, v18
    s_nop 0
    s_cmp_ge_u32 s14, 1
    s_cbranch_scc1 L_pollok7
    s_cmp_lt_u32 s60, 20000
    s_cbranch_scc1 L_poll7
    s_branch L_pollok7
L_last:
    s_endpgm
.section .rodata,"a"
.p2align 6
.amdhsa_kernel parallel_sum__sliding_local_dilated__mixer_token_mlp__prompt_kernel
  .amdhsa_next_free_vgpr 512
  .amdhsa_next_free_sgpr 102
  .amdhsa_accum_offset 256
  .amdhsa_group_segment_fixed_size 0
  .amdhsa_kernarg_size 88
  .amdhsa_user_sgpr_count 2
  .amdhsa_user_sgpr_kernarg_segment_ptr 1
  .amdhsa_system_sgpr_workgroup_id_x 1
.end_amdhsa_kernel
```

```asm
; @launch grid=(256,1,1) block=(256,1,1) lds=163840
.amdgcn_target "amdgcn-amd-amdhsa--gfx950"
.text
.globl parallel_sum__sliding_local_dilated__mixer_token_mlp__prompt_kernel
.p2align 8
.type parallel_sum__sliding_local_dilated__mixer_token_mlp__prompt_kernel,@function
parallel_sum__sliding_local_dilated__mixer_token_mlp__prompt_kernel:
    s_cmp_ge_u32 s2, 256
    s_cbranch_scc1 L_end
    s_load_dwordx2 s[8:9], s[0:1], 0
    s_load_dwordx2 s[20:21], s[0:1], 32
    s_load_dwordx2 s[28:29], s[0:1], 80
    s_load_dwordx2 s[44:45], s[0:1], 72
    s_load_dwordx2 s[12:13], s[0:1], 8
    s_load_dwordx2 s[16:17], s[0:1], 16
    s_load_dwordx2 s[24:25], s[0:1], 48
    s_load_dwordx2 s[32:33], s[0:1], 64
    s_load_dwordx2 s[36:37], s[0:1], 40
    s_load_dwordx2 s[40:41], s[0:1], 56
    s_memrealtime s[78:79]
    s_getpc_b64 s[6:7]
L_pc:
    s_and_b32 s3, s2, 0xf8
    v_lshrrev_b32 v13, 5, v0
    v_add_lshl_u32 v13, s3, v13, 7
    v_min_u32 v13, L_last-L_pc, v13
    global_load_dword v18, v13, s[6:7]
    v_lshrrev_b32 v13, 6, v0
    v_and_b32 v10, 31, v0
    v_readfirstlane_b32 s48, v13
    v_bfe_u32 v9, v0, 5, 1
    v_mul_u32_u24 v14, 896, v9
    v_lshl_add_u32 v14, v10, 4, v14
    v_cmp_gt_u32 vcc, 28, v10
    v_mov_b32 v15, 268435456
    s_mov_b32 s10, 1835008
    s_mov_b32 s11, 0x20000
    v_cndmask_b32 v14, v15, v14, vcc
    s_lshr_b32 s4, s48, 1
    s_and_b32 s5, s48, 1
    s_and_b32 s3, s2, 0xfe
    s_add_u32 s3, s3, s4
    s_lshl_b32 s3, s3, 1
    s_and_b32 s60, s2, 1
    s_add_u32 s3, s3, s60
    s_lshl_b32 s3, s3, 1
    s_add_u32 s3, s3, s5
    s_mul_i32 s3, s3, 1792
    s_waitcnt lgkmcnt(0)
    buffer_load_dwordx4 v[182:185], v14, s[8:11], s3 offen
    buffer_load_dwordx4 v[186:189], v14, s[8:11], s3 offen offset:448
    v_and_b32 v1, 63, v0
    s_mov_b32 s46, 256
    s_mov_b32 s47, 0x20000
    s_lshl_b32 s3, s48, 8
    s_add_u32 s3, s3, s2
    s_cmp_lt_u32 s3, 8
    s_cselect_b32 s3, 0, 268435456
    s_or_b32 s78, s78, 1
    v_mov_b32 v234, s78
    v_mov_b32 v235, 0
    v_lshlrev_b32 v11, 25, v1
    buffer_atomic_cmpswap v[234:235], v11, s[44:47], s3 offen sc1
    s_bfe_u32 s6, s2, 0x20001
    s_and_b32 s7, s2, 1
    s_and_b32 s61, s2, 7
    s_lshr_b32 s101, s2, 3
    s_mul_i32 s52, s7, 25
    s_add_u32 s52, s52, s101
    s_mul_i32 s51, s52, 37
    s_lshr_b32 s51, s51, 8
    s_mul_i32 s3, s51, 7
    s_sub_u32 s52, s52, s3
    s_and_b32 s3, s6, 1
    s_mul_i32 s3, s3, 6
    s_add_u32 s51, s51, s3
    s_add_u32 s51, s51, 1
    s_add_u32 s3, s3, s51
    s_cmp_eq_u32 s3, 7
    s_cselect_b32 s51, 0, s51
    s_lshr_b32 s59, s6, 1
    s_lshl_b32 s51, s51, 1
    s_add_u32 s51, s51, s59
    s_max_u32 s60, s101, 25
    s_sub_u32 s60, s60, 25
    s_add_u32 s3, s101, s7
    s_cmp_lt_u32 s3, 25
    s_cselect_b32 s55, 1, 0
    s_cselect_b32 s52, s52, s60
    s_mov_b32 s22, 7340032
    s_mov_b32 s23, 0x20000
    s_lshl_b32 s3, s52, 1
    s_sub_u32 s60, s3, 7
    s_cmp_ge_u32 s3, 7
    s_cselect_b32 s3, s60, s3
    s_and_b32 s3, s3, 7
    s_mul_i32 s60, s61, 2
    s_add_u32 s3, s3, s60
    s_and_b32 s3, s3, 7
    s_mul_i32 s0, s3, 458752
    s_lshl_b32 s1, s3, 13
    s_lshl_b32 s58, s48, 12
    v_lshrrev_b32 v3, 4, v1
    v_lshrrev_b32 v5, 3, v1
    v_and_b32 v6, 7, v1
    v_lshlrev_b32 v14, 1, v3
    v_xor_b32 v14, v14, v6
    v_lshlrev_b32 v83, 4, v14
    s_cmp_eq_u32 s55, 0
    s_cbranch_scc1 L_nog1
    v_mul_u32_u24 v14, 3584, v5
    s_lshl_b32 s3, s59, 5
    s_add_u32 s3, s3, s48
    s_mul_i32 s3, s3, 114688
    s_lshl_b32 s60, s51, 7
    s_add_u32 s3, s3, s60
    v_add3_u32 v55, v14, v83, s3
    v_add_u32 v56, 56320, v55
    v_add_u32 v57, 26624, v55
    v_add_u32 v58, 82944, v55
    s_mov_b32 s38, 3584
    s_mov_b32 s39, 0x20000
    v_lshlrev_b32 v13, 3, v3
    s_lshl_b32 s3, s51, 1
    s_add_u32 s3, s3, s4
    s_lshl_b32 s3, s3, 6
    buffer_load_dwordx2 v[246:247], v13, s[36:39], s3 offen offset:0
    buffer_load_dwordx2 v[248:249], v13, s[36:39], s3 offen offset:32
    s_add_u32 m0, s58, 0
    v_xor_b32 v55, 128, v55
    buffer_load_dwordx4 v55, s[20:23], s0 offen lds
    v_xor_b32 v56, 128, v56
    buffer_load_dwordx4 v56, s[20:23], s0 offen offset:1024 lds
    v_xor_b32 v57, 128, v57
    buffer_load_dwordx4 v57, s[20:23], s0 offen offset:2048 lds
    v_xor_b32 v58, 128, v58
    buffer_load_dwordx4 v58, s[20:23], s0 offen offset:3072 lds
    s_mul_i32 s53, s101, 37
    s_lshr_b32 s53, s53, 8
    s_mul_i32 s54, s53, 7
    s_sub_u32 s54, s101, s54
    s_and_b32 s53, s53, 3
    s_xor_b32 s53, s53, 0
    s_lshl_b32 s3, s6, 2
    s_add_u32 s53, s53, s3
    s_lshl_b32 s53, s53, 1
    s_add_u32 s53, s53, s7
    s_mov_b32 s42, 4096
    s_mov_b32 s43, 0x20000
    s_lshl_b32 s3, s53, 2
    s_add_u32 s3, s3, s48
    s_lshl_b32 s60, s3, 5
    v_lshl_add_u32 v82, v5, 1, s60
    s_mul_i32 s3, s3, 14336
    s_lshl_b32 s60, s54, 7
    s_add_u32 s3, s3, s60
    v_mul_u32_u24 v14, 896, v5
    v_lshl_add_u32 v14, v6, 4, v14
    v_add_u32 v85, s3, v14
    v_add_u32 v86, 7168, v85
    s_cmp_lt_u32 s101, 28
    s_cselect_b32 s56, 1, 0
    s_lshl_b32 s50, s7, 3
    s_and_b32 s3, s101, 7
    s_add_u32 s50, s50, s3
    s_lshr_b32 s60, s101, 3
    s_lshl_b32 s49, s6, 2
    s_add_u32 s49, s49, s60
    s_lshl_b32 s49, s49, 2
    s_add_u32 s49, s49, s48
    s_mul_i32 s60, s60, 0
    s_add_u32 s3, s3, s60
    s_sub_u32 s60, s3, 7
    s_cmp_ge_u32 s3, 7
    s_cselect_b32 s3, s60, s3
    s_lshl_b32 s62, s3, 18
    s_mul_i32 s63, s3, 12288
    s_mov_b32 s30, 20971520
    s_mov_b32 s31, 0x20000
    s_mov_b32 s75, 0x3727c5ac
    s_mov_b32 s76, 0x3b124925
    s_mov_b32 s77, 0x3f803f80
    v_lshlrev_b32 v4, 4, v1
    v_bfe_u32 v7, v1, 2, 2
    v_and_b32 v8, 3, v1
    v_mul_u32_u24 v13, 960, v9
    v_lshl_add_u32 v13, v10, 4, v13
    s_mul_i32 s3, s48, 1920
    s_add_u32 s3, s3, 147456
    v_add_u32 v230, s3, v13
    v_mul_u32_u24 v13, 960, v7
    v_lshl_add_u32 v13, v3, 5, v13
    v_lshl_add_u32 v13, v8, 3, v13
    s_lshl_b32 s3, s48, 8
    s_add_u32 s3, s3, 147456
    v_add_u32 v231, s3, v13
    s_lshl_b32 s3, s48, 3
    s_add_u32 s3, s3, 155648
    v_lshl_add_u32 v232, v9, 2, s3
    v_lshlrev_b32 v237, 2, v6
    v_and_b32 v2, 15, v1
    v_lshlrev_b32 v238, 13, v3
    v_add_lshl_u32 v238, v238, v2, 3
    v_add_u32 v237, 155648, v237
    v_lshlrev_b32 v13, 17, v9
    v_lshl_add_u32 v233, v10, 4, v13
    s_cmp_eq_u32 s48, 3
    s_cselect_b32 s60, 268435456, 0
    s_lshl_b32 s70, s48, 10
    s_add_u32 s70, s70, s2
    s_lshl_b32 s70, s70, 9
    s_add_u32 s71, s70, 262144
    s_add_u32 s71, s71, s60
    s_xor_b32 s60, s60, 268435456
    s_lshl_b32 s72, s2, 7
    s_add_u32 s72, s72, s60
    s_add_u32 s72, s72, 6291456
    s_lshr_b32 s74, s2, 2
    s_lshl_b32 s74, s74, 4
    s_and_b32 s3, s2, 3
    s_add_u32 s74, s74, s3
    s_lshl_b32 s74, s74, 2
    s_add_u32 s74, s74, 10485760
    v_cmp_gt_u32 vcc, 8, v0
    v_lshlrev_b32 v236, 13, v0
    v_mov_b32 v13, 268435456
    s_and_b32 s3, s2, 7
    s_lshl_b32 s3, s3, 13
    s_add_u32 s3, s3, 10485760
    v_lshrrev_b32 v14, 2, v0
    v_lshl_add_u32 v14, v14, 6, s3
    v_and_b32 v15, 3, v0
    v_lshl_add_u32 v20, v15, 2, v14
    v_cndmask_b32 v236, v13, v236, vcc
    v_mov_b32 v16, 0
    s_lshl_b32 s3, s48, 14
    s_add_u32 s74, s74, s3
    s_add_u32 s73, s74, 8192
    s_waitcnt vmcnt(8)
    v_dot2_f32_bf16 v226, v182, s77, 0
    v_dot2_f32_bf16 v227, v182, v182, 0
    v_dot2_f32_bf16 v226, v183, s77, v226
    v_dot2_f32_bf16 v227, v183, v183, v227
    v_dot2_f32_bf16 v226, v184, s77, v226
    v_dot2_f32_bf16 v227, v184, v184, v227
    v_dot2_f32_bf16 v226, v185, s77, v226
    v_dot2_f32_bf16 v227, v185, v185, v227
    s_waitcnt vmcnt(7)
    v_dot2_f32_bf16 v226, v186, s77, v226
    v_dot2_f32_bf16 v227, v186, v186, v227
    v_dot2_f32_bf16 v226, v187, s77, v226
    v_dot2_f32_bf16 v227, v187, v187, v227
    v_dot2_f32_bf16 v226, v188, s77, v226
    v_dot2_f32_bf16 v227, v188, v188, v227
    v_dot2_f32_bf16 v226, v189, s77, v226
    v_dot2_f32_bf16 v227, v189, v189, v227
    buffer_load_dword v12, v16, s[44:47], 0 offen sc1
    v_lshlrev_b32 v190, 16, v182
    v_and_b32 v191, 0xffff0000, v182
    v_add_f32_dpp v226, v226, v226 quad_perm:[1,0,3,2] row_mask:0xf bank_mask:0xf
    v_add_f32_dpp v227, v227, v227 quad_perm:[1,0,3,2] row_mask:0xf bank_mask:0xf
    v_lshlrev_b32 v192, 16, v183
    v_add_f32_dpp v226, v226, v226 quad_perm:[2,3,0,1] row_mask:0xf bank_mask:0xf
    v_add_f32_dpp v227, v227, v227 quad_perm:[2,3,0,1] row_mask:0xf bank_mask:0xf
    v_and_b32 v193, 0xffff0000, v183
    v_add_f32_dpp v226, v226, v226 row_half_mirror row_mask:0xf bank_mask:0xf
    v_add_f32_dpp v227, v227, v227 row_half_mirror row_mask:0xf bank_mask:0xf
    v_lshlrev_b32 v194, 16, v184
    v_add_f32_dpp v226, v226, v226 row_mirror row_mask:0xf bank_mask:0xf
    v_add_f32_dpp v227, v227, v227 row_mirror row_mask:0xf bank_mask:0xf
    v_and_b32 v195, 0xffff0000, v184
    v_mov_b32 v228, v226
    v_mov_b32 v229, v227
    v_lshlrev_b32 v196, 16, v185
    v_permlane16_swap_b32 v226, v228
    v_permlane16_swap_b32 v227, v229
    v_add_f32 v226, v226, v228
    v_add_f32 v227, v227, v229
    v_mul_f32_e64 v226, -v226, s76
    v_mul_f32 v228, v226, v226
    v_fma_f32 v227, v227, s76, -v228
    v_max_f32 v227, 0, v227
    v_add_f32 v228, s75, v227
    v_rsq_f32 v222, v228
    v_and_b32 v197, 0xffff0000, v185
    v_mul_f32 v228, v222, v222
    v_fma_f32 v229, v228, v227, s75
    v_rsq_f32 v228, v229
    v_mul_f32 v223, v226, v222
    v_mul_f32 v224, v222, v228
    v_mul_f32 v225, v223, v228
    v_mul_f32 v229, v229, v228
    ds_write_b32 v232, v229
    v_lshlrev_b32 v198, 16, v186
    v_and_b32 v199, 0xffff0000, v186
    v_lshlrev_b32 v200, 16, v187
    v_and_b32 v201, 0xffff0000, v187
    v_lshlrev_b32 v202, 16, v188
    v_and_b32 v203, 0xffff0000, v188
    v_lshlrev_b32 v204, 16, v189
    v_and_b32 v205, 0xffff0000, v189
    v_pk_fma_f32 v[206:207], v[190:191], v[224:225], v[224:225] op_sel:[0,0,1] op_sel_hi:[1,0,1]
    v_pk_fma_f32 v[208:209], v[192:193], v[224:225], v[224:225] op_sel:[0,0,1] op_sel_hi:[1,0,1]
    v_pk_fma_f32 v[210:211], v[194:195], v[224:225], v[224:225] op_sel:[0,0,1] op_sel_hi:[1,0,1]
    v_pk_fma_f32 v[212:213], v[196:197], v[224:225], v[224:225] op_sel:[0,0,1] op_sel_hi:[1,0,1]
    v_cvt_pk_bf16_f32 v182, v206, v207
    v_cvt_pk_bf16_f32 v183, v208, v209
    v_cvt_pk_bf16_f32 v184, v210, v211
    v_cvt_pk_bf16_f32 v185, v212, v213
    ds_write_b128 v230, v[182:185] offset:0
    v_pk_fma_f32 v[214:215], v[198:199], v[224:225], v[224:225] op_sel:[0,0,1] op_sel_hi:[1,0,1]
    v_pk_fma_f32 v[216:217], v[200:201], v[224:225], v[224:225] op_sel:[0,0,1] op_sel_hi:[1,0,1]
    v_pk_fma_f32 v[218:219], v[202:203], v[224:225], v[224:225] op_sel:[0,0,1] op_sel_hi:[1,0,1]
    v_pk_fma_f32 v[220:221], v[204:205], v[224:225], v[224:225] op_sel:[0,0,1] op_sel_hi:[1,0,1]
    v_cvt_pk_bf16_f32 v186, v214, v215
    v_cvt_pk_bf16_f32 v187, v216, v217
    v_cvt_pk_bf16_f32 v188, v218, v219
    v_cvt_pk_bf16_f32 v189, v220, v221
    ds_write_b128 v230, v[186:189] offset:448
    s_waitcnt lgkmcnt(0)
    s_barrier
    ds_read_b64_tr_b16 v[110:111], v231 offset:0
    ds_read_b64_tr_b16 v[112:113], v231 offset:3840
    ds_read_b64_tr_b16 v[114:115], v231 offset:128
    ds_read_b64_tr_b16 v[116:117], v231 offset:3968
    ds_read_b32 v229, v237
    s_waitcnt lgkmcnt(3)
    buffer_store_dwordx4 v[110:113], v233, s[28:31], s70 offen sc1
    s_waitcnt lgkmcnt(1)
    buffer_store_dwordx4 v[114:117], v233, s[28:31], s71 offen sc1
    v_cmp_gt_u32 vcc, 16, v1
    s_waitcnt lgkmcnt(0)
    s_nop 0
    v_cndmask_b32 v229, 0, v229, vcc
    v_mov_b32 v228, v229
    buffer_store_dwordx2 v[228:229], v238, s[28:31], s72 offen sc1
    s_add_u32 m0, s58, 16384
    s_add_u32 s0, s0, 458752
    s_cmp_eq_u32 s0, 3670016
    s_cselect_b32 s0, 0, s0
    buffer_load_dwordx4 v55, s[20:23], s0 offen lds
    buffer_load_dwordx4 v56, s[20:23], s0 offen offset:1024 lds
    buffer_load_dwordx4 v57, s[20:23], s0 offen offset:2048 lds
    buffer_load_dwordx4 v58, s[20:23], s0 offen offset:3072 lds
    s_branch L_anchor
.p2align 12
L_anchor:
    s_mov_b32 s18, 401408
    s_mov_b32 s19, 0x20000
    s_mov_b32 s26, 7340032
    s_mov_b32 s27, 0x20000
    s_mov_b32 s34, 1835008
    s_mov_b32 s35, 0x20000
    s_mov_b32 s36, 1
    v_lshrrev_b32 v14, 2, v1
    v_lshlrev_b32 v14, 7, v14
    v_lshl_add_u32 v14, v8, 3, v14
    v_and_b32 v15, 3, v5
    v_lshl_add_u32 v14, v15, 5, v14
    s_mul_i32 s3, s4, 8256
    v_xor_b32 v31, s3, v14
    v_xor_b32 v32, 32, v31
    v_xor_b32 v33, 64, v31
    v_xor_b32 v34, 96, v31
    v_add_u32 v35, 65536, v31
    v_add_u32 v36, 65536, v32
    v_add_u32 v37, 65536, v33
    v_add_u32 v38, 65536, v34
    v_add_u32 v39, 131072, v31
    v_add_u32 v40, 131072, v32
    v_add_u32 v41, 131072, v33
    v_add_u32 v42, 131072, v34
    s_lshl_b32 s6, s52, 1
    s_add_u32 s6, s6, s5
    s_lshl_b32 s3, s6, 1
    s_add_u32 s3, s3, s59
    s_lshl_b32 s3, s3, 4
    s_add_u32 s3, s3, s4
    s_lshl_b32 s3, s3, 12
    v_lshl_add_u32 v78, v3, 8, v4
    v_add_u32 v78, s3, v78
    s_xor_b32 s37, s51, 1
    s_lshl_b32 s37, s37, 3
    s_add_u32 s37, s37, s52
    s_lshl_b32 s3, s37, 14
    s_add_u32 s3, s3, s58
    s_add_u32 s3, s3, 16777216
    v_add_u32 v23, s3, v4
    s_lshl_b32 s37, s37, 5
    s_add_u32 s37, s37, s5
    s_lshl_b32 s37, s37, 2
    s_add_u32 s37, s37, 6422528
    s_mul_i32 s67, s6, 56
    s_lshl_b32 s3, s51, 1
    s_add_u32 s3, s3, s4
    s_add_u32 s67, s67, s3
    s_lshl_b32 s67, s67, 11
    s_add_u32 s67, s67, 2097152
    v_add_u32 v81, s58, v4
    s_lshl_b32 s68, s52, 2
    s_and_b32 s3, s51, 1
    s_add_u32 s68, s68, s3
    s_cmp_ge_u32 s51, 14
    s_cselect_b32 s3, 2, 0
    s_add_u32 s68, s68, s3
    s_lshl_b32 s68, s68, 7
    s_add_u32 s68, s68, 6356992
    s_waitcnt vmcnt(7)
    v_readfirstlane_b32 s57, v12
    s_mov_b32 s60, 0
    s_cmp_lg_u32 s57, 0
    s_cbranch_scc0 L_nonce
L_nonce_ok:
    s_waitcnt vmcnt(4)
    s_barrier
    s_atomic_swap s57, s[28:29], s74
    s_atomic_swap s57, s[28:29], s73
    buffer_load_dwordx4 v[96:99], v85, s[8:11], 0 offen
    buffer_load_ushort v93, v82, s[40:43], 0 offen offset:0
    buffer_load_dwordx4 v[100:103], v86, s[8:11], 0 offen
    buffer_load_ushort v94, v82, s[40:43], 0 offen offset:16
    v_add_u32 v53, 65536, v4
    s_add_u32 m0, s58, 32768
    s_add_u32 s0, s0, 458752
    s_cmp_eq_u32 s0, 3670016
    s_cselect_b32 s0, 0, s0
    buffer_load_dwordx4 v55, s[20:23], s0 offen lds
    v_add_u32 v54, 131072, v4
    s_mul_i32 s59, s48, 3072
    s_mul_i32 s3, s50, 86016
    s_add_u32 s3, s3, s59
    s_add_u32 s3, s3, 8388608
    v_add_u32 v80, s3, v4
    v_lshlrev_b32 v14, 7, v9
    v_xor_b32 v14, v14, v4
    s_lshl_b32 s3, s49, 11
    v_add_u32 v67, s3, v14
    v_add_u32 v68, 129024, v67
    s_lshr_b32 s3, s49, 2
    s_lshl_b32 s3, s3, 3
    s_max_u32 s3, s3, 1
    s_sub_u32 s3, s3, 1
    s_lshl_b32 s3, s3, 10
    s_lshl_b32 s6, s5, 17
    s_add_u32 s3, s3, s6
    s_lshl_b32 s6, s4, 28
    s_add_u32 s3, s3, s6
    v_add_u32 v69, s3, v14
    buffer_load_dwordx4 v56, s[20:23], s0 offen offset:1024 lds
    s_lshl_b32 s100, s5, 1
    s_add_u32 s100, s100, s4
    s_lshl_b32 s100, s100, 10
    v_and_b32 v14, 1, v1
    v_mul_u32_u24 v14, 640, v14
    v_lshrrev_b32 v15, 2, v1
    v_lshlrev_b32 v15, 4, v15
    v_xor_b32 v14, v14, v15
    v_bfe_u32 v15, v1, 1, 1
    v_lshl_add_u32 v14, v15, 3, v14
    buffer_load_dwordx4 v57, s[20:23], s0 offen offset:2048 lds
    s_add_u32 s3, s58, 12288
    v_add_u32 v70, s3, v14
    s_sub_u32 s3, s3, 3072
    s_cmp_eq_u32 s48, 0
    s_cselect_b32 s3, 28672, s3
    v_add_u32 v71, s3, v14
    v_add_u32 v72, 65536, v70
    v_add_u32 v73, 65536, v71
    v_add_u32 v74, 131072, v70
    v_add_u32 v75, 131072, v71
    s_lshl_b32 s3, s49, 1
    v_min_u32 v14, 2, v3
    v_add_u32 v14, s3, v14
    v_max_u32 v14, 1, v14
    v_lshlrev_b32 v14, 1, v14
    v_and_b32 v15, 1, v7
    buffer_load_dwordx4 v58, s[20:23], s0 offen offset:3072 lds
    v_add_lshl_u32 v14, v14, v15, 7
    v_lshrrev_b32 v15, 1, v7
    v_lshl_add_u32 v15, v15, 2, v8
    v_lshl_add_u32 v14, v15, 3, v14
    v_add_u32 v77, 6291200, v14
    s_min_u32 s15, s48, 2
    s_lshl_b32 s15, s15, 6
    s_add_u32 s15, s15, 64
    s_lshl_b32 s82, s49, 5
    s_add_u32 s82, s82, s50
    s_lshl_b32 s82, s82, 10
    s_add_u32 s82, s82, 4194304
    s_lshr_b32 s69, s49, 2
    s_lshl_b32 s69, s69, 1
    s_and_b32 s3, s50, 1
    s_add_u32 s69, s69, s3
    s_lshl_b32 s69, s69, 7
    s_add_u32 s69, s69, 6361088
    s_and_b32 s7, s53, 1
    s_mul_i32 s3, s7, 28
    s_add_u32 s3, s3, s48
    s_lshl_b32 s3, s3, 17
    s_xor_b32 s6, s53, 1
    s_lshl_b32 s55, s6, 3
    s_lshl_b32 s6, s53, 7
    s_add_u32 s3, s3, s6
    v_lshlrev_b32 v14, 12, v5
    s_add_u32 m0, s58, 49152
    s_add_u32 s0, s0, 458752
    s_cmp_eq_u32 s0, 3670016
    s_cselect_b32 s0, 0, s0
    buffer_load_dwordx4 v55, s[20:23], s0 offen lds
    v_add3_u32 v59, v14, v83, s3
    v_add_u32 v60, 31744, v59
    v_add_u32 v61, 63488, v59
    v_add_u32 v62, 95232, v59
    v_mul_u32_u24 v14, 896, v5
    s_mul_i32 s3, s4, 25088
    s_mul_i32 s6, s5, 14336
    s_add_u32 s3, s3, s6
    s_lshl_b32 s6, s54, 7
    s_add_u32 s3, s3, s6
    v_add3_u32 v63, v14, v83, s3
    buffer_load_dwordx4 v56, s[20:23], s0 offen offset:1024 lds
    v_add_u32 v64, 6144, v63
    s_lshl_b32 s6, s53, 1
    s_add_u32 s6, s6, s5
    s_and_b32 s3, s53, 30
    s_add_u32 s3, s3, s4
    s_lshl_b32 s3, s3, 7
    s_add_u32 s39, s3, 6361088
    s_lshl_b32 s3, s6, 5
    s_add_u32 s3, s3, s4
    s_lshl_b32 s3, s3, 10
    s_add_u32 s3, s3, 4194304
    v_add_u32 v65, s3, v4
    v_add_u32 v66, 15360, v65
    s_xor_b32 s3, s4, s5
    s_lshl_b32 s3, s3, 6
    v_xor_b32 v43, s3, v31
    buffer_load_dwordx4 v57, s[20:23], s0 offen offset:2048 lds
    v_xor_b32 v44, 32, v43
    v_add_u32 v45, 65536, v43
    v_add_u32 v46, 65536, v44
    s_mul_i32 s3, s4, 12288
    v_add_u32 v47, s3, v4
    v_xor_b32 v48, 4096, v47
    v_add_u32 v49, 65536, v47
    v_add_u32 v50, 65536, v48
    v_add_u32 v51, 131072, v47
    v_add_u32 v52, 131072, v48
    s_lshl_b32 s6, s54, 1
    s_add_u32 s6, s6, s5
    s_lshl_b32 s3, s6, 1
    s_add_u32 s3, s3, s7
    s_mul_i32 s3, s3, 14
    s_add_u32 s3, s3, s4
    s_lshl_b32 s3, s3, 12
    s_add_u32 s3, s3, 2097152
    v_add_u32 v79, s3, v4
    buffer_load_dwordx4 v58, s[20:23], s0 offen offset:3072 lds
    s_lshl_b32 s3, s54, 1
    s_add_u32 s3, s3, s7
    s_lshl_b32 s3, s3, 1
    s_add_u32 s3, s3, s4
    s_lshl_b32 s3, s3, 7
    s_add_u32 s38, s3, 6356992
    s_and_b32 s3, s2, 6
    s_add_u32 s3, s3, s54
    s_sub_u32 s6, s3, 7
    s_cmp_ge_u32 s3, 7
    s_cselect_b32 s3, s6, s3
    s_lshl_b32 s64, s3, 19
    s_lshl_b32 s65, s3, 13
    s_add_u32 s55, s55, s54
    s_lshl_b32 s3, s55, 14
    s_add_u32 s3, s3, s58
    s_add_u32 s3, s3, 12582912
    v_add_u32 v21, s3, v4
    s_add_u32 m0, s58, 65536
    s_add_u32 s0, s0, 458752
    s_cmp_eq_u32 s0, 3670016
    s_cselect_b32 s0, 0, s0
    buffer_load_dwordx4 v55, s[20:23], s0 offen lds
    s_lshl_b32 s55, s55, 5
    s_add_u32 s55, s55, s48
    s_lshl_b32 s55, s55, 2
    s_add_u32 s55, s55, 6488064
    s_lshl_b32 s3, s5, 3
    v_add_u32 v13, s3, v3
    v_xor_b32 v13, v13, v6
    v_lshlrev_b32 v13, 4, v13
    v_lshl_add_u32 v13, v2, 8, v13
    buffer_load_dwordx4 v56, s[20:23], s0 offen offset:1024 lds
    s_lshl_b32 s3, s4, 14
    s_add_u32 s3, s3, 32768
    v_add_u32 v87, s3, v13
    v_xor_b32 v88, 64, v87
    s_lshr_b32 s3, s53, 1
    s_add_u32 s66, s3, s54
    s_mov_b32 s51, s66
    v_lshlrev_b32 v13, 1, v6
    v_xor_b32 v13, v13, v5
    v_lshlrev_b32 v13, 4, v13
    v_lshl_add_u32 v13, v5, 8, v13
    s_add_u32 s3, s58, 32768
    v_add_u32 v89, s3, v13
    v_xor_b32 v90, 16, v89
    v_xor_b32 v91, 24576, v89
    v_xor_b32 v92, 24592, v89
    buffer_load_dwordx4 v57, s[20:23], s0 offen offset:2048 lds
    v_lshlrev_b32 v150, 16, v246
    v_and_b32 v151, 0xffff0000, v246
    v_lshlrev_b32 v152, 16, v247
    v_and_b32 v153, 0xffff0000, v247
    v_lshlrev_b32 v154, 16, v248
    v_and_b32 v155, 0xffff0000, v248
    v_lshlrev_b32 v156, 16, v249
    v_and_b32 v157, 0xffff0000, v249
    v_lshlrev_b32 v158, 16, v246
    v_and_b32 v159, 0xffff0000, v246
    v_lshlrev_b32 v160, 16, v247
    v_and_b32 v161, 0xffff0000, v247
    v_lshlrev_b32 v162, 16, v248
    v_and_b32 v163, 0xffff0000, v248
    v_lshlrev_b32 v164, 16, v249
    v_and_b32 v165, 0xffff0000, v249
    buffer_load_dwordx4 v58, s[20:23], s0 offen offset:3072 lds
    s_add_u32 m0, s58, 81920
    s_add_u32 s0, s0, 458752
    s_cmp_eq_u32 s0, 3670016
    s_cselect_b32 s0, 0, s0
    buffer_load_dwordx4 v55, s[20:23], s0 offen lds
    buffer_load_dwordx4 v56, s[20:23], s0 offen offset:1024 lds
    buffer_load_dwordx4 v57, s[20:23], s0 offen offset:2048 lds
    buffer_load_dwordx4 v58, s[20:23], s0 offen offset:3072 lds
    s_add_u32 m0, s58, 98304
    s_add_u32 s0, s0, 458752
    s_cmp_eq_u32 s0, 3670016
    s_cselect_b32 s0, 0, s0
    buffer_load_dwordx4 v55, s[20:23], s0 offen lds
    buffer_load_dwordx4 v56, s[20:23], s0 offen offset:1024 lds
    buffer_load_dwordx4 v57, s[20:23], s0 offen offset:2048 lds
    buffer_load_dwordx4 v58, s[20:23], s0 offen offset:3072 lds
    buffer_load_dword v18, v20, s[28:31], 0 offen sc1
    s_add_u32 m0, s58, 114688
    s_add_u32 s0, s0, 458752
    s_cmp_eq_u32 s0, 3670016
    s_cselect_b32 s0, 0, s0
    buffer_load_dwordx4 v55, s[20:23], s0 offen lds
    buffer_load_dwordx4 v56, s[20:23], s0 offen offset:1024 lds
    buffer_load_dwordx4 v57, s[20:23], s0 offen offset:2048 lds
    buffer_load_dwordx4 v58, s[20:23], s0 offen offset:3072 lds
    s_mov_b32 s3, s48
    s_mov_b64 exec, 0
L_warm:
    s_add_u32 s3, s3, 4
    s_cmp_eq_u32 s3, 4
    s_cbranch_scc1 L_pad0
    s_cmp_eq_u32 s3, 5
    s_cbranch_scc1 L_pad1
    s_cmp_eq_u32 s3, 6
    s_cbranch_scc1 L_pad2
    s_cmp_eq_u32 s3, 7
    s_cbranch_scc1 L_pad3
    s_cmp_eq_u32 s3, 8
    s_cbranch_scc1 L_pad4
    s_mov_b64 exec, -1
    s_waitcnt vmcnt(4)
    v_cmp_ne_u32 vcc, s57, v18
    s_cbranch_vccnz L_pollin0
L_pollok0:
    s_barrier
    buffer_load_dwordx4 a[0:3], v78, s[28:31], s1 offen offset:0 sc1
    buffer_load_dwordx4 a[4:7], v78, s[28:31], s1 offen offset:256 sc1
    buffer_load_dwordx4 a[8:11], v78, s[28:31], s1 offen offset:2048 sc1
    buffer_load_dwordx4 a[12:15], v78, s[28:31], s1 offen offset:2304 sc1
    buffer_load_dword v76, v77, s[28:31], 0 offen sc1
    s_add_u32 s1, s1, 8192
    s_and_b32 s1, s1, 0xffff
    buffer_load_dwordx4 a[16:19], v78, s[28:31], s1 offen offset:0 sc1
    buffer_load_dwordx4 a[20:23], v78, s[28:31], s1 offen offset:256 sc1
    buffer_load_dwordx4 a[24:27], v78, s[28:31], s1 offen offset:2048 sc1
    buffer_load_dwordx4 a[28:31], v78, s[28:31], s1 offen offset:2304 sc1
    s_add_u32 s1, s1, 8192
    s_and_b32 s1, s1, 0xffff
    buffer_load_dwordx4 a[32:35], v78, s[28:31], s1 offen offset:0 sc1
    buffer_load_dwordx4 a[36:39], v78, s[28:31], s1 offen offset:256 sc1
    buffer_load_dwordx4 a[40:43], v78, s[28:31], s1 offen offset:2048 sc1
    buffer_load_dwordx4 a[44:47], v78, s[28:31], s1 offen offset:2304 sc1
    ds_read_b64_tr_b16 a[200:201], v31 offset:0
    ds_read_b64_tr_b16 a[202:203], v31 offset:2048
    ds_read_b64_tr_b16 a[204:205], v33 offset:0
    ds_read_b64_tr_b16 a[206:207], v33 offset:2048
    ds_read_b64_tr_b16 a[208:209], v32 offset:0
    ds_read_b64_tr_b16 a[210:211], v32 offset:2048
    ds_read_b64_tr_b16 a[212:213], v34 offset:0
    ds_read_b64_tr_b16 a[214:215], v34 offset:2048
    ds_read_b64_tr_b16 a[216:217], v31 offset:4096
    ds_read_b64_tr_b16 a[218:219], v31 offset:6144
    ds_read_b64_tr_b16 a[220:221], v33 offset:4096
    ds_read_b64_tr_b16 a[222:223], v33 offset:6144
    s_waitcnt vmcnt(11) lgkmcnt(8)
    v_mfma_f32_16x16x32_bf16 v[182:185], a[200:203], a[0:3], 0
    ds_read_b64_tr_b16 a[224:225], v32 offset:4096
    s_add_u32 s1, s1, 8192
    v_mfma_f32_16x16x32_bf16 v[190:193], a[200:203], a[4:7], 0
    ds_read_b64_tr_b16 a[226:227], v32 offset:6144
    s_and_b32 s1, s1, 0xffff
    s_mov_b32 s70, 0xaaaaaaaa
    s_mov_b32 s71, 0xaaaaaaaa
    s_mov_b32 s72, 0xfff0ffff
    s_mov_b32 s73, 0xf000ff00
    s_mov_b32 s74, 0xffc0fffc
    v_mfma_f32_16x16x32_bf16 v[198:201], a[204:207], a[0:3], 0
    ds_read_b64_tr_b16 a[228:229], v34 offset:4096
    buffer_load_dwordx4 a[48:51], v78, s[28:31], s1 offen offset:0 sc1
    v_mfma_f32_16x16x32_bf16 v[206:209], a[204:207], a[4:7], 0
    ds_read_b64_tr_b16 a[230:231], v34 offset:6144
    s_mov_b32 s75, 0xc000fc00
    s_waitcnt lgkmcnt(8)
    v_mfma_f32_16x16x32_bf16 v[186:189], a[208:211], a[0:3], 0
    ds_read_b64_tr_b16 a[200:201], v31 offset:16384
    s_mov_b32 s83, 0x3e8b97f6
    v_mfma_f32_16x16x32_bf16 v[194:197], a[208:211], a[4:7], 0
    ds_read_b64_tr_b16 a[202:203], v31 offset:18432
    buffer_load_dwordx4 a[52:55], v78, s[28:31], s1 offen offset:256 sc1
    v_lshlrev_b32 v13, 2, v2
    v_mfma_f32_16x16x32_bf16 v[202:205], a[212:215], a[0:3], 0
    ds_read_b64_tr_b16 a[204:205], v33 offset:16384
    v_and_b32 v14, 1, v1
    v_mfma_f32_16x16x32_bf16 v[210:213], a[212:215], a[4:7], 0
    ds_read_b64_tr_b16 a[206:207], v33 offset:18432
    s_waitcnt vmcnt(11) lgkmcnt(8)
    v_mfma_f32_16x16x32_bf16 v[182:185], a[216:219], a[8:11], v[182:185]
    ds_read_b64_tr_b16 a[208:209], v32 offset:16384
    buffer_load_dwordx4 a[56:59], v78, s[28:31], s1 offen offset:2048 sc1
    v_mfma_f32_16x16x32_bf16 v[190:193], a[216:219], a[12:15], v[190:193]
    ds_read_b64_tr_b16 a[210:211], v32 offset:18432
    v_lshl_add_u32 v14, v3, 2, v14
    v_mfma_f32_16x16x32_bf16 v[198:201], a[220:223], a[8:11], v[198:201]
    ds_read_b64_tr_b16 a[212:213], v34 offset:16384
    v_lshlrev_b32 v14, 2, v14
    v_mfma_f32_16x16x32_bf16 v[206:209], a[220:223], a[12:15], v[206:209]
    ds_read_b64_tr_b16 a[214:215], v34 offset:18432
    s_waitcnt lgkmcnt(8)
    v_mfma_f32_16x16x32_bf16 v[186:189], a[224:227], a[8:11], v[186:189]
    ds_read_b64_tr_b16 a[216:217], v31 offset:20480
    buffer_load_dwordx4 a[60:63], v78, s[28:31], s1 offen offset:2304 sc1
    v_mfma_f32_16x16x32_bf16 v[194:197], a[224:227], a[12:15], v[194:197]
    ds_read_b64_tr_b16 a[218:219], v31 offset:22528
    s_add_u32 s1, s1, 8192
    v_add_u32 v15, 64, v14
    v_mfma_f32_16x16x32_bf16 v[202:205], a[228:231], a[8:11], v[202:205]
    ds_read_b64_tr_b16 a[220:221], v33 offset:20480
    s_and_b32 s1, s1, 0xffff
    v_mfma_f32_16x16x32_bf16 v[210:213], a[228:231], a[12:15], v[210:213]
    ds_read_b64_tr_b16 a[222:223], v33 offset:22528
    s_waitcnt vmcnt(10) lgkmcnt(8)
    v_mfma_f32_16x16x32_bf16 v[182:185], a[200:203], a[16:19], v[182:185]
    ds_read_b64_tr_b16 a[224:225], v32 offset:20480
    buffer_load_dwordx4 a[64:67], v78, s[28:31], s1 offen offset:0 sc1
    v_mfma_f32_16x16x32_bf16 v[190:193], a[200:203], a[20:23], v[190:193]
    ds_read_b64_tr_b16 a[226:227], v32 offset:22528
    v_cndmask_b32 v16, v14, v15, s[72:73]
    v_mfma_f32_16x16x32_bf16 v[198:201], a[204:207], a[16:19], v[198:201]
    ds_read_b64_tr_b16 a[228:229], v34 offset:20480
    buffer_load_dwordx4 a[68:71], v78, s[28:31], s1 offen offset:256 sc1
    v_mfma_f32_16x16x32_bf16 v[206:209], a[204:207], a[20:23], v[206:209]
    ds_read_b64_tr_b16 a[230:231], v34 offset:22528
    v_cndmask_b32 v14, v14, v15, s[74:75]
    s_waitcnt lgkmcnt(8)
    v_mfma_f32_16x16x32_bf16 v[186:189], a[208:211], a[16:19], v[186:189]
    ds_read_b64_tr_b16 a[200:201], v31 offset:32768
    ds_bpermute_b32 v25, v13, v76 offset:64
    v_mfma_f32_16x16x32_bf16 v[194:197], a[208:211], a[20:23], v[194:197]
    ds_read_b64_tr_b16 a[202:203], v31 offset:34816
    buffer_load_dwordx4 a[72:75], v78, s[28:31], s1 offen offset:2048 sc1
    ds_bpermute_b32 v27, v16, v76 offset:0
    v_mfma_f32_16x16x32_bf16 v[202:205], a[212:215], a[16:19], v[202:205]
    ds_read_b64_tr_b16 a[204:205], v33 offset:32768
    ds_bpermute_b32 v28, v14, v76 offset:8
    v_mfma_f32_16x16x32_bf16 v[210:213], a[212:215], a[20:23], v[210:213]
    ds_read_b64_tr_b16 a[206:207], v33 offset:34816
    s_waitcnt vmcnt(11) lgkmcnt(11)
    v_mfma_f32_16x16x32_bf16 v[182:185], a[216:219], a[24:27], v[182:185]
    ds_read_b64_tr_b16 a[208:209], v32 offset:32768
    ds_bpermute_b32 v26, v13, v76 offset:128
    v_mfma_f32_16x16x32_bf16 v[190:193], a[216:219], a[28:31], v[190:193]
    ds_read_b64_tr_b16 a[210:211], v32 offset:34816
    buffer_load_dwordx4 a[76:79], v78, s[28:31], s1 offen offset:2304 sc1
    ds_bpermute_b32 v29, v16, v76 offset:64
    v_mfma_f32_16x16x32_bf16 v[198:201], a[220:223], a[24:27], v[198:201]
    ds_read_b64_tr_b16 a[212:213], v34 offset:32768
    s_add_u32 s1, s1, 8192
    v_mfma_f32_16x16x32_bf16 v[206:209], a[220:223], a[28:31], v[206:209]
    ds_read_b64_tr_b16 a[214:215], v34 offset:34816
    s_waitcnt lgkmcnt(13)
    v_mfma_f32_16x16x32_bf16 v[186:189], a[224:227], a[24:27], v[186:189]
    ds_read_b64_tr_b16 a[216:217], v31 offset:36864
    s_and_b32 s1, s1, 0xffff
    v_mfma_f32_16x16x32_bf16 v[194:197], a[224:227], a[28:31], v[194:197]
    ds_read_b64_tr_b16 a[218:219], v31 offset:38912
    buffer_load_dwordx4 a[80:83], v78, s[28:31], s1 offen offset:0 sc1
    ds_bpermute_b32 v30, v14, v76 offset:72
    v_mfma_f32_16x16x32_bf16 v[202:205], a[228:231], a[24:27], v[202:205]
    ds_read_b64_tr_b16 a[220:221], v33 offset:36864
    v_mfma_f32_16x16x32_bf16 v[210:213], a[228:231], a[28:31], v[210:213]
    ds_read_b64_tr_b16 a[222:223], v33 offset:38912
    s_waitcnt vmcnt(11) lgkmcnt(11)
    v_mfma_f32_16x16x32_bf16 v[182:185], a[200:203], a[32:35], v[182:185]
    ds_read_b64_tr_b16 a[224:225], v32 offset:36864
    buffer_load_dwordx4 a[84:87], v78, s[28:31], s1 offen offset:256 sc1
    v_mfma_f32_16x16x32_bf16 v[190:193], a[200:203], a[36:39], v[190:193]
    ds_read_b64_tr_b16 a[226:227], v32 offset:38912
    v_mfma_f32_16x16x32_bf16 v[198:201], a[204:207], a[32:35], v[198:201]
    ds_read_b64_tr_b16 a[228:229], v34 offset:36864
    v_mfma_f32_16x16x32_bf16 v[206:209], a[204:207], a[36:39], v[206:209]
    ds_read_b64_tr_b16 a[230:231], v34 offset:38912
    s_waitcnt lgkmcnt(9)
    v_mfma_f32_16x16x32_bf16 v[186:189], a[208:211], a[32:35], v[186:189]
    s_barrier
    ds_read_b64_tr_b16 a[200:201], v31 offset:49152
    buffer_load_dwordx4 a[88:91], v78, s[28:31], s1 offen offset:2048 sc1
    v_mfma_f32_16x16x32_bf16 v[194:197], a[208:211], a[36:39], v[194:197]
    ds_read_b64_tr_b16 a[202:203], v31 offset:51200
    v_mfma_f32_16x16x32_bf16 v[202:205], a[212:215], a[32:35], v[202:205]
    ds_read_b64_tr_b16 a[204:205], v33 offset:49152
    buffer_load_dwordx4 a[92:95], v78, s[28:31], s1 offen offset:2304 sc1
    v_mfma_f32_16x16x32_bf16 v[210:213], a[212:215], a[36:39], v[210:213]
    ds_read_b64_tr_b16 a[206:207], v33 offset:51200
    s_waitcnt vmcnt(12) lgkmcnt(8)
    v_mfma_f32_16x16x32_bf16 v[182:185], a[216:219], a[40:43], v[182:185]
    ds_read_b64_tr_b16 a[208:209], v32 offset:49152
    s_add_u32 m0, s58, 131072
    v_mfma_f32_16x16x32_bf16 v[190:193], a[216:219], a[44:47], v[190:193]
    ds_read_b64_tr_b16 a[210:211], v32 offset:51200
    s_add_u32 s0, s0, 458752
    v_mul_f32 v25, s83, v25
    v_mfma_f32_16x16x32_bf16 v[198:201], a[220:223], a[40:43], v[198:201]
    ds_read_b64_tr_b16 a[212:213], v34 offset:49152
    s_cmp_eq_u32 s0, 3670016
    v_mfma_f32_16x16x32_bf16 v[206:209], a[220:223], a[44:47], v[206:209]
    ds_read_b64_tr_b16 a[214:215], v34 offset:51200
    s_cselect_b32 s0, 0, s0
    v_xor_b32 v55, 128, v55
    buffer_load_dwordx4 v55, s[20:23], s0 offen lds
    s_waitcnt lgkmcnt(8)
    v_mfma_f32_16x16x32_bf16 v[186:189], a[224:227], a[40:43], v[186:189]
    ds_read_b64_tr_b16 a[216:217], v31 offset:53248
    v_xor_b32 v56, 128, v56
    v_mfma_f32_16x16x32_bf16 v[194:197], a[224:227], a[44:47], v[194:197]
    ds_read_b64_tr_b16 a[218:219], v31 offset:55296
    buffer_load_dwordx4 v56, s[20:23], s0 offen offset:1024 lds
    v_mul_f32 v26, s83, v26
    v_mfma_f32_16x16x32_bf16 v[202:205], a[228:231], a[40:43], v[202:205]
    ds_read_b64_tr_b16 a[220:221], v33 offset:53248
    v_xor_b32 v57, 128, v57
    v_mfma_f32_16x16x32_bf16 v[210:213], a[228:231], a[44:47], v[210:213]
    ds_read_b64_tr_b16 a[222:223], v33 offset:55296
    s_waitcnt vmcnt(12) lgkmcnt(8)
    v_mfma_f32_16x16x32_bf16 v[182:185], a[200:203], a[48:51], v[182:185]
    ds_read_b64_tr_b16 a[224:225], v32 offset:53248
    buffer_load_dwordx4 v57, s[20:23], s0 offen offset:2048 lds
    v_mfma_f32_16x16x32_bf16 v[190:193], a[200:203], a[52:55], v[190:193]
    ds_read_b64_tr_b16 a[226:227], v32 offset:55296
    v_xor_b32 v58, 128, v58
    s_cmp_eq_u32 s49, 0
    s_cselect_b64 s[76:77], 0, -1
    v_mfma_f32_16x16x32_bf16 v[198:201], a[204:207], a[48:51], v[198:201]
    ds_read_b64_tr_b16 a[228:229], v34 offset:53248
    v_mov_b32 v13, 0xffff
    v_mfma_f32_16x16x32_bf16 v[206:209], a[204:207], a[52:55], v[206:209]
    ds_read_b64_tr_b16 a[230:231], v34 offset:55296
    s_waitcnt lgkmcnt(8)
    v_mfma_f32_16x16x32_bf16 v[186:189], a[208:211], a[48:51], v[186:189]
    ds_read_b64_tr_b16 a[200:201], v35 offset:0
    buffer_load_dwordx4 v58, s[20:23], s0 offen offset:3072 lds
    v_mfma_f32_16x16x32_bf16 v[194:197], a[208:211], a[52:55], v[194:197]
    ds_read_b64_tr_b16 a[202:203], v35 offset:2048
    s_add_u32 s1, s1, 8192
    v_mov_b32 v14, 0xffff0000
    v_mfma_f32_16x16x32_bf16 v[202:205], a[212:215], a[48:51], v[202:205]
    ds_read_b64_tr_b16 a[204:205], v37 offset:0
    s_and_b32 s1, s1, 0xffff
    v_mfma_f32_16x16x32_bf16 v[210:213], a[212:215], a[52:55], v[210:213]
    ds_read_b64_tr_b16 a[206:207], v37 offset:2048
    v_cndmask_b32 v13, v13, v14, s[70:71]
    s_waitcnt vmcnt(12) lgkmcnt(8)
    v_mfma_f32_16x16x32_bf16 v[182:185], a[216:219], a[56:59], v[182:185]
    ds_read_b64_tr_b16 a[208:209], v36 offset:0
    buffer_load_dwordx4 a[96:99], v78, s[28:31], s1 offen offset:0 sc1
    v_mfma_f32_16x16x32_bf16 v[190:193], a[216:219], a[60:63], v[190:193]
    ds_read_b64_tr_b16 a[210:211], v36 offset:2048
    v_cndmask_b32 v104, v13, 0, s[72:73]
    v_mfma_f32_16x16x32_bf16 v[198:201], a[220:223], a[56:59], v[198:201]
    ds_read_b64_tr_b16 a[212:213], v38 offset:0
    buffer_load_dwordx4 a[100:103], v78, s[28:31], s1 offen offset:256 sc1
    v_mfma_f32_16x16x32_bf16 v[206:209], a[220:223], a[60:63], v[206:209]
    ds_read_b64_tr_b16 a[214:215], v38 offset:2048
    v_cndmask_b32 v106, 0, v13, s[72:73]
    s_waitcnt lgkmcnt(8)
    v_mfma_f32_16x16x32_bf16 v[186:189], a[224:227], a[56:59], v[186:189]
    ds_read_b64_tr_b16 a[216:217], v35 offset:4096
    v_cndmask_b32 v105, v13, 0, s[74:75]
    v_mfma_f32_16x16x32_bf16 v[194:197], a[224:227], a[60:63], v[194:197]
    ds_read_b64_tr_b16 a[218:219], v35 offset:6144
    buffer_load_dwordx4 a[104:107], v78, s[28:31], s1 offen offset:2048 sc1
    v_cndmask_b32 v107, 0, v13, s[74:75]
    v_mfma_f32_16x16x32_bf16 v[202:205], a[228:231], a[56:59], v[202:205]
    ds_read_b64_tr_b16 a[220:221], v37 offset:4096
    v_mov_b32 v84, 0xf149f2ca
    v_mfma_f32_16x16x32_bf16 v[210:213], a[228:231], a[60:63], v[210:213]
    ds_read_b64_tr_b16 a[222:223], v37 offset:6144
    s_waitcnt vmcnt(13) lgkmcnt(8)
    v_mfma_f32_16x16x32_bf16 v[182:185], a[200:203], a[64:67], v[182:185]
    ds_read_b64_tr_b16 a[224:225], v36 offset:4096
    buffer_load_dwordx4 a[108:111], v78, s[28:31], s1 offen offset:2304 sc1
    v_mfma_f32_16x16x32_bf16 v[190:193], a[200:203], a[68:71], v[190:193]
    ds_read_b64_tr_b16 a[226:227], v36 offset:6144
    s_add_u32 m0, s58, 147456
    s_mov_b32 s83, 0x3e8b97f6
    v_mfma_f32_16x16x32_bf16 v[198:201], a[204:207], a[64:67], v[198:201]
    ds_read_b64_tr_b16 a[228:229], v38 offset:4096
    s_add_u32 s0, s0, 458752
    v_mfma_f32_16x16x32_bf16 v[206:209], a[204:207], a[68:71], v[206:209]
    ds_read_b64_tr_b16 a[230:231], v38 offset:6144
    s_mov_b32 s78, 0xbdd2d3e8
    s_mov_b32 s79, 0xbdd2d3e8
    s_waitcnt lgkmcnt(8)
    v_mfma_f32_16x16x32_bf16 v[186:189], a[208:211], a[64:67], v[186:189]
    s_barrier
    s_mov_b32 s14, 0
    s_load_dword s14, s[44:45], s15
    ds_read_b64_tr_b16 a[200:201], v35 offset:16384
    s_cmp_eq_u32 s0, 3670016
    s_cselect_b32 s0, 0, s0
    buffer_load_dwordx4 v55, s[20:23], s0 offen lds
    v_mfma_f32_16x16x32_bf16 v[194:197], a[208:211], a[68:71], v[194:197]
    ds_read_b64_tr_b16 a[202:203], v35 offset:18432
    s_mov_b32 s80, 1.0
    v_mfma_f32_16x16x32_bf16 v[202:205], a[212:215], a[64:67], v[202:205]
    ds_read_b64_tr_b16 a[204:205], v37 offset:16384
    buffer_load_dwordx4 v56, s[20:23], s0 offen offset:1024 lds
    v_mfma_f32_16x16x32_bf16 v[210:213], a[212:215], a[68:71], v[210:213]
    ds_read_b64_tr_b16 a[206:207], v37 offset:18432
    s_mov_b32 s81, 1.0
    s_waitcnt vmcnt(14) lgkmcnt(8)
    v_mfma_f32_16x16x32_bf16 v[182:185], a[216:219], a[72:75], v[182:185]
    ds_read_b64_tr_b16 a[208:209], v36 offset:16384
    v_mov_b32 v108, 0xc0135761
    v_mfma_f32_16x16x32_bf16 v[190:193], a[216:219], a[76:79], v[190:193]
    ds_read_b64_tr_b16 a[210:211], v36 offset:18432
    buffer_load_dwordx4 v57, s[20:23], s0 offen offset:2048 lds
    v_mov_b32 v109, 0xc0135761
    v_mfma_f32_16x16x32_bf16 v[198:201], a[220:223], a[72:75], v[198:201]
    ds_read_b64_tr_b16 a[212:213], v38 offset:16384
    v_lshrrev_b32 v13, 1, v2
    v_mfma_f32_16x16x32_bf16 v[206:209], a[220:223], a[76:79], v[206:209]
    ds_read_b64_tr_b16 a[214:215], v38 offset:18432
    s_waitcnt lgkmcnt(8)
    v_mfma_f32_16x16x32_bf16 v[186:189], a[224:227], a[72:75], v[186:189]
    ds_read_b64_tr_b16 a[216:217], v35 offset:20480
    buffer_load_dwordx4 v58, s[20:23], s0 offen offset:3072 lds
    v_mfma_f32_16x16x32_bf16 v[194:197], a[224:227], a[76:79], v[194:197]
    ds_read_b64_tr_b16 a[218:219], v35 offset:22528
    s_add_u32 s1, s1, 8192
    v_lshlrev_b32 v14, 1, v3
    v_mfma_f32_16x16x32_bf16 v[202:205], a[228:231], a[72:75], v[202:205]
    ds_read_b64_tr_b16 a[220:221], v37 offset:20480
    s_and_b32 s1, s1, 0xffff
    v_mfma_f32_16x16x32_bf16 v[210:213], a[228:231], a[76:79], v[210:213]
    ds_read_b64_tr_b16 a[222:223], v37 offset:22528
    s_waitcnt vmcnt(14) lgkmcnt(8)
    v_mfma_f32_16x16x32_bf16 v[182:185], a[200:203], a[80:83], v[182:185]
    ds_read_b64_tr_b16 a[224:225], v36 offset:20480
    buffer_load_dwordx4 a[112:115], v78, s[28:31], s1 offen offset:0 sc1
    v_mfma_f32_16x16x32_bf16 v[190:193], a[200:203], a[84:87], v[190:193]
L_pad0:
    s_cbranch_execz L_warm
    ds_read_b64_tr_b16 a[226:227], v36 offset:22528
    v_sub_u32 v13, v13, v14
    v_mfma_f32_16x16x32_bf16 v[198:201], a[204:207], a[80:83], v[198:201]
    ds_read_b64_tr_b16 a[228:229], v38 offset:20480
    buffer_load_dwordx4 a[116:119], v78, s[28:31], s1 offen offset:256 sc1
    v_mfma_f32_16x16x32_bf16 v[206:209], a[204:207], a[84:87], v[206:209]
    ds_read_b64_tr_b16 a[230:231], v38 offset:22528
    v_mov_b32 v14, 0x3f80
    s_waitcnt lgkmcnt(8)
    v_mfma_f32_16x16x32_bf16 v[186:189], a[208:211], a[80:83], v[186:189]
    ds_read_b64_tr_b16 a[200:201], v35 offset:32768
    v_cndmask_b32 v14, v14, 1.0, s[70:71]
    v_mfma_f32_16x16x32_bf16 v[194:197], a[208:211], a[84:87], v[194:197]
    ds_read_b64_tr_b16 a[202:203], v35 offset:34816
    buffer_load_dwordx4 a[120:123], v78, s[28:31], s1 offen offset:2048 sc1
    v_cmp_eq_i32 vcc, 0, v13
    v_mfma_f32_16x16x32_bf16 v[202:205], a[212:215], a[80:83], v[202:205]
    ds_read_b64_tr_b16 a[204:205], v37 offset:32768
    v_accvgpr_write_b32 a248, 0
    v_mfma_f32_16x16x32_bf16 v[210:213], a[212:215], a[84:87], v[210:213]
    ds_read_b64_tr_b16 a[206:207], v37 offset:34816
    s_waitcnt vmcnt(15) lgkmcnt(8)
    v_mfma_f32_16x16x32_bf16 v[182:185], a[216:219], a[88:91], v[182:185]
    ds_read_b64_tr_b16 a[208:209], v36 offset:32768
    buffer_load_dwordx4 a[124:127], v78, s[28:31], s1 offen offset:2304 sc1
    v_mfma_f32_16x16x32_bf16 v[190:193], a[216:219], a[92:95], v[190:193]
    ds_read_b64_tr_b16 a[210:211], v36 offset:34816
    s_add_u32 m0, s58, 0
    v_accvgpr_write_b32 a252, 0
    v_mfma_f32_16x16x32_bf16 v[198:201], a[220:223], a[88:91], v[198:201]
    ds_read_b64_tr_b16 a[212:213], v38 offset:32768
    s_add_u32 s0, s0, 458752
    v_mfma_f32_16x16x32_bf16 v[206:209], a[220:223], a[92:95], v[206:209]
    ds_read_b64_tr_b16 a[214:215], v38 offset:34816
    s_waitcnt lgkmcnt(8)
    v_mfma_f32_16x16x32_bf16 v[186:189], a[224:227], a[88:91], v[186:189]
    ds_read_b64_tr_b16 a[216:217], v35 offset:36864
    s_cmp_eq_u32 s0, 3670016
    v_mfma_f32_16x16x32_bf16 v[194:197], a[224:227], a[92:95], v[194:197]
    ds_read_b64_tr_b16 a[218:219], v35 offset:38912
    s_cselect_b32 s0, 0, s0
    buffer_load_dwordx4 v55, s[20:23], s0 offen lds
    v_cndmask_b32 v15, 0, v14, vcc
    v_mfma_f32_16x16x32_bf16 v[202:205], a[228:231], a[88:91], v[202:205]
    ds_read_b64_tr_b16 a[220:221], v37 offset:36864
    v_accvgpr_write_b32 a250, v15
    v_mfma_f32_16x16x32_bf16 v[210:213], a[228:231], a[92:95], v[210:213]
    ds_read_b64_tr_b16 a[222:223], v37 offset:38912
    s_waitcnt vmcnt(11) lgkmcnt(8)
    v_mfma_f32_16x16x32_bf16 v[182:185], a[200:203], a[96:99], v[182:185]
    ds_read_b64_tr_b16 a[224:225], v36 offset:36864
    buffer_load_dwordx4 v56, s[20:23], s0 offen offset:1024 lds
    v_mfma_f32_16x16x32_bf16 v[190:193], a[200:203], a[100:103], v[190:193]
    ds_read_b64_tr_b16 a[226:227], v36 offset:38912
    v_cmp_eq_i32 vcc, 1, v13
    v_mfma_f32_16x16x32_bf16 v[198:201], a[204:207], a[96:99], v[198:201]
    ds_read_b64_tr_b16 a[228:229], v38 offset:36864
    buffer_load_dwordx4 v57, s[20:23], s0 offen offset:2048 lds
    v_mfma_f32_16x16x32_bf16 v[206:209], a[204:207], a[100:103], v[206:209]
    ds_read_b64_tr_b16 a[230:231], v38 offset:38912
    v_accvgpr_write_b32 a249, 0
    s_waitcnt lgkmcnt(8)
    v_mfma_f32_16x16x32_bf16 v[186:189], a[208:211], a[96:99], v[186:189]
    s_waitcnt vmcnt(7)
    s_barrier
    ds_read_b64_tr_b16 a[200:201], v35 offset:49152
    buffer_load_dwordx4 v58, s[20:23], s0 offen offset:3072 lds
    v_mfma_f32_16x16x32_bf16 v[194:197], a[208:211], a[100:103], v[194:197]
    ds_read_b64_tr_b16 a[202:203], v35 offset:51200
    s_add_u32 m0, s58, 16384
    v_accvgpr_write_b32 a253, 0
    v_mfma_f32_16x16x32_bf16 v[202:205], a[212:215], a[96:99], v[202:205]
    ds_read_b64_tr_b16 a[204:205], v37 offset:49152
    s_add_u32 s0, s0, 458752
    v_mfma_f32_16x16x32_bf16 v[210:213], a[212:215], a[100:103], v[210:213]
    ds_read_b64_tr_b16 a[206:207], v37 offset:51200
    s_waitcnt lgkmcnt(8)
    v_mfma_f32_16x16x32_bf16 v[182:185], a[216:219], a[104:107], v[182:185]
    ds_read_b64_tr_b16 a[208:209], v36 offset:49152
    s_cmp_eq_u32 s0, 3670016
    v_mfma_f32_16x16x32_bf16 v[190:193], a[216:219], a[108:111], v[190:193]
    ds_read_b64_tr_b16 a[210:211], v36 offset:51200
    s_cselect_b32 s0, 0, s0
    buffer_load_dwordx4 v55, s[20:23], s0 offen lds
    v_cndmask_b32 v15, 0, v14, vcc
    v_mfma_f32_16x16x32_bf16 v[198:201], a[220:223], a[104:107], v[198:201]
    ds_read_b64_tr_b16 a[212:213], v38 offset:49152
    v_accvgpr_write_b32 a251, v15
    v_mfma_f32_16x16x32_bf16 v[206:209], a[220:223], a[108:111], v[206:209]
    ds_read_b64_tr_b16 a[214:215], v38 offset:51200
    s_waitcnt lgkmcnt(8)
    v_mfma_f32_16x16x32_bf16 v[186:189], a[224:227], a[104:107], v[186:189]
    ds_read_b64_tr_b16 a[216:217], v35 offset:53248
    buffer_load_dwordx4 v56, s[20:23], s0 offen offset:1024 lds
    v_mfma_f32_16x16x32_bf16 v[194:197], a[224:227], a[108:111], v[194:197]
    ds_read_b64_tr_b16 a[218:219], v35 offset:55296
    v_mfma_f32_16x16x32_bf16 v[202:205], a[228:231], a[104:107], v[202:205]
    ds_read_b64_tr_b16 a[220:221], v37 offset:53248
    buffer_load_dwordx4 v57, s[20:23], s0 offen offset:2048 lds
    v_mfma_f32_16x16x32_bf16 v[210:213], a[228:231], a[108:111], v[210:213]
    ds_read_b64_tr_b16 a[222:223], v37 offset:55296
    s_waitcnt vmcnt(9) lgkmcnt(8)
    v_mfma_f32_16x16x32_bf16 v[182:185], a[200:203], a[112:115], v[182:185]
    ds_read_b64_tr_b16 a[224:225], v36 offset:53248
    v_mfma_f32_16x16x32_bf16 v[190:193], a[200:203], a[116:119], v[190:193]
    ds_read_b64_tr_b16 a[226:227], v36 offset:55296
    buffer_load_dwordx4 v58, s[20:23], s0 offen offset:3072 lds
    v_mfma_f32_16x16x32_bf16 v[198:201], a[204:207], a[112:115], v[198:201]
    ds_read_b64_tr_b16 a[228:229], v38 offset:53248
    s_add_u32 m0, s58, 32768
    v_mfma_f32_16x16x32_bf16 v[206:209], a[204:207], a[116:119], v[206:209]
    ds_read_b64_tr_b16 a[230:231], v38 offset:55296
    s_waitcnt lgkmcnt(8)
    v_mfma_f32_16x16x32_bf16 v[186:189], a[208:211], a[112:115], v[186:189]
    s_cmp_ge_u32 s14, 14
    s_cbranch_scc0 L_pollin1
L_pollok1:
    ds_read_b64_tr_b16 a[200:201], v39 offset:0
    s_add_u32 s0, s0, 458752
    v_mfma_f32_16x16x32_bf16 v[194:197], a[208:211], a[116:119], v[194:197]
    ds_read_b64_tr_b16 a[202:203], v39 offset:2048
    s_cmp_eq_u32 s0, 3670016
    s_cselect_b32 s0, 0, s0
    buffer_load_dwordx4 v55, s[20:23], s0 offen lds
    v_mfma_f32_16x16x32_bf16 v[202:205], a[212:215], a[112:115], v[202:205]
    ds_read_b64_tr_b16 a[204:205], v41 offset:0
    v_mfma_f32_16x16x32_bf16 v[210:213], a[212:215], a[116:119], v[210:213]
    ds_read_b64_tr_b16 a[206:207], v41 offset:2048
    s_waitcnt vmcnt(9) lgkmcnt(8)
    v_mfma_f32_16x16x32_bf16 v[182:185], a[216:219], a[120:123], v[182:185]
    ds_read_b64_tr_b16 a[208:209], v40 offset:0
    buffer_load_dwordx4 v56, s[20:23], s0 offen offset:1024 lds
    v_mfma_f32_16x16x32_bf16 v[190:193], a[216:219], a[124:127], v[190:193]
    ds_read_b64_tr_b16 a[210:211], v40 offset:2048
    v_mfma_f32_16x16x32_bf16 v[198:201], a[220:223], a[120:123], v[198:201]
    ds_read_b64_tr_b16 a[212:213], v42 offset:0
    buffer_load_dwordx4 v57, s[20:23], s0 offen offset:2048 lds
    v_mfma_f32_16x16x32_bf16 v[206:209], a[220:223], a[124:127], v[206:209]
    ds_read_b64_tr_b16 a[214:215], v42 offset:2048
    s_waitcnt lgkmcnt(8)
    v_mfma_f32_16x16x32_bf16 v[186:189], a[224:227], a[120:123], v[186:189]
    ds_read_b64_tr_b16 a[216:217], v39 offset:4096
    v_mfma_f32_16x16x32_bf16 v[194:197], a[224:227], a[124:127], v[194:197]
    ds_read_b64_tr_b16 a[218:219], v39 offset:6144
    v_mfma_f32_16x16x32_bf16 v[202:205], a[228:231], a[120:123], v[202:205]
    ds_read_b64_tr_b16 a[220:221], v41 offset:4096
    buffer_load_dwordx4 v58, s[20:23], s0 offen offset:3072 lds
    v_mfma_f32_16x16x32_bf16 v[210:213], a[228:231], a[124:127], v[210:213]
    ds_read_b64_tr_b16 a[222:223], v41 offset:6144
    s_waitcnt lgkmcnt(8)
    v_mfma_f32_16x16x32_bf16 v[150:153], a[200:203], a[0:3], v[150:153]
    ds_read_b64_tr_b16 a[224:225], v40 offset:4096
    s_add_u32 m0, s58, 49152
    v_mfma_f32_16x16x32_bf16 v[158:161], a[200:203], a[4:7], v[158:161]
    ds_read_b64_tr_b16 a[226:227], v40 offset:6144
    s_add_u32 s0, s0, 458752
    v_mfma_f32_16x16x32_bf16 v[166:169], a[204:207], a[0:3], 0
    ds_read_b64_tr_b16 a[228:229], v42 offset:4096
    s_cmp_eq_u32 s0, 3670016
    s_cselect_b32 s0, 0, s0
    buffer_load_dwordx4 v55, s[20:23], s0 offen lds
    v_mfma_f32_16x16x32_bf16 v[174:177], a[204:207], a[4:7], 0
    ds_read_b64_tr_b16 a[230:231], v42 offset:6144
    v_cvt_pk_bf16_f32 v182, v182, v183
    v_cvt_pk_bf16_f32 v183, v184, v185
    v_cvt_pk_bf16_f32 v184, v186, v187
    s_waitcnt lgkmcnt(8)
    v_mfma_f32_16x16x32_bf16 v[154:157], a[208:211], a[0:3], v[154:157]
    s_waitcnt vmcnt(5)
    s_barrier
    ds_read_b64_tr_b16 a[200:201], v39 offset:16384
    buffer_load_dwordx4 v56, s[20:23], s0 offen offset:1024 lds
    v_mfma_f32_16x16x32_bf16 v[162:165], a[208:211], a[4:7], v[162:165]
    ds_read_b64_tr_b16 a[202:203], v39 offset:18432
    v_cvt_pk_bf16_f32 v185, v188, v189
    buffer_store_dwordx4 v[182:185], v23, s[28:31], 0 offen offset:0 sc1
    v_cvt_pk_bf16_f32 v190, v190, v191
    v_cvt_pk_bf16_f32 v191, v192, v193
    v_cvt_pk_bf16_f32 v192, v194, v195
    v_mfma_f32_16x16x32_bf16 v[170:173], a[212:215], a[0:3], 0
    ds_read_b64_tr_b16 a[204:205], v41 offset:16384
    v_cvt_pk_bf16_f32 v193, v196, v197
    v_mfma_f32_16x16x32_bf16 v[178:181], a[212:215], a[4:7], 0
    ds_read_b64_tr_b16 a[206:207], v41 offset:18432
    buffer_store_dwordx4 v[190:193], v23, s[28:31], 0 offen offset:1024 sc1
    v_cvt_pk_bf16_f32 v198, v198, v199
    v_cvt_pk_bf16_f32 v199, v200, v201
    v_cvt_pk_bf16_f32 v200, v202, v203
    s_waitcnt lgkmcnt(8)
    v_mfma_f32_16x16x32_bf16 v[150:153], a[216:219], a[8:11], v[150:153]
    ds_read_b64_tr_b16 a[208:209], v40 offset:16384
    buffer_load_dwordx4 v57, s[20:23], s0 offen offset:2048 lds
    v_mfma_f32_16x16x32_bf16 v[158:161], a[216:219], a[12:15], v[158:161]
    ds_read_b64_tr_b16 a[210:211], v40 offset:18432
    v_cvt_pk_bf16_f32 v201, v204, v205
    buffer_store_dwordx4 v[198:201], v23, s[28:31], 0 offen offset:2048 sc1
    v_cvt_pk_bf16_f32 v206, v206, v207
    v_cvt_pk_bf16_f32 v207, v208, v209
    v_cvt_pk_bf16_f32 v208, v210, v211
    v_mfma_f32_16x16x32_bf16 v[166:169], a[220:223], a[8:11], v[166:169]
    ds_read_b64_tr_b16 a[212:213], v42 offset:16384
    v_cvt_pk_bf16_f32 v209, v212, v213
    v_mfma_f32_16x16x32_bf16 v[174:177], a[220:223], a[12:15], v[174:177]
    ds_read_b64_tr_b16 a[214:215], v42 offset:18432
    s_waitcnt lgkmcnt(8)
    v_mfma_f32_16x16x32_bf16 v[154:157], a[224:227], a[8:11], v[154:157]
    ds_read_b64_tr_b16 a[216:217], v39 offset:20480
    buffer_load_dwordx4 v58, s[20:23], s0 offen offset:3072 lds
    v_mfma_f32_16x16x32_bf16 v[162:165], a[224:227], a[12:15], v[162:165]
    ds_read_b64_tr_b16 a[218:219], v39 offset:22528
    s_add_u32 m0, s58, 65536
    buffer_store_dwordx4 v[206:209], v23, s[28:31], 0 offen offset:3072 sc1
    v_mfma_f32_16x16x32_bf16 v[170:173], a[228:231], a[8:11], v[170:173]
    ds_read_b64_tr_b16 a[220:221], v41 offset:20480
    s_add_u32 s0, s0, 458752
    v_mfma_f32_16x16x32_bf16 v[178:181], a[228:231], a[12:15], v[178:181]
    ds_read_b64_tr_b16 a[222:223], v41 offset:22528
    s_waitcnt lgkmcnt(8)
    v_mfma_f32_16x16x32_bf16 v[150:153], a[200:203], a[16:19], v[150:153]
    ds_read_b64_tr_b16 a[224:225], v40 offset:20480
    s_cmp_eq_u32 s0, 3670016
    v_mfma_f32_16x16x32_bf16 v[158:161], a[200:203], a[20:23], v[158:161]
    ds_read_b64_tr_b16 a[226:227], v40 offset:22528
    s_cselect_b32 s0, 0, s0
    buffer_load_dwordx4 v55, s[20:23], s0 offen lds
    v_mfma_f32_16x16x32_bf16 v[166:169], a[204:207], a[16:19], v[166:169]
    ds_read_b64_tr_b16 a[228:229], v42 offset:20480
    v_mfma_f32_16x16x32_bf16 v[174:177], a[204:207], a[20:23], v[174:177]
    ds_read_b64_tr_b16 a[230:231], v42 offset:22528
    s_waitcnt lgkmcnt(8)
    v_mfma_f32_16x16x32_bf16 v[154:157], a[208:211], a[16:19], v[154:157]
    ds_read_b64_tr_b16 a[200:201], v31 offset:0
    buffer_load_dwordx4 v56, s[20:23], s0 offen offset:1024 lds
    v_mfma_f32_16x16x32_bf16 v[162:165], a[208:211], a[20:23], v[162:165]
    ds_read_b64_tr_b16 a[202:203], v31 offset:2048
    v_mfma_f32_16x16x32_bf16 v[170:173], a[212:215], a[16:19], v[170:173]
    ds_read_b64_tr_b16 a[204:205], v33 offset:0
    buffer_load_dwordx4 v57, s[20:23], s0 offen offset:2048 lds
    v_mfma_f32_16x16x32_bf16 v[178:181], a[212:215], a[20:23], v[178:181]
    ds_read_b64_tr_b16 a[206:207], v33 offset:2048
    s_waitcnt lgkmcnt(8)
    v_mfma_f32_16x16x32_bf16 v[150:153], a[216:219], a[24:27], v[150:153]
    ds_read_b64_tr_b16 a[208:209], v32 offset:0
    v_mfma_f32_16x16x32_bf16 v[158:161], a[216:219], a[28:31], v[158:161]
    ds_read_b64_tr_b16 a[210:211], v32 offset:2048
    buffer_load_dwordx4 v58, s[20:23], s0 offen offset:3072 lds
    v_mfma_f32_16x16x32_bf16 v[166:169], a[220:223], a[24:27], v[166:169]
    ds_read_b64_tr_b16 a[212:213], v34 offset:0
    s_add_u32 m0, s58, 81920
    v_mfma_f32_16x16x32_bf16 v[174:177], a[220:223], a[28:31], v[174:177]
    ds_read_b64_tr_b16 a[214:215], v34 offset:2048
    s_waitcnt lgkmcnt(8)
    v_mfma_f32_16x16x32_bf16 v[154:157], a[224:227], a[24:27], v[154:157]
    ds_read_b64_tr_b16 a[216:217], v31 offset:4096
    s_add_u32 s0, s0, 458752
    v_mfma_f32_16x16x32_bf16 v[162:165], a[224:227], a[28:31], v[162:165]
    ds_read_b64_tr_b16 a[218:219], v31 offset:6144
    s_cmp_eq_u32 s0, 3670016
    v_mfma_f32_16x16x32_bf16 v[170:173], a[228:231], a[24:27], v[170:173]
    ds_read_b64_tr_b16 a[220:221], v33 offset:4096
    s_cselect_b32 s0, 0, s0
    buffer_load_dwordx4 v55, s[20:23], s0 offen lds
    v_mfma_f32_16x16x32_bf16 v[178:181], a[228:231], a[28:31], v[178:181]
    ds_read_b64_tr_b16 a[222:223], v33 offset:6144
    s_waitcnt lgkmcnt(8)
    v_mfma_f32_16x16x32_bf16 v[150:153], a[200:203], a[32:35], v[150:153]
    ds_read_b64_tr_b16 a[224:225], v32 offset:4096
    buffer_load_dwordx4 v56, s[20:23], s0 offen offset:1024 lds
    v_mfma_f32_16x16x32_bf16 v[158:161], a[200:203], a[36:39], v[158:161]
    ds_read_b64_tr_b16 a[226:227], v32 offset:6144
    v_mfma_f32_16x16x32_bf16 v[166:169], a[204:207], a[32:35], v[166:169]
    ds_read_b64_tr_b16 a[228:229], v34 offset:4096
    v_mfma_f32_16x16x32_bf16 v[174:177], a[204:207], a[36:39], v[174:177]
    ds_read_b64_tr_b16 a[230:231], v34 offset:6144
    s_waitcnt lgkmcnt(8)
    v_mfma_f32_16x16x32_bf16 v[154:157], a[208:211], a[32:35], v[154:157]
    s_waitcnt vmcnt(7)
    s_barrier
    s_waitcnt vmcnt(6)
    s_atomic_add s36, s[28:29], s37
    ds_read_b64_tr_b16 a[200:201], v31 offset:16384
    buffer_load_dwordx4 v57, s[20:23], s0 offen offset:2048 lds
    v_mfma_f32_16x16x32_bf16 v[162:165], a[208:211], a[36:39], v[162:165]
    ds_read_b64_tr_b16 a[202:203], v31 offset:18432
    v_mfma_f32_16x16x32_bf16 v[170:173], a[212:215], a[32:35], v[170:173]
    ds_read_b64_tr_b16 a[204:205], v33 offset:16384
    buffer_load_dwordx4 v58, s[20:23], s0 offen offset:3072 lds
    v_mfma_f32_16x16x32_bf16 v[178:181], a[212:215], a[36:39], v[178:181]
    ds_read_b64_tr_b16 a[206:207], v33 offset:18432
    s_waitcnt lgkmcnt(8)
    v_mfma_f32_16x16x32_bf16 v[150:153], a[216:219], a[40:43], v[150:153]
    ds_read_b64_tr_b16 a[208:209], v32 offset:16384
    s_add_u32 m0, s59, 98304
    v_mfma_f32_16x16x32_bf16 v[158:161], a[216:219], a[44:47], v[158:161]
    ds_read_b64_tr_b16 a[210:211], v32 offset:18432
    buffer_load_dwordx4 v80, s[28:31], s63 offen sc1 lds
    v_mfma_f32_16x16x32_bf16 v[166:169], a[220:223], a[40:43], v[166:169]
    ds_read_b64_tr_b16 a[212:213], v34 offset:16384
    v_mfma_f32_16x16x32_bf16 v[174:177], a[220:223], a[44:47], v[174:177]
    ds_read_b64_tr_b16 a[214:215], v34 offset:18432
    s_waitcnt lgkmcnt(8)
    v_mfma_f32_16x16x32_bf16 v[154:157], a[224:227], a[40:43], v[154:157]
    ds_read_b64_tr_b16 a[216:217], v31 offset:20480
    v_mfma_f32_16x16x32_bf16 v[162:165], a[224:227], a[44:47], v[162:165]
    ds_read_b64_tr_b16 a[218:219], v31 offset:22528
    buffer_load_dwordx4 v80, s[28:31], s63 offen offset:1024 sc1 lds
    v_mfma_f32_16x16x32_bf16 v[170:173], a[228:231], a[40:43], v[170:173]
    ds_read_b64_tr_b16 a[220:221], v33 offset:20480
    v_mfma_f32_16x16x32_bf16 v[178:181], a[228:231], a[44:47], v[178:181]
    ds_read_b64_tr_b16 a[222:223], v33 offset:22528
    s_waitcnt lgkmcnt(8)
    v_mfma_f32_16x16x32_bf16 v[150:153], a[200:203], a[48:51], v[150:153]
    ds_read_b64_tr_b16 a[224:225], v32 offset:20480
    buffer_load_dwordx4 v80, s[28:31], s63 offen offset:2048 sc1 lds
    v_mfma_f32_16x16x32_bf16 v[158:161], a[200:203], a[52:55], v[158:161]
    ds_read_b64_tr_b16 a[226:227], v32 offset:22528
    s_add_u32 m0, s100, 126976
    v_mfma_f32_16x16x32_bf16 v[166:169], a[204:207], a[48:51], v[166:169]
    ds_read_b64_tr_b16 a[228:229], v34 offset:20480
    v_mfma_f32_16x16x32_bf16 v[174:177], a[204:207], a[52:55], v[174:177]
    ds_read_b64_tr_b16 a[230:231], v34 offset:22528
    s_waitcnt lgkmcnt(8)
    v_mfma_f32_16x16x32_bf16 v[154:157], a[208:211], a[48:51], v[154:157]
    ds_read_b64_tr_b16 a[200:201], v31 offset:32768
    buffer_load_dwordx4 v69, s[28:31], s62 offen sc1 lds
    v_mfma_f32_16x16x32_bf16 v[162:165], a[208:211], a[52:55], v[162:165]
    ds_read_b64_tr_b16 a[202:203], v31 offset:34816
    s_add_u32 m0, s58, 110592
    v_mfma_f32_16x16x32_bf16 v[170:173], a[212:215], a[48:51], v[170:173]
    ds_read_b64_tr_b16 a[204:205], v33 offset:32768
    v_mfma_f32_16x16x32_bf16 v[178:181], a[212:215], a[52:55], v[178:181]
    ds_read_b64_tr_b16 a[206:207], v33 offset:34816
    s_waitcnt lgkmcnt(8)
    v_mfma_f32_16x16x32_bf16 v[150:153], a[216:219], a[56:59], v[150:153]
    ds_read_b64_tr_b16 a[208:209], v32 offset:32768
    buffer_load_dwordx4 v67, s[28:31], s62 offen sc1 lds
    v_mfma_f32_16x16x32_bf16 v[158:161], a[216:219], a[60:63], v[158:161]
    ds_read_b64_tr_b16 a[210:211], v32 offset:34816
    v_mfma_f32_16x16x32_bf16 v[166:169], a[220:223], a[56:59], v[166:169]
    ds_read_b64_tr_b16 a[212:213], v34 offset:32768
    v_mfma_f32_16x16x32_bf16 v[174:177], a[220:223], a[60:63], v[174:177]
    ds_read_b64_tr_b16 a[214:215], v34 offset:34816
    s_waitcnt lgkmcnt(8)
    v_mfma_f32_16x16x32_bf16 v[154:157], a[224:227], a[56:59], v[154:157]
    ds_read_b64_tr_b16 a[216:217], v31 offset:36864
    buffer_load_dwordx4 v67, s[28:31], s62 offen offset:1024 sc1 lds
    v_mfma_f32_16x16x32_bf16 v[162:165], a[224:227], a[60:63], v[162:165]
    ds_read_b64_tr_b16 a[218:219], v31 offset:38912
    v_mfma_f32_16x16x32_bf16 v[170:173], a[228:231], a[56:59], v[170:173]
    ds_read_b64_tr_b16 a[220:221], v33 offset:36864
    buffer_load_dwordx4 v68, s[28:31], s62 offen offset:2048 sc1 lds
    v_mfma_f32_16x16x32_bf16 v[178:181], a[228:231], a[60:63], v[178:181]
    ds_read_b64_tr_b16 a[222:223], v33 offset:38912
    s_waitcnt lgkmcnt(8)
    v_mfma_f32_16x16x32_bf16 v[150:153], a[200:203], a[64:67], v[150:153]
    ds_read_b64_tr_b16 a[224:225], v32 offset:36864
    v_mfma_f32_16x16x32_bf16 v[158:161], a[200:203], a[68:71], v[158:161]
    ds_read_b64_tr_b16 a[226:227], v32 offset:38912
    v_mfma_f32_16x16x32_bf16 v[166:169], a[204:207], a[64:67], v[166:169]
    ds_read_b64_tr_b16 a[228:229], v34 offset:36864
    buffer_load_dwordx4 v68, s[28:31], s62 offen offset:3072 sc1 lds
    v_mfma_f32_16x16x32_bf16 v[174:177], a[204:207], a[68:71], v[174:177]
    ds_read_b64_tr_b16 a[230:231], v34 offset:38912
    s_waitcnt lgkmcnt(8)
    v_mfma_f32_16x16x32_bf16 v[154:157], a[208:211], a[64:67], v[154:157]
    s_waitcnt vmcnt(8)
    s_barrier
    s_xor_b32 s37, s37, 1024
    s_mov_b32 s14, 0
    s_load_dword s14, s[28:29], s37
    ds_read_b64_tr_b16 a[200:201], v31 offset:49152
    s_add_u32 m0, s59, 131072
    v_mfma_f32_16x16x32_bf16 v[162:165], a[208:211], a[68:71], v[162:165]
    ds_read_b64_tr_b16 a[202:203], v31 offset:51200
    s_add_u32 s63, s63, 12288
    v_mfma_f32_16x16x32_bf16 v[170:173], a[212:215], a[64:67], v[170:173]
    ds_read_b64_tr_b16 a[204:205], v33 offset:49152
    s_cmp_eq_u32 s63, 86016
    s_cselect_b32 s63, 0, s63
    buffer_load_dwordx4 v80, s[28:31], s63 offen sc1 lds
    v_mfma_f32_16x16x32_bf16 v[178:181], a[212:215], a[68:71], v[178:181]
    ds_read_b64_tr_b16 a[206:207], v33 offset:51200
    s_waitcnt lgkmcnt(8)
    v_mfma_f32_16x16x32_bf16 v[150:153], a[216:219], a[72:75], v[150:153]
    ds_read_b64_tr_b16 a[208:209], v32 offset:49152
    buffer_load_dwordx4 v80, s[28:31], s63 offen offset:1024 sc1 lds
    v_mfma_f32_16x16x32_bf16 v[158:161], a[216:219], a[76:79], v[158:161]
    ds_read_b64_tr_b16 a[210:211], v32 offset:51200
    v_mfma_f32_16x16x32_bf16 v[166:169], a[220:223], a[72:75], v[166:169]
    ds_read_b64_tr_b16 a[212:213], v34 offset:49152
    v_mfma_f32_16x16x32_bf16 v[174:177], a[220:223], a[76:79], v[174:177]
    ds_read_b64_tr_b16 a[214:215], v34 offset:51200
    s_waitcnt lgkmcnt(8)
    v_mfma_f32_16x16x32_bf16 v[154:157], a[224:227], a[72:75], v[154:157]
    ds_read_b64_tr_b16 a[216:217], v31 offset:53248
    buffer_load_dwordx4 v80, s[28:31], s63 offen offset:2048 sc1 lds
    v_mfma_f32_16x16x32_bf16 v[162:165], a[224:227], a[76:79], v[162:165]
    ds_read_b64_tr_b16 a[218:219], v31 offset:55296
    s_add_u32 m0, s100, 159744
    v_mfma_f32_16x16x32_bf16 v[170:173], a[228:231], a[72:75], v[170:173]
    ds_read_b64_tr_b16 a[220:221], v33 offset:53248
    s_add_u32 s62, s62, 262144
    v_mfma_f32_16x16x32_bf16 v[178:181], a[228:231], a[76:79], v[178:181]
    ds_read_b64_tr_b16 a[222:223], v33 offset:55296
    s_waitcnt lgkmcnt(8)
    v_mfma_f32_16x16x32_bf16 v[150:153], a[200:203], a[80:83], v[150:153]
    ds_read_b64_tr_b16 a[224:225], v32 offset:53248
    s_cmp_eq_u32 s62, 1835008
    v_mfma_f32_16x16x32_bf16 v[158:161], a[200:203], a[84:87], v[158:161]
    ds_read_b64_tr_b16 a[226:227], v32 offset:55296
    s_cselect_b32 s62, 0, s62
    buffer_load_dwordx4 v69, s[28:31], s62 offen sc1 lds
    v_mfma_f32_16x16x32_bf16 v[166:169], a[204:207], a[80:83], v[166:169]
    ds_read_b64_tr_b16 a[228:229], v34 offset:53248
    s_add_u32 m0, s58, 143360
    v_mfma_f32_16x16x32_bf16 v[174:177], a[204:207], a[84:87], v[174:177]
    ds_read_b64_tr_b16 a[230:231], v34 offset:55296
    s_waitcnt lgkmcnt(8)
    v_mfma_f32_16x16x32_bf16 v[154:157], a[208:211], a[80:83], v[154:157]
    s_barrier
    ds_read_b64_tr_b16 a[200:201], v37 offset:0
    buffer_load_dwordx4 v67, s[28:31], s62 offen sc1 lds
    v_mfma_f32_16x16x32_bf16 v[162:165], a[208:211], a[84:87], v[162:165]
    ds_read_b64_tr_b16 a[202:203], v37 offset:2048
    v_mfma_f32_16x16x32_bf16 v[170:173], a[212:215], a[80:83], v[170:173]
    ds_read_b64_tr_b16 a[204:205], v38 offset:0
    buffer_load_dwordx4 v67, s[28:31], s62 offen offset:1024 sc1 lds
    v_mfma_f32_16x16x32_bf16 v[178:181], a[212:215], a[84:87], v[178:181]
    ds_read_b64_tr_b16 a[206:207], v38 offset:2048
    s_waitcnt lgkmcnt(8)
    v_mfma_f32_16x16x32_bf16 v[150:153], a[216:219], a[88:91], v[150:153]
    ds_read_b64_tr_b16 a[208:209], v37 offset:4096
    v_mfma_f32_16x16x32_bf16 v[158:161], a[216:219], a[92:95], v[158:161]
    ds_read_b64_tr_b16 a[210:211], v37 offset:6144
    v_mfma_f32_16x16x32_bf16 v[166:169], a[220:223], a[88:91], v[166:169]
    ds_read_b64_tr_b16 a[212:213], v38 offset:4096
    buffer_load_dwordx4 v68, s[28:31], s62 offen offset:2048 sc1 lds
    v_mfma_f32_16x16x32_bf16 v[174:177], a[220:223], a[92:95], v[174:177]
    ds_read_b64_tr_b16 a[214:215], v38 offset:6144
    s_waitcnt lgkmcnt(8)
    v_mfma_f32_16x16x32_bf16 v[154:157], a[224:227], a[88:91], v[154:157]
    ds_read_b64_tr_b16 a[216:217], v37 offset:16384
    v_mfma_f32_16x16x32_bf16 v[162:165], a[224:227], a[92:95], v[162:165]
    ds_read_b64_tr_b16 a[218:219], v37 offset:18432
    buffer_load_dwordx4 v68, s[28:31], s62 offen offset:3072 sc1 lds
    v_mfma_f32_16x16x32_bf16 v[170:173], a[228:231], a[88:91], v[170:173]
    ds_read_b64_tr_b16 a[220:221], v38 offset:16384
    s_add_u32 m0, s59, 0
    v_mfma_f32_16x16x32_bf16 v[178:181], a[228:231], a[92:95], v[178:181]
    ds_read_b64_tr_b16 a[222:223], v38 offset:18432
    s_waitcnt lgkmcnt(8)
    v_mfma_f32_16x16x32_bf16 v[166:169], a[200:203], a[96:99], v[166:169]
    s_cmp_ge_u32 s14, 2
    s_cbranch_scc0 L_pollin2
L_pollok2:
    v_xor_b32 v23, 131072, v23
    v_xor_b32 v22, 8192, v23
    ds_read_b64_tr_b16 a[224:225], v37 offset:20480
    buffer_load_dwordx4 v[214:217], v23, s[28:31], 0 offen offset:0 sc1
    v_mfma_f32_16x16x32_bf16 v[174:177], a[200:203], a[100:103], v[174:177]
    ds_read_b64_tr_b16 a[226:227], v37 offset:22528
    v_mfma_f32_16x16x32_bf16 v[170:173], a[204:207], a[96:99], v[170:173]
    ds_read_b64_tr_b16 a[228:229], v38 offset:20480
    buffer_load_dwordx4 v[218:221], v23, s[28:31], 0 offen offset:1024 sc1
    v_mfma_f32_16x16x32_bf16 v[178:181], a[204:207], a[100:103], v[178:181]
    ds_read_b64_tr_b16 a[230:231], v38 offset:22528
    s_waitcnt lgkmcnt(8)
    v_mfma_f32_16x16x32_bf16 v[166:169], a[208:211], a[104:107], v[166:169]
    ds_read_b64_tr_b16 a[200:201], v35 offset:0
    buffer_load_dwordx4 v[222:225], v22, s[28:31], 0 offen offset:2048 sc1
    v_mfma_f32_16x16x32_bf16 v[174:177], a[208:211], a[108:111], v[174:177]
    ds_read_b64_tr_b16 a[202:203], v35 offset:2048
    v_mfma_f32_16x16x32_bf16 v[170:173], a[212:215], a[104:107], v[170:173]
    ds_read_b64_tr_b16 a[204:205], v36 offset:0
    buffer_load_dwordx4 v[226:229], v22, s[28:31], 0 offen offset:3072 sc1
    v_mfma_f32_16x16x32_bf16 v[178:181], a[212:215], a[108:111], v[178:181]
    ds_read_b64_tr_b16 a[206:207], v36 offset:2048
    s_waitcnt lgkmcnt(8)
    v_mfma_f32_16x16x32_bf16 v[166:169], a[216:219], a[112:115], v[166:169]
    ds_read_b64_tr_b16 a[208:209], v35 offset:4096
    s_add_u32 s63, s63, 12288
    v_mfma_f32_16x16x32_bf16 v[174:177], a[216:219], a[116:119], v[174:177]
    ds_read_b64_tr_b16 a[210:211], v35 offset:6144
    s_cmp_eq_u32 s63, 86016
    s_cselect_b32 s63, 0, s63
    buffer_load_dwordx4 v80, s[28:31], s63 offen sc1 lds
    v_mfma_f32_16x16x32_bf16 v[170:173], a[220:223], a[112:115], v[170:173]
    ds_read_b64_tr_b16 a[212:213], v36 offset:4096
    v_mfma_f32_16x16x32_bf16 v[178:181], a[220:223], a[116:119], v[178:181]
    ds_read_b64_tr_b16 a[214:215], v36 offset:6144
    s_waitcnt lgkmcnt(8)
    v_mfma_f32_16x16x32_bf16 v[166:169], a[224:227], a[120:123], v[166:169]
    ds_read_b64_tr_b16 a[216:217], v35 offset:16384
    buffer_load_dwordx4 v80, s[28:31], s63 offen offset:1024 sc1 lds
    v_mfma_f32_16x16x32_bf16 v[174:177], a[224:227], a[124:127], v[174:177]
    ds_read_b64_tr_b16 a[218:219], v35 offset:18432
    v_mfma_f32_16x16x32_bf16 v[170:173], a[228:231], a[120:123], v[170:173]
    ds_read_b64_tr_b16 a[220:221], v36 offset:16384
    v_mfma_f32_16x16x32_bf16 v[178:181], a[228:231], a[124:127], v[178:181]
    ds_read_b64_tr_b16 a[222:223], v36 offset:18432
    s_waitcnt lgkmcnt(8)
    v_mfma_f32_16x16x32_bf16 v[150:153], a[200:203], a[96:99], v[150:153]
    ds_read_b64_tr_b16 a[224:225], v35 offset:20480
    buffer_load_dwordx4 v80, s[28:31], s63 offen offset:2048 sc1 lds
    v_mfma_f32_16x16x32_bf16 v[158:161], a[200:203], a[100:103], v[158:161]
    ds_read_b64_tr_b16 a[226:227], v35 offset:22528
    s_add_u32 m0, s100, 28672
    v_mfma_f32_16x16x32_bf16 v[154:157], a[204:207], a[96:99], v[154:157]
    ds_read_b64_tr_b16 a[228:229], v36 offset:20480
    s_add_u32 s62, s62, 262144
    v_mfma_f32_16x16x32_bf16 v[162:165], a[204:207], a[100:103], v[162:165]
    ds_read_b64_tr_b16 a[230:231], v36 offset:22528
    v_cvt_pk_bf16_f32 v166, v166, v167
    v_cvt_pk_bf16_f32 v167, v168, v169
    s_waitcnt lgkmcnt(8)
    v_mfma_f32_16x16x32_bf16 v[150:153], a[208:211], a[104:107], v[150:153]
    s_cmp_eq_u32 s62, 1835008
    s_cselect_b32 s62, 0, s62
    buffer_load_dwordx4 v69, s[28:31], s62 offen sc1 lds
    v_mfma_f32_16x16x32_bf16 v[158:161], a[208:211], a[108:111], v[158:161]
    s_add_u32 m0, s58, 12288
    v_cvt_pk_bf16_f32 v168, v170, v171
    v_cvt_pk_bf16_f32 v169, v172, v173
    ds_write_b128 v81, v[166:169] offset:32768
    v_mfma_f32_16x16x32_bf16 v[154:157], a[212:215], a[104:107], v[154:157]
    buffer_load_dwordx4 v67, s[28:31], s62 offen sc1 lds
    v_cvt_pk_bf16_f32 v174, v174, v175
    v_mfma_f32_16x16x32_bf16 v[162:165], a[212:215], a[108:111], v[162:165]
    v_cvt_pk_bf16_f32 v175, v176, v177
    s_waitcnt lgkmcnt(5)
    v_mfma_f32_16x16x32_bf16 v[150:153], a[216:219], a[112:115], v[150:153]
    v_cvt_pk_bf16_f32 v176, v178, v179
    v_cvt_pk_bf16_f32 v177, v180, v181
    v_mfma_f32_16x16x32_bf16 v[158:161], a[216:219], a[116:119], v[158:161]
    buffer_load_dwordx4 v67, s[28:31], s62 offen offset:1024 sc1 lds
    ds_write_b128 v81, v[174:177] offset:33792
    v_mfma_f32_16x16x32_bf16 v[154:157], a[220:223], a[112:115], v[154:157]
    v_mfma_f32_16x16x32_bf16 v[162:165], a[220:223], a[116:119], v[162:165]
    s_waitcnt lgkmcnt(2)
    v_mfma_f32_16x16x32_bf16 v[150:153], a[224:227], a[120:123], v[150:153]
    buffer_load_dwordx4 v68, s[28:31], s62 offen offset:2048 sc1 lds
    v_mfma_f32_16x16x32_bf16 v[158:161], a[224:227], a[124:127], v[158:161]
    v_mfma_f32_16x16x32_bf16 v[154:157], a[228:231], a[120:123], v[154:157]
    v_xor_b32 v81, 8192, v81
    s_waitcnt vmcnt(19) lgkmcnt(0)
    s_barrier
    ds_read_b128 v[182:185], v81 offset:32768
    ds_read_b128 v[186:189], v81 offset:33792
    v_mfma_f32_16x16x32_bf16 v[162:165], a[228:231], a[124:127], v[162:165]
    buffer_load_dwordx4 v68, s[28:31], s62 offen offset:3072 sc1 lds
    s_waitcnt vmcnt(11)
    v_mfma_f32_16x16x32_bf16 v[150:153], a[250:253], v[214:217], v[150:153]
    s_add_u32 m0, s59, 65536
L_pad1:
    s_cbranch_execz L_warm
    s_add_u32 s63, s63, 12288
    v_mfma_f32_16x16x32_bf16 v[154:157], a[248:251], v[214:217], v[154:157]
    s_cmp_eq_u32 s63, 86016
    s_cselect_b32 s63, 0, s63
    s_waitcnt vmcnt(10)
    v_mfma_f32_16x16x32_bf16 v[158:161], a[250:253], v[218:221], v[158:161]
    buffer_load_dwordx4 v80, s[28:31], s63 offen sc1 lds
    v_mfma_f32_16x16x32_bf16 v[162:165], a[248:251], v[218:221], v[162:165]
    s_waitcnt vmcnt(10)
    v_mfma_f32_16x16x32_bf16 v[150:153], a[250:253], v[222:225], v[150:153]
    v_mfma_f32_16x16x32_bf16 v[154:157], a[248:251], v[222:225], v[154:157]
    s_waitcnt vmcnt(9)
    v_mfma_f32_16x16x32_bf16 v[158:161], a[250:253], v[226:229], v[158:161]
    buffer_load_dwordx4 v80, s[28:31], s63 offen offset:1024 sc1 lds
    v_mfma_f32_16x16x32_bf16 v[162:165], a[248:251], v[226:229], v[162:165]
    s_waitcnt lgkmcnt(1)
    v_mfma_f32_16x16x32_bf16 v[150:153], a[250:253], v[182:185], v[150:153]
    v_mfma_f32_16x16x32_bf16 v[154:157], a[248:251], v[182:185], v[154:157]
    buffer_load_dwordx4 v80, s[28:31], s63 offen offset:2048 sc1 lds
    s_add_u32 m0, s100, 94208
    s_waitcnt lgkmcnt(0)
    v_mfma_f32_16x16x32_bf16 v[158:161], a[250:253], v[186:189], v[158:161]
    s_add_u32 s62, s62, 262144
    s_cmp_eq_u32 s62, 1835008
    v_mfma_f32_16x16x32_bf16 v[162:165], a[248:251], v[186:189], v[162:165]
    s_cselect_b32 s62, 0, s62
    v_pk_mul_f32 v[182:183], v[150:151], v[150:151]
    v_pk_mul_f32 v[184:185], v[152:153], v[152:153]
    v_pk_mul_f32 v[186:187], v[154:155], v[154:155]
    v_pk_mul_f32 v[188:189], v[156:157], v[156:157]
    v_pk_fma_f32 v[182:183], v[182:183], s[78:79], v[108:109]
    buffer_load_dwordx4 v69, s[28:31], s62 offen sc1 lds
    v_pk_fma_f32 v[184:185], v[184:185], s[78:79], v[108:109]
    v_pk_fma_f32 v[186:187], v[186:187], s[78:79], v[108:109]
    v_pk_fma_f32 v[188:189], v[188:189], s[78:79], v[108:109]
    v_pk_mul_f32 v[182:183], v[182:183], v[150:151]
    v_pk_mul_f32 v[184:185], v[184:185], v[152:153]
    v_pk_mul_f32 v[186:187], v[186:187], v[154:155]
    v_pk_mul_f32 v[188:189], v[188:189], v[156:157]
    v_exp_f32 v182, v182
    v_exp_f32 v183, v183
    v_exp_f32 v184, v184
    v_exp_f32 v185, v185
    s_add_u32 m0, s58, 77824
    s_nop 0
    buffer_load_dwordx4 v67, s[28:31], s62 offen sc1 lds
    v_exp_f32 v186, v186
    v_exp_f32 v187, v187
    v_exp_f32 v188, v188
    v_exp_f32 v189, v189
    v_pk_add_f32 v[182:183], v[182:183], s[80:81]
    v_pk_add_f32 v[184:185], v[184:185], s[80:81]
    v_pk_add_f32 v[186:187], v[186:187], s[80:81]
    v_pk_add_f32 v[188:189], v[188:189], s[80:81]
    v_rcp_f32 v182, v182
    buffer_load_dwordx4 v67, s[28:31], s62 offen offset:1024 sc1 lds
    v_rcp_f32 v183, v183
    v_rcp_f32 v184, v184
    v_rcp_f32 v185, v185
    v_rcp_f32 v186, v186
    v_rcp_f32 v187, v187
    v_rcp_f32 v188, v188
    v_rcp_f32 v189, v189
    buffer_load_dwordx4 v68, s[28:31], s62 offen offset:2048 sc1 lds
    v_pk_mul_f32 v[182:183], v[182:183], v[150:151]
    v_pk_mul_f32 v[184:185], v[184:185], v[152:153]
    v_pk_mul_f32 v[186:187], v[186:187], v[154:155]
    v_pk_mul_f32 v[188:189], v[188:189], v[156:157]
    v_cvt_pk_bf16_f32 v110, v182, v183
    v_cvt_pk_bf16_f32 v111, v184, v185
    v_cvt_pk_bf16_f32 v112, v186, v187
    v_cvt_pk_bf16_f32 v113, v188, v189
    v_pk_mul_f32 v[190:191], v[158:159], v[158:159]
    v_pk_mul_f32 v[192:193], v[160:161], v[160:161]
    v_pk_mul_f32 v[194:195], v[162:163], v[162:163]
    v_pk_mul_f32 v[196:197], v[164:165], v[164:165]
    v_pk_fma_f32 v[190:191], v[190:191], s[78:79], v[108:109]
    buffer_load_dwordx4 v68, s[28:31], s62 offen offset:3072 sc1 lds
    v_pk_fma_f32 v[192:193], v[192:193], s[78:79], v[108:109]
    v_pk_fma_f32 v[194:195], v[194:195], s[78:79], v[108:109]
    v_pk_fma_f32 v[196:197], v[196:197], s[78:79], v[108:109]
    v_pk_mul_f32 v[190:191], v[190:191], v[158:159]
    v_pk_mul_f32 v[192:193], v[192:193], v[160:161]
    v_pk_mul_f32 v[194:195], v[194:195], v[162:163]
    v_pk_mul_f32 v[196:197], v[196:197], v[164:165]
    v_exp_f32 v190, v190
    v_exp_f32 v191, v191
    v_exp_f32 v192, v192
    v_exp_f32 v193, v193
    v_exp_f32 v194, v194
    v_exp_f32 v195, v195
    v_exp_f32 v196, v196
    v_exp_f32 v197, v197
    v_pk_add_f32 v[190:191], v[190:191], s[80:81]
    v_pk_add_f32 v[192:193], v[192:193], s[80:81]
    v_pk_add_f32 v[194:195], v[194:195], s[80:81]
    v_pk_add_f32 v[196:197], v[196:197], s[80:81]
    v_rcp_f32 v190, v190
    v_rcp_f32 v191, v191
    v_rcp_f32 v192, v192
    v_rcp_f32 v193, v193
    v_rcp_f32 v194, v194
    v_rcp_f32 v195, v195
    v_rcp_f32 v196, v196
    v_rcp_f32 v197, v197
    v_pk_mul_f32 v[190:191], v[190:191], v[158:159]
    v_pk_mul_f32 v[192:193], v[192:193], v[160:161]
    v_pk_mul_f32 v[194:195], v[194:195], v[162:163]
    v_pk_mul_f32 v[196:197], v[196:197], v[164:165]
    v_cvt_pk_bf16_f32 v114, v190, v191
    v_cvt_pk_bf16_f32 v115, v192, v193
    v_cvt_pk_bf16_f32 v116, v194, v195
    v_cvt_pk_bf16_f32 v117, v196, v197
    ds_read_b64_tr_b16 a[180:181], v72 offset:32768
    ds_read_b64_tr_b16 a[182:183], v72 offset:33024
    ds_read_b128 a[128:131], v53 offset:32768
    ds_read_b64_tr_b16 a[184:185], v72 offset:33792
    ds_read_b64_tr_b16 a[186:187], v72 offset:34048
    ds_read_b128 a[132:135], v53 offset:33792
    ds_read_b128 a[136:139], v53 offset:34816
    ds_read_b64_tr_b16 a[176:177], v73 offset:32768
    ds_read_b64_tr_b16 a[178:179], v73 offset:33024
    ds_read_b128 a[140:143], v53 offset:35840
    ds_read_b128 a[144:147], v53 offset:36864
    ds_read_b128 a[148:151], v53 offset:37888
    buffer_store_dwordx4 v[110:113], v4, s[28:31], s67 offen offset:0 sc1
    buffer_store_dwordx4 v[114:117], v4, s[28:31], s67 offen offset:1024 sc1
L_q:
    s_waitcnt lgkmcnt(6)
    v_mfma_f32_16x16x32_bf16 v[182:185], a[128:131], a[180:183], 0
    ds_read_b64_tr_b16 a[192:193], v72 offset:34816
    v_mfma_f32_16x16x32_bf16 v[190:193], a[128:131], a[184:187], 0
    ds_read_b64_tr_b16 a[194:195], v72 offset:35072
    v_mfma_f32_16x16x32_bf16 v[186:189], a[132:135], a[180:183], 0
    ds_read_b128 a[152:155], v53 offset:38912
    v_mfma_f32_16x16x32_bf16 v[194:197], a[132:135], a[184:187], 0
    ds_read_b64_tr_b16 a[196:197], v72 offset:35840
    s_waitcnt lgkmcnt(4)
    v_mfma_f32_16x16x32_bf16 v[206:209], a[136:139], a[180:183], 0
    ds_read_b64_tr_b16 a[198:199], v72 offset:36096
    v_mfma_f32_16x16x32_bf16 v[214:217], a[136:139], a[184:187], 0
    ds_read_b128 a[156:159], v53 offset:39936
    v_mfma_f32_16x16x32_bf16 v[198:201], a[136:139], a[176:179], 0
    ds_read_b128 a[160:163], v53 offset:40960
    v_mfma_f32_16x16x32_bf16 v[210:213], a[140:143], a[180:183], 0
    ds_read_b64_tr_b16 a[188:189], v73 offset:34816
    v_mfma_f32_16x16x32_bf16 v[218:221], a[140:143], a[184:187], 0
    ds_read_b64_tr_b16 a[190:191], v73 offset:35072
    v_mfma_f32_16x16x32_bf16 v[202:205], a[140:143], a[176:179], 0
    ds_read_b128 a[164:167], v53 offset:41984
    v_mfma_f32_16x16x32_bf16 v[230:233], a[180:183], a[144:147], 0
    ds_read_b128 a[168:171], v53 offset:43008
    v_mfma_f32_16x16x32_bf16 v[238:241], a[184:187], a[144:147], 0
    ds_read_b128 a[172:175], v53 offset:44032
    v_mfma_f32_16x16x32_bf16 v[222:225], a[176:179], a[144:147], 0
    v_mfma_f32_16x16x32_bf16 v[234:237], a[180:183], a[148:151], 0
    v_mfma_f32_16x16x32_bf16 v[242:245], a[184:187], a[148:151], 0
    v_mfma_f32_16x16x32_bf16 v[226:229], a[176:179], a[148:151], 0
    s_waitcnt lgkmcnt(0)
    s_barrier
    v_mfma_f32_16x16x32_bf16 v[182:185], a[152:155], a[192:195], v[182:185]
    ds_read_b64_tr_b16 a[180:181], v74 offset:0
    s_add_u32 m0, s59, 32768
    v_mfma_f32_16x16x32_bf16 v[190:193], a[152:155], a[196:199], v[190:193]
    ds_read_b64_tr_b16 a[182:183], v74 offset:256
    s_add_u32 s63, s63, 12288
    v_mfma_f32_16x16x32_bf16 v[186:189], a[156:159], a[192:195], v[186:189]
    ds_read_b128 a[128:131], v54 offset:0
    s_cmp_eq_u32 s63, 86016
    v_mfma_f32_16x16x32_bf16 v[194:197], a[156:159], a[196:199], v[194:197]
    ds_read_b64_tr_b16 a[184:185], v74 offset:1024
    v_mfma_f32_16x16x32_bf16 v[206:209], a[160:163], a[192:195], v[206:209]
    ds_read_b64_tr_b16 a[186:187], v74 offset:1280
    s_cselect_b32 s63, 0, s63
    v_mfma_f32_16x16x32_bf16 v[214:217], a[160:163], a[196:199], v[214:217]
    ds_read_b128 a[132:135], v54 offset:1024
    buffer_load_dwordx4 v80, s[28:31], s63 offen sc1 lds
    v_mfma_f32_16x16x32_bf16 v[198:201], a[160:163], a[188:191], v[198:201]
    ds_read_b128 a[136:139], v54 offset:2048
    v_mfma_f32_16x16x32_bf16 v[210:213], a[164:167], a[192:195], v[210:213]
    ds_read_b64_tr_b16 a[176:177], v75 offset:0
    buffer_load_dwordx4 v80, s[28:31], s63 offen offset:1024 sc1 lds
    v_mfma_f32_16x16x32_bf16 v[218:221], a[164:167], a[196:199], v[218:221]
    ds_read_b64_tr_b16 a[178:179], v75 offset:256
    v_mfma_f32_16x16x32_bf16 v[202:205], a[164:167], a[188:191], v[202:205]
    ds_read_b128 a[140:143], v54 offset:3072
    v_mfma_f32_16x16x32_bf16 v[230:233], a[192:195], a[168:171], v[230:233]
    ds_read_b128 a[144:147], v54 offset:4096
    buffer_load_dwordx4 v80, s[28:31], s63 offen offset:2048 sc1 lds
    v_mfma_f32_16x16x32_bf16 v[238:241], a[196:199], a[168:171], v[238:241]
    ds_read_b128 a[148:151], v54 offset:5120
    s_add_u32 m0, s100, 61440
    v_mfma_f32_16x16x32_bf16 v[222:225], a[188:191], a[168:171], v[222:225]
    s_add_u32 s62, s62, 262144
    s_cmp_eq_u32 s62, 1835008
    v_mfma_f32_16x16x32_bf16 v[234:237], a[192:195], a[172:175], v[234:237]
    s_cselect_b32 s62, 0, s62
    buffer_load_dwordx4 v69, s[28:31], s62 offen sc1 lds
    v_mfma_f32_16x16x32_bf16 v[242:245], a[196:199], a[172:175], v[242:245]
    s_add_u32 m0, s58, 45056
    v_mfma_f32_16x16x32_bf16 v[226:229], a[188:191], a[172:175], v[226:229]
    s_waitcnt lgkmcnt(6)
    v_mfma_f32_16x16x32_bf16 v[182:185], a[128:131], a[180:183], v[182:185]
    ds_read_b64_tr_b16 a[192:193], v74 offset:2048
    buffer_load_dwordx4 v67, s[28:31], s62 offen sc1 lds
    v_mfma_f32_16x16x32_bf16 v[190:193], a[128:131], a[184:187], v[190:193]
    ds_read_b64_tr_b16 a[194:195], v74 offset:2304
    v_mfma_f32_16x16x32_bf16 v[186:189], a[132:135], a[180:183], v[186:189]
    ds_read_b128 a[152:155], v54 offset:6144
    v_mfma_f32_16x16x32_bf16 v[194:197], a[132:135], a[184:187], v[194:197]
    ds_read_b64_tr_b16 a[196:197], v74 offset:3072
    s_waitcnt lgkmcnt(4)
    v_mfma_f32_16x16x32_bf16 v[206:209], a[136:139], a[180:183], v[206:209]
    ds_read_b64_tr_b16 a[198:199], v74 offset:3328
    buffer_load_dwordx4 v67, s[28:31], s62 offen offset:1024 sc1 lds
    v_mfma_f32_16x16x32_bf16 v[214:217], a[136:139], a[184:187], v[214:217]
    ds_read_b128 a[156:159], v54 offset:7168
    v_mfma_f32_16x16x32_bf16 v[198:201], a[136:139], a[176:179], v[198:201]
    ds_read_b128 a[160:163], v54 offset:8192
    buffer_load_dwordx4 v68, s[28:31], s62 offen offset:2048 sc1 lds
    v_mfma_f32_16x16x32_bf16 v[210:213], a[140:143], a[180:183], v[210:213]
    ds_read_b64_tr_b16 a[188:189], v75 offset:2048
    v_mfma_f32_16x16x32_bf16 v[218:221], a[140:143], a[184:187], v[218:221]
    ds_read_b64_tr_b16 a[190:191], v75 offset:2304
    v_mfma_f32_16x16x32_bf16 v[202:205], a[140:143], a[176:179], v[202:205]
    ds_read_b128 a[164:167], v54 offset:9216
    buffer_load_dwordx4 v68, s[28:31], s62 offen offset:3072 sc1 lds
    v_mfma_f32_16x16x32_bf16 v[230:233], a[180:183], a[144:147], v[230:233]
    ds_read_b128 a[168:171], v54 offset:10240
    s_add_u32 m0, s59, 98304
    v_mfma_f32_16x16x32_bf16 v[238:241], a[184:187], a[144:147], v[238:241]
    ds_read_b128 a[172:175], v54 offset:11264
    s_add_u32 s63, s63, 12288
    v_mfma_f32_16x16x32_bf16 v[222:225], a[176:179], a[144:147], v[222:225]
    s_cmp_eq_u32 s63, 86016
    s_cselect_b32 s63, 0, s63
    v_mfma_f32_16x16x32_bf16 v[234:237], a[180:183], a[148:151], v[234:237]
    buffer_load_dwordx4 v80, s[28:31], s63 offen sc1 lds
    v_mfma_f32_16x16x32_bf16 v[242:245], a[184:187], a[148:151], v[242:245]
    v_mfma_f32_16x16x32_bf16 v[226:229], a[176:179], a[148:151], v[226:229]
    s_waitcnt vmcnt(9) lgkmcnt(0)
    s_barrier
    s_cmp_lg_u32 s48, 0
    s_cbranch_scc1 L_sig2
    s_atomic_add s36, s[28:29], s68
L_sig2:
    v_mfma_f32_16x16x32_bf16 v[182:185], a[152:155], a[192:195], v[182:185]
    ds_read_b64_tr_b16 a[180:181], v70 offset:0
    buffer_load_dwordx4 v80, s[28:31], s63 offen offset:1024 sc1 lds
    v_mfma_f32_16x16x32_bf16 v[190:193], a[152:155], a[196:199], v[190:193]
    ds_read_b64_tr_b16 a[182:183], v70 offset:256
    v_mfma_f32_16x16x32_bf16 v[186:189], a[156:159], a[192:195], v[186:189]
    ds_read_b128 a[128:131], v4 offset:0
    buffer_load_dwordx4 v80, s[28:31], s63 offen offset:2048 sc1 lds
    v_mfma_f32_16x16x32_bf16 v[194:197], a[156:159], a[196:199], v[194:197]
    ds_read_b64_tr_b16 a[184:185], v70 offset:1024
    v_mfma_f32_16x16x32_bf16 v[206:209], a[160:163], a[192:195], v[206:209]
    ds_read_b64_tr_b16 a[186:187], v70 offset:1280
    s_add_u32 m0, s100, 126976
    v_mfma_f32_16x16x32_bf16 v[214:217], a[160:163], a[196:199], v[214:217]
    ds_read_b128 a[132:135], v4 offset:1024
    s_add_u32 s62, s62, 262144
    v_mfma_f32_16x16x32_bf16 v[198:201], a[160:163], a[188:191], v[198:201]
    ds_read_b128 a[136:139], v4 offset:2048
    s_cmp_eq_u32 s62, 1835008
    v_mfma_f32_16x16x32_bf16 v[210:213], a[164:167], a[192:195], v[210:213]
    ds_read_b64_tr_b16 a[176:177], v71 offset:0
    s_cselect_b32 s62, 0, s62
    v_mfma_f32_16x16x32_bf16 v[218:221], a[164:167], a[196:199], v[218:221]
    ds_read_b64_tr_b16 a[178:179], v71 offset:256
    buffer_load_dwordx4 v69, s[28:31], s62 offen sc1 lds
    v_mfma_f32_16x16x32_bf16 v[202:205], a[164:167], a[188:191], v[202:205]
    ds_read_b128 a[140:143], v4 offset:3072
    s_add_u32 m0, s58, 110592
    v_mfma_f32_16x16x32_bf16 v[230:233], a[192:195], a[168:171], v[230:233]
    ds_read_b128 a[144:147], v4 offset:4096
    buffer_load_dwordx4 v67, s[28:31], s62 offen sc1 lds
    v_mfma_f32_16x16x32_bf16 v[238:241], a[196:199], a[168:171], v[238:241]
    ds_read_b128 a[148:151], v4 offset:5120
    v_mfma_f32_16x16x32_bf16 v[222:225], a[188:191], a[168:171], v[222:225]
    v_mfma_f32_16x16x32_bf16 v[234:237], a[192:195], a[172:175], v[234:237]
    buffer_load_dwordx4 v67, s[28:31], s62 offen offset:1024 sc1 lds
    v_mfma_f32_16x16x32_bf16 v[242:245], a[196:199], a[172:175], v[242:245]
    v_mfma_f32_16x16x32_bf16 v[226:229], a[188:191], a[172:175], v[226:229]
    s_waitcnt lgkmcnt(6)
    v_mfma_f32_16x16x32_bf16 v[182:185], a[128:131], a[180:183], v[182:185]
    ds_read_b64_tr_b16 a[192:193], v70 offset:2048
    buffer_load_dwordx4 v68, s[28:31], s62 offen offset:2048 sc1 lds
    v_mfma_f32_16x16x32_bf16 v[190:193], a[128:131], a[184:187], v[190:193]
    ds_read_b64_tr_b16 a[194:195], v70 offset:2304
    v_mfma_f32_16x16x32_bf16 v[186:189], a[132:135], a[180:183], v[186:189]
    ds_read_b128 a[152:155], v4 offset:6144
    v_mfma_f32_16x16x32_bf16 v[194:197], a[132:135], a[184:187], v[194:197]
    ds_read_b64_tr_b16 a[196:197], v70 offset:3072
    s_waitcnt lgkmcnt(4)
    v_mfma_f32_16x16x32_bf16 v[206:209], a[136:139], a[180:183], v[206:209]
    ds_read_b64_tr_b16 a[198:199], v70 offset:3328
    buffer_load_dwordx4 v68, s[28:31], s62 offen offset:3072 sc1 lds
    v_mfma_f32_16x16x32_bf16 v[214:217], a[136:139], a[184:187], v[214:217]
    ds_read_b128 a[156:159], v4 offset:7168
    s_add_u32 m0, s59, 131072
    v_mfma_f32_16x16x32_bf16 v[198:201], a[136:139], a[176:179], v[198:201]
    ds_read_b128 a[160:163], v4 offset:8192
    s_add_u32 s63, s63, 12288
    v_mfma_f32_16x16x32_bf16 v[210:213], a[140:143], a[180:183], v[210:213]
    ds_read_b64_tr_b16 a[188:189], v71 offset:2048
    s_cmp_eq_u32 s63, 86016
    v_mfma_f32_16x16x32_bf16 v[218:221], a[140:143], a[184:187], v[218:221]
    ds_read_b64_tr_b16 a[190:191], v71 offset:2304
    s_cselect_b32 s63, 0, s63
    v_mfma_f32_16x16x32_bf16 v[202:205], a[140:143], a[176:179], v[202:205]
    ds_read_b128 a[164:167], v4 offset:9216
    buffer_load_dwordx4 v80, s[28:31], s63 offen sc1 lds
    v_mfma_f32_16x16x32_bf16 v[230:233], a[180:183], a[144:147], v[230:233]
    ds_read_b128 a[168:171], v4 offset:10240
    v_mfma_f32_16x16x32_bf16 v[238:241], a[184:187], a[144:147], v[238:241]
    ds_read_b128 a[172:175], v4 offset:11264
    buffer_load_dwordx4 v80, s[28:31], s63 offen offset:1024 sc1 lds
    v_mfma_f32_16x16x32_bf16 v[222:225], a[176:179], a[144:147], v[222:225]
    v_mfma_f32_16x16x32_bf16 v[234:237], a[180:183], a[148:151], v[234:237]
    v_mfma_f32_16x16x32_bf16 v[242:245], a[184:187], a[148:151], v[242:245]
    buffer_load_dwordx4 v80, s[28:31], s63 offen offset:2048 sc1 lds
    s_add_u32 m0, s100, 159744
    v_mfma_f32_16x16x32_bf16 v[226:229], a[176:179], a[148:151], v[226:229]
    s_add_u32 s62, s62, 262144
    ds_read_b32 v24, v4
    s_waitcnt lgkmcnt(1)
    s_barrier
    v_mfma_f32_16x16x32_bf16 v[182:185], a[152:155], a[192:195], v[182:185]
    ds_read_b64_tr_b16 a[180:181], v72 offset:0
    s_cmp_eq_u32 s62, 1835008
    v_mfma_f32_16x16x32_bf16 v[190:193], a[152:155], a[196:199], v[190:193]
    ds_read_b64_tr_b16 a[182:183], v72 offset:256
    s_cselect_b32 s62, 0, s62
    v_mfma_f32_16x16x32_bf16 v[186:189], a[156:159], a[192:195], v[186:189]
    ds_read_b128 a[128:131], v53 offset:0
    buffer_load_dwordx4 v69, s[28:31], s62 offen sc1 lds
    v_mfma_f32_16x16x32_bf16 v[194:197], a[156:159], a[196:199], v[194:197]
    ds_read_b64_tr_b16 a[184:185], v72 offset:1024
    v_mfma_f32_16x16x32_bf16 v[206:209], a[160:163], a[192:195], v[206:209]
    ds_read_b64_tr_b16 a[186:187], v72 offset:1280
    s_add_u32 m0, s58, 143360
    v_mfma_f32_16x16x32_bf16 v[214:217], a[160:163], a[196:199], v[214:217]
    ds_read_b128 a[132:135], v53 offset:1024
    buffer_load_dwordx4 v67, s[28:31], s62 offen sc1 lds
    v_mfma_f32_16x16x32_bf16 v[198:201], a[160:163], a[188:191], v[198:201]
    ds_read_b128 a[136:139], v53 offset:2048
    v_mfma_f32_16x16x32_bf16 v[210:213], a[164:167], a[192:195], v[210:213]
    ds_read_b64_tr_b16 a[176:177], v73 offset:0
    buffer_load_dwordx4 v67, s[28:31], s62 offen offset:1024 sc1 lds
    v_mfma_f32_16x16x32_bf16 v[218:221], a[164:167], a[196:199], v[218:221]
    ds_read_b64_tr_b16 a[178:179], v73 offset:256
    v_mfma_f32_16x16x32_bf16 v[202:205], a[164:167], a[188:191], v[202:205]
    ds_read_b128 a[140:143], v53 offset:3072
    v_mfma_f32_16x16x32_bf16 v[230:233], a[192:195], a[168:171], v[230:233]
    ds_read_b128 a[144:147], v53 offset:4096
    buffer_load_dwordx4 v68, s[28:31], s62 offen offset:2048 sc1 lds
    v_mfma_f32_16x16x32_bf16 v[238:241], a[196:199], a[168:171], v[238:241]
    ds_read_b128 a[148:151], v53 offset:5120
    v_mfma_f32_16x16x32_bf16 v[222:225], a[188:191], a[168:171], v[222:225]
    v_mfma_f32_16x16x32_bf16 v[234:237], a[192:195], a[172:175], v[234:237]
    buffer_load_dwordx4 v68, s[28:31], s62 offen offset:3072 sc1 lds
    s_add_u32 m0, s58, 0
    v_mfma_f32_16x16x32_bf16 v[242:245], a[196:199], a[172:175], v[242:245]
    v_mfma_f32_16x16x32_bf16 v[226:229], a[188:191], a[172:175], v[226:229]
    s_waitcnt lgkmcnt(6)
    v_mfma_f32_16x16x32_bf16 v[182:185], a[128:131], a[180:183], v[182:185]
    ds_read_b64_tr_b16 a[192:193], v72 offset:2048
    buffer_load_dwordx4 v59, s[24:27], s64 offen lds
    v_mfma_f32_16x16x32_bf16 v[190:193], a[128:131], a[184:187], v[190:193]
    ds_read_b64_tr_b16 a[194:195], v72 offset:2304
    v_mfma_f32_16x16x32_bf16 v[186:189], a[132:135], a[180:183], v[186:189]
    ds_read_b128 a[152:155], v53 offset:6144
    v_mfma_f32_16x16x32_bf16 v[194:197], a[132:135], a[184:187], v[194:197]
    ds_read_b64_tr_b16 a[196:197], v72 offset:3072
    s_waitcnt lgkmcnt(4)
    v_mfma_f32_16x16x32_bf16 v[206:209], a[136:139], a[180:183], v[206:209]
    ds_read_b64_tr_b16 a[198:199], v72 offset:3328
    buffer_load_dwordx4 v60, s[24:27], s64 offen offset:1024 lds
    v_mfma_f32_16x16x32_bf16 v[214:217], a[136:139], a[184:187], v[214:217]
    ds_read_b128 a[156:159], v53 offset:7168
    v_mfma_f32_16x16x32_bf16 v[198:201], a[136:139], a[176:179], v[198:201]
    ds_read_b128 a[160:163], v53 offset:8192
    v_mfma_f32_16x16x32_bf16 v[210:213], a[140:143], a[180:183], v[210:213]
    ds_read_b64_tr_b16 a[188:189], v73 offset:2048
    buffer_load_dwordx4 v61, s[24:27], s64 offen offset:2048 lds
    v_mfma_f32_16x16x32_bf16 v[218:221], a[140:143], a[184:187], v[218:221]
    ds_read_b64_tr_b16 a[190:191], v73 offset:2304
    v_mfma_f32_16x16x32_bf16 v[202:205], a[140:143], a[176:179], v[202:205]
    ds_read_b128 a[164:167], v53 offset:9216
    v_mfma_f32_16x16x32_bf16 v[230:233], a[180:183], a[144:147], v[230:233]
    ds_read_b128 a[168:171], v53 offset:10240
    buffer_load_dwordx4 v62, s[24:27], s64 offen offset:3072 lds
    v_mfma_f32_16x16x32_bf16 v[238:241], a[184:187], a[144:147], v[238:241]
    ds_read_b128 a[172:175], v53 offset:11264
    s_add_u32 m0, s58, 16384
    v_mfma_f32_16x16x32_bf16 v[222:225], a[176:179], a[144:147], v[222:225]
    v_xor_b32 v59, 128, v59
    v_mfma_f32_16x16x32_bf16 v[234:237], a[180:183], a[148:151], v[234:237]
    buffer_load_dwordx4 v59, s[24:27], s64 offen lds
    v_xor_b32 v60, 128, v60
    v_mfma_f32_16x16x32_bf16 v[242:245], a[184:187], a[148:151], v[242:245]
    v_mfma_f32_16x16x32_bf16 v[226:229], a[176:179], a[148:151], v[226:229]
    ds_read_b32 v24, v4
    s_waitcnt vmcnt(21) lgkmcnt(1)
    s_barrier
    v_mfma_f32_16x16x32_bf16 v[182:185], a[152:155], a[192:195], v[182:185]
    ds_read_b64_tr_b16 a[180:181], v70 offset:32768
    buffer_load_dwordx4 v60, s[24:27], s64 offen offset:1024 lds
    v_mfma_f32_16x16x32_bf16 v[190:193], a[152:155], a[196:199], v[190:193]
    ds_read_b64_tr_b16 a[182:183], v70 offset:33024
    v_xor_b32 v61, 128, v61
    v_mfma_f32_16x16x32_bf16 v[186:189], a[156:159], a[192:195], v[186:189]
    ds_read_b128 a[128:131], v4 offset:32768
    v_mfma_f32_16x16x32_bf16 v[194:197], a[156:159], a[196:199], v[194:197]
    ds_read_b64_tr_b16 a[184:185], v70 offset:33792
    v_mfma_f32_16x16x32_bf16 v[206:209], a[160:163], a[192:195], v[206:209]
    ds_read_b64_tr_b16 a[186:187], v70 offset:34048
    buffer_load_dwordx4 v61, s[24:27], s64 offen offset:2048 lds
    v_mfma_f32_16x16x32_bf16 v[214:217], a[160:163], a[196:199], v[214:217]
    ds_read_b128 a[132:135], v4 offset:33792
    v_xor_b32 v62, 128, v62
    v_mfma_f32_16x16x32_bf16 v[198:201], a[160:163], a[188:191], v[198:201]
    ds_read_b128 a[136:139], v4 offset:34816
    buffer_load_dwordx4 v62, s[24:27], s64 offen offset:3072 lds
    v_mfma_f32_16x16x32_bf16 v[210:213], a[164:167], a[192:195], v[210:213]
    ds_read_b64_tr_b16 a[176:177], v71 offset:32768
    s_add_u32 m0, s58, 65536
    v_mfma_f32_16x16x32_bf16 v[218:221], a[164:167], a[196:199], v[218:221]
    ds_read_b64_tr_b16 a[178:179], v71 offset:33024
    s_add_u32 s64, s64, 524288
    v_mfma_f32_16x16x32_bf16 v[202:205], a[164:167], a[188:191], v[202:205]
    ds_read_b128 a[140:143], v4 offset:35840
    s_cmp_eq_u32 s64, 3670016
    v_mfma_f32_16x16x32_bf16 v[230:233], a[192:195], a[168:171], v[230:233]
    ds_read_b128 a[144:147], v4 offset:36864
    s_cselect_b32 s64, 0, s64
    v_mfma_f32_16x16x32_bf16 v[238:241], a[196:199], a[168:171], v[238:241]
    ds_read_b128 a[148:151], v4 offset:37888
    buffer_load_dwordx4 v59, s[24:27], s64 offen lds
    v_mfma_f32_16x16x32_bf16 v[222:225], a[188:191], a[168:171], v[222:225]
    v_mfma_f32_16x16x32_bf16 v[234:237], a[192:195], a[172:175], v[234:237]
    buffer_load_dwordx4 v60, s[24:27], s64 offen offset:1024 lds
    v_mfma_f32_16x16x32_bf16 v[242:245], a[196:199], a[172:175], v[242:245]
    v_mfma_f32_16x16x32_bf16 v[226:229], a[188:191], a[172:175], v[226:229]
    s_waitcnt lgkmcnt(6)
    v_mfma_f32_16x16x32_bf16 v[182:185], a[128:131], a[180:183], v[182:185]
    ds_read_b64_tr_b16 a[192:193], v70 offset:34816
    buffer_load_dwordx4 v61, s[24:27], s64 offen offset:2048 lds
    v_mfma_f32_16x16x32_bf16 v[190:193], a[128:131], a[184:187], v[190:193]
    ds_read_b64_tr_b16 a[194:195], v70 offset:35072
    v_mfma_f32_16x16x32_bf16 v[186:189], a[132:135], a[180:183], v[186:189]
    ds_read_b128 a[152:155], v4 offset:38912
    v_mfma_f32_16x16x32_bf16 v[194:197], a[132:135], a[184:187], v[194:197]
    ds_read_b64_tr_b16 a[196:197], v70 offset:35840
    s_waitcnt lgkmcnt(4)
    v_mfma_f32_16x16x32_bf16 v[206:209], a[136:139], a[180:183], v[206:209]
    ds_read_b64_tr_b16 a[198:199], v70 offset:36096
    buffer_load_dwordx4 v62, s[24:27], s64 offen offset:3072 lds
    v_mfma_f32_16x16x32_bf16 v[214:217], a[136:139], a[184:187], v[214:217]
    ds_read_b128 a[156:159], v4 offset:39936
    s_add_u32 m0, s58, 81920
    v_mfma_f32_16x16x32_bf16 v[198:201], a[136:139], a[176:179], v[198:201]
    ds_read_b128 a[160:163], v4 offset:40960
    s_add_u32 s64, s64, 524288
    v_mfma_f32_16x16x32_bf16 v[210:213], a[140:143], a[180:183], v[210:213]
    ds_read_b64_tr_b16 a[188:189], v71 offset:34816
    s_cmp_eq_u32 s64, 3670016
    v_mfma_f32_16x16x32_bf16 v[218:221], a[140:143], a[184:187], v[218:221]
    ds_read_b64_tr_b16 a[190:191], v71 offset:35072
    s_cselect_b32 s64, 0, s64
    v_mfma_f32_16x16x32_bf16 v[202:205], a[140:143], a[176:179], v[202:205]
    ds_read_b128 a[164:167], v4 offset:41984
    buffer_load_dwordx4 v59, s[24:27], s64 offen lds
    v_mfma_f32_16x16x32_bf16 v[230:233], a[180:183], a[144:147], v[230:233]
    ds_read_b128 a[168:171], v4 offset:43008
    v_mfma_f32_16x16x32_bf16 v[238:241], a[184:187], a[144:147], v[238:241]
    ds_read_b128 a[172:175], v4 offset:44032
    buffer_load_dwordx4 v60, s[24:27], s64 offen offset:1024 lds
    v_mfma_f32_16x16x32_bf16 v[222:225], a[176:179], a[144:147], v[222:225]
    v_mfma_f32_16x16x32_bf16 v[234:237], a[180:183], a[148:151], v[234:237]
    v_mfma_f32_16x16x32_bf16 v[242:245], a[184:187], a[148:151], v[242:245]
    buffer_load_dwordx4 v61, s[24:27], s64 offen offset:2048 lds
    v_mfma_f32_16x16x32_bf16 v[226:229], a[176:179], a[148:151], v[226:229]
    ds_read_b32 v24, v4
    s_waitcnt vmcnt(23) lgkmcnt(1)
    s_barrier
    v_mfma_f32_16x16x32_bf16 v[182:185], a[152:155], a[192:195], v[182:185]
    ds_read_b64_tr_b16 a[180:181], v72 offset:32768
    v_mfma_f32_16x16x32_bf16 v[190:193], a[152:155], a[196:199], v[190:193]
    ds_read_b64_tr_b16 a[182:183], v72 offset:33024
    buffer_load_dwordx4 v62, s[24:27], s64 offen offset:3072 lds
    v_mfma_f32_16x16x32_bf16 v[186:189], a[156:159], a[192:195], v[186:189]
    ds_read_b128 a[128:131], v53 offset:32768
    s_add_u32 m0, s58, 32768
    v_mfma_f32_16x16x32_bf16 v[194:197], a[156:159], a[196:199], v[194:197]
    ds_read_b64_tr_b16 a[184:185], v72 offset:33792
    v_mfma_f32_16x16x32_bf16 v[206:209], a[160:163], a[192:195], v[206:209]
    ds_read_b64_tr_b16 a[186:187], v72 offset:34048
    s_add_u32 s64, s64, 524288
    v_mfma_f32_16x16x32_bf16 v[214:217], a[160:163], a[196:199], v[214:217]
    ds_read_b128 a[132:135], v53 offset:33792
    s_cmp_eq_u32 s64, 3670016
    v_mfma_f32_16x16x32_bf16 v[198:201], a[160:163], a[188:191], v[198:201]
    ds_read_b128 a[136:139], v53 offset:34816
    s_cselect_b32 s64, 0, s64
    v_mfma_f32_16x16x32_bf16 v[210:213], a[164:167], a[192:195], v[210:213]
    ds_read_b64_tr_b16 a[176:177], v73 offset:32768
    buffer_load_dwordx4 v59, s[24:27], s64 offen lds
    v_mfma_f32_16x16x32_bf16 v[218:221], a[164:167], a[196:199], v[218:221]
    ds_read_b64_tr_b16 a[178:179], v73 offset:33024
    v_mfma_f32_16x16x32_bf16 v[202:205], a[164:167], a[188:191], v[202:205]
    ds_read_b128 a[140:143], v53 offset:35840
    buffer_load_dwordx4 v60, s[24:27], s64 offen offset:1024 lds
    v_mfma_f32_16x16x32_bf16 v[230:233], a[192:195], a[168:171], v[230:233]
    ds_read_b128 a[144:147], v53 offset:36864
    v_mfma_f32_16x16x32_bf16 v[238:241], a[196:199], a[168:171], v[238:241]
    ds_read_b128 a[148:151], v53 offset:37888
    v_mfma_f32_16x16x32_bf16 v[222:225], a[188:191], a[168:171], v[222:225]
    buffer_load_dwordx4 v61, s[24:27], s64 offen offset:2048 lds
    v_mfma_f32_16x16x32_bf16 v[234:237], a[192:195], a[172:175], v[234:237]
    v_mfma_f32_16x16x32_bf16 v[242:245], a[196:199], a[172:175], v[242:245]
    v_mfma_f32_16x16x32_bf16 v[226:229], a[188:191], a[172:175], v[226:229]
    buffer_load_dwordx4 v62, s[24:27], s64 offen offset:3072 lds
    s_waitcnt lgkmcnt(6)
    v_mfma_f32_16x16x32_bf16 v[182:185], a[128:131], a[180:183], v[182:185]
    ds_read_b64_tr_b16 a[192:193], v72 offset:34816
    s_add_u32 m0, s58, 49152
    v_mfma_f32_16x16x32_bf16 v[190:193], a[128:131], a[184:187], v[190:193]
    ds_read_b64_tr_b16 a[194:195], v72 offset:35072
    s_add_u32 s64, s64, 524288
    v_mfma_f32_16x16x32_bf16 v[186:189], a[132:135], a[180:183], v[186:189]
    ds_read_b128 a[152:155], v53 offset:38912
    s_cmp_eq_u32 s64, 3670016
    v_mfma_f32_16x16x32_bf16 v[194:197], a[132:135], a[184:187], v[194:197]
    ds_read_b64_tr_b16 a[196:197], v72 offset:35840
    s_waitcnt lgkmcnt(4)
    v_mfma_f32_16x16x32_bf16 v[206:209], a[136:139], a[180:183], v[206:209]
    ds_read_b64_tr_b16 a[198:199], v72 offset:36096
    s_cselect_b32 s64, 0, s64
    v_mfma_f32_16x16x32_bf16 v[214:217], a[136:139], a[184:187], v[214:217]
    ds_read_b128 a[156:159], v53 offset:39936
    buffer_load_dwordx4 v59, s[24:27], s64 offen lds
    v_mfma_f32_16x16x32_bf16 v[198:201], a[136:139], a[176:179], v[198:201]
    ds_read_b128 a[160:163], v53 offset:40960
    v_mfma_f32_16x16x32_bf16 v[210:213], a[140:143], a[180:183], v[210:213]
    ds_read_b64_tr_b16 a[188:189], v73 offset:34816
    buffer_load_dwordx4 v60, s[24:27], s64 offen offset:1024 lds
    v_mfma_f32_16x16x32_bf16 v[218:221], a[140:143], a[184:187], v[218:221]
    ds_read_b64_tr_b16 a[190:191], v73 offset:35072
    v_mfma_f32_16x16x32_bf16 v[202:205], a[140:143], a[176:179], v[202:205]
L_pad2:
    s_cbranch_execz L_warm
    ds_read_b128 a[164:167], v53 offset:41984
    v_mfma_f32_16x16x32_bf16 v[230:233], a[180:183], a[144:147], v[230:233]
    ds_read_b128 a[168:171], v53 offset:43008
    buffer_load_dwordx4 v61, s[24:27], s64 offen offset:2048 lds
    v_mfma_f32_16x16x32_bf16 v[238:241], a[184:187], a[144:147], v[238:241]
    ds_read_b128 a[172:175], v53 offset:44032
    v_mfma_f32_16x16x32_bf16 v[222:225], a[176:179], a[144:147], v[222:225]
    v_mfma_f32_16x16x32_bf16 v[234:237], a[180:183], a[148:151], v[234:237]
    buffer_load_dwordx4 v62, s[24:27], s64 offen offset:3072 lds
    v_mfma_f32_16x16x32_bf16 v[242:245], a[184:187], a[148:151], v[242:245]
    v_mfma_f32_16x16x32_bf16 v[226:229], a[176:179], a[148:151], v[226:229]
    ds_read_b32 v24, v4
    s_waitcnt vmcnt(24) lgkmcnt(1)
    s_barrier
    s_mov_b32 s14, 0
    s_load_dword s14, s[28:29], s38
    v_mfma_f32_16x16x32_bf16 v[182:185], a[152:155], a[192:195], v[182:185]
    ds_read_b64_tr_b16 a[180:181], v74 offset:0
    s_add_u32 m0, s58, 98304
    v_mfma_f32_16x16x32_bf16 v[190:193], a[152:155], a[196:199], v[190:193]
    ds_read_b64_tr_b16 a[182:183], v74 offset:256
    s_add_u32 s64, s64, 524288
    v_mfma_f32_16x16x32_bf16 v[186:189], a[156:159], a[192:195], v[186:189]
    ds_read_b128 a[128:131], v54 offset:0
    s_cmp_eq_u32 s64, 3670016
    v_mfma_f32_16x16x32_bf16 v[194:197], a[156:159], a[196:199], v[194:197]
    ds_read_b64_tr_b16 a[184:185], v74 offset:1024
    v_mfma_f32_16x16x32_bf16 v[206:209], a[160:163], a[192:195], v[206:209]
    ds_read_b64_tr_b16 a[186:187], v74 offset:1280
    s_cselect_b32 s64, 0, s64
    v_mfma_f32_16x16x32_bf16 v[214:217], a[160:163], a[196:199], v[214:217]
    ds_read_b128 a[132:135], v54 offset:1024
    buffer_load_dwordx4 v59, s[24:27], s64 offen lds
    v_mfma_f32_16x16x32_bf16 v[198:201], a[160:163], a[188:191], v[198:201]
    ds_read_b128 a[136:139], v54 offset:2048
    v_mfma_f32_16x16x32_bf16 v[210:213], a[164:167], a[192:195], v[210:213]
    ds_read_b64_tr_b16 a[176:177], v75 offset:0
    buffer_load_dwordx4 v60, s[24:27], s64 offen offset:1024 lds
    v_mfma_f32_16x16x32_bf16 v[218:221], a[164:167], a[196:199], v[218:221]
    ds_read_b64_tr_b16 a[178:179], v75 offset:256
    v_mfma_f32_16x16x32_bf16 v[202:205], a[164:167], a[188:191], v[202:205]
    ds_read_b128 a[140:143], v54 offset:3072
    v_mfma_f32_16x16x32_bf16 v[230:233], a[192:195], a[168:171], v[230:233]
    ds_read_b128 a[144:147], v54 offset:4096
    buffer_load_dwordx4 v61, s[24:27], s64 offen offset:2048 lds
    v_mfma_f32_16x16x32_bf16 v[238:241], a[196:199], a[168:171], v[238:241]
    ds_read_b128 a[148:151], v54 offset:5120
    v_mfma_f32_16x16x32_bf16 v[222:225], a[188:191], a[168:171], v[222:225]
    v_mfma_f32_16x16x32_bf16 v[234:237], a[192:195], a[172:175], v[234:237]
    buffer_load_dwordx4 v62, s[24:27], s64 offen offset:3072 lds
    s_add_u32 m0, s58, 114688
    v_mfma_f32_16x16x32_bf16 v[242:245], a[196:199], a[172:175], v[242:245]
    s_add_u32 s64, s64, 524288
    s_cmp_eq_u32 s64, 3670016
    v_mfma_f32_16x16x32_bf16 v[226:229], a[188:191], a[172:175], v[226:229]
    s_cselect_b32 s64, 0, s64
    s_waitcnt lgkmcnt(6)
    v_mfma_f32_16x16x32_bf16 v[182:185], a[128:131], a[180:183], v[182:185]
    ds_read_b64_tr_b16 a[192:193], v74 offset:2048
    buffer_load_dwordx4 v59, s[24:27], s64 offen lds
    v_mfma_f32_16x16x32_bf16 v[190:193], a[128:131], a[184:187], v[190:193]
    ds_read_b64_tr_b16 a[194:195], v74 offset:2304
    v_mfma_f32_16x16x32_bf16 v[186:189], a[132:135], a[180:183], v[186:189]
    ds_read_b128 a[152:155], v54 offset:6144
    v_mfma_f32_16x16x32_bf16 v[194:197], a[132:135], a[184:187], v[194:197]
    ds_read_b64_tr_b16 a[196:197], v74 offset:3072
    s_waitcnt lgkmcnt(4)
    v_mfma_f32_16x16x32_bf16 v[206:209], a[136:139], a[180:183], v[206:209]
    ds_read_b64_tr_b16 a[198:199], v74 offset:3328
    buffer_load_dwordx4 v60, s[24:27], s64 offen offset:1024 lds
    v_mfma_f32_16x16x32_bf16 v[214:217], a[136:139], a[184:187], v[214:217]
    ds_read_b128 a[156:159], v54 offset:7168
    v_mfma_f32_16x16x32_bf16 v[198:201], a[136:139], a[176:179], v[198:201]
    ds_read_b128 a[160:163], v54 offset:8192
    buffer_load_dwordx4 v61, s[24:27], s64 offen offset:2048 lds
    v_mfma_f32_16x16x32_bf16 v[210:213], a[140:143], a[180:183], v[210:213]
    ds_read_b64_tr_b16 a[188:189], v75 offset:2048
    v_mfma_f32_16x16x32_bf16 v[218:221], a[140:143], a[184:187], v[218:221]
    ds_read_b64_tr_b16 a[190:191], v75 offset:2304
    v_mfma_f32_16x16x32_bf16 v[202:205], a[140:143], a[176:179], v[202:205]
    ds_read_b128 a[164:167], v54 offset:9216
    buffer_load_dwordx4 v62, s[24:27], s64 offen offset:3072 lds
    v_mfma_f32_16x16x32_bf16 v[230:233], a[180:183], a[144:147], v[230:233]
    ds_read_b128 a[168:171], v54 offset:10240
    v_mfma_f32_16x16x32_bf16 v[238:241], a[184:187], a[144:147], v[238:241]
    ds_read_b128 a[172:175], v54 offset:11264
    v_mfma_f32_16x16x32_bf16 v[222:225], a[176:179], a[144:147], v[222:225]
    v_mfma_f32_16x16x32_bf16 v[234:237], a[180:183], a[148:151], v[234:237]
    v_mfma_f32_16x16x32_bf16 v[242:245], a[184:187], a[148:151], v[242:245]
    v_mfma_f32_16x16x32_bf16 v[226:229], a[176:179], a[148:151], v[226:229]
    ds_read_b32 v24, v4
    s_waitcnt vmcnt(16) lgkmcnt(1)
    s_barrier
    s_cmp_ge_u32 s14, 7
    s_cbranch_scc0 L_pollin5
L_pollok5:
    v_mfma_f32_16x16x32_bf16 v[182:185], a[152:155], a[192:195], v[182:185]
    ds_read_b64_tr_b16 a[200:201], v31 offset:16384
    buffer_load_dwordx4 a[0:3], v79, s[28:31], s65 offen offset:0 sc1
    v_mfma_f32_16x16x32_bf16 v[190:193], a[152:155], a[196:199], v[190:193]
    ds_read_b64_tr_b16 a[202:203], v31 offset:18432
    v_mfma_f32_16x16x32_bf16 v[186:189], a[156:159], a[192:195], v[186:189]
    ds_read_b64_tr_b16 a[204:205], v33 offset:16384
    buffer_load_dwordx4 a[4:7], v79, s[28:31], s65 offen offset:1024 sc1
    v_mfma_f32_16x16x32_bf16 v[194:197], a[156:159], a[196:199], v[194:197]
    ds_read_b64_tr_b16 a[206:207], v33 offset:18432
    v_mfma_f32_16x16x32_bf16 v[206:209], a[160:163], a[192:195], v[206:209]
    ds_read_b64_tr_b16 a[208:209], v32 offset:16384
    v_mfma_f32_16x16x32_bf16 v[214:217], a[160:163], a[196:199], v[214:217]
    ds_read_b64_tr_b16 a[210:211], v32 offset:18432
    v_mfma_f32_16x16x32_bf16 v[198:201], a[160:163], a[188:191], v[198:201]
    ds_read_b64_tr_b16 a[212:213], v34 offset:16384
    buffer_load_dwordx4 a[8:11], v79, s[28:31], s65 offen offset:2048 sc1
    v_mfma_f32_16x16x32_bf16 v[210:213], a[164:167], a[192:195], v[210:213]
    ds_read_b64_tr_b16 a[214:215], v34 offset:18432
    v_mfma_f32_16x16x32_bf16 v[218:221], a[164:167], a[196:199], v[218:221]
    ds_read_b64_tr_b16 a[216:217], v31 offset:20480
    v_mfma_f32_16x16x32_bf16 v[202:205], a[164:167], a[188:191], v[202:205]
    ds_read_b64_tr_b16 a[218:219], v31 offset:22528
    buffer_load_dwordx4 a[12:15], v79, s[28:31], s65 offen offset:3072 sc1
    v_mfma_f32_16x16x32_bf16 v[230:233], a[192:195], a[168:171], v[230:233]
    ds_read_b64_tr_b16 a[220:221], v33 offset:20480
    s_add_u32 s65, s65, 8192
    v_mfma_f32_16x16x32_bf16 v[238:241], a[196:199], a[168:171], v[238:241]
    ds_read_b64_tr_b16 a[222:223], v33 offset:22528
    s_cmp_eq_u32 s65, 57344
    v_mfma_f32_16x16x32_bf16 v[222:225], a[188:191], a[168:171], v[222:225]
    s_cselect_b32 s65, 0, s65
    v_mfma_f32_16x16x32_bf16 v[234:237], a[192:195], a[172:175], v[234:237]
    buffer_load_dwordx4 a[16:19], v79, s[28:31], s65 offen offset:0 sc1
    v_mfma_f32_16x16x32_bf16 v[242:245], a[196:199], a[172:175], v[242:245]
    v_mfma_f32_16x16x32_bf16 v[226:229], a[188:191], a[172:175], v[226:229]
    v_cvt_pk_bf16_f32 v118, v182, v183
    v_cvt_pk_bf16_f32 v119, v184, v185
    v_cvt_pk_bf16_f32 v120, v186, v187
    buffer_load_dwordx4 a[20:23], v79, s[28:31], s65 offen offset:1024 sc1
    v_cvt_pk_bf16_f32 v121, v188, v189
    v_cvt_pk_bf16_f32 v122, v190, v191
    v_cvt_pk_bf16_f32 v123, v192, v193
    v_cvt_pk_bf16_f32 v124, v194, v195
    v_cvt_pk_bf16_f32 v125, v196, v197
    v_cvt_pk_bf16_f32 v130, v206, v207
    v_cvt_pk_bf16_f32 v131, v208, v209
    v_cvt_pk_bf16_f32 v132, v210, v211
    v_cvt_pk_bf16_f32 v133, v212, v213
    v_cvt_pk_bf16_f32 v134, v214, v215
    v_cvt_pk_bf16_f32 v135, v216, v217
    v_cvt_pk_bf16_f32 v136, v218, v219
    v_cvt_pk_bf16_f32 v137, v220, v221
    v_cvt_pk_bf16_f32 v126, v198, v199
    buffer_load_dwordx4 a[24:27], v79, s[28:31], s65 offen offset:2048 sc1
    v_cvt_pk_bf16_f32 v127, v200, v201
    v_cvt_pk_bf16_f32 v128, v202, v203
    v_cvt_pk_bf16_f32 v129, v204, v205
    v_mfma_f32_16x16x32_bf16 v[154:157], v[130:133], v[118:121], 0
    v_mfma_f32_16x16x32_bf16 v[158:161], v[130:133], v[122:125], 0
    v_mfma_f32_16x16x32_bf16 v[162:165], v[134:137], v[122:125], 0
    buffer_load_dwordx4 a[28:31], v79, s[28:31], s65 offen offset:3072 sc1
    v_mfma_f32_16x16x32_bf16 v[150:153], v[126:129], v[118:121], 0
    v_cvt_pk_bf16_f32 v166, v222, v223
    v_cvt_pk_bf16_f32 v167, v224, v225
    v_cvt_pk_bf16_f32 v168, v230, v231
    v_cvt_pk_bf16_f32 v169, v232, v233
    v_cvt_pk_bf16_f32 v170, v238, v239
    v_cvt_pk_bf16_f32 v171, v240, v241
    v_cndmask_b32 v250, v158, v159, s[70:71]
    v_cndmask_b32 v253, v162, v163, s[70:71]
    v_cndmask_b32 v250, v250, v253, s[72:73]
    s_add_u32 s65, s65, 8192
    s_cmp_eq_u32 s65, 57344
    s_cselect_b32 s65, 0, s65
    buffer_load_dwordx4 a[32:35], v79, s[28:31], s65 offen offset:0 sc1
    v_mul_f32 v250, v250, v29
    v_cndmask_b32 v251, v160, v161, s[70:71]
    v_cndmask_b32 v253, v164, v165, s[70:71]
    v_cndmask_b32 v251, v251, v253, s[74:75]
    v_mul_f32 v251, v251, v30
    v_cndmask_b32 v246, v150, v151, s[70:71]
    v_cndmask_b32 v246, v84, v246, s[76:77]
    v_cndmask_b32 v249, v154, v155, s[70:71]
    v_cndmask_b32 v246, v246, v249, s[72:73]
    v_mul_f32 v246, v246, v27
    v_cndmask_b32 v247, v152, v153, s[70:71]
    v_cndmask_b32 v247, v84, v247, s[76:77]
    v_cndmask_b32 v249, v156, v157, s[70:71]
    v_cndmask_b32 v247, v247, v249, s[74:75]
    buffer_load_dwordx4 a[36:39], v79, s[28:31], s65 offen offset:1024 sc1
    v_mul_f32 v247, v247, v28
    v_max_f32 v248, v246, v247
    v_max_f32 v252, v250, v251
    v_mov_b32 v249, v248
    v_mov_b32 v253, v252
    v_cvt_pk_bf16_f32 v172, v226, v227
    v_permlane16_swap_b32 v248, v249
    v_permlane16_swap_b32 v252, v253
    v_max_f32 v248, v248, v249
    v_max_f32 v252, v252, v253
    v_mov_b32 v249, v248
    v_mov_b32 v253, v252
    v_cvt_pk_bf16_f32 v173, v228, v229
    v_permlane32_swap_b32 v248, v249
    buffer_load_dwordx4 a[40:43], v79, s[28:31], s65 offen offset:2048 sc1
    v_permlane32_swap_b32 v252, v253
    v_max_f32 v248, v248, v249
    v_max_f32 v252, v252, v253
    v_mul_f32 v248, v25, v248
    v_mul_f32 v252, v26, v252
    v_fma_f32 v246, v246, v25, -v248
    v_fma_f32 v247, v247, v25, -v248
    v_fma_f32 v250, v250, v26, -v252
    v_fma_f32 v251, v251, v26, -v252
    v_exp_f32 v246, v246
    v_exp_f32 v247, v247
    v_exp_f32 v250, v250
    buffer_load_dwordx4 a[44:47], v79, s[28:31], s65 offen offset:3072 sc1
    v_exp_f32 v251, v251
    v_add_f32 v248, v246, v247
    v_add_f32 v252, v250, v251
    v_mov_b32 v249, v248
    v_mov_b32 v253, v252
    v_cvt_pk_bf16_f32 v174, v234, v235
    v_permlane16_swap_b32 v248, v249
    v_permlane16_swap_b32 v252, v253
    v_add_f32 v248, v248, v249
    v_add_f32 v252, v252, v253
    v_mov_b32 v249, v248
    v_mov_b32 v253, v252
    s_add_u32 m0, s58, 131072
    s_add_u32 s64, s64, 524288
    s_cmp_eq_u32 s64, 3670016
    s_cselect_b32 s64, 0, s64
    s_add_u32 s64, s64, 524288
    s_cmp_eq_u32 s64, 3670016
    s_cselect_b32 s64, 0, s64
    v_xor_b32 v59, 128, v59
    buffer_load_dwordx4 v59, s[24:27], s64 offen lds
    v_cvt_pk_bf16_f32 v175, v236, v237
    v_permlane32_swap_b32 v248, v249
    v_permlane32_swap_b32 v252, v253
    v_add_f32 v248, v248, v249
    v_add_f32 v252, v252, v253
    v_rcp_f32 v248, v248
    v_rcp_f32 v252, v252
    v_cvt_pk_bf16_f32 v176, v242, v243
    v_cvt_pk_bf16_f32 v177, v244, v245
    v_mul_f32 v246, v246, v27
    v_xor_b32 v60, 128, v60
    buffer_load_dwordx4 v60, s[24:27], s64 offen offset:1024 lds
    v_mul_f32 v247, v247, v28
    v_mul_f32 v250, v250, v29
    v_mul_f32 v251, v251, v30
    v_mul_f32 v246, v246, v248
    v_mul_f32 v247, v247, v248
    v_mul_f32 v250, v250, v252
    v_mul_f32 v251, v251, v252
    v_cvt_pk_bf16_f32 v246, v246, v246
    v_cvt_pk_bf16_f32 v247, v247, v247
    v_cvt_pk_bf16_f32 v250, v250, v250
    v_cvt_pk_bf16_f32 v251, v251, v251
    v_and_b32 v138, v246, v104
    v_and_b32 v139, v247, v105
    v_xor_b32 v61, 128, v61
    buffer_load_dwordx4 v61, s[24:27], s64 offen offset:2048 lds
    v_and_b32 v140, v246, v106
    v_and_b32 v141, v247, v107
    v_and_b32 v142, v250, v104
    v_and_b32 v143, v251, v105
    v_and_b32 v144, v250, v106
    v_and_b32 v145, v251, v107
    v_mfma_f32_16x16x32_bf16 v[182:185], v[166:169], v[138:141], 0
    v_mfma_f32_16x16x32_bf16 v[186:189], v[172:175], v[138:141], 0
    v_xor_b32 v62, 128, v62
    buffer_load_dwordx4 v62, s[24:27], s64 offen offset:3072 lds
    v_mfma_f32_16x16x32_bf16 v[190:193], v[168:171], v[142:145], 0
    v_mfma_f32_16x16x32_bf16 v[194:197], v[174:177], v[142:145], 0
    s_add_u32 s83, s82, 16384
    s_nop 1
    v_cvt_pk_bf16_f32 v110, v182, v183
    v_cvt_pk_bf16_f32 v111, v184, v185
    s_add_u32 m0, s58, 147456
    s_add_u32 s64, s64, 524288
    s_cmp_eq_u32 s64, 3670016
    s_cselect_b32 s64, 0, s64
    buffer_load_dwordx4 v59, s[24:27], s64 offen lds
    v_cvt_pk_bf16_f32 v112, v186, v187
    v_cvt_pk_bf16_f32 v113, v188, v189
    v_cvt_pk_bf16_f32 v114, v190, v191
    v_cvt_pk_bf16_f32 v115, v192, v193
    v_cvt_pk_bf16_f32 v116, v194, v195
    v_cvt_pk_bf16_f32 v117, v196, v197
    buffer_store_dwordx4 v[110:113], v4, s[28:31], s82 offen sc1
    buffer_store_dwordx4 v[114:117], v4, s[28:31], s83 offen sc1
    s_cmp_lg_u32 s56, 0
    s_cbranch_scc0 L_nof
L_f:
    s_waitcnt vmcnt(17) lgkmcnt(8)
    v_mfma_f32_16x16x32_bf16 v[182:185], a[0:3], a[200:203], 0
    ds_read_b64_tr_b16 a[224:225], v32 offset:20480
    s_add_u32 s65, s65, 8192
    s_cmp_eq_u32 s65, 57344
    s_cselect_b32 s65, 0, s65
    buffer_load_dwordx4 a[48:51], v79, s[28:31], s65 offen offset:0 sc1
    v_mfma_f32_16x16x32_bf16 v[186:189], a[4:7], a[200:203], 0
    ds_read_b64_tr_b16 a[226:227], v32 offset:22528
    v_lshlrev_b32 v93, 16, v93
    v_mfma_f32_16x16x32_bf16 v[238:241], a[0:3], a[204:207], 0
    ds_read_b64_tr_b16 a[228:229], v34 offset:20480
    buffer_load_dwordx4 a[52:55], v79, s[28:31], s65 offen offset:1024 sc1
    v_mfma_f32_16x16x32_bf16 v[242:245], a[4:7], a[204:207], 0
    ds_read_b64_tr_b16 a[230:231], v34 offset:22528
    s_waitcnt lgkmcnt(8)
    v_mfma_f32_16x16x32_bf16 v[190:193], a[0:3], a[208:211], 0
    ds_read_b64_tr_b16 a[200:201], v35 offset:0
    v_lshlrev_b32 v222, 16, v96
    v_mfma_f32_16x16x32_bf16 v[194:197], a[4:7], a[208:211], 0
    ds_read_b64_tr_b16 a[202:203], v35 offset:2048
    v_and_b32 v223, 0xffff0000, v96
    v_mfma_f32_16x16x32_bf16 v[246:249], a[0:3], a[212:215], 0
    ds_read_b64_tr_b16 a[204:205], v37 offset:0
    buffer_load_dwordx4 a[56:59], v79, s[28:31], s65 offen offset:2048 sc1
    v_mfma_f32_16x16x32_bf16 v[250:253], a[4:7], a[212:215], 0
    ds_read_b64_tr_b16 a[206:207], v37 offset:2048
    s_waitcnt vmcnt(18) lgkmcnt(8)
    v_mfma_f32_16x16x32_bf16 v[182:185], a[8:11], a[216:219], v[182:185]
    ds_read_b64_tr_b16 a[208:209], v36 offset:0
    v_add_f32 v222, v222, v93
    v_mfma_f32_16x16x32_bf16 v[186:189], a[12:15], a[216:219], v[186:189]
    ds_read_b64_tr_b16 a[210:211], v36 offset:2048
    buffer_load_dwordx4 a[60:63], v79, s[28:31], s65 offen offset:3072 sc1
    v_add_f32 v223, v223, v93
    v_mfma_f32_16x16x32_bf16 v[238:241], a[8:11], a[220:223], v[238:241]
    ds_read_b64_tr_b16 a[212:213], v38 offset:0
    s_add_u32 s65, s65, 8192
    v_mfma_f32_16x16x32_bf16 v[242:245], a[12:15], a[220:223], v[242:245]
    ds_read_b64_tr_b16 a[214:215], v38 offset:2048
    s_waitcnt lgkmcnt(8)
    v_mfma_f32_16x16x32_bf16 v[190:193], a[8:11], a[224:227], v[190:193]
    ds_read_b64_tr_b16 a[216:217], v35 offset:4096
    s_cmp_eq_u32 s65, 57344
    v_mfma_f32_16x16x32_bf16 v[194:197], a[12:15], a[224:227], v[194:197]
    ds_read_b64_tr_b16 a[218:219], v35 offset:6144
    s_cselect_b32 s65, 0, s65
    v_lshlrev_b32 v224, 16, v97
    v_mfma_f32_16x16x32_bf16 v[246:249], a[8:11], a[228:231], v[246:249]
    ds_read_b64_tr_b16 a[220:221], v37 offset:4096
    buffer_load_dwordx4 a[64:67], v79, s[28:31], s65 offen offset:0 sc1
    v_mfma_f32_16x16x32_bf16 v[250:253], a[12:15], a[228:231], v[250:253]
    ds_read_b64_tr_b16 a[222:223], v37 offset:6144
    s_waitcnt vmcnt(18) lgkmcnt(8)
    v_mfma_f32_16x16x32_bf16 v[182:185], a[16:19], a[200:203], v[182:185]
    ds_read_b64_tr_b16 a[224:225], v36 offset:4096
    buffer_load_dwordx4 a[68:71], v79, s[28:31], s65 offen offset:1024 sc1
    v_mfma_f32_16x16x32_bf16 v[186:189], a[20:23], a[200:203], v[186:189]
    ds_read_b64_tr_b16 a[226:227], v36 offset:6144
    v_and_b32 v225, 0xffff0000, v97
    v_mfma_f32_16x16x32_bf16 v[238:241], a[16:19], a[204:207], v[238:241]
    ds_read_b64_tr_b16 a[228:229], v38 offset:4096
    v_add_f32 v224, v224, v93
    v_mfma_f32_16x16x32_bf16 v[242:245], a[20:23], a[204:207], v[242:245]
    ds_read_b64_tr_b16 a[230:231], v38 offset:6144
    s_waitcnt lgkmcnt(8)
    v_mfma_f32_16x16x32_bf16 v[190:193], a[16:19], a[208:211], v[190:193]
    ds_read_b64_tr_b16 a[200:201], v35 offset:16384
    buffer_load_dwordx4 a[72:75], v79, s[28:31], s65 offen offset:2048 sc1
    v_mfma_f32_16x16x32_bf16 v[194:197], a[20:23], a[208:211], v[194:197]
    ds_read_b64_tr_b16 a[202:203], v35 offset:18432
    v_add_f32 v225, v225, v93
    v_mfma_f32_16x16x32_bf16 v[246:249], a[16:19], a[212:215], v[246:249]
    ds_read_b64_tr_b16 a[204:205], v37 offset:16384
    v_lshlrev_b32 v226, 16, v98
    v_mfma_f32_16x16x32_bf16 v[250:253], a[20:23], a[212:215], v[250:253]
    ds_read_b64_tr_b16 a[206:207], v37 offset:18432
    s_waitcnt vmcnt(18) lgkmcnt(8)
    v_mfma_f32_16x16x32_bf16 v[182:185], a[24:27], a[216:219], v[182:185]
    ds_read_b64_tr_b16 a[208:209], v36 offset:16384
    buffer_load_dwordx4 a[76:79], v79, s[28:31], s65 offen offset:3072 sc1
    v_mfma_f32_16x16x32_bf16 v[186:189], a[28:31], a[216:219], v[186:189]
    ds_read_b64_tr_b16 a[210:211], v36 offset:18432
    s_add_u32 s65, s65, 8192
    v_and_b32 v227, 0xffff0000, v98
    v_mfma_f32_16x16x32_bf16 v[238:241], a[24:27], a[220:223], v[238:241]
    ds_read_b64_tr_b16 a[212:213], v38 offset:16384
    s_cmp_eq_u32 s65, 57344
    v_mfma_f32_16x16x32_bf16 v[242:245], a[28:31], a[220:223], v[242:245]
    ds_read_b64_tr_b16 a[214:215], v38 offset:18432
    v_add_f32 v226, v226, v93
    s_waitcnt lgkmcnt(8)
    v_mfma_f32_16x16x32_bf16 v[190:193], a[24:27], a[224:227], v[190:193]
    ds_read_b64_tr_b16 a[216:217], v35 offset:20480
    s_cselect_b32 s65, 0, s65
    buffer_load_dwordx4 a[80:83], v79, s[28:31], s65 offen offset:0 sc1
    v_mfma_f32_16x16x32_bf16 v[194:197], a[28:31], a[224:227], v[194:197]
    ds_read_b64_tr_b16 a[218:219], v35 offset:22528
    v_add_f32 v227, v227, v93
    v_mfma_f32_16x16x32_bf16 v[246:249], a[24:27], a[228:231], v[246:249]
    ds_read_b64_tr_b16 a[220:221], v37 offset:20480
    buffer_load_dwordx4 a[84:87], v79, s[28:31], s65 offen offset:1024 sc1
    v_mfma_f32_16x16x32_bf16 v[250:253], a[28:31], a[228:231], v[250:253]
    ds_read_b64_tr_b16 a[222:223], v37 offset:22528
    v_lshlrev_b32 v228, 16, v99
    s_waitcnt vmcnt(19) lgkmcnt(8)
    v_mfma_f32_16x16x32_bf16 v[182:185], a[32:35], a[200:203], v[182:185]
    ds_read_b64_tr_b16 a[224:225], v36 offset:20480
    v_and_b32 v229, 0xffff0000, v99
    v_mfma_f32_16x16x32_bf16 v[186:189], a[36:39], a[200:203], v[186:189]
    ds_read_b64_tr_b16 a[226:227], v36 offset:22528
    buffer_load_dwordx4 a[88:91], v79, s[28:31], s65 offen offset:2048 sc1
    v_add_f32 v228, v228, v93
    v_mfma_f32_16x16x32_bf16 v[238:241], a[32:35], a[204:207], v[238:241]
    ds_read_b64_tr_b16 a[228:229], v38 offset:20480
    v_add_f32 v229, v229, v93
    v_mfma_f32_16x16x32_bf16 v[242:245], a[36:39], a[204:207], v[242:245]
    ds_read_b64_tr_b16 a[230:231], v38 offset:22528
    s_waitcnt lgkmcnt(8)
    v_mfma_f32_16x16x32_bf16 v[190:193], a[32:35], a[208:211], v[190:193]
    s_waitcnt vmcnt(11)
    s_barrier
    s_cmp_lg_u32 s48, 0
    s_cbranch_scc1 L_sig4
    s_atomic_add s36, s[28:29], s69
L_sig4:
    ds_read_b64_tr_b16 a[200:201], v31 offset:32768
    buffer_load_dwordx4 a[92:95], v79, s[28:31], s65 offen offset:3072 sc1
    v_mfma_f32_16x16x32_bf16 v[194:197], a[36:39], a[208:211], v[194:197]
    ds_read_b64_tr_b16 a[202:203], v31 offset:34816
    s_add_u32 s65, s65, 8192
    v_lshlrev_b32 v94, 16, v94
    v_mfma_f32_16x16x32_bf16 v[246:249], a[32:35], a[212:215], v[246:249]
    ds_read_b64_tr_b16 a[204:205], v33 offset:32768
    s_cmp_eq_u32 s65, 57344
    v_mfma_f32_16x16x32_bf16 v[250:253], a[36:39], a[212:215], v[250:253]
    ds_read_b64_tr_b16 a[206:207], v33 offset:34816
    s_waitcnt lgkmcnt(8)
    v_mfma_f32_16x16x32_bf16 v[182:185], a[40:43], a[216:219], v[182:185]
    ds_read_b64_tr_b16 a[208:209], v32 offset:32768
    s_cselect_b32 s65, 0, s65
    v_mfma_f32_16x16x32_bf16 v[186:189], a[44:47], a[216:219], v[186:189]
    ds_read_b64_tr_b16 a[210:211], v32 offset:34816
    buffer_load_dwordx4 a[96:99], v79, s[28:31], s65 offen offset:0 sc1
    v_lshlrev_b32 v230, 16, v100
    v_mfma_f32_16x16x32_bf16 v[238:241], a[40:43], a[220:223], v[238:241]
    ds_read_b64_tr_b16 a[212:213], v34 offset:32768
    v_and_b32 v231, 0xffff0000, v100
    v_mfma_f32_16x16x32_bf16 v[242:245], a[44:47], a[220:223], v[242:245]
    ds_read_b64_tr_b16 a[214:215], v34 offset:34816
    s_waitcnt lgkmcnt(8)
    v_mfma_f32_16x16x32_bf16 v[190:193], a[40:43], a[224:227], v[190:193]
    ds_read_b64_tr_b16 a[216:217], v31 offset:36864
    buffer_load_dwordx4 a[100:103], v79, s[28:31], s65 offen offset:1024 sc1
    v_mfma_f32_16x16x32_bf16 v[194:197], a[44:47], a[224:227], v[194:197]
    ds_read_b64_tr_b16 a[218:219], v31 offset:38912
    v_add_f32 v230, v230, v94
    v_mfma_f32_16x16x32_bf16 v[246:249], a[40:43], a[228:231], v[246:249]
    ds_read_b64_tr_b16 a[220:221], v33 offset:36864
    buffer_load_dwordx4 a[104:107], v79, s[28:31], s65 offen offset:2048 sc1
    v_mfma_f32_16x16x32_bf16 v[250:253], a[44:47], a[228:231], v[250:253]
    ds_read_b64_tr_b16 a[222:223], v33 offset:38912
    v_add_f32 v231, v231, v94
    s_waitcnt vmcnt(13) lgkmcnt(8)
    v_mfma_f32_16x16x32_bf16 v[182:185], a[48:51], a[200:203], v[182:185]
    ds_read_b64_tr_b16 a[224:225], v32 offset:36864
    v_lshlrev_b32 v232, 16, v101
    v_mfma_f32_16x16x32_bf16 v[186:189], a[52:55], a[200:203], v[186:189]
    ds_read_b64_tr_b16 a[226:227], v32 offset:38912
    v_and_b32 v233, 0xffff0000, v101
    v_mfma_f32_16x16x32_bf16 v[238:241], a[48:51], a[204:207], v[238:241]
    ds_read_b64_tr_b16 a[228:229], v34 offset:36864
    buffer_load_dwordx4 a[108:111], v79, s[28:31], s65 offen offset:3072 sc1
    v_mfma_f32_16x16x32_bf16 v[242:245], a[52:55], a[204:207], v[242:245]
    ds_read_b64_tr_b16 a[230:231], v34 offset:38912
    s_waitcnt lgkmcnt(8)
    v_mfma_f32_16x16x32_bf16 v[190:193], a[48:51], a[208:211], v[190:193]
    ds_read_b64_tr_b16 a[200:201], v31 offset:49152
    v_add_f32 v232, v232, v94
    v_mfma_f32_16x16x32_bf16 v[194:197], a[52:55], a[208:211], v[194:197]
    ds_read_b64_tr_b16 a[202:203], v31 offset:51200
    buffer_load_dwordx4 v60, s[24:27], s64 offen offset:1024 lds
    v_add_f32 v233, v233, v94
    v_mfma_f32_16x16x32_bf16 v[246:249], a[48:51], a[212:215], v[246:249]
    ds_read_b64_tr_b16 a[204:205], v33 offset:49152
    v_lshlrev_b32 v234, 16, v102
    v_mfma_f32_16x16x32_bf16 v[250:253], a[52:55], a[212:215], v[250:253]
    ds_read_b64_tr_b16 a[206:207], v33 offset:51200
    s_waitcnt vmcnt(13) lgkmcnt(8)
    v_mfma_f32_16x16x32_bf16 v[182:185], a[56:59], a[216:219], v[182:185]
    ds_read_b64_tr_b16 a[208:209], v32 offset:49152
    buffer_load_dwordx4 v61, s[24:27], s64 offen offset:2048 lds
    v_mfma_f32_16x16x32_bf16 v[186:189], a[60:63], a[216:219], v[186:189]
    ds_read_b64_tr_b16 a[210:211], v32 offset:51200
    v_and_b32 v235, 0xffff0000, v102
    v_mfma_f32_16x16x32_bf16 v[238:241], a[56:59], a[220:223], v[238:241]
    ds_read_b64_tr_b16 a[212:213], v34 offset:49152
    buffer_load_dwordx4 v62, s[24:27], s64 offen offset:3072 lds
    v_mfma_f32_16x16x32_bf16 v[242:245], a[60:63], a[220:223], v[242:245]
    ds_read_b64_tr_b16 a[214:215], v34 offset:51200
    s_waitcnt lgkmcnt(8)
    v_mfma_f32_16x16x32_bf16 v[190:193], a[56:59], a[224:227], v[190:193]
    ds_read_b64_tr_b16 a[216:217], v31 offset:53248
    s_add_u32 m0, s58, 16384
    v_mfma_f32_16x16x32_bf16 v[194:197], a[60:63], a[224:227], v[194:197]
    ds_read_b64_tr_b16 a[218:219], v31 offset:55296
    s_add_u32 s64, s64, 524288
    v_add_f32 v234, v234, v94
    v_mfma_f32_16x16x32_bf16 v[246:249], a[56:59], a[228:231], v[246:249]
    ds_read_b64_tr_b16 a[220:221], v33 offset:53248
    s_cmp_eq_u32 s64, 3670016
    v_mfma_f32_16x16x32_bf16 v[250:253], a[60:63], a[228:231], v[250:253]
    ds_read_b64_tr_b16 a[222:223], v33 offset:55296
    s_cselect_b32 s64, 0, s64
    buffer_load_dwordx4 v59, s[24:27], s64 offen lds
    v_add_f32 v235, v235, v94
    s_waitcnt vmcnt(14) lgkmcnt(8)
    v_mfma_f32_16x16x32_bf16 v[182:185], a[64:67], a[200:203], v[182:185]
    ds_read_b64_tr_b16 a[224:225], v32 offset:53248
    v_lshlrev_b32 v236, 16, v103
    v_mfma_f32_16x16x32_bf16 v[186:189], a[68:71], a[200:203], v[186:189]
    ds_read_b64_tr_b16 a[226:227], v32 offset:55296
    buffer_load_dwordx4 v60, s[24:27], s64 offen offset:1024 lds
    v_and_b32 v237, 0xffff0000, v103
    v_mfma_f32_16x16x32_bf16 v[238:241], a[64:67], a[204:207], v[238:241]
    ds_read_b64_tr_b16 a[228:229], v34 offset:53248
    v_add_f32 v236, v236, v94
    v_mfma_f32_16x16x32_bf16 v[242:245], a[68:71], a[204:207], v[242:245]
    ds_read_b64_tr_b16 a[230:231], v34 offset:55296
    s_waitcnt lgkmcnt(8)
    v_mfma_f32_16x16x32_bf16 v[190:193], a[64:67], a[208:211], v[190:193]
    s_barrier
    ds_read_b64_tr_b16 a[200:201], v35 offset:32768
    buffer_load_dwordx4 v61, s[24:27], s64 offen offset:2048 lds
    v_mfma_f32_16x16x32_bf16 v[194:197], a[68:71], a[208:211], v[194:197]
    ds_read_b64_tr_b16 a[202:203], v35 offset:34816
    v_add_f32 v237, v237, v94
    v_mfma_f32_16x16x32_bf16 v[246:249], a[64:67], a[212:215], v[246:249]
    ds_read_b64_tr_b16 a[204:205], v37 offset:32768
    v_mfma_f32_16x16x32_bf16 v[250:253], a[68:71], a[212:215], v[250:253]
    ds_read_b64_tr_b16 a[206:207], v37 offset:34816
    s_waitcnt vmcnt(14) lgkmcnt(8)
    v_mfma_f32_16x16x32_bf16 v[182:185], a[72:75], a[216:219], v[182:185]
    ds_read_b64_tr_b16 a[208:209], v36 offset:32768
    buffer_load_dwordx4 v62, s[24:27], s64 offen offset:3072 lds
    v_mfma_f32_16x16x32_bf16 v[186:189], a[76:79], a[216:219], v[186:189]
    ds_read_b64_tr_b16 a[210:211], v36 offset:34816
    s_add_u32 m0, s58, 65536
    v_mfma_f32_16x16x32_bf16 v[238:241], a[72:75], a[220:223], v[238:241]
    ds_read_b64_tr_b16 a[212:213], v38 offset:32768
    s_add_u32 s64, s64, 524288
    v_mfma_f32_16x16x32_bf16 v[242:245], a[76:79], a[220:223], v[242:245]
    ds_read_b64_tr_b16 a[214:215], v38 offset:34816
    s_waitcnt lgkmcnt(8)
    v_mfma_f32_16x16x32_bf16 v[190:193], a[72:75], a[224:227], v[190:193]
    ds_read_b64_tr_b16 a[216:217], v35 offset:36864
    s_cmp_eq_u32 s64, 3670016
    v_mfma_f32_16x16x32_bf16 v[194:197], a[76:79], a[224:227], v[194:197]
    ds_read_b64_tr_b16 a[218:219], v35 offset:38912
    s_cselect_b32 s64, 0, s64
    buffer_load_dwordx4 v59, s[24:27], s64 offen lds
    v_mfma_f32_16x16x32_bf16 v[246:249], a[72:75], a[228:231], v[246:249]
    ds_read_b64_tr_b16 a[220:221], v37 offset:36864
    v_mfma_f32_16x16x32_bf16 v[250:253], a[76:79], a[228:231], v[250:253]
    ds_read_b64_tr_b16 a[222:223], v37 offset:38912
    s_waitcnt vmcnt(14) lgkmcnt(8)
    v_mfma_f32_16x16x32_bf16 v[182:185], a[80:83], a[200:203], v[182:185]
    ds_read_b64_tr_b16 a[224:225], v36 offset:36864
    buffer_load_dwordx4 v60, s[24:27], s64 offen offset:1024 lds
    v_mfma_f32_16x16x32_bf16 v[186:189], a[84:87], a[200:203], v[186:189]
    ds_read_b64_tr_b16 a[226:227], v36 offset:38912
    v_mfma_f32_16x16x32_bf16 v[238:241], a[80:83], a[204:207], v[238:241]
    ds_read_b64_tr_b16 a[228:229], v38 offset:36864
    v_mfma_f32_16x16x32_bf16 v[242:245], a[84:87], a[204:207], v[242:245]
    ds_read_b64_tr_b16 a[230:231], v38 offset:38912
    s_waitcnt lgkmcnt(8)
    v_mfma_f32_16x16x32_bf16 v[190:193], a[80:83], a[208:211], v[190:193]
    ds_read_b64_tr_b16 a[200:201], v35 offset:49152
    buffer_load_dwordx4 v61, s[24:27], s64 offen offset:2048 lds
    v_mfma_f32_16x16x32_bf16 v[194:197], a[84:87], a[208:211], v[194:197]
    ds_read_b64_tr_b16 a[202:203], v35 offset:51200
    v_mfma_f32_16x16x32_bf16 v[246:249], a[80:83], a[212:215], v[246:249]
    ds_read_b64_tr_b16 a[204:205], v37 offset:49152
    v_mfma_f32_16x16x32_bf16 v[250:253], a[84:87], a[212:215], v[250:253]
    ds_read_b64_tr_b16 a[206:207], v37 offset:51200
    s_waitcnt vmcnt(14) lgkmcnt(8)
    v_mfma_f32_16x16x32_bf16 v[182:185], a[88:91], a[216:219], v[182:185]
L_pad3:
    s_cbranch_execz L_warm
    ds_read_b64_tr_b16 a[208:209], v36 offset:49152
    buffer_load_dwordx4 v62, s[24:27], s64 offen offset:3072 lds
    v_mfma_f32_16x16x32_bf16 v[186:189], a[92:95], a[216:219], v[186:189]
    ds_read_b64_tr_b16 a[210:211], v36 offset:51200
    s_add_u32 m0, s58, 81920
    v_mfma_f32_16x16x32_bf16 v[238:241], a[88:91], a[220:223], v[238:241]
    ds_read_b64_tr_b16 a[212:213], v38 offset:49152
    s_add_u32 s64, s64, 524288
    v_mfma_f32_16x16x32_bf16 v[242:245], a[92:95], a[220:223], v[242:245]
    ds_read_b64_tr_b16 a[214:215], v38 offset:51200
    s_waitcnt lgkmcnt(8)
    v_mfma_f32_16x16x32_bf16 v[190:193], a[88:91], a[224:227], v[190:193]
    ds_read_b64_tr_b16 a[216:217], v35 offset:53248
    s_cmp_eq_u32 s64, 3670016
    s_cselect_b32 s64, 0, s64
    buffer_load_dwordx4 v59, s[24:27], s64 offen lds
    v_mfma_f32_16x16x32_bf16 v[194:197], a[92:95], a[224:227], v[194:197]
    ds_read_b64_tr_b16 a[218:219], v35 offset:55296
    v_mfma_f32_16x16x32_bf16 v[246:249], a[88:91], a[228:231], v[246:249]
    ds_read_b64_tr_b16 a[220:221], v37 offset:53248
    buffer_load_dwordx4 v60, s[24:27], s64 offen offset:1024 lds
    v_mfma_f32_16x16x32_bf16 v[250:253], a[92:95], a[228:231], v[250:253]
    ds_read_b64_tr_b16 a[222:223], v37 offset:55296
    s_waitcnt vmcnt(15) lgkmcnt(8)
    v_mfma_f32_16x16x32_bf16 v[182:185], a[96:99], a[200:203], v[182:185]
    ds_read_b64_tr_b16 a[224:225], v36 offset:53248
    v_mfma_f32_16x16x32_bf16 v[186:189], a[100:103], a[200:203], v[186:189]
    ds_read_b64_tr_b16 a[226:227], v36 offset:55296
    v_mfma_f32_16x16x32_bf16 v[238:241], a[96:99], a[204:207], v[238:241]
    ds_read_b64_tr_b16 a[228:229], v38 offset:53248
    buffer_load_dwordx4 v61, s[24:27], s64 offen offset:2048 lds
    v_mfma_f32_16x16x32_bf16 v[242:245], a[100:103], a[204:207], v[242:245]
    ds_read_b64_tr_b16 a[230:231], v38 offset:55296
    s_waitcnt lgkmcnt(8)
    v_mfma_f32_16x16x32_bf16 v[190:193], a[96:99], a[208:211], v[190:193]
    ds_read_b64_tr_b16 a[200:201], v31 offset:0
    v_mfma_f32_16x16x32_bf16 v[194:197], a[100:103], a[208:211], v[194:197]
    ds_read_b64_tr_b16 a[202:203], v31 offset:2048
    v_mfma_f32_16x16x32_bf16 v[246:249], a[96:99], a[212:215], v[246:249]
    ds_read_b64_tr_b16 a[204:205], v33 offset:0
    buffer_load_dwordx4 v62, s[24:27], s64 offen offset:3072 lds
    v_mfma_f32_16x16x32_bf16 v[250:253], a[100:103], a[212:215], v[250:253]
    ds_read_b64_tr_b16 a[206:207], v33 offset:2048
    s_waitcnt vmcnt(15) lgkmcnt(8)
    v_mfma_f32_16x16x32_bf16 v[182:185], a[104:107], a[216:219], v[182:185]
    ds_read_b64_tr_b16 a[208:209], v32 offset:0
    s_add_u32 m0, s58, 32768
    v_mfma_f32_16x16x32_bf16 v[186:189], a[108:111], a[216:219], v[186:189]
    ds_read_b64_tr_b16 a[210:211], v32 offset:2048
    s_add_u32 s64, s64, 524288
    v_mfma_f32_16x16x32_bf16 v[238:241], a[104:107], a[220:223], v[238:241]
    ds_read_b64_tr_b16 a[212:213], v34 offset:0
    s_cmp_eq_u32 s64, 3670016
    v_mfma_f32_16x16x32_bf16 v[242:245], a[108:111], a[220:223], v[242:245]
    ds_read_b64_tr_b16 a[214:215], v34 offset:2048
    s_cselect_b32 s64, 0, s64
    buffer_load_dwordx4 v59, s[24:27], s64 offen lds
    s_waitcnt lgkmcnt(8)
    v_mfma_f32_16x16x32_bf16 v[190:193], a[104:107], a[224:227], v[190:193]
    ds_read_b64_tr_b16 a[216:217], v31 offset:4096
    v_mfma_f32_16x16x32_bf16 v[194:197], a[108:111], a[224:227], v[194:197]
    ds_read_b64_tr_b16 a[218:219], v31 offset:6144
    buffer_load_dwordx4 v60, s[24:27], s64 offen offset:1024 lds
    v_mfma_f32_16x16x32_bf16 v[246:249], a[104:107], a[228:231], v[246:249]
    ds_read_b64_tr_b16 a[220:221], v33 offset:4096
    v_mfma_f32_16x16x32_bf16 v[250:253], a[108:111], a[228:231], v[250:253]
    ds_read_b64_tr_b16 a[222:223], v33 offset:6144
    s_waitcnt lgkmcnt(8)
    v_mfma_f32_16x16x32_bf16 v[150:153], a[0:3], a[200:203], 0
    ds_read_b64_tr_b16 a[224:225], v32 offset:4096
    v_mfma_f32_16x16x32_bf16 v[154:157], a[4:7], a[200:203], 0
    ds_read_b64_tr_b16 a[226:227], v32 offset:6144
    buffer_load_dwordx4 v61, s[24:27], s64 offen offset:2048 lds
    v_mfma_f32_16x16x32_bf16 v[166:169], a[0:3], a[204:207], 0
    ds_read_b64_tr_b16 a[228:229], v34 offset:4096
    v_cvt_pk_bf16_f32 v182, v182, v183
    v_mfma_f32_16x16x32_bf16 v[170:173], a[4:7], a[204:207], 0
    ds_read_b64_tr_b16 a[230:231], v34 offset:6144
    v_cvt_pk_bf16_f32 v183, v184, v185
    v_cvt_pk_bf16_f32 v184, v186, v187
    s_waitcnt lgkmcnt(8)
    v_mfma_f32_16x16x32_bf16 v[158:161], a[0:3], a[208:211], 0
    s_waitcnt vmcnt(15)
    s_barrier
    ds_read_b64_tr_b16 a[200:201], v39 offset:0
    buffer_load_dwordx4 v62, s[24:27], s64 offen offset:3072 lds
    v_mfma_f32_16x16x32_bf16 v[162:165], a[4:7], a[208:211], 0
    ds_read_b64_tr_b16 a[202:203], v39 offset:2048
    s_add_u32 m0, s58, 49152
    v_cvt_pk_bf16_f32 v185, v188, v189
    buffer_store_dwordx4 v[182:185], v21, s[28:31], 0 offen offset:0 sc1
    v_cvt_pk_bf16_f32 v190, v190, v191
    v_cvt_pk_bf16_f32 v191, v192, v193
    v_cvt_pk_bf16_f32 v192, v194, v195
    v_mfma_f32_16x16x32_bf16 v[174:177], a[0:3], a[212:215], 0
    ds_read_b64_tr_b16 a[204:205], v41 offset:0
    s_add_u32 s66, s66, 1
    v_mfma_f32_16x16x32_bf16 v[178:181], a[4:7], a[212:215], 0
    ds_read_b64_tr_b16 a[206:207], v41 offset:2048
    v_cvt_pk_bf16_f32 v193, v196, v197
    buffer_store_dwordx4 v[190:193], v21, s[28:31], 0 offen offset:1024 sc1
    v_cvt_pk_bf16_f32 v238, v238, v239
    v_cvt_pk_bf16_f32 v239, v240, v241
    v_cvt_pk_bf16_f32 v240, v242, v243
    s_waitcnt lgkmcnt(8)
    v_mfma_f32_16x16x32_bf16 v[150:153], a[8:11], a[216:219], v[150:153]
    ds_read_b64_tr_b16 a[208:209], v40 offset:0
    s_and_b32 s66, s66, 3
    v_mfma_f32_16x16x32_bf16 v[154:157], a[12:15], a[216:219], v[154:157]
    ds_read_b64_tr_b16 a[210:211], v40 offset:2048
    s_mul_i32 s61, s66, 100352
    buffer_load_dwordx4 v63, s[16:19], s61 offen lds
    v_cvt_pk_bf16_f32 v241, v244, v245
    buffer_store_dwordx4 v[238:241], v21, s[28:31], 0 offen offset:2048 sc1
    v_cvt_pk_bf16_f32 v246, v246, v247
    v_cvt_pk_bf16_f32 v247, v248, v249
    v_cvt_pk_bf16_f32 v248, v250, v251
    v_mfma_f32_16x16x32_bf16 v[166:169], a[8:11], a[220:223], v[166:169]
    ds_read_b64_tr_b16 a[212:213], v42 offset:0
    v_cvt_pk_bf16_f32 v249, v252, v253
    v_mfma_f32_16x16x32_bf16 v[170:173], a[12:15], a[220:223], v[170:173]
    ds_read_b64_tr_b16 a[214:215], v42 offset:2048
    s_waitcnt lgkmcnt(8)
    v_mfma_f32_16x16x32_bf16 v[158:161], a[8:11], a[224:227], v[158:161]
    ds_read_b64_tr_b16 a[216:217], v39 offset:4096
    buffer_load_dwordx4 v64, s[16:19], s61 offen offset:1024 lds
    v_mfma_f32_16x16x32_bf16 v[162:165], a[12:15], a[224:227], v[162:165]
    ds_read_b64_tr_b16 a[218:219], v39 offset:6144
    s_add_u32 s61, s61, 48128
    buffer_store_dwordx4 v[246:249], v21, s[28:31], 0 offen offset:3072 sc1
    v_mfma_f32_16x16x32_bf16 v[174:177], a[8:11], a[228:231], v[174:177]
    ds_read_b64_tr_b16 a[220:221], v41 offset:4096
    v_mfma_f32_16x16x32_bf16 v[178:181], a[12:15], a[228:231], v[178:181]
    ds_read_b64_tr_b16 a[222:223], v41 offset:6144
    s_waitcnt lgkmcnt(8)
    v_mfma_f32_16x16x32_bf16 v[150:153], a[16:19], a[200:203], v[150:153]
    ds_read_b64_tr_b16 a[224:225], v40 offset:4096
    buffer_load_dwordx4 v63, s[16:19], s61 offen offset:2048 lds
    v_mfma_f32_16x16x32_bf16 v[154:157], a[20:23], a[200:203], v[154:157]
    ds_read_b64_tr_b16 a[226:227], v40 offset:6144
    v_mfma_f32_16x16x32_bf16 v[166:169], a[16:19], a[204:207], v[166:169]
    ds_read_b64_tr_b16 a[228:229], v42 offset:4096
    v_mfma_f32_16x16x32_bf16 v[170:173], a[20:23], a[204:207], v[170:173]
    ds_read_b64_tr_b16 a[230:231], v42 offset:6144
    s_waitcnt lgkmcnt(8)
    v_mfma_f32_16x16x32_bf16 v[158:161], a[16:19], a[208:211], v[158:161]
    s_mov_b32 s14, 0
    s_load_dword s14, s[28:29], s39
    ds_read_b64_tr_b16 a[200:201], v39 offset:16384
    buffer_load_dwordx4 v64, s[16:19], s61 offen offset:3072 lds
    v_mfma_f32_16x16x32_bf16 v[162:165], a[20:23], a[208:211], v[162:165]
    ds_read_b64_tr_b16 a[202:203], v39 offset:18432
    s_add_u32 m0, s58, 98304
    v_mfma_f32_16x16x32_bf16 v[174:177], a[16:19], a[212:215], v[174:177]
    ds_read_b64_tr_b16 a[204:205], v41 offset:16384
    s_add_u32 s66, s66, 1
    v_mfma_f32_16x16x32_bf16 v[178:181], a[20:23], a[212:215], v[178:181]
    ds_read_b64_tr_b16 a[206:207], v41 offset:18432
    s_waitcnt lgkmcnt(8)
    v_mfma_f32_16x16x32_bf16 v[150:153], a[24:27], a[216:219], v[150:153]
    ds_read_b64_tr_b16 a[208:209], v40 offset:16384
    s_and_b32 s66, s66, 3
    s_mul_i32 s61, s66, 100352
    buffer_load_dwordx4 v63, s[16:19], s61 offen lds
    v_mfma_f32_16x16x32_bf16 v[154:157], a[28:31], a[216:219], v[154:157]
    ds_read_b64_tr_b16 a[210:211], v40 offset:18432
    v_mfma_f32_16x16x32_bf16 v[166:169], a[24:27], a[220:223], v[166:169]
    ds_read_b64_tr_b16 a[212:213], v42 offset:16384
    buffer_load_dwordx4 v64, s[16:19], s61 offen offset:1024 lds
    v_mfma_f32_16x16x32_bf16 v[170:173], a[28:31], a[220:223], v[170:173]
    ds_read_b64_tr_b16 a[214:215], v42 offset:18432
    s_waitcnt lgkmcnt(8)
    v_mfma_f32_16x16x32_bf16 v[158:161], a[24:27], a[224:227], v[158:161]
    ds_read_b64_tr_b16 a[216:217], v39 offset:20480
    s_add_u32 s61, s61, 48128
    v_mfma_f32_16x16x32_bf16 v[162:165], a[28:31], a[224:227], v[162:165]
    ds_read_b64_tr_b16 a[218:219], v39 offset:22528
    v_mfma_f32_16x16x32_bf16 v[174:177], a[24:27], a[228:231], v[174:177]
    ds_read_b64_tr_b16 a[220:221], v41 offset:20480
    buffer_load_dwordx4 v63, s[16:19], s61 offen offset:2048 lds
    v_mfma_f32_16x16x32_bf16 v[178:181], a[28:31], a[228:231], v[178:181]
    ds_read_b64_tr_b16 a[222:223], v41 offset:22528
    s_waitcnt lgkmcnt(8)
    v_mfma_f32_16x16x32_bf16 v[150:153], a[32:35], a[200:203], v[150:153]
    ds_read_b64_tr_b16 a[224:225], v40 offset:20480
    v_mfma_f32_16x16x32_bf16 v[154:157], a[36:39], a[200:203], v[154:157]
    ds_read_b64_tr_b16 a[226:227], v40 offset:22528
    v_mfma_f32_16x16x32_bf16 v[166:169], a[32:35], a[204:207], v[166:169]
    ds_read_b64_tr_b16 a[228:229], v42 offset:20480
    buffer_load_dwordx4 v64, s[16:19], s61 offen offset:3072 lds
    v_mfma_f32_16x16x32_bf16 v[170:173], a[36:39], a[204:207], v[170:173]
    ds_read_b64_tr_b16 a[230:231], v42 offset:22528
    s_waitcnt lgkmcnt(8)
    v_mfma_f32_16x16x32_bf16 v[158:161], a[32:35], a[208:211], v[158:161]
    s_waitcnt vmcnt(20)
    s_barrier
    ds_read_b64_tr_b16 a[200:201], v31 offset:16384
    s_add_u32 m0, s58, 114688
    v_mfma_f32_16x16x32_bf16 v[162:165], a[36:39], a[208:211], v[162:165]
    ds_read_b64_tr_b16 a[202:203], v31 offset:18432
    s_add_u32 s66, s66, 1
    v_mfma_f32_16x16x32_bf16 v[174:177], a[32:35], a[212:215], v[174:177]
    ds_read_b64_tr_b16 a[204:205], v33 offset:16384
    s_and_b32 s66, s66, 3
    v_mfma_f32_16x16x32_bf16 v[178:181], a[36:39], a[212:215], v[178:181]
    ds_read_b64_tr_b16 a[206:207], v33 offset:18432
    s_mul_i32 s61, s66, 100352
    buffer_load_dwordx4 v63, s[16:19], s61 offen lds
    s_waitcnt lgkmcnt(8)
    v_mfma_f32_16x16x32_bf16 v[150:153], a[40:43], a[216:219], v[150:153]
    ds_read_b64_tr_b16 a[208:209], v32 offset:16384
    v_mfma_f32_16x16x32_bf16 v[154:157], a[44:47], a[216:219], v[154:157]
    ds_read_b64_tr_b16 a[210:211], v32 offset:18432
    buffer_load_dwordx4 v64, s[16:19], s61 offen offset:1024 lds
    v_mfma_f32_16x16x32_bf16 v[166:169], a[40:43], a[220:223], v[166:169]
    ds_read_b64_tr_b16 a[212:213], v34 offset:16384
    s_add_u32 s61, s61, 48128
    v_mfma_f32_16x16x32_bf16 v[170:173], a[44:47], a[220:223], v[170:173]
    ds_read_b64_tr_b16 a[214:215], v34 offset:18432
    s_waitcnt lgkmcnt(8)
    v_mfma_f32_16x16x32_bf16 v[158:161], a[40:43], a[224:227], v[158:161]
    ds_read_b64_tr_b16 a[216:217], v31 offset:20480
    v_mfma_f32_16x16x32_bf16 v[162:165], a[44:47], a[224:227], v[162:165]
    ds_read_b64_tr_b16 a[218:219], v31 offset:22528
    buffer_load_dwordx4 v63, s[16:19], s61 offen offset:2048 lds
    v_mfma_f32_16x16x32_bf16 v[174:177], a[40:43], a[228:231], v[174:177]
    ds_read_b64_tr_b16 a[220:221], v33 offset:20480
    v_mfma_f32_16x16x32_bf16 v[178:181], a[44:47], a[228:231], v[178:181]
    ds_read_b64_tr_b16 a[222:223], v33 offset:22528
    s_waitcnt lgkmcnt(8)
    v_mfma_f32_16x16x32_bf16 v[150:153], a[48:51], a[200:203], v[150:153]
    ds_read_b64_tr_b16 a[224:225], v32 offset:20480
    v_mfma_f32_16x16x32_bf16 v[154:157], a[52:55], a[200:203], v[154:157]
    ds_read_b64_tr_b16 a[226:227], v32 offset:22528
    buffer_load_dwordx4 v64, s[16:19], s61 offen offset:3072 lds
    v_mfma_f32_16x16x32_bf16 v[166:169], a[48:51], a[204:207], v[166:169]
    ds_read_b64_tr_b16 a[228:229], v34 offset:20480
    v_mfma_f32_16x16x32_bf16 v[170:173], a[52:55], a[204:207], v[170:173]
    ds_read_b64_tr_b16 a[230:231], v34 offset:22528
    s_waitcnt lgkmcnt(8)
    v_mfma_f32_16x16x32_bf16 v[158:161], a[48:51], a[208:211], v[158:161]
    s_waitcnt vmcnt(10)
    s_atomic_add s36, s[28:29], s55
    ds_read_b64_tr_b16 a[200:201], v35 offset:0
    v_mfma_f32_16x16x32_bf16 v[162:165], a[52:55], a[208:211], v[162:165]
    ds_read_b64_tr_b16 a[202:203], v35 offset:2048
    v_mfma_f32_16x16x32_bf16 v[174:177], a[48:51], a[212:215], v[174:177]
    ds_read_b64_tr_b16 a[204:205], v37 offset:0
    v_mfma_f32_16x16x32_bf16 v[178:181], a[52:55], a[212:215], v[178:181]
    ds_read_b64_tr_b16 a[206:207], v37 offset:2048
    s_waitcnt lgkmcnt(8)
    v_mfma_f32_16x16x32_bf16 v[150:153], a[56:59], a[216:219], v[150:153]
    ds_read_b64_tr_b16 a[208:209], v36 offset:0
    v_mfma_f32_16x16x32_bf16 v[154:157], a[60:63], a[216:219], v[154:157]
    ds_read_b64_tr_b16 a[210:211], v36 offset:2048
    v_mfma_f32_16x16x32_bf16 v[166:169], a[56:59], a[220:223], v[166:169]
    ds_read_b64_tr_b16 a[212:213], v38 offset:0
    v_mfma_f32_16x16x32_bf16 v[170:173], a[60:63], a[220:223], v[170:173]
    ds_read_b64_tr_b16 a[214:215], v38 offset:2048
    s_waitcnt lgkmcnt(8)
    v_mfma_f32_16x16x32_bf16 v[158:161], a[56:59], a[224:227], v[158:161]
    ds_read_b64_tr_b16 a[216:217], v35 offset:4096
    v_mfma_f32_16x16x32_bf16 v[162:165], a[60:63], a[224:227], v[162:165]
    ds_read_b64_tr_b16 a[218:219], v35 offset:6144
    v_mfma_f32_16x16x32_bf16 v[174:177], a[56:59], a[228:231], v[174:177]
    ds_read_b64_tr_b16 a[220:221], v37 offset:4096
    v_mfma_f32_16x16x32_bf16 v[178:181], a[60:63], a[228:231], v[178:181]
    ds_read_b64_tr_b16 a[222:223], v37 offset:6144
    s_waitcnt lgkmcnt(8)
    v_mfma_f32_16x16x32_bf16 v[150:153], a[64:67], a[200:203], v[150:153]
    s_cmp_ge_u32 s14, 8
    s_cbranch_scc0 L_pollin6
L_pollok6:
    ds_read_b64_tr_b16 a[224:225], v36 offset:4096
    s_add_u32 m0, s58, 0
    s_add_u32 s51, s51, 1
    s_and_b32 s51, s51, 3
    s_lshl_b32 s61, s51, 12
    buffer_load_dwordx4 v65, s[28:31], s61 offen sc1 lds
    v_mfma_f32_16x16x32_bf16 v[154:157], a[68:71], a[200:203], v[154:157]
    ds_read_b64_tr_b16 a[226:227], v36 offset:6144
    v_mfma_f32_16x16x32_bf16 v[166:169], a[64:67], a[204:207], v[166:169]
    ds_read_b64_tr_b16 a[228:229], v38 offset:4096
    buffer_load_dwordx4 v66, s[28:31], s61 offen offset:1024 sc1 lds
    v_mfma_f32_16x16x32_bf16 v[170:173], a[68:71], a[204:207], v[170:173]
    ds_read_b64_tr_b16 a[230:231], v38 offset:6144
    s_waitcnt lgkmcnt(8)
    v_mfma_f32_16x16x32_bf16 v[158:161], a[64:67], a[208:211], v[158:161]
    s_barrier
    ds_read_b64_tr_b16 a[200:201], v35 offset:16384
    buffer_load_dwordx4 v65, s[28:31], s61 offen offset:2048 sc1 lds
    v_mfma_f32_16x16x32_bf16 v[162:165], a[68:71], a[208:211], v[162:165]
    ds_read_b64_tr_b16 a[202:203], v35 offset:18432
    v_mfma_f32_16x16x32_bf16 v[174:177], a[64:67], a[212:215], v[174:177]
    ds_read_b64_tr_b16 a[204:205], v37 offset:16384
    v_mfma_f32_16x16x32_bf16 v[178:181], a[68:71], a[212:215], v[178:181]
    ds_read_b64_tr_b16 a[206:207], v37 offset:18432
    s_waitcnt lgkmcnt(8)
    v_mfma_f32_16x16x32_bf16 v[150:153], a[72:75], a[216:219], v[150:153]
    ds_read_b64_tr_b16 a[208:209], v36 offset:16384
    buffer_load_dwordx4 v66, s[28:31], s61 offen offset:3072 sc1 lds
    v_mfma_f32_16x16x32_bf16 v[154:157], a[76:79], a[216:219], v[154:157]
    ds_read_b64_tr_b16 a[210:211], v36 offset:18432
    s_add_u32 m0, s58, 131072
    v_mfma_f32_16x16x32_bf16 v[166:169], a[72:75], a[220:223], v[166:169]
    ds_read_b64_tr_b16 a[212:213], v38 offset:16384
    s_add_u32 s51, s51, 1
    v_mfma_f32_16x16x32_bf16 v[170:173], a[76:79], a[220:223], v[170:173]
    ds_read_b64_tr_b16 a[214:215], v38 offset:18432
    s_waitcnt lgkmcnt(8)
    v_mfma_f32_16x16x32_bf16 v[158:161], a[72:75], a[224:227], v[158:161]
    ds_read_b64_tr_b16 a[216:217], v35 offset:20480
    s_and_b32 s51, s51, 3
    s_lshl_b32 s61, s51, 12
    buffer_load_dwordx4 v65, s[28:31], s61 offen sc1 lds
    v_mfma_f32_16x16x32_bf16 v[162:165], a[76:79], a[224:227], v[162:165]
    ds_read_b64_tr_b16 a[218:219], v35 offset:22528
    v_mfma_f32_16x16x32_bf16 v[174:177], a[72:75], a[228:231], v[174:177]
    ds_read_b64_tr_b16 a[220:221], v37 offset:20480
    buffer_load_dwordx4 v66, s[28:31], s61 offen offset:1024 sc1 lds
    v_mfma_f32_16x16x32_bf16 v[178:181], a[76:79], a[228:231], v[178:181]
    ds_read_b64_tr_b16 a[222:223], v37 offset:22528
    s_waitcnt lgkmcnt(8)
    v_mfma_f32_16x16x32_bf16 v[150:153], a[80:83], a[200:203], v[150:153]
    ds_read_b64_tr_b16 a[224:225], v36 offset:20480
    v_mfma_f32_16x16x32_bf16 v[154:157], a[84:87], a[200:203], v[154:157]
    ds_read_b64_tr_b16 a[226:227], v36 offset:22528
    buffer_load_dwordx4 v65, s[28:31], s61 offen offset:2048 sc1 lds
    v_mfma_f32_16x16x32_bf16 v[166:169], a[80:83], a[204:207], v[166:169]
    ds_read_b64_tr_b16 a[228:229], v38 offset:20480
    v_mfma_f32_16x16x32_bf16 v[170:173], a[84:87], a[204:207], v[170:173]
    ds_read_b64_tr_b16 a[230:231], v38 offset:22528
    s_waitcnt lgkmcnt(8)
    v_mfma_f32_16x16x32_bf16 v[158:161], a[80:83], a[208:211], v[158:161]
    s_barrier
    ds_read_b64_tr_b16 a[200:201], v31 offset:32768
    buffer_load_dwordx4 v66, s[28:31], s61 offen offset:3072 sc1 lds
    v_mfma_f32_16x16x32_bf16 v[162:165], a[84:87], a[208:211], v[162:165]
    ds_read_b64_tr_b16 a[202:203], v31 offset:34816
    s_add_u32 m0, s58, 147456
    v_mfma_f32_16x16x32_bf16 v[174:177], a[80:83], a[212:215], v[174:177]
    ds_read_b64_tr_b16 a[204:205], v33 offset:32768
    s_add_u32 s51, s51, 1
    v_mfma_f32_16x16x32_bf16 v[178:181], a[84:87], a[212:215], v[178:181]
    ds_read_b64_tr_b16 a[206:207], v33 offset:34816
    s_waitcnt lgkmcnt(8)
    v_mfma_f32_16x16x32_bf16 v[150:153], a[88:91], a[216:219], v[150:153]
    ds_read_b64_tr_b16 a[208:209], v32 offset:32768
    s_and_b32 s51, s51, 3
    s_lshl_b32 s61, s51, 12
    buffer_load_dwordx4 v65, s[28:31], s61 offen sc1 lds
    v_mfma_f32_16x16x32_bf16 v[154:157], a[92:95], a[216:219], v[154:157]
    ds_read_b64_tr_b16 a[210:211], v32 offset:34816
    v_mfma_f32_16x16x32_bf16 v[166:169], a[88:91], a[220:223], v[166:169]
    ds_read_b64_tr_b16 a[212:213], v34 offset:32768
    buffer_load_dwordx4 v66, s[28:31], s61 offen offset:1024 sc1 lds
    v_mfma_f32_16x16x32_bf16 v[170:173], a[92:95], a[220:223], v[170:173]
    ds_read_b64_tr_b16 a[214:215], v34 offset:34816
    s_waitcnt lgkmcnt(8)
    v_mfma_f32_16x16x32_bf16 v[158:161], a[88:91], a[224:227], v[158:161]
    ds_read_b64_tr_b16 a[216:217], v31 offset:36864
    v_mfma_f32_16x16x32_bf16 v[162:165], a[92:95], a[224:227], v[162:165]
    ds_read_b64_tr_b16 a[218:219], v31 offset:38912
    buffer_load_dwordx4 v65, s[28:31], s61 offen offset:2048 sc1 lds
    v_mfma_f32_16x16x32_bf16 v[174:177], a[88:91], a[228:231], v[174:177]
    ds_read_b64_tr_b16 a[220:221], v33 offset:36864
    v_mfma_f32_16x16x32_bf16 v[178:181], a[92:95], a[228:231], v[178:181]
    ds_read_b64_tr_b16 a[222:223], v33 offset:38912
    s_waitcnt lgkmcnt(8)
    v_mfma_f32_16x16x32_bf16 v[150:153], a[96:99], a[200:203], v[150:153]
    ds_read_b64_tr_b16 a[224:225], v32 offset:36864
    buffer_load_dwordx4 v66, s[28:31], s61 offen offset:3072 sc1 lds
    v_mfma_f32_16x16x32_bf16 v[154:157], a[100:103], a[200:203], v[154:157]
    ds_read_b64_tr_b16 a[226:227], v32 offset:38912
    s_add_u32 m0, s58, 16384
    v_mfma_f32_16x16x32_bf16 v[166:169], a[96:99], a[204:207], v[166:169]
    ds_read_b64_tr_b16 a[228:229], v34 offset:36864
    s_add_u32 s66, s66, 1
    v_mfma_f32_16x16x32_bf16 v[170:173], a[100:103], a[204:207], v[170:173]
    ds_read_b64_tr_b16 a[230:231], v34 offset:38912
    s_waitcnt lgkmcnt(8)
    v_mfma_f32_16x16x32_bf16 v[158:161], a[96:99], a[208:211], v[158:161]
    s_waitcnt vmcnt(8)
    s_barrier
    s_xor_b32 s55, s55, 1024
    s_mov_b32 s14, 0
    s_load_dword s14, s[28:29], s55
    ds_read_b64_tr_b16 v[198:199], v43 offset:49152
    ds_read_b64_tr_b16 v[200:201], v43 offset:53248
    s_and_b32 s66, s66, 3
    s_mul_i32 s61, s66, 100352
    buffer_load_dwordx4 v63, s[16:19], s61 offen lds
    v_mfma_f32_16x16x32_bf16 v[162:165], a[100:103], a[208:211], v[162:165]
    ds_read_b64_tr_b16 v[202:203], v44 offset:49152
    v_mfma_f32_16x16x32_bf16 v[174:177], a[96:99], a[212:215], v[174:177]
    ds_read_b64_tr_b16 v[204:205], v44 offset:53248
    buffer_load_dwordx4 v64, s[16:19], s61 offen offset:1024 lds
    v_mfma_f32_16x16x32_bf16 v[178:181], a[100:103], a[212:215], v[178:181]
    ds_read_b128 a[200:203], v47 offset:0
    s_waitcnt lgkmcnt(9)
    v_mfma_f32_16x16x32_bf16 v[150:153], a[104:107], a[216:219], v[150:153]
    ds_read_b128 a[204:207], v48 offset:0
    s_add_u32 s61, s61, 48128
    v_mfma_f32_16x16x32_bf16 v[154:157], a[108:111], a[216:219], v[154:157]
    ds_read_b128 a[208:211], v47 offset:1024
    buffer_load_dwordx4 v63, s[16:19], s61 offen offset:2048 lds
    v_mfma_f32_16x16x32_bf16 v[166:169], a[104:107], a[220:223], v[166:169]
    ds_read_b128 a[212:215], v48 offset:1024
    v_mfma_f32_16x16x32_bf16 v[170:173], a[108:111], a[220:223], v[170:173]
    s_waitcnt lgkmcnt(8)
    v_mfma_f32_16x16x32_bf16 v[158:161], a[104:107], a[224:227], v[158:161]
    ds_read_b64_tr_b16 v[206:207], v43 offset:51200
    ds_read_b64_tr_b16 v[208:209], v43 offset:55296
    v_mfma_f32_16x16x32_bf16 v[162:165], a[108:111], a[224:227], v[162:165]
    ds_read_b64_tr_b16 v[210:211], v44 offset:51200
    buffer_load_dwordx4 v64, s[16:19], s61 offen offset:3072 lds
    v_mfma_f32_16x16x32_bf16 v[174:177], a[104:107], a[228:231], v[174:177]
    ds_read_b64_tr_b16 v[212:213], v44 offset:55296
    s_add_u32 m0, s58, 65536
    v_mfma_f32_16x16x32_bf16 v[178:181], a[108:111], a[228:231], v[178:181]
    ds_read_b128 a[216:219], v47 offset:2048
    s_waitcnt lgkmcnt(7)
    v_mfma_f32_16x16x32_bf16 v[150:153], v[198:201], a[200:203], v[150:153]
    ds_read_b128 a[220:223], v48 offset:2048
    s_add_u32 s51, s51, 1
    s_and_b32 s51, s51, 3
    s_lshl_b32 s61, s51, 12
    buffer_load_dwordx4 v65, s[28:31], s61 offen sc1 lds
    v_mfma_f32_16x16x32_bf16 v[154:157], v[202:205], a[200:203], v[154:157]
    ds_read_b128 a[224:227], v47 offset:3072
    v_mfma_f32_16x16x32_bf16 v[166:169], v[198:201], a[204:207], v[166:169]
    ds_read_b128 a[228:231], v48 offset:3072
    buffer_load_dwordx4 v66, s[28:31], s61 offen offset:1024 sc1 lds
    v_mfma_f32_16x16x32_bf16 v[170:173], v[202:205], a[204:207], v[170:173]
    s_waitcnt lgkmcnt(8)
    v_mfma_f32_16x16x32_bf16 v[158:161], v[198:201], a[208:211], v[158:161]
    s_waitcnt vmcnt(10)
    s_barrier
    ds_read_b64_tr_b16 v[214:215], v45 offset:32768
    ds_read_b64_tr_b16 v[216:217], v45 offset:36864
    v_mfma_f32_16x16x32_bf16 v[162:165], v[202:205], a[208:211], v[162:165]
    ds_read_b64_tr_b16 v[218:219], v46 offset:32768
    buffer_load_dwordx4 v65, s[28:31], s61 offen offset:2048 sc1 lds
    v_mfma_f32_16x16x32_bf16 v[174:177], v[198:201], a[212:215], v[174:177]
    ds_read_b64_tr_b16 v[220:221], v46 offset:36864
    v_mfma_f32_16x16x32_bf16 v[178:181], v[202:205], a[212:215], v[178:181]
    ds_read_b128 a[200:203], v51 offset:0
    s_waitcnt lgkmcnt(7)
    v_mfma_f32_16x16x32_bf16 v[150:153], v[206:209], a[216:219], v[150:153]
    ds_read_b128 a[204:207], v52 offset:0
    buffer_load_dwordx4 v66, s[28:31], s61 offen offset:3072 sc1 lds
    v_mfma_f32_16x16x32_bf16 v[154:157], v[210:213], a[216:219], v[154:157]
    ds_read_b128 a[208:211], v51 offset:1024
    v_mfma_f32_16x16x32_bf16 v[166:169], v[206:209], a[220:223], v[166:169]
    ds_read_b128 a[212:215], v52 offset:1024
    v_mfma_f32_16x16x32_bf16 v[170:173], v[210:213], a[220:223], v[170:173]
    s_waitcnt lgkmcnt(8)
    v_mfma_f32_16x16x32_bf16 v[158:161], v[206:209], a[224:227], v[158:161]
    s_cmp_ge_u32 s14, 1
    s_cbranch_scc0 L_pollin7
L_pollok7:
    v_xor_b32 v21, 131072, v21
    ds_read_b64_tr_b16 v[198:199], v45 offset:34816
    ds_read_b64_tr_b16 v[200:201], v45 offset:38912
    buffer_load_dwordx4 v[246:249], v21, s[28:31], 0 offen offset:2048 sc1
    v_mfma_f32_16x16x32_bf16 v[162:165], v[210:213], a[224:227], v[162:165]
    ds_read_b64_tr_b16 v[202:203], v46 offset:34816
    buffer_load_dwordx4 v[250:253], v21, s[28:31], 0 offen offset:3072 sc1
    v_mfma_f32_16x16x32_bf16 v[174:177], v[206:209], a[228:231], v[174:177]
    ds_read_b64_tr_b16 v[204:205], v46 offset:38912
    v_mfma_f32_16x16x32_bf16 v[178:181], v[210:213], a[228:231], v[178:181]
    ds_read_b128 a[216:219], v51 offset:2048
    s_waitcnt lgkmcnt(7)
    v_mfma_f32_16x16x32_bf16 v[150:153], v[214:217], a[200:203], v[150:153]
    ds_read_b128 a[220:223], v52 offset:2048
    buffer_load_dwordx4 v[238:241], v21, s[28:31], 0 offen offset:0 sc1
    v_mfma_f32_16x16x32_bf16 v[154:157], v[218:221], a[200:203], v[154:157]
    ds_read_b128 a[224:227], v51 offset:3072
    buffer_load_dwordx4 v[242:245], v21, s[28:31], 0 offen offset:1024 sc1
    v_mfma_f32_16x16x32_bf16 v[166:169], v[214:217], a[204:207], v[166:169]
    ds_read_b128 a[228:231], v52 offset:3072
    v_mfma_f32_16x16x32_bf16 v[170:173], v[218:221], a[204:207], v[170:173]
    s_waitcnt lgkmcnt(8)
    v_mfma_f32_16x16x32_bf16 v[158:161], v[214:217], a[208:211], v[158:161]
    s_waitcnt vmcnt(12)
    s_barrier
    ds_read_b64_tr_b16 v[206:207], v45 offset:49152
    ds_read_b64_tr_b16 v[208:209], v45 offset:53248
    v_mfma_f32_16x16x32_bf16 v[162:165], v[218:221], a[208:211], v[162:165]
    ds_read_b64_tr_b16 v[210:211], v46 offset:49152
    v_mfma_f32_16x16x32_bf16 v[174:177], v[214:217], a[212:215], v[174:177]
    ds_read_b64_tr_b16 v[212:213], v46 offset:53248
    v_mfma_f32_16x16x32_bf16 v[178:181], v[218:221], a[212:215], v[178:181]
    ds_read_b128 a[200:203], v51 offset:16384
    s_waitcnt lgkmcnt(7)
    v_mfma_f32_16x16x32_bf16 v[150:153], v[198:201], a[216:219], v[150:153]
    ds_read_b128 a[204:207], v52 offset:16384
    v_mfma_f32_16x16x32_bf16 v[154:157], v[202:205], a[216:219], v[154:157]
    ds_read_b128 a[208:211], v51 offset:17408
    v_mfma_f32_16x16x32_bf16 v[166:169], v[198:201], a[220:223], v[166:169]
    ds_read_b128 a[212:215], v52 offset:17408
    v_mfma_f32_16x16x32_bf16 v[170:173], v[202:205], a[220:223], v[170:173]
    s_waitcnt lgkmcnt(8)
    v_mfma_f32_16x16x32_bf16 v[158:161], v[198:201], a[224:227], v[158:161]
    ds_read_b64_tr_b16 v[214:215], v45 offset:51200
    ds_read_b64_tr_b16 v[216:217], v45 offset:55296
    v_mfma_f32_16x16x32_bf16 v[162:165], v[202:205], a[224:227], v[162:165]
    ds_read_b64_tr_b16 v[218:219], v46 offset:51200
    v_mfma_f32_16x16x32_bf16 v[174:177], v[198:201], a[228:231], v[174:177]
    ds_read_b64_tr_b16 v[220:221], v46 offset:55296
    v_mfma_f32_16x16x32_bf16 v[178:181], v[202:205], a[228:231], v[178:181]
    ds_read_b128 a[216:219], v51 offset:18432
    s_waitcnt lgkmcnt(7)
    v_mfma_f32_16x16x32_bf16 v[150:153], v[206:209], a[200:203], v[150:153]
    ds_read_b128 a[220:223], v52 offset:18432
    v_mfma_f32_16x16x32_bf16 v[154:157], v[210:213], a[200:203], v[154:157]
    ds_read_b128 a[224:227], v51 offset:19456
    v_mfma_f32_16x16x32_bf16 v[166:169], v[206:209], a[204:207], v[166:169]
    ds_read_b128 a[228:231], v52 offset:19456
    v_mfma_f32_16x16x32_bf16 v[170:173], v[210:213], a[204:207], v[170:173]
    s_waitcnt lgkmcnt(8)
    v_mfma_f32_16x16x32_bf16 v[158:161], v[206:209], a[208:211], v[158:161]
    s_waitcnt vmcnt(4)
    s_barrier
    ds_read_b64_tr_b16 v[198:199], v43 offset:16384
    ds_read_b64_tr_b16 v[200:201], v43 offset:20480
    v_mfma_f32_16x16x32_bf16 v[162:165], v[210:213], a[208:211], v[162:165]
    ds_read_b64_tr_b16 v[202:203], v44 offset:16384
    v_mfma_f32_16x16x32_bf16 v[174:177], v[206:209], a[212:215], v[174:177]
    ds_read_b64_tr_b16 v[204:205], v44 offset:20480
    v_mfma_f32_16x16x32_bf16 v[178:181], v[210:213], a[212:215], v[178:181]
    ds_read_b128 a[200:203], v50 offset:0
    s_waitcnt lgkmcnt(7)
    v_mfma_f32_16x16x32_bf16 v[150:153], v[214:217], a[216:219], v[150:153]
    ds_read_b128 a[204:207], v50 offset:1024
    ds_read_b64_tr_b16 v[206:207], v43 offset:18432
    v_mfma_f32_16x16x32_bf16 v[154:157], v[218:221], a[216:219], v[154:157]
    ds_read_b64_tr_b16 v[208:209], v43 offset:22528
    ds_read_b64_tr_b16 v[210:211], v44 offset:18432
    v_mfma_f32_16x16x32_bf16 v[166:169], v[214:217], a[220:223], v[166:169]
    ds_read_b64_tr_b16 v[212:213], v44 offset:22528
    v_mfma_f32_16x16x32_bf16 v[170:173], v[218:221], a[220:223], v[170:173]
    ds_read_b128 a[208:211], v50 offset:2048
    s_waitcnt lgkmcnt(11)
    v_mfma_f32_16x16x32_bf16 v[158:161], v[214:217], a[224:227], v[158:161]
    ds_read_b128 a[212:215], v50 offset:3072
    v_mfma_f32_16x16x32_bf16 v[162:165], v[218:221], a[224:227], v[162:165]
    v_mfma_f32_16x16x32_bf16 v[174:177], v[214:217], a[228:231], v[174:177]
    v_mfma_f32_16x16x32_bf16 v[178:181], v[218:221], a[228:231], v[178:181]
    s_waitcnt lgkmcnt(6)
    v_mfma_f32_16x16x32_bf16 v[166:169], v[198:201], a[200:203], v[166:169]
    ds_read_b128 a[224:227], v49 offset:0
    v_mfma_f32_16x16x32_bf16 v[170:173], v[202:205], a[200:203], v[170:173]
    v_mfma_f32_16x16x32_bf16 v[174:177], v[198:201], a[204:207], v[174:177]
    ds_read_b128 a[228:231], v49 offset:1024
    v_mfma_f32_16x16x32_bf16 v[178:181], v[202:205], a[204:207], v[178:181]
    s_waitcnt lgkmcnt(2)
    v_mfma_f32_16x16x32_bf16 v[166:169], v[206:209], a[208:211], v[166:169]
    ds_read_b128 a[200:203], v49 offset:2048
L_pad4:
    s_cbranch_execz L_warm
    v_mfma_f32_16x16x32_bf16 v[170:173], v[210:213], a[208:211], v[170:173]
    v_mfma_f32_16x16x32_bf16 v[174:177], v[206:209], a[212:215], v[174:177]
    ds_read_b128 a[204:207], v49 offset:3072
    v_mfma_f32_16x16x32_bf16 v[178:181], v[210:213], a[212:215], v[178:181]
    s_waitcnt vmcnt(3)
    v_mfma_f32_16x16x32_bf16 v[166:169], a[250:253], v[246:249], v[166:169]
    v_mfma_f32_16x16x32_bf16 v[170:173], a[248:251], v[246:249], v[170:173]
    s_waitcnt vmcnt(2)
    v_mfma_f32_16x16x32_bf16 v[174:177], a[250:253], v[250:253], v[174:177]
    v_mfma_f32_16x16x32_bf16 v[178:181], a[248:251], v[250:253], v[178:181]
    s_waitcnt lgkmcnt(2)
    v_mfma_f32_16x16x32_bf16 v[150:153], v[198:201], a[224:227], v[150:153]
    v_mfma_f32_16x16x32_bf16 v[154:157], v[202:205], a[224:227], v[154:157]
    v_mfma_f32_16x16x32_bf16 v[158:161], v[198:201], a[228:231], v[158:161]
    ds_write_b128 v87, v[166:169] offset:8192
    v_mfma_f32_16x16x32_bf16 v[162:165], v[202:205], a[228:231], v[162:165]
    s_waitcnt lgkmcnt(1)
    v_mfma_f32_16x16x32_bf16 v[150:153], v[206:209], a[200:203], v[150:153]
    ds_write_b128 v88, v[170:173] offset:8192
    v_mfma_f32_16x16x32_bf16 v[154:157], v[210:213], a[200:203], v[154:157]
    v_mfma_f32_16x16x32_bf16 v[158:161], v[206:209], a[204:207], v[158:161]
    ds_write_b128 v87, v[174:177] offset:12288
    v_mfma_f32_16x16x32_bf16 v[162:165], v[210:213], a[204:207], v[162:165]
    s_waitcnt vmcnt(1)
    v_mfma_f32_16x16x32_bf16 v[150:153], a[250:253], v[238:241], v[150:153]
    ds_write_b128 v88, v[178:181] offset:12288
    v_mfma_f32_16x16x32_bf16 v[154:157], a[248:251], v[238:241], v[154:157]
    s_waitcnt vmcnt(0)
    v_mfma_f32_16x16x32_bf16 v[158:161], a[250:253], v[242:245], v[158:161]
    v_mfma_f32_16x16x32_bf16 v[162:165], a[248:251], v[242:245], v[162:165]
    s_nop 2
    ds_write_b128 v87, v[150:153] offset:0
    s_nop 0
    ds_write_b128 v88, v[154:157] offset:0
    s_nop 0
    ds_write_b128 v87, v[158:161] offset:4096
    ds_write_b128 v88, v[162:165] offset:4096
    s_waitcnt lgkmcnt(0)
    s_barrier
    ds_read_b128 v[118:121], v89 offset:0
    ds_read_b128 v[122:125], v90 offset:0
    ds_read_b128 v[126:129], v91 offset:0
    ds_read_b128 v[130:133], v92 offset:0
    ds_read_b128 v[134:137], v89 offset:2048
    ds_read_b128 v[138:141], v90 offset:2048
    ds_read_b128 v[142:145], v91 offset:2048
    ds_read_b128 v[146:149], v92 offset:2048
    s_waitcnt lgkmcnt(7)
    v_pk_add_f32 v[222:223], v[222:223], v[118:119]
    v_pk_add_f32 v[224:225], v[224:225], v[120:121]
    s_waitcnt lgkmcnt(6)
    v_pk_add_f32 v[226:227], v[226:227], v[122:123]
    v_pk_add_f32 v[228:229], v[228:229], v[124:125]
    s_waitcnt lgkmcnt(5)
    v_pk_add_f32 v[222:223], v[222:223], v[126:127]
    v_pk_add_f32 v[224:225], v[224:225], v[128:129]
    s_waitcnt lgkmcnt(4)
    v_pk_add_f32 v[226:227], v[226:227], v[130:131]
    v_pk_add_f32 v[228:229], v[228:229], v[132:133]
    v_cvt_pk_bf16_f32 v110, v222, v223
    v_cvt_pk_bf16_f32 v111, v224, v225
    v_cvt_pk_bf16_f32 v112, v226, v227
    v_cvt_pk_bf16_f32 v113, v228, v229
    buffer_store_dwordx4 v[110:113], v85, s[32:35], 0 offen
    s_waitcnt lgkmcnt(3)
    v_pk_add_f32 v[230:231], v[230:231], v[134:135]
    v_pk_add_f32 v[232:233], v[232:233], v[136:137]
    s_waitcnt lgkmcnt(2)
    v_pk_add_f32 v[234:235], v[234:235], v[138:139]
    v_pk_add_f32 v[236:237], v[236:237], v[140:141]
    s_waitcnt lgkmcnt(1)
    v_pk_add_f32 v[230:231], v[230:231], v[142:143]
    v_pk_add_f32 v[232:233], v[232:233], v[144:145]
    s_waitcnt lgkmcnt(0)
    v_pk_add_f32 v[234:235], v[234:235], v[146:147]
    v_pk_add_f32 v[236:237], v[236:237], v[148:149]
    v_cvt_pk_bf16_f32 v114, v230, v231
    v_cvt_pk_bf16_f32 v115, v232, v233
    v_cvt_pk_bf16_f32 v116, v234, v235
    v_cvt_pk_bf16_f32 v117, v236, v237
    buffer_store_dwordx4 v[114:117], v86, s[32:35], 0 offen
L_fin:
L_end:
    s_endpgm
L_nonce:
    buffer_load_dword v12, v16, s[44:47], 0 offen sc1
    s_add_u32 s60, s60, 1
    s_waitcnt vmcnt(0)
    v_readfirstlane_b32 s57, v12
    s_cmp_ge_u32 s60, 20000
    s_cbranch_scc1 L_nonce_ok
    s_cmp_eq_u32 s57, 0
    s_cbranch_scc1 L_nonce
    s_branch L_nonce_ok
L_pollin0:
    s_mov_b32 s60, 0
L_poll0:
    s_sleep 4
    buffer_load_dword v18, v20, s[28:31], 0 offen sc1
    s_add_u32 s60, s60, 1
    s_waitcnt vmcnt(0)
    v_cmp_ne_u32 vcc, s57, v18
    s_cbranch_vccz L_pollok0
    s_cmp_lt_u32 s60, 20000
    s_cbranch_scc1 L_poll0
    s_branch L_pollok0
L_pollin1:
    s_waitcnt lgkmcnt(0)
    s_cmp_ge_u32 s14, 14
    s_cbranch_scc1 L_pollok1
    s_mov_b32 s60, 0
    s_branch L_poll1a
L_poll1:
    s_sleep 8
L_poll1a:
    buffer_load_dword v18, off, s[44:47], s15 sc1
    s_add_u32 s60, s60, 1
    s_waitcnt vmcnt(0)
    v_readfirstlane_b32 s14, v18
    s_nop 0
    s_cmp_ge_u32 s14, 14
    s_cbranch_scc1 L_pollok1
    s_cmp_lt_u32 s60, 20000
    s_cbranch_scc1 L_poll1
    s_branch L_pollok1
L_pollin2:
    s_waitcnt lgkmcnt(0)
    s_cmp_ge_u32 s14, 2
    s_cbranch_scc1 L_pollok2
    s_mov_b32 s60, 0
    s_branch L_poll2a
L_poll2:
    s_sleep 4
L_poll2a:
    buffer_load_dword v18, off, s[28:31], s37 sc1
    s_add_u32 s60, s60, 1
    s_waitcnt vmcnt(0)
    v_readfirstlane_b32 s14, v18
    s_nop 0
    s_cmp_ge_u32 s14, 2
    s_cbranch_scc1 L_pollok2
    s_cmp_lt_u32 s60, 20000
    s_cbranch_scc1 L_poll2
    s_branch L_pollok2
L_nonceh:
    buffer_load_dword v12, v16, s[44:47], 0 offen sc1
    s_add_u32 s60, s60, 1
    s_waitcnt vmcnt(0)
    v_readfirstlane_b32 s57, v12
    s_cmp_ge_u32 s60, 20000
    s_cbranch_scc1 L_nonce_okh
    s_cmp_eq_u32 s57, 0
    s_cbranch_scc1 L_nonceh
    s_branch L_nonce_okh
L_pollin3:
    s_mov_b32 s60, 0
L_poll3:
    s_sleep 8
    buffer_load_dword v18, v20, s[28:31], 0 offen sc1
    s_add_u32 s60, s60, 1
    s_waitcnt vmcnt(0)
    v_cmp_ne_u32 vcc, s57, v18
    s_cbranch_vccz L_pollok3
    s_cmp_lt_u32 s60, 20000
    s_cbranch_scc1 L_poll3
    s_branch L_pollok3
L_pollin4:
    s_waitcnt lgkmcnt(0)
    s_cmp_ge_u32 s14, 14
    s_cbranch_scc1 L_pollok4
    s_mov_b32 s60, 0
    s_branch L_poll4a
L_poll4:
    s_sleep 16
L_poll4a:
    buffer_load_dword v18, off, s[44:47], s15 sc1
    s_add_u32 s60, s60, 1
    s_waitcnt vmcnt(0)
    v_readfirstlane_b32 s14, v18
    s_nop 0
    s_cmp_ge_u32 s14, 14
    s_cbranch_scc1 L_pollok4
    s_cmp_lt_u32 s60, 20000
    s_cbranch_scc1 L_poll4
    s_branch L_pollok4
L_nog1:
    s_nop 1
    s_mov_b32 s14, 1204224
    s_mov_b32 s15, 0x20000
    s_sub_u32 s3, s2, 200
    s_cmp_lt_u32 s3, 42
    s_cselect_b32 s81, 0, 268435456
    s_cselect_b32 s3, s3, 0
    s_mul_i32 s79, s3, 43
    s_lshr_b32 s79, s79, 7
    s_mul_i32 s80, s79, 3
    s_sub_u32 s80, s3, s80
    v_min_u32 v13, 55, v1
    s_lshl_b32 s3, s79, 2
    s_add_u32 s3, s3, s48
    s_mul_i32 s3, s3, 21504
    s_mul_i32 s60, s80, 896
    s_add_u32 s3, s3, s60
    s_add_u32 s3, s3, s81
    v_lshl_add_u32 v242, v13, 4, s3
    s_mul_i32 s60, s48, 8448
    s_add_u32 m0, s60, 0
    s_mov_b32 s3, 0
    buffer_load_dwordx4 v242, s[12:15], s3 offen lds
    s_add_u32 m0, s60, 1056
    s_mov_b32 s3, 2688
    buffer_load_dwordx4 v242, s[12:15], s3 offen lds
    s_add_u32 m0, s60, 2112
    s_mov_b32 s3, 5376
    buffer_load_dwordx4 v242, s[12:15], s3 offen lds
    s_add_u32 m0, s60, 3168
    s_mov_b32 s3, 8064
    buffer_load_dwordx4 v242, s[12:15], s3 offen lds
    s_add_u32 m0, s60, 4224
    s_mov_b32 s3, 10752
    buffer_load_dwordx4 v242, s[12:15], s3 offen lds
    s_add_u32 m0, s60, 5280
    s_mov_b32 s3, 13440
    buffer_load_dwordx4 v242, s[12:15], s3 offen lds
    s_add_u32 m0, s60, 6336
    s_mov_b32 s3, 16128
    buffer_load_dwordx4 v242, s[12:15], s3 offen lds
    s_add_u32 m0, s60, 7392
    s_mov_b32 s3, 18816
    buffer_load_dwordx4 v242, s[12:15], s3 offen lds
    s_mul_i32 s53, s101, 37
    s_lshr_b32 s53, s53, 8
    s_mul_i32 s54, s53, 7
    s_sub_u32 s54, s101, s54
    s_and_b32 s53, s53, 3
    s_xor_b32 s53, s53, 0
    s_lshl_b32 s3, s6, 2
    s_add_u32 s53, s53, s3
    s_lshl_b32 s53, s53, 1
    s_add_u32 s53, s53, s7
    s_mov_b32 s42, 4096
    s_mov_b32 s43, 0x20000
    s_lshl_b32 s3, s53, 2
    s_add_u32 s3, s3, s48
    s_lshl_b32 s60, s3, 5
    v_lshl_add_u32 v82, v5, 1, s60
    s_mul_i32 s3, s3, 14336
    s_lshl_b32 s60, s54, 7
    s_add_u32 s3, s3, s60
    v_mul_u32_u24 v14, 896, v5
    v_lshl_add_u32 v14, v6, 4, v14
    v_add_u32 v85, s3, v14
    v_add_u32 v86, 7168, v85
    s_cmp_lt_u32 s101, 28
    s_cselect_b32 s56, 1, 0
    s_lshl_b32 s50, s7, 3
    s_and_b32 s3, s101, 7
    s_add_u32 s50, s50, s3
    s_lshr_b32 s60, s101, 3
    s_lshl_b32 s49, s6, 2
    s_add_u32 s49, s49, s60
    s_lshl_b32 s49, s49, 2
    s_add_u32 s49, s49, s48
    s_mul_i32 s60, s60, 0
    s_add_u32 s3, s3, s60
    s_sub_u32 s60, s3, 7
    s_cmp_ge_u32 s3, 7
    s_cselect_b32 s3, s60, s3
    s_lshl_b32 s62, s3, 18
    s_mul_i32 s63, s3, 12288
    s_mov_b32 s30, 20971520
    s_mov_b32 s31, 0x20000
    s_mov_b32 s75, 0x3727c5ac
    s_mov_b32 s76, 0x3b124925
    s_mov_b32 s77, 0x3f803f80
    v_lshlrev_b32 v4, 4, v1
    v_bfe_u32 v7, v1, 2, 2
    v_and_b32 v8, 3, v1
    v_mul_u32_u24 v13, 960, v9
    v_lshl_add_u32 v13, v10, 4, v13
    s_mul_i32 s3, s48, 1920
    s_add_u32 s3, s3, 147456
    v_add_u32 v230, s3, v13
    v_mul_u32_u24 v13, 960, v7
    v_lshl_add_u32 v13, v3, 5, v13
    v_lshl_add_u32 v13, v8, 3, v13
    s_lshl_b32 s3, s48, 8
    s_add_u32 s3, s3, 147456
    v_add_u32 v231, s3, v13
    s_lshl_b32 s3, s48, 3
    s_add_u32 s3, s3, 155648
    v_lshl_add_u32 v232, v9, 2, s3
    v_lshlrev_b32 v237, 2, v6
    v_and_b32 v2, 15, v1
    v_lshlrev_b32 v238, 13, v3
    v_add_lshl_u32 v238, v238, v2, 3
    v_add_u32 v237, 155648, v237
    v_lshlrev_b32 v13, 17, v9
    v_lshl_add_u32 v233, v10, 4, v13
    s_cmp_eq_u32 s48, 3
    s_cselect_b32 s60, 268435456, 0
    s_lshl_b32 s70, s48, 10
    s_add_u32 s70, s70, s2
    s_lshl_b32 s70, s70, 9
    s_add_u32 s71, s70, 262144
    s_add_u32 s71, s71, s60
    s_xor_b32 s60, s60, 268435456
    s_lshl_b32 s72, s2, 7
    s_add_u32 s72, s72, s60
    s_add_u32 s72, s72, 6291456
    s_lshr_b32 s74, s2, 2
    s_lshl_b32 s74, s74, 4
    s_and_b32 s3, s2, 3
    s_add_u32 s74, s74, s3
    s_lshl_b32 s74, s74, 2
    s_add_u32 s74, s74, 10485760
    v_cmp_gt_u32 vcc, 8, v0
    v_lshlrev_b32 v236, 13, v0
    v_mov_b32 v13, 268435456
    s_and_b32 s3, s2, 7
    s_lshl_b32 s3, s3, 13
    s_add_u32 s3, s3, 10485760
    v_lshrrev_b32 v14, 2, v0
    v_lshl_add_u32 v14, v14, 6, s3
    v_and_b32 v15, 3, v0
    v_lshl_add_u32 v20, v15, 2, v14
    v_cndmask_b32 v236, v13, v236, vcc
    v_mov_b32 v16, 0
    s_lshl_b32 s3, s48, 14
    s_add_u32 s74, s74, s3
    s_add_u32 s73, s74, 8192
    s_waitcnt vmcnt(10)
    v_dot2_f32_bf16 v226, v182, s77, 0
    v_dot2_f32_bf16 v227, v182, v182, 0
    v_dot2_f32_bf16 v226, v183, s77, v226
    v_dot2_f32_bf16 v227, v183, v183, v227
    v_dot2_f32_bf16 v226, v184, s77, v226
    v_dot2_f32_bf16 v227, v184, v184, v227
    v_dot2_f32_bf16 v226, v185, s77, v226
    v_dot2_f32_bf16 v227, v185, v185, v227
    s_waitcnt vmcnt(9)
    v_dot2_f32_bf16 v226, v186, s77, v226
    v_dot2_f32_bf16 v227, v186, v186, v227
    v_dot2_f32_bf16 v226, v187, s77, v226
    v_dot2_f32_bf16 v227, v187, v187, v227
    v_dot2_f32_bf16 v226, v188, s77, v226
    v_dot2_f32_bf16 v227, v188, v188, v227
    v_dot2_f32_bf16 v226, v189, s77, v226
    v_dot2_f32_bf16 v227, v189, v189, v227
    buffer_load_dword v12, v16, s[44:47], 0 offen sc1
    v_lshlrev_b32 v190, 16, v182
    v_and_b32 v191, 0xffff0000, v182
    v_add_f32_dpp v226, v226, v226 quad_perm:[1,0,3,2] row_mask:0xf bank_mask:0xf
    v_add_f32_dpp v227, v227, v227 quad_perm:[1,0,3,2] row_mask:0xf bank_mask:0xf
    v_lshlrev_b32 v192, 16, v183
    v_add_f32_dpp v226, v226, v226 quad_perm:[2,3,0,1] row_mask:0xf bank_mask:0xf
    v_add_f32_dpp v227, v227, v227 quad_perm:[2,3,0,1] row_mask:0xf bank_mask:0xf
    v_and_b32 v193, 0xffff0000, v183
    v_add_f32_dpp v226, v226, v226 row_half_mirror row_mask:0xf bank_mask:0xf
    v_add_f32_dpp v227, v227, v227 row_half_mirror row_mask:0xf bank_mask:0xf
    v_lshlrev_b32 v194, 16, v184
    v_add_f32_dpp v226, v226, v226 row_mirror row_mask:0xf bank_mask:0xf
    v_add_f32_dpp v227, v227, v227 row_mirror row_mask:0xf bank_mask:0xf
    v_and_b32 v195, 0xffff0000, v184
    v_mov_b32 v228, v226
    v_mov_b32 v229, v227
    v_lshlrev_b32 v196, 16, v185
    v_permlane16_swap_b32 v226, v228
    v_permlane16_swap_b32 v227, v229
    v_add_f32 v226, v226, v228
    v_add_f32 v227, v227, v229
    v_mul_f32_e64 v226, -v226, s76
    v_mul_f32 v228, v226, v226
    v_fma_f32 v227, v227, s76, -v228
    v_max_f32 v227, 0, v227
    v_add_f32 v228, s75, v227
    v_rsq_f32 v222, v228
    v_and_b32 v197, 0xffff0000, v185
    v_mul_f32 v228, v222, v222
    v_fma_f32 v229, v228, v227, s75
    v_rsq_f32 v228, v229
    v_mul_f32 v223, v226, v222
    v_mul_f32 v224, v222, v228
    v_mul_f32 v225, v223, v228
    v_mul_f32 v229, v229, v228
    ds_write_b32 v232, v229
    v_lshlrev_b32 v198, 16, v186
    v_and_b32 v199, 0xffff0000, v186
    v_lshlrev_b32 v200, 16, v187
    v_and_b32 v201, 0xffff0000, v187
    v_lshlrev_b32 v202, 16, v188
    v_and_b32 v203, 0xffff0000, v188
    v_lshlrev_b32 v204, 16, v189
    v_and_b32 v205, 0xffff0000, v189
    v_pk_fma_f32 v[206:207], v[190:191], v[224:225], v[224:225] op_sel:[0,0,1] op_sel_hi:[1,0,1]
    v_pk_fma_f32 v[208:209], v[192:193], v[224:225], v[224:225] op_sel:[0,0,1] op_sel_hi:[1,0,1]
    v_pk_fma_f32 v[210:211], v[194:195], v[224:225], v[224:225] op_sel:[0,0,1] op_sel_hi:[1,0,1]
    v_pk_fma_f32 v[212:213], v[196:197], v[224:225], v[224:225] op_sel:[0,0,1] op_sel_hi:[1,0,1]
    v_cvt_pk_bf16_f32 v182, v206, v207
    v_cvt_pk_bf16_f32 v183, v208, v209
    v_cvt_pk_bf16_f32 v184, v210, v211
    v_cvt_pk_bf16_f32 v185, v212, v213
    ds_write_b128 v230, v[182:185] offset:0
    v_pk_fma_f32 v[214:215], v[198:199], v[224:225], v[224:225] op_sel:[0,0,1] op_sel_hi:[1,0,1]
    v_pk_fma_f32 v[216:217], v[200:201], v[224:225], v[224:225] op_sel:[0,0,1] op_sel_hi:[1,0,1]
    v_pk_fma_f32 v[218:219], v[202:203], v[224:225], v[224:225] op_sel:[0,0,1] op_sel_hi:[1,0,1]
    v_pk_fma_f32 v[220:221], v[204:205], v[224:225], v[224:225] op_sel:[0,0,1] op_sel_hi:[1,0,1]
    v_cvt_pk_bf16_f32 v186, v214, v215
    v_cvt_pk_bf16_f32 v187, v216, v217
    v_cvt_pk_bf16_f32 v188, v218, v219
    v_cvt_pk_bf16_f32 v189, v220, v221
    ds_write_b128 v230, v[186:189] offset:448
    s_waitcnt lgkmcnt(0)
    s_barrier
    ds_read_b64_tr_b16 v[110:111], v231 offset:0
    ds_read_b64_tr_b16 v[112:113], v231 offset:3840
    ds_read_b64_tr_b16 v[114:115], v231 offset:128
    ds_read_b64_tr_b16 v[116:117], v231 offset:3968
    ds_read_b32 v229, v237
    s_waitcnt lgkmcnt(3)
    buffer_store_dwordx4 v[110:113], v233, s[28:31], s70 offen sc1
    s_waitcnt lgkmcnt(1)
    buffer_store_dwordx4 v[114:117], v233, s[28:31], s71 offen sc1
    v_cmp_gt_u32 vcc, 16, v1
    s_waitcnt lgkmcnt(0)
    s_nop 0
    v_cndmask_b32 v229, 0, v229, vcc
    v_mov_b32 v228, v229
    buffer_store_dwordx2 v[228:229], v238, s[28:31], s72 offen sc1
    v_lshrrev_b32 v13, 2, v1
    v_mul_u32_u24 v13, 1056, v13
    v_lshl_add_u32 v13, v8, 3, v13
    s_mul_i32 s3, s48, 224
    v_add_u32 v243, s3, v13
    s_mov_b32 s18, 401408
    s_mov_b32 s19, 0x20000
    s_mov_b32 s26, 7340032
    s_mov_b32 s27, 0x20000
    s_mov_b32 s34, 1835008
    s_mov_b32 s35, 0x20000
    s_mov_b32 s36, 1
    v_lshrrev_b32 v14, 2, v1
    v_lshlrev_b32 v14, 7, v14
    v_lshl_add_u32 v14, v8, 3, v14
    v_and_b32 v15, 3, v5
    v_lshl_add_u32 v14, v15, 5, v14
    s_mul_i32 s3, s4, 8256
    v_xor_b32 v31, s3, v14
    v_xor_b32 v32, 32, v31
    v_xor_b32 v33, 64, v31
    v_xor_b32 v34, 96, v31
    v_add_u32 v35, 65536, v31
    v_add_u32 v36, 65536, v32
    v_add_u32 v37, 65536, v33
    v_add_u32 v38, 65536, v34
    v_add_u32 v39, 131072, v31
    v_add_u32 v40, 131072, v32
    v_add_u32 v41, 131072, v33
    v_add_u32 v42, 131072, v34
    s_lshl_b32 s6, s52, 1
    s_add_u32 s6, s6, s5
    s_lshl_b32 s3, s6, 1
    s_add_u32 s3, s3, s59
    s_lshl_b32 s3, s3, 4
    s_add_u32 s3, s3, s4
    s_lshl_b32 s3, s3, 12
    v_lshl_add_u32 v78, v3, 8, v4
    v_add_u32 v78, s3, v78
    s_xor_b32 s37, s51, 1
    s_lshl_b32 s37, s37, 3
    s_add_u32 s37, s37, s52
    s_lshl_b32 s3, s37, 14
    s_add_u32 s3, s3, s58
    s_add_u32 s3, s3, 16777216
    v_add_u32 v23, s3, v4
    s_lshl_b32 s37, s37, 5
    s_add_u32 s37, s37, s5
    s_lshl_b32 s37, s37, 2
    s_add_u32 s37, s37, 6422528
    s_mul_i32 s67, s6, 56
    s_lshl_b32 s3, s51, 1
    s_add_u32 s3, s3, s4
    s_add_u32 s67, s67, s3
    s_lshl_b32 s67, s67, 11
    s_add_u32 s67, s67, 2097152
    v_add_u32 v81, s58, v4
    s_lshl_b32 s68, s52, 2
    s_and_b32 s3, s51, 1
    s_add_u32 s68, s68, s3
    s_cmp_ge_u32 s51, 14
    s_cselect_b32 s3, 2, 0
    s_add_u32 s68, s68, s3
    s_lshl_b32 s68, s68, 7
    s_add_u32 s68, s68, 6356992
    s_waitcnt vmcnt(3)
    v_readfirstlane_b32 s57, v12
    s_mov_b32 s60, 0
    s_cmp_lg_u32 s57, 0
    s_cbranch_scc0 L_nonceh
L_nonce_okh:
    s_waitcnt vmcnt(0)
    s_barrier
    s_atomic_swap s57, s[28:29], s74
    s_atomic_swap s57, s[28:29], s73
    buffer_load_dwordx4 v[96:99], v85, s[8:11], 0 offen
    buffer_load_ushort v93, v82, s[40:43], 0 offen offset:0
    buffer_load_dwordx4 v[100:103], v86, s[8:11], 0 offen
    buffer_load_ushort v94, v82, s[40:43], 0 offen offset:16
    v_cmp_gt_u32 vcc, 12, v2
    s_mul_i32 s3, s48, 56
    s_add_u32 s3, s3, s79
    s_mul_i32 s3, s3, 3
    s_add_u32 s3, s3, s80
    s_lshl_b32 s3, s3, 11
    s_add_u32 s3, s3, 8388608
    s_add_u32 s3, s3, s81
    ds_read_b64_tr_b16 v[182:183], v243 offset:0
    ds_read_b64_tr_b16 v[184:185], v243 offset:16896
    ds_read_b64_tr_b16 v[186:187], v243 offset:32
    ds_read_b64_tr_b16 v[188:189], v243 offset:16928
    ds_read_b64_tr_b16 v[190:191], v243 offset:56
    ds_read_b64_tr_b16 v[192:193], v243 offset:16952
    ds_read_b64_tr_b16 v[194:195], v243 offset:88
    ds_read_b64_tr_b16 v[196:197], v243 offset:16984
    ds_read_b64_tr_b16 v[198:199], v243 offset:112
    ds_read_b64_tr_b16 v[200:201], v243 offset:17008
    ds_read_b64_tr_b16 v[202:203], v243 offset:144
    ds_read_b64_tr_b16 v[204:205], v243 offset:17040
    ds_read_b64_tr_b16 v[206:207], v243 offset:168
    ds_read_b64_tr_b16 v[208:209], v243 offset:17064
    ds_read_b64_tr_b16 v[210:211], v243 offset:200
    ds_read_b64_tr_b16 v[212:213], v243 offset:17096
    s_waitcnt lgkmcnt(13)
    v_cndmask_b32 v186, 0, v186, vcc
    v_cndmask_b32 v187, 0, v187, vcc
    s_waitcnt lgkmcnt(12)
    v_cndmask_b32 v188, 0, v188, vcc
    v_cndmask_b32 v189, 0, v189, vcc
    buffer_store_dwordx4 v[182:185], v4, s[28:31], s3 offen offset:0 sc1
    buffer_store_dwordx4 v[186:189], v4, s[28:31], s3 offen offset:1024 sc1
    s_add_u32 s3, s3, 86016
    s_waitcnt lgkmcnt(9)
    v_cndmask_b32 v194, 0, v194, vcc
    v_cndmask_b32 v195, 0, v195, vcc
    s_waitcnt lgkmcnt(8)
    v_cndmask_b32 v196, 0, v196, vcc
    v_cndmask_b32 v197, 0, v197, vcc
    buffer_store_dwordx4 v[190:193], v4, s[28:31], s3 offen offset:0 sc1
    buffer_store_dwordx4 v[194:197], v4, s[28:31], s3 offen offset:1024 sc1
    s_add_u32 s3, s3, 86016
    s_waitcnt lgkmcnt(5)
    v_cndmask_b32 v202, 0, v202, vcc
    v_cndmask_b32 v203, 0, v203, vcc
    s_waitcnt lgkmcnt(4)
    v_cndmask_b32 v204, 0, v204, vcc
    v_cndmask_b32 v205, 0, v205, vcc
    buffer_store_dwordx4 v[198:201], v4, s[28:31], s3 offen offset:0 sc1
    buffer_store_dwordx4 v[202:205], v4, s[28:31], s3 offen offset:1024 sc1
    s_add_u32 s3, s3, 86016
    ds_read_b32 v24, v4
    s_waitcnt lgkmcnt(2)
    v_cndmask_b32 v210, 0, v210, vcc
    v_cndmask_b32 v211, 0, v211, vcc
    ds_read_b32 v24, v4
    s_waitcnt lgkmcnt(2)
    v_cndmask_b32 v212, 0, v212, vcc
    v_cndmask_b32 v213, 0, v213, vcc
    buffer_store_dwordx4 v[206:209], v4, s[28:31], s3 offen offset:0 sc1
    buffer_store_dwordx4 v[210:213], v4, s[28:31], s3 offen offset:1024 sc1
    s_add_u32 s3, s3, 86016
    s_lshl_b32 s67, s80, 6
    s_add_u32 s67, s67, 64
    s_cmp_eq_u32 s81, 0
    s_cselect_b32 s37, s48, 1
    s_mov_b32 s68, 6369792
    s_and_b32 s3, s2, 1
    s_mul_i32 s3, s3, 3
    s_bfe_u32 s6, s2, 0x10001
    s_mul_i32 s7, s6, 6
    s_add_u32 s3, s3, s7
    s_add_u32 s3, s3, 1
    v_add_u32 v14, s3, v8
    s_mul_i32 s6, s6, 64
    s_add_u32 s6, s6, 7
    v_cmp_ne_u32 vcc, s6, v14
    v_lshrrev_b32 v15, 2, v1
    v_mul_u32_u24 v15, 3584, v15
    v_cndmask_b32 v14, 0, v14, vcc
    v_lshl_add_u32 v14, v14, 8, v15
    s_lshl_b32 s3, s52, 2
    s_add_u32 s3, s3, s48
    s_mul_i32 s3, s3, 37
    s_min_u32 s3, s3, 987
    s_mul_i32 s3, s3, 3584
    s_mul_i32 s6, s59, 3670144
    s_add_u32 s3, s3, s6
    buffer_load_dword v226, v14, s[20:23], s3 offen
    s_add_u32 s3, s3, 57344
    buffer_load_dword v227, v14, s[20:23], s3 offen
    s_add_u32 s3, s3, 57344
    v_cmp_gt_u32 vcc, 20, v1
    v_mov_b32 v15, 268435456
    s_nop 0
    v_cndmask_b32 v14, v15, v14, vcc
    buffer_load_dword v228, v14, s[20:23], s3 offen
    s_add_u32 s3, s3, 57344
    v_add_u32 v53, 65536, v4
    v_add_u32 v54, 131072, v4
    s_mul_i32 s59, s48, 3072
    s_mul_i32 s3, s50, 86016
    s_add_u32 s3, s3, s59
    s_add_u32 s3, s3, 8388608
    v_add_u32 v80, s3, v4
    v_lshlrev_b32 v14, 7, v9
    v_xor_b32 v14, v14, v4
    s_lshl_b32 s3, s49, 11
    v_add_u32 v67, s3, v14
    v_add_u32 v68, 129024, v67
    s_lshr_b32 s3, s49, 2
    s_lshl_b32 s3, s3, 3
    s_max_u32 s3, s3, 1
    s_sub_u32 s3, s3, 1
    s_lshl_b32 s3, s3, 10
    s_lshl_b32 s6, s5, 17
    s_add_u32 s3, s3, s6
    s_lshl_b32 s6, s4, 28
    s_add_u32 s3, s3, s6
    v_add_u32 v69, s3, v14
    s_lshl_b32 s100, s5, 1
    s_add_u32 s100, s100, s4
    s_lshl_b32 s100, s100, 10
    v_and_b32 v14, 1, v1
    v_mul_u32_u24 v14, 640, v14
    v_lshrrev_b32 v15, 2, v1
    v_lshlrev_b32 v15, 4, v15
    v_xor_b32 v14, v14, v15
    v_bfe_u32 v15, v1, 1, 1
    v_lshl_add_u32 v14, v15, 3, v14
    s_add_u32 s3, s58, 12288
    v_add_u32 v70, s3, v14
    s_sub_u32 s3, s3, 3072
    s_cmp_eq_u32 s48, 0
    s_cselect_b32 s3, 28672, s3
    v_add_u32 v71, s3, v14
    v_add_u32 v72, 65536, v70
    v_add_u32 v73, 65536, v71
    v_add_u32 v74, 131072, v70
    v_add_u32 v75, 131072, v71
    s_lshl_b32 s3, s49, 1
    v_min_u32 v14, 2, v3
    v_add_u32 v14, s3, v14
    v_max_u32 v14, 1, v14
    v_lshlrev_b32 v14, 1, v14
    v_and_b32 v15, 1, v7
    v_add_lshl_u32 v14, v14, v15, 7
    v_lshrrev_b32 v15, 1, v7
    v_lshl_add_u32 v15, v15, 2, v8
    v_lshl_add_u32 v14, v15, 3, v14
    v_add_u32 v77, 6291200, v14
    s_min_u32 s15, s48, 2
    s_lshl_b32 s15, s15, 6
    s_add_u32 s15, s15, 64
    s_lshl_b32 s82, s49, 5
    s_add_u32 s82, s82, s50
    s_lshl_b32 s82, s82, 10
    s_add_u32 s82, s82, 4194304
    s_lshr_b32 s69, s49, 2
    s_lshl_b32 s69, s69, 1
    s_and_b32 s3, s50, 1
    s_add_u32 s69, s69, s3
    s_lshl_b32 s69, s69, 7
    s_add_u32 s69, s69, 6361088
    s_and_b32 s7, s53, 1
    s_mul_i32 s3, s7, 28
    s_add_u32 s3, s3, s48
    s_lshl_b32 s3, s3, 17
    s_xor_b32 s6, s53, 1
    s_lshl_b32 s55, s6, 3
    s_lshl_b32 s6, s53, 7
    s_add_u32 s3, s3, s6
    v_lshlrev_b32 v14, 12, v5
    v_add3_u32 v59, v14, v83, s3
    v_add_u32 v60, 31744, v59
    v_add_u32 v61, 63488, v59
    v_add_u32 v62, 95232, v59
    v_mul_u32_u24 v14, 896, v5
    s_mul_i32 s3, s4, 25088
    s_mul_i32 s6, s5, 14336
    s_add_u32 s3, s3, s6
    s_lshl_b32 s6, s54, 7
    s_add_u32 s3, s3, s6
    v_add3_u32 v63, v14, v83, s3
    v_add_u32 v64, 6144, v63
    s_lshl_b32 s6, s53, 1
    s_add_u32 s6, s6, s5
    s_and_b32 s3, s53, 30
    s_add_u32 s3, s3, s4
    s_lshl_b32 s3, s3, 7
    s_add_u32 s39, s3, 6361088
    s_lshl_b32 s3, s6, 5
    s_add_u32 s3, s3, s4
    s_lshl_b32 s3, s3, 10
    s_add_u32 s3, s3, 4194304
    v_add_u32 v65, s3, v4
    v_add_u32 v66, 15360, v65
    s_xor_b32 s3, s4, s5
    s_lshl_b32 s3, s3, 6
    v_xor_b32 v43, s3, v31
    v_xor_b32 v44, 32, v43
    v_add_u32 v45, 65536, v43
    v_add_u32 v46, 65536, v44
    s_mul_i32 s3, s4, 12288
    v_add_u32 v47, s3, v4
    v_xor_b32 v48, 4096, v47
    v_add_u32 v49, 65536, v47
    v_add_u32 v50, 65536, v48
    v_add_u32 v51, 131072, v47
    v_add_u32 v52, 131072, v48
    s_lshl_b32 s6, s54, 1
    s_add_u32 s6, s6, s5
    s_lshl_b32 s3, s6, 1
    s_add_u32 s3, s3, s7
    s_mul_i32 s3, s3, 14
    s_add_u32 s3, s3, s4
    s_lshl_b32 s3, s3, 12
    s_add_u32 s3, s3, 2097152
    v_add_u32 v79, s3, v4
    s_lshl_b32 s3, s54, 1
    s_add_u32 s3, s3, s7
    s_lshl_b32 s3, s3, 1
    s_add_u32 s3, s3, s4
    s_lshl_b32 s3, s3, 7
    s_add_u32 s38, s3, 6356992
    s_and_b32 s3, s2, 6
    s_add_u32 s3, s3, s54
    s_sub_u32 s6, s3, 7
    s_cmp_ge_u32 s3, 7
    s_cselect_b32 s3, s6, s3
    s_lshl_b32 s64, s3, 19
    s_lshl_b32 s65, s3, 13
    s_add_u32 s55, s55, s54
    s_lshl_b32 s3, s55, 14
    s_add_u32 s3, s3, s58
    s_add_u32 s3, s3, 12582912
    v_add_u32 v21, s3, v4
    s_lshl_b32 s55, s55, 5
    s_add_u32 s55, s55, s48
    s_lshl_b32 s55, s55, 2
    s_add_u32 s55, s55, 6488064
    s_lshl_b32 s3, s5, 3
    v_add_u32 v13, s3, v3
    v_xor_b32 v13, v13, v6
    v_lshlrev_b32 v13, 4, v13
    v_lshl_add_u32 v13, v2, 8, v13
    s_lshl_b32 s3, s4, 14
    s_add_u32 s3, s3, 32768
    v_add_u32 v87, s3, v13
    v_xor_b32 v88, 64, v87
    s_lshr_b32 s3, s53, 1
    s_add_u32 s66, s3, s54
    s_mov_b32 s51, s66
    v_lshlrev_b32 v13, 1, v6
    v_xor_b32 v13, v13, v5
    v_lshlrev_b32 v13, 4, v13
    v_lshl_add_u32 v13, v5, 8, v13
    s_add_u32 s3, s58, 32768
    v_add_u32 v89, s3, v13
    v_xor_b32 v90, 16, v89
    v_xor_b32 v91, 24576, v89
    v_xor_b32 v92, 24592, v89
    s_mov_b32 s70, 0xaaaaaaaa
    s_mov_b32 s71, 0xaaaaaaaa
    s_mov_b32 s72, 0xfff0ffff
    s_mov_b32 s73, 0xf000ff00
    s_mov_b32 s74, 0xffc0fffc
    s_mov_b32 s75, 0xc000fc00
    s_cmp_eq_u32 s49, 0
    s_cselect_b64 s[76:77], 0, -1
    v_mov_b32 v13, 0xffff
    v_mov_b32 v14, 0xffff0000
    v_cndmask_b32 v13, v13, v14, s[70:71]
    v_cndmask_b32 v104, v13, 0, s[72:73]
    v_cndmask_b32 v106, 0, v13, s[72:73]
    v_cndmask_b32 v105, v13, 0, s[74:75]
    v_cndmask_b32 v107, 0, v13, s[74:75]
    v_mov_b32 v84, 0xf149f2ca
    s_mov_b32 s83, 0x3e8b97f6
    s_mov_b32 s78, 0xbdd2d3e8
    s_mov_b32 s79, 0xbdd2d3e8
    s_mov_b32 s80, 1.0
    s_mov_b32 s81, 1.0
    v_mov_b32 v108, 0xc0135761
    v_mov_b32 v109, 0xc0135761
    v_lshrrev_b32 v13, 1, v2
    v_lshlrev_b32 v14, 1, v3
    v_sub_u32 v13, v13, v14
    v_mov_b32 v14, 0x3f80
    v_cndmask_b32 v14, v14, 1.0, s[70:71]
    v_cmp_eq_i32 vcc, 0, v13
    v_accvgpr_write_b32 a248, 0
    v_accvgpr_write_b32 a252, 0
    v_cndmask_b32 v15, 0, v14, vcc
    v_accvgpr_write_b32 a250, v15
    v_cmp_eq_i32 vcc, 1, v13
    v_accvgpr_write_b32 a249, 0
    v_accvgpr_write_b32 a253, 0
    v_cndmask_b32 v15, 0, v14, vcc
    v_accvgpr_write_b32 a251, v15
    s_waitcnt vmcnt(3)
    s_barrier
    s_cmp_lg_u32 s37, 0
    s_cbranch_scc1 L_nowsig
    s_atomic_add s36, s[44:45], s67
L_nowsig:
    buffer_load_dword v18, v20, s[28:31], 0 offen sc1
    s_mov_b32 s26, 7340032
    s_and_b32 s3, s2, 1
    s_mul_i32 s3, s3, 7
    s_add_u32 s3, s3, s52
    s_lshl_b32 s3, s3, 2
    s_add_u32 s3, s3, s48
    s_lshl_b32 s3, s3, 17
    s_and_b32 s6, s2, 6
    s_lshl_b32 s6, s6, 9
    s_add_u32 s3, s3, s6
    v_lshlrev_b32 v242, 12, v10
    v_mul_u32_u24 v243, 512, v9
    v_add_u32 v243, v242, v243
    buffer_load_dword v232, v243, s[24:27], s3 offen offset:384
    v_mul_u32_u24 v243, 512, v9
    v_add_u32 v243, v242, v243
    buffer_load_dword v233, v243, s[24:27], s3 offen offset:256
    s_cmp_eq_u32 s56, 0
    s_cselect_b32 s26, 0, s26
    s_cmp_eq_u32 s56, 0
    s_cselect_b32 s26, 0, s26
    v_and_b32 v13, 0xfffff000, v78
    v_lshl_add_u32 v13, v10, 7, v13
    s_add_u32 s3, s1, 8192
    v_lshl_add_u32 v14, v9, 13, s3
    s_waitcnt vmcnt(2)
    v_cmp_ne_u32 vcc, s57, v18
    s_cbranch_vccnz L_pollin3
L_pollok3:
    s_mov_b32 s14, 0
    s_load_dword s14, s[44:45], s15
    s_barrier
    buffer_load_dword v76, v77, s[28:31], 0 offen sc1
    s_cmp_ge_u32 s14, 14
    s_cbranch_scc0 L_pollin4
L_pollok4:
    s_barrier
    s_cmp_eq_u32 s56, 0
    s_cselect_b32 s3, 268435456, 0
    v_add_u32 v79, s3, v79
    s_mov_b32 s26, 7340032
    s_and_b32 s3, s54, 1
    s_lshl_b32 s3, s3, 2
    s_lshr_b32 s6, s54, 1
    s_add_u32 s3, s3, s6
    s_lshl_b32 s3, s3, 7
    s_cmp_eq_u32 s56, 0
    s_cselect_b32 s3, s3, 0
    v_xor_b32 v59, s3, v59
    v_xor_b32 v60, s3, v60
    v_xor_b32 v61, s3, v61
    v_xor_b32 v62, s3, v62
    s_add_u32 m0, s59, 98304
    s_nop 0
    buffer_load_dwordx4 v80, s[28:31], s63 offen sc1 lds
    buffer_load_dwordx4 v80, s[28:31], s63 offen offset:1024 sc1 lds
    buffer_load_dwordx4 v80, s[28:31], s63 offen offset:2048 sc1 lds
    s_add_u32 m0, s100, 126976
    s_nop 0
    buffer_load_dwordx4 v69, s[28:31], s62 offen sc1 lds
    s_add_u32 m0, s58, 110592
    s_nop 0
    buffer_load_dwordx4 v67, s[28:31], s62 offen sc1 lds
    buffer_load_dwordx4 v67, s[28:31], s62 offen offset:1024 sc1 lds
    buffer_load_dwordx4 v68, s[28:31], s62 offen offset:2048 sc1 lds
    buffer_load_dwordx4 v68, s[28:31], s62 offen offset:3072 sc1 lds
    s_add_u32 m0, s59, 131072
    s_add_u32 s63, s63, 12288
    s_cmp_eq_u32 s63, 86016
    s_cselect_b32 s63, 0, s63
    buffer_load_dwordx4 v80, s[28:31], s63 offen sc1 lds
    buffer_load_dwordx4 v80, s[28:31], s63 offen offset:1024 sc1 lds
    buffer_load_dwordx4 v80, s[28:31], s63 offen offset:2048 sc1 lds
    s_add_u32 m0, s100, 159744
    s_add_u32 s62, s62, 262144
    s_cmp_eq_u32 s62, 1835008
    s_cselect_b32 s62, 0, s62
    buffer_load_dwordx4 v69, s[28:31], s62 offen sc1 lds
    s_add_u32 m0, s58, 143360
    s_nop 0
    buffer_load_dwordx4 v67, s[28:31], s62 offen sc1 lds
    buffer_load_dwordx4 v67, s[28:31], s62 offen offset:1024 sc1 lds
    buffer_load_dwordx4 v68, s[28:31], s62 offen offset:2048 sc1 lds
    buffer_load_dwordx4 v68, s[28:31], s62 offen offset:3072 sc1 lds
    s_add_u32 m0, s59, 0
    s_add_u32 s63, s63, 12288
    s_cmp_eq_u32 s63, 86016
    s_cselect_b32 s63, 0, s63
    buffer_load_dwordx4 v80, s[28:31], s63 offen sc1 lds
    buffer_load_dwordx4 v80, s[28:31], s63 offen offset:1024 sc1 lds
    buffer_load_dwordx4 v80, s[28:31], s63 offen offset:2048 sc1 lds
    s_add_u32 m0, s100, 28672
    s_add_u32 s62, s62, 262144
    s_cmp_eq_u32 s62, 1835008
    s_cselect_b32 s62, 0, s62
    buffer_load_dwordx4 v69, s[28:31], s62 offen sc1 lds
    s_add_u32 m0, s58, 12288
    s_nop 0
    buffer_load_dwordx4 v67, s[28:31], s62 offen sc1 lds
    buffer_load_dwordx4 v67, s[28:31], s62 offen offset:1024 sc1 lds
    buffer_load_dwordx4 v68, s[28:31], s62 offen offset:2048 sc1 lds
    buffer_load_dwordx4 v68, s[28:31], s62 offen offset:3072 sc1 lds
    s_add_u32 m0, s59, 65536
    s_add_u32 s63, s63, 12288
    s_cmp_eq_u32 s63, 86016
    s_cselect_b32 s63, 0, s63
    buffer_load_dwordx4 v80, s[28:31], s63 offen sc1 lds
    buffer_load_dwordx4 v80, s[28:31], s63 offen offset:1024 sc1 lds
    buffer_load_dwordx4 v80, s[28:31], s63 offen offset:2048 sc1 lds
    s_add_u32 m0, s100, 94208
    s_add_u32 s62, s62, 262144
    s_cmp_eq_u32 s62, 1835008
    s_cselect_b32 s62, 0, s62
    buffer_load_dwordx4 v69, s[28:31], s62 offen sc1 lds
    s_add_u32 m0, s58, 77824
    s_nop 0
    buffer_load_dwordx4 v67, s[28:31], s62 offen sc1 lds
    buffer_load_dwordx4 v67, s[28:31], s62 offen offset:1024 sc1 lds
    buffer_load_dwordx4 v68, s[28:31], s62 offen offset:2048 sc1 lds
    buffer_load_dwordx4 v68, s[28:31], s62 offen offset:3072 sc1 lds
    s_mov_b32 s3, 268435456
    buffer_store_dword v12, v11, s[28:31], s3 offen
    buffer_store_dword v12, v11, s[28:31], s3 offen
    v_lshlrev_b32 v13, 2, v2
    v_and_b32 v14, 1, v1
    v_lshl_add_u32 v14, v3, 2, v14
    v_lshlrev_b32 v14, 2, v14
    v_add_u32 v15, 64, v14
    v_cndmask_b32 v16, v14, v15, s[72:73]
    v_cndmask_b32 v14, v14, v15, s[74:75]
    s_waitcnt vmcnt(34)
    ds_bpermute_b32 v25, v13, v76 offset:64
    ds_bpermute_b32 v27, v16, v76 offset:0
    ds_bpermute_b32 v28, v14, v76 offset:8
    ds_bpermute_b32 v26, v13, v76 offset:128
    ds_bpermute_b32 v29, v16, v76 offset:64
    ds_bpermute_b32 v30, v14, v76 offset:72
    s_waitcnt lgkmcnt(5)
    v_mul_f32 v25, s83, v25
    ds_read_b32 v24, v4
    s_waitcnt lgkmcnt(3)
    v_mul_f32 v26, s83, v26
    ds_read_b32 v24, v4
    ds_read_b32 v24, v4
    ds_read_b32 v24, v4
    s_waitcnt vmcnt(18) lgkmcnt(3)
    s_barrier
    ds_read_b64_tr_b16 a[180:181], v72 offset:32768
    ds_read_b64_tr_b16 a[182:183], v72 offset:33024
    ds_read_b128 a[128:131], v53 offset:32768
    ds_read_b64_tr_b16 a[184:185], v72 offset:33792
    ds_read_b64_tr_b16 a[186:187], v72 offset:34048
    ds_read_b128 a[132:135], v53 offset:33792
    ds_read_b128 a[136:139], v53 offset:34816
    ds_read_b64_tr_b16 a[176:177], v73 offset:32768
    ds_read_b64_tr_b16 a[178:179], v73 offset:33024
    ds_read_b128 a[140:143], v53 offset:35840
    ds_read_b128 a[144:147], v53 offset:36864
    ds_read_b128 a[148:151], v53 offset:37888
    s_waitcnt lgkmcnt(0)
    s_nop 3
    s_branch L_q
L_pollin5:
    s_waitcnt lgkmcnt(0)
    s_cmp_ge_u32 s14, 7
    s_cbranch_scc1 L_pollok5
    s_cmp_eq_u32 s56, 0
    s_cbranch_scc1 L_pollok5
    s_mov_b32 s60, 0
    s_branch L_poll5a
L_poll5:
    s_sleep 8
L_poll5a:
    buffer_load_dword v18, off, s[28:31], s38 sc1
    s_add_u32 s60, s60, 1
    s_waitcnt vmcnt(0)
    v_readfirstlane_b32 s14, v18
    s_nop 0
    s_cmp_ge_u32 s14, 7
    s_cbranch_scc1 L_pollok5
    s_cmp_lt_u32 s60, 20000
    s_cbranch_scc1 L_poll5
    s_branch L_pollok5
L_nof:
    v_min_u32 v14, 48, v1
    s_lshl_b32 s3, s54, 2
    s_add_u32 s3, s3, s48
    s_mul_i32 s3, s3, 25088
    v_lshl_add_u32 v14, v14, 7, s3
    s_add_u32 s3, s2, 0
    s_and_b32 s3, s3, 3
    s_mul_i32 s3, s3, 6272
    buffer_load_dword v182, v14, s[16:19], s3 offen
    s_waitcnt vmcnt(1)
    s_barrier
    s_cmp_lg_u32 s48, 0
    s_cbranch_scc1 L_sig3
    s_atomic_add s36, s[28:29], s69
L_sig3:
    s_add_u32 s3, s2, 1
    s_and_b32 s3, s3, 3
    s_mul_i32 s3, s3, 6272
    buffer_load_dword v183, v14, s[16:19], s3 offen
    s_add_u32 s3, s2, 2
    s_and_b32 s3, s3, 3
    s_mul_i32 s3, s3, 6272
    buffer_load_dword v184, v14, s[16:19], s3 offen
    s_add_u32 s3, s2, 3
    s_and_b32 s3, s3, 3
    s_mul_i32 s3, s3, 6272
    buffer_load_dword v185, v14, s[16:19], s3 offen
    s_branch L_fin
L_pollin6:
    s_waitcnt lgkmcnt(0)
    s_cmp_ge_u32 s14, 8
    s_cbranch_scc1 L_pollok6
    s_mov_b32 s60, 0
    s_branch L_poll6a
L_poll6:
    s_sleep 8
L_poll6a:
    buffer_load_dword v18, off, s[28:31], s39 sc1
    s_add_u32 s60, s60, 1
    s_waitcnt vmcnt(0)
    v_readfirstlane_b32 s14, v18
    s_nop 0
    s_cmp_ge_u32 s14, 8
    s_cbranch_scc1 L_pollok6
    s_cmp_lt_u32 s60, 20000
    s_cbranch_scc1 L_poll6
    s_branch L_pollok6
L_pollin7:
    s_waitcnt lgkmcnt(0)
    s_cmp_ge_u32 s14, 1
    s_cbranch_scc1 L_pollok7
    s_mov_b32 s60, 0
    s_branch L_poll7a
L_poll7:
    s_sleep 4
L_poll7a:
    buffer_load_dword v18, off, s[28:31], s55 sc1
    s_add_u32 s60, s60, 1
    s_waitcnt vmcnt(0)
    v_readfirstlane_b32 s14, v18
    s_nop 0
    s_cmp_ge_u32 s14, 1
    s_cbranch_scc1 L_pollok7
    s_cmp_lt_u32 s60, 20000
    s_cbranch_scc1 L_poll7
    s_branch L_pollok7
L_last:
    s_endpgm
.section .rodata,"a"
.p2align 6
.amdhsa_kernel parallel_sum__sliding_local_dilated__mixer_token_mlp__prompt_kernel
  .amdhsa_next_free_vgpr 512
  .amdhsa_next_free_sgpr 102
  .amdhsa_accum_offset 256
  .amdhsa_group_segment_fixed_size 0
  .amdhsa_kernarg_size 88
  .amdhsa_user_sgpr_count 2
  .amdhsa_user_sgpr_kernarg_segment_ptr 1
  .amdhsa_system_sgpr_workgroup_id_x 1
.end_amdhsa_kernel
```

```asm
; @launch grid=(256,1,1) block=(256,1,1) lds=163840
.amdgcn_target "amdgcn-amd-amdhsa--gfx950"
.text
.globl parallel_sum__sliding_local_dilated__mixer_token_mlp__prompt_kernel
.p2align 8
.type parallel_sum__sliding_local_dilated__mixer_token_mlp__prompt_kernel,@function
parallel_sum__sliding_local_dilated__mixer_token_mlp__prompt_kernel:
    s_cmp_ge_u32 s2, 256
    s_cbranch_scc1 L_end
    s_load_dwordx2 s[8:9], s[0:1], 0
    s_load_dwordx2 s[20:21], s[0:1], 32
    s_load_dwordx2 s[28:29], s[0:1], 80
    s_load_dwordx2 s[44:45], s[0:1], 72
    s_load_dwordx2 s[12:13], s[0:1], 8
    s_load_dwordx2 s[16:17], s[0:1], 16
    s_load_dwordx2 s[24:25], s[0:1], 48
    s_load_dwordx2 s[32:33], s[0:1], 64
    s_load_dwordx2 s[36:37], s[0:1], 40
    s_load_dwordx2 s[40:41], s[0:1], 56
    s_memrealtime s[78:79]
    s_getpc_b64 s[6:7]
L_pc:
    s_and_b32 s3, s2, 0xf8
    v_lshrrev_b32 v13, 5, v0
    v_add_lshl_u32 v13, s3, v13, 7
    v_min_u32 v13, L_last-L_pc, v13
    global_load_dword v18, v13, s[6:7]
    v_lshrrev_b32 v13, 6, v0
    v_and_b32 v10, 31, v0
    v_readfirstlane_b32 s48, v13
    v_bfe_u32 v9, v0, 5, 1
    v_mul_u32_u24 v14, 896, v9
    v_lshl_add_u32 v14, v10, 4, v14
    v_cmp_gt_u32 vcc, 28, v10
    v_mov_b32 v15, 268435456
    s_mov_b32 s10, 1835008
    s_mov_b32 s11, 0x20000
    v_cndmask_b32 v14, v15, v14, vcc
    s_lshr_b32 s4, s48, 1
    s_and_b32 s5, s48, 1
    s_and_b32 s3, s2, 0xfe
    s_add_u32 s3, s3, s4
    s_lshl_b32 s3, s3, 1
    s_and_b32 s60, s2, 1
    s_add_u32 s3, s3, s60
    s_lshl_b32 s3, s3, 1
    s_add_u32 s3, s3, s5
    s_mul_i32 s3, s3, 1792
    s_waitcnt lgkmcnt(0)
    buffer_load_dwordx4 v[182:185], v14, s[8:11], s3 offen
    buffer_load_dwordx4 v[186:189], v14, s[8:11], s3 offen offset:448
    v_and_b32 v1, 63, v0
    s_mov_b32 s46, 256
    s_mov_b32 s47, 0x20000
    s_lshl_b32 s3, s48, 8
    s_add_u32 s3, s3, s2
    s_cmp_lt_u32 s3, 8
    s_cselect_b32 s3, 0, 268435456
    s_or_b32 s78, s78, 1
    v_mov_b32 v234, s78
    v_mov_b32 v235, 0
    v_lshlrev_b32 v11, 25, v1
    buffer_atomic_cmpswap v[234:235], v11, s[44:47], s3 offen sc1
    s_bfe_u32 s6, s2, 0x20001
    s_and_b32 s7, s2, 1
    s_and_b32 s61, s2, 7
    s_lshr_b32 s101, s2, 3
    s_mul_i32 s52, s7, 25
    s_add_u32 s52, s52, s101
    s_mul_i32 s51, s52, 37
    s_lshr_b32 s51, s51, 8
    s_mul_i32 s3, s51, 7
    s_sub_u32 s52, s52, s3
    s_and_b32 s3, s6, 1
    s_mul_i32 s3, s3, 6
    s_add_u32 s51, s51, s3
    s_add_u32 s51, s51, 1
    s_add_u32 s3, s3, s51
    s_cmp_eq_u32 s3, 7
    s_cselect_b32 s51, 0, s51
    s_lshr_b32 s59, s6, 1
    s_lshl_b32 s51, s51, 1
    s_add_u32 s51, s51, s59
    s_max_u32 s60, s101, 25
    s_sub_u32 s60, s60, 25
    s_add_u32 s3, s101, s7
    s_cmp_lt_u32 s3, 25
    s_cselect_b32 s55, 1, 0
    s_cselect_b32 s52, s52, s60
    s_mov_b32 s22, 7340032
    s_mov_b32 s23, 0x20000
    s_lshl_b32 s3, s52, 1
    s_sub_u32 s60, s3, 7
    s_cmp_ge_u32 s3, 7
    s_cselect_b32 s3, s60, s3
    s_and_b32 s3, s3, 7
    s_mul_i32 s60, s61, 2
    s_add_u32 s3, s3, s60
    s_and_b32 s3, s3, 7
    s_mul_i32 s0, s3, 458752
    s_lshl_b32 s1, s3, 13
    s_lshl_b32 s58, s48, 12
    v_lshrrev_b32 v3, 4, v1
    v_lshrrev_b32 v5, 3, v1
    v_and_b32 v6, 7, v1
    v_lshlrev_b32 v14, 1, v3
    v_xor_b32 v14, v14, v6
    v_lshlrev_b32 v83, 4, v14
    s_cmp_eq_u32 s55, 0
    s_cbranch_scc1 L_nog1
    v_mul_u32_u24 v14, 3584, v5
    s_lshl_b32 s3, s59, 5
    s_add_u32 s3, s3, s48
    s_mul_i32 s3, s3, 114688
    s_lshl_b32 s60, s51, 7
    s_add_u32 s3, s3, s60
    v_add3_u32 v55, v14, v83, s3
    v_add_u32 v56, 56320, v55
    v_add_u32 v57, 26624, v55
    v_add_u32 v58, 82944, v55
    s_mov_b32 s38, 3584
    s_mov_b32 s39, 0x20000
    v_lshlrev_b32 v13, 3, v3
    s_lshl_b32 s3, s51, 1
    s_add_u32 s3, s3, s4
    s_lshl_b32 s3, s3, 6
    buffer_load_dwordx2 v[246:247], v13, s[36:39], s3 offen offset:0
    buffer_load_dwordx2 v[248:249], v13, s[36:39], s3 offen offset:32
    s_add_u32 m0, s58, 0
    v_xor_b32 v55, 128, v55
    buffer_load_dwordx4 v55, s[20:23], s0 offen lds
    v_xor_b32 v56, 128, v56
    buffer_load_dwordx4 v56, s[20:23], s0 offen offset:1024 lds
    v_xor_b32 v57, 128, v57
    buffer_load_dwordx4 v57, s[20:23], s0 offen offset:2048 lds
    v_xor_b32 v58, 128, v58
    buffer_load_dwordx4 v58, s[20:23], s0 offen offset:3072 lds
    s_mul_i32 s53, s101, 37
    s_lshr_b32 s53, s53, 8
    s_mul_i32 s54, s53, 7
    s_sub_u32 s54, s101, s54
    s_and_b32 s53, s53, 3
    s_xor_b32 s53, s53, 0
    s_lshl_b32 s3, s6, 2
    s_add_u32 s53, s53, s3
    s_lshl_b32 s53, s53, 1
    s_add_u32 s53, s53, s7
    s_mov_b32 s42, 4096
    s_mov_b32 s43, 0x20000
    s_lshl_b32 s3, s53, 2
    s_add_u32 s3, s3, s48
    s_lshl_b32 s60, s3, 5
    v_lshl_add_u32 v82, v5, 1, s60
    s_mul_i32 s3, s3, 14336
    s_lshl_b32 s60, s54, 7
    s_add_u32 s3, s3, s60
    v_mul_u32_u24 v14, 896, v5
    v_lshl_add_u32 v14, v6, 4, v14
    v_add_u32 v85, s3, v14
    v_add_u32 v86, 7168, v85
    s_cmp_lt_u32 s101, 28
    s_cselect_b32 s56, 1, 0
    s_lshl_b32 s50, s7, 3
    s_and_b32 s3, s101, 7
    s_add_u32 s50, s50, s3
    s_lshr_b32 s60, s101, 3
    s_lshl_b32 s49, s6, 2
    s_add_u32 s49, s49, s60
    s_lshl_b32 s49, s49, 2
    s_add_u32 s49, s49, s48
    s_mul_i32 s60, s60, 0
    s_add_u32 s3, s3, s60
    s_sub_u32 s60, s3, 7
    s_cmp_ge_u32 s3, 7
    s_cselect_b32 s3, s60, s3
    s_lshl_b32 s62, s3, 18
    s_mul_i32 s63, s3, 12288
    s_mov_b32 s30, 20971520
    s_mov_b32 s31, 0x20000
    s_mov_b32 s75, 0x3727c5ac
    s_mov_b32 s76, 0x3b124925
    s_mov_b32 s77, 0x3f803f80
    v_lshlrev_b32 v4, 4, v1
    v_bfe_u32 v7, v1, 2, 2
    v_and_b32 v8, 3, v1
    v_mul_u32_u24 v13, 960, v9
    v_lshl_add_u32 v13, v10, 4, v13
    s_mul_i32 s3, s48, 1920
    s_add_u32 s3, s3, 147456
    v_add_u32 v230, s3, v13
    v_mul_u32_u24 v13, 960, v7
    v_lshl_add_u32 v13, v3, 5, v13
    v_lshl_add_u32 v13, v8, 3, v13
    s_lshl_b32 s3, s48, 8
    s_add_u32 s3, s3, 147456
    v_add_u32 v231, s3, v13
    s_lshl_b32 s3, s48, 3
    s_add_u32 s3, s3, 155648
    v_lshl_add_u32 v232, v9, 2, s3
    v_lshlrev_b32 v237, 2, v6
    v_and_b32 v2, 15, v1
    v_lshlrev_b32 v238, 13, v3
    v_add_lshl_u32 v238, v238, v2, 3
    v_add_u32 v237, 155648, v237
    v_lshlrev_b32 v13, 17, v9
    v_lshl_add_u32 v233, v10, 4, v13
    s_cmp_eq_u32 s48, 3
    s_cselect_b32 s60, 268435456, 0
    s_lshl_b32 s70, s48, 10
    s_add_u32 s70, s70, s2
    s_lshl_b32 s70, s70, 9
    s_add_u32 s71, s70, 262144
    s_add_u32 s71, s71, s60
    s_xor_b32 s60, s60, 268435456
    s_lshl_b32 s72, s2, 7
    s_add_u32 s72, s72, s60
    s_add_u32 s72, s72, 6291456
    s_lshr_b32 s74, s2, 2
    s_lshl_b32 s74, s74, 4
    s_and_b32 s3, s2, 3
    s_add_u32 s74, s74, s3
    s_lshl_b32 s74, s74, 2
    s_add_u32 s74, s74, 10485760
    v_cmp_gt_u32 vcc, 8, v0
    v_lshlrev_b32 v236, 13, v0
    v_mov_b32 v13, 268435456
    s_and_b32 s3, s2, 7
    s_lshl_b32 s3, s3, 13
    s_add_u32 s3, s3, 10485760
    v_lshrrev_b32 v14, 2, v0
    v_lshl_add_u32 v14, v14, 6, s3
    v_and_b32 v15, 3, v0
    v_lshl_add_u32 v20, v15, 2, v14
    v_cndmask_b32 v236, v13, v236, vcc
    v_mov_b32 v16, 0
    s_lshl_b32 s3, s48, 14
    s_add_u32 s74, s74, s3
    s_add_u32 s73, s74, 8192
    s_waitcnt vmcnt(8)
    v_dot2_f32_bf16 v226, v182, s77, 0
    v_dot2_f32_bf16 v227, v182, v182, 0
    v_dot2_f32_bf16 v226, v183, s77, v226
    v_dot2_f32_bf16 v227, v183, v183, v227
    v_dot2_f32_bf16 v226, v184, s77, v226
    v_dot2_f32_bf16 v227, v184, v184, v227
    v_dot2_f32_bf16 v226, v185, s77, v226
    v_dot2_f32_bf16 v227, v185, v185, v227
    s_waitcnt vmcnt(7)
    v_dot2_f32_bf16 v226, v186, s77, v226
    v_dot2_f32_bf16 v227, v186, v186, v227
    v_dot2_f32_bf16 v226, v187, s77, v226
    v_dot2_f32_bf16 v227, v187, v187, v227
    v_dot2_f32_bf16 v226, v188, s77, v226
    v_dot2_f32_bf16 v227, v188, v188, v227
    v_dot2_f32_bf16 v226, v189, s77, v226
    v_dot2_f32_bf16 v227, v189, v189, v227
    buffer_load_dword v12, v16, s[44:47], 0 offen sc1
    v_lshlrev_b32 v190, 16, v182
    v_and_b32 v191, 0xffff0000, v182
    v_add_f32_dpp v226, v226, v226 quad_perm:[1,0,3,2] row_mask:0xf bank_mask:0xf
    v_add_f32_dpp v227, v227, v227 quad_perm:[1,0,3,2] row_mask:0xf bank_mask:0xf
    v_lshlrev_b32 v192, 16, v183
    v_add_f32_dpp v226, v226, v226 quad_perm:[2,3,0,1] row_mask:0xf bank_mask:0xf
    v_add_f32_dpp v227, v227, v227 quad_perm:[2,3,0,1] row_mask:0xf bank_mask:0xf
    v_and_b32 v193, 0xffff0000, v183
    v_add_f32_dpp v226, v226, v226 row_half_mirror row_mask:0xf bank_mask:0xf
    v_add_f32_dpp v227, v227, v227 row_half_mirror row_mask:0xf bank_mask:0xf
    v_lshlrev_b32 v194, 16, v184
    v_add_f32_dpp v226, v226, v226 row_mirror row_mask:0xf bank_mask:0xf
    v_add_f32_dpp v227, v227, v227 row_mirror row_mask:0xf bank_mask:0xf
    v_and_b32 v195, 0xffff0000, v184
    v_mov_b32 v228, v226
    v_mov_b32 v229, v227
    v_lshlrev_b32 v196, 16, v185
    v_permlane16_swap_b32 v226, v228
    v_permlane16_swap_b32 v227, v229
    v_add_f32 v226, v226, v228
    v_add_f32 v227, v227, v229
    v_mul_f32_e64 v226, -v226, s76
    v_mul_f32 v228, v226, v226
    v_fma_f32 v227, v227, s76, -v228
    v_max_f32 v227, 0, v227
    v_add_f32 v228, s75, v227
    v_rsq_f32 v222, v228
    v_and_b32 v197, 0xffff0000, v185
    v_mul_f32 v228, v222, v222
    v_fma_f32 v229, v228, v227, s75
    v_rsq_f32 v228, v229
    v_mul_f32 v223, v226, v222
    v_mul_f32 v224, v222, v228
    v_mul_f32 v225, v223, v228
    v_mul_f32 v229, v229, v228
    ds_write_b32 v232, v229
    v_lshlrev_b32 v198, 16, v186
    v_and_b32 v199, 0xffff0000, v186
    v_lshlrev_b32 v200, 16, v187
    v_and_b32 v201, 0xffff0000, v187
    v_lshlrev_b32 v202, 16, v188
    v_and_b32 v203, 0xffff0000, v188
    v_lshlrev_b32 v204, 16, v189
    v_and_b32 v205, 0xffff0000, v189
    v_pk_fma_f32 v[206:207], v[190:191], v[224:225], v[224:225] op_sel:[0,0,1] op_sel_hi:[1,0,1]
    v_pk_fma_f32 v[208:209], v[192:193], v[224:225], v[224:225] op_sel:[0,0,1] op_sel_hi:[1,0,1]
    v_pk_fma_f32 v[210:211], v[194:195], v[224:225], v[224:225] op_sel:[0,0,1] op_sel_hi:[1,0,1]
    v_pk_fma_f32 v[212:213], v[196:197], v[224:225], v[224:225] op_sel:[0,0,1] op_sel_hi:[1,0,1]
    v_cvt_pk_bf16_f32 v182, v206, v207
    v_cvt_pk_bf16_f32 v183, v208, v209
    v_cvt_pk_bf16_f32 v184, v210, v211
    v_cvt_pk_bf16_f32 v185, v212, v213
    ds_write_b128 v230, v[182:185] offset:0
    v_pk_fma_f32 v[214:215], v[198:199], v[224:225], v[224:225] op_sel:[0,0,1] op_sel_hi:[1,0,1]
    v_pk_fma_f32 v[216:217], v[200:201], v[224:225], v[224:225] op_sel:[0,0,1] op_sel_hi:[1,0,1]
    v_pk_fma_f32 v[218:219], v[202:203], v[224:225], v[224:225] op_sel:[0,0,1] op_sel_hi:[1,0,1]
    v_pk_fma_f32 v[220:221], v[204:205], v[224:225], v[224:225] op_sel:[0,0,1] op_sel_hi:[1,0,1]
    v_cvt_pk_bf16_f32 v186, v214, v215
    v_cvt_pk_bf16_f32 v187, v216, v217
    v_cvt_pk_bf16_f32 v188, v218, v219
    v_cvt_pk_bf16_f32 v189, v220, v221
    ds_write_b128 v230, v[186:189] offset:448
    s_waitcnt lgkmcnt(0)
    s_barrier
    ds_read_b64_tr_b16 v[110:111], v231 offset:0
    ds_read_b64_tr_b16 v[112:113], v231 offset:3840
    ds_read_b64_tr_b16 v[114:115], v231 offset:128
    ds_read_b64_tr_b16 v[116:117], v231 offset:3968
    ds_read_b32 v229, v237
    s_waitcnt lgkmcnt(3)
    buffer_store_dwordx4 v[110:113], v233, s[28:31], s70 offen sc1
    s_waitcnt lgkmcnt(1)
    buffer_store_dwordx4 v[114:117], v233, s[28:31], s71 offen sc1
    v_cmp_gt_u32 vcc, 16, v1
    s_waitcnt lgkmcnt(0)
    s_nop 0
    v_cndmask_b32 v229, 0, v229, vcc
    v_mov_b32 v228, v229
    buffer_store_dwordx2 v[228:229], v238, s[28:31], s72 offen sc1
    s_add_u32 m0, s58, 16384
    s_add_u32 s0, s0, 458752
    s_cmp_eq_u32 s0, 3670016
    s_cselect_b32 s0, 0, s0
    buffer_load_dwordx4 v55, s[20:23], s0 offen lds
    buffer_load_dwordx4 v56, s[20:23], s0 offen offset:1024 lds
    buffer_load_dwordx4 v57, s[20:23], s0 offen offset:2048 lds
    buffer_load_dwordx4 v58, s[20:23], s0 offen offset:3072 lds
    s_branch L_anchor
.p2align 12
L_anchor:
    s_mov_b32 s18, 401408
    s_mov_b32 s19, 0x20000
    s_mov_b32 s26, 7340032
    s_mov_b32 s27, 0x20000
    s_mov_b32 s34, 1835008
    s_mov_b32 s35, 0x20000
    s_mov_b32 s36, 1
    v_lshrrev_b32 v14, 2, v1
    v_lshlrev_b32 v14, 7, v14
    v_lshl_add_u32 v14, v8, 3, v14
    v_and_b32 v15, 3, v5
    v_lshl_add_u32 v14, v15, 5, v14
    s_mul_i32 s3, s4, 8256
    v_xor_b32 v31, s3, v14
    v_xor_b32 v32, 32, v31
    v_xor_b32 v33, 64, v31
    v_xor_b32 v34, 96, v31
    v_add_u32 v35, 65536, v31
    v_add_u32 v36, 65536, v32
    v_add_u32 v37, 65536, v33
    v_add_u32 v38, 65536, v34
    v_add_u32 v39, 131072, v31
    v_add_u32 v40, 131072, v32
    v_add_u32 v41, 131072, v33
    v_add_u32 v42, 131072, v34
    s_lshl_b32 s6, s52, 1
    s_add_u32 s6, s6, s5
    s_lshl_b32 s3, s6, 1
    s_add_u32 s3, s3, s59
    s_lshl_b32 s3, s3, 4
    s_add_u32 s3, s3, s4
    s_lshl_b32 s3, s3, 12
    v_lshl_add_u32 v78, v3, 8, v4
    v_add_u32 v78, s3, v78
    s_xor_b32 s37, s51, 1
    s_lshl_b32 s37, s37, 3
    s_add_u32 s37, s37, s52
    s_lshl_b32 s3, s37, 14
    s_add_u32 s3, s3, s58
    s_add_u32 s3, s3, 16777216
    v_add_u32 v23, s3, v4
    s_lshl_b32 s37, s37, 5
    s_add_u32 s37, s37, s5
    s_lshl_b32 s37, s37, 2
    s_add_u32 s37, s37, 6422528
    s_mul_i32 s67, s6, 56
    s_lshl_b32 s3, s51, 1
    s_add_u32 s3, s3, s4
    s_add_u32 s67, s67, s3
    s_lshl_b32 s67, s67, 11
    s_add_u32 s67, s67, 2097152
    v_add_u32 v81, s58, v4
    s_lshl_b32 s68, s52, 2
    s_and_b32 s3, s51, 1
    s_add_u32 s68, s68, s3
    s_cmp_ge_u32 s51, 14
    s_cselect_b32 s3, 2, 0
    s_add_u32 s68, s68, s3
    s_lshl_b32 s68, s68, 7
    s_add_u32 s68, s68, 6356992
    s_waitcnt vmcnt(7)
    v_readfirstlane_b32 s57, v12
    s_mov_b32 s60, 0
    s_cmp_lg_u32 s57, 0
    s_cbranch_scc0 L_nonce
L_nonce_ok:
    s_waitcnt vmcnt(4)
    s_barrier
    s_atomic_swap s57, s[28:29], s74
    s_atomic_swap s57, s[28:29], s73
    buffer_load_dwordx4 v[96:99], v85, s[8:11], 0 offen
    buffer_load_dwordx4 v[100:103], v86, s[8:11], 0 offen
    buffer_load_ushort v93, v82, s[40:43], 0 offen offset:0
    buffer_load_ushort v94, v82, s[40:43], 0 offen offset:16
    v_add_u32 v53, 65536, v4
    s_add_u32 m0, s58, 32768
    s_add_u32 s0, s0, 458752
    s_cmp_eq_u32 s0, 3670016
    s_cselect_b32 s0, 0, s0
    buffer_load_dwordx4 v55, s[20:23], s0 offen lds
    v_add_u32 v54, 131072, v4
    s_mul_i32 s59, s48, 3072
    s_mul_i32 s3, s50, 86016
    s_add_u32 s3, s3, s59
    s_add_u32 s3, s3, 8388608
    v_add_u32 v80, s3, v4
    v_lshlrev_b32 v14, 7, v9
    v_xor_b32 v14, v14, v4
    s_lshl_b32 s3, s49, 11
    v_add_u32 v67, s3, v14
    v_add_u32 v68, 129024, v67
    s_lshr_b32 s3, s49, 2
    s_lshl_b32 s3, s3, 3
    s_max_u32 s3, s3, 1
    s_sub_u32 s3, s3, 1
    s_lshl_b32 s3, s3, 10
    s_lshl_b32 s6, s5, 17
    s_add_u32 s3, s3, s6
    s_lshl_b32 s6, s4, 28
    s_add_u32 s3, s3, s6
    v_add_u32 v69, s3, v14
    buffer_load_dwordx4 v56, s[20:23], s0 offen offset:1024 lds
    s_lshl_b32 s100, s5, 1
    s_add_u32 s100, s100, s4
    s_lshl_b32 s100, s100, 10
    v_and_b32 v14, 1, v1
    v_mul_u32_u24 v14, 640, v14
    v_lshrrev_b32 v15, 2, v1
    v_lshlrev_b32 v15, 4, v15
    v_xor_b32 v14, v14, v15
    v_bfe_u32 v15, v1, 1, 1
    v_lshl_add_u32 v14, v15, 3, v14
    buffer_load_dwordx4 v57, s[20:23], s0 offen offset:2048 lds
    s_add_u32 s3, s58, 12288
    v_add_u32 v70, s3, v14
    s_sub_u32 s3, s3, 3072
    s_cmp_eq_u32 s48, 0
    s_cselect_b32 s3, 28672, s3
    v_add_u32 v71, s3, v14
    v_add_u32 v72, 65536, v70
    v_add_u32 v73, 65536, v71
    v_add_u32 v74, 131072, v70
    v_add_u32 v75, 131072, v71
    s_lshl_b32 s3, s49, 1
    v_min_u32 v14, 2, v3
    v_add_u32 v14, s3, v14
    v_max_u32 v14, 1, v14
    v_lshlrev_b32 v14, 1, v14
    v_and_b32 v15, 1, v7
    buffer_load_dwordx4 v58, s[20:23], s0 offen offset:3072 lds
    v_add_lshl_u32 v14, v14, v15, 7
    v_lshrrev_b32 v15, 1, v7
    v_lshl_add_u32 v15, v15, 2, v8
    v_lshl_add_u32 v14, v15, 3, v14
    v_add_u32 v77, 6291200, v14
    s_min_u32 s15, s48, 2
    s_lshl_b32 s15, s15, 6
    s_add_u32 s15, s15, 64
    s_lshl_b32 s82, s49, 5
    s_add_u32 s82, s82, s50
    s_lshl_b32 s82, s82, 10
    s_add_u32 s82, s82, 4194304
    s_lshr_b32 s69, s49, 2
    s_lshl_b32 s69, s69, 1
    s_and_b32 s3, s50, 1
    s_add_u32 s69, s69, s3
    s_lshl_b32 s69, s69, 7
    s_add_u32 s69, s69, 6361088
    s_and_b32 s7, s53, 1
    s_mul_i32 s3, s7, 28
    s_add_u32 s3, s3, s48
    s_lshl_b32 s3, s3, 17
    s_xor_b32 s6, s53, 1
    s_lshl_b32 s55, s6, 3
    s_lshl_b32 s6, s53, 7
    s_add_u32 s3, s3, s6
    v_lshlrev_b32 v14, 12, v5
    s_add_u32 m0, s58, 49152
    s_add_u32 s0, s0, 458752
    s_cmp_eq_u32 s0, 3670016
    s_cselect_b32 s0, 0, s0
    buffer_load_dwordx4 v55, s[20:23], s0 offen lds
    v_add3_u32 v59, v14, v83, s3
    v_add_u32 v60, 31744, v59
    v_add_u32 v61, 63488, v59
    v_add_u32 v62, 95232, v59
    v_mul_u32_u24 v14, 896, v5
    s_mul_i32 s3, s4, 25088
    s_mul_i32 s6, s5, 14336
    s_add_u32 s3, s3, s6
    s_lshl_b32 s6, s54, 7
    s_add_u32 s3, s3, s6
    v_add3_u32 v63, v14, v83, s3
    buffer_load_dwordx4 v56, s[20:23], s0 offen offset:1024 lds
    v_add_u32 v64, 6144, v63
    s_lshl_b32 s6, s53, 1
    s_add_u32 s6, s6, s5
    s_and_b32 s3, s53, 30
    s_add_u32 s3, s3, s4
    s_lshl_b32 s3, s3, 7
    s_add_u32 s39, s3, 6361088
    s_lshl_b32 s3, s6, 5
    s_add_u32 s3, s3, s4
    s_lshl_b32 s3, s3, 10
    s_add_u32 s3, s3, 4194304
    v_add_u32 v65, s3, v4
    v_add_u32 v66, 15360, v65
    s_xor_b32 s3, s4, s5
    s_lshl_b32 s3, s3, 6
    v_xor_b32 v43, s3, v31
    buffer_load_dwordx4 v57, s[20:23], s0 offen offset:2048 lds
    v_xor_b32 v44, 32, v43
    v_add_u32 v45, 65536, v43
    v_add_u32 v46, 65536, v44
    s_mul_i32 s3, s4, 12288
    v_add_u32 v47, s3, v4
    v_xor_b32 v48, 4096, v47
    v_add_u32 v49, 65536, v47
    v_add_u32 v50, 65536, v48
    v_add_u32 v51, 131072, v47
    v_add_u32 v52, 131072, v48
    s_lshl_b32 s6, s54, 1
    s_add_u32 s6, s6, s5
    s_lshl_b32 s3, s6, 1
    s_add_u32 s3, s3, s7
    s_mul_i32 s3, s3, 14
    s_add_u32 s3, s3, s4
    s_lshl_b32 s3, s3, 12
    s_add_u32 s3, s3, 2097152
    v_add_u32 v79, s3, v4
    buffer_load_dwordx4 v58, s[20:23], s0 offen offset:3072 lds
    s_lshl_b32 s3, s54, 1
    s_add_u32 s3, s3, s7
    s_lshl_b32 s3, s3, 1
    s_add_u32 s3, s3, s4
    s_lshl_b32 s3, s3, 7
    s_add_u32 s38, s3, 6356992
    s_and_b32 s3, s2, 6
    s_add_u32 s3, s3, s54
    s_sub_u32 s6, s3, 7
    s_cmp_ge_u32 s3, 7
    s_cselect_b32 s3, s6, s3
    s_lshl_b32 s64, s3, 19
    s_lshl_b32 s65, s3, 13
    s_add_u32 s55, s55, s54
    s_lshl_b32 s3, s55, 14
    s_add_u32 s3, s3, s58
    s_add_u32 s3, s3, 12582912
    v_add_u32 v21, s3, v4
    s_add_u32 m0, s58, 65536
    s_add_u32 s0, s0, 458752
    s_cmp_eq_u32 s0, 3670016
    s_cselect_b32 s0, 0, s0
    buffer_load_dwordx4 v55, s[20:23], s0 offen lds
    s_lshl_b32 s55, s55, 5
    s_add_u32 s55, s55, s48
    s_lshl_b32 s55, s55, 2
    s_add_u32 s55, s55, 6488064
    s_lshl_b32 s3, s5, 3
    v_add_u32 v13, s3, v3
    v_xor_b32 v13, v13, v6
    v_lshlrev_b32 v13, 4, v13
    v_lshl_add_u32 v13, v2, 8, v13
    buffer_load_dwordx4 v56, s[20:23], s0 offen offset:1024 lds
    s_lshl_b32 s3, s4, 14
    s_add_u32 s3, s3, 32768
    v_add_u32 v87, s3, v13
    v_xor_b32 v88, 64, v87
    s_lshr_b32 s3, s53, 1
    s_add_u32 s66, s3, s54
    s_mov_b32 s51, s66
    v_lshlrev_b32 v13, 1, v6
    v_xor_b32 v13, v13, v5
    v_lshlrev_b32 v13, 4, v13
    v_lshl_add_u32 v13, v5, 8, v13
    s_add_u32 s3, s58, 32768
    v_add_u32 v89, s3, v13
    v_xor_b32 v90, 16, v89
    v_xor_b32 v91, 24576, v89
    v_xor_b32 v92, 24592, v89
    buffer_load_dwordx4 v57, s[20:23], s0 offen offset:2048 lds
    v_lshlrev_b32 v150, 16, v246
    v_and_b32 v151, 0xffff0000, v246
    v_lshlrev_b32 v152, 16, v247
    v_and_b32 v153, 0xffff0000, v247
    v_lshlrev_b32 v154, 16, v248
    v_and_b32 v155, 0xffff0000, v248
    v_lshlrev_b32 v156, 16, v249
    v_and_b32 v157, 0xffff0000, v249
    v_lshlrev_b32 v158, 16, v246
    v_and_b32 v159, 0xffff0000, v246
    v_lshlrev_b32 v160, 16, v247
    v_and_b32 v161, 0xffff0000, v247
    v_lshlrev_b32 v162, 16, v248
    v_and_b32 v163, 0xffff0000, v248
    v_lshlrev_b32 v164, 16, v249
    v_and_b32 v165, 0xffff0000, v249
    buffer_load_dwordx4 v58, s[20:23], s0 offen offset:3072 lds
    s_add_u32 m0, s58, 81920
    s_add_u32 s0, s0, 458752
    s_cmp_eq_u32 s0, 3670016
    s_cselect_b32 s0, 0, s0
    buffer_load_dwordx4 v55, s[20:23], s0 offen lds
    buffer_load_dwordx4 v56, s[20:23], s0 offen offset:1024 lds
    buffer_load_dwordx4 v57, s[20:23], s0 offen offset:2048 lds
    buffer_load_dwordx4 v58, s[20:23], s0 offen offset:3072 lds
    s_add_u32 m0, s58, 98304
    s_add_u32 s0, s0, 458752
    s_cmp_eq_u32 s0, 3670016
    s_cselect_b32 s0, 0, s0
    buffer_load_dwordx4 v55, s[20:23], s0 offen lds
    buffer_load_dwordx4 v56, s[20:23], s0 offen offset:1024 lds
    buffer_load_dwordx4 v57, s[20:23], s0 offen offset:2048 lds
    buffer_load_dwordx4 v58, s[20:23], s0 offen offset:3072 lds
    buffer_load_dword v18, v20, s[28:31], 0 offen sc1
    s_add_u32 m0, s58, 114688
    s_add_u32 s0, s0, 458752
    s_cmp_eq_u32 s0, 3670016
    s_cselect_b32 s0, 0, s0
    buffer_load_dwordx4 v55, s[20:23], s0 offen lds
    buffer_load_dwordx4 v56, s[20:23], s0 offen offset:1024 lds
    buffer_load_dwordx4 v57, s[20:23], s0 offen offset:2048 lds
    buffer_load_dwordx4 v58, s[20:23], s0 offen offset:3072 lds
    s_mov_b32 s3, s48
    s_mov_b64 exec, 0
L_warm:
    s_add_u32 s3, s3, 4
    s_cmp_eq_u32 s3, 4
    s_cbranch_scc1 L_pad0
    s_cmp_eq_u32 s3, 5
    s_cbranch_scc1 L_pad1
    s_cmp_eq_u32 s3, 6
    s_cbranch_scc1 L_pad2
    s_cmp_eq_u32 s3, 7
    s_cbranch_scc1 L_pad3
    s_cmp_eq_u32 s3, 8
    s_cbranch_scc1 L_pad4
    s_mov_b64 exec, -1
    s_waitcnt vmcnt(4)
    v_cmp_ne_u32 vcc, s57, v18
    s_cbranch_vccnz L_pollin0
L_pollok0:
    s_barrier
    buffer_load_dwordx4 a[0:3], v78, s[28:31], s1 offen offset:0 sc1
    buffer_load_dwordx4 a[4:7], v78, s[28:31], s1 offen offset:256 sc1
    buffer_load_dwordx4 a[8:11], v78, s[28:31], s1 offen offset:2048 sc1
    buffer_load_dwordx4 a[12:15], v78, s[28:31], s1 offen offset:2304 sc1
    buffer_load_dword v76, v77, s[28:31], 0 offen sc1
    s_add_u32 s1, s1, 8192
    s_and_b32 s1, s1, 0xffff
    buffer_load_dwordx4 a[16:19], v78, s[28:31], s1 offen offset:0 sc1
    buffer_load_dwordx4 a[20:23], v78, s[28:31], s1 offen offset:256 sc1
    buffer_load_dwordx4 a[24:27], v78, s[28:31], s1 offen offset:2048 sc1
    buffer_load_dwordx4 a[28:31], v78, s[28:31], s1 offen offset:2304 sc1
    s_add_u32 s1, s1, 8192
    s_and_b32 s1, s1, 0xffff
    buffer_load_dwordx4 a[32:35], v78, s[28:31], s1 offen offset:0 sc1
    buffer_load_dwordx4 a[36:39], v78, s[28:31], s1 offen offset:256 sc1
    buffer_load_dwordx4 a[40:43], v78, s[28:31], s1 offen offset:2048 sc1
    buffer_load_dwordx4 a[44:47], v78, s[28:31], s1 offen offset:2304 sc1
    ds_read_b64_tr_b16 a[200:201], v31 offset:0
    ds_read_b64_tr_b16 a[202:203], v31 offset:2048
    ds_read_b64_tr_b16 a[204:205], v33 offset:0
    ds_read_b64_tr_b16 a[206:207], v33 offset:2048
    ds_read_b64_tr_b16 a[208:209], v32 offset:0
    ds_read_b64_tr_b16 a[210:211], v32 offset:2048
    ds_read_b64_tr_b16 a[212:213], v34 offset:0
    ds_read_b64_tr_b16 a[214:215], v34 offset:2048
    ds_read_b64_tr_b16 a[216:217], v31 offset:4096
    ds_read_b64_tr_b16 a[218:219], v31 offset:6144
    ds_read_b64_tr_b16 a[220:221], v33 offset:4096
    ds_read_b64_tr_b16 a[222:223], v33 offset:6144
    s_waitcnt vmcnt(11) lgkmcnt(8)
    v_mfma_f32_16x16x32_bf16 v[182:185], a[200:203], a[0:3], 0
    ds_read_b64_tr_b16 a[224:225], v32 offset:4096
    s_add_u32 s1, s1, 8192
    v_mfma_f32_16x16x32_bf16 v[190:193], a[200:203], a[4:7], 0
    ds_read_b64_tr_b16 a[226:227], v32 offset:6144
    s_and_b32 s1, s1, 0xffff
    s_mov_b32 s70, 0xaaaaaaaa
    s_mov_b32 s71, 0xaaaaaaaa
    s_mov_b32 s72, 0xfff0ffff
    s_mov_b32 s73, 0xf000ff00
    s_mov_b32 s74, 0xffc0fffc
    v_mfma_f32_16x16x32_bf16 v[198:201], a[204:207], a[0:3], 0
    ds_read_b64_tr_b16 a[228:229], v34 offset:4096
    buffer_load_dwordx4 a[48:51], v78, s[28:31], s1 offen offset:0 sc1
    v_mfma_f32_16x16x32_bf16 v[206:209], a[204:207], a[4:7], 0
    ds_read_b64_tr_b16 a[230:231], v34 offset:6144
    s_mov_b32 s75, 0xc000fc00
    s_waitcnt lgkmcnt(8)
    v_mfma_f32_16x16x32_bf16 v[186:189], a[208:211], a[0:3], 0
    ds_read_b64_tr_b16 a[200:201], v31 offset:16384
    s_mov_b32 s83, 0x3e8b97f6
    v_mfma_f32_16x16x32_bf16 v[194:197], a[208:211], a[4:7], 0
    ds_read_b64_tr_b16 a[202:203], v31 offset:18432
    buffer_load_dwordx4 a[52:55], v78, s[28:31], s1 offen offset:256 sc1
    v_lshlrev_b32 v13, 2, v2
    v_mfma_f32_16x16x32_bf16 v[202:205], a[212:215], a[0:3], 0
    ds_read_b64_tr_b16 a[204:205], v33 offset:16384
    v_and_b32 v14, 1, v1
    v_mfma_f32_16x16x32_bf16 v[210:213], a[212:215], a[4:7], 0
    ds_read_b64_tr_b16 a[206:207], v33 offset:18432
    s_waitcnt vmcnt(11) lgkmcnt(8)
    v_mfma_f32_16x16x32_bf16 v[182:185], a[216:219], a[8:11], v[182:185]
    ds_read_b64_tr_b16 a[208:209], v32 offset:16384
    buffer_load_dwordx4 a[56:59], v78, s[28:31], s1 offen offset:2048 sc1
    v_mfma_f32_16x16x32_bf16 v[190:193], a[216:219], a[12:15], v[190:193]
    ds_read_b64_tr_b16 a[210:211], v32 offset:18432
    v_lshl_add_u32 v14, v3, 2, v14
    v_mfma_f32_16x16x32_bf16 v[198:201], a[220:223], a[8:11], v[198:201]
    ds_read_b64_tr_b16 a[212:213], v34 offset:16384
    v_lshlrev_b32 v14, 2, v14
    v_mfma_f32_16x16x32_bf16 v[206:209], a[220:223], a[12:15], v[206:209]
    ds_read_b64_tr_b16 a[214:215], v34 offset:18432
    s_waitcnt lgkmcnt(8)
    v_mfma_f32_16x16x32_bf16 v[186:189], a[224:227], a[8:11], v[186:189]
    ds_read_b64_tr_b16 a[216:217], v31 offset:20480
    buffer_load_dwordx4 a[60:63], v78, s[28:31], s1 offen offset:2304 sc1
    v_mfma_f32_16x16x32_bf16 v[194:197], a[224:227], a[12:15], v[194:197]
    ds_read_b64_tr_b16 a[218:219], v31 offset:22528
    s_add_u32 s1, s1, 8192
    v_add_u32 v15, 64, v14
    v_mfma_f32_16x16x32_bf16 v[202:205], a[228:231], a[8:11], v[202:205]
    ds_read_b64_tr_b16 a[220:221], v33 offset:20480
    s_and_b32 s1, s1, 0xffff
    v_mfma_f32_16x16x32_bf16 v[210:213], a[228:231], a[12:15], v[210:213]
    ds_read_b64_tr_b16 a[222:223], v33 offset:22528
    s_waitcnt vmcnt(10) lgkmcnt(8)
    v_mfma_f32_16x16x32_bf16 v[182:185], a[200:203], a[16:19], v[182:185]
    ds_read_b64_tr_b16 a[224:225], v32 offset:20480
    buffer_load_dwordx4 a[64:67], v78, s[28:31], s1 offen offset:0 sc1
    v_mfma_f32_16x16x32_bf16 v[190:193], a[200:203], a[20:23], v[190:193]
    ds_read_b64_tr_b16 a[226:227], v32 offset:22528
    v_cndmask_b32 v16, v14, v15, s[72:73]
    v_mfma_f32_16x16x32_bf16 v[198:201], a[204:207], a[16:19], v[198:201]
    ds_read_b64_tr_b16 a[228:229], v34 offset:20480
    buffer_load_dwordx4 a[68:71], v78, s[28:31], s1 offen offset:256 sc1
    v_mfma_f32_16x16x32_bf16 v[206:209], a[204:207], a[20:23], v[206:209]
    ds_read_b64_tr_b16 a[230:231], v34 offset:22528
    v_cndmask_b32 v14, v14, v15, s[74:75]
    s_waitcnt lgkmcnt(8)
    v_mfma_f32_16x16x32_bf16 v[186:189], a[208:211], a[16:19], v[186:189]
    ds_read_b64_tr_b16 a[200:201], v31 offset:32768
    ds_bpermute_b32 v25, v13, v76 offset:64
    v_mfma_f32_16x16x32_bf16 v[194:197], a[208:211], a[20:23], v[194:197]
    ds_read_b64_tr_b16 a[202:203], v31 offset:34816
    buffer_load_dwordx4 a[72:75], v78, s[28:31], s1 offen offset:2048 sc1
    ds_bpermute_b32 v27, v16, v76 offset:0
    v_mfma_f32_16x16x32_bf16 v[202:205], a[212:215], a[16:19], v[202:205]
    ds_read_b64_tr_b16 a[204:205], v33 offset:32768
    ds_bpermute_b32 v28, v14, v76 offset:8
    v_mfma_f32_16x16x32_bf16 v[210:213], a[212:215], a[20:23], v[210:213]
    ds_read_b64_tr_b16 a[206:207], v33 offset:34816
    s_waitcnt vmcnt(11) lgkmcnt(11)
    v_mfma_f32_16x16x32_bf16 v[182:185], a[216:219], a[24:27], v[182:185]
    ds_read_b64_tr_b16 a[208:209], v32 offset:32768
    ds_bpermute_b32 v26, v13, v76 offset:128
    v_mfma_f32_16x16x32_bf16 v[190:193], a[216:219], a[28:31], v[190:193]
    ds_read_b64_tr_b16 a[210:211], v32 offset:34816
    buffer_load_dwordx4 a[76:79], v78, s[28:31], s1 offen offset:2304 sc1
    ds_bpermute_b32 v29, v16, v76 offset:64
    v_mfma_f32_16x16x32_bf16 v[198:201], a[220:223], a[24:27], v[198:201]
    ds_read_b64_tr_b16 a[212:213], v34 offset:32768
    s_add_u32 s1, s1, 8192
    v_mfma_f32_16x16x32_bf16 v[206:209], a[220:223], a[28:31], v[206:209]
    ds_read_b64_tr_b16 a[214:215], v34 offset:34816
    s_waitcnt lgkmcnt(13)
    v_mfma_f32_16x16x32_bf16 v[186:189], a[224:227], a[24:27], v[186:189]
    ds_read_b64_tr_b16 a[216:217], v31 offset:36864
    s_and_b32 s1, s1, 0xffff
    v_mfma_f32_16x16x32_bf16 v[194:197], a[224:227], a[28:31], v[194:197]
    ds_read_b64_tr_b16 a[218:219], v31 offset:38912
    buffer_load_dwordx4 a[80:83], v78, s[28:31], s1 offen offset:0 sc1
    ds_bpermute_b32 v30, v14, v76 offset:72
    v_mfma_f32_16x16x32_bf16 v[202:205], a[228:231], a[24:27], v[202:205]
    ds_read_b64_tr_b16 a[220:221], v33 offset:36864
    v_mfma_f32_16x16x32_bf16 v[210:213], a[228:231], a[28:31], v[210:213]
    ds_read_b64_tr_b16 a[222:223], v33 offset:38912
    s_waitcnt vmcnt(11) lgkmcnt(11)
    v_mfma_f32_16x16x32_bf16 v[182:185], a[200:203], a[32:35], v[182:185]
    ds_read_b64_tr_b16 a[224:225], v32 offset:36864
    buffer_load_dwordx4 a[84:87], v78, s[28:31], s1 offen offset:256 sc1
    v_mfma_f32_16x16x32_bf16 v[190:193], a[200:203], a[36:39], v[190:193]
    ds_read_b64_tr_b16 a[226:227], v32 offset:38912
    v_mfma_f32_16x16x32_bf16 v[198:201], a[204:207], a[32:35], v[198:201]
    ds_read_b64_tr_b16 a[228:229], v34 offset:36864
    v_mfma_f32_16x16x32_bf16 v[206:209], a[204:207], a[36:39], v[206:209]
    ds_read_b64_tr_b16 a[230:231], v34 offset:38912
    s_waitcnt lgkmcnt(9)
    v_mfma_f32_16x16x32_bf16 v[186:189], a[208:211], a[32:35], v[186:189]
    s_barrier
    ds_read_b64_tr_b16 a[200:201], v31 offset:49152
    buffer_load_dwordx4 a[88:91], v78, s[28:31], s1 offen offset:2048 sc1
    v_mfma_f32_16x16x32_bf16 v[194:197], a[208:211], a[36:39], v[194:197]
    ds_read_b64_tr_b16 a[202:203], v31 offset:51200
    v_mfma_f32_16x16x32_bf16 v[202:205], a[212:215], a[32:35], v[202:205]
    ds_read_b64_tr_b16 a[204:205], v33 offset:49152
    buffer_load_dwordx4 a[92:95], v78, s[28:31], s1 offen offset:2304 sc1
    v_mfma_f32_16x16x32_bf16 v[210:213], a[212:215], a[36:39], v[210:213]
    ds_read_b64_tr_b16 a[206:207], v33 offset:51200
    s_waitcnt vmcnt(12) lgkmcnt(8)
    v_mfma_f32_16x16x32_bf16 v[182:185], a[216:219], a[40:43], v[182:185]
    ds_read_b64_tr_b16 a[208:209], v32 offset:49152
    s_add_u32 m0, s58, 131072
    v_mfma_f32_16x16x32_bf16 v[190:193], a[216:219], a[44:47], v[190:193]
    ds_read_b64_tr_b16 a[210:211], v32 offset:51200
    s_add_u32 s0, s0, 458752
    v_mul_f32 v25, s83, v25
    v_mfma_f32_16x16x32_bf16 v[198:201], a[220:223], a[40:43], v[198:201]
    ds_read_b64_tr_b16 a[212:213], v34 offset:49152
    s_cmp_eq_u32 s0, 3670016
    v_mfma_f32_16x16x32_bf16 v[206:209], a[220:223], a[44:47], v[206:209]
    ds_read_b64_tr_b16 a[214:215], v34 offset:51200
    s_cselect_b32 s0, 0, s0
    v_xor_b32 v55, 128, v55
    buffer_load_dwordx4 v55, s[20:23], s0 offen lds
    s_waitcnt lgkmcnt(8)
    v_mfma_f32_16x16x32_bf16 v[186:189], a[224:227], a[40:43], v[186:189]
    ds_read_b64_tr_b16 a[216:217], v31 offset:53248
    v_xor_b32 v56, 128, v56
    v_mfma_f32_16x16x32_bf16 v[194:197], a[224:227], a[44:47], v[194:197]
    ds_read_b64_tr_b16 a[218:219], v31 offset:55296
    buffer_load_dwordx4 v56, s[20:23], s0 offen offset:1024 lds
    v_mul_f32 v26, s83, v26
    v_mfma_f32_16x16x32_bf16 v[202:205], a[228:231], a[40:43], v[202:205]
    ds_read_b64_tr_b16 a[220:221], v33 offset:53248
    v_xor_b32 v57, 128, v57
    v_mfma_f32_16x16x32_bf16 v[210:213], a[228:231], a[44:47], v[210:213]
    ds_read_b64_tr_b16 a[222:223], v33 offset:55296
    s_waitcnt vmcnt(12) lgkmcnt(8)
    v_mfma_f32_16x16x32_bf16 v[182:185], a[200:203], a[48:51], v[182:185]
    ds_read_b64_tr_b16 a[224:225], v32 offset:53248
    buffer_load_dwordx4 v57, s[20:23], s0 offen offset:2048 lds
    v_mfma_f32_16x16x32_bf16 v[190:193], a[200:203], a[52:55], v[190:193]
    ds_read_b64_tr_b16 a[226:227], v32 offset:55296
    v_xor_b32 v58, 128, v58
    s_cmp_eq_u32 s49, 0
    s_cselect_b64 s[76:77], 0, -1
    v_mfma_f32_16x16x32_bf16 v[198:201], a[204:207], a[48:51], v[198:201]
    ds_read_b64_tr_b16 a[228:229], v34 offset:53248
    v_mov_b32 v13, 0xffff
    v_mfma_f32_16x16x32_bf16 v[206:209], a[204:207], a[52:55], v[206:209]
    ds_read_b64_tr_b16 a[230:231], v34 offset:55296
    s_waitcnt lgkmcnt(8)
    v_mfma_f32_16x16x32_bf16 v[186:189], a[208:211], a[48:51], v[186:189]
    ds_read_b64_tr_b16 a[200:201], v35 offset:0
    buffer_load_dwordx4 v58, s[20:23], s0 offen offset:3072 lds
    v_mfma_f32_16x16x32_bf16 v[194:197], a[208:211], a[52:55], v[194:197]
    ds_read_b64_tr_b16 a[202:203], v35 offset:2048
    s_add_u32 s1, s1, 8192
    v_mov_b32 v14, 0xffff0000
    v_mfma_f32_16x16x32_bf16 v[202:205], a[212:215], a[48:51], v[202:205]
    ds_read_b64_tr_b16 a[204:205], v37 offset:0
    s_and_b32 s1, s1, 0xffff
    v_mfma_f32_16x16x32_bf16 v[210:213], a[212:215], a[52:55], v[210:213]
    ds_read_b64_tr_b16 a[206:207], v37 offset:2048
    v_cndmask_b32 v13, v13, v14, s[70:71]
    s_waitcnt vmcnt(12) lgkmcnt(8)
    v_mfma_f32_16x16x32_bf16 v[182:185], a[216:219], a[56:59], v[182:185]
    ds_read_b64_tr_b16 a[208:209], v36 offset:0
    buffer_load_dwordx4 a[96:99], v78, s[28:31], s1 offen offset:0 sc1
    v_mfma_f32_16x16x32_bf16 v[190:193], a[216:219], a[60:63], v[190:193]
    ds_read_b64_tr_b16 a[210:211], v36 offset:2048
    v_cndmask_b32 v104, v13, 0, s[72:73]
    v_mfma_f32_16x16x32_bf16 v[198:201], a[220:223], a[56:59], v[198:201]
    ds_read_b64_tr_b16 a[212:213], v38 offset:0
    buffer_load_dwordx4 a[100:103], v78, s[28:31], s1 offen offset:256 sc1
    v_mfma_f32_16x16x32_bf16 v[206:209], a[220:223], a[60:63], v[206:209]
    ds_read_b64_tr_b16 a[214:215], v38 offset:2048
    v_cndmask_b32 v106, 0, v13, s[72:73]
    s_waitcnt lgkmcnt(8)
    v_mfma_f32_16x16x32_bf16 v[186:189], a[224:227], a[56:59], v[186:189]
    ds_read_b64_tr_b16 a[216:217], v35 offset:4096
    v_cndmask_b32 v105, v13, 0, s[74:75]
    v_mfma_f32_16x16x32_bf16 v[194:197], a[224:227], a[60:63], v[194:197]
    ds_read_b64_tr_b16 a[218:219], v35 offset:6144
    buffer_load_dwordx4 a[104:107], v78, s[28:31], s1 offen offset:2048 sc1
    v_cndmask_b32 v107, 0, v13, s[74:75]
    v_mfma_f32_16x16x32_bf16 v[202:205], a[228:231], a[56:59], v[202:205]
    ds_read_b64_tr_b16 a[220:221], v37 offset:4096
    v_mov_b32 v84, 0xf149f2ca
    v_mfma_f32_16x16x32_bf16 v[210:213], a[228:231], a[60:63], v[210:213]
    ds_read_b64_tr_b16 a[222:223], v37 offset:6144
    s_waitcnt vmcnt(13) lgkmcnt(8)
    v_mfma_f32_16x16x32_bf16 v[182:185], a[200:203], a[64:67], v[182:185]
    ds_read_b64_tr_b16 a[224:225], v36 offset:4096
    buffer_load_dwordx4 a[108:111], v78, s[28:31], s1 offen offset:2304 sc1
    v_mfma_f32_16x16x32_bf16 v[190:193], a[200:203], a[68:71], v[190:193]
    ds_read_b64_tr_b16 a[226:227], v36 offset:6144
    s_add_u32 m0, s58, 147456
    s_mov_b32 s83, 0x3e8b97f6
    v_mfma_f32_16x16x32_bf16 v[198:201], a[204:207], a[64:67], v[198:201]
    ds_read_b64_tr_b16 a[228:229], v38 offset:4096
    s_add_u32 s0, s0, 458752
    v_mfma_f32_16x16x32_bf16 v[206:209], a[204:207], a[68:71], v[206:209]
    ds_read_b64_tr_b16 a[230:231], v38 offset:6144
    s_mov_b32 s78, 0xbdd2d3e8
    s_mov_b32 s79, 0xbdd2d3e8
    s_waitcnt lgkmcnt(8)
    v_mfma_f32_16x16x32_bf16 v[186:189], a[208:211], a[64:67], v[186:189]
    s_barrier
    s_mov_b32 s14, 0
    s_load_dword s14, s[44:45], s15
    ds_read_b64_tr_b16 a[200:201], v35 offset:16384
    s_cmp_eq_u32 s0, 3670016
    s_cselect_b32 s0, 0, s0
    buffer_load_dwordx4 v55, s[20:23], s0 offen lds
    v_mfma_f32_16x16x32_bf16 v[194:197], a[208:211], a[68:71], v[194:197]
    ds_read_b64_tr_b16 a[202:203], v35 offset:18432
    s_mov_b32 s80, 1.0
    v_mfma_f32_16x16x32_bf16 v[202:205], a[212:215], a[64:67], v[202:205]
    ds_read_b64_tr_b16 a[204:205], v37 offset:16384
    buffer_load_dwordx4 v56, s[20:23], s0 offen offset:1024 lds
    v_mfma_f32_16x16x32_bf16 v[210:213], a[212:215], a[68:71], v[210:213]
    ds_read_b64_tr_b16 a[206:207], v37 offset:18432
    s_mov_b32 s81, 1.0
    s_waitcnt vmcnt(14) lgkmcnt(8)
    v_mfma_f32_16x16x32_bf16 v[182:185], a[216:219], a[72:75], v[182:185]
    ds_read_b64_tr_b16 a[208:209], v36 offset:16384
    v_mov_b32 v108, 0xc0135761
    v_mfma_f32_16x16x32_bf16 v[190:193], a[216:219], a[76:79], v[190:193]
    ds_read_b64_tr_b16 a[210:211], v36 offset:18432
    buffer_load_dwordx4 v57, s[20:23], s0 offen offset:2048 lds
    v_mov_b32 v109, 0xc0135761
    v_mfma_f32_16x16x32_bf16 v[198:201], a[220:223], a[72:75], v[198:201]
    ds_read_b64_tr_b16 a[212:213], v38 offset:16384
    v_lshrrev_b32 v13, 1, v2
    v_mfma_f32_16x16x32_bf16 v[206:209], a[220:223], a[76:79], v[206:209]
    ds_read_b64_tr_b16 a[214:215], v38 offset:18432
    s_waitcnt lgkmcnt(8)
    v_mfma_f32_16x16x32_bf16 v[186:189], a[224:227], a[72:75], v[186:189]
    ds_read_b64_tr_b16 a[216:217], v35 offset:20480
    buffer_load_dwordx4 v58, s[20:23], s0 offen offset:3072 lds
    v_mfma_f32_16x16x32_bf16 v[194:197], a[224:227], a[76:79], v[194:197]
    ds_read_b64_tr_b16 a[218:219], v35 offset:22528
    s_add_u32 s1, s1, 8192
    v_lshlrev_b32 v14, 1, v3
    v_mfma_f32_16x16x32_bf16 v[202:205], a[228:231], a[72:75], v[202:205]
    ds_read_b64_tr_b16 a[220:221], v37 offset:20480
    s_and_b32 s1, s1, 0xffff
    v_mfma_f32_16x16x32_bf16 v[210:213], a[228:231], a[76:79], v[210:213]
    ds_read_b64_tr_b16 a[222:223], v37 offset:22528
    s_waitcnt vmcnt(14) lgkmcnt(8)
    v_mfma_f32_16x16x32_bf16 v[182:185], a[200:203], a[80:83], v[182:185]
    ds_read_b64_tr_b16 a[224:225], v36 offset:20480
    buffer_load_dwordx4 a[112:115], v78, s[28:31], s1 offen offset:0 sc1
    v_mfma_f32_16x16x32_bf16 v[190:193], a[200:203], a[84:87], v[190:193]
L_pad0:
    s_cbranch_execz L_warm
    ds_read_b64_tr_b16 a[226:227], v36 offset:22528
    v_sub_u32 v13, v13, v14
    v_mfma_f32_16x16x32_bf16 v[198:201], a[204:207], a[80:83], v[198:201]
    ds_read_b64_tr_b16 a[228:229], v38 offset:20480
    buffer_load_dwordx4 a[116:119], v78, s[28:31], s1 offen offset:256 sc1
    v_mfma_f32_16x16x32_bf16 v[206:209], a[204:207], a[84:87], v[206:209]
    ds_read_b64_tr_b16 a[230:231], v38 offset:22528
    v_mov_b32 v14, 0x3f80
    s_waitcnt lgkmcnt(8)
    v_mfma_f32_16x16x32_bf16 v[186:189], a[208:211], a[80:83], v[186:189]
    ds_read_b64_tr_b16 a[200:201], v35 offset:32768
    v_cndmask_b32 v14, v14, 1.0, s[70:71]
    v_mfma_f32_16x16x32_bf16 v[194:197], a[208:211], a[84:87], v[194:197]
    ds_read_b64_tr_b16 a[202:203], v35 offset:34816
    buffer_load_dwordx4 a[120:123], v78, s[28:31], s1 offen offset:2048 sc1
    v_cmp_eq_i32 vcc, 0, v13
    v_mfma_f32_16x16x32_bf16 v[202:205], a[212:215], a[80:83], v[202:205]
    ds_read_b64_tr_b16 a[204:205], v37 offset:32768
    v_accvgpr_write_b32 a248, 0
    v_mfma_f32_16x16x32_bf16 v[210:213], a[212:215], a[84:87], v[210:213]
    ds_read_b64_tr_b16 a[206:207], v37 offset:34816
    s_waitcnt vmcnt(15) lgkmcnt(8)
    v_mfma_f32_16x16x32_bf16 v[182:185], a[216:219], a[88:91], v[182:185]
    ds_read_b64_tr_b16 a[208:209], v36 offset:32768
    buffer_load_dwordx4 a[124:127], v78, s[28:31], s1 offen offset:2304 sc1
    v_mfma_f32_16x16x32_bf16 v[190:193], a[216:219], a[92:95], v[190:193]
    ds_read_b64_tr_b16 a[210:211], v36 offset:34816
    s_add_u32 m0, s58, 0
    v_accvgpr_write_b32 a252, 0
    v_mfma_f32_16x16x32_bf16 v[198:201], a[220:223], a[88:91], v[198:201]
    ds_read_b64_tr_b16 a[212:213], v38 offset:32768
    s_add_u32 s0, s0, 458752
    v_mfma_f32_16x16x32_bf16 v[206:209], a[220:223], a[92:95], v[206:209]
    ds_read_b64_tr_b16 a[214:215], v38 offset:34816
    s_waitcnt lgkmcnt(8)
    v_mfma_f32_16x16x32_bf16 v[186:189], a[224:227], a[88:91], v[186:189]
    ds_read_b64_tr_b16 a[216:217], v35 offset:36864
    s_cmp_eq_u32 s0, 3670016
    v_mfma_f32_16x16x32_bf16 v[194:197], a[224:227], a[92:95], v[194:197]
    ds_read_b64_tr_b16 a[218:219], v35 offset:38912
    s_cselect_b32 s0, 0, s0
    buffer_load_dwordx4 v55, s[20:23], s0 offen lds
    v_cndmask_b32 v15, 0, v14, vcc
    v_mfma_f32_16x16x32_bf16 v[202:205], a[228:231], a[88:91], v[202:205]
    ds_read_b64_tr_b16 a[220:221], v37 offset:36864
    v_accvgpr_write_b32 a250, v15
    v_mfma_f32_16x16x32_bf16 v[210:213], a[228:231], a[92:95], v[210:213]
    ds_read_b64_tr_b16 a[222:223], v37 offset:38912
    s_waitcnt vmcnt(11) lgkmcnt(8)
    v_mfma_f32_16x16x32_bf16 v[182:185], a[200:203], a[96:99], v[182:185]
    ds_read_b64_tr_b16 a[224:225], v36 offset:36864
    buffer_load_dwordx4 v56, s[20:23], s0 offen offset:1024 lds
    v_mfma_f32_16x16x32_bf16 v[190:193], a[200:203], a[100:103], v[190:193]
    ds_read_b64_tr_b16 a[226:227], v36 offset:38912
    v_cmp_eq_i32 vcc, 1, v13
    v_mfma_f32_16x16x32_bf16 v[198:201], a[204:207], a[96:99], v[198:201]
    ds_read_b64_tr_b16 a[228:229], v38 offset:36864
    buffer_load_dwordx4 v57, s[20:23], s0 offen offset:2048 lds
    v_mfma_f32_16x16x32_bf16 v[206:209], a[204:207], a[100:103], v[206:209]
    ds_read_b64_tr_b16 a[230:231], v38 offset:38912
    v_accvgpr_write_b32 a249, 0
    s_waitcnt lgkmcnt(8)
    v_mfma_f32_16x16x32_bf16 v[186:189], a[208:211], a[96:99], v[186:189]
    ds_read_b64_tr_b16 a[200:201], v35 offset:49152
    v_accvgpr_write_b32 a253, 0
    v_mfma_f32_16x16x32_bf16 v[194:197], a[208:211], a[100:103], v[194:197]
    ds_read_b64_tr_b16 a[202:203], v35 offset:51200
    buffer_load_dwordx4 v58, s[20:23], s0 offen offset:3072 lds
    v_cndmask_b32 v15, 0, v14, vcc
    v_mfma_f32_16x16x32_bf16 v[202:205], a[212:215], a[96:99], v[202:205]
    ds_read_b64_tr_b16 a[204:205], v37 offset:49152
    s_add_u32 m0, s58, 16384
    v_mfma_f32_16x16x32_bf16 v[210:213], a[212:215], a[100:103], v[210:213]
    ds_read_b64_tr_b16 a[206:207], v37 offset:51200
    s_waitcnt vmcnt(12) lgkmcnt(8)
    v_mfma_f32_16x16x32_bf16 v[182:185], a[216:219], a[104:107], v[182:185]
    ds_read_b64_tr_b16 a[208:209], v36 offset:49152
    s_add_u32 s0, s0, 458752
    v_mfma_f32_16x16x32_bf16 v[190:193], a[216:219], a[108:111], v[190:193]
    ds_read_b64_tr_b16 a[210:211], v36 offset:51200
    s_cmp_eq_u32 s0, 3670016
    s_cselect_b32 s0, 0, s0
    buffer_load_dwordx4 v55, s[20:23], s0 offen lds
    v_accvgpr_write_b32 a251, v15
    v_mfma_f32_16x16x32_bf16 v[198:201], a[220:223], a[104:107], v[198:201]
    ds_read_b64_tr_b16 a[212:213], v38 offset:49152
    v_mfma_f32_16x16x32_bf16 v[206:209], a[220:223], a[108:111], v[206:209]
    ds_read_b64_tr_b16 a[214:215], v38 offset:51200
    s_waitcnt lgkmcnt(8)
    v_mfma_f32_16x16x32_bf16 v[186:189], a[224:227], a[104:107], v[186:189]
    ds_read_b64_tr_b16 a[216:217], v35 offset:53248
    buffer_load_dwordx4 v56, s[20:23], s0 offen offset:1024 lds
    v_mfma_f32_16x16x32_bf16 v[194:197], a[224:227], a[108:111], v[194:197]
    ds_read_b64_tr_b16 a[218:219], v35 offset:55296
    v_mfma_f32_16x16x32_bf16 v[202:205], a[228:231], a[104:107], v[202:205]
    ds_read_b64_tr_b16 a[220:221], v37 offset:53248
    buffer_load_dwordx4 v57, s[20:23], s0 offen offset:2048 lds
    v_mfma_f32_16x16x32_bf16 v[210:213], a[228:231], a[108:111], v[210:213]
    ds_read_b64_tr_b16 a[222:223], v37 offset:55296
    s_waitcnt vmcnt(9) lgkmcnt(8)
    v_mfma_f32_16x16x32_bf16 v[182:185], a[200:203], a[112:115], v[182:185]
    ds_read_b64_tr_b16 a[224:225], v36 offset:53248
    v_mfma_f32_16x16x32_bf16 v[190:193], a[200:203], a[116:119], v[190:193]
    ds_read_b64_tr_b16 a[226:227], v36 offset:55296
    buffer_load_dwordx4 v58, s[20:23], s0 offen offset:3072 lds
    v_mfma_f32_16x16x32_bf16 v[198:201], a[204:207], a[112:115], v[198:201]
    ds_read_b64_tr_b16 a[228:229], v38 offset:53248
    s_add_u32 m0, s58, 32768
    v_mfma_f32_16x16x32_bf16 v[206:209], a[204:207], a[116:119], v[206:209]
    ds_read_b64_tr_b16 a[230:231], v38 offset:55296
    s_waitcnt lgkmcnt(8)
    v_mfma_f32_16x16x32_bf16 v[186:189], a[208:211], a[112:115], v[186:189]
    s_cmp_ge_u32 s14, 14
    s_cbranch_scc0 L_pollin1
L_pollok1:
    s_barrier
    ds_read_b64_tr_b16 a[200:201], v39 offset:0
    s_add_u32 s0, s0, 458752
    v_mfma_f32_16x16x32_bf16 v[194:197], a[208:211], a[116:119], v[194:197]
    ds_read_b64_tr_b16 a[202:203], v39 offset:2048
    s_cmp_eq_u32 s0, 3670016
    s_cselect_b32 s0, 0, s0
    buffer_load_dwordx4 v55, s[20:23], s0 offen lds
    v_mfma_f32_16x16x32_bf16 v[202:205], a[212:215], a[112:115], v[202:205]
    ds_read_b64_tr_b16 a[204:205], v41 offset:0
    v_mfma_f32_16x16x32_bf16 v[210:213], a[212:215], a[116:119], v[210:213]
    ds_read_b64_tr_b16 a[206:207], v41 offset:2048
    s_waitcnt vmcnt(9) lgkmcnt(8)
    v_mfma_f32_16x16x32_bf16 v[182:185], a[216:219], a[120:123], v[182:185]
    ds_read_b64_tr_b16 a[208:209], v40 offset:0
    buffer_load_dwordx4 v56, s[20:23], s0 offen offset:1024 lds
    v_mfma_f32_16x16x32_bf16 v[190:193], a[216:219], a[124:127], v[190:193]
    ds_read_b64_tr_b16 a[210:211], v40 offset:2048
    v_mfma_f32_16x16x32_bf16 v[198:201], a[220:223], a[120:123], v[198:201]
    ds_read_b64_tr_b16 a[212:213], v42 offset:0
    buffer_load_dwordx4 v57, s[20:23], s0 offen offset:2048 lds
    v_mfma_f32_16x16x32_bf16 v[206:209], a[220:223], a[124:127], v[206:209]
    ds_read_b64_tr_b16 a[214:215], v42 offset:2048
    s_waitcnt lgkmcnt(8)
    v_mfma_f32_16x16x32_bf16 v[186:189], a[224:227], a[120:123], v[186:189]
    ds_read_b64_tr_b16 a[216:217], v39 offset:4096
    v_mfma_f32_16x16x32_bf16 v[194:197], a[224:227], a[124:127], v[194:197]
    ds_read_b64_tr_b16 a[218:219], v39 offset:6144
    buffer_load_dwordx4 v58, s[20:23], s0 offen offset:3072 lds
    v_mfma_f32_16x16x32_bf16 v[202:205], a[228:231], a[120:123], v[202:205]
    ds_read_b64_tr_b16 a[220:221], v41 offset:4096
    s_add_u32 m0, s58, 49152
    v_mfma_f32_16x16x32_bf16 v[210:213], a[228:231], a[124:127], v[210:213]
    ds_read_b64_tr_b16 a[222:223], v41 offset:6144
    s_waitcnt lgkmcnt(8)
    v_mfma_f32_16x16x32_bf16 v[150:153], a[200:203], a[0:3], v[150:153]
    ds_read_b64_tr_b16 a[224:225], v40 offset:4096
    s_add_u32 s0, s0, 458752
    v_mfma_f32_16x16x32_bf16 v[158:161], a[200:203], a[4:7], v[158:161]
    ds_read_b64_tr_b16 a[226:227], v40 offset:6144
    s_cmp_eq_u32 s0, 3670016
    v_mfma_f32_16x16x32_bf16 v[166:169], a[204:207], a[0:3], 0
    ds_read_b64_tr_b16 a[228:229], v42 offset:4096
    s_cselect_b32 s0, 0, s0
    buffer_load_dwordx4 v55, s[20:23], s0 offen lds
    v_mfma_f32_16x16x32_bf16 v[174:177], a[204:207], a[4:7], 0
    ds_read_b64_tr_b16 a[230:231], v42 offset:6144
    v_cvt_pk_bf16_f32 v182, v182, v183
    v_cvt_pk_bf16_f32 v183, v184, v185
    v_cvt_pk_bf16_f32 v184, v186, v187
    s_waitcnt lgkmcnt(8)
    v_mfma_f32_16x16x32_bf16 v[154:157], a[208:211], a[0:3], v[154:157]
    ds_read_b64_tr_b16 a[200:201], v39 offset:16384
    buffer_load_dwordx4 v56, s[20:23], s0 offen offset:1024 lds
    v_mfma_f32_16x16x32_bf16 v[162:165], a[208:211], a[4:7], v[162:165]
    ds_read_b64_tr_b16 a[202:203], v39 offset:18432
    v_cvt_pk_bf16_f32 v185, v188, v189
    buffer_store_dwordx4 v[182:185], v23, s[28:31], 0 offen offset:0 sc1
    v_cvt_pk_bf16_f32 v190, v190, v191
    v_cvt_pk_bf16_f32 v191, v192, v193
    v_cvt_pk_bf16_f32 v192, v194, v195
    v_mfma_f32_16x16x32_bf16 v[170:173], a[212:215], a[0:3], 0
    ds_read_b64_tr_b16 a[204:205], v41 offset:16384
    v_cvt_pk_bf16_f32 v193, v196, v197
    v_mfma_f32_16x16x32_bf16 v[178:181], a[212:215], a[4:7], 0
    ds_read_b64_tr_b16 a[206:207], v41 offset:18432
    buffer_store_dwordx4 v[190:193], v23, s[28:31], 0 offen offset:1024 sc1
    v_cvt_pk_bf16_f32 v198, v198, v199
    v_cvt_pk_bf16_f32 v199, v200, v201
    v_cvt_pk_bf16_f32 v200, v202, v203
    s_waitcnt lgkmcnt(8)
    v_mfma_f32_16x16x32_bf16 v[150:153], a[216:219], a[8:11], v[150:153]
    ds_read_b64_tr_b16 a[208:209], v40 offset:16384
    buffer_load_dwordx4 v57, s[20:23], s0 offen offset:2048 lds
    v_mfma_f32_16x16x32_bf16 v[158:161], a[216:219], a[12:15], v[158:161]
    ds_read_b64_tr_b16 a[210:211], v40 offset:18432
    v_cvt_pk_bf16_f32 v201, v204, v205
    buffer_store_dwordx4 v[198:201], v23, s[28:31], 0 offen offset:2048 sc1
    v_cvt_pk_bf16_f32 v206, v206, v207
    v_cvt_pk_bf16_f32 v207, v208, v209
    v_cvt_pk_bf16_f32 v208, v210, v211
    v_mfma_f32_16x16x32_bf16 v[166:169], a[220:223], a[8:11], v[166:169]
    ds_read_b64_tr_b16 a[212:213], v42 offset:16384
    v_cvt_pk_bf16_f32 v209, v212, v213
    v_mfma_f32_16x16x32_bf16 v[174:177], a[220:223], a[12:15], v[174:177]
    ds_read_b64_tr_b16 a[214:215], v42 offset:18432
    s_waitcnt lgkmcnt(8)
    v_mfma_f32_16x16x32_bf16 v[154:157], a[224:227], a[8:11], v[154:157]
    ds_read_b64_tr_b16 a[216:217], v39 offset:20480
    buffer_load_dwordx4 v58, s[20:23], s0 offen offset:3072 lds
    v_mfma_f32_16x16x32_bf16 v[162:165], a[224:227], a[12:15], v[162:165]
    ds_read_b64_tr_b16 a[218:219], v39 offset:22528
    s_add_u32 m0, s58, 65536
    buffer_store_dwordx4 v[206:209], v23, s[28:31], 0 offen offset:3072 sc1
    v_mfma_f32_16x16x32_bf16 v[170:173], a[228:231], a[8:11], v[170:173]
    ds_read_b64_tr_b16 a[220:221], v41 offset:20480
    s_add_u32 s0, s0, 458752
    v_mfma_f32_16x16x32_bf16 v[178:181], a[228:231], a[12:15], v[178:181]
    ds_read_b64_tr_b16 a[222:223], v41 offset:22528
    s_waitcnt lgkmcnt(8)
    v_mfma_f32_16x16x32_bf16 v[150:153], a[200:203], a[16:19], v[150:153]
    ds_read_b64_tr_b16 a[224:225], v40 offset:20480
    s_cmp_eq_u32 s0, 3670016
    v_mfma_f32_16x16x32_bf16 v[158:161], a[200:203], a[20:23], v[158:161]
    ds_read_b64_tr_b16 a[226:227], v40 offset:22528
    s_cselect_b32 s0, 0, s0
    buffer_load_dwordx4 v55, s[20:23], s0 offen lds
    v_mfma_f32_16x16x32_bf16 v[166:169], a[204:207], a[16:19], v[166:169]
    ds_read_b64_tr_b16 a[228:229], v42 offset:20480
    v_mfma_f32_16x16x32_bf16 v[174:177], a[204:207], a[20:23], v[174:177]
    ds_read_b64_tr_b16 a[230:231], v42 offset:22528
    s_waitcnt lgkmcnt(8)
    v_mfma_f32_16x16x32_bf16 v[154:157], a[208:211], a[16:19], v[154:157]
    s_waitcnt vmcnt(13)
    s_barrier
    ds_read_b64_tr_b16 a[200:201], v31 offset:0
    buffer_load_dwordx4 v56, s[20:23], s0 offen offset:1024 lds
    v_mfma_f32_16x16x32_bf16 v[162:165], a[208:211], a[20:23], v[162:165]
    ds_read_b64_tr_b16 a[202:203], v31 offset:2048
    v_mfma_f32_16x16x32_bf16 v[170:173], a[212:215], a[16:19], v[170:173]
    ds_read_b64_tr_b16 a[204:205], v33 offset:0
    buffer_load_dwordx4 v57, s[20:23], s0 offen offset:2048 lds
    v_mfma_f32_16x16x32_bf16 v[178:181], a[212:215], a[20:23], v[178:181]
    ds_read_b64_tr_b16 a[206:207], v33 offset:2048
    s_waitcnt lgkmcnt(8)
    v_mfma_f32_16x16x32_bf16 v[150:153], a[216:219], a[24:27], v[150:153]
    ds_read_b64_tr_b16 a[208:209], v32 offset:0
    v_mfma_f32_16x16x32_bf16 v[158:161], a[216:219], a[28:31], v[158:161]
    ds_read_b64_tr_b16 a[210:211], v32 offset:2048
    buffer_load_dwordx4 v58, s[20:23], s0 offen offset:3072 lds
    v_mfma_f32_16x16x32_bf16 v[166:169], a[220:223], a[24:27], v[166:169]
    ds_read_b64_tr_b16 a[212:213], v34 offset:0
    s_add_u32 m0, s58, 81920
    v_mfma_f32_16x16x32_bf16 v[174:177], a[220:223], a[28:31], v[174:177]
    ds_read_b64_tr_b16 a[214:215], v34 offset:2048
    s_waitcnt lgkmcnt(8)
    v_mfma_f32_16x16x32_bf16 v[154:157], a[224:227], a[24:27], v[154:157]
    ds_read_b64_tr_b16 a[216:217], v31 offset:4096
    s_add_u32 s0, s0, 458752
    v_mfma_f32_16x16x32_bf16 v[162:165], a[224:227], a[28:31], v[162:165]
    ds_read_b64_tr_b16 a[218:219], v31 offset:6144
    s_cmp_eq_u32 s0, 3670016
    v_mfma_f32_16x16x32_bf16 v[170:173], a[228:231], a[24:27], v[170:173]
    ds_read_b64_tr_b16 a[220:221], v33 offset:4096
    s_cselect_b32 s0, 0, s0
    buffer_load_dwordx4 v55, s[20:23], s0 offen lds
    v_mfma_f32_16x16x32_bf16 v[178:181], a[228:231], a[28:31], v[178:181]
    ds_read_b64_tr_b16 a[222:223], v33 offset:6144
    s_waitcnt lgkmcnt(8)
    v_mfma_f32_16x16x32_bf16 v[150:153], a[200:203], a[32:35], v[150:153]
    ds_read_b64_tr_b16 a[224:225], v32 offset:4096
    buffer_load_dwordx4 v56, s[20:23], s0 offen offset:1024 lds
    v_mfma_f32_16x16x32_bf16 v[158:161], a[200:203], a[36:39], v[158:161]
    ds_read_b64_tr_b16 a[226:227], v32 offset:6144
    v_mfma_f32_16x16x32_bf16 v[166:169], a[204:207], a[32:35], v[166:169]
    ds_read_b64_tr_b16 a[228:229], v34 offset:4096
    v_mfma_f32_16x16x32_bf16 v[174:177], a[204:207], a[36:39], v[174:177]
    ds_read_b64_tr_b16 a[230:231], v34 offset:6144
    s_waitcnt lgkmcnt(8)
    v_mfma_f32_16x16x32_bf16 v[154:157], a[208:211], a[32:35], v[154:157]
    s_waitcnt vmcnt(6)
    s_atomic_add s36, s[28:29], s37
    ds_read_b64_tr_b16 a[200:201], v31 offset:16384
    buffer_load_dwordx4 v57, s[20:23], s0 offen offset:2048 lds
    v_mfma_f32_16x16x32_bf16 v[162:165], a[208:211], a[36:39], v[162:165]
    ds_read_b64_tr_b16 a[202:203], v31 offset:18432
    v_mfma_f32_16x16x32_bf16 v[170:173], a[212:215], a[32:35], v[170:173]
    ds_read_b64_tr_b16 a[204:205], v33 offset:16384
    buffer_load_dwordx4 v58, s[20:23], s0 offen offset:3072 lds
    v_mfma_f32_16x16x32_bf16 v[178:181], a[212:215], a[36:39], v[178:181]
    ds_read_b64_tr_b16 a[206:207], v33 offset:18432
    s_waitcnt lgkmcnt(8)
    v_mfma_f32_16x16x32_bf16 v[150:153], a[216:219], a[40:43], v[150:153]
    ds_read_b64_tr_b16 a[208:209], v32 offset:16384
    s_add_u32 m0, s59, 98304
    v_mfma_f32_16x16x32_bf16 v[158:161], a[216:219], a[44:47], v[158:161]
    ds_read_b64_tr_b16 a[210:211], v32 offset:18432
    buffer_load_dwordx4 v80, s[28:31], s63 offen sc1 lds
    v_mfma_f32_16x16x32_bf16 v[166:169], a[220:223], a[40:43], v[166:169]
    ds_read_b64_tr_b16 a[212:213], v34 offset:16384
    v_mfma_f32_16x16x32_bf16 v[174:177], a[220:223], a[44:47], v[174:177]
    ds_read_b64_tr_b16 a[214:215], v34 offset:18432
    s_waitcnt lgkmcnt(8)
    v_mfma_f32_16x16x32_bf16 v[154:157], a[224:227], a[40:43], v[154:157]
    ds_read_b64_tr_b16 a[216:217], v31 offset:20480
    v_mfma_f32_16x16x32_bf16 v[162:165], a[224:227], a[44:47], v[162:165]
    ds_read_b64_tr_b16 a[218:219], v31 offset:22528
    buffer_load_dwordx4 v80, s[28:31], s63 offen offset:1024 sc1 lds
    v_mfma_f32_16x16x32_bf16 v[170:173], a[228:231], a[40:43], v[170:173]
    ds_read_b64_tr_b16 a[220:221], v33 offset:20480
    v_mfma_f32_16x16x32_bf16 v[178:181], a[228:231], a[44:47], v[178:181]
    ds_read_b64_tr_b16 a[222:223], v33 offset:22528
    s_waitcnt lgkmcnt(8)
    v_mfma_f32_16x16x32_bf16 v[150:153], a[200:203], a[48:51], v[150:153]
    ds_read_b64_tr_b16 a[224:225], v32 offset:20480
    buffer_load_dwordx4 v80, s[28:31], s63 offen offset:2048 sc1 lds
    v_mfma_f32_16x16x32_bf16 v[158:161], a[200:203], a[52:55], v[158:161]
    ds_read_b64_tr_b16 a[226:227], v32 offset:22528
    s_add_u32 m0, s100, 126976
    v_mfma_f32_16x16x32_bf16 v[166:169], a[204:207], a[48:51], v[166:169]
    ds_read_b64_tr_b16 a[228:229], v34 offset:20480
    v_mfma_f32_16x16x32_bf16 v[174:177], a[204:207], a[52:55], v[174:177]
    ds_read_b64_tr_b16 a[230:231], v34 offset:22528
    s_waitcnt lgkmcnt(8)
    v_mfma_f32_16x16x32_bf16 v[154:157], a[208:211], a[48:51], v[154:157]
    s_barrier
    ds_read_b64_tr_b16 a[200:201], v31 offset:32768
    buffer_load_dwordx4 v69, s[28:31], s62 offen sc1 lds
    v_mfma_f32_16x16x32_bf16 v[162:165], a[208:211], a[52:55], v[162:165]
    ds_read_b64_tr_b16 a[202:203], v31 offset:34816
    s_add_u32 m0, s58, 110592
    v_mfma_f32_16x16x32_bf16 v[170:173], a[212:215], a[48:51], v[170:173]
    ds_read_b64_tr_b16 a[204:205], v33 offset:32768
    v_mfma_f32_16x16x32_bf16 v[178:181], a[212:215], a[52:55], v[178:181]
    ds_read_b64_tr_b16 a[206:207], v33 offset:34816
    s_waitcnt lgkmcnt(8)
    v_mfma_f32_16x16x32_bf16 v[150:153], a[216:219], a[56:59], v[150:153]
    ds_read_b64_tr_b16 a[208:209], v32 offset:32768
    buffer_load_dwordx4 v67, s[28:31], s62 offen sc1 lds
    v_mfma_f32_16x16x32_bf16 v[158:161], a[216:219], a[60:63], v[158:161]
    ds_read_b64_tr_b16 a[210:211], v32 offset:34816
    v_mfma_f32_16x16x32_bf16 v[166:169], a[220:223], a[56:59], v[166:169]
    ds_read_b64_tr_b16 a[212:213], v34 offset:32768
    v_mfma_f32_16x16x32_bf16 v[174:177], a[220:223], a[60:63], v[174:177]
    ds_read_b64_tr_b16 a[214:215], v34 offset:34816
    s_waitcnt lgkmcnt(8)
    v_mfma_f32_16x16x32_bf16 v[154:157], a[224:227], a[56:59], v[154:157]
    ds_read_b64_tr_b16 a[216:217], v31 offset:36864
    buffer_load_dwordx4 v67, s[28:31], s62 offen offset:1024 sc1 lds
    v_mfma_f32_16x16x32_bf16 v[162:165], a[224:227], a[60:63], v[162:165]
    ds_read_b64_tr_b16 a[218:219], v31 offset:38912
    v_mfma_f32_16x16x32_bf16 v[170:173], a[228:231], a[56:59], v[170:173]
    ds_read_b64_tr_b16 a[220:221], v33 offset:36864
    buffer_load_dwordx4 v68, s[28:31], s62 offen offset:2048 sc1 lds
    v_mfma_f32_16x16x32_bf16 v[178:181], a[228:231], a[60:63], v[178:181]
    ds_read_b64_tr_b16 a[222:223], v33 offset:38912
    s_waitcnt lgkmcnt(8)
    v_mfma_f32_16x16x32_bf16 v[150:153], a[200:203], a[64:67], v[150:153]
    ds_read_b64_tr_b16 a[224:225], v32 offset:36864
    v_mfma_f32_16x16x32_bf16 v[158:161], a[200:203], a[68:71], v[158:161]
    ds_read_b64_tr_b16 a[226:227], v32 offset:38912
    v_mfma_f32_16x16x32_bf16 v[166:169], a[204:207], a[64:67], v[166:169]
    ds_read_b64_tr_b16 a[228:229], v34 offset:36864
    buffer_load_dwordx4 v68, s[28:31], s62 offen offset:3072 sc1 lds
    v_mfma_f32_16x16x32_bf16 v[174:177], a[204:207], a[68:71], v[174:177]
    ds_read_b64_tr_b16 a[230:231], v34 offset:38912
    s_waitcnt lgkmcnt(8)
    v_mfma_f32_16x16x32_bf16 v[154:157], a[208:211], a[64:67], v[154:157]
    s_xor_b32 s37, s37, 1024
    s_mov_b32 s14, 0
    s_load_dword s14, s[28:29], s37
    ds_read_b64_tr_b16 a[200:201], v31 offset:49152
    s_add_u32 m0, s59, 131072
    v_mfma_f32_16x16x32_bf16 v[162:165], a[208:211], a[68:71], v[162:165]
    ds_read_b64_tr_b16 a[202:203], v31 offset:51200
    s_add_u32 s63, s63, 12288
    v_mfma_f32_16x16x32_bf16 v[170:173], a[212:215], a[64:67], v[170:173]
    ds_read_b64_tr_b16 a[204:205], v33 offset:49152
    s_cmp_eq_u32 s63, 86016
    s_cselect_b32 s63, 0, s63
    buffer_load_dwordx4 v80, s[28:31], s63 offen sc1 lds
    v_mfma_f32_16x16x32_bf16 v[178:181], a[212:215], a[68:71], v[178:181]
    ds_read_b64_tr_b16 a[206:207], v33 offset:51200
    s_waitcnt lgkmcnt(8)
    v_mfma_f32_16x16x32_bf16 v[150:153], a[216:219], a[72:75], v[150:153]
    ds_read_b64_tr_b16 a[208:209], v32 offset:49152
    buffer_load_dwordx4 v80, s[28:31], s63 offen offset:1024 sc1 lds
    v_mfma_f32_16x16x32_bf16 v[158:161], a[216:219], a[76:79], v[158:161]
    ds_read_b64_tr_b16 a[210:211], v32 offset:51200
    v_mfma_f32_16x16x32_bf16 v[166:169], a[220:223], a[72:75], v[166:169]
    ds_read_b64_tr_b16 a[212:213], v34 offset:49152
    v_mfma_f32_16x16x32_bf16 v[174:177], a[220:223], a[76:79], v[174:177]
    ds_read_b64_tr_b16 a[214:215], v34 offset:51200
    s_waitcnt lgkmcnt(8)
    v_mfma_f32_16x16x32_bf16 v[154:157], a[224:227], a[72:75], v[154:157]
    ds_read_b64_tr_b16 a[216:217], v31 offset:53248
    buffer_load_dwordx4 v80, s[28:31], s63 offen offset:2048 sc1 lds
    v_mfma_f32_16x16x32_bf16 v[162:165], a[224:227], a[76:79], v[162:165]
    ds_read_b64_tr_b16 a[218:219], v31 offset:55296
    s_add_u32 m0, s100, 159744
    v_mfma_f32_16x16x32_bf16 v[170:173], a[228:231], a[72:75], v[170:173]
    ds_read_b64_tr_b16 a[220:221], v33 offset:53248
    s_add_u32 s62, s62, 262144
    v_mfma_f32_16x16x32_bf16 v[178:181], a[228:231], a[76:79], v[178:181]
    ds_read_b64_tr_b16 a[222:223], v33 offset:55296
    s_waitcnt lgkmcnt(8)
    v_mfma_f32_16x16x32_bf16 v[150:153], a[200:203], a[80:83], v[150:153]
    ds_read_b64_tr_b16 a[224:225], v32 offset:53248
    s_cmp_eq_u32 s62, 1835008
    v_mfma_f32_16x16x32_bf16 v[158:161], a[200:203], a[84:87], v[158:161]
    ds_read_b64_tr_b16 a[226:227], v32 offset:55296
    s_cselect_b32 s62, 0, s62
    buffer_load_dwordx4 v69, s[28:31], s62 offen sc1 lds
    v_mfma_f32_16x16x32_bf16 v[166:169], a[204:207], a[80:83], v[166:169]
    ds_read_b64_tr_b16 a[228:229], v34 offset:53248
    s_add_u32 m0, s58, 143360
    v_mfma_f32_16x16x32_bf16 v[174:177], a[204:207], a[84:87], v[174:177]
    ds_read_b64_tr_b16 a[230:231], v34 offset:55296
    s_waitcnt lgkmcnt(8)
    v_mfma_f32_16x16x32_bf16 v[154:157], a[208:211], a[80:83], v[154:157]
    s_waitcnt vmcnt(12)
    s_barrier
    ds_read_b64_tr_b16 a[200:201], v37 offset:0
    buffer_load_dwordx4 v67, s[28:31], s62 offen sc1 lds
    v_mfma_f32_16x16x32_bf16 v[162:165], a[208:211], a[84:87], v[162:165]
    ds_read_b64_tr_b16 a[202:203], v37 offset:2048
    v_mfma_f32_16x16x32_bf16 v[170:173], a[212:215], a[80:83], v[170:173]
    ds_read_b64_tr_b16 a[204:205], v38 offset:0
    buffer_load_dwordx4 v67, s[28:31], s62 offen offset:1024 sc1 lds
    v_mfma_f32_16x16x32_bf16 v[178:181], a[212:215], a[84:87], v[178:181]
    ds_read_b64_tr_b16 a[206:207], v38 offset:2048
    s_waitcnt lgkmcnt(8)
    v_mfma_f32_16x16x32_bf16 v[150:153], a[216:219], a[88:91], v[150:153]
    ds_read_b64_tr_b16 a[208:209], v37 offset:4096
    v_mfma_f32_16x16x32_bf16 v[158:161], a[216:219], a[92:95], v[158:161]
    ds_read_b64_tr_b16 a[210:211], v37 offset:6144
    v_mfma_f32_16x16x32_bf16 v[166:169], a[220:223], a[88:91], v[166:169]
    ds_read_b64_tr_b16 a[212:213], v38 offset:4096
    buffer_load_dwordx4 v68, s[28:31], s62 offen offset:2048 sc1 lds
    v_mfma_f32_16x16x32_bf16 v[174:177], a[220:223], a[92:95], v[174:177]
    ds_read_b64_tr_b16 a[214:215], v38 offset:6144
    s_waitcnt lgkmcnt(8)
    v_mfma_f32_16x16x32_bf16 v[154:157], a[224:227], a[88:91], v[154:157]
    ds_read_b64_tr_b16 a[216:217], v37 offset:16384
    v_mfma_f32_16x16x32_bf16 v[162:165], a[224:227], a[92:95], v[162:165]
    ds_read_b64_tr_b16 a[218:219], v37 offset:18432
    buffer_load_dwordx4 v68, s[28:31], s62 offen offset:3072 sc1 lds
    v_mfma_f32_16x16x32_bf16 v[170:173], a[228:231], a[88:91], v[170:173]
    ds_read_b64_tr_b16 a[220:221], v38 offset:16384
    s_add_u32 m0, s59, 0
    v_mfma_f32_16x16x32_bf16 v[178:181], a[228:231], a[92:95], v[178:181]
    ds_read_b64_tr_b16 a[222:223], v38 offset:18432
    s_waitcnt lgkmcnt(8)
    v_mfma_f32_16x16x32_bf16 v[166:169], a[200:203], a[96:99], v[166:169]
    s_cmp_ge_u32 s14, 2
    s_cbranch_scc0 L_pollin2
L_pollok2:
    v_xor_b32 v23, 131072, v23
    v_xor_b32 v22, 8192, v23
    ds_read_b64_tr_b16 a[224:225], v37 offset:20480
    buffer_load_dwordx4 v[214:217], v23, s[28:31], 0 offen offset:0 sc1
    v_mfma_f32_16x16x32_bf16 v[174:177], a[200:203], a[100:103], v[174:177]
    ds_read_b64_tr_b16 a[226:227], v37 offset:22528
    v_mfma_f32_16x16x32_bf16 v[170:173], a[204:207], a[96:99], v[170:173]
    ds_read_b64_tr_b16 a[228:229], v38 offset:20480
    buffer_load_dwordx4 v[218:221], v23, s[28:31], 0 offen offset:1024 sc1
    v_mfma_f32_16x16x32_bf16 v[178:181], a[204:207], a[100:103], v[178:181]
    ds_read_b64_tr_b16 a[230:231], v38 offset:22528
    s_waitcnt lgkmcnt(8)
    v_mfma_f32_16x16x32_bf16 v[166:169], a[208:211], a[104:107], v[166:169]
    ds_read_b64_tr_b16 a[200:201], v35 offset:0
    buffer_load_dwordx4 v[222:225], v22, s[28:31], 0 offen offset:2048 sc1
    v_mfma_f32_16x16x32_bf16 v[174:177], a[208:211], a[108:111], v[174:177]
    ds_read_b64_tr_b16 a[202:203], v35 offset:2048
    v_mfma_f32_16x16x32_bf16 v[170:173], a[212:215], a[104:107], v[170:173]
    ds_read_b64_tr_b16 a[204:205], v36 offset:0
    buffer_load_dwordx4 v[226:229], v22, s[28:31], 0 offen offset:3072 sc1
    v_mfma_f32_16x16x32_bf16 v[178:181], a[212:215], a[108:111], v[178:181]
    ds_read_b64_tr_b16 a[206:207], v36 offset:2048
    s_waitcnt lgkmcnt(8)
    v_mfma_f32_16x16x32_bf16 v[166:169], a[216:219], a[112:115], v[166:169]
    ds_read_b64_tr_b16 a[208:209], v35 offset:4096
    s_add_u32 s63, s63, 12288
    v_mfma_f32_16x16x32_bf16 v[174:177], a[216:219], a[116:119], v[174:177]
    ds_read_b64_tr_b16 a[210:211], v35 offset:6144
    s_cmp_eq_u32 s63, 86016
    s_cselect_b32 s63, 0, s63
    buffer_load_dwordx4 v80, s[28:31], s63 offen sc1 lds
    v_mfma_f32_16x16x32_bf16 v[170:173], a[220:223], a[112:115], v[170:173]
    ds_read_b64_tr_b16 a[212:213], v36 offset:4096
    v_mfma_f32_16x16x32_bf16 v[178:181], a[220:223], a[116:119], v[178:181]
    ds_read_b64_tr_b16 a[214:215], v36 offset:6144
    s_waitcnt lgkmcnt(8)
    v_mfma_f32_16x16x32_bf16 v[166:169], a[224:227], a[120:123], v[166:169]
    ds_read_b64_tr_b16 a[216:217], v35 offset:16384
    buffer_load_dwordx4 v80, s[28:31], s63 offen offset:1024 sc1 lds
    v_mfma_f32_16x16x32_bf16 v[174:177], a[224:227], a[124:127], v[174:177]
    ds_read_b64_tr_b16 a[218:219], v35 offset:18432
    v_mfma_f32_16x16x32_bf16 v[170:173], a[228:231], a[120:123], v[170:173]
    ds_read_b64_tr_b16 a[220:221], v36 offset:16384
    v_mfma_f32_16x16x32_bf16 v[178:181], a[228:231], a[124:127], v[178:181]
    ds_read_b64_tr_b16 a[222:223], v36 offset:18432
    s_waitcnt lgkmcnt(8)
    v_mfma_f32_16x16x32_bf16 v[150:153], a[200:203], a[96:99], v[150:153]
    ds_read_b64_tr_b16 a[224:225], v35 offset:20480
    buffer_load_dwordx4 v80, s[28:31], s63 offen offset:2048 sc1 lds
    v_mfma_f32_16x16x32_bf16 v[158:161], a[200:203], a[100:103], v[158:161]
    ds_read_b64_tr_b16 a[226:227], v35 offset:22528
    s_add_u32 m0, s100, 28672
    v_mfma_f32_16x16x32_bf16 v[154:157], a[204:207], a[96:99], v[154:157]
    ds_read_b64_tr_b16 a[228:229], v36 offset:20480
    s_add_u32 s62, s62, 262144
    v_mfma_f32_16x16x32_bf16 v[162:165], a[204:207], a[100:103], v[162:165]
    ds_read_b64_tr_b16 a[230:231], v36 offset:22528
    v_cvt_pk_bf16_f32 v166, v166, v167
    v_cvt_pk_bf16_f32 v167, v168, v169
    s_waitcnt lgkmcnt(8)
    v_mfma_f32_16x16x32_bf16 v[150:153], a[208:211], a[104:107], v[150:153]
    s_cmp_eq_u32 s62, 1835008
    s_cselect_b32 s62, 0, s62
    buffer_load_dwordx4 v69, s[28:31], s62 offen sc1 lds
    v_mfma_f32_16x16x32_bf16 v[158:161], a[208:211], a[108:111], v[158:161]
    s_add_u32 m0, s58, 12288
    v_cvt_pk_bf16_f32 v168, v170, v171
    v_cvt_pk_bf16_f32 v169, v172, v173
    ds_write_b128 v81, v[166:169] offset:32768
    v_mfma_f32_16x16x32_bf16 v[154:157], a[212:215], a[104:107], v[154:157]
    buffer_load_dwordx4 v67, s[28:31], s62 offen sc1 lds
    v_cvt_pk_bf16_f32 v174, v174, v175
    v_mfma_f32_16x16x32_bf16 v[162:165], a[212:215], a[108:111], v[162:165]
    v_cvt_pk_bf16_f32 v175, v176, v177
    s_waitcnt lgkmcnt(5)
    v_mfma_f32_16x16x32_bf16 v[150:153], a[216:219], a[112:115], v[150:153]
    v_cvt_pk_bf16_f32 v176, v178, v179
    v_cvt_pk_bf16_f32 v177, v180, v181
    v_mfma_f32_16x16x32_bf16 v[158:161], a[216:219], a[116:119], v[158:161]
    buffer_load_dwordx4 v67, s[28:31], s62 offen offset:1024 sc1 lds
    ds_write_b128 v81, v[174:177] offset:33792
    v_mfma_f32_16x16x32_bf16 v[154:157], a[220:223], a[112:115], v[154:157]
    v_mfma_f32_16x16x32_bf16 v[162:165], a[220:223], a[116:119], v[162:165]
    s_waitcnt lgkmcnt(2)
    v_mfma_f32_16x16x32_bf16 v[150:153], a[224:227], a[120:123], v[150:153]
    buffer_load_dwordx4 v68, s[28:31], s62 offen offset:2048 sc1 lds
    v_mfma_f32_16x16x32_bf16 v[158:161], a[224:227], a[124:127], v[158:161]
    v_mfma_f32_16x16x32_bf16 v[154:157], a[228:231], a[120:123], v[154:157]
    v_xor_b32 v81, 8192, v81
    s_waitcnt vmcnt(19) lgkmcnt(0)
    s_barrier
    ds_read_b128 v[182:185], v81 offset:32768
    ds_read_b128 v[186:189], v81 offset:33792
    v_mfma_f32_16x16x32_bf16 v[162:165], a[228:231], a[124:127], v[162:165]
    buffer_load_dwordx4 v68, s[28:31], s62 offen offset:3072 sc1 lds
    s_waitcnt vmcnt(11)
    v_mfma_f32_16x16x32_bf16 v[150:153], a[250:253], v[214:217], v[150:153]
    s_add_u32 m0, s59, 65536
    s_add_u32 s63, s63, 12288
L_pad1:
    s_cbranch_execz L_warm
    v_mfma_f32_16x16x32_bf16 v[154:157], a[248:251], v[214:217], v[154:157]
    s_cmp_eq_u32 s63, 86016
    s_cselect_b32 s63, 0, s63
    s_waitcnt vmcnt(10)
    v_mfma_f32_16x16x32_bf16 v[158:161], a[250:253], v[218:221], v[158:161]
    buffer_load_dwordx4 v80, s[28:31], s63 offen sc1 lds
    v_mfma_f32_16x16x32_bf16 v[162:165], a[248:251], v[218:221], v[162:165]
    s_waitcnt vmcnt(10)
    v_mfma_f32_16x16x32_bf16 v[150:153], a[250:253], v[222:225], v[150:153]
    v_mfma_f32_16x16x32_bf16 v[154:157], a[248:251], v[222:225], v[154:157]
    s_waitcnt vmcnt(9)
    v_mfma_f32_16x16x32_bf16 v[158:161], a[250:253], v[226:229], v[158:161]
    buffer_load_dwordx4 v80, s[28:31], s63 offen offset:1024 sc1 lds
    v_mfma_f32_16x16x32_bf16 v[162:165], a[248:251], v[226:229], v[162:165]
    s_waitcnt lgkmcnt(1)
    v_mfma_f32_16x16x32_bf16 v[150:153], a[250:253], v[182:185], v[150:153]
    v_mfma_f32_16x16x32_bf16 v[154:157], a[248:251], v[182:185], v[154:157]
    buffer_load_dwordx4 v80, s[28:31], s63 offen offset:2048 sc1 lds
    s_add_u32 m0, s100, 94208
    s_waitcnt lgkmcnt(0)
    v_mfma_f32_16x16x32_bf16 v[158:161], a[250:253], v[186:189], v[158:161]
    s_add_u32 s62, s62, 262144
    s_cmp_eq_u32 s62, 1835008
    v_mfma_f32_16x16x32_bf16 v[162:165], a[248:251], v[186:189], v[162:165]
    s_cselect_b32 s62, 0, s62
    v_pk_mul_f32 v[182:183], v[150:151], v[150:151]
    v_pk_mul_f32 v[184:185], v[152:153], v[152:153]
    v_pk_mul_f32 v[186:187], v[154:155], v[154:155]
    v_pk_mul_f32 v[188:189], v[156:157], v[156:157]
    v_pk_fma_f32 v[182:183], v[182:183], s[78:79], v[108:109]
    buffer_load_dwordx4 v69, s[28:31], s62 offen sc1 lds
    v_pk_fma_f32 v[184:185], v[184:185], s[78:79], v[108:109]
    v_pk_fma_f32 v[186:187], v[186:187], s[78:79], v[108:109]
    v_pk_fma_f32 v[188:189], v[188:189], s[78:79], v[108:109]
    v_pk_mul_f32 v[182:183], v[182:183], v[150:151]
    v_pk_mul_f32 v[184:185], v[184:185], v[152:153]
    v_pk_mul_f32 v[186:187], v[186:187], v[154:155]
    v_pk_mul_f32 v[188:189], v[188:189], v[156:157]
    v_exp_f32 v182, v182
    v_exp_f32 v183, v183
    v_exp_f32 v184, v184
    v_exp_f32 v185, v185
    s_add_u32 m0, s58, 77824
    s_nop 0
    buffer_load_dwordx4 v67, s[28:31], s62 offen sc1 lds
    v_exp_f32 v186, v186
    v_exp_f32 v187, v187
    v_exp_f32 v188, v188
    v_exp_f32 v189, v189
    v_pk_add_f32 v[182:183], v[182:183], s[80:81]
    v_pk_add_f32 v[184:185], v[184:185], s[80:81]
    v_pk_add_f32 v[186:187], v[186:187], s[80:81]
    v_pk_add_f32 v[188:189], v[188:189], s[80:81]
    v_rcp_f32 v182, v182
    buffer_load_dwordx4 v67, s[28:31], s62 offen offset:1024 sc1 lds
    v_rcp_f32 v183, v183
    v_rcp_f32 v184, v184
    v_rcp_f32 v185, v185
    v_rcp_f32 v186, v186
    v_rcp_f32 v187, v187
    v_rcp_f32 v188, v188
    v_rcp_f32 v189, v189
    buffer_load_dwordx4 v68, s[28:31], s62 offen offset:2048 sc1 lds
    v_pk_mul_f32 v[182:183], v[182:183], v[150:151]
    v_pk_mul_f32 v[184:185], v[184:185], v[152:153]
    v_pk_mul_f32 v[186:187], v[186:187], v[154:155]
    v_pk_mul_f32 v[188:189], v[188:189], v[156:157]
    v_cvt_pk_bf16_f32 v110, v182, v183
    v_cvt_pk_bf16_f32 v111, v184, v185
    v_cvt_pk_bf16_f32 v112, v186, v187
    v_cvt_pk_bf16_f32 v113, v188, v189
    v_pk_mul_f32 v[190:191], v[158:159], v[158:159]
    v_pk_mul_f32 v[192:193], v[160:161], v[160:161]
    v_pk_mul_f32 v[194:195], v[162:163], v[162:163]
    v_pk_mul_f32 v[196:197], v[164:165], v[164:165]
    v_pk_fma_f32 v[190:191], v[190:191], s[78:79], v[108:109]
    buffer_load_dwordx4 v68, s[28:31], s62 offen offset:3072 sc1 lds
    v_pk_fma_f32 v[192:193], v[192:193], s[78:79], v[108:109]
    v_pk_fma_f32 v[194:195], v[194:195], s[78:79], v[108:109]
    v_pk_fma_f32 v[196:197], v[196:197], s[78:79], v[108:109]
    v_pk_mul_f32 v[190:191], v[190:191], v[158:159]
    v_pk_mul_f32 v[192:193], v[192:193], v[160:161]
    v_pk_mul_f32 v[194:195], v[194:195], v[162:163]
    v_pk_mul_f32 v[196:197], v[196:197], v[164:165]
    v_exp_f32 v190, v190
    v_exp_f32 v191, v191
    v_exp_f32 v192, v192
    v_exp_f32 v193, v193
    v_exp_f32 v194, v194
    v_exp_f32 v195, v195
    v_exp_f32 v196, v196
    v_exp_f32 v197, v197
    v_pk_add_f32 v[190:191], v[190:191], s[80:81]
    v_pk_add_f32 v[192:193], v[192:193], s[80:81]
    v_pk_add_f32 v[194:195], v[194:195], s[80:81]
    v_pk_add_f32 v[196:197], v[196:197], s[80:81]
    v_rcp_f32 v190, v190
    v_rcp_f32 v191, v191
    v_rcp_f32 v192, v192
    v_rcp_f32 v193, v193
    v_rcp_f32 v194, v194
    v_rcp_f32 v195, v195
    v_rcp_f32 v196, v196
    v_rcp_f32 v197, v197
    v_pk_mul_f32 v[190:191], v[190:191], v[158:159]
    v_pk_mul_f32 v[192:193], v[192:193], v[160:161]
    v_pk_mul_f32 v[194:195], v[194:195], v[162:163]
    v_pk_mul_f32 v[196:197], v[196:197], v[164:165]
    v_cvt_pk_bf16_f32 v114, v190, v191
    v_cvt_pk_bf16_f32 v115, v192, v193
    v_cvt_pk_bf16_f32 v116, v194, v195
    v_cvt_pk_bf16_f32 v117, v196, v197
    ds_read_b64_tr_b16 a[180:181], v72 offset:32768
    ds_read_b64_tr_b16 a[182:183], v72 offset:33024
    ds_read_b128 a[128:131], v53 offset:32768
    ds_read_b64_tr_b16 a[184:185], v72 offset:33792
    ds_read_b64_tr_b16 a[186:187], v72 offset:34048
    ds_read_b128 a[132:135], v53 offset:33792
    ds_read_b128 a[136:139], v53 offset:34816
    ds_read_b64_tr_b16 a[176:177], v73 offset:32768
    ds_read_b64_tr_b16 a[178:179], v73 offset:33024
    ds_read_b128 a[140:143], v53 offset:35840
    ds_read_b128 a[144:147], v53 offset:36864
    ds_read_b128 a[148:151], v53 offset:37888
    buffer_store_dwordx4 v[110:113], v4, s[28:31], s67 offen offset:0 sc1
    buffer_store_dwordx4 v[114:117], v4, s[28:31], s67 offen offset:1024 sc1
L_q:
    s_waitcnt lgkmcnt(6)
    v_mfma_f32_16x16x32_bf16 v[182:185], a[128:131], a[180:183], 0
    ds_read_b64_tr_b16 a[192:193], v72 offset:34816
    v_mfma_f32_16x16x32_bf16 v[190:193], a[128:131], a[184:187], 0
    ds_read_b64_tr_b16 a[194:195], v72 offset:35072
    v_mfma_f32_16x16x32_bf16 v[186:189], a[132:135], a[180:183], 0
    ds_read_b128 a[152:155], v53 offset:38912
    v_mfma_f32_16x16x32_bf16 v[194:197], a[132:135], a[184:187], 0
    ds_read_b64_tr_b16 a[196:197], v72 offset:35840
    s_waitcnt lgkmcnt(4)
    v_mfma_f32_16x16x32_bf16 v[206:209], a[136:139], a[180:183], 0
    ds_read_b64_tr_b16 a[198:199], v72 offset:36096
    v_mfma_f32_16x16x32_bf16 v[214:217], a[136:139], a[184:187], 0
    ds_read_b128 a[156:159], v53 offset:39936
    v_mfma_f32_16x16x32_bf16 v[198:201], a[136:139], a[176:179], 0
    ds_read_b128 a[160:163], v53 offset:40960
    v_mfma_f32_16x16x32_bf16 v[210:213], a[140:143], a[180:183], 0
    ds_read_b64_tr_b16 a[188:189], v73 offset:34816
    v_mfma_f32_16x16x32_bf16 v[218:221], a[140:143], a[184:187], 0
    ds_read_b64_tr_b16 a[190:191], v73 offset:35072
    v_mfma_f32_16x16x32_bf16 v[202:205], a[140:143], a[176:179], 0
    ds_read_b128 a[164:167], v53 offset:41984
    v_mfma_f32_16x16x32_bf16 v[230:233], a[180:183], a[144:147], 0
    ds_read_b128 a[168:171], v53 offset:43008
    v_mfma_f32_16x16x32_bf16 v[238:241], a[184:187], a[144:147], 0
    ds_read_b128 a[172:175], v53 offset:44032
    v_mfma_f32_16x16x32_bf16 v[222:225], a[176:179], a[144:147], 0
    v_mfma_f32_16x16x32_bf16 v[234:237], a[180:183], a[148:151], 0
    v_mfma_f32_16x16x32_bf16 v[242:245], a[184:187], a[148:151], 0
    v_mfma_f32_16x16x32_bf16 v[226:229], a[176:179], a[148:151], 0
    s_waitcnt lgkmcnt(0)
    s_barrier
    v_mfma_f32_16x16x32_bf16 v[182:185], a[152:155], a[192:195], v[182:185]
    ds_read_b64_tr_b16 a[180:181], v74 offset:0
    s_add_u32 m0, s59, 32768
    v_mfma_f32_16x16x32_bf16 v[190:193], a[152:155], a[196:199], v[190:193]
    ds_read_b64_tr_b16 a[182:183], v74 offset:256
    s_add_u32 s63, s63, 12288
    v_mfma_f32_16x16x32_bf16 v[186:189], a[156:159], a[192:195], v[186:189]
    ds_read_b128 a[128:131], v54 offset:0
    s_cmp_eq_u32 s63, 86016
    v_mfma_f32_16x16x32_bf16 v[194:197], a[156:159], a[196:199], v[194:197]
    ds_read_b64_tr_b16 a[184:185], v74 offset:1024
    v_mfma_f32_16x16x32_bf16 v[206:209], a[160:163], a[192:195], v[206:209]
    ds_read_b64_tr_b16 a[186:187], v74 offset:1280
    s_cselect_b32 s63, 0, s63
    v_mfma_f32_16x16x32_bf16 v[214:217], a[160:163], a[196:199], v[214:217]
    ds_read_b128 a[132:135], v54 offset:1024
    buffer_load_dwordx4 v80, s[28:31], s63 offen sc1 lds
    v_mfma_f32_16x16x32_bf16 v[198:201], a[160:163], a[188:191], v[198:201]
    ds_read_b128 a[136:139], v54 offset:2048
    v_mfma_f32_16x16x32_bf16 v[210:213], a[164:167], a[192:195], v[210:213]
    ds_read_b64_tr_b16 a[176:177], v75 offset:0
    buffer_load_dwordx4 v80, s[28:31], s63 offen offset:1024 sc1 lds
    v_mfma_f32_16x16x32_bf16 v[218:221], a[164:167], a[196:199], v[218:221]
    ds_read_b64_tr_b16 a[178:179], v75 offset:256
    v_mfma_f32_16x16x32_bf16 v[202:205], a[164:167], a[188:191], v[202:205]
    ds_read_b128 a[140:143], v54 offset:3072
    v_mfma_f32_16x16x32_bf16 v[230:233], a[192:195], a[168:171], v[230:233]
    ds_read_b128 a[144:147], v54 offset:4096
    buffer_load_dwordx4 v80, s[28:31], s63 offen offset:2048 sc1 lds
    v_mfma_f32_16x16x32_bf16 v[238:241], a[196:199], a[168:171], v[238:241]
    ds_read_b128 a[148:151], v54 offset:5120
    s_add_u32 m0, s100, 61440
    v_mfma_f32_16x16x32_bf16 v[222:225], a[188:191], a[168:171], v[222:225]
    s_add_u32 s62, s62, 262144
    s_cmp_eq_u32 s62, 1835008
    v_mfma_f32_16x16x32_bf16 v[234:237], a[192:195], a[172:175], v[234:237]
    s_cselect_b32 s62, 0, s62
    buffer_load_dwordx4 v69, s[28:31], s62 offen sc1 lds
    v_mfma_f32_16x16x32_bf16 v[242:245], a[196:199], a[172:175], v[242:245]
    s_add_u32 m0, s58, 45056
    v_mfma_f32_16x16x32_bf16 v[226:229], a[188:191], a[172:175], v[226:229]
    s_waitcnt lgkmcnt(6)
    v_mfma_f32_16x16x32_bf16 v[182:185], a[128:131], a[180:183], v[182:185]
    ds_read_b64_tr_b16 a[192:193], v74 offset:2048
    buffer_load_dwordx4 v67, s[28:31], s62 offen sc1 lds
    v_mfma_f32_16x16x32_bf16 v[190:193], a[128:131], a[184:187], v[190:193]
    ds_read_b64_tr_b16 a[194:195], v74 offset:2304
    v_mfma_f32_16x16x32_bf16 v[186:189], a[132:135], a[180:183], v[186:189]
    ds_read_b128 a[152:155], v54 offset:6144
    v_mfma_f32_16x16x32_bf16 v[194:197], a[132:135], a[184:187], v[194:197]
    ds_read_b64_tr_b16 a[196:197], v74 offset:3072
    s_waitcnt lgkmcnt(4)
    v_mfma_f32_16x16x32_bf16 v[206:209], a[136:139], a[180:183], v[206:209]
    ds_read_b64_tr_b16 a[198:199], v74 offset:3328
    buffer_load_dwordx4 v67, s[28:31], s62 offen offset:1024 sc1 lds
    v_mfma_f32_16x16x32_bf16 v[214:217], a[136:139], a[184:187], v[214:217]
    ds_read_b128 a[156:159], v54 offset:7168
    v_mfma_f32_16x16x32_bf16 v[198:201], a[136:139], a[176:179], v[198:201]
    ds_read_b128 a[160:163], v54 offset:8192
    buffer_load_dwordx4 v68, s[28:31], s62 offen offset:2048 sc1 lds
    v_mfma_f32_16x16x32_bf16 v[210:213], a[140:143], a[180:183], v[210:213]
    ds_read_b64_tr_b16 a[188:189], v75 offset:2048
    v_mfma_f32_16x16x32_bf16 v[218:221], a[140:143], a[184:187], v[218:221]
    ds_read_b64_tr_b16 a[190:191], v75 offset:2304
    v_mfma_f32_16x16x32_bf16 v[202:205], a[140:143], a[176:179], v[202:205]
    ds_read_b128 a[164:167], v54 offset:9216
    buffer_load_dwordx4 v68, s[28:31], s62 offen offset:3072 sc1 lds
    v_mfma_f32_16x16x32_bf16 v[230:233], a[180:183], a[144:147], v[230:233]
    ds_read_b128 a[168:171], v54 offset:10240
    s_add_u32 m0, s59, 98304
    v_mfma_f32_16x16x32_bf16 v[238:241], a[184:187], a[144:147], v[238:241]
    ds_read_b128 a[172:175], v54 offset:11264
    s_add_u32 s63, s63, 12288
    v_mfma_f32_16x16x32_bf16 v[222:225], a[176:179], a[144:147], v[222:225]
    s_cmp_eq_u32 s63, 86016
    s_cselect_b32 s63, 0, s63
    v_mfma_f32_16x16x32_bf16 v[234:237], a[180:183], a[148:151], v[234:237]
    buffer_load_dwordx4 v80, s[28:31], s63 offen sc1 lds
    v_mfma_f32_16x16x32_bf16 v[242:245], a[184:187], a[148:151], v[242:245]
    v_mfma_f32_16x16x32_bf16 v[226:229], a[176:179], a[148:151], v[226:229]
    s_waitcnt vmcnt(9) lgkmcnt(0)
    s_barrier
    s_cmp_lg_u32 s48, 0
    s_cbranch_scc1 L_sig2
    s_atomic_add s36, s[28:29], s68
L_sig2:
    v_mfma_f32_16x16x32_bf16 v[182:185], a[152:155], a[192:195], v[182:185]
    ds_read_b64_tr_b16 a[180:181], v70 offset:0
    buffer_load_dwordx4 v80, s[28:31], s63 offen offset:1024 sc1 lds
    v_mfma_f32_16x16x32_bf16 v[190:193], a[152:155], a[196:199], v[190:193]
    ds_read_b64_tr_b16 a[182:183], v70 offset:256
    v_mfma_f32_16x16x32_bf16 v[186:189], a[156:159], a[192:195], v[186:189]
    ds_read_b128 a[128:131], v4 offset:0
    buffer_load_dwordx4 v80, s[28:31], s63 offen offset:2048 sc1 lds
    v_mfma_f32_16x16x32_bf16 v[194:197], a[156:159], a[196:199], v[194:197]
    ds_read_b64_tr_b16 a[184:185], v70 offset:1024
    v_mfma_f32_16x16x32_bf16 v[206:209], a[160:163], a[192:195], v[206:209]
    ds_read_b64_tr_b16 a[186:187], v70 offset:1280
    s_add_u32 m0, s100, 126976
    v_mfma_f32_16x16x32_bf16 v[214:217], a[160:163], a[196:199], v[214:217]
    ds_read_b128 a[132:135], v4 offset:1024
    s_add_u32 s62, s62, 262144
    v_mfma_f32_16x16x32_bf16 v[198:201], a[160:163], a[188:191], v[198:201]
    ds_read_b128 a[136:139], v4 offset:2048
    s_cmp_eq_u32 s62, 1835008
    v_mfma_f32_16x16x32_bf16 v[210:213], a[164:167], a[192:195], v[210:213]
    ds_read_b64_tr_b16 a[176:177], v71 offset:0
    s_cselect_b32 s62, 0, s62
    v_mfma_f32_16x16x32_bf16 v[218:221], a[164:167], a[196:199], v[218:221]
    ds_read_b64_tr_b16 a[178:179], v71 offset:256
    buffer_load_dwordx4 v69, s[28:31], s62 offen sc1 lds
    v_mfma_f32_16x16x32_bf16 v[202:205], a[164:167], a[188:191], v[202:205]
    ds_read_b128 a[140:143], v4 offset:3072
    s_add_u32 m0, s58, 110592
    v_mfma_f32_16x16x32_bf16 v[230:233], a[192:195], a[168:171], v[230:233]
    ds_read_b128 a[144:147], v4 offset:4096
    buffer_load_dwordx4 v67, s[28:31], s62 offen sc1 lds
    v_mfma_f32_16x16x32_bf16 v[238:241], a[196:199], a[168:171], v[238:241]
    ds_read_b128 a[148:151], v4 offset:5120
    v_mfma_f32_16x16x32_bf16 v[222:225], a[188:191], a[168:171], v[222:225]
    v_mfma_f32_16x16x32_bf16 v[234:237], a[192:195], a[172:175], v[234:237]
    buffer_load_dwordx4 v67, s[28:31], s62 offen offset:1024 sc1 lds
    v_mfma_f32_16x16x32_bf16 v[242:245], a[196:199], a[172:175], v[242:245]
    v_mfma_f32_16x16x32_bf16 v[226:229], a[188:191], a[172:175], v[226:229]
    s_waitcnt lgkmcnt(6)
    v_mfma_f32_16x16x32_bf16 v[182:185], a[128:131], a[180:183], v[182:185]
    ds_read_b64_tr_b16 a[192:193], v70 offset:2048
    buffer_load_dwordx4 v68, s[28:31], s62 offen offset:2048 sc1 lds
    v_mfma_f32_16x16x32_bf16 v[190:193], a[128:131], a[184:187], v[190:193]
    ds_read_b64_tr_b16 a[194:195], v70 offset:2304
    v_mfma_f32_16x16x32_bf16 v[186:189], a[132:135], a[180:183], v[186:189]
    ds_read_b128 a[152:155], v4 offset:6144
    v_mfma_f32_16x16x32_bf16 v[194:197], a[132:135], a[184:187], v[194:197]
    ds_read_b64_tr_b16 a[196:197], v70 offset:3072
    s_waitcnt lgkmcnt(4)
    v_mfma_f32_16x16x32_bf16 v[206:209], a[136:139], a[180:183], v[206:209]
    ds_read_b64_tr_b16 a[198:199], v70 offset:3328
    buffer_load_dwordx4 v68, s[28:31], s62 offen offset:3072 sc1 lds
    v_mfma_f32_16x16x32_bf16 v[214:217], a[136:139], a[184:187], v[214:217]
    ds_read_b128 a[156:159], v4 offset:7168
    s_add_u32 m0, s59, 131072
    v_mfma_f32_16x16x32_bf16 v[198:201], a[136:139], a[176:179], v[198:201]
    ds_read_b128 a[160:163], v4 offset:8192
    s_add_u32 s63, s63, 12288
    v_mfma_f32_16x16x32_bf16 v[210:213], a[140:143], a[180:183], v[210:213]
    ds_read_b64_tr_b16 a[188:189], v71 offset:2048
    s_cmp_eq_u32 s63, 86016
    v_mfma_f32_16x16x32_bf16 v[218:221], a[140:143], a[184:187], v[218:221]
    ds_read_b64_tr_b16 a[190:191], v71 offset:2304
    s_cselect_b32 s63, 0, s63
    v_mfma_f32_16x16x32_bf16 v[202:205], a[140:143], a[176:179], v[202:205]
    ds_read_b128 a[164:167], v4 offset:9216
    buffer_load_dwordx4 v80, s[28:31], s63 offen sc1 lds
    v_mfma_f32_16x16x32_bf16 v[230:233], a[180:183], a[144:147], v[230:233]
    ds_read_b128 a[168:171], v4 offset:10240
    v_mfma_f32_16x16x32_bf16 v[238:241], a[184:187], a[144:147], v[238:241]
    ds_read_b128 a[172:175], v4 offset:11264
    buffer_load_dwordx4 v80, s[28:31], s63 offen offset:1024 sc1 lds
    v_mfma_f32_16x16x32_bf16 v[222:225], a[176:179], a[144:147], v[222:225]
    v_mfma_f32_16x16x32_bf16 v[234:237], a[180:183], a[148:151], v[234:237]
    v_mfma_f32_16x16x32_bf16 v[242:245], a[184:187], a[148:151], v[242:245]
    buffer_load_dwordx4 v80, s[28:31], s63 offen offset:2048 sc1 lds
    s_add_u32 m0, s100, 159744
    v_mfma_f32_16x16x32_bf16 v[226:229], a[176:179], a[148:151], v[226:229]
    s_add_u32 s62, s62, 262144
    ds_read_b32 v24, v4
    s_waitcnt lgkmcnt(1)
    s_barrier
    v_mfma_f32_16x16x32_bf16 v[182:185], a[152:155], a[192:195], v[182:185]
    ds_read_b64_tr_b16 a[180:181], v72 offset:0
    s_cmp_eq_u32 s62, 1835008
    v_mfma_f32_16x16x32_bf16 v[190:193], a[152:155], a[196:199], v[190:193]
    ds_read_b64_tr_b16 a[182:183], v72 offset:256
    s_cselect_b32 s62, 0, s62
    v_mfma_f32_16x16x32_bf16 v[186:189], a[156:159], a[192:195], v[186:189]
    ds_read_b128 a[128:131], v53 offset:0
    buffer_load_dwordx4 v69, s[28:31], s62 offen sc1 lds
    v_mfma_f32_16x16x32_bf16 v[194:197], a[156:159], a[196:199], v[194:197]
    ds_read_b64_tr_b16 a[184:185], v72 offset:1024
    v_mfma_f32_16x16x32_bf16 v[206:209], a[160:163], a[192:195], v[206:209]
    ds_read_b64_tr_b16 a[186:187], v72 offset:1280
    s_add_u32 m0, s58, 143360
    v_mfma_f32_16x16x32_bf16 v[214:217], a[160:163], a[196:199], v[214:217]
    ds_read_b128 a[132:135], v53 offset:1024
    buffer_load_dwordx4 v67, s[28:31], s62 offen sc1 lds
    v_mfma_f32_16x16x32_bf16 v[198:201], a[160:163], a[188:191], v[198:201]
    ds_read_b128 a[136:139], v53 offset:2048
    v_mfma_f32_16x16x32_bf16 v[210:213], a[164:167], a[192:195], v[210:213]
    ds_read_b64_tr_b16 a[176:177], v73 offset:0
    buffer_load_dwordx4 v67, s[28:31], s62 offen offset:1024 sc1 lds
    v_mfma_f32_16x16x32_bf16 v[218:221], a[164:167], a[196:199], v[218:221]
    ds_read_b64_tr_b16 a[178:179], v73 offset:256
    v_mfma_f32_16x16x32_bf16 v[202:205], a[164:167], a[188:191], v[202:205]
    ds_read_b128 a[140:143], v53 offset:3072
    v_mfma_f32_16x16x32_bf16 v[230:233], a[192:195], a[168:171], v[230:233]
    ds_read_b128 a[144:147], v53 offset:4096
    buffer_load_dwordx4 v68, s[28:31], s62 offen offset:2048 sc1 lds
    v_mfma_f32_16x16x32_bf16 v[238:241], a[196:199], a[168:171], v[238:241]
    ds_read_b128 a[148:151], v53 offset:5120
    v_mfma_f32_16x16x32_bf16 v[222:225], a[188:191], a[168:171], v[222:225]
    v_mfma_f32_16x16x32_bf16 v[234:237], a[192:195], a[172:175], v[234:237]
    buffer_load_dwordx4 v68, s[28:31], s62 offen offset:3072 sc1 lds
    s_add_u32 m0, s58, 0
    v_mfma_f32_16x16x32_bf16 v[242:245], a[196:199], a[172:175], v[242:245]
    v_mfma_f32_16x16x32_bf16 v[226:229], a[188:191], a[172:175], v[226:229]
    s_waitcnt lgkmcnt(6)
    v_mfma_f32_16x16x32_bf16 v[182:185], a[128:131], a[180:183], v[182:185]
    ds_read_b64_tr_b16 a[192:193], v72 offset:2048
    buffer_load_dwordx4 v59, s[24:27], s64 offen lds
    v_mfma_f32_16x16x32_bf16 v[190:193], a[128:131], a[184:187], v[190:193]
    ds_read_b64_tr_b16 a[194:195], v72 offset:2304
    v_mfma_f32_16x16x32_bf16 v[186:189], a[132:135], a[180:183], v[186:189]
    ds_read_b128 a[152:155], v53 offset:6144
    v_mfma_f32_16x16x32_bf16 v[194:197], a[132:135], a[184:187], v[194:197]
    ds_read_b64_tr_b16 a[196:197], v72 offset:3072
    s_waitcnt lgkmcnt(4)
    v_mfma_f32_16x16x32_bf16 v[206:209], a[136:139], a[180:183], v[206:209]
    ds_read_b64_tr_b16 a[198:199], v72 offset:3328
    buffer_load_dwordx4 v60, s[24:27], s64 offen offset:1024 lds
    v_mfma_f32_16x16x32_bf16 v[214:217], a[136:139], a[184:187], v[214:217]
    ds_read_b128 a[156:159], v53 offset:7168
    v_mfma_f32_16x16x32_bf16 v[198:201], a[136:139], a[176:179], v[198:201]
    ds_read_b128 a[160:163], v53 offset:8192
    v_mfma_f32_16x16x32_bf16 v[210:213], a[140:143], a[180:183], v[210:213]
    ds_read_b64_tr_b16 a[188:189], v73 offset:2048
    buffer_load_dwordx4 v61, s[24:27], s64 offen offset:2048 lds
    v_mfma_f32_16x16x32_bf16 v[218:221], a[140:143], a[184:187], v[218:221]
    ds_read_b64_tr_b16 a[190:191], v73 offset:2304
    v_mfma_f32_16x16x32_bf16 v[202:205], a[140:143], a[176:179], v[202:205]
    ds_read_b128 a[164:167], v53 offset:9216
    v_mfma_f32_16x16x32_bf16 v[230:233], a[180:183], a[144:147], v[230:233]
    ds_read_b128 a[168:171], v53 offset:10240
    buffer_load_dwordx4 v62, s[24:27], s64 offen offset:3072 lds
    v_mfma_f32_16x16x32_bf16 v[238:241], a[184:187], a[144:147], v[238:241]
    ds_read_b128 a[172:175], v53 offset:11264
    s_add_u32 m0, s58, 16384
    v_mfma_f32_16x16x32_bf16 v[222:225], a[176:179], a[144:147], v[222:225]
    v_xor_b32 v59, 128, v59
    v_mfma_f32_16x16x32_bf16 v[234:237], a[180:183], a[148:151], v[234:237]
    buffer_load_dwordx4 v59, s[24:27], s64 offen lds
    v_xor_b32 v60, 128, v60
    v_mfma_f32_16x16x32_bf16 v[242:245], a[184:187], a[148:151], v[242:245]
    v_mfma_f32_16x16x32_bf16 v[226:229], a[176:179], a[148:151], v[226:229]
    ds_read_b32 v24, v4
    s_waitcnt vmcnt(21) lgkmcnt(1)
    s_barrier
    v_mfma_f32_16x16x32_bf16 v[182:185], a[152:155], a[192:195], v[182:185]
    ds_read_b64_tr_b16 a[180:181], v70 offset:32768
    buffer_load_dwordx4 v60, s[24:27], s64 offen offset:1024 lds
    v_mfma_f32_16x16x32_bf16 v[190:193], a[152:155], a[196:199], v[190:193]
    ds_read_b64_tr_b16 a[182:183], v70 offset:33024
    v_xor_b32 v61, 128, v61
    v_mfma_f32_16x16x32_bf16 v[186:189], a[156:159], a[192:195], v[186:189]
    ds_read_b128 a[128:131], v4 offset:32768
    v_mfma_f32_16x16x32_bf16 v[194:197], a[156:159], a[196:199], v[194:197]
    ds_read_b64_tr_b16 a[184:185], v70 offset:33792
    v_mfma_f32_16x16x32_bf16 v[206:209], a[160:163], a[192:195], v[206:209]
    ds_read_b64_tr_b16 a[186:187], v70 offset:34048
    buffer_load_dwordx4 v61, s[24:27], s64 offen offset:2048 lds
    v_mfma_f32_16x16x32_bf16 v[214:217], a[160:163], a[196:199], v[214:217]
    ds_read_b128 a[132:135], v4 offset:33792
    v_xor_b32 v62, 128, v62
    v_mfma_f32_16x16x32_bf16 v[198:201], a[160:163], a[188:191], v[198:201]
    ds_read_b128 a[136:139], v4 offset:34816
    buffer_load_dwordx4 v62, s[24:27], s64 offen offset:3072 lds
    v_mfma_f32_16x16x32_bf16 v[210:213], a[164:167], a[192:195], v[210:213]
    ds_read_b64_tr_b16 a[176:177], v71 offset:32768
    s_add_u32 m0, s58, 65536
    v_mfma_f32_16x16x32_bf16 v[218:221], a[164:167], a[196:199], v[218:221]
    ds_read_b64_tr_b16 a[178:179], v71 offset:33024
    s_add_u32 s64, s64, 524288
    v_mfma_f32_16x16x32_bf16 v[202:205], a[164:167], a[188:191], v[202:205]
    ds_read_b128 a[140:143], v4 offset:35840
    s_cmp_eq_u32 s64, 3670016
    v_mfma_f32_16x16x32_bf16 v[230:233], a[192:195], a[168:171], v[230:233]
    ds_read_b128 a[144:147], v4 offset:36864
    s_cselect_b32 s64, 0, s64
    v_mfma_f32_16x16x32_bf16 v[238:241], a[196:199], a[168:171], v[238:241]
    ds_read_b128 a[148:151], v4 offset:37888
    buffer_load_dwordx4 v59, s[24:27], s64 offen lds
    v_mfma_f32_16x16x32_bf16 v[222:225], a[188:191], a[168:171], v[222:225]
    v_mfma_f32_16x16x32_bf16 v[234:237], a[192:195], a[172:175], v[234:237]
    buffer_load_dwordx4 v60, s[24:27], s64 offen offset:1024 lds
    v_mfma_f32_16x16x32_bf16 v[242:245], a[196:199], a[172:175], v[242:245]
    v_mfma_f32_16x16x32_bf16 v[226:229], a[188:191], a[172:175], v[226:229]
    s_waitcnt lgkmcnt(6)
    v_mfma_f32_16x16x32_bf16 v[182:185], a[128:131], a[180:183], v[182:185]
    ds_read_b64_tr_b16 a[192:193], v70 offset:34816
    buffer_load_dwordx4 v61, s[24:27], s64 offen offset:2048 lds
    v_mfma_f32_16x16x32_bf16 v[190:193], a[128:131], a[184:187], v[190:193]
    ds_read_b64_tr_b16 a[194:195], v70 offset:35072
    v_mfma_f32_16x16x32_bf16 v[186:189], a[132:135], a[180:183], v[186:189]
    ds_read_b128 a[152:155], v4 offset:38912
    v_mfma_f32_16x16x32_bf16 v[194:197], a[132:135], a[184:187], v[194:197]
    ds_read_b64_tr_b16 a[196:197], v70 offset:35840
    s_waitcnt lgkmcnt(4)
    v_mfma_f32_16x16x32_bf16 v[206:209], a[136:139], a[180:183], v[206:209]
    ds_read_b64_tr_b16 a[198:199], v70 offset:36096
    buffer_load_dwordx4 v62, s[24:27], s64 offen offset:3072 lds
    v_mfma_f32_16x16x32_bf16 v[214:217], a[136:139], a[184:187], v[214:217]
    ds_read_b128 a[156:159], v4 offset:39936
    s_add_u32 m0, s58, 81920
    v_mfma_f32_16x16x32_bf16 v[198:201], a[136:139], a[176:179], v[198:201]
    ds_read_b128 a[160:163], v4 offset:40960
    s_add_u32 s64, s64, 524288
    v_mfma_f32_16x16x32_bf16 v[210:213], a[140:143], a[180:183], v[210:213]
    ds_read_b64_tr_b16 a[188:189], v71 offset:34816
    s_cmp_eq_u32 s64, 3670016
    v_mfma_f32_16x16x32_bf16 v[218:221], a[140:143], a[184:187], v[218:221]
    ds_read_b64_tr_b16 a[190:191], v71 offset:35072
    s_cselect_b32 s64, 0, s64
    v_mfma_f32_16x16x32_bf16 v[202:205], a[140:143], a[176:179], v[202:205]
    ds_read_b128 a[164:167], v4 offset:41984
    buffer_load_dwordx4 v59, s[24:27], s64 offen lds
    v_mfma_f32_16x16x32_bf16 v[230:233], a[180:183], a[144:147], v[230:233]
    ds_read_b128 a[168:171], v4 offset:43008
    v_mfma_f32_16x16x32_bf16 v[238:241], a[184:187], a[144:147], v[238:241]
    ds_read_b128 a[172:175], v4 offset:44032
    buffer_load_dwordx4 v60, s[24:27], s64 offen offset:1024 lds
    v_mfma_f32_16x16x32_bf16 v[222:225], a[176:179], a[144:147], v[222:225]
    v_mfma_f32_16x16x32_bf16 v[234:237], a[180:183], a[148:151], v[234:237]
    v_mfma_f32_16x16x32_bf16 v[242:245], a[184:187], a[148:151], v[242:245]
    buffer_load_dwordx4 v61, s[24:27], s64 offen offset:2048 lds
    v_mfma_f32_16x16x32_bf16 v[226:229], a[176:179], a[148:151], v[226:229]
    ds_read_b32 v24, v4
    s_waitcnt vmcnt(23) lgkmcnt(1)
    s_barrier
    v_mfma_f32_16x16x32_bf16 v[182:185], a[152:155], a[192:195], v[182:185]
    ds_read_b64_tr_b16 a[180:181], v72 offset:32768
    v_mfma_f32_16x16x32_bf16 v[190:193], a[152:155], a[196:199], v[190:193]
    ds_read_b64_tr_b16 a[182:183], v72 offset:33024
    buffer_load_dwordx4 v62, s[24:27], s64 offen offset:3072 lds
    v_mfma_f32_16x16x32_bf16 v[186:189], a[156:159], a[192:195], v[186:189]
    ds_read_b128 a[128:131], v53 offset:32768
    s_add_u32 m0, s58, 32768
    v_mfma_f32_16x16x32_bf16 v[194:197], a[156:159], a[196:199], v[194:197]
    ds_read_b64_tr_b16 a[184:185], v72 offset:33792
    v_mfma_f32_16x16x32_bf16 v[206:209], a[160:163], a[192:195], v[206:209]
    ds_read_b64_tr_b16 a[186:187], v72 offset:34048
    s_add_u32 s64, s64, 524288
    v_mfma_f32_16x16x32_bf16 v[214:217], a[160:163], a[196:199], v[214:217]
    ds_read_b128 a[132:135], v53 offset:33792
    s_cmp_eq_u32 s64, 3670016
    v_mfma_f32_16x16x32_bf16 v[198:201], a[160:163], a[188:191], v[198:201]
    ds_read_b128 a[136:139], v53 offset:34816
    s_cselect_b32 s64, 0, s64
    v_mfma_f32_16x16x32_bf16 v[210:213], a[164:167], a[192:195], v[210:213]
    ds_read_b64_tr_b16 a[176:177], v73 offset:32768
    buffer_load_dwordx4 v59, s[24:27], s64 offen lds
    v_mfma_f32_16x16x32_bf16 v[218:221], a[164:167], a[196:199], v[218:221]
    ds_read_b64_tr_b16 a[178:179], v73 offset:33024
    v_mfma_f32_16x16x32_bf16 v[202:205], a[164:167], a[188:191], v[202:205]
    ds_read_b128 a[140:143], v53 offset:35840
    buffer_load_dwordx4 v60, s[24:27], s64 offen offset:1024 lds
    v_mfma_f32_16x16x32_bf16 v[230:233], a[192:195], a[168:171], v[230:233]
    ds_read_b128 a[144:147], v53 offset:36864
    v_mfma_f32_16x16x32_bf16 v[238:241], a[196:199], a[168:171], v[238:241]
    ds_read_b128 a[148:151], v53 offset:37888
    v_mfma_f32_16x16x32_bf16 v[222:225], a[188:191], a[168:171], v[222:225]
    buffer_load_dwordx4 v61, s[24:27], s64 offen offset:2048 lds
    v_mfma_f32_16x16x32_bf16 v[234:237], a[192:195], a[172:175], v[234:237]
    v_mfma_f32_16x16x32_bf16 v[242:245], a[196:199], a[172:175], v[242:245]
    v_mfma_f32_16x16x32_bf16 v[226:229], a[188:191], a[172:175], v[226:229]
    buffer_load_dwordx4 v62, s[24:27], s64 offen offset:3072 lds
    s_waitcnt lgkmcnt(6)
    v_mfma_f32_16x16x32_bf16 v[182:185], a[128:131], a[180:183], v[182:185]
    ds_read_b64_tr_b16 a[192:193], v72 offset:34816
    s_add_u32 m0, s58, 49152
    v_mfma_f32_16x16x32_bf16 v[190:193], a[128:131], a[184:187], v[190:193]
    ds_read_b64_tr_b16 a[194:195], v72 offset:35072
    s_add_u32 s64, s64, 524288
    v_mfma_f32_16x16x32_bf16 v[186:189], a[132:135], a[180:183], v[186:189]
    ds_read_b128 a[152:155], v53 offset:38912
    s_cmp_eq_u32 s64, 3670016
    v_mfma_f32_16x16x32_bf16 v[194:197], a[132:135], a[184:187], v[194:197]
    ds_read_b64_tr_b16 a[196:197], v72 offset:35840
    s_waitcnt lgkmcnt(4)
    v_mfma_f32_16x16x32_bf16 v[206:209], a[136:139], a[180:183], v[206:209]
    ds_read_b64_tr_b16 a[198:199], v72 offset:36096
    s_cselect_b32 s64, 0, s64
    v_mfma_f32_16x16x32_bf16 v[214:217], a[136:139], a[184:187], v[214:217]
    ds_read_b128 a[156:159], v53 offset:39936
    buffer_load_dwordx4 v59, s[24:27], s64 offen lds
    v_mfma_f32_16x16x32_bf16 v[198:201], a[136:139], a[176:179], v[198:201]
    ds_read_b128 a[160:163], v53 offset:40960
    v_mfma_f32_16x16x32_bf16 v[210:213], a[140:143], a[180:183], v[210:213]
    ds_read_b64_tr_b16 a[188:189], v73 offset:34816
    buffer_load_dwordx4 v60, s[24:27], s64 offen offset:1024 lds
    v_mfma_f32_16x16x32_bf16 v[218:221], a[140:143], a[184:187], v[218:221]
    ds_read_b64_tr_b16 a[190:191], v73 offset:35072
    v_mfma_f32_16x16x32_bf16 v[202:205], a[140:143], a[176:179], v[202:205]
    ds_read_b128 a[164:167], v53 offset:41984
L_pad2:
    s_cbranch_execz L_warm
    v_mfma_f32_16x16x32_bf16 v[230:233], a[180:183], a[144:147], v[230:233]
    ds_read_b128 a[168:171], v53 offset:43008
    buffer_load_dwordx4 v61, s[24:27], s64 offen offset:2048 lds
    v_mfma_f32_16x16x32_bf16 v[238:241], a[184:187], a[144:147], v[238:241]
    ds_read_b128 a[172:175], v53 offset:44032
    v_mfma_f32_16x16x32_bf16 v[222:225], a[176:179], a[144:147], v[222:225]
    v_mfma_f32_16x16x32_bf16 v[234:237], a[180:183], a[148:151], v[234:237]
    buffer_load_dwordx4 v62, s[24:27], s64 offen offset:3072 lds
    v_mfma_f32_16x16x32_bf16 v[242:245], a[184:187], a[148:151], v[242:245]
    v_mfma_f32_16x16x32_bf16 v[226:229], a[176:179], a[148:151], v[226:229]
    ds_read_b32 v24, v4
    s_waitcnt vmcnt(24) lgkmcnt(1)
    s_barrier
    s_mov_b32 s14, 0
    s_load_dword s14, s[28:29], s38
    v_mfma_f32_16x16x32_bf16 v[182:185], a[152:155], a[192:195], v[182:185]
    ds_read_b64_tr_b16 a[180:181], v74 offset:0
    s_add_u32 m0, s58, 98304
    v_mfma_f32_16x16x32_bf16 v[190:193], a[152:155], a[196:199], v[190:193]
    ds_read_b64_tr_b16 a[182:183], v74 offset:256
    s_add_u32 s64, s64, 524288
    v_mfma_f32_16x16x32_bf16 v[186:189], a[156:159], a[192:195], v[186:189]
    ds_read_b128 a[128:131], v54 offset:0
    s_cmp_eq_u32 s64, 3670016
    v_mfma_f32_16x16x32_bf16 v[194:197], a[156:159], a[196:199], v[194:197]
    ds_read_b64_tr_b16 a[184:185], v74 offset:1024
    v_mfma_f32_16x16x32_bf16 v[206:209], a[160:163], a[192:195], v[206:209]
    ds_read_b64_tr_b16 a[186:187], v74 offset:1280
    s_cselect_b32 s64, 0, s64
    v_mfma_f32_16x16x32_bf16 v[214:217], a[160:163], a[196:199], v[214:217]
    ds_read_b128 a[132:135], v54 offset:1024
    buffer_load_dwordx4 v59, s[24:27], s64 offen lds
    v_mfma_f32_16x16x32_bf16 v[198:201], a[160:163], a[188:191], v[198:201]
    ds_read_b128 a[136:139], v54 offset:2048
    v_mfma_f32_16x16x32_bf16 v[210:213], a[164:167], a[192:195], v[210:213]
    ds_read_b64_tr_b16 a[176:177], v75 offset:0
    buffer_load_dwordx4 v60, s[24:27], s64 offen offset:1024 lds
    v_mfma_f32_16x16x32_bf16 v[218:221], a[164:167], a[196:199], v[218:221]
    ds_read_b64_tr_b16 a[178:179], v75 offset:256
    v_mfma_f32_16x16x32_bf16 v[202:205], a[164:167], a[188:191], v[202:205]
    ds_read_b128 a[140:143], v54 offset:3072
    v_mfma_f32_16x16x32_bf16 v[230:233], a[192:195], a[168:171], v[230:233]
    ds_read_b128 a[144:147], v54 offset:4096
    buffer_load_dwordx4 v61, s[24:27], s64 offen offset:2048 lds
    v_mfma_f32_16x16x32_bf16 v[238:241], a[196:199], a[168:171], v[238:241]
    ds_read_b128 a[148:151], v54 offset:5120
    v_mfma_f32_16x16x32_bf16 v[222:225], a[188:191], a[168:171], v[222:225]
    v_mfma_f32_16x16x32_bf16 v[234:237], a[192:195], a[172:175], v[234:237]
    buffer_load_dwordx4 v62, s[24:27], s64 offen offset:3072 lds
    s_add_u32 m0, s58, 114688
    v_mfma_f32_16x16x32_bf16 v[242:245], a[196:199], a[172:175], v[242:245]
    s_add_u32 s64, s64, 524288
    s_cmp_eq_u32 s64, 3670016
    v_mfma_f32_16x16x32_bf16 v[226:229], a[188:191], a[172:175], v[226:229]
    s_cselect_b32 s64, 0, s64
    s_waitcnt lgkmcnt(6)
    v_mfma_f32_16x16x32_bf16 v[182:185], a[128:131], a[180:183], v[182:185]
    ds_read_b64_tr_b16 a[192:193], v74 offset:2048
    buffer_load_dwordx4 v59, s[24:27], s64 offen lds
    v_mfma_f32_16x16x32_bf16 v[190:193], a[128:131], a[184:187], v[190:193]
    ds_read_b64_tr_b16 a[194:195], v74 offset:2304
    v_mfma_f32_16x16x32_bf16 v[186:189], a[132:135], a[180:183], v[186:189]
    ds_read_b128 a[152:155], v54 offset:6144
    v_mfma_f32_16x16x32_bf16 v[194:197], a[132:135], a[184:187], v[194:197]
    ds_read_b64_tr_b16 a[196:197], v74 offset:3072
    s_waitcnt lgkmcnt(4)
    v_mfma_f32_16x16x32_bf16 v[206:209], a[136:139], a[180:183], v[206:209]
    ds_read_b64_tr_b16 a[198:199], v74 offset:3328
    buffer_load_dwordx4 v60, s[24:27], s64 offen offset:1024 lds
    v_mfma_f32_16x16x32_bf16 v[214:217], a[136:139], a[184:187], v[214:217]
    ds_read_b128 a[156:159], v54 offset:7168
    v_mfma_f32_16x16x32_bf16 v[198:201], a[136:139], a[176:179], v[198:201]
    ds_read_b128 a[160:163], v54 offset:8192
    buffer_load_dwordx4 v61, s[24:27], s64 offen offset:2048 lds
    v_mfma_f32_16x16x32_bf16 v[210:213], a[140:143], a[180:183], v[210:213]
    ds_read_b64_tr_b16 a[188:189], v75 offset:2048
    v_mfma_f32_16x16x32_bf16 v[218:221], a[140:143], a[184:187], v[218:221]
    ds_read_b64_tr_b16 a[190:191], v75 offset:2304
    v_mfma_f32_16x16x32_bf16 v[202:205], a[140:143], a[176:179], v[202:205]
    ds_read_b128 a[164:167], v54 offset:9216
    buffer_load_dwordx4 v62, s[24:27], s64 offen offset:3072 lds
    v_mfma_f32_16x16x32_bf16 v[230:233], a[180:183], a[144:147], v[230:233]
    ds_read_b128 a[168:171], v54 offset:10240
    v_mfma_f32_16x16x32_bf16 v[238:241], a[184:187], a[144:147], v[238:241]
    ds_read_b128 a[172:175], v54 offset:11264
    v_mfma_f32_16x16x32_bf16 v[222:225], a[176:179], a[144:147], v[222:225]
    v_mfma_f32_16x16x32_bf16 v[234:237], a[180:183], a[148:151], v[234:237]
    v_mfma_f32_16x16x32_bf16 v[242:245], a[184:187], a[148:151], v[242:245]
    v_mfma_f32_16x16x32_bf16 v[226:229], a[176:179], a[148:151], v[226:229]
    ds_read_b32 v24, v4
    s_waitcnt vmcnt(16) lgkmcnt(1)
    s_barrier
    s_cmp_ge_u32 s14, 7
    s_cbranch_scc0 L_pollin5
L_pollok5:
    v_mfma_f32_16x16x32_bf16 v[182:185], a[152:155], a[192:195], v[182:185]
    ds_read_b64_tr_b16 a[200:201], v31 offset:16384
    buffer_load_dwordx4 a[0:3], v79, s[28:31], s65 offen offset:0 sc1
    v_mfma_f32_16x16x32_bf16 v[190:193], a[152:155], a[196:199], v[190:193]
    ds_read_b64_tr_b16 a[202:203], v31 offset:18432
    v_mfma_f32_16x16x32_bf16 v[186:189], a[156:159], a[192:195], v[186:189]
    ds_read_b64_tr_b16 a[204:205], v33 offset:16384
    buffer_load_dwordx4 a[4:7], v79, s[28:31], s65 offen offset:1024 sc1
    v_mfma_f32_16x16x32_bf16 v[194:197], a[156:159], a[196:199], v[194:197]
    ds_read_b64_tr_b16 a[206:207], v33 offset:18432
    v_mfma_f32_16x16x32_bf16 v[206:209], a[160:163], a[192:195], v[206:209]
    ds_read_b64_tr_b16 a[208:209], v32 offset:16384
    v_mfma_f32_16x16x32_bf16 v[214:217], a[160:163], a[196:199], v[214:217]
    ds_read_b64_tr_b16 a[210:211], v32 offset:18432
    v_mfma_f32_16x16x32_bf16 v[198:201], a[160:163], a[188:191], v[198:201]
    ds_read_b64_tr_b16 a[212:213], v34 offset:16384
    buffer_load_dwordx4 a[8:11], v79, s[28:31], s65 offen offset:2048 sc1
    v_mfma_f32_16x16x32_bf16 v[210:213], a[164:167], a[192:195], v[210:213]
    ds_read_b64_tr_b16 a[214:215], v34 offset:18432
    v_mfma_f32_16x16x32_bf16 v[218:221], a[164:167], a[196:199], v[218:221]
    ds_read_b64_tr_b16 a[216:217], v31 offset:20480
    v_mfma_f32_16x16x32_bf16 v[202:205], a[164:167], a[188:191], v[202:205]
    ds_read_b64_tr_b16 a[218:219], v31 offset:22528
    buffer_load_dwordx4 a[12:15], v79, s[28:31], s65 offen offset:3072 sc1
    v_mfma_f32_16x16x32_bf16 v[230:233], a[192:195], a[168:171], v[230:233]
    ds_read_b64_tr_b16 a[220:221], v33 offset:20480
    s_add_u32 s65, s65, 8192
    v_mfma_f32_16x16x32_bf16 v[238:241], a[196:199], a[168:171], v[238:241]
    ds_read_b64_tr_b16 a[222:223], v33 offset:22528
    s_cmp_eq_u32 s65, 57344
    v_mfma_f32_16x16x32_bf16 v[222:225], a[188:191], a[168:171], v[222:225]
    s_cselect_b32 s65, 0, s65
    v_mfma_f32_16x16x32_bf16 v[234:237], a[192:195], a[172:175], v[234:237]
    buffer_load_dwordx4 a[16:19], v79, s[28:31], s65 offen offset:0 sc1
    v_mfma_f32_16x16x32_bf16 v[242:245], a[196:199], a[172:175], v[242:245]
    v_mfma_f32_16x16x32_bf16 v[226:229], a[188:191], a[172:175], v[226:229]
    v_cvt_pk_bf16_f32 v118, v182, v183
    v_cvt_pk_bf16_f32 v119, v184, v185
    v_cvt_pk_bf16_f32 v120, v186, v187
    buffer_load_dwordx4 a[20:23], v79, s[28:31], s65 offen offset:1024 sc1
    v_cvt_pk_bf16_f32 v121, v188, v189
    v_cvt_pk_bf16_f32 v122, v190, v191
    v_cvt_pk_bf16_f32 v123, v192, v193
    v_cvt_pk_bf16_f32 v124, v194, v195
    v_cvt_pk_bf16_f32 v125, v196, v197
    v_cvt_pk_bf16_f32 v130, v206, v207
    v_cvt_pk_bf16_f32 v131, v208, v209
    v_cvt_pk_bf16_f32 v132, v210, v211
    v_cvt_pk_bf16_f32 v133, v212, v213
    v_cvt_pk_bf16_f32 v134, v214, v215
    v_cvt_pk_bf16_f32 v135, v216, v217
    v_cvt_pk_bf16_f32 v136, v218, v219
    v_cvt_pk_bf16_f32 v137, v220, v221
    v_cvt_pk_bf16_f32 v126, v198, v199
    buffer_load_dwordx4 a[24:27], v79, s[28:31], s65 offen offset:2048 sc1
    v_cvt_pk_bf16_f32 v127, v200, v201
    v_cvt_pk_bf16_f32 v128, v202, v203
    v_cvt_pk_bf16_f32 v129, v204, v205
    v_mfma_f32_16x16x32_bf16 v[154:157], v[130:133], v[118:121], 0
    v_mfma_f32_16x16x32_bf16 v[158:161], v[130:133], v[122:125], 0
    v_mfma_f32_16x16x32_bf16 v[162:165], v[134:137], v[122:125], 0
    buffer_load_dwordx4 a[28:31], v79, s[28:31], s65 offen offset:3072 sc1
    v_mfma_f32_16x16x32_bf16 v[150:153], v[126:129], v[118:121], 0
    v_cvt_pk_bf16_f32 v166, v222, v223
    v_cvt_pk_bf16_f32 v167, v224, v225
    v_cvt_pk_bf16_f32 v168, v230, v231
    v_cvt_pk_bf16_f32 v169, v232, v233
    v_cvt_pk_bf16_f32 v170, v238, v239
    v_cvt_pk_bf16_f32 v171, v240, v241
    v_cndmask_b32 v250, v158, v159, s[70:71]
    v_cndmask_b32 v253, v162, v163, s[70:71]
    v_cndmask_b32 v250, v250, v253, s[72:73]
    s_add_u32 s65, s65, 8192
    s_cmp_eq_u32 s65, 57344
    s_cselect_b32 s65, 0, s65
    buffer_load_dwordx4 a[32:35], v79, s[28:31], s65 offen offset:0 sc1
    v_mul_f32 v250, v250, v29
    v_cndmask_b32 v251, v160, v161, s[70:71]
    v_cndmask_b32 v253, v164, v165, s[70:71]
    v_cndmask_b32 v251, v251, v253, s[74:75]
    v_mul_f32 v251, v251, v30
    v_cndmask_b32 v246, v150, v151, s[70:71]
    v_cndmask_b32 v246, v84, v246, s[76:77]
    v_cndmask_b32 v249, v154, v155, s[70:71]
    v_cndmask_b32 v246, v246, v249, s[72:73]
    v_mul_f32 v246, v246, v27
    v_cndmask_b32 v247, v152, v153, s[70:71]
    v_cndmask_b32 v247, v84, v247, s[76:77]
    v_cndmask_b32 v249, v156, v157, s[70:71]
    v_cndmask_b32 v247, v247, v249, s[74:75]
    buffer_load_dwordx4 a[36:39], v79, s[28:31], s65 offen offset:1024 sc1
    v_mul_f32 v247, v247, v28
    v_max_f32 v248, v246, v247
    v_max_f32 v252, v250, v251
    v_mov_b32 v249, v248
    v_mov_b32 v253, v252
    v_cvt_pk_bf16_f32 v172, v226, v227
    v_permlane16_swap_b32 v248, v249
    v_permlane16_swap_b32 v252, v253
    v_max_f32 v248, v248, v249
    v_max_f32 v252, v252, v253
    v_mov_b32 v249, v248
    v_mov_b32 v253, v252
    v_cvt_pk_bf16_f32 v173, v228, v229
    v_permlane32_swap_b32 v248, v249
    buffer_load_dwordx4 a[40:43], v79, s[28:31], s65 offen offset:2048 sc1
    v_permlane32_swap_b32 v252, v253
    v_max_f32 v248, v248, v249
    v_max_f32 v252, v252, v253
    v_mul_f32 v248, v25, v248
    v_mul_f32 v252, v26, v252
    v_fma_f32 v246, v246, v25, -v248
    v_fma_f32 v247, v247, v25, -v248
    v_fma_f32 v250, v250, v26, -v252
    v_fma_f32 v251, v251, v26, -v252
    v_exp_f32 v246, v246
    v_exp_f32 v247, v247
    v_exp_f32 v250, v250
    buffer_load_dwordx4 a[44:47], v79, s[28:31], s65 offen offset:3072 sc1
    v_exp_f32 v251, v251
    v_add_f32 v248, v246, v247
    v_add_f32 v252, v250, v251
    v_mov_b32 v249, v248
    v_mov_b32 v253, v252
    v_cvt_pk_bf16_f32 v174, v234, v235
    v_permlane16_swap_b32 v248, v249
    v_permlane16_swap_b32 v252, v253
    v_add_f32 v248, v248, v249
    v_add_f32 v252, v252, v253
    v_mov_b32 v249, v248
    v_mov_b32 v253, v252
    s_add_u32 m0, s58, 131072
    s_add_u32 s64, s64, 524288
    s_cmp_eq_u32 s64, 3670016
    s_cselect_b32 s64, 0, s64
    s_add_u32 s64, s64, 524288
    s_cmp_eq_u32 s64, 3670016
    s_cselect_b32 s64, 0, s64
    v_xor_b32 v59, 128, v59
    buffer_load_dwordx4 v59, s[24:27], s64 offen lds
    v_cvt_pk_bf16_f32 v175, v236, v237
    v_permlane32_swap_b32 v248, v249
    v_permlane32_swap_b32 v252, v253
    v_add_f32 v248, v248, v249
    v_add_f32 v252, v252, v253
    v_rcp_f32 v248, v248
    v_rcp_f32 v252, v252
    v_cvt_pk_bf16_f32 v176, v242, v243
    v_cvt_pk_bf16_f32 v177, v244, v245
    v_mul_f32 v246, v246, v27
    v_xor_b32 v60, 128, v60
    buffer_load_dwordx4 v60, s[24:27], s64 offen offset:1024 lds
    v_mul_f32 v247, v247, v28
    v_mul_f32 v250, v250, v29
    v_mul_f32 v251, v251, v30
    v_mul_f32 v246, v246, v248
    v_mul_f32 v247, v247, v248
    v_mul_f32 v250, v250, v252
    v_mul_f32 v251, v251, v252
    v_cvt_pk_bf16_f32 v246, v246, v246
    v_cvt_pk_bf16_f32 v247, v247, v247
    v_cvt_pk_bf16_f32 v250, v250, v250
    v_cvt_pk_bf16_f32 v251, v251, v251
    v_and_b32 v138, v246, v104
    v_and_b32 v139, v247, v105
    v_xor_b32 v61, 128, v61
    buffer_load_dwordx4 v61, s[24:27], s64 offen offset:2048 lds
    v_and_b32 v140, v246, v106
    v_and_b32 v141, v247, v107
    v_and_b32 v142, v250, v104
    v_and_b32 v143, v251, v105
    v_and_b32 v144, v250, v106
    v_and_b32 v145, v251, v107
    v_mfma_f32_16x16x32_bf16 v[182:185], v[166:169], v[138:141], 0
    v_mfma_f32_16x16x32_bf16 v[186:189], v[172:175], v[138:141], 0
    v_xor_b32 v62, 128, v62
    buffer_load_dwordx4 v62, s[24:27], s64 offen offset:3072 lds
    v_mfma_f32_16x16x32_bf16 v[190:193], v[168:171], v[142:145], 0
    v_mfma_f32_16x16x32_bf16 v[194:197], v[174:177], v[142:145], 0
    s_add_u32 s83, s82, 16384
    s_nop 1
    v_cvt_pk_bf16_f32 v110, v182, v183
    v_cvt_pk_bf16_f32 v111, v184, v185
    s_add_u32 m0, s58, 147456
    s_add_u32 s64, s64, 524288
    s_cmp_eq_u32 s64, 3670016
    s_cselect_b32 s64, 0, s64
    buffer_load_dwordx4 v59, s[24:27], s64 offen lds
    v_cvt_pk_bf16_f32 v112, v186, v187
    v_cvt_pk_bf16_f32 v113, v188, v189
    v_cvt_pk_bf16_f32 v114, v190, v191
    v_cvt_pk_bf16_f32 v115, v192, v193
    v_cvt_pk_bf16_f32 v116, v194, v195
    v_cvt_pk_bf16_f32 v117, v196, v197
    buffer_store_dwordx4 v[110:113], v4, s[28:31], s82 offen sc1
    buffer_store_dwordx4 v[114:117], v4, s[28:31], s83 offen sc1
    s_cmp_lg_u32 s56, 0
    s_cbranch_scc0 L_nof
L_f:
    s_waitcnt vmcnt(17) lgkmcnt(8)
    v_mfma_f32_16x16x32_bf16 v[182:185], a[0:3], a[200:203], 0
    ds_read_b64_tr_b16 a[224:225], v32 offset:20480
    s_add_u32 s65, s65, 8192
    s_cmp_eq_u32 s65, 57344
    s_cselect_b32 s65, 0, s65
    buffer_load_dwordx4 a[48:51], v79, s[28:31], s65 offen offset:0 sc1
    v_mfma_f32_16x16x32_bf16 v[186:189], a[4:7], a[200:203], 0
    ds_read_b64_tr_b16 a[226:227], v32 offset:22528
    v_lshlrev_b32 v93, 16, v93
    v_mfma_f32_16x16x32_bf16 v[238:241], a[0:3], a[204:207], 0
    ds_read_b64_tr_b16 a[228:229], v34 offset:20480
    buffer_load_dwordx4 a[52:55], v79, s[28:31], s65 offen offset:1024 sc1
    v_mfma_f32_16x16x32_bf16 v[242:245], a[4:7], a[204:207], 0
    ds_read_b64_tr_b16 a[230:231], v34 offset:22528
    s_waitcnt lgkmcnt(8)
    v_mfma_f32_16x16x32_bf16 v[190:193], a[0:3], a[208:211], 0
    ds_read_b64_tr_b16 a[200:201], v35 offset:0
    v_lshlrev_b32 v222, 16, v96
    v_mfma_f32_16x16x32_bf16 v[194:197], a[4:7], a[208:211], 0
    ds_read_b64_tr_b16 a[202:203], v35 offset:2048
    v_and_b32 v223, 0xffff0000, v96
    v_mfma_f32_16x16x32_bf16 v[246:249], a[0:3], a[212:215], 0
    ds_read_b64_tr_b16 a[204:205], v37 offset:0
    buffer_load_dwordx4 a[56:59], v79, s[28:31], s65 offen offset:2048 sc1
    v_mfma_f32_16x16x32_bf16 v[250:253], a[4:7], a[212:215], 0
    ds_read_b64_tr_b16 a[206:207], v37 offset:2048
    s_waitcnt vmcnt(18) lgkmcnt(8)
    v_mfma_f32_16x16x32_bf16 v[182:185], a[8:11], a[216:219], v[182:185]
    ds_read_b64_tr_b16 a[208:209], v36 offset:0
    v_add_f32 v222, v222, v93
    v_mfma_f32_16x16x32_bf16 v[186:189], a[12:15], a[216:219], v[186:189]
    ds_read_b64_tr_b16 a[210:211], v36 offset:2048
    buffer_load_dwordx4 a[60:63], v79, s[28:31], s65 offen offset:3072 sc1
    v_add_f32 v223, v223, v93
    v_mfma_f32_16x16x32_bf16 v[238:241], a[8:11], a[220:223], v[238:241]
    ds_read_b64_tr_b16 a[212:213], v38 offset:0
    s_add_u32 s65, s65, 8192
    v_mfma_f32_16x16x32_bf16 v[242:245], a[12:15], a[220:223], v[242:245]
    ds_read_b64_tr_b16 a[214:215], v38 offset:2048
    s_waitcnt lgkmcnt(8)
    v_mfma_f32_16x16x32_bf16 v[190:193], a[8:11], a[224:227], v[190:193]
    ds_read_b64_tr_b16 a[216:217], v35 offset:4096
    s_cmp_eq_u32 s65, 57344
    v_mfma_f32_16x16x32_bf16 v[194:197], a[12:15], a[224:227], v[194:197]
    ds_read_b64_tr_b16 a[218:219], v35 offset:6144
    s_cselect_b32 s65, 0, s65
    v_lshlrev_b32 v224, 16, v97
    v_mfma_f32_16x16x32_bf16 v[246:249], a[8:11], a[228:231], v[246:249]
    ds_read_b64_tr_b16 a[220:221], v37 offset:4096
    buffer_load_dwordx4 a[64:67], v79, s[28:31], s65 offen offset:0 sc1
    v_mfma_f32_16x16x32_bf16 v[250:253], a[12:15], a[228:231], v[250:253]
    ds_read_b64_tr_b16 a[222:223], v37 offset:6144
    s_waitcnt vmcnt(18) lgkmcnt(8)
    v_mfma_f32_16x16x32_bf16 v[182:185], a[16:19], a[200:203], v[182:185]
    ds_read_b64_tr_b16 a[224:225], v36 offset:4096
    buffer_load_dwordx4 a[68:71], v79, s[28:31], s65 offen offset:1024 sc1
    v_mfma_f32_16x16x32_bf16 v[186:189], a[20:23], a[200:203], v[186:189]
    ds_read_b64_tr_b16 a[226:227], v36 offset:6144
    v_and_b32 v225, 0xffff0000, v97
    v_mfma_f32_16x16x32_bf16 v[238:241], a[16:19], a[204:207], v[238:241]
    ds_read_b64_tr_b16 a[228:229], v38 offset:4096
    v_add_f32 v224, v224, v93
    v_mfma_f32_16x16x32_bf16 v[242:245], a[20:23], a[204:207], v[242:245]
    ds_read_b64_tr_b16 a[230:231], v38 offset:6144
    s_waitcnt lgkmcnt(8)
    v_mfma_f32_16x16x32_bf16 v[190:193], a[16:19], a[208:211], v[190:193]
    ds_read_b64_tr_b16 a[200:201], v35 offset:16384
    buffer_load_dwordx4 a[72:75], v79, s[28:31], s65 offen offset:2048 sc1
    v_mfma_f32_16x16x32_bf16 v[194:197], a[20:23], a[208:211], v[194:197]
    ds_read_b64_tr_b16 a[202:203], v35 offset:18432
    v_add_f32 v225, v225, v93
    v_mfma_f32_16x16x32_bf16 v[246:249], a[16:19], a[212:215], v[246:249]
    ds_read_b64_tr_b16 a[204:205], v37 offset:16384
    v_lshlrev_b32 v226, 16, v98
    v_mfma_f32_16x16x32_bf16 v[250:253], a[20:23], a[212:215], v[250:253]
    ds_read_b64_tr_b16 a[206:207], v37 offset:18432
    s_waitcnt vmcnt(18) lgkmcnt(8)
    v_mfma_f32_16x16x32_bf16 v[182:185], a[24:27], a[216:219], v[182:185]
    ds_read_b64_tr_b16 a[208:209], v36 offset:16384
    buffer_load_dwordx4 a[76:79], v79, s[28:31], s65 offen offset:3072 sc1
    v_mfma_f32_16x16x32_bf16 v[186:189], a[28:31], a[216:219], v[186:189]
    ds_read_b64_tr_b16 a[210:211], v36 offset:18432
    s_add_u32 s65, s65, 8192
    v_and_b32 v227, 0xffff0000, v98
    v_mfma_f32_16x16x32_bf16 v[238:241], a[24:27], a[220:223], v[238:241]
    ds_read_b64_tr_b16 a[212:213], v38 offset:16384
    s_cmp_eq_u32 s65, 57344
    v_mfma_f32_16x16x32_bf16 v[242:245], a[28:31], a[220:223], v[242:245]
    ds_read_b64_tr_b16 a[214:215], v38 offset:18432
    v_add_f32 v226, v226, v93
    s_waitcnt lgkmcnt(8)
    v_mfma_f32_16x16x32_bf16 v[190:193], a[24:27], a[224:227], v[190:193]
    ds_read_b64_tr_b16 a[216:217], v35 offset:20480
    s_cselect_b32 s65, 0, s65
    buffer_load_dwordx4 a[80:83], v79, s[28:31], s65 offen offset:0 sc1
    v_mfma_f32_16x16x32_bf16 v[194:197], a[28:31], a[224:227], v[194:197]
    ds_read_b64_tr_b16 a[218:219], v35 offset:22528
    v_add_f32 v227, v227, v93
    v_mfma_f32_16x16x32_bf16 v[246:249], a[24:27], a[228:231], v[246:249]
    ds_read_b64_tr_b16 a[220:221], v37 offset:20480
    buffer_load_dwordx4 a[84:87], v79, s[28:31], s65 offen offset:1024 sc1
    v_mfma_f32_16x16x32_bf16 v[250:253], a[28:31], a[228:231], v[250:253]
    ds_read_b64_tr_b16 a[222:223], v37 offset:22528
    v_lshlrev_b32 v228, 16, v99
    s_waitcnt vmcnt(19) lgkmcnt(8)
    v_mfma_f32_16x16x32_bf16 v[182:185], a[32:35], a[200:203], v[182:185]
    ds_read_b64_tr_b16 a[224:225], v36 offset:20480
    v_and_b32 v229, 0xffff0000, v99
    v_mfma_f32_16x16x32_bf16 v[186:189], a[36:39], a[200:203], v[186:189]
    ds_read_b64_tr_b16 a[226:227], v36 offset:22528
    buffer_load_dwordx4 a[88:91], v79, s[28:31], s65 offen offset:2048 sc1
    v_add_f32 v228, v228, v93
    v_mfma_f32_16x16x32_bf16 v[238:241], a[32:35], a[204:207], v[238:241]
    ds_read_b64_tr_b16 a[228:229], v38 offset:20480
    v_add_f32 v229, v229, v93
    v_mfma_f32_16x16x32_bf16 v[242:245], a[36:39], a[204:207], v[242:245]
    ds_read_b64_tr_b16 a[230:231], v38 offset:22528
    s_waitcnt lgkmcnt(8)
    v_mfma_f32_16x16x32_bf16 v[190:193], a[32:35], a[208:211], v[190:193]
    s_waitcnt vmcnt(11)
    s_barrier
    s_cmp_lg_u32 s48, 0
    s_cbranch_scc1 L_sig4
    s_atomic_add s36, s[28:29], s69
L_sig4:
    ds_read_b64_tr_b16 a[200:201], v31 offset:32768
    buffer_load_dwordx4 a[92:95], v79, s[28:31], s65 offen offset:3072 sc1
    v_mfma_f32_16x16x32_bf16 v[194:197], a[36:39], a[208:211], v[194:197]
    ds_read_b64_tr_b16 a[202:203], v31 offset:34816
    s_add_u32 s65, s65, 8192
    v_lshlrev_b32 v94, 16, v94
    v_mfma_f32_16x16x32_bf16 v[246:249], a[32:35], a[212:215], v[246:249]
    ds_read_b64_tr_b16 a[204:205], v33 offset:32768
    s_cmp_eq_u32 s65, 57344
    v_mfma_f32_16x16x32_bf16 v[250:253], a[36:39], a[212:215], v[250:253]
    ds_read_b64_tr_b16 a[206:207], v33 offset:34816
    s_waitcnt lgkmcnt(8)
    v_mfma_f32_16x16x32_bf16 v[182:185], a[40:43], a[216:219], v[182:185]
    ds_read_b64_tr_b16 a[208:209], v32 offset:32768
    s_cselect_b32 s65, 0, s65
    v_mfma_f32_16x16x32_bf16 v[186:189], a[44:47], a[216:219], v[186:189]
    ds_read_b64_tr_b16 a[210:211], v32 offset:34816
    buffer_load_dwordx4 a[96:99], v79, s[28:31], s65 offen offset:0 sc1
    v_lshlrev_b32 v230, 16, v100
    v_mfma_f32_16x16x32_bf16 v[238:241], a[40:43], a[220:223], v[238:241]
    ds_read_b64_tr_b16 a[212:213], v34 offset:32768
    v_and_b32 v231, 0xffff0000, v100
    v_mfma_f32_16x16x32_bf16 v[242:245], a[44:47], a[220:223], v[242:245]
    ds_read_b64_tr_b16 a[214:215], v34 offset:34816
    s_waitcnt lgkmcnt(8)
    v_mfma_f32_16x16x32_bf16 v[190:193], a[40:43], a[224:227], v[190:193]
    ds_read_b64_tr_b16 a[216:217], v31 offset:36864
    buffer_load_dwordx4 a[100:103], v79, s[28:31], s65 offen offset:1024 sc1
    v_mfma_f32_16x16x32_bf16 v[194:197], a[44:47], a[224:227], v[194:197]
    ds_read_b64_tr_b16 a[218:219], v31 offset:38912
    v_add_f32 v230, v230, v94
    v_mfma_f32_16x16x32_bf16 v[246:249], a[40:43], a[228:231], v[246:249]
    ds_read_b64_tr_b16 a[220:221], v33 offset:36864
    buffer_load_dwordx4 a[104:107], v79, s[28:31], s65 offen offset:2048 sc1
    v_mfma_f32_16x16x32_bf16 v[250:253], a[44:47], a[228:231], v[250:253]
    ds_read_b64_tr_b16 a[222:223], v33 offset:38912
    v_add_f32 v231, v231, v94
    s_waitcnt vmcnt(13) lgkmcnt(8)
    v_mfma_f32_16x16x32_bf16 v[182:185], a[48:51], a[200:203], v[182:185]
    ds_read_b64_tr_b16 a[224:225], v32 offset:36864
    v_lshlrev_b32 v232, 16, v101
    v_mfma_f32_16x16x32_bf16 v[186:189], a[52:55], a[200:203], v[186:189]
    ds_read_b64_tr_b16 a[226:227], v32 offset:38912
    v_and_b32 v233, 0xffff0000, v101
    v_mfma_f32_16x16x32_bf16 v[238:241], a[48:51], a[204:207], v[238:241]
    ds_read_b64_tr_b16 a[228:229], v34 offset:36864
    buffer_load_dwordx4 a[108:111], v79, s[28:31], s65 offen offset:3072 sc1
    v_mfma_f32_16x16x32_bf16 v[242:245], a[52:55], a[204:207], v[242:245]
    ds_read_b64_tr_b16 a[230:231], v34 offset:38912
    s_waitcnt lgkmcnt(8)
    v_mfma_f32_16x16x32_bf16 v[190:193], a[48:51], a[208:211], v[190:193]
    ds_read_b64_tr_b16 a[200:201], v31 offset:49152
    v_add_f32 v232, v232, v94
    v_mfma_f32_16x16x32_bf16 v[194:197], a[52:55], a[208:211], v[194:197]
    ds_read_b64_tr_b16 a[202:203], v31 offset:51200
    buffer_load_dwordx4 v60, s[24:27], s64 offen offset:1024 lds
    v_add_f32 v233, v233, v94
    v_mfma_f32_16x16x32_bf16 v[246:249], a[48:51], a[212:215], v[246:249]
    ds_read_b64_tr_b16 a[204:205], v33 offset:49152
    v_lshlrev_b32 v234, 16, v102
    v_mfma_f32_16x16x32_bf16 v[250:253], a[52:55], a[212:215], v[250:253]
    ds_read_b64_tr_b16 a[206:207], v33 offset:51200
    s_waitcnt vmcnt(13) lgkmcnt(8)
    v_mfma_f32_16x16x32_bf16 v[182:185], a[56:59], a[216:219], v[182:185]
    ds_read_b64_tr_b16 a[208:209], v32 offset:49152
    buffer_load_dwordx4 v61, s[24:27], s64 offen offset:2048 lds
    v_mfma_f32_16x16x32_bf16 v[186:189], a[60:63], a[216:219], v[186:189]
    ds_read_b64_tr_b16 a[210:211], v32 offset:51200
    v_and_b32 v235, 0xffff0000, v102
    v_mfma_f32_16x16x32_bf16 v[238:241], a[56:59], a[220:223], v[238:241]
    ds_read_b64_tr_b16 a[212:213], v34 offset:49152
    buffer_load_dwordx4 v62, s[24:27], s64 offen offset:3072 lds
    v_mfma_f32_16x16x32_bf16 v[242:245], a[60:63], a[220:223], v[242:245]
    ds_read_b64_tr_b16 a[214:215], v34 offset:51200
    s_waitcnt lgkmcnt(8)
    v_mfma_f32_16x16x32_bf16 v[190:193], a[56:59], a[224:227], v[190:193]
    ds_read_b64_tr_b16 a[216:217], v31 offset:53248
    s_add_u32 m0, s58, 16384
    v_mfma_f32_16x16x32_bf16 v[194:197], a[60:63], a[224:227], v[194:197]
    ds_read_b64_tr_b16 a[218:219], v31 offset:55296
    s_add_u32 s64, s64, 524288
    v_add_f32 v234, v234, v94
    v_mfma_f32_16x16x32_bf16 v[246:249], a[56:59], a[228:231], v[246:249]
    ds_read_b64_tr_b16 a[220:221], v33 offset:53248
    s_cmp_eq_u32 s64, 3670016
    v_mfma_f32_16x16x32_bf16 v[250:253], a[60:63], a[228:231], v[250:253]
    ds_read_b64_tr_b16 a[222:223], v33 offset:55296
    s_cselect_b32 s64, 0, s64
    buffer_load_dwordx4 v59, s[24:27], s64 offen lds
    v_add_f32 v235, v235, v94
    s_waitcnt vmcnt(14) lgkmcnt(8)
    v_mfma_f32_16x16x32_bf16 v[182:185], a[64:67], a[200:203], v[182:185]
    ds_read_b64_tr_b16 a[224:225], v32 offset:53248
    v_lshlrev_b32 v236, 16, v103
    v_mfma_f32_16x16x32_bf16 v[186:189], a[68:71], a[200:203], v[186:189]
    ds_read_b64_tr_b16 a[226:227], v32 offset:55296
    buffer_load_dwordx4 v60, s[24:27], s64 offen offset:1024 lds
    v_and_b32 v237, 0xffff0000, v103
    v_mfma_f32_16x16x32_bf16 v[238:241], a[64:67], a[204:207], v[238:241]
    ds_read_b64_tr_b16 a[228:229], v34 offset:53248
    v_add_f32 v236, v236, v94
    v_mfma_f32_16x16x32_bf16 v[242:245], a[68:71], a[204:207], v[242:245]
    ds_read_b64_tr_b16 a[230:231], v34 offset:55296
    s_waitcnt lgkmcnt(8)
    v_mfma_f32_16x16x32_bf16 v[190:193], a[64:67], a[208:211], v[190:193]
    s_barrier
    ds_read_b64_tr_b16 a[200:201], v35 offset:32768
    buffer_load_dwordx4 v61, s[24:27], s64 offen offset:2048 lds
    v_mfma_f32_16x16x32_bf16 v[194:197], a[68:71], a[208:211], v[194:197]
    ds_read_b64_tr_b16 a[202:203], v35 offset:34816
    v_add_f32 v237, v237, v94
    v_mfma_f32_16x16x32_bf16 v[246:249], a[64:67], a[212:215], v[246:249]
    ds_read_b64_tr_b16 a[204:205], v37 offset:32768
    v_mfma_f32_16x16x32_bf16 v[250:253], a[68:71], a[212:215], v[250:253]
    ds_read_b64_tr_b16 a[206:207], v37 offset:34816
    s_waitcnt vmcnt(14) lgkmcnt(8)
    v_mfma_f32_16x16x32_bf16 v[182:185], a[72:75], a[216:219], v[182:185]
    ds_read_b64_tr_b16 a[208:209], v36 offset:32768
    buffer_load_dwordx4 v62, s[24:27], s64 offen offset:3072 lds
    v_mfma_f32_16x16x32_bf16 v[186:189], a[76:79], a[216:219], v[186:189]
    ds_read_b64_tr_b16 a[210:211], v36 offset:34816
    s_add_u32 m0, s58, 65536
    v_mfma_f32_16x16x32_bf16 v[238:241], a[72:75], a[220:223], v[238:241]
    ds_read_b64_tr_b16 a[212:213], v38 offset:32768
    s_add_u32 s64, s64, 524288
    v_mfma_f32_16x16x32_bf16 v[242:245], a[76:79], a[220:223], v[242:245]
    ds_read_b64_tr_b16 a[214:215], v38 offset:34816
    s_waitcnt lgkmcnt(8)
    v_mfma_f32_16x16x32_bf16 v[190:193], a[72:75], a[224:227], v[190:193]
    ds_read_b64_tr_b16 a[216:217], v35 offset:36864
    s_cmp_eq_u32 s64, 3670016
    v_mfma_f32_16x16x32_bf16 v[194:197], a[76:79], a[224:227], v[194:197]
    ds_read_b64_tr_b16 a[218:219], v35 offset:38912
    s_cselect_b32 s64, 0, s64
    buffer_load_dwordx4 v59, s[24:27], s64 offen lds
    v_mfma_f32_16x16x32_bf16 v[246:249], a[72:75], a[228:231], v[246:249]
    ds_read_b64_tr_b16 a[220:221], v37 offset:36864
    v_mfma_f32_16x16x32_bf16 v[250:253], a[76:79], a[228:231], v[250:253]
    ds_read_b64_tr_b16 a[222:223], v37 offset:38912
    s_waitcnt vmcnt(14) lgkmcnt(8)
    v_mfma_f32_16x16x32_bf16 v[182:185], a[80:83], a[200:203], v[182:185]
    ds_read_b64_tr_b16 a[224:225], v36 offset:36864
    buffer_load_dwordx4 v60, s[24:27], s64 offen offset:1024 lds
    v_mfma_f32_16x16x32_bf16 v[186:189], a[84:87], a[200:203], v[186:189]
    ds_read_b64_tr_b16 a[226:227], v36 offset:38912
    v_mfma_f32_16x16x32_bf16 v[238:241], a[80:83], a[204:207], v[238:241]
    ds_read_b64_tr_b16 a[228:229], v38 offset:36864
    v_mfma_f32_16x16x32_bf16 v[242:245], a[84:87], a[204:207], v[242:245]
    ds_read_b64_tr_b16 a[230:231], v38 offset:38912
    s_waitcnt lgkmcnt(8)
    v_mfma_f32_16x16x32_bf16 v[190:193], a[80:83], a[208:211], v[190:193]
    ds_read_b64_tr_b16 a[200:201], v35 offset:49152
    buffer_load_dwordx4 v61, s[24:27], s64 offen offset:2048 lds
    v_mfma_f32_16x16x32_bf16 v[194:197], a[84:87], a[208:211], v[194:197]
    ds_read_b64_tr_b16 a[202:203], v35 offset:51200
    v_mfma_f32_16x16x32_bf16 v[246:249], a[80:83], a[212:215], v[246:249]
    ds_read_b64_tr_b16 a[204:205], v37 offset:49152
    v_mfma_f32_16x16x32_bf16 v[250:253], a[84:87], a[212:215], v[250:253]
    ds_read_b64_tr_b16 a[206:207], v37 offset:51200
    s_waitcnt vmcnt(14) lgkmcnt(8)
    v_mfma_f32_16x16x32_bf16 v[182:185], a[88:91], a[216:219], v[182:185]
    ds_read_b64_tr_b16 a[208:209], v36 offset:49152
L_pad3:
    s_cbranch_execz L_warm
    buffer_load_dwordx4 v62, s[24:27], s64 offen offset:3072 lds
    v_mfma_f32_16x16x32_bf16 v[186:189], a[92:95], a[216:219], v[186:189]
    ds_read_b64_tr_b16 a[210:211], v36 offset:51200
    s_add_u32 m0, s58, 81920
    v_mfma_f32_16x16x32_bf16 v[238:241], a[88:91], a[220:223], v[238:241]
    ds_read_b64_tr_b16 a[212:213], v38 offset:49152
    s_add_u32 s64, s64, 524288
    v_mfma_f32_16x16x32_bf16 v[242:245], a[92:95], a[220:223], v[242:245]
    ds_read_b64_tr_b16 a[214:215], v38 offset:51200
    s_waitcnt lgkmcnt(8)
    v_mfma_f32_16x16x32_bf16 v[190:193], a[88:91], a[224:227], v[190:193]
    ds_read_b64_tr_b16 a[216:217], v35 offset:53248
    s_cmp_eq_u32 s64, 3670016
    s_cselect_b32 s64, 0, s64
    buffer_load_dwordx4 v59, s[24:27], s64 offen lds
    v_mfma_f32_16x16x32_bf16 v[194:197], a[92:95], a[224:227], v[194:197]
    ds_read_b64_tr_b16 a[218:219], v35 offset:55296
    v_mfma_f32_16x16x32_bf16 v[246:249], a[88:91], a[228:231], v[246:249]
    ds_read_b64_tr_b16 a[220:221], v37 offset:53248
    buffer_load_dwordx4 v60, s[24:27], s64 offen offset:1024 lds
    v_mfma_f32_16x16x32_bf16 v[250:253], a[92:95], a[228:231], v[250:253]
    ds_read_b64_tr_b16 a[222:223], v37 offset:55296
    s_waitcnt vmcnt(15) lgkmcnt(8)
    v_mfma_f32_16x16x32_bf16 v[182:185], a[96:99], a[200:203], v[182:185]
    ds_read_b64_tr_b16 a[224:225], v36 offset:53248
    v_mfma_f32_16x16x32_bf16 v[186:189], a[100:103], a[200:203], v[186:189]
    ds_read_b64_tr_b16 a[226:227], v36 offset:55296
    v_mfma_f32_16x16x32_bf16 v[238:241], a[96:99], a[204:207], v[238:241]
    ds_read_b64_tr_b16 a[228:229], v38 offset:53248
    buffer_load_dwordx4 v61, s[24:27], s64 offen offset:2048 lds
    v_mfma_f32_16x16x32_bf16 v[242:245], a[100:103], a[204:207], v[242:245]
    ds_read_b64_tr_b16 a[230:231], v38 offset:55296
    s_waitcnt lgkmcnt(8)
    v_mfma_f32_16x16x32_bf16 v[190:193], a[96:99], a[208:211], v[190:193]
    ds_read_b64_tr_b16 a[200:201], v31 offset:0
    v_mfma_f32_16x16x32_bf16 v[194:197], a[100:103], a[208:211], v[194:197]
    ds_read_b64_tr_b16 a[202:203], v31 offset:2048
    v_mfma_f32_16x16x32_bf16 v[246:249], a[96:99], a[212:215], v[246:249]
    ds_read_b64_tr_b16 a[204:205], v33 offset:0
    buffer_load_dwordx4 v62, s[24:27], s64 offen offset:3072 lds
    v_mfma_f32_16x16x32_bf16 v[250:253], a[100:103], a[212:215], v[250:253]
    ds_read_b64_tr_b16 a[206:207], v33 offset:2048
    s_waitcnt vmcnt(15) lgkmcnt(8)
    v_mfma_f32_16x16x32_bf16 v[182:185], a[104:107], a[216:219], v[182:185]
    ds_read_b64_tr_b16 a[208:209], v32 offset:0
    s_add_u32 m0, s58, 32768
    v_mfma_f32_16x16x32_bf16 v[186:189], a[108:111], a[216:219], v[186:189]
    ds_read_b64_tr_b16 a[210:211], v32 offset:2048
    s_add_u32 s64, s64, 524288
    v_mfma_f32_16x16x32_bf16 v[238:241], a[104:107], a[220:223], v[238:241]
    ds_read_b64_tr_b16 a[212:213], v34 offset:0
    s_cmp_eq_u32 s64, 3670016
    v_mfma_f32_16x16x32_bf16 v[242:245], a[108:111], a[220:223], v[242:245]
    ds_read_b64_tr_b16 a[214:215], v34 offset:2048
    s_cselect_b32 s64, 0, s64
    buffer_load_dwordx4 v59, s[24:27], s64 offen lds
    s_waitcnt lgkmcnt(8)
    v_mfma_f32_16x16x32_bf16 v[190:193], a[104:107], a[224:227], v[190:193]
    ds_read_b64_tr_b16 a[216:217], v31 offset:4096
    v_mfma_f32_16x16x32_bf16 v[194:197], a[108:111], a[224:227], v[194:197]
    ds_read_b64_tr_b16 a[218:219], v31 offset:6144
    buffer_load_dwordx4 v60, s[24:27], s64 offen offset:1024 lds
    v_mfma_f32_16x16x32_bf16 v[246:249], a[104:107], a[228:231], v[246:249]
    ds_read_b64_tr_b16 a[220:221], v33 offset:4096
    v_mfma_f32_16x16x32_bf16 v[250:253], a[108:111], a[228:231], v[250:253]
    ds_read_b64_tr_b16 a[222:223], v33 offset:6144
    s_waitcnt lgkmcnt(8)
    v_mfma_f32_16x16x32_bf16 v[150:153], a[0:3], a[200:203], 0
    ds_read_b64_tr_b16 a[224:225], v32 offset:4096
    v_mfma_f32_16x16x32_bf16 v[154:157], a[4:7], a[200:203], 0
    ds_read_b64_tr_b16 a[226:227], v32 offset:6144
    buffer_load_dwordx4 v61, s[24:27], s64 offen offset:2048 lds
    v_mfma_f32_16x16x32_bf16 v[166:169], a[0:3], a[204:207], 0
    ds_read_b64_tr_b16 a[228:229], v34 offset:4096
    v_cvt_pk_bf16_f32 v182, v182, v183
    v_mfma_f32_16x16x32_bf16 v[170:173], a[4:7], a[204:207], 0
    ds_read_b64_tr_b16 a[230:231], v34 offset:6144
    v_cvt_pk_bf16_f32 v183, v184, v185
    v_cvt_pk_bf16_f32 v184, v186, v187
    s_waitcnt lgkmcnt(8)
    v_mfma_f32_16x16x32_bf16 v[158:161], a[0:3], a[208:211], 0
    s_waitcnt vmcnt(15)
    s_barrier
    ds_read_b64_tr_b16 a[200:201], v39 offset:0
    buffer_load_dwordx4 v62, s[24:27], s64 offen offset:3072 lds
    v_mfma_f32_16x16x32_bf16 v[162:165], a[4:7], a[208:211], 0
    ds_read_b64_tr_b16 a[202:203], v39 offset:2048
    s_add_u32 m0, s58, 49152
    v_cvt_pk_bf16_f32 v185, v188, v189
    buffer_store_dwordx4 v[182:185], v21, s[28:31], 0 offen offset:0 sc1
    v_cvt_pk_bf16_f32 v190, v190, v191
    v_cvt_pk_bf16_f32 v191, v192, v193
    v_cvt_pk_bf16_f32 v192, v194, v195
    v_mfma_f32_16x16x32_bf16 v[174:177], a[0:3], a[212:215], 0
    ds_read_b64_tr_b16 a[204:205], v41 offset:0
    s_add_u32 s66, s66, 1
    v_mfma_f32_16x16x32_bf16 v[178:181], a[4:7], a[212:215], 0
    ds_read_b64_tr_b16 a[206:207], v41 offset:2048
    v_cvt_pk_bf16_f32 v193, v196, v197
    buffer_store_dwordx4 v[190:193], v21, s[28:31], 0 offen offset:1024 sc1
    v_cvt_pk_bf16_f32 v238, v238, v239
    v_cvt_pk_bf16_f32 v239, v240, v241
    v_cvt_pk_bf16_f32 v240, v242, v243
    s_waitcnt lgkmcnt(8)
    v_mfma_f32_16x16x32_bf16 v[150:153], a[8:11], a[216:219], v[150:153]
    ds_read_b64_tr_b16 a[208:209], v40 offset:0
    s_and_b32 s66, s66, 3
    v_mfma_f32_16x16x32_bf16 v[154:157], a[12:15], a[216:219], v[154:157]
    ds_read_b64_tr_b16 a[210:211], v40 offset:2048
    s_mul_i32 s61, s66, 100352
    buffer_load_dwordx4 v63, s[16:19], s61 offen lds
    v_cvt_pk_bf16_f32 v241, v244, v245
    buffer_store_dwordx4 v[238:241], v21, s[28:31], 0 offen offset:2048 sc1
    v_cvt_pk_bf16_f32 v246, v246, v247
    v_cvt_pk_bf16_f32 v247, v248, v249
    v_cvt_pk_bf16_f32 v248, v250, v251
    v_mfma_f32_16x16x32_bf16 v[166:169], a[8:11], a[220:223], v[166:169]
    ds_read_b64_tr_b16 a[212:213], v42 offset:0
    v_cvt_pk_bf16_f32 v249, v252, v253
    v_mfma_f32_16x16x32_bf16 v[170:173], a[12:15], a[220:223], v[170:173]
    ds_read_b64_tr_b16 a[214:215], v42 offset:2048
    s_waitcnt lgkmcnt(8)
    v_mfma_f32_16x16x32_bf16 v[158:161], a[8:11], a[224:227], v[158:161]
    ds_read_b64_tr_b16 a[216:217], v39 offset:4096
    buffer_load_dwordx4 v64, s[16:19], s61 offen offset:1024 lds
    v_mfma_f32_16x16x32_bf16 v[162:165], a[12:15], a[224:227], v[162:165]
    ds_read_b64_tr_b16 a[218:219], v39 offset:6144
    s_add_u32 s61, s61, 48128
    buffer_store_dwordx4 v[246:249], v21, s[28:31], 0 offen offset:3072 sc1
    v_mfma_f32_16x16x32_bf16 v[174:177], a[8:11], a[228:231], v[174:177]
    ds_read_b64_tr_b16 a[220:221], v41 offset:4096
    v_mfma_f32_16x16x32_bf16 v[178:181], a[12:15], a[228:231], v[178:181]
    ds_read_b64_tr_b16 a[222:223], v41 offset:6144
    s_waitcnt lgkmcnt(8)
    v_mfma_f32_16x16x32_bf16 v[150:153], a[16:19], a[200:203], v[150:153]
    ds_read_b64_tr_b16 a[224:225], v40 offset:4096
    buffer_load_dwordx4 v63, s[16:19], s61 offen offset:2048 lds
    v_mfma_f32_16x16x32_bf16 v[154:157], a[20:23], a[200:203], v[154:157]
    ds_read_b64_tr_b16 a[226:227], v40 offset:6144
    v_mfma_f32_16x16x32_bf16 v[166:169], a[16:19], a[204:207], v[166:169]
    ds_read_b64_tr_b16 a[228:229], v42 offset:4096
    v_mfma_f32_16x16x32_bf16 v[170:173], a[20:23], a[204:207], v[170:173]
    ds_read_b64_tr_b16 a[230:231], v42 offset:6144
    s_waitcnt lgkmcnt(8)
    v_mfma_f32_16x16x32_bf16 v[158:161], a[16:19], a[208:211], v[158:161]
    s_mov_b32 s14, 0
    s_load_dword s14, s[28:29], s39
    ds_read_b64_tr_b16 a[200:201], v39 offset:16384
    buffer_load_dwordx4 v64, s[16:19], s61 offen offset:3072 lds
    v_mfma_f32_16x16x32_bf16 v[162:165], a[20:23], a[208:211], v[162:165]
    ds_read_b64_tr_b16 a[202:203], v39 offset:18432
    s_add_u32 m0, s58, 98304
    v_mfma_f32_16x16x32_bf16 v[174:177], a[16:19], a[212:215], v[174:177]
    ds_read_b64_tr_b16 a[204:205], v41 offset:16384
    s_add_u32 s66, s66, 1
    v_mfma_f32_16x16x32_bf16 v[178:181], a[20:23], a[212:215], v[178:181]
    ds_read_b64_tr_b16 a[206:207], v41 offset:18432
    s_waitcnt lgkmcnt(8)
    v_mfma_f32_16x16x32_bf16 v[150:153], a[24:27], a[216:219], v[150:153]
    ds_read_b64_tr_b16 a[208:209], v40 offset:16384
    s_and_b32 s66, s66, 3
    s_mul_i32 s61, s66, 100352
    buffer_load_dwordx4 v63, s[16:19], s61 offen lds
    v_mfma_f32_16x16x32_bf16 v[154:157], a[28:31], a[216:219], v[154:157]
    ds_read_b64_tr_b16 a[210:211], v40 offset:18432
    v_mfma_f32_16x16x32_bf16 v[166:169], a[24:27], a[220:223], v[166:169]
    ds_read_b64_tr_b16 a[212:213], v42 offset:16384
    buffer_load_dwordx4 v64, s[16:19], s61 offen offset:1024 lds
    v_mfma_f32_16x16x32_bf16 v[170:173], a[28:31], a[220:223], v[170:173]
    ds_read_b64_tr_b16 a[214:215], v42 offset:18432
    s_waitcnt lgkmcnt(8)
    v_mfma_f32_16x16x32_bf16 v[158:161], a[24:27], a[224:227], v[158:161]
    ds_read_b64_tr_b16 a[216:217], v39 offset:20480
    s_add_u32 s61, s61, 48128
    v_mfma_f32_16x16x32_bf16 v[162:165], a[28:31], a[224:227], v[162:165]
    ds_read_b64_tr_b16 a[218:219], v39 offset:22528
    v_mfma_f32_16x16x32_bf16 v[174:177], a[24:27], a[228:231], v[174:177]
    ds_read_b64_tr_b16 a[220:221], v41 offset:20480
    buffer_load_dwordx4 v63, s[16:19], s61 offen offset:2048 lds
    v_mfma_f32_16x16x32_bf16 v[178:181], a[28:31], a[228:231], v[178:181]
    ds_read_b64_tr_b16 a[222:223], v41 offset:22528
    s_waitcnt lgkmcnt(8)
    v_mfma_f32_16x16x32_bf16 v[150:153], a[32:35], a[200:203], v[150:153]
    ds_read_b64_tr_b16 a[224:225], v40 offset:20480
    v_mfma_f32_16x16x32_bf16 v[154:157], a[36:39], a[200:203], v[154:157]
    ds_read_b64_tr_b16 a[226:227], v40 offset:22528
    v_mfma_f32_16x16x32_bf16 v[166:169], a[32:35], a[204:207], v[166:169]
    ds_read_b64_tr_b16 a[228:229], v42 offset:20480
    buffer_load_dwordx4 v64, s[16:19], s61 offen offset:3072 lds
    v_mfma_f32_16x16x32_bf16 v[170:173], a[36:39], a[204:207], v[170:173]
    ds_read_b64_tr_b16 a[230:231], v42 offset:22528
    s_waitcnt lgkmcnt(8)
    v_mfma_f32_16x16x32_bf16 v[158:161], a[32:35], a[208:211], v[158:161]
    s_waitcnt vmcnt(20)
    s_barrier
    ds_read_b64_tr_b16 a[200:201], v31 offset:16384
    s_add_u32 m0, s58, 114688
    v_mfma_f32_16x16x32_bf16 v[162:165], a[36:39], a[208:211], v[162:165]
    ds_read_b64_tr_b16 a[202:203], v31 offset:18432
    s_add_u32 s66, s66, 1
    v_mfma_f32_16x16x32_bf16 v[174:177], a[32:35], a[212:215], v[174:177]
    ds_read_b64_tr_b16 a[204:205], v33 offset:16384
    s_and_b32 s66, s66, 3
    v_mfma_f32_16x16x32_bf16 v[178:181], a[36:39], a[212:215], v[178:181]
    ds_read_b64_tr_b16 a[206:207], v33 offset:18432
    s_mul_i32 s61, s66, 100352
    buffer_load_dwordx4 v63, s[16:19], s61 offen lds
    s_waitcnt lgkmcnt(8)
    v_mfma_f32_16x16x32_bf16 v[150:153], a[40:43], a[216:219], v[150:153]
    ds_read_b64_tr_b16 a[208:209], v32 offset:16384
    v_mfma_f32_16x16x32_bf16 v[154:157], a[44:47], a[216:219], v[154:157]
    ds_read_b64_tr_b16 a[210:211], v32 offset:18432
    buffer_load_dwordx4 v64, s[16:19], s61 offen offset:1024 lds
    v_mfma_f32_16x16x32_bf16 v[166:169], a[40:43], a[220:223], v[166:169]
    ds_read_b64_tr_b16 a[212:213], v34 offset:16384
    s_add_u32 s61, s61, 48128
    v_mfma_f32_16x16x32_bf16 v[170:173], a[44:47], a[220:223], v[170:173]
    ds_read_b64_tr_b16 a[214:215], v34 offset:18432
    s_waitcnt lgkmcnt(8)
    v_mfma_f32_16x16x32_bf16 v[158:161], a[40:43], a[224:227], v[158:161]
    ds_read_b64_tr_b16 a[216:217], v31 offset:20480
    v_mfma_f32_16x16x32_bf16 v[162:165], a[44:47], a[224:227], v[162:165]
    ds_read_b64_tr_b16 a[218:219], v31 offset:22528
    buffer_load_dwordx4 v63, s[16:19], s61 offen offset:2048 lds
    v_mfma_f32_16x16x32_bf16 v[174:177], a[40:43], a[228:231], v[174:177]
    ds_read_b64_tr_b16 a[220:221], v33 offset:20480
    v_mfma_f32_16x16x32_bf16 v[178:181], a[44:47], a[228:231], v[178:181]
    ds_read_b64_tr_b16 a[222:223], v33 offset:22528
    s_waitcnt lgkmcnt(8)
    v_mfma_f32_16x16x32_bf16 v[150:153], a[48:51], a[200:203], v[150:153]
    ds_read_b64_tr_b16 a[224:225], v32 offset:20480
    v_mfma_f32_16x16x32_bf16 v[154:157], a[52:55], a[200:203], v[154:157]
    ds_read_b64_tr_b16 a[226:227], v32 offset:22528
    buffer_load_dwordx4 v64, s[16:19], s61 offen offset:3072 lds
    v_mfma_f32_16x16x32_bf16 v[166:169], a[48:51], a[204:207], v[166:169]
    ds_read_b64_tr_b16 a[228:229], v34 offset:20480
    v_mfma_f32_16x16x32_bf16 v[170:173], a[52:55], a[204:207], v[170:173]
    ds_read_b64_tr_b16 a[230:231], v34 offset:22528
    s_waitcnt lgkmcnt(8)
    v_mfma_f32_16x16x32_bf16 v[158:161], a[48:51], a[208:211], v[158:161]
    s_waitcnt vmcnt(10)
    s_atomic_add s36, s[28:29], s55
    ds_read_b64_tr_b16 a[200:201], v35 offset:0
    v_mfma_f32_16x16x32_bf16 v[162:165], a[52:55], a[208:211], v[162:165]
    ds_read_b64_tr_b16 a[202:203], v35 offset:2048
    v_mfma_f32_16x16x32_bf16 v[174:177], a[48:51], a[212:215], v[174:177]
    ds_read_b64_tr_b16 a[204:205], v37 offset:0
    v_mfma_f32_16x16x32_bf16 v[178:181], a[52:55], a[212:215], v[178:181]
    ds_read_b64_tr_b16 a[206:207], v37 offset:2048
    s_waitcnt lgkmcnt(8)
    v_mfma_f32_16x16x32_bf16 v[150:153], a[56:59], a[216:219], v[150:153]
    ds_read_b64_tr_b16 a[208:209], v36 offset:0
    v_mfma_f32_16x16x32_bf16 v[154:157], a[60:63], a[216:219], v[154:157]
    ds_read_b64_tr_b16 a[210:211], v36 offset:2048
    v_mfma_f32_16x16x32_bf16 v[166:169], a[56:59], a[220:223], v[166:169]
    ds_read_b64_tr_b16 a[212:213], v38 offset:0
    v_mfma_f32_16x16x32_bf16 v[170:173], a[60:63], a[220:223], v[170:173]
    ds_read_b64_tr_b16 a[214:215], v38 offset:2048
    s_waitcnt lgkmcnt(8)
    v_mfma_f32_16x16x32_bf16 v[158:161], a[56:59], a[224:227], v[158:161]
    ds_read_b64_tr_b16 a[216:217], v35 offset:4096
    v_mfma_f32_16x16x32_bf16 v[162:165], a[60:63], a[224:227], v[162:165]
    ds_read_b64_tr_b16 a[218:219], v35 offset:6144
    v_mfma_f32_16x16x32_bf16 v[174:177], a[56:59], a[228:231], v[174:177]
    ds_read_b64_tr_b16 a[220:221], v37 offset:4096
    v_mfma_f32_16x16x32_bf16 v[178:181], a[60:63], a[228:231], v[178:181]
    ds_read_b64_tr_b16 a[222:223], v37 offset:6144
    s_waitcnt lgkmcnt(8)
    v_mfma_f32_16x16x32_bf16 v[150:153], a[64:67], a[200:203], v[150:153]
    s_cmp_ge_u32 s14, 8
    s_cbranch_scc0 L_pollin6
L_pollok6:
    ds_read_b64_tr_b16 a[224:225], v36 offset:4096
    s_add_u32 m0, s58, 0
    s_add_u32 s51, s51, 1
    s_and_b32 s51, s51, 3
    s_lshl_b32 s61, s51, 12
    buffer_load_dwordx4 v65, s[28:31], s61 offen sc1 lds
    v_mfma_f32_16x16x32_bf16 v[154:157], a[68:71], a[200:203], v[154:157]
    ds_read_b64_tr_b16 a[226:227], v36 offset:6144
    v_mfma_f32_16x16x32_bf16 v[166:169], a[64:67], a[204:207], v[166:169]
    ds_read_b64_tr_b16 a[228:229], v38 offset:4096
    buffer_load_dwordx4 v66, s[28:31], s61 offen offset:1024 sc1 lds
    v_mfma_f32_16x16x32_bf16 v[170:173], a[68:71], a[204:207], v[170:173]
    ds_read_b64_tr_b16 a[230:231], v38 offset:6144
    s_waitcnt lgkmcnt(8)
    v_mfma_f32_16x16x32_bf16 v[158:161], a[64:67], a[208:211], v[158:161]
    s_barrier
    ds_read_b64_tr_b16 a[200:201], v35 offset:16384
    buffer_load_dwordx4 v65, s[28:31], s61 offen offset:2048 sc1 lds
    v_mfma_f32_16x16x32_bf16 v[162:165], a[68:71], a[208:211], v[162:165]
    ds_read_b64_tr_b16 a[202:203], v35 offset:18432
    v_mfma_f32_16x16x32_bf16 v[174:177], a[64:67], a[212:215], v[174:177]
    ds_read_b64_tr_b16 a[204:205], v37 offset:16384
    v_mfma_f32_16x16x32_bf16 v[178:181], a[68:71], a[212:215], v[178:181]
    ds_read_b64_tr_b16 a[206:207], v37 offset:18432
    s_waitcnt lgkmcnt(8)
    v_mfma_f32_16x16x32_bf16 v[150:153], a[72:75], a[216:219], v[150:153]
    ds_read_b64_tr_b16 a[208:209], v36 offset:16384
    buffer_load_dwordx4 v66, s[28:31], s61 offen offset:3072 sc1 lds
    v_mfma_f32_16x16x32_bf16 v[154:157], a[76:79], a[216:219], v[154:157]
    ds_read_b64_tr_b16 a[210:211], v36 offset:18432
    s_add_u32 m0, s58, 131072
    v_mfma_f32_16x16x32_bf16 v[166:169], a[72:75], a[220:223], v[166:169]
    ds_read_b64_tr_b16 a[212:213], v38 offset:16384
    s_add_u32 s51, s51, 1
    v_mfma_f32_16x16x32_bf16 v[170:173], a[76:79], a[220:223], v[170:173]
    ds_read_b64_tr_b16 a[214:215], v38 offset:18432
    s_waitcnt lgkmcnt(8)
    v_mfma_f32_16x16x32_bf16 v[158:161], a[72:75], a[224:227], v[158:161]
    ds_read_b64_tr_b16 a[216:217], v35 offset:20480
    s_and_b32 s51, s51, 3
    s_lshl_b32 s61, s51, 12
    buffer_load_dwordx4 v65, s[28:31], s61 offen sc1 lds
    v_mfma_f32_16x16x32_bf16 v[162:165], a[76:79], a[224:227], v[162:165]
    ds_read_b64_tr_b16 a[218:219], v35 offset:22528
    v_mfma_f32_16x16x32_bf16 v[174:177], a[72:75], a[228:231], v[174:177]
    ds_read_b64_tr_b16 a[220:221], v37 offset:20480
    buffer_load_dwordx4 v66, s[28:31], s61 offen offset:1024 sc1 lds
    v_mfma_f32_16x16x32_bf16 v[178:181], a[76:79], a[228:231], v[178:181]
    ds_read_b64_tr_b16 a[222:223], v37 offset:22528
    s_waitcnt lgkmcnt(8)
    v_mfma_f32_16x16x32_bf16 v[150:153], a[80:83], a[200:203], v[150:153]
    ds_read_b64_tr_b16 a[224:225], v36 offset:20480
    v_mfma_f32_16x16x32_bf16 v[154:157], a[84:87], a[200:203], v[154:157]
    ds_read_b64_tr_b16 a[226:227], v36 offset:22528
    buffer_load_dwordx4 v65, s[28:31], s61 offen offset:2048 sc1 lds
    v_mfma_f32_16x16x32_bf16 v[166:169], a[80:83], a[204:207], v[166:169]
    ds_read_b64_tr_b16 a[228:229], v38 offset:20480
    v_mfma_f32_16x16x32_bf16 v[170:173], a[84:87], a[204:207], v[170:173]
    ds_read_b64_tr_b16 a[230:231], v38 offset:22528
    s_waitcnt lgkmcnt(8)
    v_mfma_f32_16x16x32_bf16 v[158:161], a[80:83], a[208:211], v[158:161]
    s_barrier
    ds_read_b64_tr_b16 a[200:201], v31 offset:32768
    buffer_load_dwordx4 v66, s[28:31], s61 offen offset:3072 sc1 lds
    v_mfma_f32_16x16x32_bf16 v[162:165], a[84:87], a[208:211], v[162:165]
    ds_read_b64_tr_b16 a[202:203], v31 offset:34816
    s_add_u32 m0, s58, 147456
    v_mfma_f32_16x16x32_bf16 v[174:177], a[80:83], a[212:215], v[174:177]
    ds_read_b64_tr_b16 a[204:205], v33 offset:32768
    s_add_u32 s51, s51, 1
    v_mfma_f32_16x16x32_bf16 v[178:181], a[84:87], a[212:215], v[178:181]
    ds_read_b64_tr_b16 a[206:207], v33 offset:34816
    s_waitcnt lgkmcnt(8)
    v_mfma_f32_16x16x32_bf16 v[150:153], a[88:91], a[216:219], v[150:153]
    ds_read_b64_tr_b16 a[208:209], v32 offset:32768
    s_and_b32 s51, s51, 3
    s_lshl_b32 s61, s51, 12
    buffer_load_dwordx4 v65, s[28:31], s61 offen sc1 lds
    v_mfma_f32_16x16x32_bf16 v[154:157], a[92:95], a[216:219], v[154:157]
    ds_read_b64_tr_b16 a[210:211], v32 offset:34816
    v_mfma_f32_16x16x32_bf16 v[166:169], a[88:91], a[220:223], v[166:169]
    ds_read_b64_tr_b16 a[212:213], v34 offset:32768
    buffer_load_dwordx4 v66, s[28:31], s61 offen offset:1024 sc1 lds
    v_mfma_f32_16x16x32_bf16 v[170:173], a[92:95], a[220:223], v[170:173]
    ds_read_b64_tr_b16 a[214:215], v34 offset:34816
    s_waitcnt lgkmcnt(8)
    v_mfma_f32_16x16x32_bf16 v[158:161], a[88:91], a[224:227], v[158:161]
    ds_read_b64_tr_b16 a[216:217], v31 offset:36864
    v_mfma_f32_16x16x32_bf16 v[162:165], a[92:95], a[224:227], v[162:165]
    ds_read_b64_tr_b16 a[218:219], v31 offset:38912
    buffer_load_dwordx4 v65, s[28:31], s61 offen offset:2048 sc1 lds
    v_mfma_f32_16x16x32_bf16 v[174:177], a[88:91], a[228:231], v[174:177]
    ds_read_b64_tr_b16 a[220:221], v33 offset:36864
    v_mfma_f32_16x16x32_bf16 v[178:181], a[92:95], a[228:231], v[178:181]
    ds_read_b64_tr_b16 a[222:223], v33 offset:38912
    s_waitcnt lgkmcnt(8)
    v_mfma_f32_16x16x32_bf16 v[150:153], a[96:99], a[200:203], v[150:153]
    ds_read_b64_tr_b16 a[224:225], v32 offset:36864
    buffer_load_dwordx4 v66, s[28:31], s61 offen offset:3072 sc1 lds
    v_mfma_f32_16x16x32_bf16 v[154:157], a[100:103], a[200:203], v[154:157]
    ds_read_b64_tr_b16 a[226:227], v32 offset:38912
    s_add_u32 m0, s58, 16384
    v_mfma_f32_16x16x32_bf16 v[166:169], a[96:99], a[204:207], v[166:169]
    ds_read_b64_tr_b16 a[228:229], v34 offset:36864
    s_add_u32 s66, s66, 1
    v_mfma_f32_16x16x32_bf16 v[170:173], a[100:103], a[204:207], v[170:173]
    ds_read_b64_tr_b16 a[230:231], v34 offset:38912
    s_waitcnt lgkmcnt(8)
    v_mfma_f32_16x16x32_bf16 v[158:161], a[96:99], a[208:211], v[158:161]
    s_waitcnt vmcnt(8)
    s_barrier
    s_xor_b32 s55, s55, 1024
    s_mov_b32 s14, 0
    s_load_dword s14, s[28:29], s55
    ds_read_b64_tr_b16 v[198:199], v43 offset:49152
    ds_read_b64_tr_b16 v[200:201], v43 offset:53248
    s_and_b32 s66, s66, 3
    s_mul_i32 s61, s66, 100352
    buffer_load_dwordx4 v63, s[16:19], s61 offen lds
    v_mfma_f32_16x16x32_bf16 v[162:165], a[100:103], a[208:211], v[162:165]
    ds_read_b64_tr_b16 v[202:203], v44 offset:49152
    v_mfma_f32_16x16x32_bf16 v[174:177], a[96:99], a[212:215], v[174:177]
    ds_read_b64_tr_b16 v[204:205], v44 offset:53248
    buffer_load_dwordx4 v64, s[16:19], s61 offen offset:1024 lds
    v_mfma_f32_16x16x32_bf16 v[178:181], a[100:103], a[212:215], v[178:181]
    ds_read_b128 a[200:203], v47 offset:0
    s_waitcnt lgkmcnt(9)
    v_mfma_f32_16x16x32_bf16 v[150:153], a[104:107], a[216:219], v[150:153]
    ds_read_b128 a[204:207], v48 offset:0
    s_add_u32 s61, s61, 48128
    v_mfma_f32_16x16x32_bf16 v[154:157], a[108:111], a[216:219], v[154:157]
    ds_read_b128 a[208:211], v47 offset:1024
    buffer_load_dwordx4 v63, s[16:19], s61 offen offset:2048 lds
    v_mfma_f32_16x16x32_bf16 v[166:169], a[104:107], a[220:223], v[166:169]
    ds_read_b128 a[212:215], v48 offset:1024
    v_mfma_f32_16x16x32_bf16 v[170:173], a[108:111], a[220:223], v[170:173]
    s_waitcnt lgkmcnt(8)
    v_mfma_f32_16x16x32_bf16 v[158:161], a[104:107], a[224:227], v[158:161]
    ds_read_b64_tr_b16 v[206:207], v43 offset:51200
    ds_read_b64_tr_b16 v[208:209], v43 offset:55296
    v_mfma_f32_16x16x32_bf16 v[162:165], a[108:111], a[224:227], v[162:165]
    ds_read_b64_tr_b16 v[210:211], v44 offset:51200
    buffer_load_dwordx4 v64, s[16:19], s61 offen offset:3072 lds
    v_mfma_f32_16x16x32_bf16 v[174:177], a[104:107], a[228:231], v[174:177]
    ds_read_b64_tr_b16 v[212:213], v44 offset:55296
    s_add_u32 m0, s58, 65536
    v_mfma_f32_16x16x32_bf16 v[178:181], a[108:111], a[228:231], v[178:181]
    ds_read_b128 a[216:219], v47 offset:2048
    s_waitcnt lgkmcnt(7)
    v_mfma_f32_16x16x32_bf16 v[150:153], v[198:201], a[200:203], v[150:153]
    ds_read_b128 a[220:223], v48 offset:2048
    s_add_u32 s51, s51, 1
    s_and_b32 s51, s51, 3
    s_lshl_b32 s61, s51, 12
    buffer_load_dwordx4 v65, s[28:31], s61 offen sc1 lds
    v_mfma_f32_16x16x32_bf16 v[154:157], v[202:205], a[200:203], v[154:157]
    ds_read_b128 a[224:227], v47 offset:3072
    v_mfma_f32_16x16x32_bf16 v[166:169], v[198:201], a[204:207], v[166:169]
    ds_read_b128 a[228:231], v48 offset:3072
    buffer_load_dwordx4 v66, s[28:31], s61 offen offset:1024 sc1 lds
    v_mfma_f32_16x16x32_bf16 v[170:173], v[202:205], a[204:207], v[170:173]
    s_waitcnt lgkmcnt(8)
    v_mfma_f32_16x16x32_bf16 v[158:161], v[198:201], a[208:211], v[158:161]
    s_waitcnt vmcnt(10)
    s_barrier
    ds_read_b64_tr_b16 v[214:215], v45 offset:32768
    ds_read_b64_tr_b16 v[216:217], v45 offset:36864
    v_mfma_f32_16x16x32_bf16 v[162:165], v[202:205], a[208:211], v[162:165]
    ds_read_b64_tr_b16 v[218:219], v46 offset:32768
    buffer_load_dwordx4 v65, s[28:31], s61 offen offset:2048 sc1 lds
    v_mfma_f32_16x16x32_bf16 v[174:177], v[198:201], a[212:215], v[174:177]
    ds_read_b64_tr_b16 v[220:221], v46 offset:36864
    v_mfma_f32_16x16x32_bf16 v[178:181], v[202:205], a[212:215], v[178:181]
    ds_read_b128 a[200:203], v51 offset:0
    s_waitcnt lgkmcnt(7)
    v_mfma_f32_16x16x32_bf16 v[150:153], v[206:209], a[216:219], v[150:153]
    ds_read_b128 a[204:207], v52 offset:0
    buffer_load_dwordx4 v66, s[28:31], s61 offen offset:3072 sc1 lds
    v_mfma_f32_16x16x32_bf16 v[154:157], v[210:213], a[216:219], v[154:157]
    ds_read_b128 a[208:211], v51 offset:1024
    v_mfma_f32_16x16x32_bf16 v[166:169], v[206:209], a[220:223], v[166:169]
    ds_read_b128 a[212:215], v52 offset:1024
    v_mfma_f32_16x16x32_bf16 v[170:173], v[210:213], a[220:223], v[170:173]
    s_waitcnt lgkmcnt(8)
    v_mfma_f32_16x16x32_bf16 v[158:161], v[206:209], a[224:227], v[158:161]
    s_cmp_ge_u32 s14, 1
    s_cbranch_scc0 L_pollin7
L_pollok7:
    v_xor_b32 v21, 131072, v21
    ds_read_b64_tr_b16 v[198:199], v45 offset:34816
    ds_read_b64_tr_b16 v[200:201], v45 offset:38912
    buffer_load_dwordx4 v[246:249], v21, s[28:31], 0 offen offset:2048 sc1
    v_mfma_f32_16x16x32_bf16 v[162:165], v[210:213], a[224:227], v[162:165]
    ds_read_b64_tr_b16 v[202:203], v46 offset:34816
    buffer_load_dwordx4 v[250:253], v21, s[28:31], 0 offen offset:3072 sc1
    v_mfma_f32_16x16x32_bf16 v[174:177], v[206:209], a[228:231], v[174:177]
    ds_read_b64_tr_b16 v[204:205], v46 offset:38912
    v_mfma_f32_16x16x32_bf16 v[178:181], v[210:213], a[228:231], v[178:181]
    ds_read_b128 a[216:219], v51 offset:2048
    s_waitcnt lgkmcnt(7)
    v_mfma_f32_16x16x32_bf16 v[150:153], v[214:217], a[200:203], v[150:153]
    ds_read_b128 a[220:223], v52 offset:2048
    buffer_load_dwordx4 v[238:241], v21, s[28:31], 0 offen offset:0 sc1
    v_mfma_f32_16x16x32_bf16 v[154:157], v[218:221], a[200:203], v[154:157]
    ds_read_b128 a[224:227], v51 offset:3072
    buffer_load_dwordx4 v[242:245], v21, s[28:31], 0 offen offset:1024 sc1
    v_mfma_f32_16x16x32_bf16 v[166:169], v[214:217], a[204:207], v[166:169]
    ds_read_b128 a[228:231], v52 offset:3072
    v_mfma_f32_16x16x32_bf16 v[170:173], v[218:221], a[204:207], v[170:173]
    s_waitcnt lgkmcnt(8)
    v_mfma_f32_16x16x32_bf16 v[158:161], v[214:217], a[208:211], v[158:161]
    s_waitcnt vmcnt(12)
    s_barrier
    ds_read_b64_tr_b16 v[206:207], v45 offset:49152
    ds_read_b64_tr_b16 v[208:209], v45 offset:53248
    v_mfma_f32_16x16x32_bf16 v[162:165], v[218:221], a[208:211], v[162:165]
    ds_read_b64_tr_b16 v[210:211], v46 offset:49152
    v_mfma_f32_16x16x32_bf16 v[174:177], v[214:217], a[212:215], v[174:177]
    ds_read_b64_tr_b16 v[212:213], v46 offset:53248
    v_mfma_f32_16x16x32_bf16 v[178:181], v[218:221], a[212:215], v[178:181]
    ds_read_b128 a[200:203], v51 offset:16384
    s_waitcnt lgkmcnt(7)
    v_mfma_f32_16x16x32_bf16 v[150:153], v[198:201], a[216:219], v[150:153]
    ds_read_b128 a[204:207], v52 offset:16384
    v_mfma_f32_16x16x32_bf16 v[154:157], v[202:205], a[216:219], v[154:157]
    ds_read_b128 a[208:211], v51 offset:17408
    v_mfma_f32_16x16x32_bf16 v[166:169], v[198:201], a[220:223], v[166:169]
    ds_read_b128 a[212:215], v52 offset:17408
    v_mfma_f32_16x16x32_bf16 v[170:173], v[202:205], a[220:223], v[170:173]
    s_waitcnt lgkmcnt(8)
    v_mfma_f32_16x16x32_bf16 v[158:161], v[198:201], a[224:227], v[158:161]
    ds_read_b64_tr_b16 v[214:215], v45 offset:51200
    ds_read_b64_tr_b16 v[216:217], v45 offset:55296
    v_mfma_f32_16x16x32_bf16 v[162:165], v[202:205], a[224:227], v[162:165]
    ds_read_b64_tr_b16 v[218:219], v46 offset:51200
    v_mfma_f32_16x16x32_bf16 v[174:177], v[198:201], a[228:231], v[174:177]
    ds_read_b64_tr_b16 v[220:221], v46 offset:55296
    v_mfma_f32_16x16x32_bf16 v[178:181], v[202:205], a[228:231], v[178:181]
    ds_read_b128 a[216:219], v51 offset:18432
    s_waitcnt lgkmcnt(7)
    v_mfma_f32_16x16x32_bf16 v[150:153], v[206:209], a[200:203], v[150:153]
    ds_read_b128 a[220:223], v52 offset:18432
    v_mfma_f32_16x16x32_bf16 v[154:157], v[210:213], a[200:203], v[154:157]
    ds_read_b128 a[224:227], v51 offset:19456
    v_mfma_f32_16x16x32_bf16 v[166:169], v[206:209], a[204:207], v[166:169]
    ds_read_b128 a[228:231], v52 offset:19456
    v_mfma_f32_16x16x32_bf16 v[170:173], v[210:213], a[204:207], v[170:173]
    s_waitcnt lgkmcnt(8)
    v_mfma_f32_16x16x32_bf16 v[158:161], v[206:209], a[208:211], v[158:161]
    s_waitcnt vmcnt(4)
    s_barrier
    ds_read_b64_tr_b16 v[198:199], v43 offset:16384
    ds_read_b64_tr_b16 v[200:201], v43 offset:20480
    v_mfma_f32_16x16x32_bf16 v[162:165], v[210:213], a[208:211], v[162:165]
    ds_read_b64_tr_b16 v[202:203], v44 offset:16384
    v_mfma_f32_16x16x32_bf16 v[174:177], v[206:209], a[212:215], v[174:177]
    ds_read_b64_tr_b16 v[204:205], v44 offset:20480
    v_mfma_f32_16x16x32_bf16 v[178:181], v[210:213], a[212:215], v[178:181]
    ds_read_b128 a[200:203], v50 offset:0
    s_waitcnt lgkmcnt(7)
    v_mfma_f32_16x16x32_bf16 v[150:153], v[214:217], a[216:219], v[150:153]
    ds_read_b128 a[204:207], v50 offset:1024
    ds_read_b64_tr_b16 v[206:207], v43 offset:18432
    v_mfma_f32_16x16x32_bf16 v[154:157], v[218:221], a[216:219], v[154:157]
    ds_read_b64_tr_b16 v[208:209], v43 offset:22528
    ds_read_b64_tr_b16 v[210:211], v44 offset:18432
    v_mfma_f32_16x16x32_bf16 v[166:169], v[214:217], a[220:223], v[166:169]
    ds_read_b64_tr_b16 v[212:213], v44 offset:22528
    v_mfma_f32_16x16x32_bf16 v[170:173], v[218:221], a[220:223], v[170:173]
    ds_read_b128 a[208:211], v50 offset:2048
    s_waitcnt lgkmcnt(11)
    v_mfma_f32_16x16x32_bf16 v[158:161], v[214:217], a[224:227], v[158:161]
    ds_read_b128 a[212:215], v50 offset:3072
    v_mfma_f32_16x16x32_bf16 v[162:165], v[218:221], a[224:227], v[162:165]
    v_mfma_f32_16x16x32_bf16 v[174:177], v[214:217], a[228:231], v[174:177]
    v_mfma_f32_16x16x32_bf16 v[178:181], v[218:221], a[228:231], v[178:181]
    s_waitcnt lgkmcnt(6)
    v_mfma_f32_16x16x32_bf16 v[166:169], v[198:201], a[200:203], v[166:169]
    ds_read_b128 a[224:227], v49 offset:0
    v_mfma_f32_16x16x32_bf16 v[170:173], v[202:205], a[200:203], v[170:173]
    v_mfma_f32_16x16x32_bf16 v[174:177], v[198:201], a[204:207], v[174:177]
    ds_read_b128 a[228:231], v49 offset:1024
    v_mfma_f32_16x16x32_bf16 v[178:181], v[202:205], a[204:207], v[178:181]
    s_waitcnt lgkmcnt(2)
    v_mfma_f32_16x16x32_bf16 v[166:169], v[206:209], a[208:211], v[166:169]
    ds_read_b128 a[200:203], v49 offset:2048
    v_mfma_f32_16x16x32_bf16 v[170:173], v[210:213], a[208:211], v[170:173]
L_pad4:
    s_cbranch_execz L_warm
    v_mfma_f32_16x16x32_bf16 v[174:177], v[206:209], a[212:215], v[174:177]
    ds_read_b128 a[204:207], v49 offset:3072
    v_mfma_f32_16x16x32_bf16 v[178:181], v[210:213], a[212:215], v[178:181]
    s_waitcnt vmcnt(3)
    v_mfma_f32_16x16x32_bf16 v[166:169], a[250:253], v[246:249], v[166:169]
    v_mfma_f32_16x16x32_bf16 v[170:173], a[248:251], v[246:249], v[170:173]
    s_waitcnt vmcnt(2)
    v_mfma_f32_16x16x32_bf16 v[174:177], a[250:253], v[250:253], v[174:177]
    v_mfma_f32_16x16x32_bf16 v[178:181], a[248:251], v[250:253], v[178:181]
    s_waitcnt lgkmcnt(2)
    v_mfma_f32_16x16x32_bf16 v[150:153], v[198:201], a[224:227], v[150:153]
    v_mfma_f32_16x16x32_bf16 v[154:157], v[202:205], a[224:227], v[154:157]
    v_mfma_f32_16x16x32_bf16 v[158:161], v[198:201], a[228:231], v[158:161]
    ds_write_b128 v87, v[166:169] offset:8192
    v_mfma_f32_16x16x32_bf16 v[162:165], v[202:205], a[228:231], v[162:165]
    s_waitcnt lgkmcnt(1)
    v_mfma_f32_16x16x32_bf16 v[150:153], v[206:209], a[200:203], v[150:153]
    ds_write_b128 v88, v[170:173] offset:8192
    v_mfma_f32_16x16x32_bf16 v[154:157], v[210:213], a[200:203], v[154:157]
    v_mfma_f32_16x16x32_bf16 v[158:161], v[206:209], a[204:207], v[158:161]
    ds_write_b128 v87, v[174:177] offset:12288
    v_mfma_f32_16x16x32_bf16 v[162:165], v[210:213], a[204:207], v[162:165]
    s_waitcnt vmcnt(1)
    v_mfma_f32_16x16x32_bf16 v[150:153], a[250:253], v[238:241], v[150:153]
    ds_write_b128 v88, v[178:181] offset:12288
    v_mfma_f32_16x16x32_bf16 v[154:157], a[248:251], v[238:241], v[154:157]
    s_waitcnt vmcnt(0)
    v_mfma_f32_16x16x32_bf16 v[158:161], a[250:253], v[242:245], v[158:161]
    v_mfma_f32_16x16x32_bf16 v[162:165], a[248:251], v[242:245], v[162:165]
    s_nop 2
    ds_write_b128 v87, v[150:153] offset:0
    s_nop 0
    ds_write_b128 v88, v[154:157] offset:0
    s_nop 0
    ds_write_b128 v87, v[158:161] offset:4096
    ds_write_b128 v88, v[162:165] offset:4096
    s_waitcnt lgkmcnt(0)
    s_barrier
    ds_read_b128 v[118:121], v89 offset:0
    ds_read_b128 v[122:125], v90 offset:0
    ds_read_b128 v[126:129], v91 offset:0
    ds_read_b128 v[130:133], v92 offset:0
    ds_read_b128 v[134:137], v89 offset:2048
    ds_read_b128 v[138:141], v90 offset:2048
    ds_read_b128 v[142:145], v91 offset:2048
    ds_read_b128 v[146:149], v92 offset:2048
    s_waitcnt lgkmcnt(7)
    v_pk_add_f32 v[222:223], v[222:223], v[118:119]
    v_pk_add_f32 v[224:225], v[224:225], v[120:121]
    s_waitcnt lgkmcnt(6)
    v_pk_add_f32 v[226:227], v[226:227], v[122:123]
    v_pk_add_f32 v[228:229], v[228:229], v[124:125]
    s_waitcnt lgkmcnt(5)
    v_pk_add_f32 v[222:223], v[222:223], v[126:127]
    v_pk_add_f32 v[224:225], v[224:225], v[128:129]
    s_waitcnt lgkmcnt(4)
    v_pk_add_f32 v[226:227], v[226:227], v[130:131]
    v_pk_add_f32 v[228:229], v[228:229], v[132:133]
    v_cvt_pk_bf16_f32 v110, v222, v223
    v_cvt_pk_bf16_f32 v111, v224, v225
    v_cvt_pk_bf16_f32 v112, v226, v227
    v_cvt_pk_bf16_f32 v113, v228, v229
    buffer_store_dwordx4 v[110:113], v85, s[32:35], 0 offen
    s_waitcnt lgkmcnt(3)
    v_pk_add_f32 v[230:231], v[230:231], v[134:135]
    v_pk_add_f32 v[232:233], v[232:233], v[136:137]
    s_waitcnt lgkmcnt(2)
    v_pk_add_f32 v[234:235], v[234:235], v[138:139]
    v_pk_add_f32 v[236:237], v[236:237], v[140:141]
    s_waitcnt lgkmcnt(1)
    v_pk_add_f32 v[230:231], v[230:231], v[142:143]
    v_pk_add_f32 v[232:233], v[232:233], v[144:145]
    s_waitcnt lgkmcnt(0)
    v_pk_add_f32 v[234:235], v[234:235], v[146:147]
    v_pk_add_f32 v[236:237], v[236:237], v[148:149]
    v_cvt_pk_bf16_f32 v114, v230, v231
    v_cvt_pk_bf16_f32 v115, v232, v233
    v_cvt_pk_bf16_f32 v116, v234, v235
    v_cvt_pk_bf16_f32 v117, v236, v237
    buffer_store_dwordx4 v[114:117], v86, s[32:35], 0 offen
L_fin:
L_end:
    s_endpgm
L_nonce:
    buffer_load_dword v12, v16, s[44:47], 0 offen sc1
    s_add_u32 s60, s60, 1
    s_waitcnt vmcnt(0)
    v_readfirstlane_b32 s57, v12
    s_cmp_ge_u32 s60, 20000
    s_cbranch_scc1 L_nonce_ok
    s_cmp_eq_u32 s57, 0
    s_cbranch_scc1 L_nonce
    s_branch L_nonce_ok
L_pollin0:
    s_mov_b32 s60, 0
L_poll0:
    s_sleep 4
    buffer_load_dword v18, v20, s[28:31], 0 offen sc1
    s_add_u32 s60, s60, 1
    s_waitcnt vmcnt(0)
    v_cmp_ne_u32 vcc, s57, v18
    s_cbranch_vccz L_pollok0
    s_cmp_lt_u32 s60, 20000
    s_cbranch_scc1 L_poll0
    s_branch L_pollok0
L_pollin1:
    s_waitcnt lgkmcnt(0)
    s_cmp_ge_u32 s14, 14
    s_cbranch_scc1 L_pollok1
    s_mov_b32 s60, 0
    s_branch L_poll1a
L_poll1:
    s_sleep 8
L_poll1a:
    buffer_load_dword v18, off, s[44:47], s15 sc1
    s_add_u32 s60, s60, 1
    s_waitcnt vmcnt(0)
    v_readfirstlane_b32 s14, v18
    s_nop 0
    s_cmp_ge_u32 s14, 14
    s_cbranch_scc1 L_pollok1
    s_cmp_lt_u32 s60, 20000
    s_cbranch_scc1 L_poll1
    s_branch L_pollok1
L_pollin2:
    s_waitcnt lgkmcnt(0)
    s_cmp_ge_u32 s14, 2
    s_cbranch_scc1 L_pollok2
    s_mov_b32 s60, 0
    s_branch L_poll2a
L_poll2:
    s_sleep 4
L_poll2a:
    buffer_load_dword v18, off, s[28:31], s37 sc1
    s_add_u32 s60, s60, 1
    s_waitcnt vmcnt(0)
    v_readfirstlane_b32 s14, v18
    s_nop 0
    s_cmp_ge_u32 s14, 2
    s_cbranch_scc1 L_pollok2
    s_cmp_lt_u32 s60, 20000
    s_cbranch_scc1 L_poll2
    s_branch L_pollok2
L_nonceh:
    buffer_load_dword v12, v16, s[44:47], 0 offen sc1
    s_add_u32 s60, s60, 1
    s_waitcnt vmcnt(0)
    v_readfirstlane_b32 s57, v12
    s_cmp_ge_u32 s60, 20000
    s_cbranch_scc1 L_nonce_okh
    s_cmp_eq_u32 s57, 0
    s_cbranch_scc1 L_nonceh
    s_branch L_nonce_okh
L_pollin3:
    s_mov_b32 s60, 0
L_poll3:
    s_sleep 8
    buffer_load_dword v18, v20, s[28:31], 0 offen sc1
    s_add_u32 s60, s60, 1
    s_waitcnt vmcnt(0)
    v_cmp_ne_u32 vcc, s57, v18
    s_cbranch_vccz L_pollok3
    s_cmp_lt_u32 s60, 20000
    s_cbranch_scc1 L_poll3
    s_branch L_pollok3
L_pollin4:
    s_waitcnt lgkmcnt(0)
    s_cmp_ge_u32 s14, 14
    s_cbranch_scc1 L_pollok4
    s_mov_b32 s60, 0
    s_branch L_poll4a
L_poll4:
    s_sleep 16
L_poll4a:
    buffer_load_dword v18, off, s[44:47], s15 sc1
    s_add_u32 s60, s60, 1
    s_waitcnt vmcnt(0)
    v_readfirstlane_b32 s14, v18
    s_nop 0
    s_cmp_ge_u32 s14, 14
    s_cbranch_scc1 L_pollok4
    s_cmp_lt_u32 s60, 20000
    s_cbranch_scc1 L_poll4
    s_branch L_pollok4
L_nog1:
    s_nop 1
    s_mov_b32 s14, 1204224
    s_mov_b32 s15, 0x20000
    s_sub_u32 s3, s2, 200
    s_cmp_lt_u32 s3, 42
    s_cselect_b32 s81, 0, 268435456
    s_cselect_b32 s3, s3, 0
    s_mul_i32 s79, s3, 43
    s_lshr_b32 s79, s79, 7
    s_mul_i32 s80, s79, 3
    s_sub_u32 s80, s3, s80
    v_min_u32 v13, 55, v1
    s_lshl_b32 s3, s79, 2
    s_add_u32 s3, s3, s48
    s_mul_i32 s3, s3, 21504
    s_mul_i32 s60, s80, 896
    s_add_u32 s3, s3, s60
    s_add_u32 s3, s3, s81
    v_lshl_add_u32 v242, v13, 4, s3
    s_mul_i32 s60, s48, 8448
    s_add_u32 m0, s60, 0
    s_mov_b32 s3, 0
    buffer_load_dwordx4 v242, s[12:15], s3 offen lds
    s_add_u32 m0, s60, 1056
    s_mov_b32 s3, 2688
    buffer_load_dwordx4 v242, s[12:15], s3 offen lds
    s_add_u32 m0, s60, 2112
    s_mov_b32 s3, 5376
    buffer_load_dwordx4 v242, s[12:15], s3 offen lds
    s_add_u32 m0, s60, 3168
    s_mov_b32 s3, 8064
    buffer_load_dwordx4 v242, s[12:15], s3 offen lds
    s_add_u32 m0, s60, 4224
    s_mov_b32 s3, 10752
    buffer_load_dwordx4 v242, s[12:15], s3 offen lds
    s_add_u32 m0, s60, 5280
    s_mov_b32 s3, 13440
    buffer_load_dwordx4 v242, s[12:15], s3 offen lds
    s_add_u32 m0, s60, 6336
    s_mov_b32 s3, 16128
    buffer_load_dwordx4 v242, s[12:15], s3 offen lds
    s_add_u32 m0, s60, 7392
    s_mov_b32 s3, 18816
    buffer_load_dwordx4 v242, s[12:15], s3 offen lds
    s_mul_i32 s53, s101, 37
    s_lshr_b32 s53, s53, 8
    s_mul_i32 s54, s53, 7
    s_sub_u32 s54, s101, s54
    s_and_b32 s53, s53, 3
    s_xor_b32 s53, s53, 0
    s_lshl_b32 s3, s6, 2
    s_add_u32 s53, s53, s3
    s_lshl_b32 s53, s53, 1
    s_add_u32 s53, s53, s7
    s_mov_b32 s42, 4096
    s_mov_b32 s43, 0x20000
    s_lshl_b32 s3, s53, 2
    s_add_u32 s3, s3, s48
    s_lshl_b32 s60, s3, 5
    v_lshl_add_u32 v82, v5, 1, s60
    s_mul_i32 s3, s3, 14336
    s_lshl_b32 s60, s54, 7
    s_add_u32 s3, s3, s60
    v_mul_u32_u24 v14, 896, v5
    v_lshl_add_u32 v14, v6, 4, v14
    v_add_u32 v85, s3, v14
    v_add_u32 v86, 7168, v85
    s_cmp_lt_u32 s101, 28
    s_cselect_b32 s56, 1, 0
    s_lshl_b32 s50, s7, 3
    s_and_b32 s3, s101, 7
    s_add_u32 s50, s50, s3
    s_lshr_b32 s60, s101, 3
    s_lshl_b32 s49, s6, 2
    s_add_u32 s49, s49, s60
    s_lshl_b32 s49, s49, 2
    s_add_u32 s49, s49, s48
    s_mul_i32 s60, s60, 0
    s_add_u32 s3, s3, s60
    s_sub_u32 s60, s3, 7
    s_cmp_ge_u32 s3, 7
    s_cselect_b32 s3, s60, s3
    s_lshl_b32 s62, s3, 18
    s_mul_i32 s63, s3, 12288
    s_mov_b32 s30, 20971520
    s_mov_b32 s31, 0x20000
    s_mov_b32 s75, 0x3727c5ac
    s_mov_b32 s76, 0x3b124925
    s_mov_b32 s77, 0x3f803f80
    v_lshlrev_b32 v4, 4, v1
    v_bfe_u32 v7, v1, 2, 2
    v_and_b32 v8, 3, v1
    v_mul_u32_u24 v13, 960, v9
    v_lshl_add_u32 v13, v10, 4, v13
    s_mul_i32 s3, s48, 1920
    s_add_u32 s3, s3, 147456
    v_add_u32 v230, s3, v13
    v_mul_u32_u24 v13, 960, v7
    v_lshl_add_u32 v13, v3, 5, v13
    v_lshl_add_u32 v13, v8, 3, v13
    s_lshl_b32 s3, s48, 8
    s_add_u32 s3, s3, 147456
    v_add_u32 v231, s3, v13
    s_lshl_b32 s3, s48, 3
    s_add_u32 s3, s3, 155648
    v_lshl_add_u32 v232, v9, 2, s3
    v_lshlrev_b32 v237, 2, v6
    v_and_b32 v2, 15, v1
    v_lshlrev_b32 v238, 13, v3
    v_add_lshl_u32 v238, v238, v2, 3
    v_add_u32 v237, 155648, v237
    v_lshlrev_b32 v13, 17, v9
    v_lshl_add_u32 v233, v10, 4, v13
    s_cmp_eq_u32 s48, 3
    s_cselect_b32 s60, 268435456, 0
    s_lshl_b32 s70, s48, 10
    s_add_u32 s70, s70, s2
    s_lshl_b32 s70, s70, 9
    s_add_u32 s71, s70, 262144
    s_add_u32 s71, s71, s60
    s_xor_b32 s60, s60, 268435456
    s_lshl_b32 s72, s2, 7
    s_add_u32 s72, s72, s60
    s_add_u32 s72, s72, 6291456
    s_lshr_b32 s74, s2, 2
    s_lshl_b32 s74, s74, 4
    s_and_b32 s3, s2, 3
    s_add_u32 s74, s74, s3
    s_lshl_b32 s74, s74, 2
    s_add_u32 s74, s74, 10485760
    v_cmp_gt_u32 vcc, 8, v0
    v_lshlrev_b32 v236, 13, v0
    v_mov_b32 v13, 268435456
    s_and_b32 s3, s2, 7
    s_lshl_b32 s3, s3, 13
    s_add_u32 s3, s3, 10485760
    v_lshrrev_b32 v14, 2, v0
    v_lshl_add_u32 v14, v14, 6, s3
    v_and_b32 v15, 3, v0
    v_lshl_add_u32 v20, v15, 2, v14
    v_cndmask_b32 v236, v13, v236, vcc
    v_mov_b32 v16, 0
    s_lshl_b32 s3, s48, 14
    s_add_u32 s74, s74, s3
    s_add_u32 s73, s74, 8192
    s_waitcnt vmcnt(10)
    v_dot2_f32_bf16 v226, v182, s77, 0
    v_dot2_f32_bf16 v227, v182, v182, 0
    v_dot2_f32_bf16 v226, v183, s77, v226
    v_dot2_f32_bf16 v227, v183, v183, v227
    v_dot2_f32_bf16 v226, v184, s77, v226
    v_dot2_f32_bf16 v227, v184, v184, v227
    v_dot2_f32_bf16 v226, v185, s77, v226
    v_dot2_f32_bf16 v227, v185, v185, v227
    s_waitcnt vmcnt(9)
    v_dot2_f32_bf16 v226, v186, s77, v226
    v_dot2_f32_bf16 v227, v186, v186, v227
    v_dot2_f32_bf16 v226, v187, s77, v226
    v_dot2_f32_bf16 v227, v187, v187, v227
    v_dot2_f32_bf16 v226, v188, s77, v226
    v_dot2_f32_bf16 v227, v188, v188, v227
    v_dot2_f32_bf16 v226, v189, s77, v226
    v_dot2_f32_bf16 v227, v189, v189, v227
    buffer_load_dword v12, v16, s[44:47], 0 offen sc1
    v_lshlrev_b32 v190, 16, v182
    v_and_b32 v191, 0xffff0000, v182
    v_add_f32_dpp v226, v226, v226 quad_perm:[1,0,3,2] row_mask:0xf bank_mask:0xf
    v_add_f32_dpp v227, v227, v227 quad_perm:[1,0,3,2] row_mask:0xf bank_mask:0xf
    v_lshlrev_b32 v192, 16, v183
    v_add_f32_dpp v226, v226, v226 quad_perm:[2,3,0,1] row_mask:0xf bank_mask:0xf
    v_add_f32_dpp v227, v227, v227 quad_perm:[2,3,0,1] row_mask:0xf bank_mask:0xf
    v_and_b32 v193, 0xffff0000, v183
    v_add_f32_dpp v226, v226, v226 row_half_mirror row_mask:0xf bank_mask:0xf
    v_add_f32_dpp v227, v227, v227 row_half_mirror row_mask:0xf bank_mask:0xf
    v_lshlrev_b32 v194, 16, v184
    v_add_f32_dpp v226, v226, v226 row_mirror row_mask:0xf bank_mask:0xf
    v_add_f32_dpp v227, v227, v227 row_mirror row_mask:0xf bank_mask:0xf
    v_and_b32 v195, 0xffff0000, v184
    v_mov_b32 v228, v226
    v_mov_b32 v229, v227
    v_lshlrev_b32 v196, 16, v185
    v_permlane16_swap_b32 v226, v228
    v_permlane16_swap_b32 v227, v229
    v_add_f32 v226, v226, v228
    v_add_f32 v227, v227, v229
    v_mul_f32_e64 v226, -v226, s76
    v_mul_f32 v228, v226, v226
    v_fma_f32 v227, v227, s76, -v228
    v_max_f32 v227, 0, v227
    v_add_f32 v228, s75, v227
    v_rsq_f32 v222, v228
    v_and_b32 v197, 0xffff0000, v185
    v_mul_f32 v228, v222, v222
    v_fma_f32 v229, v228, v227, s75
    v_rsq_f32 v228, v229
    v_mul_f32 v223, v226, v222
    v_mul_f32 v224, v222, v228
    v_mul_f32 v225, v223, v228
    v_mul_f32 v229, v229, v228
    ds_write_b32 v232, v229
    v_lshlrev_b32 v198, 16, v186
    v_and_b32 v199, 0xffff0000, v186
    v_lshlrev_b32 v200, 16, v187
    v_and_b32 v201, 0xffff0000, v187
    v_lshlrev_b32 v202, 16, v188
    v_and_b32 v203, 0xffff0000, v188
    v_lshlrev_b32 v204, 16, v189
    v_and_b32 v205, 0xffff0000, v189
    v_pk_fma_f32 v[206:207], v[190:191], v[224:225], v[224:225] op_sel:[0,0,1] op_sel_hi:[1,0,1]
    v_pk_fma_f32 v[208:209], v[192:193], v[224:225], v[224:225] op_sel:[0,0,1] op_sel_hi:[1,0,1]
    v_pk_fma_f32 v[210:211], v[194:195], v[224:225], v[224:225] op_sel:[0,0,1] op_sel_hi:[1,0,1]
    v_pk_fma_f32 v[212:213], v[196:197], v[224:225], v[224:225] op_sel:[0,0,1] op_sel_hi:[1,0,1]
    v_cvt_pk_bf16_f32 v182, v206, v207
    v_cvt_pk_bf16_f32 v183, v208, v209
    v_cvt_pk_bf16_f32 v184, v210, v211
    v_cvt_pk_bf16_f32 v185, v212, v213
    ds_write_b128 v230, v[182:185] offset:0
    v_pk_fma_f32 v[214:215], v[198:199], v[224:225], v[224:225] op_sel:[0,0,1] op_sel_hi:[1,0,1]
    v_pk_fma_f32 v[216:217], v[200:201], v[224:225], v[224:225] op_sel:[0,0,1] op_sel_hi:[1,0,1]
    v_pk_fma_f32 v[218:219], v[202:203], v[224:225], v[224:225] op_sel:[0,0,1] op_sel_hi:[1,0,1]
    v_pk_fma_f32 v[220:221], v[204:205], v[224:225], v[224:225] op_sel:[0,0,1] op_sel_hi:[1,0,1]
    v_cvt_pk_bf16_f32 v186, v214, v215
    v_cvt_pk_bf16_f32 v187, v216, v217
    v_cvt_pk_bf16_f32 v188, v218, v219
    v_cvt_pk_bf16_f32 v189, v220, v221
    ds_write_b128 v230, v[186:189] offset:448
    s_waitcnt lgkmcnt(0)
    s_barrier
    ds_read_b64_tr_b16 v[110:111], v231 offset:0
    ds_read_b64_tr_b16 v[112:113], v231 offset:3840
    ds_read_b64_tr_b16 v[114:115], v231 offset:128
    ds_read_b64_tr_b16 v[116:117], v231 offset:3968
    ds_read_b32 v229, v237
    s_waitcnt lgkmcnt(3)
    buffer_store_dwordx4 v[110:113], v233, s[28:31], s70 offen sc1
    s_waitcnt lgkmcnt(1)
    buffer_store_dwordx4 v[114:117], v233, s[28:31], s71 offen sc1
    v_cmp_gt_u32 vcc, 16, v1
    s_waitcnt lgkmcnt(0)
    s_nop 0
    v_cndmask_b32 v229, 0, v229, vcc
    v_mov_b32 v228, v229
    buffer_store_dwordx2 v[228:229], v238, s[28:31], s72 offen sc1
    v_lshrrev_b32 v13, 2, v1
    v_mul_u32_u24 v13, 1056, v13
    v_lshl_add_u32 v13, v8, 3, v13
    s_mul_i32 s3, s48, 224
    v_add_u32 v243, s3, v13
    s_mov_b32 s18, 401408
    s_mov_b32 s19, 0x20000
    s_mov_b32 s26, 7340032
    s_mov_b32 s27, 0x20000
    s_mov_b32 s34, 1835008
    s_mov_b32 s35, 0x20000
    s_mov_b32 s36, 1
    v_lshrrev_b32 v14, 2, v1
    v_lshlrev_b32 v14, 7, v14
    v_lshl_add_u32 v14, v8, 3, v14
    v_and_b32 v15, 3, v5
    v_lshl_add_u32 v14, v15, 5, v14
    s_mul_i32 s3, s4, 8256
    v_xor_b32 v31, s3, v14
    v_xor_b32 v32, 32, v31
    v_xor_b32 v33, 64, v31
    v_xor_b32 v34, 96, v31
    v_add_u32 v35, 65536, v31
    v_add_u32 v36, 65536, v32
    v_add_u32 v37, 65536, v33
    v_add_u32 v38, 65536, v34
    v_add_u32 v39, 131072, v31
    v_add_u32 v40, 131072, v32
    v_add_u32 v41, 131072, v33
    v_add_u32 v42, 131072, v34
    s_lshl_b32 s6, s52, 1
    s_add_u32 s6, s6, s5
    s_lshl_b32 s3, s6, 1
    s_add_u32 s3, s3, s59
    s_lshl_b32 s3, s3, 4
    s_add_u32 s3, s3, s4
    s_lshl_b32 s3, s3, 12
    v_lshl_add_u32 v78, v3, 8, v4
    v_add_u32 v78, s3, v78
    s_xor_b32 s37, s51, 1
    s_lshl_b32 s37, s37, 3
    s_add_u32 s37, s37, s52
    s_lshl_b32 s3, s37, 14
    s_add_u32 s3, s3, s58
    s_add_u32 s3, s3, 16777216
    v_add_u32 v23, s3, v4
    s_lshl_b32 s37, s37, 5
    s_add_u32 s37, s37, s5
    s_lshl_b32 s37, s37, 2
    s_add_u32 s37, s37, 6422528
    s_mul_i32 s67, s6, 56
    s_lshl_b32 s3, s51, 1
    s_add_u32 s3, s3, s4
    s_add_u32 s67, s67, s3
    s_lshl_b32 s67, s67, 11
    s_add_u32 s67, s67, 2097152
    v_add_u32 v81, s58, v4
    s_lshl_b32 s68, s52, 2
    s_and_b32 s3, s51, 1
    s_add_u32 s68, s68, s3
    s_cmp_ge_u32 s51, 14
    s_cselect_b32 s3, 2, 0
    s_add_u32 s68, s68, s3
    s_lshl_b32 s68, s68, 7
    s_add_u32 s68, s68, 6356992
    s_waitcnt vmcnt(3)
    v_readfirstlane_b32 s57, v12
    s_mov_b32 s60, 0
    s_cmp_lg_u32 s57, 0
    s_cbranch_scc0 L_nonceh
L_nonce_okh:
    s_waitcnt vmcnt(0)
    s_barrier
    s_atomic_swap s57, s[28:29], s74
    s_atomic_swap s57, s[28:29], s73
    buffer_load_dwordx4 v[96:99], v85, s[8:11], 0 offen
    buffer_load_dwordx4 v[100:103], v86, s[8:11], 0 offen
    buffer_load_ushort v93, v82, s[40:43], 0 offen offset:0
    buffer_load_ushort v94, v82, s[40:43], 0 offen offset:16
    v_cmp_gt_u32 vcc, 12, v2
    s_mul_i32 s3, s48, 56
    s_add_u32 s3, s3, s79
    s_mul_i32 s3, s3, 3
    s_add_u32 s3, s3, s80
    s_lshl_b32 s3, s3, 11
    s_add_u32 s3, s3, 8388608
    s_add_u32 s3, s3, s81
    ds_read_b64_tr_b16 v[182:183], v243 offset:0
    ds_read_b64_tr_b16 v[184:185], v243 offset:16896
    ds_read_b64_tr_b16 v[186:187], v243 offset:32
    ds_read_b64_tr_b16 v[188:189], v243 offset:16928
    ds_read_b64_tr_b16 v[190:191], v243 offset:56
    ds_read_b64_tr_b16 v[192:193], v243 offset:16952
    ds_read_b64_tr_b16 v[194:195], v243 offset:88
    ds_read_b64_tr_b16 v[196:197], v243 offset:16984
    ds_read_b64_tr_b16 v[198:199], v243 offset:112
    ds_read_b64_tr_b16 v[200:201], v243 offset:17008
    ds_read_b64_tr_b16 v[202:203], v243 offset:144
    ds_read_b64_tr_b16 v[204:205], v243 offset:17040
    ds_read_b64_tr_b16 v[206:207], v243 offset:168
    ds_read_b64_tr_b16 v[208:209], v243 offset:17064
    ds_read_b64_tr_b16 v[210:211], v243 offset:200
    ds_read_b64_tr_b16 v[212:213], v243 offset:17096
    s_waitcnt lgkmcnt(13)
    v_cndmask_b32 v186, 0, v186, vcc
    v_cndmask_b32 v187, 0, v187, vcc
    s_waitcnt lgkmcnt(12)
    v_cndmask_b32 v188, 0, v188, vcc
    v_cndmask_b32 v189, 0, v189, vcc
    buffer_store_dwordx4 v[182:185], v4, s[28:31], s3 offen offset:0 sc1
    buffer_store_dwordx4 v[186:189], v4, s[28:31], s3 offen offset:1024 sc1
    s_add_u32 s3, s3, 86016
    s_waitcnt lgkmcnt(9)
    v_cndmask_b32 v194, 0, v194, vcc
    v_cndmask_b32 v195, 0, v195, vcc
    s_waitcnt lgkmcnt(8)
    v_cndmask_b32 v196, 0, v196, vcc
    v_cndmask_b32 v197, 0, v197, vcc
    buffer_store_dwordx4 v[190:193], v4, s[28:31], s3 offen offset:0 sc1
    buffer_store_dwordx4 v[194:197], v4, s[28:31], s3 offen offset:1024 sc1
    s_add_u32 s3, s3, 86016
    s_waitcnt lgkmcnt(5)
    v_cndmask_b32 v202, 0, v202, vcc
    v_cndmask_b32 v203, 0, v203, vcc
    s_waitcnt lgkmcnt(4)
    v_cndmask_b32 v204, 0, v204, vcc
    v_cndmask_b32 v205, 0, v205, vcc
    buffer_store_dwordx4 v[198:201], v4, s[28:31], s3 offen offset:0 sc1
    buffer_store_dwordx4 v[202:205], v4, s[28:31], s3 offen offset:1024 sc1
    s_add_u32 s3, s3, 86016
    ds_read_b32 v24, v4
    s_waitcnt lgkmcnt(2)
    v_cndmask_b32 v210, 0, v210, vcc
    v_cndmask_b32 v211, 0, v211, vcc
    ds_read_b32 v24, v4
    s_waitcnt lgkmcnt(2)
    v_cndmask_b32 v212, 0, v212, vcc
    v_cndmask_b32 v213, 0, v213, vcc
    buffer_store_dwordx4 v[206:209], v4, s[28:31], s3 offen offset:0 sc1
    buffer_store_dwordx4 v[210:213], v4, s[28:31], s3 offen offset:1024 sc1
    s_add_u32 s3, s3, 86016
    s_lshl_b32 s67, s80, 6
    s_add_u32 s67, s67, 64
    s_cmp_eq_u32 s81, 0
    s_cselect_b32 s37, s48, 1
    s_mov_b32 s68, 6369792
    s_and_b32 s3, s2, 1
    s_mul_i32 s3, s3, 3
    s_bfe_u32 s6, s2, 0x10001
    s_mul_i32 s7, s6, 6
    s_add_u32 s3, s3, s7
    s_add_u32 s3, s3, 1
    v_add_u32 v14, s3, v8
    s_mul_i32 s6, s6, 64
    s_add_u32 s6, s6, 7
    v_cmp_ne_u32 vcc, s6, v14
    v_lshrrev_b32 v15, 2, v1
    v_mul_u32_u24 v15, 3584, v15
    v_cndmask_b32 v14, 0, v14, vcc
    v_lshl_add_u32 v14, v14, 8, v15
    s_lshl_b32 s3, s52, 2
    s_add_u32 s3, s3, s48
    s_mul_i32 s3, s3, 37
    s_min_u32 s3, s3, 987
    s_mul_i32 s3, s3, 3584
    s_mul_i32 s6, s59, 3670144
    s_add_u32 s3, s3, s6
    buffer_load_dword v226, v14, s[20:23], s3 offen
    s_add_u32 s3, s3, 57344
    buffer_load_dword v227, v14, s[20:23], s3 offen
    s_add_u32 s3, s3, 57344
    v_cmp_gt_u32 vcc, 20, v1
    v_mov_b32 v15, 268435456
    s_nop 0
    v_cndmask_b32 v14, v15, v14, vcc
    buffer_load_dword v228, v14, s[20:23], s3 offen
    s_add_u32 s3, s3, 57344
    v_add_u32 v53, 65536, v4
    v_add_u32 v54, 131072, v4
    s_mul_i32 s59, s48, 3072
    s_mul_i32 s3, s50, 86016
    s_add_u32 s3, s3, s59
    s_add_u32 s3, s3, 8388608
    v_add_u32 v80, s3, v4
    v_lshlrev_b32 v14, 7, v9
    v_xor_b32 v14, v14, v4
    s_lshl_b32 s3, s49, 11
    v_add_u32 v67, s3, v14
    v_add_u32 v68, 129024, v67
    s_lshr_b32 s3, s49, 2
    s_lshl_b32 s3, s3, 3
    s_max_u32 s3, s3, 1
    s_sub_u32 s3, s3, 1
    s_lshl_b32 s3, s3, 10
    s_lshl_b32 s6, s5, 17
    s_add_u32 s3, s3, s6
    s_lshl_b32 s6, s4, 28
    s_add_u32 s3, s3, s6
    v_add_u32 v69, s3, v14
    s_lshl_b32 s100, s5, 1
    s_add_u32 s100, s100, s4
    s_lshl_b32 s100, s100, 10
    v_and_b32 v14, 1, v1
    v_mul_u32_u24 v14, 640, v14
    v_lshrrev_b32 v15, 2, v1
    v_lshlrev_b32 v15, 4, v15
    v_xor_b32 v14, v14, v15
    v_bfe_u32 v15, v1, 1, 1
    v_lshl_add_u32 v14, v15, 3, v14
    s_add_u32 s3, s58, 12288
    v_add_u32 v70, s3, v14
    s_sub_u32 s3, s3, 3072
    s_cmp_eq_u32 s48, 0
    s_cselect_b32 s3, 28672, s3
    v_add_u32 v71, s3, v14
    v_add_u32 v72, 65536, v70
    v_add_u32 v73, 65536, v71
    v_add_u32 v74, 131072, v70
    v_add_u32 v75, 131072, v71
    s_lshl_b32 s3, s49, 1
    v_min_u32 v14, 2, v3
    v_add_u32 v14, s3, v14
    v_max_u32 v14, 1, v14
    v_lshlrev_b32 v14, 1, v14
    v_and_b32 v15, 1, v7
    v_add_lshl_u32 v14, v14, v15, 7
    v_lshrrev_b32 v15, 1, v7
    v_lshl_add_u32 v15, v15, 2, v8
    v_lshl_add_u32 v14, v15, 3, v14
    v_add_u32 v77, 6291200, v14
    s_min_u32 s15, s48, 2
    s_lshl_b32 s15, s15, 6
    s_add_u32 s15, s15, 64
    s_lshl_b32 s82, s49, 5
    s_add_u32 s82, s82, s50
    s_lshl_b32 s82, s82, 10
    s_add_u32 s82, s82, 4194304
    s_lshr_b32 s69, s49, 2
    s_lshl_b32 s69, s69, 1
    s_and_b32 s3, s50, 1
    s_add_u32 s69, s69, s3
    s_lshl_b32 s69, s69, 7
    s_add_u32 s69, s69, 6361088
    s_and_b32 s7, s53, 1
    s_mul_i32 s3, s7, 28
    s_add_u32 s3, s3, s48
    s_lshl_b32 s3, s3, 17
    s_xor_b32 s6, s53, 1
    s_lshl_b32 s55, s6, 3
    s_lshl_b32 s6, s53, 7
    s_add_u32 s3, s3, s6
    v_lshlrev_b32 v14, 12, v5
    v_add3_u32 v59, v14, v83, s3
    v_add_u32 v60, 31744, v59
    v_add_u32 v61, 63488, v59
    v_add_u32 v62, 95232, v59
    v_mul_u32_u24 v14, 896, v5
    s_mul_i32 s3, s4, 25088
    s_mul_i32 s6, s5, 14336
    s_add_u32 s3, s3, s6
    s_lshl_b32 s6, s54, 7
    s_add_u32 s3, s3, s6
    v_add3_u32 v63, v14, v83, s3
    v_add_u32 v64, 6144, v63
    s_lshl_b32 s6, s53, 1
    s_add_u32 s6, s6, s5
    s_and_b32 s3, s53, 30
    s_add_u32 s3, s3, s4
    s_lshl_b32 s3, s3, 7
    s_add_u32 s39, s3, 6361088
    s_lshl_b32 s3, s6, 5
    s_add_u32 s3, s3, s4
    s_lshl_b32 s3, s3, 10
    s_add_u32 s3, s3, 4194304
    v_add_u32 v65, s3, v4
    v_add_u32 v66, 15360, v65
    s_xor_b32 s3, s4, s5
    s_lshl_b32 s3, s3, 6
    v_xor_b32 v43, s3, v31
    v_xor_b32 v44, 32, v43
    v_add_u32 v45, 65536, v43
    v_add_u32 v46, 65536, v44
    s_mul_i32 s3, s4, 12288
    v_add_u32 v47, s3, v4
    v_xor_b32 v48, 4096, v47
    v_add_u32 v49, 65536, v47
    v_add_u32 v50, 65536, v48
    v_add_u32 v51, 131072, v47
    v_add_u32 v52, 131072, v48
    s_lshl_b32 s6, s54, 1
    s_add_u32 s6, s6, s5
    s_lshl_b32 s3, s6, 1
    s_add_u32 s3, s3, s7
    s_mul_i32 s3, s3, 14
    s_add_u32 s3, s3, s4
    s_lshl_b32 s3, s3, 12
    s_add_u32 s3, s3, 2097152
    v_add_u32 v79, s3, v4
    s_lshl_b32 s3, s54, 1
    s_add_u32 s3, s3, s7
    s_lshl_b32 s3, s3, 1
    s_add_u32 s3, s3, s4
    s_lshl_b32 s3, s3, 7
    s_add_u32 s38, s3, 6356992
    s_and_b32 s3, s2, 6
    s_add_u32 s3, s3, s54
    s_sub_u32 s6, s3, 7
    s_cmp_ge_u32 s3, 7
    s_cselect_b32 s3, s6, s3
    s_lshl_b32 s64, s3, 19
    s_lshl_b32 s65, s3, 13
    s_add_u32 s55, s55, s54
    s_lshl_b32 s3, s55, 14
    s_add_u32 s3, s3, s58
    s_add_u32 s3, s3, 12582912
    v_add_u32 v21, s3, v4
    s_lshl_b32 s55, s55, 5
    s_add_u32 s55, s55, s48
    s_lshl_b32 s55, s55, 2
    s_add_u32 s55, s55, 6488064
    s_lshl_b32 s3, s5, 3
    v_add_u32 v13, s3, v3
    v_xor_b32 v13, v13, v6
    v_lshlrev_b32 v13, 4, v13
    v_lshl_add_u32 v13, v2, 8, v13
    s_lshl_b32 s3, s4, 14
    s_add_u32 s3, s3, 32768
    v_add_u32 v87, s3, v13
    v_xor_b32 v88, 64, v87
    s_lshr_b32 s3, s53, 1
    s_add_u32 s66, s3, s54
    s_mov_b32 s51, s66
    v_lshlrev_b32 v13, 1, v6
    v_xor_b32 v13, v13, v5
    v_lshlrev_b32 v13, 4, v13
    v_lshl_add_u32 v13, v5, 8, v13
    s_add_u32 s3, s58, 32768
    v_add_u32 v89, s3, v13
    v_xor_b32 v90, 16, v89
    v_xor_b32 v91, 24576, v89
    v_xor_b32 v92, 24592, v89
    s_mov_b32 s70, 0xaaaaaaaa
    s_mov_b32 s71, 0xaaaaaaaa
    s_mov_b32 s72, 0xfff0ffff
    s_mov_b32 s73, 0xf000ff00
    s_mov_b32 s74, 0xffc0fffc
    s_mov_b32 s75, 0xc000fc00
    s_cmp_eq_u32 s49, 0
    s_cselect_b64 s[76:77], 0, -1
    v_mov_b32 v13, 0xffff
    v_mov_b32 v14, 0xffff0000
    v_cndmask_b32 v13, v13, v14, s[70:71]
    v_cndmask_b32 v104, v13, 0, s[72:73]
    v_cndmask_b32 v106, 0, v13, s[72:73]
    v_cndmask_b32 v105, v13, 0, s[74:75]
    v_cndmask_b32 v107, 0, v13, s[74:75]
    v_mov_b32 v84, 0xf149f2ca
    s_mov_b32 s83, 0x3e8b97f6
    s_mov_b32 s78, 0xbdd2d3e8
    s_mov_b32 s79, 0xbdd2d3e8
    s_mov_b32 s80, 1.0
    s_mov_b32 s81, 1.0
    v_mov_b32 v108, 0xc0135761
    v_mov_b32 v109, 0xc0135761
    v_lshrrev_b32 v13, 1, v2
    v_lshlrev_b32 v14, 1, v3
    v_sub_u32 v13, v13, v14
    v_mov_b32 v14, 0x3f80
    v_cndmask_b32 v14, v14, 1.0, s[70:71]
    v_cmp_eq_i32 vcc, 0, v13
    v_accvgpr_write_b32 a248, 0
    v_accvgpr_write_b32 a252, 0
    v_cndmask_b32 v15, 0, v14, vcc
    v_accvgpr_write_b32 a250, v15
    v_cmp_eq_i32 vcc, 1, v13
    v_accvgpr_write_b32 a249, 0
    v_accvgpr_write_b32 a253, 0
    v_cndmask_b32 v15, 0, v14, vcc
    v_accvgpr_write_b32 a251, v15
    s_waitcnt vmcnt(3)
    s_barrier
    s_cmp_lg_u32 s37, 0
    s_cbranch_scc1 L_nowsig
    s_atomic_add s36, s[44:45], s67
L_nowsig:
    buffer_load_dword v18, v20, s[28:31], 0 offen sc1
    s_mov_b32 s26, 7340032
    s_and_b32 s3, s2, 1
    s_mul_i32 s3, s3, 7
    s_add_u32 s3, s3, s52
    s_lshl_b32 s3, s3, 2
    s_add_u32 s3, s3, s48
    s_lshl_b32 s3, s3, 17
    s_and_b32 s6, s2, 6
    s_lshl_b32 s6, s6, 9
    s_add_u32 s3, s3, s6
    v_lshlrev_b32 v242, 12, v10
    v_mul_u32_u24 v243, 512, v9
    v_add_u32 v243, v242, v243
    buffer_load_dword v232, v243, s[24:27], s3 offen offset:384
    v_mul_u32_u24 v243, 512, v9
    v_add_u32 v243, v242, v243
    buffer_load_dword v233, v243, s[24:27], s3 offen offset:256
    s_cmp_eq_u32 s56, 0
    s_cselect_b32 s26, 0, s26
    s_cmp_eq_u32 s56, 0
    s_cselect_b32 s26, 0, s26
    v_and_b32 v13, 0xfffff000, v78
    v_lshl_add_u32 v13, v10, 7, v13
    s_add_u32 s3, s1, 8192
    v_lshl_add_u32 v14, v9, 13, s3
    s_waitcnt vmcnt(2)
    v_cmp_ne_u32 vcc, s57, v18
    s_cbranch_vccnz L_pollin3
L_pollok3:
    s_mov_b32 s14, 0
    s_load_dword s14, s[44:45], s15
    s_barrier
    buffer_load_dword v76, v77, s[28:31], 0 offen sc1
    s_cmp_ge_u32 s14, 14
    s_cbranch_scc0 L_pollin4
L_pollok4:
    s_barrier
    s_cmp_eq_u32 s56, 0
    s_cselect_b32 s3, 268435456, 0
    v_add_u32 v79, s3, v79
    s_mov_b32 s26, 7340032
    s_and_b32 s3, s54, 1
    s_lshl_b32 s3, s3, 2
    s_lshr_b32 s6, s54, 1
    s_add_u32 s3, s3, s6
    s_lshl_b32 s3, s3, 7
    s_cmp_eq_u32 s56, 0
    s_cselect_b32 s3, s3, 0
    v_xor_b32 v59, s3, v59
    v_xor_b32 v60, s3, v60
    v_xor_b32 v61, s3, v61
    v_xor_b32 v62, s3, v62
    s_add_u32 m0, s59, 98304
    s_nop 0
    buffer_load_dwordx4 v80, s[28:31], s63 offen sc1 lds
    buffer_load_dwordx4 v80, s[28:31], s63 offen offset:1024 sc1 lds
    buffer_load_dwordx4 v80, s[28:31], s63 offen offset:2048 sc1 lds
    s_add_u32 m0, s100, 126976
    s_nop 0
    buffer_load_dwordx4 v69, s[28:31], s62 offen sc1 lds
    s_add_u32 m0, s58, 110592
    s_nop 0
    buffer_load_dwordx4 v67, s[28:31], s62 offen sc1 lds
    buffer_load_dwordx4 v67, s[28:31], s62 offen offset:1024 sc1 lds
    buffer_load_dwordx4 v68, s[28:31], s62 offen offset:2048 sc1 lds
    buffer_load_dwordx4 v68, s[28:31], s62 offen offset:3072 sc1 lds
    s_add_u32 m0, s59, 131072
    s_add_u32 s63, s63, 12288
    s_cmp_eq_u32 s63, 86016
    s_cselect_b32 s63, 0, s63
    buffer_load_dwordx4 v80, s[28:31], s63 offen sc1 lds
    buffer_load_dwordx4 v80, s[28:31], s63 offen offset:1024 sc1 lds
    buffer_load_dwordx4 v80, s[28:31], s63 offen offset:2048 sc1 lds
    s_add_u32 m0, s100, 159744
    s_add_u32 s62, s62, 262144
    s_cmp_eq_u32 s62, 1835008
    s_cselect_b32 s62, 0, s62
    buffer_load_dwordx4 v69, s[28:31], s62 offen sc1 lds
    s_add_u32 m0, s58, 143360
    s_nop 0
    buffer_load_dwordx4 v67, s[28:31], s62 offen sc1 lds
    buffer_load_dwordx4 v67, s[28:31], s62 offen offset:1024 sc1 lds
    buffer_load_dwordx4 v68, s[28:31], s62 offen offset:2048 sc1 lds
    buffer_load_dwordx4 v68, s[28:31], s62 offen offset:3072 sc1 lds
    s_add_u32 m0, s59, 0
    s_add_u32 s63, s63, 12288
    s_cmp_eq_u32 s63, 86016
    s_cselect_b32 s63, 0, s63
    buffer_load_dwordx4 v80, s[28:31], s63 offen sc1 lds
    buffer_load_dwordx4 v80, s[28:31], s63 offen offset:1024 sc1 lds
    buffer_load_dwordx4 v80, s[28:31], s63 offen offset:2048 sc1 lds
    s_add_u32 m0, s100, 28672
    s_add_u32 s62, s62, 262144
    s_cmp_eq_u32 s62, 1835008
    s_cselect_b32 s62, 0, s62
    buffer_load_dwordx4 v69, s[28:31], s62 offen sc1 lds
    s_add_u32 m0, s58, 12288
    s_nop 0
    buffer_load_dwordx4 v67, s[28:31], s62 offen sc1 lds
    buffer_load_dwordx4 v67, s[28:31], s62 offen offset:1024 sc1 lds
    buffer_load_dwordx4 v68, s[28:31], s62 offen offset:2048 sc1 lds
    buffer_load_dwordx4 v68, s[28:31], s62 offen offset:3072 sc1 lds
    s_add_u32 m0, s59, 65536
    s_add_u32 s63, s63, 12288
    s_cmp_eq_u32 s63, 86016
    s_cselect_b32 s63, 0, s63
    buffer_load_dwordx4 v80, s[28:31], s63 offen sc1 lds
    buffer_load_dwordx4 v80, s[28:31], s63 offen offset:1024 sc1 lds
    buffer_load_dwordx4 v80, s[28:31], s63 offen offset:2048 sc1 lds
    s_add_u32 m0, s100, 94208
    s_add_u32 s62, s62, 262144
    s_cmp_eq_u32 s62, 1835008
    s_cselect_b32 s62, 0, s62
    buffer_load_dwordx4 v69, s[28:31], s62 offen sc1 lds
    s_add_u32 m0, s58, 77824
    s_nop 0
    buffer_load_dwordx4 v67, s[28:31], s62 offen sc1 lds
    buffer_load_dwordx4 v67, s[28:31], s62 offen offset:1024 sc1 lds
    buffer_load_dwordx4 v68, s[28:31], s62 offen offset:2048 sc1 lds
    buffer_load_dwordx4 v68, s[28:31], s62 offen offset:3072 sc1 lds
    s_mov_b32 s3, 268435456
    buffer_store_dword v12, v11, s[28:31], s3 offen
    buffer_store_dword v12, v11, s[28:31], s3 offen
    v_lshlrev_b32 v13, 2, v2
    v_and_b32 v14, 1, v1
    v_lshl_add_u32 v14, v3, 2, v14
    v_lshlrev_b32 v14, 2, v14
    v_add_u32 v15, 64, v14
    v_cndmask_b32 v16, v14, v15, s[72:73]
    v_cndmask_b32 v14, v14, v15, s[74:75]
    s_waitcnt vmcnt(34)
    ds_bpermute_b32 v25, v13, v76 offset:64
    ds_bpermute_b32 v27, v16, v76 offset:0
    ds_bpermute_b32 v28, v14, v76 offset:8
    ds_bpermute_b32 v26, v13, v76 offset:128
    ds_bpermute_b32 v29, v16, v76 offset:64
    ds_bpermute_b32 v30, v14, v76 offset:72
    s_waitcnt lgkmcnt(5)
    v_mul_f32 v25, s83, v25
    ds_read_b32 v24, v4
    s_waitcnt lgkmcnt(3)
    v_mul_f32 v26, s83, v26
    ds_read_b32 v24, v4
    ds_read_b32 v24, v4
    ds_read_b32 v24, v4
    s_waitcnt vmcnt(18) lgkmcnt(3)
    s_barrier
    ds_read_b64_tr_b16 a[180:181], v72 offset:32768
    ds_read_b64_tr_b16 a[182:183], v72 offset:33024
    ds_read_b128 a[128:131], v53 offset:32768
    ds_read_b64_tr_b16 a[184:185], v72 offset:33792
    ds_read_b64_tr_b16 a[186:187], v72 offset:34048
    ds_read_b128 a[132:135], v53 offset:33792
    ds_read_b128 a[136:139], v53 offset:34816
    ds_read_b64_tr_b16 a[176:177], v73 offset:32768
    ds_read_b64_tr_b16 a[178:179], v73 offset:33024
    ds_read_b128 a[140:143], v53 offset:35840
    ds_read_b128 a[144:147], v53 offset:36864
    ds_read_b128 a[148:151], v53 offset:37888
    s_waitcnt lgkmcnt(0)
    s_nop 3
    s_branch L_q
L_pollin5:
    s_waitcnt lgkmcnt(0)
    s_cmp_ge_u32 s14, 7
    s_cbranch_scc1 L_pollok5
    s_cmp_eq_u32 s56, 0
    s_cbranch_scc1 L_pollok5
    s_mov_b32 s60, 0
    s_branch L_poll5a
L_poll5:
    s_sleep 8
L_poll5a:
    buffer_load_dword v18, off, s[28:31], s38 sc1
    s_add_u32 s60, s60, 1
    s_waitcnt vmcnt(0)
    v_readfirstlane_b32 s14, v18
    s_nop 0
    s_cmp_ge_u32 s14, 7
    s_cbranch_scc1 L_pollok5
    s_cmp_lt_u32 s60, 20000
    s_cbranch_scc1 L_poll5
    s_branch L_pollok5
L_nof:
    v_min_u32 v14, 48, v1
    s_lshl_b32 s3, s54, 2
    s_add_u32 s3, s3, s48
    s_mul_i32 s3, s3, 25088
    v_lshl_add_u32 v14, v14, 7, s3
    s_add_u32 s3, s2, 0
    s_and_b32 s3, s3, 3
    s_mul_i32 s3, s3, 6272
    buffer_load_dword v182, v14, s[16:19], s3 offen
    s_waitcnt vmcnt(1)
    s_barrier
    s_cmp_lg_u32 s48, 0
    s_cbranch_scc1 L_sig3
    s_atomic_add s36, s[28:29], s69
L_sig3:
    s_add_u32 s3, s2, 1
    s_and_b32 s3, s3, 3
    s_mul_i32 s3, s3, 6272
    buffer_load_dword v183, v14, s[16:19], s3 offen
    s_add_u32 s3, s2, 2
    s_and_b32 s3, s3, 3
    s_mul_i32 s3, s3, 6272
    buffer_load_dword v184, v14, s[16:19], s3 offen
    s_add_u32 s3, s2, 3
    s_and_b32 s3, s3, 3
    s_mul_i32 s3, s3, 6272
    buffer_load_dword v185, v14, s[16:19], s3 offen
    s_branch L_fin
L_pollin6:
    s_waitcnt lgkmcnt(0)
    s_cmp_ge_u32 s14, 8
    s_cbranch_scc1 L_pollok6
    s_mov_b32 s60, 0
    s_branch L_poll6a
L_poll6:
    s_sleep 8
L_poll6a:
    buffer_load_dword v18, off, s[28:31], s39 sc1
    s_add_u32 s60, s60, 1
    s_waitcnt vmcnt(0)
    v_readfirstlane_b32 s14, v18
    s_nop 0
    s_cmp_ge_u32 s14, 8
    s_cbranch_scc1 L_pollok6
    s_cmp_lt_u32 s60, 20000
    s_cbranch_scc1 L_poll6
    s_branch L_pollok6
L_pollin7:
    s_waitcnt lgkmcnt(0)
    s_cmp_ge_u32 s14, 1
    s_cbranch_scc1 L_pollok7
    s_mov_b32 s60, 0
    s_branch L_poll7a
L_poll7:
    s_sleep 4
L_poll7a:
    buffer_load_dword v18, off, s[28:31], s55 sc1
    s_add_u32 s60, s60, 1
    s_waitcnt vmcnt(0)
    v_readfirstlane_b32 s14, v18
    s_nop 0
    s_cmp_ge_u32 s14, 1
    s_cbranch_scc1 L_pollok7
    s_cmp_lt_u32 s60, 20000
    s_cbranch_scc1 L_poll7
    s_branch L_pollok7
L_last:
    s_endpgm
.section .rodata,"a"
.p2align 6
.amdhsa_kernel parallel_sum__sliding_local_dilated__mixer_token_mlp__prompt_kernel
  .amdhsa_next_free_vgpr 512
  .amdhsa_next_free_sgpr 102
  .amdhsa_accum_offset 256
  .amdhsa_group_segment_fixed_size 0
  .amdhsa_kernarg_size 88
  .amdhsa_user_sgpr_count 2
  .amdhsa_user_sgpr_kernarg_segment_ptr 1
  .amdhsa_system_sgpr_workgroup_id_x 1
.end_amdhsa_kernel
```

```asm
; @launch grid=(256,1,1) block=(256,1,1) lds=163840
.amdgcn_target "amdgcn-amd-amdhsa--gfx950"
.text
.globl parallel_sum__sliding_local_dilated__mixer_token_mlp__prompt_kernel
.p2align 8
.type parallel_sum__sliding_local_dilated__mixer_token_mlp__prompt_kernel,@function
parallel_sum__sliding_local_dilated__mixer_token_mlp__prompt_kernel:
    s_cmp_ge_u32 s2, 256
    s_cbranch_scc1 L_end
    s_load_dwordx2 s[8:9], s[0:1], 0
    s_load_dwordx2 s[20:21], s[0:1], 32
    s_load_dwordx2 s[28:29], s[0:1], 80
    s_load_dwordx2 s[44:45], s[0:1], 72
    s_load_dwordx2 s[12:13], s[0:1], 8
    s_load_dwordx2 s[16:17], s[0:1], 16
    s_load_dwordx2 s[24:25], s[0:1], 48
    s_load_dwordx2 s[32:33], s[0:1], 64
    s_load_dwordx2 s[36:37], s[0:1], 40
    s_load_dwordx2 s[40:41], s[0:1], 56
    s_memrealtime s[78:79]
    s_getpc_b64 s[6:7]
L_pc:
    s_and_b32 s3, s2, 0xf8
    v_lshrrev_b32 v13, 5, v0
    v_add_lshl_u32 v13, s3, v13, 7
    v_min_u32 v13, L_last-L_pc, v13
    global_load_dword v18, v13, s[6:7]
    v_lshrrev_b32 v13, 6, v0
    v_and_b32 v10, 31, v0
    v_readfirstlane_b32 s48, v13
    v_bfe_u32 v9, v0, 5, 1
    v_mul_u32_u24 v14, 896, v9
    v_lshl_add_u32 v14, v10, 4, v14
    v_cmp_gt_u32 vcc, 28, v10
    v_mov_b32 v15, 268435456
    s_mov_b32 s10, 1835008
    s_mov_b32 s11, 0x20000
    v_cndmask_b32 v14, v15, v14, vcc
    s_lshr_b32 s4, s48, 1
    s_and_b32 s5, s48, 1
    s_and_b32 s3, s2, 0xfe
    s_add_u32 s3, s3, s4
    s_lshl_b32 s3, s3, 1
    s_and_b32 s60, s2, 1
    s_add_u32 s3, s3, s60
    s_lshl_b32 s3, s3, 1
    s_add_u32 s3, s3, s5
    s_mul_i32 s3, s3, 1792
    s_waitcnt lgkmcnt(0)
    buffer_load_dwordx4 v[182:185], v14, s[8:11], s3 offen
    buffer_load_dwordx4 v[186:189], v14, s[8:11], s3 offen offset:448
    v_and_b32 v1, 63, v0
    s_mov_b32 s46, 256
    s_mov_b32 s47, 0x20000
    s_lshl_b32 s3, s48, 8
    s_add_u32 s3, s3, s2
    s_cmp_lt_u32 s3, 8
    s_cselect_b32 s3, 0, 268435456
    s_or_b32 s78, s78, 1
    v_mov_b32 v234, s78
    v_mov_b32 v235, 0
    v_lshlrev_b32 v11, 25, v1
    buffer_atomic_cmpswap v[234:235], v11, s[44:47], s3 offen sc1
    s_bfe_u32 s6, s2, 0x20001
    s_and_b32 s7, s2, 1
    s_and_b32 s61, s2, 7
    s_lshr_b32 s101, s2, 3
    s_mul_i32 s52, s7, 25
    s_add_u32 s52, s52, s101
    s_mul_i32 s51, s52, 37
    s_lshr_b32 s51, s51, 8
    s_mul_i32 s3, s51, 7
    s_sub_u32 s52, s52, s3
    s_and_b32 s3, s6, 1
    s_mul_i32 s3, s3, 6
    s_add_u32 s51, s51, s3
    s_add_u32 s51, s51, 1
    s_add_u32 s3, s3, s51
    s_cmp_eq_u32 s3, 7
    s_cselect_b32 s51, 0, s51
    s_lshr_b32 s59, s6, 1
    s_lshl_b32 s51, s51, 1
    s_add_u32 s51, s51, s59
    s_max_u32 s60, s101, 25
    s_sub_u32 s60, s60, 25
    s_add_u32 s3, s101, s7
    s_cmp_lt_u32 s3, 25
    s_cselect_b32 s55, 1, 0
    s_cselect_b32 s52, s52, s60
    s_mov_b32 s22, 7340032
    s_mov_b32 s23, 0x20000
    s_lshl_b32 s3, s52, 1
    s_sub_u32 s60, s3, 7
    s_cmp_ge_u32 s3, 7
    s_cselect_b32 s3, s60, s3
    s_and_b32 s3, s3, 7
    s_mul_i32 s60, s61, 3
    s_add_u32 s3, s3, s60
    s_and_b32 s3, s3, 7
    s_mul_i32 s0, s3, 458752
    s_lshl_b32 s1, s3, 13
    s_lshl_b32 s58, s48, 12
    v_lshrrev_b32 v3, 4, v1
    v_lshrrev_b32 v5, 3, v1
    v_and_b32 v6, 7, v1
    v_lshlrev_b32 v14, 1, v3
    v_xor_b32 v14, v14, v6
    v_lshlrev_b32 v83, 4, v14
    s_cmp_eq_u32 s55, 0
    s_cbranch_scc1 L_nog1
    v_mul_u32_u24 v14, 3584, v5
    s_lshl_b32 s3, s59, 5
    s_add_u32 s3, s3, s48
    s_mul_i32 s3, s3, 114688
    s_lshl_b32 s60, s51, 7
    s_add_u32 s3, s3, s60
    v_add3_u32 v55, v14, v83, s3
    v_add_u32 v56, 56320, v55
    v_add_u32 v57, 26624, v55
    v_add_u32 v58, 82944, v55
    s_mov_b32 s38, 3584
    s_mov_b32 s39, 0x20000
    v_lshlrev_b32 v13, 3, v3
    s_lshl_b32 s3, s51, 1
    s_add_u32 s3, s3, s4
    s_lshl_b32 s3, s3, 6
    buffer_load_dwordx2 v[246:247], v13, s[36:39], s3 offen offset:0
    buffer_load_dwordx2 v[248:249], v13, s[36:39], s3 offen offset:32
    s_add_u32 m0, s58, 0
    v_xor_b32 v55, 128, v55
    buffer_load_dwordx4 v55, s[20:23], s0 offen lds
    v_xor_b32 v56, 128, v56
    buffer_load_dwordx4 v56, s[20:23], s0 offen offset:1024 lds
    v_xor_b32 v57, 128, v57
    buffer_load_dwordx4 v57, s[20:23], s0 offen offset:2048 lds
    v_xor_b32 v58, 128, v58
    buffer_load_dwordx4 v58, s[20:23], s0 offen offset:3072 lds
    s_mul_i32 s53, s101, 37
    s_lshr_b32 s53, s53, 8
    s_mul_i32 s54, s53, 7
    s_sub_u32 s54, s101, s54
    s_and_b32 s53, s53, 3
    s_xor_b32 s53, s53, 0
    s_lshl_b32 s3, s6, 2
    s_add_u32 s53, s53, s3
    s_lshl_b32 s53, s53, 1
    s_add_u32 s53, s53, s7
    s_mov_b32 s42, 4096
    s_mov_b32 s43, 0x20000
    s_lshl_b32 s3, s53, 2
    s_add_u32 s3, s3, s48
    s_lshl_b32 s60, s3, 5
    v_lshl_add_u32 v82, v5, 1, s60
    s_mul_i32 s3, s3, 14336
    s_lshl_b32 s60, s54, 7
    s_add_u32 s3, s3, s60
    v_mul_u32_u24 v14, 896, v5
    v_lshl_add_u32 v14, v6, 4, v14
    v_add_u32 v85, s3, v14
    v_add_u32 v86, 7168, v85
    s_cmp_lt_u32 s101, 28
    s_cselect_b32 s56, 1, 0
    s_lshl_b32 s50, s7, 3
    s_and_b32 s3, s101, 7
    s_add_u32 s50, s50, s3
    s_lshr_b32 s60, s101, 3
    s_lshl_b32 s49, s6, 2
    s_add_u32 s49, s49, s60
    s_lshl_b32 s49, s49, 2
    s_add_u32 s49, s49, s48
    s_mul_i32 s60, s60, 0
    s_add_u32 s3, s3, s60
    s_sub_u32 s60, s3, 7
    s_cmp_ge_u32 s3, 7
    s_cselect_b32 s3, s60, s3
    s_lshl_b32 s62, s3, 18
    s_mul_i32 s63, s3, 12288
    s_mov_b32 s30, 20971520
    s_mov_b32 s31, 0x20000
    s_mov_b32 s75, 0x3727c5ac
    s_mov_b32 s76, 0x3b124925
    s_mov_b32 s77, 0x3f803f80
    v_lshlrev_b32 v4, 4, v1
    v_bfe_u32 v7, v1, 2, 2
    v_and_b32 v8, 3, v1
    v_mul_u32_u24 v13, 960, v9
    v_lshl_add_u32 v13, v10, 4, v13
    s_mul_i32 s3, s48, 1920
    s_add_u32 s3, s3, 147456
    v_add_u32 v230, s3, v13
    v_mul_u32_u24 v13, 960, v7
    v_lshl_add_u32 v13, v3, 5, v13
    v_lshl_add_u32 v13, v8, 3, v13
    s_lshl_b32 s3, s48, 8
    s_add_u32 s3, s3, 147456
    v_add_u32 v231, s3, v13
    s_lshl_b32 s3, s48, 3
    s_add_u32 s3, s3, 155648
    v_lshl_add_u32 v232, v9, 2, s3
    v_lshlrev_b32 v237, 2, v6
    v_and_b32 v2, 15, v1
    v_lshlrev_b32 v238, 13, v3
    v_add_lshl_u32 v238, v238, v2, 3
    v_add_u32 v237, 155648, v237
    v_lshlrev_b32 v13, 17, v9
    v_lshl_add_u32 v233, v10, 4, v13
    s_cmp_eq_u32 s48, 3
    s_cselect_b32 s60, 268435456, 0
    s_lshl_b32 s70, s48, 10
    s_add_u32 s70, s70, s2
    s_lshl_b32 s70, s70, 9
    s_add_u32 s71, s70, 262144
    s_add_u32 s71, s71, s60
    s_xor_b32 s60, s60, 268435456
    s_lshl_b32 s72, s2, 7
    s_add_u32 s72, s72, s60
    s_add_u32 s72, s72, 6291456
    s_lshr_b32 s74, s2, 2
    s_lshl_b32 s74, s74, 4
    s_and_b32 s3, s2, 3
    s_add_u32 s74, s74, s3
    s_lshl_b32 s74, s74, 2
    s_add_u32 s74, s74, 10485760
    v_cmp_gt_u32 vcc, 8, v0
    v_lshlrev_b32 v236, 13, v0
    v_mov_b32 v13, 268435456
    s_and_b32 s3, s2, 7
    s_lshl_b32 s3, s3, 13
    s_add_u32 s3, s3, 10485760
    v_lshrrev_b32 v14, 2, v0
    v_lshl_add_u32 v14, v14, 6, s3
    v_and_b32 v15, 3, v0
    v_lshl_add_u32 v20, v15, 2, v14
    v_cndmask_b32 v236, v13, v236, vcc
    v_mov_b32 v16, 0
    s_lshl_b32 s3, s48, 14
    s_add_u32 s74, s74, s3
    s_add_u32 s73, s74, 8192
    s_waitcnt vmcnt(8)
    v_dot2_f32_bf16 v226, v182, s77, 0
    v_dot2_f32_bf16 v227, v182, v182, 0
    v_dot2_f32_bf16 v226, v183, s77, v226
    v_dot2_f32_bf16 v227, v183, v183, v227
    v_dot2_f32_bf16 v226, v184, s77, v226
    v_dot2_f32_bf16 v227, v184, v184, v227
    v_dot2_f32_bf16 v226, v185, s77, v226
    v_dot2_f32_bf16 v227, v185, v185, v227
    s_waitcnt vmcnt(7)
    v_dot2_f32_bf16 v226, v186, s77, v226
    v_dot2_f32_bf16 v227, v186, v186, v227
    v_dot2_f32_bf16 v226, v187, s77, v226
    v_dot2_f32_bf16 v227, v187, v187, v227
    v_dot2_f32_bf16 v226, v188, s77, v226
    v_dot2_f32_bf16 v227, v188, v188, v227
    v_dot2_f32_bf16 v226, v189, s77, v226
    v_dot2_f32_bf16 v227, v189, v189, v227
    buffer_load_dword v12, v16, s[44:47], 0 offen sc1
    v_lshlrev_b32 v190, 16, v182
    v_and_b32 v191, 0xffff0000, v182
    v_add_f32_dpp v226, v226, v226 quad_perm:[1,0,3,2] row_mask:0xf bank_mask:0xf
    v_add_f32_dpp v227, v227, v227 quad_perm:[1,0,3,2] row_mask:0xf bank_mask:0xf
    v_lshlrev_b32 v192, 16, v183
    v_add_f32_dpp v226, v226, v226 quad_perm:[2,3,0,1] row_mask:0xf bank_mask:0xf
    v_add_f32_dpp v227, v227, v227 quad_perm:[2,3,0,1] row_mask:0xf bank_mask:0xf
    v_and_b32 v193, 0xffff0000, v183
    v_add_f32_dpp v226, v226, v226 row_half_mirror row_mask:0xf bank_mask:0xf
    v_add_f32_dpp v227, v227, v227 row_half_mirror row_mask:0xf bank_mask:0xf
    v_lshlrev_b32 v194, 16, v184
    v_add_f32_dpp v226, v226, v226 row_mirror row_mask:0xf bank_mask:0xf
    v_add_f32_dpp v227, v227, v227 row_mirror row_mask:0xf bank_mask:0xf
    v_and_b32 v195, 0xffff0000, v184
    v_mov_b32 v228, v226
    v_mov_b32 v229, v227
    v_lshlrev_b32 v196, 16, v185
    v_permlane16_swap_b32 v226, v228
    v_permlane16_swap_b32 v227, v229
    v_add_f32 v226, v226, v228
    v_add_f32 v227, v227, v229
    v_mul_f32_e64 v226, -v226, s76
    v_mul_f32 v228, v226, v226
    v_fma_f32 v227, v227, s76, -v228
    v_max_f32 v227, 0, v227
    v_add_f32 v228, s75, v227
    v_rsq_f32 v222, v228
    v_and_b32 v197, 0xffff0000, v185
    v_mul_f32 v228, v222, v222
    v_fma_f32 v229, v228, v227, s75
    v_rsq_f32 v228, v229
    v_mul_f32 v223, v226, v222
    v_mul_f32 v224, v222, v228
    v_mul_f32 v225, v223, v228
    v_mul_f32 v229, v229, v228
    ds_write_b32 v232, v229
    v_lshlrev_b32 v198, 16, v186
    v_and_b32 v199, 0xffff0000, v186
    v_lshlrev_b32 v200, 16, v187
    v_and_b32 v201, 0xffff0000, v187
    v_lshlrev_b32 v202, 16, v188
    v_and_b32 v203, 0xffff0000, v188
    v_lshlrev_b32 v204, 16, v189
    v_and_b32 v205, 0xffff0000, v189
    v_pk_fma_f32 v[206:207], v[190:191], v[224:225], v[224:225] op_sel:[0,0,1] op_sel_hi:[1,0,1]
    v_pk_fma_f32 v[208:209], v[192:193], v[224:225], v[224:225] op_sel:[0,0,1] op_sel_hi:[1,0,1]
    v_pk_fma_f32 v[210:211], v[194:195], v[224:225], v[224:225] op_sel:[0,0,1] op_sel_hi:[1,0,1]
    v_pk_fma_f32 v[212:213], v[196:197], v[224:225], v[224:225] op_sel:[0,0,1] op_sel_hi:[1,0,1]
    v_cvt_pk_bf16_f32 v182, v206, v207
    v_cvt_pk_bf16_f32 v183, v208, v209
    v_cvt_pk_bf16_f32 v184, v210, v211
    v_cvt_pk_bf16_f32 v185, v212, v213
    ds_write_b128 v230, v[182:185] offset:0
    v_pk_fma_f32 v[214:215], v[198:199], v[224:225], v[224:225] op_sel:[0,0,1] op_sel_hi:[1,0,1]
    v_pk_fma_f32 v[216:217], v[200:201], v[224:225], v[224:225] op_sel:[0,0,1] op_sel_hi:[1,0,1]
    v_pk_fma_f32 v[218:219], v[202:203], v[224:225], v[224:225] op_sel:[0,0,1] op_sel_hi:[1,0,1]
    v_pk_fma_f32 v[220:221], v[204:205], v[224:225], v[224:225] op_sel:[0,0,1] op_sel_hi:[1,0,1]
    v_cvt_pk_bf16_f32 v186, v214, v215
    v_cvt_pk_bf16_f32 v187, v216, v217
    v_cvt_pk_bf16_f32 v188, v218, v219
    v_cvt_pk_bf16_f32 v189, v220, v221
    ds_write_b128 v230, v[186:189] offset:448
    s_waitcnt lgkmcnt(0)
    s_barrier
    ds_read_b64_tr_b16 v[110:111], v231 offset:0
    ds_read_b64_tr_b16 v[112:113], v231 offset:3840
    ds_read_b64_tr_b16 v[114:115], v231 offset:128
    ds_read_b64_tr_b16 v[116:117], v231 offset:3968
    ds_read_b32 v229, v237
    s_waitcnt lgkmcnt(3)
    buffer_store_dwordx4 v[110:113], v233, s[28:31], s70 offen sc1
    s_waitcnt lgkmcnt(1)
    buffer_store_dwordx4 v[114:117], v233, s[28:31], s71 offen sc1
    v_cmp_gt_u32 vcc, 16, v1
    s_waitcnt lgkmcnt(0)
    s_nop 0
    v_cndmask_b32 v229, 0, v229, vcc
    v_mov_b32 v228, v229
    buffer_store_dwordx2 v[228:229], v238, s[28:31], s72 offen sc1
    s_add_u32 m0, s58, 16384
    s_add_u32 s0, s0, 458752
    s_cmp_eq_u32 s0, 3670016
    s_cselect_b32 s0, 0, s0
    buffer_load_dwordx4 v55, s[20:23], s0 offen lds
    buffer_load_dwordx4 v56, s[20:23], s0 offen offset:1024 lds
    buffer_load_dwordx4 v57, s[20:23], s0 offen offset:2048 lds
    buffer_load_dwordx4 v58, s[20:23], s0 offen offset:3072 lds
    s_branch L_anchor
.p2align 12
L_anchor:
    s_mov_b32 s18, 401408
    s_mov_b32 s19, 0x20000
    s_mov_b32 s26, 7340032
    s_mov_b32 s27, 0x20000
    s_mov_b32 s34, 1835008
    s_mov_b32 s35, 0x20000
    s_mov_b32 s36, 1
    v_lshrrev_b32 v14, 2, v1
    v_lshlrev_b32 v14, 7, v14
    v_lshl_add_u32 v14, v8, 3, v14
    v_and_b32 v15, 3, v5
    v_lshl_add_u32 v14, v15, 5, v14
    s_mul_i32 s3, s4, 8256
    v_xor_b32 v31, s3, v14
    v_xor_b32 v32, 32, v31
    v_xor_b32 v33, 64, v31
    v_xor_b32 v34, 96, v31
    v_add_u32 v35, 65536, v31
    v_add_u32 v36, 65536, v32
    v_add_u32 v37, 65536, v33
    v_add_u32 v38, 65536, v34
    v_add_u32 v39, 131072, v31
    v_add_u32 v40, 131072, v32
    v_add_u32 v41, 131072, v33
    v_add_u32 v42, 131072, v34
    s_lshl_b32 s6, s52, 1
    s_add_u32 s6, s6, s5
    s_lshl_b32 s3, s6, 1
    s_add_u32 s3, s3, s59
    s_lshl_b32 s3, s3, 4
    s_add_u32 s3, s3, s4
    s_lshl_b32 s3, s3, 12
    v_lshl_add_u32 v78, v3, 8, v4
    v_add_u32 v78, s3, v78
    s_xor_b32 s37, s51, 1
    s_lshl_b32 s37, s37, 3
    s_add_u32 s37, s37, s52
    s_lshl_b32 s3, s37, 14
    s_add_u32 s3, s3, s58
    s_add_u32 s3, s3, 16777216
    v_add_u32 v23, s3, v4
    s_lshl_b32 s37, s37, 5
    s_add_u32 s37, s37, s5
    s_lshl_b32 s37, s37, 2
    s_add_u32 s37, s37, 6422528
    s_mul_i32 s67, s6, 56
    s_lshl_b32 s3, s51, 1
    s_add_u32 s3, s3, s4
    s_add_u32 s67, s67, s3
    s_lshl_b32 s67, s67, 11
    s_add_u32 s67, s67, 2097152
    v_add_u32 v81, s58, v4
    s_lshl_b32 s68, s52, 2
    s_and_b32 s3, s51, 1
    s_add_u32 s68, s68, s3
    s_cmp_ge_u32 s51, 14
    s_cselect_b32 s3, 2, 0
    s_add_u32 s68, s68, s3
    s_lshl_b32 s68, s68, 7
    s_add_u32 s68, s68, 6356992
    s_waitcnt vmcnt(7)
    v_readfirstlane_b32 s57, v12
    s_mov_b32 s60, 0
    s_cmp_lg_u32 s57, 0
    s_cbranch_scc0 L_nonce
L_nonce_ok:
    s_waitcnt vmcnt(4)
    s_barrier
    s_atomic_swap s57, s[28:29], s74
    s_atomic_swap s57, s[28:29], s73
    buffer_load_dwordx4 v[96:99], v85, s[8:11], 0 offen
    buffer_load_dwordx4 v[100:103], v86, s[8:11], 0 offen
    buffer_load_ushort v93, v82, s[40:43], 0 offen offset:0
    buffer_load_ushort v94, v82, s[40:43], 0 offen offset:16
    v_add_u32 v53, 65536, v4
    s_add_u32 m0, s58, 32768
    s_add_u32 s0, s0, 458752
    s_cmp_eq_u32 s0, 3670016
    s_cselect_b32 s0, 0, s0
    buffer_load_dwordx4 v55, s[20:23], s0 offen lds
    v_add_u32 v54, 131072, v4
    s_mul_i32 s59, s48, 3072
    s_mul_i32 s3, s50, 86016
    s_add_u32 s3, s3, s59
    s_add_u32 s3, s3, 8388608
    v_add_u32 v80, s3, v4
    v_lshlrev_b32 v14, 7, v9
    v_xor_b32 v14, v14, v4
    s_lshl_b32 s3, s49, 11
    v_add_u32 v67, s3, v14
    v_add_u32 v68, 129024, v67
    s_lshr_b32 s3, s49, 2
    s_lshl_b32 s3, s3, 3
    s_max_u32 s3, s3, 1
    s_sub_u32 s3, s3, 1
    s_lshl_b32 s3, s3, 10
    s_lshl_b32 s6, s5, 17
    s_add_u32 s3, s3, s6
    s_lshl_b32 s6, s4, 28
    s_add_u32 s3, s3, s6
    v_add_u32 v69, s3, v14
    buffer_load_dwordx4 v56, s[20:23], s0 offen offset:1024 lds
    s_lshl_b32 s100, s5, 1
    s_add_u32 s100, s100, s4
    s_lshl_b32 s100, s100, 10
    v_and_b32 v14, 1, v1
    v_mul_u32_u24 v14, 640, v14
    v_lshrrev_b32 v15, 2, v1
    v_lshlrev_b32 v15, 4, v15
    v_xor_b32 v14, v14, v15
    v_bfe_u32 v15, v1, 1, 1
    v_lshl_add_u32 v14, v15, 3, v14
    buffer_load_dwordx4 v57, s[20:23], s0 offen offset:2048 lds
    s_add_u32 s3, s58, 12288
    v_add_u32 v70, s3, v14
    s_sub_u32 s3, s3, 3072
    s_cmp_eq_u32 s48, 0
    s_cselect_b32 s3, 28672, s3
    v_add_u32 v71, s3, v14
    v_add_u32 v72, 65536, v70
    v_add_u32 v73, 65536, v71
    v_add_u32 v74, 131072, v70
    v_add_u32 v75, 131072, v71
    s_lshl_b32 s3, s49, 1
    v_min_u32 v14, 2, v3
    v_add_u32 v14, s3, v14
    v_max_u32 v14, 1, v14
    v_lshlrev_b32 v14, 1, v14
    v_and_b32 v15, 1, v7
    buffer_load_dwordx4 v58, s[20:23], s0 offen offset:3072 lds
    v_add_lshl_u32 v14, v14, v15, 7
    v_lshrrev_b32 v15, 1, v7
    v_lshl_add_u32 v15, v15, 2, v8
    v_lshl_add_u32 v14, v15, 3, v14
    v_add_u32 v77, 6291200, v14
    s_min_u32 s15, s48, 2
    s_lshl_b32 s15, s15, 6
    s_add_u32 s15, s15, 64
    s_lshl_b32 s82, s49, 5
    s_add_u32 s82, s82, s50
    s_lshl_b32 s82, s82, 10
    s_add_u32 s82, s82, 4194304
    s_lshr_b32 s69, s49, 2
    s_lshl_b32 s69, s69, 1
    s_and_b32 s3, s50, 1
    s_add_u32 s69, s69, s3
    s_lshl_b32 s69, s69, 7
    s_add_u32 s69, s69, 6361088
    s_and_b32 s7, s53, 1
    s_mul_i32 s3, s7, 28
    s_add_u32 s3, s3, s48
    s_lshl_b32 s3, s3, 17
    s_xor_b32 s6, s53, 1
    s_lshl_b32 s55, s6, 3
    s_lshl_b32 s6, s53, 7
    s_add_u32 s3, s3, s6
    v_lshlrev_b32 v14, 12, v5
    s_add_u32 m0, s58, 49152
    s_add_u32 s0, s0, 458752
    s_cmp_eq_u32 s0, 3670016
    s_cselect_b32 s0, 0, s0
    buffer_load_dwordx4 v55, s[20:23], s0 offen lds
    v_add3_u32 v59, v14, v83, s3
    v_add_u32 v60, 31744, v59
    v_add_u32 v61, 63488, v59
    v_add_u32 v62, 95232, v59
    v_mul_u32_u24 v14, 896, v5
    s_mul_i32 s3, s4, 25088
    s_mul_i32 s6, s5, 14336
    s_add_u32 s3, s3, s6
    s_lshl_b32 s6, s54, 7
    s_add_u32 s3, s3, s6
    v_add3_u32 v63, v14, v83, s3
    buffer_load_dwordx4 v56, s[20:23], s0 offen offset:1024 lds
    v_add_u32 v64, 6144, v63
    s_lshl_b32 s6, s53, 1
    s_add_u32 s6, s6, s5
    s_and_b32 s3, s53, 30
    s_add_u32 s3, s3, s4
    s_lshl_b32 s3, s3, 7
    s_add_u32 s39, s3, 6361088
    s_lshl_b32 s3, s6, 5
    s_add_u32 s3, s3, s4
    s_lshl_b32 s3, s3, 10
    s_add_u32 s3, s3, 4194304
    v_add_u32 v65, s3, v4
    v_add_u32 v66, 15360, v65
    s_xor_b32 s3, s4, s5
    s_lshl_b32 s3, s3, 6
    v_xor_b32 v43, s3, v31
    buffer_load_dwordx4 v57, s[20:23], s0 offen offset:2048 lds
    v_xor_b32 v44, 32, v43
    v_add_u32 v45, 65536, v43
    v_add_u32 v46, 65536, v44
    s_mul_i32 s3, s4, 12288
    v_add_u32 v47, s3, v4
    v_xor_b32 v48, 4096, v47
    v_add_u32 v49, 65536, v47
    v_add_u32 v50, 65536, v48
    v_add_u32 v51, 131072, v47
    v_add_u32 v52, 131072, v48
    s_lshl_b32 s6, s54, 1
    s_add_u32 s6, s6, s5
    s_lshl_b32 s3, s6, 1
    s_add_u32 s3, s3, s7
    s_mul_i32 s3, s3, 14
    s_add_u32 s3, s3, s4
    s_lshl_b32 s3, s3, 12
    s_add_u32 s3, s3, 2097152
    v_add_u32 v79, s3, v4
    buffer_load_dwordx4 v58, s[20:23], s0 offen offset:3072 lds
    s_lshl_b32 s3, s54, 1
    s_add_u32 s3, s3, s7
    s_lshl_b32 s3, s3, 1
    s_add_u32 s3, s3, s4
    s_lshl_b32 s3, s3, 7
    s_add_u32 s38, s3, 6356992
    s_and_b32 s3, s2, 6
    s_add_u32 s3, s3, s54
    s_sub_u32 s6, s3, 7
    s_cmp_ge_u32 s3, 7
    s_cselect_b32 s3, s6, s3
    s_lshl_b32 s64, s3, 19
    s_lshl_b32 s65, s3, 13
    s_add_u32 s55, s55, s54
    s_lshl_b32 s3, s55, 14
    s_add_u32 s3, s3, s58
    s_add_u32 s3, s3, 12582912
    v_add_u32 v21, s3, v4
    s_add_u32 m0, s58, 65536
    s_add_u32 s0, s0, 458752
    s_cmp_eq_u32 s0, 3670016
    s_cselect_b32 s0, 0, s0
    buffer_load_dwordx4 v55, s[20:23], s0 offen lds
    s_lshl_b32 s55, s55, 5
    s_add_u32 s55, s55, s48
    s_lshl_b32 s55, s55, 2
    s_add_u32 s55, s55, 6488064
    s_lshl_b32 s3, s5, 3
    v_add_u32 v13, s3, v3
    v_xor_b32 v13, v13, v6
    v_lshlrev_b32 v13, 4, v13
    v_lshl_add_u32 v13, v2, 8, v13
    buffer_load_dwordx4 v56, s[20:23], s0 offen offset:1024 lds
    s_lshl_b32 s3, s4, 14
    s_add_u32 s3, s3, 32768
    v_add_u32 v87, s3, v13
    v_xor_b32 v88, 64, v87
    s_lshr_b32 s3, s53, 1
    s_add_u32 s66, s3, s54
    s_mov_b32 s51, s66
    v_lshlrev_b32 v13, 1, v6
    v_xor_b32 v13, v13, v5
    v_lshlrev_b32 v13, 4, v13
    v_lshl_add_u32 v13, v5, 8, v13
    s_add_u32 s3, s58, 32768
    v_add_u32 v89, s3, v13
    v_xor_b32 v90, 16, v89
    v_xor_b32 v91, 24576, v89
    v_xor_b32 v92, 24592, v89
    buffer_load_dwordx4 v57, s[20:23], s0 offen offset:2048 lds
    v_lshlrev_b32 v150, 16, v246
    v_and_b32 v151, 0xffff0000, v246
    v_lshlrev_b32 v152, 16, v247
    v_and_b32 v153, 0xffff0000, v247
    v_lshlrev_b32 v154, 16, v248
    v_and_b32 v155, 0xffff0000, v248
    v_lshlrev_b32 v156, 16, v249
    v_and_b32 v157, 0xffff0000, v249
    v_lshlrev_b32 v158, 16, v246
    v_and_b32 v159, 0xffff0000, v246
    v_lshlrev_b32 v160, 16, v247
    v_and_b32 v161, 0xffff0000, v247
    v_lshlrev_b32 v162, 16, v248
    v_and_b32 v163, 0xffff0000, v248
    v_lshlrev_b32 v164, 16, v249
    v_and_b32 v165, 0xffff0000, v249
    buffer_load_dwordx4 v58, s[20:23], s0 offen offset:3072 lds
    s_add_u32 m0, s58, 81920
    s_add_u32 s0, s0, 458752
    s_cmp_eq_u32 s0, 3670016
    s_cselect_b32 s0, 0, s0
    buffer_load_dwordx4 v55, s[20:23], s0 offen lds
    buffer_load_dwordx4 v56, s[20:23], s0 offen offset:1024 lds
    buffer_load_dwordx4 v57, s[20:23], s0 offen offset:2048 lds
    buffer_load_dwordx4 v58, s[20:23], s0 offen offset:3072 lds
    s_add_u32 m0, s58, 98304
    s_add_u32 s0, s0, 458752
    s_cmp_eq_u32 s0, 3670016
    s_cselect_b32 s0, 0, s0
    buffer_load_dwordx4 v55, s[20:23], s0 offen lds
    buffer_load_dwordx4 v56, s[20:23], s0 offen offset:1024 lds
    buffer_load_dwordx4 v57, s[20:23], s0 offen offset:2048 lds
    buffer_load_dwordx4 v58, s[20:23], s0 offen offset:3072 lds
    buffer_load_dword v18, v20, s[28:31], 0 offen sc1
    s_add_u32 m0, s58, 114688
    s_add_u32 s0, s0, 458752
    s_cmp_eq_u32 s0, 3670016
    s_cselect_b32 s0, 0, s0
    buffer_load_dwordx4 v55, s[20:23], s0 offen lds
    buffer_load_dwordx4 v56, s[20:23], s0 offen offset:1024 lds
    buffer_load_dwordx4 v57, s[20:23], s0 offen offset:2048 lds
    buffer_load_dwordx4 v58, s[20:23], s0 offen offset:3072 lds
    s_mov_b32 s3, s48
    s_mov_b64 exec, 0
L_warm:
    s_add_u32 s3, s3, 4
    s_cmp_eq_u32 s3, 4
    s_cbranch_scc1 L_pad0
    s_cmp_eq_u32 s3, 5
    s_cbranch_scc1 L_pad1
    s_cmp_eq_u32 s3, 6
    s_cbranch_scc1 L_pad2
    s_cmp_eq_u32 s3, 7
    s_cbranch_scc1 L_pad3
    s_cmp_eq_u32 s3, 8
    s_cbranch_scc1 L_pad4
    s_mov_b64 exec, -1
    s_waitcnt vmcnt(4)
    v_cmp_ne_u32 vcc, s57, v18
    s_cbranch_vccnz L_pollin0
L_pollok0:
    s_barrier
    buffer_load_dwordx4 a[0:3], v78, s[28:31], s1 offen offset:0 sc1
    buffer_load_dwordx4 a[4:7], v78, s[28:31], s1 offen offset:256 sc1
    buffer_load_dwordx4 a[8:11], v78, s[28:31], s1 offen offset:2048 sc1
    buffer_load_dwordx4 a[12:15], v78, s[28:31], s1 offen offset:2304 sc1
    buffer_load_dword v76, v77, s[28:31], 0 offen sc1
    s_add_u32 s1, s1, 8192
    s_and_b32 s1, s1, 0xffff
    buffer_load_dwordx4 a[16:19], v78, s[28:31], s1 offen offset:0 sc1
    buffer_load_dwordx4 a[20:23], v78, s[28:31], s1 offen offset:256 sc1
    buffer_load_dwordx4 a[24:27], v78, s[28:31], s1 offen offset:2048 sc1
    buffer_load_dwordx4 a[28:31], v78, s[28:31], s1 offen offset:2304 sc1
    s_add_u32 s1, s1, 8192
    s_and_b32 s1, s1, 0xffff
    buffer_load_dwordx4 a[32:35], v78, s[28:31], s1 offen offset:0 sc1
    buffer_load_dwordx4 a[36:39], v78, s[28:31], s1 offen offset:256 sc1
    buffer_load_dwordx4 a[40:43], v78, s[28:31], s1 offen offset:2048 sc1
    buffer_load_dwordx4 a[44:47], v78, s[28:31], s1 offen offset:2304 sc1
    ds_read_b64_tr_b16 a[200:201], v31 offset:0
    ds_read_b64_tr_b16 a[202:203], v31 offset:2048
    ds_read_b64_tr_b16 a[204:205], v33 offset:0
    ds_read_b64_tr_b16 a[206:207], v33 offset:2048
    ds_read_b64_tr_b16 a[208:209], v32 offset:0
    ds_read_b64_tr_b16 a[210:211], v32 offset:2048
    ds_read_b64_tr_b16 a[212:213], v34 offset:0
    ds_read_b64_tr_b16 a[214:215], v34 offset:2048
    ds_read_b64_tr_b16 a[216:217], v31 offset:4096
    ds_read_b64_tr_b16 a[218:219], v31 offset:6144
    ds_read_b64_tr_b16 a[220:221], v33 offset:4096
    ds_read_b64_tr_b16 a[222:223], v33 offset:6144
    s_waitcnt vmcnt(11) lgkmcnt(8)
    v_mfma_f32_16x16x32_bf16 v[182:185], a[200:203], a[0:3], 0
    ds_read_b64_tr_b16 a[224:225], v32 offset:4096
    s_add_u32 s1, s1, 8192
    v_mfma_f32_16x16x32_bf16 v[190:193], a[200:203], a[4:7], 0
    ds_read_b64_tr_b16 a[226:227], v32 offset:6144
    s_and_b32 s1, s1, 0xffff
    s_mov_b32 s70, 0xaaaaaaaa
    s_mov_b32 s71, 0xaaaaaaaa
    s_mov_b32 s72, 0xfff0ffff
    s_mov_b32 s73, 0xf000ff00
    s_mov_b32 s74, 0xffc0fffc
    v_mfma_f32_16x16x32_bf16 v[198:201], a[204:207], a[0:3], 0
    ds_read_b64_tr_b16 a[228:229], v34 offset:4096
    buffer_load_dwordx4 a[48:51], v78, s[28:31], s1 offen offset:0 sc1
    v_mfma_f32_16x16x32_bf16 v[206:209], a[204:207], a[4:7], 0
    ds_read_b64_tr_b16 a[230:231], v34 offset:6144
    s_mov_b32 s75, 0xc000fc00
    s_waitcnt lgkmcnt(8)
    v_mfma_f32_16x16x32_bf16 v[186:189], a[208:211], a[0:3], 0
    ds_read_b64_tr_b16 a[200:201], v31 offset:16384
    s_mov_b32 s83, 0x3e8b97f6
    v_mfma_f32_16x16x32_bf16 v[194:197], a[208:211], a[4:7], 0
    ds_read_b64_tr_b16 a[202:203], v31 offset:18432
    buffer_load_dwordx4 a[52:55], v78, s[28:31], s1 offen offset:256 sc1
    v_lshlrev_b32 v13, 2, v2
    v_mfma_f32_16x16x32_bf16 v[202:205], a[212:215], a[0:3], 0
    ds_read_b64_tr_b16 a[204:205], v33 offset:16384
    v_and_b32 v14, 1, v1
    v_mfma_f32_16x16x32_bf16 v[210:213], a[212:215], a[4:7], 0
    ds_read_b64_tr_b16 a[206:207], v33 offset:18432
    s_waitcnt vmcnt(11) lgkmcnt(8)
    v_mfma_f32_16x16x32_bf16 v[182:185], a[216:219], a[8:11], v[182:185]
    ds_read_b64_tr_b16 a[208:209], v32 offset:16384
    buffer_load_dwordx4 a[56:59], v78, s[28:31], s1 offen offset:2048 sc1
    v_mfma_f32_16x16x32_bf16 v[190:193], a[216:219], a[12:15], v[190:193]
    ds_read_b64_tr_b16 a[210:211], v32 offset:18432
    v_lshl_add_u32 v14, v3, 2, v14
    v_mfma_f32_16x16x32_bf16 v[198:201], a[220:223], a[8:11], v[198:201]
    ds_read_b64_tr_b16 a[212:213], v34 offset:16384
    v_lshlrev_b32 v14, 2, v14
    v_mfma_f32_16x16x32_bf16 v[206:209], a[220:223], a[12:15], v[206:209]
    ds_read_b64_tr_b16 a[214:215], v34 offset:18432
    s_waitcnt lgkmcnt(8)
    v_mfma_f32_16x16x32_bf16 v[186:189], a[224:227], a[8:11], v[186:189]
    ds_read_b64_tr_b16 a[216:217], v31 offset:20480
    buffer_load_dwordx4 a[60:63], v78, s[28:31], s1 offen offset:2304 sc1
    v_mfma_f32_16x16x32_bf16 v[194:197], a[224:227], a[12:15], v[194:197]
    ds_read_b64_tr_b16 a[218:219], v31 offset:22528
    s_add_u32 s1, s1, 8192
    v_add_u32 v15, 64, v14
    v_mfma_f32_16x16x32_bf16 v[202:205], a[228:231], a[8:11], v[202:205]
    ds_read_b64_tr_b16 a[220:221], v33 offset:20480
    s_and_b32 s1, s1, 0xffff
    v_mfma_f32_16x16x32_bf16 v[210:213], a[228:231], a[12:15], v[210:213]
    ds_read_b64_tr_b16 a[222:223], v33 offset:22528
    s_waitcnt vmcnt(10) lgkmcnt(8)
    v_mfma_f32_16x16x32_bf16 v[182:185], a[200:203], a[16:19], v[182:185]
    ds_read_b64_tr_b16 a[224:225], v32 offset:20480
    buffer_load_dwordx4 a[64:67], v78, s[28:31], s1 offen offset:0 sc1
    v_mfma_f32_16x16x32_bf16 v[190:193], a[200:203], a[20:23], v[190:193]
    ds_read_b64_tr_b16 a[226:227], v32 offset:22528
    v_cndmask_b32 v16, v14, v15, s[72:73]
    v_mfma_f32_16x16x32_bf16 v[198:201], a[204:207], a[16:19], v[198:201]
    ds_read_b64_tr_b16 a[228:229], v34 offset:20480
    buffer_load_dwordx4 a[68:71], v78, s[28:31], s1 offen offset:256 sc1
    v_mfma_f32_16x16x32_bf16 v[206:209], a[204:207], a[20:23], v[206:209]
    ds_read_b64_tr_b16 a[230:231], v34 offset:22528
    v_cndmask_b32 v14, v14, v15, s[74:75]
    s_waitcnt lgkmcnt(8)
    v_mfma_f32_16x16x32_bf16 v[186:189], a[208:211], a[16:19], v[186:189]
    ds_read_b64_tr_b16 a[200:201], v31 offset:32768
    ds_bpermute_b32 v25, v13, v76 offset:64
    v_mfma_f32_16x16x32_bf16 v[194:197], a[208:211], a[20:23], v[194:197]
    ds_read_b64_tr_b16 a[202:203], v31 offset:34816
    buffer_load_dwordx4 a[72:75], v78, s[28:31], s1 offen offset:2048 sc1
    ds_bpermute_b32 v27, v16, v76 offset:0
    v_mfma_f32_16x16x32_bf16 v[202:205], a[212:215], a[16:19], v[202:205]
    ds_read_b64_tr_b16 a[204:205], v33 offset:32768
    ds_bpermute_b32 v28, v14, v76 offset:8
    v_mfma_f32_16x16x32_bf16 v[210:213], a[212:215], a[20:23], v[210:213]
    ds_read_b64_tr_b16 a[206:207], v33 offset:34816
    s_waitcnt vmcnt(11) lgkmcnt(11)
    v_mfma_f32_16x16x32_bf16 v[182:185], a[216:219], a[24:27], v[182:185]
    ds_read_b64_tr_b16 a[208:209], v32 offset:32768
    ds_bpermute_b32 v26, v13, v76 offset:128
    v_mfma_f32_16x16x32_bf16 v[190:193], a[216:219], a[28:31], v[190:193]
    ds_read_b64_tr_b16 a[210:211], v32 offset:34816
    buffer_load_dwordx4 a[76:79], v78, s[28:31], s1 offen offset:2304 sc1
    ds_bpermute_b32 v29, v16, v76 offset:64
    v_mfma_f32_16x16x32_bf16 v[198:201], a[220:223], a[24:27], v[198:201]
    ds_read_b64_tr_b16 a[212:213], v34 offset:32768
    s_add_u32 s1, s1, 8192
    v_mfma_f32_16x16x32_bf16 v[206:209], a[220:223], a[28:31], v[206:209]
    ds_read_b64_tr_b16 a[214:215], v34 offset:34816
    s_waitcnt lgkmcnt(13)
    v_mfma_f32_16x16x32_bf16 v[186:189], a[224:227], a[24:27], v[186:189]
    ds_read_b64_tr_b16 a[216:217], v31 offset:36864
    s_and_b32 s1, s1, 0xffff
    v_mfma_f32_16x16x32_bf16 v[194:197], a[224:227], a[28:31], v[194:197]
    ds_read_b64_tr_b16 a[218:219], v31 offset:38912
    buffer_load_dwordx4 a[80:83], v78, s[28:31], s1 offen offset:0 sc1
    ds_bpermute_b32 v30, v14, v76 offset:72
    v_mfma_f32_16x16x32_bf16 v[202:205], a[228:231], a[24:27], v[202:205]
    ds_read_b64_tr_b16 a[220:221], v33 offset:36864
    v_mfma_f32_16x16x32_bf16 v[210:213], a[228:231], a[28:31], v[210:213]
    ds_read_b64_tr_b16 a[222:223], v33 offset:38912
    s_waitcnt vmcnt(11) lgkmcnt(11)
    v_mfma_f32_16x16x32_bf16 v[182:185], a[200:203], a[32:35], v[182:185]
    ds_read_b64_tr_b16 a[224:225], v32 offset:36864
    buffer_load_dwordx4 a[84:87], v78, s[28:31], s1 offen offset:256 sc1
    v_mfma_f32_16x16x32_bf16 v[190:193], a[200:203], a[36:39], v[190:193]
    ds_read_b64_tr_b16 a[226:227], v32 offset:38912
    v_mfma_f32_16x16x32_bf16 v[198:201], a[204:207], a[32:35], v[198:201]
    ds_read_b64_tr_b16 a[228:229], v34 offset:36864
    v_mfma_f32_16x16x32_bf16 v[206:209], a[204:207], a[36:39], v[206:209]
    ds_read_b64_tr_b16 a[230:231], v34 offset:38912
    s_waitcnt lgkmcnt(9)
    v_mfma_f32_16x16x32_bf16 v[186:189], a[208:211], a[32:35], v[186:189]
    s_barrier
    ds_read_b64_tr_b16 a[200:201], v31 offset:49152
    buffer_load_dwordx4 a[88:91], v78, s[28:31], s1 offen offset:2048 sc1
    v_mfma_f32_16x16x32_bf16 v[194:197], a[208:211], a[36:39], v[194:197]
    ds_read_b64_tr_b16 a[202:203], v31 offset:51200
    v_mfma_f32_16x16x32_bf16 v[202:205], a[212:215], a[32:35], v[202:205]
    ds_read_b64_tr_b16 a[204:205], v33 offset:49152
    buffer_load_dwordx4 a[92:95], v78, s[28:31], s1 offen offset:2304 sc1
    v_mfma_f32_16x16x32_bf16 v[210:213], a[212:215], a[36:39], v[210:213]
    ds_read_b64_tr_b16 a[206:207], v33 offset:51200
    s_waitcnt vmcnt(12) lgkmcnt(8)
    v_mfma_f32_16x16x32_bf16 v[182:185], a[216:219], a[40:43], v[182:185]
    ds_read_b64_tr_b16 a[208:209], v32 offset:49152
    s_add_u32 m0, s58, 131072
    v_mfma_f32_16x16x32_bf16 v[190:193], a[216:219], a[44:47], v[190:193]
    ds_read_b64_tr_b16 a[210:211], v32 offset:51200
    s_add_u32 s0, s0, 458752
    v_mul_f32 v25, s83, v25
    v_mfma_f32_16x16x32_bf16 v[198:201], a[220:223], a[40:43], v[198:201]
    ds_read_b64_tr_b16 a[212:213], v34 offset:49152
    s_cmp_eq_u32 s0, 3670016
    v_mfma_f32_16x16x32_bf16 v[206:209], a[220:223], a[44:47], v[206:209]
    ds_read_b64_tr_b16 a[214:215], v34 offset:51200
    s_cselect_b32 s0, 0, s0
    v_xor_b32 v55, 128, v55
    buffer_load_dwordx4 v55, s[20:23], s0 offen lds
    s_waitcnt lgkmcnt(8)
    v_mfma_f32_16x16x32_bf16 v[186:189], a[224:227], a[40:43], v[186:189]
    ds_read_b64_tr_b16 a[216:217], v31 offset:53248
    v_xor_b32 v56, 128, v56
    v_mfma_f32_16x16x32_bf16 v[194:197], a[224:227], a[44:47], v[194:197]
    ds_read_b64_tr_b16 a[218:219], v31 offset:55296
    buffer_load_dwordx4 v56, s[20:23], s0 offen offset:1024 lds
    v_mul_f32 v26, s83, v26
    v_mfma_f32_16x16x32_bf16 v[202:205], a[228:231], a[40:43], v[202:205]
    ds_read_b64_tr_b16 a[220:221], v33 offset:53248
    v_xor_b32 v57, 128, v57
    v_mfma_f32_16x16x32_bf16 v[210:213], a[228:231], a[44:47], v[210:213]
    ds_read_b64_tr_b16 a[222:223], v33 offset:55296
    s_waitcnt vmcnt(12) lgkmcnt(8)
    v_mfma_f32_16x16x32_bf16 v[182:185], a[200:203], a[48:51], v[182:185]
    ds_read_b64_tr_b16 a[224:225], v32 offset:53248
    buffer_load_dwordx4 v57, s[20:23], s0 offen offset:2048 lds
    v_mfma_f32_16x16x32_bf16 v[190:193], a[200:203], a[52:55], v[190:193]
    ds_read_b64_tr_b16 a[226:227], v32 offset:55296
    v_xor_b32 v58, 128, v58
    s_cmp_eq_u32 s49, 0
    s_cselect_b64 s[76:77], 0, -1
    v_mfma_f32_16x16x32_bf16 v[198:201], a[204:207], a[48:51], v[198:201]
    ds_read_b64_tr_b16 a[228:229], v34 offset:53248
    v_mov_b32 v13, 0xffff
    v_mfma_f32_16x16x32_bf16 v[206:209], a[204:207], a[52:55], v[206:209]
    ds_read_b64_tr_b16 a[230:231], v34 offset:55296
    s_waitcnt lgkmcnt(8)
    v_mfma_f32_16x16x32_bf16 v[186:189], a[208:211], a[48:51], v[186:189]
    ds_read_b64_tr_b16 a[200:201], v35 offset:0
    buffer_load_dwordx4 v58, s[20:23], s0 offen offset:3072 lds
    v_mfma_f32_16x16x32_bf16 v[194:197], a[208:211], a[52:55], v[194:197]
    ds_read_b64_tr_b16 a[202:203], v35 offset:2048
    s_add_u32 s1, s1, 8192
    v_mov_b32 v14, 0xffff0000
    v_mfma_f32_16x16x32_bf16 v[202:205], a[212:215], a[48:51], v[202:205]
    ds_read_b64_tr_b16 a[204:205], v37 offset:0
    s_and_b32 s1, s1, 0xffff
    v_mfma_f32_16x16x32_bf16 v[210:213], a[212:215], a[52:55], v[210:213]
    ds_read_b64_tr_b16 a[206:207], v37 offset:2048
    v_cndmask_b32 v13, v13, v14, s[70:71]
    s_waitcnt vmcnt(12) lgkmcnt(8)
    v_mfma_f32_16x16x32_bf16 v[182:185], a[216:219], a[56:59], v[182:185]
    ds_read_b64_tr_b16 a[208:209], v36 offset:0
    buffer_load_dwordx4 a[96:99], v78, s[28:31], s1 offen offset:0 sc1
    v_mfma_f32_16x16x32_bf16 v[190:193], a[216:219], a[60:63], v[190:193]
    ds_read_b64_tr_b16 a[210:211], v36 offset:2048
    v_cndmask_b32 v104, v13, 0, s[72:73]
    v_mfma_f32_16x16x32_bf16 v[198:201], a[220:223], a[56:59], v[198:201]
    ds_read_b64_tr_b16 a[212:213], v38 offset:0
    buffer_load_dwordx4 a[100:103], v78, s[28:31], s1 offen offset:256 sc1
    v_mfma_f32_16x16x32_bf16 v[206:209], a[220:223], a[60:63], v[206:209]
    ds_read_b64_tr_b16 a[214:215], v38 offset:2048
    v_cndmask_b32 v106, 0, v13, s[72:73]
    s_waitcnt lgkmcnt(8)
    v_mfma_f32_16x16x32_bf16 v[186:189], a[224:227], a[56:59], v[186:189]
    ds_read_b64_tr_b16 a[216:217], v35 offset:4096
    v_cndmask_b32 v105, v13, 0, s[74:75]
    v_mfma_f32_16x16x32_bf16 v[194:197], a[224:227], a[60:63], v[194:197]
    ds_read_b64_tr_b16 a[218:219], v35 offset:6144
    buffer_load_dwordx4 a[104:107], v78, s[28:31], s1 offen offset:2048 sc1
    v_cndmask_b32 v107, 0, v13, s[74:75]
    v_mfma_f32_16x16x32_bf16 v[202:205], a[228:231], a[56:59], v[202:205]
    ds_read_b64_tr_b16 a[220:221], v37 offset:4096
    v_mov_b32 v84, 0xf149f2ca
    v_mfma_f32_16x16x32_bf16 v[210:213], a[228:231], a[60:63], v[210:213]
    ds_read_b64_tr_b16 a[222:223], v37 offset:6144
    s_waitcnt vmcnt(13) lgkmcnt(8)
    v_mfma_f32_16x16x32_bf16 v[182:185], a[200:203], a[64:67], v[182:185]
    ds_read_b64_tr_b16 a[224:225], v36 offset:4096
    buffer_load_dwordx4 a[108:111], v78, s[28:31], s1 offen offset:2304 sc1
    v_mfma_f32_16x16x32_bf16 v[190:193], a[200:203], a[68:71], v[190:193]
    ds_read_b64_tr_b16 a[226:227], v36 offset:6144
    s_add_u32 m0, s58, 147456
    s_mov_b32 s83, 0x3e8b97f6
    v_mfma_f32_16x16x32_bf16 v[198:201], a[204:207], a[64:67], v[198:201]
    ds_read_b64_tr_b16 a[228:229], v38 offset:4096
    s_add_u32 s0, s0, 458752
    v_mfma_f32_16x16x32_bf16 v[206:209], a[204:207], a[68:71], v[206:209]
    ds_read_b64_tr_b16 a[230:231], v38 offset:6144
    s_mov_b32 s78, 0xbdd2d3e8
    s_mov_b32 s79, 0xbdd2d3e8
    s_waitcnt lgkmcnt(8)
    v_mfma_f32_16x16x32_bf16 v[186:189], a[208:211], a[64:67], v[186:189]
    s_barrier
    s_mov_b32 s14, 0
    s_load_dword s14, s[44:45], s15
    ds_read_b64_tr_b16 a[200:201], v35 offset:16384
    s_cmp_eq_u32 s0, 3670016
    s_cselect_b32 s0, 0, s0
    buffer_load_dwordx4 v55, s[20:23], s0 offen lds
    v_mfma_f32_16x16x32_bf16 v[194:197], a[208:211], a[68:71], v[194:197]
    ds_read_b64_tr_b16 a[202:203], v35 offset:18432
    s_mov_b32 s80, 1.0
    v_mfma_f32_16x16x32_bf16 v[202:205], a[212:215], a[64:67], v[202:205]
    ds_read_b64_tr_b16 a[204:205], v37 offset:16384
    buffer_load_dwordx4 v56, s[20:23], s0 offen offset:1024 lds
    v_mfma_f32_16x16x32_bf16 v[210:213], a[212:215], a[68:71], v[210:213]
    ds_read_b64_tr_b16 a[206:207], v37 offset:18432
    s_mov_b32 s81, 1.0
    s_waitcnt vmcnt(14) lgkmcnt(8)
    v_mfma_f32_16x16x32_bf16 v[182:185], a[216:219], a[72:75], v[182:185]
    ds_read_b64_tr_b16 a[208:209], v36 offset:16384
    v_mov_b32 v108, 0xc0135761
    v_mfma_f32_16x16x32_bf16 v[190:193], a[216:219], a[76:79], v[190:193]
    ds_read_b64_tr_b16 a[210:211], v36 offset:18432
    buffer_load_dwordx4 v57, s[20:23], s0 offen offset:2048 lds
    v_mov_b32 v109, 0xc0135761
    v_mfma_f32_16x16x32_bf16 v[198:201], a[220:223], a[72:75], v[198:201]
    ds_read_b64_tr_b16 a[212:213], v38 offset:16384
    v_lshrrev_b32 v13, 1, v2
    v_mfma_f32_16x16x32_bf16 v[206:209], a[220:223], a[76:79], v[206:209]
    ds_read_b64_tr_b16 a[214:215], v38 offset:18432
    s_waitcnt lgkmcnt(8)
    v_mfma_f32_16x16x32_bf16 v[186:189], a[224:227], a[72:75], v[186:189]
    ds_read_b64_tr_b16 a[216:217], v35 offset:20480
    buffer_load_dwordx4 v58, s[20:23], s0 offen offset:3072 lds
    v_mfma_f32_16x16x32_bf16 v[194:197], a[224:227], a[76:79], v[194:197]
    ds_read_b64_tr_b16 a[218:219], v35 offset:22528
    s_add_u32 s1, s1, 8192
    v_lshlrev_b32 v14, 1, v3
    v_mfma_f32_16x16x32_bf16 v[202:205], a[228:231], a[72:75], v[202:205]
    ds_read_b64_tr_b16 a[220:221], v37 offset:20480
    s_and_b32 s1, s1, 0xffff
    v_mfma_f32_16x16x32_bf16 v[210:213], a[228:231], a[76:79], v[210:213]
    ds_read_b64_tr_b16 a[222:223], v37 offset:22528
    s_waitcnt vmcnt(14) lgkmcnt(8)
    v_mfma_f32_16x16x32_bf16 v[182:185], a[200:203], a[80:83], v[182:185]
    ds_read_b64_tr_b16 a[224:225], v36 offset:20480
    buffer_load_dwordx4 a[112:115], v78, s[28:31], s1 offen offset:0 sc1
    v_mfma_f32_16x16x32_bf16 v[190:193], a[200:203], a[84:87], v[190:193]
L_pad0:
    s_cbranch_execz L_warm
    ds_read_b64_tr_b16 a[226:227], v36 offset:22528
    v_sub_u32 v13, v13, v14
    v_mfma_f32_16x16x32_bf16 v[198:201], a[204:207], a[80:83], v[198:201]
    ds_read_b64_tr_b16 a[228:229], v38 offset:20480
    buffer_load_dwordx4 a[116:119], v78, s[28:31], s1 offen offset:256 sc1
    v_mfma_f32_16x16x32_bf16 v[206:209], a[204:207], a[84:87], v[206:209]
    ds_read_b64_tr_b16 a[230:231], v38 offset:22528
    v_mov_b32 v14, 0x3f80
    s_waitcnt lgkmcnt(8)
    v_mfma_f32_16x16x32_bf16 v[186:189], a[208:211], a[80:83], v[186:189]
    ds_read_b64_tr_b16 a[200:201], v35 offset:32768
    v_cndmask_b32 v14, v14, 1.0, s[70:71]
    v_mfma_f32_16x16x32_bf16 v[194:197], a[208:211], a[84:87], v[194:197]
    ds_read_b64_tr_b16 a[202:203], v35 offset:34816
    buffer_load_dwordx4 a[120:123], v78, s[28:31], s1 offen offset:2048 sc1
    v_cmp_eq_i32 vcc, 0, v13
    v_mfma_f32_16x16x32_bf16 v[202:205], a[212:215], a[80:83], v[202:205]
    ds_read_b64_tr_b16 a[204:205], v37 offset:32768
    v_accvgpr_write_b32 a248, 0
    v_mfma_f32_16x16x32_bf16 v[210:213], a[212:215], a[84:87], v[210:213]
    ds_read_b64_tr_b16 a[206:207], v37 offset:34816
    s_waitcnt vmcnt(15) lgkmcnt(8)
    v_mfma_f32_16x16x32_bf16 v[182:185], a[216:219], a[88:91], v[182:185]
    ds_read_b64_tr_b16 a[208:209], v36 offset:32768
    buffer_load_dwordx4 a[124:127], v78, s[28:31], s1 offen offset:2304 sc1
    v_mfma_f32_16x16x32_bf16 v[190:193], a[216:219], a[92:95], v[190:193]
    ds_read_b64_tr_b16 a[210:211], v36 offset:34816
    s_add_u32 m0, s58, 0
    v_accvgpr_write_b32 a252, 0
    v_mfma_f32_16x16x32_bf16 v[198:201], a[220:223], a[88:91], v[198:201]
    ds_read_b64_tr_b16 a[212:213], v38 offset:32768
    s_add_u32 s0, s0, 458752
    v_mfma_f32_16x16x32_bf16 v[206:209], a[220:223], a[92:95], v[206:209]
    ds_read_b64_tr_b16 a[214:215], v38 offset:34816
    s_waitcnt lgkmcnt(8)
    v_mfma_f32_16x16x32_bf16 v[186:189], a[224:227], a[88:91], v[186:189]
    ds_read_b64_tr_b16 a[216:217], v35 offset:36864
    s_cmp_eq_u32 s0, 3670016
    v_mfma_f32_16x16x32_bf16 v[194:197], a[224:227], a[92:95], v[194:197]
    ds_read_b64_tr_b16 a[218:219], v35 offset:38912
    s_cselect_b32 s0, 0, s0
    buffer_load_dwordx4 v55, s[20:23], s0 offen lds
    v_cndmask_b32 v15, 0, v14, vcc
    v_mfma_f32_16x16x32_bf16 v[202:205], a[228:231], a[88:91], v[202:205]
    ds_read_b64_tr_b16 a[220:221], v37 offset:36864
    v_accvgpr_write_b32 a250, v15
    v_mfma_f32_16x16x32_bf16 v[210:213], a[228:231], a[92:95], v[210:213]
    ds_read_b64_tr_b16 a[222:223], v37 offset:38912
    s_waitcnt vmcnt(11) lgkmcnt(8)
    v_mfma_f32_16x16x32_bf16 v[182:185], a[200:203], a[96:99], v[182:185]
    ds_read_b64_tr_b16 a[224:225], v36 offset:36864
    buffer_load_dwordx4 v56, s[20:23], s0 offen offset:1024 lds
    v_mfma_f32_16x16x32_bf16 v[190:193], a[200:203], a[100:103], v[190:193]
    ds_read_b64_tr_b16 a[226:227], v36 offset:38912
    v_cmp_eq_i32 vcc, 1, v13
    v_mfma_f32_16x16x32_bf16 v[198:201], a[204:207], a[96:99], v[198:201]
    ds_read_b64_tr_b16 a[228:229], v38 offset:36864
    buffer_load_dwordx4 v57, s[20:23], s0 offen offset:2048 lds
    v_mfma_f32_16x16x32_bf16 v[206:209], a[204:207], a[100:103], v[206:209]
    ds_read_b64_tr_b16 a[230:231], v38 offset:38912
    v_accvgpr_write_b32 a249, 0
    s_waitcnt lgkmcnt(8)
    v_mfma_f32_16x16x32_bf16 v[186:189], a[208:211], a[96:99], v[186:189]
    ds_read_b64_tr_b16 a[200:201], v35 offset:49152
    v_accvgpr_write_b32 a253, 0
    v_mfma_f32_16x16x32_bf16 v[194:197], a[208:211], a[100:103], v[194:197]
    ds_read_b64_tr_b16 a[202:203], v35 offset:51200
    buffer_load_dwordx4 v58, s[20:23], s0 offen offset:3072 lds
    v_cndmask_b32 v15, 0, v14, vcc
    v_mfma_f32_16x16x32_bf16 v[202:205], a[212:215], a[96:99], v[202:205]
    ds_read_b64_tr_b16 a[204:205], v37 offset:49152
    s_add_u32 m0, s58, 16384
    v_mfma_f32_16x16x32_bf16 v[210:213], a[212:215], a[100:103], v[210:213]
    ds_read_b64_tr_b16 a[206:207], v37 offset:51200
    s_waitcnt vmcnt(12) lgkmcnt(8)
    v_mfma_f32_16x16x32_bf16 v[182:185], a[216:219], a[104:107], v[182:185]
    ds_read_b64_tr_b16 a[208:209], v36 offset:49152
    s_add_u32 s0, s0, 458752
    v_mfma_f32_16x16x32_bf16 v[190:193], a[216:219], a[108:111], v[190:193]
    ds_read_b64_tr_b16 a[210:211], v36 offset:51200
    s_cmp_eq_u32 s0, 3670016
    s_cselect_b32 s0, 0, s0
    buffer_load_dwordx4 v55, s[20:23], s0 offen lds
    v_accvgpr_write_b32 a251, v15
    v_mfma_f32_16x16x32_bf16 v[198:201], a[220:223], a[104:107], v[198:201]
    ds_read_b64_tr_b16 a[212:213], v38 offset:49152
    v_mfma_f32_16x16x32_bf16 v[206:209], a[220:223], a[108:111], v[206:209]
    ds_read_b64_tr_b16 a[214:215], v38 offset:51200
    s_waitcnt lgkmcnt(8)
    v_mfma_f32_16x16x32_bf16 v[186:189], a[224:227], a[104:107], v[186:189]
    ds_read_b64_tr_b16 a[216:217], v35 offset:53248
    buffer_load_dwordx4 v56, s[20:23], s0 offen offset:1024 lds
    v_mfma_f32_16x16x32_bf16 v[194:197], a[224:227], a[108:111], v[194:197]
    ds_read_b64_tr_b16 a[218:219], v35 offset:55296
    v_mfma_f32_16x16x32_bf16 v[202:205], a[228:231], a[104:107], v[202:205]
    ds_read_b64_tr_b16 a[220:221], v37 offset:53248
    buffer_load_dwordx4 v57, s[20:23], s0 offen offset:2048 lds
    v_mfma_f32_16x16x32_bf16 v[210:213], a[228:231], a[108:111], v[210:213]
    ds_read_b64_tr_b16 a[222:223], v37 offset:55296
    s_waitcnt vmcnt(9) lgkmcnt(8)
    v_mfma_f32_16x16x32_bf16 v[182:185], a[200:203], a[112:115], v[182:185]
    ds_read_b64_tr_b16 a[224:225], v36 offset:53248
    v_mfma_f32_16x16x32_bf16 v[190:193], a[200:203], a[116:119], v[190:193]
    ds_read_b64_tr_b16 a[226:227], v36 offset:55296
    buffer_load_dwordx4 v58, s[20:23], s0 offen offset:3072 lds
    v_mfma_f32_16x16x32_bf16 v[198:201], a[204:207], a[112:115], v[198:201]
    ds_read_b64_tr_b16 a[228:229], v38 offset:53248
    s_add_u32 m0, s58, 32768
    v_mfma_f32_16x16x32_bf16 v[206:209], a[204:207], a[116:119], v[206:209]
    ds_read_b64_tr_b16 a[230:231], v38 offset:55296
    s_waitcnt lgkmcnt(8)
    v_mfma_f32_16x16x32_bf16 v[186:189], a[208:211], a[112:115], v[186:189]
    s_cmp_ge_u32 s14, 14
    s_cbranch_scc0 L_pollin1
L_pollok1:
    s_barrier
    ds_read_b64_tr_b16 a[200:201], v39 offset:0
    s_add_u32 s0, s0, 458752
    v_mfma_f32_16x16x32_bf16 v[194:197], a[208:211], a[116:119], v[194:197]
    ds_read_b64_tr_b16 a[202:203], v39 offset:2048
    s_cmp_eq_u32 s0, 3670016
    s_cselect_b32 s0, 0, s0
    buffer_load_dwordx4 v55, s[20:23], s0 offen lds
    v_mfma_f32_16x16x32_bf16 v[202:205], a[212:215], a[112:115], v[202:205]
    ds_read_b64_tr_b16 a[204:205], v41 offset:0
    v_mfma_f32_16x16x32_bf16 v[210:213], a[212:215], a[116:119], v[210:213]
    ds_read_b64_tr_b16 a[206:207], v41 offset:2048
    s_waitcnt vmcnt(9) lgkmcnt(8)
    v_mfma_f32_16x16x32_bf16 v[182:185], a[216:219], a[120:123], v[182:185]
    ds_read_b64_tr_b16 a[208:209], v40 offset:0
    buffer_load_dwordx4 v56, s[20:23], s0 offen offset:1024 lds
    v_mfma_f32_16x16x32_bf16 v[190:193], a[216:219], a[124:127], v[190:193]
    ds_read_b64_tr_b16 a[210:211], v40 offset:2048
    v_mfma_f32_16x16x32_bf16 v[198:201], a[220:223], a[120:123], v[198:201]
    ds_read_b64_tr_b16 a[212:213], v42 offset:0
    buffer_load_dwordx4 v57, s[20:23], s0 offen offset:2048 lds
    v_mfma_f32_16x16x32_bf16 v[206:209], a[220:223], a[124:127], v[206:209]
    ds_read_b64_tr_b16 a[214:215], v42 offset:2048
    s_waitcnt lgkmcnt(8)
    v_mfma_f32_16x16x32_bf16 v[186:189], a[224:227], a[120:123], v[186:189]
    ds_read_b64_tr_b16 a[216:217], v39 offset:4096
    v_mfma_f32_16x16x32_bf16 v[194:197], a[224:227], a[124:127], v[194:197]
    ds_read_b64_tr_b16 a[218:219], v39 offset:6144
    buffer_load_dwordx4 v58, s[20:23], s0 offen offset:3072 lds
    v_mfma_f32_16x16x32_bf16 v[202:205], a[228:231], a[120:123], v[202:205]
    ds_read_b64_tr_b16 a[220:221], v41 offset:4096
    s_add_u32 m0, s58, 49152
    v_mfma_f32_16x16x32_bf16 v[210:213], a[228:231], a[124:127], v[210:213]
    ds_read_b64_tr_b16 a[222:223], v41 offset:6144
    s_waitcnt lgkmcnt(8)
    v_mfma_f32_16x16x32_bf16 v[150:153], a[200:203], a[0:3], v[150:153]
    ds_read_b64_tr_b16 a[224:225], v40 offset:4096
    s_add_u32 s0, s0, 458752
    v_mfma_f32_16x16x32_bf16 v[158:161], a[200:203], a[4:7], v[158:161]
    ds_read_b64_tr_b16 a[226:227], v40 offset:6144
    s_cmp_eq_u32 s0, 3670016
    v_mfma_f32_16x16x32_bf16 v[166:169], a[204:207], a[0:3], 0
    ds_read_b64_tr_b16 a[228:229], v42 offset:4096
    s_cselect_b32 s0, 0, s0
    buffer_load_dwordx4 v55, s[20:23], s0 offen lds
    v_mfma_f32_16x16x32_bf16 v[174:177], a[204:207], a[4:7], 0
    ds_read_b64_tr_b16 a[230:231], v42 offset:6144
    v_cvt_pk_bf16_f32 v182, v182, v183
    v_cvt_pk_bf16_f32 v183, v184, v185
    v_cvt_pk_bf16_f32 v184, v186, v187
    s_waitcnt lgkmcnt(8)
    v_mfma_f32_16x16x32_bf16 v[154:157], a[208:211], a[0:3], v[154:157]
    ds_read_b64_tr_b16 a[200:201], v39 offset:16384
    buffer_load_dwordx4 v56, s[20:23], s0 offen offset:1024 lds
    v_mfma_f32_16x16x32_bf16 v[162:165], a[208:211], a[4:7], v[162:165]
    ds_read_b64_tr_b16 a[202:203], v39 offset:18432
    v_cvt_pk_bf16_f32 v185, v188, v189
    buffer_store_dwordx4 v[182:185], v23, s[28:31], 0 offen offset:0 sc1
    v_cvt_pk_bf16_f32 v190, v190, v191
    v_cvt_pk_bf16_f32 v191, v192, v193
    v_cvt_pk_bf16_f32 v192, v194, v195
    v_mfma_f32_16x16x32_bf16 v[170:173], a[212:215], a[0:3], 0
    ds_read_b64_tr_b16 a[204:205], v41 offset:16384
    v_cvt_pk_bf16_f32 v193, v196, v197
    v_mfma_f32_16x16x32_bf16 v[178:181], a[212:215], a[4:7], 0
    ds_read_b64_tr_b16 a[206:207], v41 offset:18432
    buffer_store_dwordx4 v[190:193], v23, s[28:31], 0 offen offset:1024 sc1
    v_cvt_pk_bf16_f32 v198, v198, v199
    v_cvt_pk_bf16_f32 v199, v200, v201
    v_cvt_pk_bf16_f32 v200, v202, v203
    s_waitcnt lgkmcnt(8)
    v_mfma_f32_16x16x32_bf16 v[150:153], a[216:219], a[8:11], v[150:153]
    ds_read_b64_tr_b16 a[208:209], v40 offset:16384
    buffer_load_dwordx4 v57, s[20:23], s0 offen offset:2048 lds
    v_mfma_f32_16x16x32_bf16 v[158:161], a[216:219], a[12:15], v[158:161]
    ds_read_b64_tr_b16 a[210:211], v40 offset:18432
    v_cvt_pk_bf16_f32 v201, v204, v205
    buffer_store_dwordx4 v[198:201], v23, s[28:31], 0 offen offset:2048 sc1
    v_cvt_pk_bf16_f32 v206, v206, v207
    v_cvt_pk_bf16_f32 v207, v208, v209
    v_cvt_pk_bf16_f32 v208, v210, v211
    v_mfma_f32_16x16x32_bf16 v[166:169], a[220:223], a[8:11], v[166:169]
    ds_read_b64_tr_b16 a[212:213], v42 offset:16384
    v_cvt_pk_bf16_f32 v209, v212, v213
    v_mfma_f32_16x16x32_bf16 v[174:177], a[220:223], a[12:15], v[174:177]
    ds_read_b64_tr_b16 a[214:215], v42 offset:18432
    s_waitcnt lgkmcnt(8)
    v_mfma_f32_16x16x32_bf16 v[154:157], a[224:227], a[8:11], v[154:157]
    ds_read_b64_tr_b16 a[216:217], v39 offset:20480
    buffer_load_dwordx4 v58, s[20:23], s0 offen offset:3072 lds
    v_mfma_f32_16x16x32_bf16 v[162:165], a[224:227], a[12:15], v[162:165]
    ds_read_b64_tr_b16 a[218:219], v39 offset:22528
    s_add_u32 m0, s58, 65536
    buffer_store_dwordx4 v[206:209], v23, s[28:31], 0 offen offset:3072 sc1
    v_mfma_f32_16x16x32_bf16 v[170:173], a[228:231], a[8:11], v[170:173]
    ds_read_b64_tr_b16 a[220:221], v41 offset:20480
    s_add_u32 s0, s0, 458752
    v_mfma_f32_16x16x32_bf16 v[178:181], a[228:231], a[12:15], v[178:181]
    ds_read_b64_tr_b16 a[222:223], v41 offset:22528
    s_waitcnt lgkmcnt(8)
    v_mfma_f32_16x16x32_bf16 v[150:153], a[200:203], a[16:19], v[150:153]
    ds_read_b64_tr_b16 a[224:225], v40 offset:20480
    s_cmp_eq_u32 s0, 3670016
    v_mfma_f32_16x16x32_bf16 v[158:161], a[200:203], a[20:23], v[158:161]
    ds_read_b64_tr_b16 a[226:227], v40 offset:22528
    s_cselect_b32 s0, 0, s0
    buffer_load_dwordx4 v55, s[20:23], s0 offen lds
    v_mfma_f32_16x16x32_bf16 v[166:169], a[204:207], a[16:19], v[166:169]
    ds_read_b64_tr_b16 a[228:229], v42 offset:20480
    v_mfma_f32_16x16x32_bf16 v[174:177], a[204:207], a[20:23], v[174:177]
    ds_read_b64_tr_b16 a[230:231], v42 offset:22528
    s_waitcnt lgkmcnt(8)
    v_mfma_f32_16x16x32_bf16 v[154:157], a[208:211], a[16:19], v[154:157]
    s_waitcnt vmcnt(13)
    s_barrier
    ds_read_b64_tr_b16 a[200:201], v31 offset:0
    buffer_load_dwordx4 v56, s[20:23], s0 offen offset:1024 lds
    v_mfma_f32_16x16x32_bf16 v[162:165], a[208:211], a[20:23], v[162:165]
    ds_read_b64_tr_b16 a[202:203], v31 offset:2048
    v_mfma_f32_16x16x32_bf16 v[170:173], a[212:215], a[16:19], v[170:173]
    ds_read_b64_tr_b16 a[204:205], v33 offset:0
    buffer_load_dwordx4 v57, s[20:23], s0 offen offset:2048 lds
    v_mfma_f32_16x16x32_bf16 v[178:181], a[212:215], a[20:23], v[178:181]
    ds_read_b64_tr_b16 a[206:207], v33 offset:2048
    s_waitcnt lgkmcnt(8)
    v_mfma_f32_16x16x32_bf16 v[150:153], a[216:219], a[24:27], v[150:153]
    ds_read_b64_tr_b16 a[208:209], v32 offset:0
    v_mfma_f32_16x16x32_bf16 v[158:161], a[216:219], a[28:31], v[158:161]
    ds_read_b64_tr_b16 a[210:211], v32 offset:2048
    buffer_load_dwordx4 v58, s[20:23], s0 offen offset:3072 lds
    v_mfma_f32_16x16x32_bf16 v[166:169], a[220:223], a[24:27], v[166:169]
    ds_read_b64_tr_b16 a[212:213], v34 offset:0
    s_add_u32 m0, s58, 81920
    v_mfma_f32_16x16x32_bf16 v[174:177], a[220:223], a[28:31], v[174:177]
    ds_read_b64_tr_b16 a[214:215], v34 offset:2048
    s_waitcnt lgkmcnt(8)
    v_mfma_f32_16x16x32_bf16 v[154:157], a[224:227], a[24:27], v[154:157]
    ds_read_b64_tr_b16 a[216:217], v31 offset:4096
    s_add_u32 s0, s0, 458752
    v_mfma_f32_16x16x32_bf16 v[162:165], a[224:227], a[28:31], v[162:165]
    ds_read_b64_tr_b16 a[218:219], v31 offset:6144
    s_cmp_eq_u32 s0, 3670016
    v_mfma_f32_16x16x32_bf16 v[170:173], a[228:231], a[24:27], v[170:173]
    ds_read_b64_tr_b16 a[220:221], v33 offset:4096
    s_cselect_b32 s0, 0, s0
    buffer_load_dwordx4 v55, s[20:23], s0 offen lds
    v_mfma_f32_16x16x32_bf16 v[178:181], a[228:231], a[28:31], v[178:181]
    ds_read_b64_tr_b16 a[222:223], v33 offset:6144
    s_waitcnt lgkmcnt(8)
    v_mfma_f32_16x16x32_bf16 v[150:153], a[200:203], a[32:35], v[150:153]
    ds_read_b64_tr_b16 a[224:225], v32 offset:4096
    buffer_load_dwordx4 v56, s[20:23], s0 offen offset:1024 lds
    v_mfma_f32_16x16x32_bf16 v[158:161], a[200:203], a[36:39], v[158:161]
    ds_read_b64_tr_b16 a[226:227], v32 offset:6144
    v_mfma_f32_16x16x32_bf16 v[166:169], a[204:207], a[32:35], v[166:169]
    ds_read_b64_tr_b16 a[228:229], v34 offset:4096
    v_mfma_f32_16x16x32_bf16 v[174:177], a[204:207], a[36:39], v[174:177]
    ds_read_b64_tr_b16 a[230:231], v34 offset:6144
    s_waitcnt lgkmcnt(8)
    v_mfma_f32_16x16x32_bf16 v[154:157], a[208:211], a[32:35], v[154:157]
    s_waitcnt vmcnt(6)
    s_atomic_add s36, s[28:29], s37
    ds_read_b64_tr_b16 a[200:201], v31 offset:16384
    buffer_load_dwordx4 v57, s[20:23], s0 offen offset:2048 lds
    v_mfma_f32_16x16x32_bf16 v[162:165], a[208:211], a[36:39], v[162:165]
    ds_read_b64_tr_b16 a[202:203], v31 offset:18432
    v_mfma_f32_16x16x32_bf16 v[170:173], a[212:215], a[32:35], v[170:173]
    ds_read_b64_tr_b16 a[204:205], v33 offset:16384
    buffer_load_dwordx4 v58, s[20:23], s0 offen offset:3072 lds
    v_mfma_f32_16x16x32_bf16 v[178:181], a[212:215], a[36:39], v[178:181]
    ds_read_b64_tr_b16 a[206:207], v33 offset:18432
    s_waitcnt lgkmcnt(8)
    v_mfma_f32_16x16x32_bf16 v[150:153], a[216:219], a[40:43], v[150:153]
    ds_read_b64_tr_b16 a[208:209], v32 offset:16384
    s_add_u32 m0, s59, 98304
    v_mfma_f32_16x16x32_bf16 v[158:161], a[216:219], a[44:47], v[158:161]
    ds_read_b64_tr_b16 a[210:211], v32 offset:18432
    buffer_load_dwordx4 v80, s[28:31], s63 offen sc1 lds
    v_mfma_f32_16x16x32_bf16 v[166:169], a[220:223], a[40:43], v[166:169]
    ds_read_b64_tr_b16 a[212:213], v34 offset:16384
    v_mfma_f32_16x16x32_bf16 v[174:177], a[220:223], a[44:47], v[174:177]
    ds_read_b64_tr_b16 a[214:215], v34 offset:18432
    s_waitcnt lgkmcnt(8)
    v_mfma_f32_16x16x32_bf16 v[154:157], a[224:227], a[40:43], v[154:157]
    ds_read_b64_tr_b16 a[216:217], v31 offset:20480
    v_mfma_f32_16x16x32_bf16 v[162:165], a[224:227], a[44:47], v[162:165]
    ds_read_b64_tr_b16 a[218:219], v31 offset:22528
    buffer_load_dwordx4 v80, s[28:31], s63 offen offset:1024 sc1 lds
    v_mfma_f32_16x16x32_bf16 v[170:173], a[228:231], a[40:43], v[170:173]
    ds_read_b64_tr_b16 a[220:221], v33 offset:20480
    v_mfma_f32_16x16x32_bf16 v[178:181], a[228:231], a[44:47], v[178:181]
    ds_read_b64_tr_b16 a[222:223], v33 offset:22528
    s_waitcnt lgkmcnt(8)
    v_mfma_f32_16x16x32_bf16 v[150:153], a[200:203], a[48:51], v[150:153]
    ds_read_b64_tr_b16 a[224:225], v32 offset:20480
    buffer_load_dwordx4 v80, s[28:31], s63 offen offset:2048 sc1 lds
    v_mfma_f32_16x16x32_bf16 v[158:161], a[200:203], a[52:55], v[158:161]
    ds_read_b64_tr_b16 a[226:227], v32 offset:22528
    s_add_u32 m0, s100, 126976
    v_mfma_f32_16x16x32_bf16 v[166:169], a[204:207], a[48:51], v[166:169]
    ds_read_b64_tr_b16 a[228:229], v34 offset:20480
    v_mfma_f32_16x16x32_bf16 v[174:177], a[204:207], a[52:55], v[174:177]
    ds_read_b64_tr_b16 a[230:231], v34 offset:22528
    s_waitcnt lgkmcnt(8)
    v_mfma_f32_16x16x32_bf16 v[154:157], a[208:211], a[48:51], v[154:157]
    s_barrier
    ds_read_b64_tr_b16 a[200:201], v31 offset:32768
    buffer_load_dwordx4 v69, s[28:31], s62 offen sc1 lds
    v_mfma_f32_16x16x32_bf16 v[162:165], a[208:211], a[52:55], v[162:165]
    ds_read_b64_tr_b16 a[202:203], v31 offset:34816
    s_add_u32 m0, s58, 110592
    v_mfma_f32_16x16x32_bf16 v[170:173], a[212:215], a[48:51], v[170:173]
    ds_read_b64_tr_b16 a[204:205], v33 offset:32768
    v_mfma_f32_16x16x32_bf16 v[178:181], a[212:215], a[52:55], v[178:181]
    ds_read_b64_tr_b16 a[206:207], v33 offset:34816
    s_waitcnt lgkmcnt(8)
    v_mfma_f32_16x16x32_bf16 v[150:153], a[216:219], a[56:59], v[150:153]
    ds_read_b64_tr_b16 a[208:209], v32 offset:32768
    buffer_load_dwordx4 v67, s[28:31], s62 offen sc1 lds
    v_mfma_f32_16x16x32_bf16 v[158:161], a[216:219], a[60:63], v[158:161]
    ds_read_b64_tr_b16 a[210:211], v32 offset:34816
    v_mfma_f32_16x16x32_bf16 v[166:169], a[220:223], a[56:59], v[166:169]
    ds_read_b64_tr_b16 a[212:213], v34 offset:32768
    v_mfma_f32_16x16x32_bf16 v[174:177], a[220:223], a[60:63], v[174:177]
    ds_read_b64_tr_b16 a[214:215], v34 offset:34816
    s_waitcnt lgkmcnt(8)
    v_mfma_f32_16x16x32_bf16 v[154:157], a[224:227], a[56:59], v[154:157]
    ds_read_b64_tr_b16 a[216:217], v31 offset:36864
    buffer_load_dwordx4 v67, s[28:31], s62 offen offset:1024 sc1 lds
    v_mfma_f32_16x16x32_bf16 v[162:165], a[224:227], a[60:63], v[162:165]
    ds_read_b64_tr_b16 a[218:219], v31 offset:38912
    v_mfma_f32_16x16x32_bf16 v[170:173], a[228:231], a[56:59], v[170:173]
    ds_read_b64_tr_b16 a[220:221], v33 offset:36864
    buffer_load_dwordx4 v68, s[28:31], s62 offen offset:2048 sc1 lds
    v_mfma_f32_16x16x32_bf16 v[178:181], a[228:231], a[60:63], v[178:181]
    ds_read_b64_tr_b16 a[222:223], v33 offset:38912
    s_waitcnt lgkmcnt(8)
    v_mfma_f32_16x16x32_bf16 v[150:153], a[200:203], a[64:67], v[150:153]
    ds_read_b64_tr_b16 a[224:225], v32 offset:36864
    v_mfma_f32_16x16x32_bf16 v[158:161], a[200:203], a[68:71], v[158:161]
    ds_read_b64_tr_b16 a[226:227], v32 offset:38912
    v_mfma_f32_16x16x32_bf16 v[166:169], a[204:207], a[64:67], v[166:169]
    ds_read_b64_tr_b16 a[228:229], v34 offset:36864
    buffer_load_dwordx4 v68, s[28:31], s62 offen offset:3072 sc1 lds
    v_mfma_f32_16x16x32_bf16 v[174:177], a[204:207], a[68:71], v[174:177]
    ds_read_b64_tr_b16 a[230:231], v34 offset:38912
    s_waitcnt lgkmcnt(8)
    v_mfma_f32_16x16x32_bf16 v[154:157], a[208:211], a[64:67], v[154:157]
    s_xor_b32 s37, s37, 1024
    s_mov_b32 s14, 0
    s_load_dword s14, s[28:29], s37
    ds_read_b64_tr_b16 a[200:201], v31 offset:49152
    s_add_u32 m0, s59, 131072
    v_mfma_f32_16x16x32_bf16 v[162:165], a[208:211], a[68:71], v[162:165]
    ds_read_b64_tr_b16 a[202:203], v31 offset:51200
    s_add_u32 s63, s63, 12288
    v_mfma_f32_16x16x32_bf16 v[170:173], a[212:215], a[64:67], v[170:173]
    ds_read_b64_tr_b16 a[204:205], v33 offset:49152
    s_cmp_eq_u32 s63, 86016
    s_cselect_b32 s63, 0, s63
    buffer_load_dwordx4 v80, s[28:31], s63 offen sc1 lds
    v_mfma_f32_16x16x32_bf16 v[178:181], a[212:215], a[68:71], v[178:181]
    ds_read_b64_tr_b16 a[206:207], v33 offset:51200
    s_waitcnt lgkmcnt(8)
    v_mfma_f32_16x16x32_bf16 v[150:153], a[216:219], a[72:75], v[150:153]
    ds_read_b64_tr_b16 a[208:209], v32 offset:49152
    buffer_load_dwordx4 v80, s[28:31], s63 offen offset:1024 sc1 lds
    v_mfma_f32_16x16x32_bf16 v[158:161], a[216:219], a[76:79], v[158:161]
    ds_read_b64_tr_b16 a[210:211], v32 offset:51200
    v_mfma_f32_16x16x32_bf16 v[166:169], a[220:223], a[72:75], v[166:169]
    ds_read_b64_tr_b16 a[212:213], v34 offset:49152
    v_mfma_f32_16x16x32_bf16 v[174:177], a[220:223], a[76:79], v[174:177]
    ds_read_b64_tr_b16 a[214:215], v34 offset:51200
    s_waitcnt lgkmcnt(8)
    v_mfma_f32_16x16x32_bf16 v[154:157], a[224:227], a[72:75], v[154:157]
    ds_read_b64_tr_b16 a[216:217], v31 offset:53248
    buffer_load_dwordx4 v80, s[28:31], s63 offen offset:2048 sc1 lds
    v_mfma_f32_16x16x32_bf16 v[162:165], a[224:227], a[76:79], v[162:165]
    ds_read_b64_tr_b16 a[218:219], v31 offset:55296
    s_add_u32 m0, s100, 159744
    v_mfma_f32_16x16x32_bf16 v[170:173], a[228:231], a[72:75], v[170:173]
    ds_read_b64_tr_b16 a[220:221], v33 offset:53248
    s_add_u32 s62, s62, 262144
    v_mfma_f32_16x16x32_bf16 v[178:181], a[228:231], a[76:79], v[178:181]
    ds_read_b64_tr_b16 a[222:223], v33 offset:55296
    s_waitcnt lgkmcnt(8)
    v_mfma_f32_16x16x32_bf16 v[150:153], a[200:203], a[80:83], v[150:153]
    ds_read_b64_tr_b16 a[224:225], v32 offset:53248
    s_cmp_eq_u32 s62, 1835008
    v_mfma_f32_16x16x32_bf16 v[158:161], a[200:203], a[84:87], v[158:161]
    ds_read_b64_tr_b16 a[226:227], v32 offset:55296
    s_cselect_b32 s62, 0, s62
    buffer_load_dwordx4 v69, s[28:31], s62 offen sc1 lds
    v_mfma_f32_16x16x32_bf16 v[166:169], a[204:207], a[80:83], v[166:169]
    ds_read_b64_tr_b16 a[228:229], v34 offset:53248
    s_add_u32 m0, s58, 143360
    v_mfma_f32_16x16x32_bf16 v[174:177], a[204:207], a[84:87], v[174:177]
    ds_read_b64_tr_b16 a[230:231], v34 offset:55296
    s_waitcnt lgkmcnt(8)
    v_mfma_f32_16x16x32_bf16 v[154:157], a[208:211], a[80:83], v[154:157]
    s_waitcnt vmcnt(12)
    s_barrier
    ds_read_b64_tr_b16 a[200:201], v37 offset:0
    buffer_load_dwordx4 v67, s[28:31], s62 offen sc1 lds
    v_mfma_f32_16x16x32_bf16 v[162:165], a[208:211], a[84:87], v[162:165]
    ds_read_b64_tr_b16 a[202:203], v37 offset:2048
    v_mfma_f32_16x16x32_bf16 v[170:173], a[212:215], a[80:83], v[170:173]
    ds_read_b64_tr_b16 a[204:205], v38 offset:0
    buffer_load_dwordx4 v67, s[28:31], s62 offen offset:1024 sc1 lds
    v_mfma_f32_16x16x32_bf16 v[178:181], a[212:215], a[84:87], v[178:181]
    ds_read_b64_tr_b16 a[206:207], v38 offset:2048
    s_waitcnt lgkmcnt(8)
    v_mfma_f32_16x16x32_bf16 v[150:153], a[216:219], a[88:91], v[150:153]
    ds_read_b64_tr_b16 a[208:209], v37 offset:4096
    v_mfma_f32_16x16x32_bf16 v[158:161], a[216:219], a[92:95], v[158:161]
    ds_read_b64_tr_b16 a[210:211], v37 offset:6144
    v_mfma_f32_16x16x32_bf16 v[166:169], a[220:223], a[88:91], v[166:169]
    ds_read_b64_tr_b16 a[212:213], v38 offset:4096
    buffer_load_dwordx4 v68, s[28:31], s62 offen offset:2048 sc1 lds
    v_mfma_f32_16x16x32_bf16 v[174:177], a[220:223], a[92:95], v[174:177]
    ds_read_b64_tr_b16 a[214:215], v38 offset:6144
    s_waitcnt lgkmcnt(8)
    v_mfma_f32_16x16x32_bf16 v[154:157], a[224:227], a[88:91], v[154:157]
    ds_read_b64_tr_b16 a[216:217], v37 offset:16384
    v_mfma_f32_16x16x32_bf16 v[162:165], a[224:227], a[92:95], v[162:165]
    ds_read_b64_tr_b16 a[218:219], v37 offset:18432
    buffer_load_dwordx4 v68, s[28:31], s62 offen offset:3072 sc1 lds
    v_mfma_f32_16x16x32_bf16 v[170:173], a[228:231], a[88:91], v[170:173]
    ds_read_b64_tr_b16 a[220:221], v38 offset:16384
    s_add_u32 m0, s59, 0
    v_mfma_f32_16x16x32_bf16 v[178:181], a[228:231], a[92:95], v[178:181]
    ds_read_b64_tr_b16 a[222:223], v38 offset:18432
    s_waitcnt lgkmcnt(8)
    v_mfma_f32_16x16x32_bf16 v[166:169], a[200:203], a[96:99], v[166:169]
    s_cmp_ge_u32 s14, 2
    s_cbranch_scc0 L_pollin2
L_pollok2:
    v_xor_b32 v23, 131072, v23
    v_xor_b32 v22, 8192, v23
    ds_read_b64_tr_b16 a[224:225], v37 offset:20480
    buffer_load_dwordx4 v[214:217], v23, s[28:31], 0 offen offset:0 sc1
    v_mfma_f32_16x16x32_bf16 v[174:177], a[200:203], a[100:103], v[174:177]
    ds_read_b64_tr_b16 a[226:227], v37 offset:22528
    v_mfma_f32_16x16x32_bf16 v[170:173], a[204:207], a[96:99], v[170:173]
    ds_read_b64_tr_b16 a[228:229], v38 offset:20480
    buffer_load_dwordx4 v[218:221], v23, s[28:31], 0 offen offset:1024 sc1
    v_mfma_f32_16x16x32_bf16 v[178:181], a[204:207], a[100:103], v[178:181]
    ds_read_b64_tr_b16 a[230:231], v38 offset:22528
    s_waitcnt lgkmcnt(8)
    v_mfma_f32_16x16x32_bf16 v[166:169], a[208:211], a[104:107], v[166:169]
    ds_read_b64_tr_b16 a[200:201], v35 offset:0
    buffer_load_dwordx4 v[222:225], v22, s[28:31], 0 offen offset:2048 sc1
    v_mfma_f32_16x16x32_bf16 v[174:177], a[208:211], a[108:111], v[174:177]
    ds_read_b64_tr_b16 a[202:203], v35 offset:2048
    v_mfma_f32_16x16x32_bf16 v[170:173], a[212:215], a[104:107], v[170:173]
    ds_read_b64_tr_b16 a[204:205], v36 offset:0
    buffer_load_dwordx4 v[226:229], v22, s[28:31], 0 offen offset:3072 sc1
    v_mfma_f32_16x16x32_bf16 v[178:181], a[212:215], a[108:111], v[178:181]
    ds_read_b64_tr_b16 a[206:207], v36 offset:2048
    s_waitcnt lgkmcnt(8)
    v_mfma_f32_16x16x32_bf16 v[166:169], a[216:219], a[112:115], v[166:169]
    ds_read_b64_tr_b16 a[208:209], v35 offset:4096
    s_add_u32 s63, s63, 12288
    v_mfma_f32_16x16x32_bf16 v[174:177], a[216:219], a[116:119], v[174:177]
    ds_read_b64_tr_b16 a[210:211], v35 offset:6144
    s_cmp_eq_u32 s63, 86016
    s_cselect_b32 s63, 0, s63
    buffer_load_dwordx4 v80, s[28:31], s63 offen sc1 lds
    v_mfma_f32_16x16x32_bf16 v[170:173], a[220:223], a[112:115], v[170:173]
    ds_read_b64_tr_b16 a[212:213], v36 offset:4096
    v_mfma_f32_16x16x32_bf16 v[178:181], a[220:223], a[116:119], v[178:181]
    ds_read_b64_tr_b16 a[214:215], v36 offset:6144
    s_waitcnt lgkmcnt(8)
    v_mfma_f32_16x16x32_bf16 v[166:169], a[224:227], a[120:123], v[166:169]
    ds_read_b64_tr_b16 a[216:217], v35 offset:16384
    buffer_load_dwordx4 v80, s[28:31], s63 offen offset:1024 sc1 lds
    v_mfma_f32_16x16x32_bf16 v[174:177], a[224:227], a[124:127], v[174:177]
    ds_read_b64_tr_b16 a[218:219], v35 offset:18432
    v_mfma_f32_16x16x32_bf16 v[170:173], a[228:231], a[120:123], v[170:173]
    ds_read_b64_tr_b16 a[220:221], v36 offset:16384
    v_mfma_f32_16x16x32_bf16 v[178:181], a[228:231], a[124:127], v[178:181]
    ds_read_b64_tr_b16 a[222:223], v36 offset:18432
    s_waitcnt lgkmcnt(8)
    v_mfma_f32_16x16x32_bf16 v[150:153], a[200:203], a[96:99], v[150:153]
    ds_read_b64_tr_b16 a[224:225], v35 offset:20480
    buffer_load_dwordx4 v80, s[28:31], s63 offen offset:2048 sc1 lds
    v_mfma_f32_16x16x32_bf16 v[158:161], a[200:203], a[100:103], v[158:161]
    ds_read_b64_tr_b16 a[226:227], v35 offset:22528
    s_add_u32 m0, s100, 28672
    v_mfma_f32_16x16x32_bf16 v[154:157], a[204:207], a[96:99], v[154:157]
    ds_read_b64_tr_b16 a[228:229], v36 offset:20480
    s_add_u32 s62, s62, 262144
    v_mfma_f32_16x16x32_bf16 v[162:165], a[204:207], a[100:103], v[162:165]
    ds_read_b64_tr_b16 a[230:231], v36 offset:22528
    v_cvt_pk_bf16_f32 v166, v166, v167
    v_cvt_pk_bf16_f32 v167, v168, v169
    s_waitcnt lgkmcnt(8)
    v_mfma_f32_16x16x32_bf16 v[150:153], a[208:211], a[104:107], v[150:153]
    s_cmp_eq_u32 s62, 1835008
    s_cselect_b32 s62, 0, s62
    buffer_load_dwordx4 v69, s[28:31], s62 offen sc1 lds
    v_mfma_f32_16x16x32_bf16 v[158:161], a[208:211], a[108:111], v[158:161]
    s_add_u32 m0, s58, 12288
    v_cvt_pk_bf16_f32 v168, v170, v171
    v_cvt_pk_bf16_f32 v169, v172, v173
    ds_write_b128 v81, v[166:169] offset:32768
    v_mfma_f32_16x16x32_bf16 v[154:157], a[212:215], a[104:107], v[154:157]
    buffer_load_dwordx4 v67, s[28:31], s62 offen sc1 lds
    v_cvt_pk_bf16_f32 v174, v174, v175
    v_mfma_f32_16x16x32_bf16 v[162:165], a[212:215], a[108:111], v[162:165]
    v_cvt_pk_bf16_f32 v175, v176, v177
    s_waitcnt lgkmcnt(5)
    v_mfma_f32_16x16x32_bf16 v[150:153], a[216:219], a[112:115], v[150:153]
    v_cvt_pk_bf16_f32 v176, v178, v179
    v_cvt_pk_bf16_f32 v177, v180, v181
    v_mfma_f32_16x16x32_bf16 v[158:161], a[216:219], a[116:119], v[158:161]
    buffer_load_dwordx4 v67, s[28:31], s62 offen offset:1024 sc1 lds
    ds_write_b128 v81, v[174:177] offset:33792
    v_mfma_f32_16x16x32_bf16 v[154:157], a[220:223], a[112:115], v[154:157]
    v_mfma_f32_16x16x32_bf16 v[162:165], a[220:223], a[116:119], v[162:165]
    s_waitcnt lgkmcnt(2)
    v_mfma_f32_16x16x32_bf16 v[150:153], a[224:227], a[120:123], v[150:153]
    buffer_load_dwordx4 v68, s[28:31], s62 offen offset:2048 sc1 lds
    v_mfma_f32_16x16x32_bf16 v[158:161], a[224:227], a[124:127], v[158:161]
    v_mfma_f32_16x16x32_bf16 v[154:157], a[228:231], a[120:123], v[154:157]
    v_xor_b32 v81, 8192, v81
    s_waitcnt vmcnt(19) lgkmcnt(0)
    s_barrier
    ds_read_b128 v[182:185], v81 offset:32768
    ds_read_b128 v[186:189], v81 offset:33792
    v_mfma_f32_16x16x32_bf16 v[162:165], a[228:231], a[124:127], v[162:165]
    buffer_load_dwordx4 v68, s[28:31], s62 offen offset:3072 sc1 lds
    s_waitcnt vmcnt(11)
    v_mfma_f32_16x16x32_bf16 v[150:153], a[250:253], v[214:217], v[150:153]
    s_add_u32 m0, s59, 65536
    s_add_u32 s63, s63, 12288
L_pad1:
    s_cbranch_execz L_warm
    v_mfma_f32_16x16x32_bf16 v[154:157], a[248:251], v[214:217], v[154:157]
    s_cmp_eq_u32 s63, 86016
    s_cselect_b32 s63, 0, s63
    s_waitcnt vmcnt(10)
    v_mfma_f32_16x16x32_bf16 v[158:161], a[250:253], v[218:221], v[158:161]
    buffer_load_dwordx4 v80, s[28:31], s63 offen sc1 lds
    v_mfma_f32_16x16x32_bf16 v[162:165], a[248:251], v[218:221], v[162:165]
    s_waitcnt vmcnt(10)
    v_mfma_f32_16x16x32_bf16 v[150:153], a[250:253], v[222:225], v[150:153]
    v_mfma_f32_16x16x32_bf16 v[154:157], a[248:251], v[222:225], v[154:157]
    s_waitcnt vmcnt(9)
    v_mfma_f32_16x16x32_bf16 v[158:161], a[250:253], v[226:229], v[158:161]
    buffer_load_dwordx4 v80, s[28:31], s63 offen offset:1024 sc1 lds
    v_mfma_f32_16x16x32_bf16 v[162:165], a[248:251], v[226:229], v[162:165]
    s_waitcnt lgkmcnt(1)
    v_mfma_f32_16x16x32_bf16 v[150:153], a[250:253], v[182:185], v[150:153]
    v_mfma_f32_16x16x32_bf16 v[154:157], a[248:251], v[182:185], v[154:157]
    buffer_load_dwordx4 v80, s[28:31], s63 offen offset:2048 sc1 lds
    s_add_u32 m0, s100, 94208
    s_waitcnt lgkmcnt(0)
    v_mfma_f32_16x16x32_bf16 v[158:161], a[250:253], v[186:189], v[158:161]
    s_add_u32 s62, s62, 262144
    s_cmp_eq_u32 s62, 1835008
    v_mfma_f32_16x16x32_bf16 v[162:165], a[248:251], v[186:189], v[162:165]
    s_cselect_b32 s62, 0, s62
    v_pk_mul_f32 v[182:183], v[150:151], v[150:151]
    v_pk_mul_f32 v[184:185], v[152:153], v[152:153]
    v_pk_mul_f32 v[186:187], v[154:155], v[154:155]
    v_pk_mul_f32 v[188:189], v[156:157], v[156:157]
    v_pk_fma_f32 v[182:183], v[182:183], s[78:79], v[108:109]
    buffer_load_dwordx4 v69, s[28:31], s62 offen sc1 lds
    v_pk_fma_f32 v[184:185], v[184:185], s[78:79], v[108:109]
    v_pk_fma_f32 v[186:187], v[186:187], s[78:79], v[108:109]
    v_pk_fma_f32 v[188:189], v[188:189], s[78:79], v[108:109]
    v_pk_mul_f32 v[182:183], v[182:183], v[150:151]
    v_pk_mul_f32 v[184:185], v[184:185], v[152:153]
    v_pk_mul_f32 v[186:187], v[186:187], v[154:155]
    v_pk_mul_f32 v[188:189], v[188:189], v[156:157]
    v_exp_f32 v182, v182
    v_exp_f32 v183, v183
    v_exp_f32 v184, v184
    v_exp_f32 v185, v185
    s_add_u32 m0, s58, 77824
    s_nop 0
    buffer_load_dwordx4 v67, s[28:31], s62 offen sc1 lds
    v_exp_f32 v186, v186
    v_exp_f32 v187, v187
    v_exp_f32 v188, v188
    v_exp_f32 v189, v189
    v_pk_add_f32 v[182:183], v[182:183], s[80:81]
    v_pk_add_f32 v[184:185], v[184:185], s[80:81]
    v_pk_add_f32 v[186:187], v[186:187], s[80:81]
    v_pk_add_f32 v[188:189], v[188:189], s[80:81]
    v_rcp_f32 v182, v182
    buffer_load_dwordx4 v67, s[28:31], s62 offen offset:1024 sc1 lds
    v_rcp_f32 v183, v183
    v_rcp_f32 v184, v184
    v_rcp_f32 v185, v185
    v_rcp_f32 v186, v186
    v_rcp_f32 v187, v187
    v_rcp_f32 v188, v188
    v_rcp_f32 v189, v189
    buffer_load_dwordx4 v68, s[28:31], s62 offen offset:2048 sc1 lds
    v_pk_mul_f32 v[182:183], v[182:183], v[150:151]
    v_pk_mul_f32 v[184:185], v[184:185], v[152:153]
    v_pk_mul_f32 v[186:187], v[186:187], v[154:155]
    v_pk_mul_f32 v[188:189], v[188:189], v[156:157]
    v_cvt_pk_bf16_f32 v110, v182, v183
    v_cvt_pk_bf16_f32 v111, v184, v185
    v_cvt_pk_bf16_f32 v112, v186, v187
    v_cvt_pk_bf16_f32 v113, v188, v189
    v_pk_mul_f32 v[190:191], v[158:159], v[158:159]
    v_pk_mul_f32 v[192:193], v[160:161], v[160:161]
    v_pk_mul_f32 v[194:195], v[162:163], v[162:163]
    v_pk_mul_f32 v[196:197], v[164:165], v[164:165]
    v_pk_fma_f32 v[190:191], v[190:191], s[78:79], v[108:109]
    buffer_load_dwordx4 v68, s[28:31], s62 offen offset:3072 sc1 lds
    v_pk_fma_f32 v[192:193], v[192:193], s[78:79], v[108:109]
    v_pk_fma_f32 v[194:195], v[194:195], s[78:79], v[108:109]
    v_pk_fma_f32 v[196:197], v[196:197], s[78:79], v[108:109]
    v_pk_mul_f32 v[190:191], v[190:191], v[158:159]
    v_pk_mul_f32 v[192:193], v[192:193], v[160:161]
    v_pk_mul_f32 v[194:195], v[194:195], v[162:163]
    v_pk_mul_f32 v[196:197], v[196:197], v[164:165]
    v_exp_f32 v190, v190
    v_exp_f32 v191, v191
    v_exp_f32 v192, v192
    v_exp_f32 v193, v193
    v_exp_f32 v194, v194
    v_exp_f32 v195, v195
    v_exp_f32 v196, v196
    v_exp_f32 v197, v197
    v_pk_add_f32 v[190:191], v[190:191], s[80:81]
    v_pk_add_f32 v[192:193], v[192:193], s[80:81]
    v_pk_add_f32 v[194:195], v[194:195], s[80:81]
    v_pk_add_f32 v[196:197], v[196:197], s[80:81]
    v_rcp_f32 v190, v190
    v_rcp_f32 v191, v191
    v_rcp_f32 v192, v192
    v_rcp_f32 v193, v193
    v_rcp_f32 v194, v194
    v_rcp_f32 v195, v195
    v_rcp_f32 v196, v196
    v_rcp_f32 v197, v197
    v_pk_mul_f32 v[190:191], v[190:191], v[158:159]
    v_pk_mul_f32 v[192:193], v[192:193], v[160:161]
    v_pk_mul_f32 v[194:195], v[194:195], v[162:163]
    v_pk_mul_f32 v[196:197], v[196:197], v[164:165]
    v_cvt_pk_bf16_f32 v114, v190, v191
    v_cvt_pk_bf16_f32 v115, v192, v193
    v_cvt_pk_bf16_f32 v116, v194, v195
    v_cvt_pk_bf16_f32 v117, v196, v197
    ds_read_b64_tr_b16 a[180:181], v72 offset:32768
    ds_read_b64_tr_b16 a[182:183], v72 offset:33024
    ds_read_b128 a[128:131], v53 offset:32768
    ds_read_b64_tr_b16 a[184:185], v72 offset:33792
    ds_read_b64_tr_b16 a[186:187], v72 offset:34048
    ds_read_b128 a[132:135], v53 offset:33792
    ds_read_b128 a[136:139], v53 offset:34816
    ds_read_b64_tr_b16 a[176:177], v73 offset:32768
    ds_read_b64_tr_b16 a[178:179], v73 offset:33024
    ds_read_b128 a[140:143], v53 offset:35840
    ds_read_b128 a[144:147], v53 offset:36864
    ds_read_b128 a[148:151], v53 offset:37888
    buffer_store_dwordx4 v[110:113], v4, s[28:31], s67 offen offset:0 sc1
    buffer_store_dwordx4 v[114:117], v4, s[28:31], s67 offen offset:1024 sc1
L_q:
    s_waitcnt lgkmcnt(6)
    v_mfma_f32_16x16x32_bf16 v[182:185], a[128:131], a[180:183], 0
    ds_read_b64_tr_b16 a[192:193], v72 offset:34816
    v_mfma_f32_16x16x32_bf16 v[190:193], a[128:131], a[184:187], 0
    ds_read_b64_tr_b16 a[194:195], v72 offset:35072
    v_mfma_f32_16x16x32_bf16 v[186:189], a[132:135], a[180:183], 0
    ds_read_b128 a[152:155], v53 offset:38912
    v_mfma_f32_16x16x32_bf16 v[194:197], a[132:135], a[184:187], 0
    ds_read_b64_tr_b16 a[196:197], v72 offset:35840
    s_waitcnt lgkmcnt(4)
    v_mfma_f32_16x16x32_bf16 v[206:209], a[136:139], a[180:183], 0
    ds_read_b64_tr_b16 a[198:199], v72 offset:36096
    v_mfma_f32_16x16x32_bf16 v[214:217], a[136:139], a[184:187], 0
    ds_read_b128 a[156:159], v53 offset:39936
    v_mfma_f32_16x16x32_bf16 v[198:201], a[136:139], a[176:179], 0
    ds_read_b128 a[160:163], v53 offset:40960
    v_mfma_f32_16x16x32_bf16 v[210:213], a[140:143], a[180:183], 0
    ds_read_b64_tr_b16 a[188:189], v73 offset:34816
    v_mfma_f32_16x16x32_bf16 v[218:221], a[140:143], a[184:187], 0
    ds_read_b64_tr_b16 a[190:191], v73 offset:35072
    v_mfma_f32_16x16x32_bf16 v[202:205], a[140:143], a[176:179], 0
    ds_read_b128 a[164:167], v53 offset:41984
    v_mfma_f32_16x16x32_bf16 v[230:233], a[180:183], a[144:147], 0
    ds_read_b128 a[168:171], v53 offset:43008
    v_mfma_f32_16x16x32_bf16 v[238:241], a[184:187], a[144:147], 0
    ds_read_b128 a[172:175], v53 offset:44032
    v_mfma_f32_16x16x32_bf16 v[222:225], a[176:179], a[144:147], 0
    v_mfma_f32_16x16x32_bf16 v[234:237], a[180:183], a[148:151], 0
    v_mfma_f32_16x16x32_bf16 v[242:245], a[184:187], a[148:151], 0
    v_mfma_f32_16x16x32_bf16 v[226:229], a[176:179], a[148:151], 0
    s_waitcnt lgkmcnt(0)
    s_barrier
    v_mfma_f32_16x16x32_bf16 v[182:185], a[152:155], a[192:195], v[182:185]
    ds_read_b64_tr_b16 a[180:181], v74 offset:0
    s_add_u32 m0, s59, 32768
    v_mfma_f32_16x16x32_bf16 v[190:193], a[152:155], a[196:199], v[190:193]
    ds_read_b64_tr_b16 a[182:183], v74 offset:256
    s_add_u32 s63, s63, 12288
    v_mfma_f32_16x16x32_bf16 v[186:189], a[156:159], a[192:195], v[186:189]
    ds_read_b128 a[128:131], v54 offset:0
    s_cmp_eq_u32 s63, 86016
    v_mfma_f32_16x16x32_bf16 v[194:197], a[156:159], a[196:199], v[194:197]
    ds_read_b64_tr_b16 a[184:185], v74 offset:1024
    v_mfma_f32_16x16x32_bf16 v[206:209], a[160:163], a[192:195], v[206:209]
    ds_read_b64_tr_b16 a[186:187], v74 offset:1280
    s_cselect_b32 s63, 0, s63
    v_mfma_f32_16x16x32_bf16 v[214:217], a[160:163], a[196:199], v[214:217]
    ds_read_b128 a[132:135], v54 offset:1024
    buffer_load_dwordx4 v80, s[28:31], s63 offen sc1 lds
    v_mfma_f32_16x16x32_bf16 v[198:201], a[160:163], a[188:191], v[198:201]
    ds_read_b128 a[136:139], v54 offset:2048
    v_mfma_f32_16x16x32_bf16 v[210:213], a[164:167], a[192:195], v[210:213]
    ds_read_b64_tr_b16 a[176:177], v75 offset:0
    buffer_load_dwordx4 v80, s[28:31], s63 offen offset:1024 sc1 lds
    v_mfma_f32_16x16x32_bf16 v[218:221], a[164:167], a[196:199], v[218:221]
    ds_read_b64_tr_b16 a[178:179], v75 offset:256
    v_mfma_f32_16x16x32_bf16 v[202:205], a[164:167], a[188:191], v[202:205]
    ds_read_b128 a[140:143], v54 offset:3072
    v_mfma_f32_16x16x32_bf16 v[230:233], a[192:195], a[168:171], v[230:233]
    ds_read_b128 a[144:147], v54 offset:4096
    buffer_load_dwordx4 v80, s[28:31], s63 offen offset:2048 sc1 lds
    v_mfma_f32_16x16x32_bf16 v[238:241], a[196:199], a[168:171], v[238:241]
    ds_read_b128 a[148:151], v54 offset:5120
    s_add_u32 m0, s100, 61440
    v_mfma_f32_16x16x32_bf16 v[222:225], a[188:191], a[168:171], v[222:225]
    s_add_u32 s62, s62, 262144
    s_cmp_eq_u32 s62, 1835008
    v_mfma_f32_16x16x32_bf16 v[234:237], a[192:195], a[172:175], v[234:237]
    s_cselect_b32 s62, 0, s62
    buffer_load_dwordx4 v69, s[28:31], s62 offen sc1 lds
    v_mfma_f32_16x16x32_bf16 v[242:245], a[196:199], a[172:175], v[242:245]
    s_add_u32 m0, s58, 45056
    v_mfma_f32_16x16x32_bf16 v[226:229], a[188:191], a[172:175], v[226:229]
    s_waitcnt lgkmcnt(6)
    v_mfma_f32_16x16x32_bf16 v[182:185], a[128:131], a[180:183], v[182:185]
    ds_read_b64_tr_b16 a[192:193], v74 offset:2048
    buffer_load_dwordx4 v67, s[28:31], s62 offen sc1 lds
    v_mfma_f32_16x16x32_bf16 v[190:193], a[128:131], a[184:187], v[190:193]
    ds_read_b64_tr_b16 a[194:195], v74 offset:2304
    v_mfma_f32_16x16x32_bf16 v[186:189], a[132:135], a[180:183], v[186:189]
    ds_read_b128 a[152:155], v54 offset:6144
    v_mfma_f32_16x16x32_bf16 v[194:197], a[132:135], a[184:187], v[194:197]
    ds_read_b64_tr_b16 a[196:197], v74 offset:3072
    s_waitcnt lgkmcnt(4)
    v_mfma_f32_16x16x32_bf16 v[206:209], a[136:139], a[180:183], v[206:209]
    ds_read_b64_tr_b16 a[198:199], v74 offset:3328
    buffer_load_dwordx4 v67, s[28:31], s62 offen offset:1024 sc1 lds
    v_mfma_f32_16x16x32_bf16 v[214:217], a[136:139], a[184:187], v[214:217]
    ds_read_b128 a[156:159], v54 offset:7168
    v_mfma_f32_16x16x32_bf16 v[198:201], a[136:139], a[176:179], v[198:201]
    ds_read_b128 a[160:163], v54 offset:8192
    buffer_load_dwordx4 v68, s[28:31], s62 offen offset:2048 sc1 lds
    v_mfma_f32_16x16x32_bf16 v[210:213], a[140:143], a[180:183], v[210:213]
    ds_read_b64_tr_b16 a[188:189], v75 offset:2048
    v_mfma_f32_16x16x32_bf16 v[218:221], a[140:143], a[184:187], v[218:221]
    ds_read_b64_tr_b16 a[190:191], v75 offset:2304
    v_mfma_f32_16x16x32_bf16 v[202:205], a[140:143], a[176:179], v[202:205]
    ds_read_b128 a[164:167], v54 offset:9216
    buffer_load_dwordx4 v68, s[28:31], s62 offen offset:3072 sc1 lds
    v_mfma_f32_16x16x32_bf16 v[230:233], a[180:183], a[144:147], v[230:233]
    ds_read_b128 a[168:171], v54 offset:10240
    s_add_u32 m0, s59, 98304
    v_mfma_f32_16x16x32_bf16 v[238:241], a[184:187], a[144:147], v[238:241]
    ds_read_b128 a[172:175], v54 offset:11264
    s_add_u32 s63, s63, 12288
    v_mfma_f32_16x16x32_bf16 v[222:225], a[176:179], a[144:147], v[222:225]
    s_cmp_eq_u32 s63, 86016
    s_cselect_b32 s63, 0, s63
    v_mfma_f32_16x16x32_bf16 v[234:237], a[180:183], a[148:151], v[234:237]
    buffer_load_dwordx4 v80, s[28:31], s63 offen sc1 lds
    v_mfma_f32_16x16x32_bf16 v[242:245], a[184:187], a[148:151], v[242:245]
    v_mfma_f32_16x16x32_bf16 v[226:229], a[176:179], a[148:151], v[226:229]
    s_waitcnt vmcnt(9) lgkmcnt(0)
    s_barrier
    s_cmp_lg_u32 s48, 0
    s_cbranch_scc1 L_sig2
    s_atomic_add s36, s[28:29], s68
L_sig2:
    v_mfma_f32_16x16x32_bf16 v[182:185], a[152:155], a[192:195], v[182:185]
    ds_read_b64_tr_b16 a[180:181], v70 offset:0
    buffer_load_dwordx4 v80, s[28:31], s63 offen offset:1024 sc1 lds
    v_mfma_f32_16x16x32_bf16 v[190:193], a[152:155], a[196:199], v[190:193]
    ds_read_b64_tr_b16 a[182:183], v70 offset:256
    v_mfma_f32_16x16x32_bf16 v[186:189], a[156:159], a[192:195], v[186:189]
    ds_read_b128 a[128:131], v4 offset:0
    buffer_load_dwordx4 v80, s[28:31], s63 offen offset:2048 sc1 lds
    v_mfma_f32_16x16x32_bf16 v[194:197], a[156:159], a[196:199], v[194:197]
    ds_read_b64_tr_b16 a[184:185], v70 offset:1024
    v_mfma_f32_16x16x32_bf16 v[206:209], a[160:163], a[192:195], v[206:209]
    ds_read_b64_tr_b16 a[186:187], v70 offset:1280
    s_add_u32 m0, s100, 126976
    v_mfma_f32_16x16x32_bf16 v[214:217], a[160:163], a[196:199], v[214:217]
    ds_read_b128 a[132:135], v4 offset:1024
    s_add_u32 s62, s62, 262144
    v_mfma_f32_16x16x32_bf16 v[198:201], a[160:163], a[188:191], v[198:201]
    ds_read_b128 a[136:139], v4 offset:2048
    s_cmp_eq_u32 s62, 1835008
    v_mfma_f32_16x16x32_bf16 v[210:213], a[164:167], a[192:195], v[210:213]
    ds_read_b64_tr_b16 a[176:177], v71 offset:0
    s_cselect_b32 s62, 0, s62
    v_mfma_f32_16x16x32_bf16 v[218:221], a[164:167], a[196:199], v[218:221]
    ds_read_b64_tr_b16 a[178:179], v71 offset:256
    buffer_load_dwordx4 v69, s[28:31], s62 offen sc1 lds
    v_mfma_f32_16x16x32_bf16 v[202:205], a[164:167], a[188:191], v[202:205]
    ds_read_b128 a[140:143], v4 offset:3072
    s_add_u32 m0, s58, 110592
    v_mfma_f32_16x16x32_bf16 v[230:233], a[192:195], a[168:171], v[230:233]
    ds_read_b128 a[144:147], v4 offset:4096
    buffer_load_dwordx4 v67, s[28:31], s62 offen sc1 lds
    v_mfma_f32_16x16x32_bf16 v[238:241], a[196:199], a[168:171], v[238:241]
    ds_read_b128 a[148:151], v4 offset:5120
    v_mfma_f32_16x16x32_bf16 v[222:225], a[188:191], a[168:171], v[222:225]
    v_mfma_f32_16x16x32_bf16 v[234:237], a[192:195], a[172:175], v[234:237]
    buffer_load_dwordx4 v67, s[28:31], s62 offen offset:1024 sc1 lds
    v_mfma_f32_16x16x32_bf16 v[242:245], a[196:199], a[172:175], v[242:245]
    v_mfma_f32_16x16x32_bf16 v[226:229], a[188:191], a[172:175], v[226:229]
    s_waitcnt lgkmcnt(6)
    v_mfma_f32_16x16x32_bf16 v[182:185], a[128:131], a[180:183], v[182:185]
    ds_read_b64_tr_b16 a[192:193], v70 offset:2048
    buffer_load_dwordx4 v68, s[28:31], s62 offen offset:2048 sc1 lds
    v_mfma_f32_16x16x32_bf16 v[190:193], a[128:131], a[184:187], v[190:193]
    ds_read_b64_tr_b16 a[194:195], v70 offset:2304
    v_mfma_f32_16x16x32_bf16 v[186:189], a[132:135], a[180:183], v[186:189]
    ds_read_b128 a[152:155], v4 offset:6144
    v_mfma_f32_16x16x32_bf16 v[194:197], a[132:135], a[184:187], v[194:197]
    ds_read_b64_tr_b16 a[196:197], v70 offset:3072
    s_waitcnt lgkmcnt(4)
    v_mfma_f32_16x16x32_bf16 v[206:209], a[136:139], a[180:183], v[206:209]
    ds_read_b64_tr_b16 a[198:199], v70 offset:3328
    buffer_load_dwordx4 v68, s[28:31], s62 offen offset:3072 sc1 lds
    v_mfma_f32_16x16x32_bf16 v[214:217], a[136:139], a[184:187], v[214:217]
    ds_read_b128 a[156:159], v4 offset:7168
    s_add_u32 m0, s59, 131072
    v_mfma_f32_16x16x32_bf16 v[198:201], a[136:139], a[176:179], v[198:201]
    ds_read_b128 a[160:163], v4 offset:8192
    s_add_u32 s63, s63, 12288
    v_mfma_f32_16x16x32_bf16 v[210:213], a[140:143], a[180:183], v[210:213]
    ds_read_b64_tr_b16 a[188:189], v71 offset:2048
    s_cmp_eq_u32 s63, 86016
    v_mfma_f32_16x16x32_bf16 v[218:221], a[140:143], a[184:187], v[218:221]
    ds_read_b64_tr_b16 a[190:191], v71 offset:2304
    s_cselect_b32 s63, 0, s63
    v_mfma_f32_16x16x32_bf16 v[202:205], a[140:143], a[176:179], v[202:205]
    ds_read_b128 a[164:167], v4 offset:9216
    buffer_load_dwordx4 v80, s[28:31], s63 offen sc1 lds
    v_mfma_f32_16x16x32_bf16 v[230:233], a[180:183], a[144:147], v[230:233]
    ds_read_b128 a[168:171], v4 offset:10240
    v_mfma_f32_16x16x32_bf16 v[238:241], a[184:187], a[144:147], v[238:241]
    ds_read_b128 a[172:175], v4 offset:11264
    buffer_load_dwordx4 v80, s[28:31], s63 offen offset:1024 sc1 lds
    v_mfma_f32_16x16x32_bf16 v[222:225], a[176:179], a[144:147], v[222:225]
    v_mfma_f32_16x16x32_bf16 v[234:237], a[180:183], a[148:151], v[234:237]
    v_mfma_f32_16x16x32_bf16 v[242:245], a[184:187], a[148:151], v[242:245]
    buffer_load_dwordx4 v80, s[28:31], s63 offen offset:2048 sc1 lds
    s_add_u32 m0, s100, 159744
    v_mfma_f32_16x16x32_bf16 v[226:229], a[176:179], a[148:151], v[226:229]
    s_add_u32 s62, s62, 262144
    ds_read_b32 v24, v4
    s_waitcnt lgkmcnt(1)
    s_barrier
    v_mfma_f32_16x16x32_bf16 v[182:185], a[152:155], a[192:195], v[182:185]
    ds_read_b64_tr_b16 a[180:181], v72 offset:0
    s_cmp_eq_u32 s62, 1835008
    v_mfma_f32_16x16x32_bf16 v[190:193], a[152:155], a[196:199], v[190:193]
    ds_read_b64_tr_b16 a[182:183], v72 offset:256
    s_cselect_b32 s62, 0, s62
    v_mfma_f32_16x16x32_bf16 v[186:189], a[156:159], a[192:195], v[186:189]
    ds_read_b128 a[128:131], v53 offset:0
    buffer_load_dwordx4 v69, s[28:31], s62 offen sc1 lds
    v_mfma_f32_16x16x32_bf16 v[194:197], a[156:159], a[196:199], v[194:197]
    ds_read_b64_tr_b16 a[184:185], v72 offset:1024
    v_mfma_f32_16x16x32_bf16 v[206:209], a[160:163], a[192:195], v[206:209]
    ds_read_b64_tr_b16 a[186:187], v72 offset:1280
    s_add_u32 m0, s58, 143360
    v_mfma_f32_16x16x32_bf16 v[214:217], a[160:163], a[196:199], v[214:217]
    ds_read_b128 a[132:135], v53 offset:1024
    buffer_load_dwordx4 v67, s[28:31], s62 offen sc1 lds
    v_mfma_f32_16x16x32_bf16 v[198:201], a[160:163], a[188:191], v[198:201]
    ds_read_b128 a[136:139], v53 offset:2048
    v_mfma_f32_16x16x32_bf16 v[210:213], a[164:167], a[192:195], v[210:213]
    ds_read_b64_tr_b16 a[176:177], v73 offset:0
    buffer_load_dwordx4 v67, s[28:31], s62 offen offset:1024 sc1 lds
    v_mfma_f32_16x16x32_bf16 v[218:221], a[164:167], a[196:199], v[218:221]
    ds_read_b64_tr_b16 a[178:179], v73 offset:256
    v_mfma_f32_16x16x32_bf16 v[202:205], a[164:167], a[188:191], v[202:205]
    ds_read_b128 a[140:143], v53 offset:3072
    v_mfma_f32_16x16x32_bf16 v[230:233], a[192:195], a[168:171], v[230:233]
    ds_read_b128 a[144:147], v53 offset:4096
    buffer_load_dwordx4 v68, s[28:31], s62 offen offset:2048 sc1 lds
    v_mfma_f32_16x16x32_bf16 v[238:241], a[196:199], a[168:171], v[238:241]
    ds_read_b128 a[148:151], v53 offset:5120
    v_mfma_f32_16x16x32_bf16 v[222:225], a[188:191], a[168:171], v[222:225]
    v_mfma_f32_16x16x32_bf16 v[234:237], a[192:195], a[172:175], v[234:237]
    buffer_load_dwordx4 v68, s[28:31], s62 offen offset:3072 sc1 lds
    s_add_u32 m0, s58, 0
    v_mfma_f32_16x16x32_bf16 v[242:245], a[196:199], a[172:175], v[242:245]
    v_mfma_f32_16x16x32_bf16 v[226:229], a[188:191], a[172:175], v[226:229]
    s_waitcnt lgkmcnt(6)
    v_mfma_f32_16x16x32_bf16 v[182:185], a[128:131], a[180:183], v[182:185]
    ds_read_b64_tr_b16 a[192:193], v72 offset:2048
    buffer_load_dwordx4 v59, s[24:27], s64 offen lds
    v_mfma_f32_16x16x32_bf16 v[190:193], a[128:131], a[184:187], v[190:193]
    ds_read_b64_tr_b16 a[194:195], v72 offset:2304
    v_mfma_f32_16x16x32_bf16 v[186:189], a[132:135], a[180:183], v[186:189]
    ds_read_b128 a[152:155], v53 offset:6144
    v_mfma_f32_16x16x32_bf16 v[194:197], a[132:135], a[184:187], v[194:197]
    ds_read_b64_tr_b16 a[196:197], v72 offset:3072
    s_waitcnt lgkmcnt(4)
    v_mfma_f32_16x16x32_bf16 v[206:209], a[136:139], a[180:183], v[206:209]
    ds_read_b64_tr_b16 a[198:199], v72 offset:3328
    buffer_load_dwordx4 v60, s[24:27], s64 offen offset:1024 lds
    v_mfma_f32_16x16x32_bf16 v[214:217], a[136:139], a[184:187], v[214:217]
    ds_read_b128 a[156:159], v53 offset:7168
    v_mfma_f32_16x16x32_bf16 v[198:201], a[136:139], a[176:179], v[198:201]
    ds_read_b128 a[160:163], v53 offset:8192
    v_mfma_f32_16x16x32_bf16 v[210:213], a[140:143], a[180:183], v[210:213]
    ds_read_b64_tr_b16 a[188:189], v73 offset:2048
    buffer_load_dwordx4 v61, s[24:27], s64 offen offset:2048 lds
    v_mfma_f32_16x16x32_bf16 v[218:221], a[140:143], a[184:187], v[218:221]
    ds_read_b64_tr_b16 a[190:191], v73 offset:2304
    v_mfma_f32_16x16x32_bf16 v[202:205], a[140:143], a[176:179], v[202:205]
    ds_read_b128 a[164:167], v53 offset:9216
    v_mfma_f32_16x16x32_bf16 v[230:233], a[180:183], a[144:147], v[230:233]
    ds_read_b128 a[168:171], v53 offset:10240
    buffer_load_dwordx4 v62, s[24:27], s64 offen offset:3072 lds
    v_mfma_f32_16x16x32_bf16 v[238:241], a[184:187], a[144:147], v[238:241]
    ds_read_b128 a[172:175], v53 offset:11264
    s_add_u32 m0, s58, 16384
    v_mfma_f32_16x16x32_bf16 v[222:225], a[176:179], a[144:147], v[222:225]
    v_xor_b32 v59, 128, v59
    v_mfma_f32_16x16x32_bf16 v[234:237], a[180:183], a[148:151], v[234:237]
    buffer_load_dwordx4 v59, s[24:27], s64 offen lds
    v_xor_b32 v60, 128, v60
    v_mfma_f32_16x16x32_bf16 v[242:245], a[184:187], a[148:151], v[242:245]
    v_mfma_f32_16x16x32_bf16 v[226:229], a[176:179], a[148:151], v[226:229]
    ds_read_b32 v24, v4
    s_waitcnt vmcnt(21) lgkmcnt(1)
    s_barrier
    v_mfma_f32_16x16x32_bf16 v[182:185], a[152:155], a[192:195], v[182:185]
    ds_read_b64_tr_b16 a[180:181], v70 offset:32768
    buffer_load_dwordx4 v60, s[24:27], s64 offen offset:1024 lds
    v_mfma_f32_16x16x32_bf16 v[190:193], a[152:155], a[196:199], v[190:193]
    ds_read_b64_tr_b16 a[182:183], v70 offset:33024
    v_xor_b32 v61, 128, v61
    v_mfma_f32_16x16x32_bf16 v[186:189], a[156:159], a[192:195], v[186:189]
    ds_read_b128 a[128:131], v4 offset:32768
    v_mfma_f32_16x16x32_bf16 v[194:197], a[156:159], a[196:199], v[194:197]
    ds_read_b64_tr_b16 a[184:185], v70 offset:33792
    v_mfma_f32_16x16x32_bf16 v[206:209], a[160:163], a[192:195], v[206:209]
    ds_read_b64_tr_b16 a[186:187], v70 offset:34048
    buffer_load_dwordx4 v61, s[24:27], s64 offen offset:2048 lds
    v_mfma_f32_16x16x32_bf16 v[214:217], a[160:163], a[196:199], v[214:217]
    ds_read_b128 a[132:135], v4 offset:33792
    v_xor_b32 v62, 128, v62
    v_mfma_f32_16x16x32_bf16 v[198:201], a[160:163], a[188:191], v[198:201]
    ds_read_b128 a[136:139], v4 offset:34816
    buffer_load_dwordx4 v62, s[24:27], s64 offen offset:3072 lds
    v_mfma_f32_16x16x32_bf16 v[210:213], a[164:167], a[192:195], v[210:213]
    ds_read_b64_tr_b16 a[176:177], v71 offset:32768
    s_add_u32 m0, s58, 65536
    v_mfma_f32_16x16x32_bf16 v[218:221], a[164:167], a[196:199], v[218:221]
    ds_read_b64_tr_b16 a[178:179], v71 offset:33024
    s_add_u32 s64, s64, 524288
    v_mfma_f32_16x16x32_bf16 v[202:205], a[164:167], a[188:191], v[202:205]
    ds_read_b128 a[140:143], v4 offset:35840
    s_cmp_eq_u32 s64, 3670016
    v_mfma_f32_16x16x32_bf16 v[230:233], a[192:195], a[168:171], v[230:233]
    ds_read_b128 a[144:147], v4 offset:36864
    s_cselect_b32 s64, 0, s64
    v_mfma_f32_16x16x32_bf16 v[238:241], a[196:199], a[168:171], v[238:241]
    ds_read_b128 a[148:151], v4 offset:37888
    buffer_load_dwordx4 v59, s[24:27], s64 offen lds
    v_mfma_f32_16x16x32_bf16 v[222:225], a[188:191], a[168:171], v[222:225]
    v_mfma_f32_16x16x32_bf16 v[234:237], a[192:195], a[172:175], v[234:237]
    buffer_load_dwordx4 v60, s[24:27], s64 offen offset:1024 lds
    v_mfma_f32_16x16x32_bf16 v[242:245], a[196:199], a[172:175], v[242:245]
    v_mfma_f32_16x16x32_bf16 v[226:229], a[188:191], a[172:175], v[226:229]
    s_waitcnt lgkmcnt(6)
    v_mfma_f32_16x16x32_bf16 v[182:185], a[128:131], a[180:183], v[182:185]
    ds_read_b64_tr_b16 a[192:193], v70 offset:34816
    buffer_load_dwordx4 v61, s[24:27], s64 offen offset:2048 lds
    v_mfma_f32_16x16x32_bf16 v[190:193], a[128:131], a[184:187], v[190:193]
    ds_read_b64_tr_b16 a[194:195], v70 offset:35072
    v_mfma_f32_16x16x32_bf16 v[186:189], a[132:135], a[180:183], v[186:189]
    ds_read_b128 a[152:155], v4 offset:38912
    v_mfma_f32_16x16x32_bf16 v[194:197], a[132:135], a[184:187], v[194:197]
    ds_read_b64_tr_b16 a[196:197], v70 offset:35840
    s_waitcnt lgkmcnt(4)
    v_mfma_f32_16x16x32_bf16 v[206:209], a[136:139], a[180:183], v[206:209]
    ds_read_b64_tr_b16 a[198:199], v70 offset:36096
    buffer_load_dwordx4 v62, s[24:27], s64 offen offset:3072 lds
    v_mfma_f32_16x16x32_bf16 v[214:217], a[136:139], a[184:187], v[214:217]
    ds_read_b128 a[156:159], v4 offset:39936
    s_add_u32 m0, s58, 81920
    v_mfma_f32_16x16x32_bf16 v[198:201], a[136:139], a[176:179], v[198:201]
    ds_read_b128 a[160:163], v4 offset:40960
    s_add_u32 s64, s64, 524288
    v_mfma_f32_16x16x32_bf16 v[210:213], a[140:143], a[180:183], v[210:213]
    ds_read_b64_tr_b16 a[188:189], v71 offset:34816
    s_cmp_eq_u32 s64, 3670016
    v_mfma_f32_16x16x32_bf16 v[218:221], a[140:143], a[184:187], v[218:221]
    ds_read_b64_tr_b16 a[190:191], v71 offset:35072
    s_cselect_b32 s64, 0, s64
    v_mfma_f32_16x16x32_bf16 v[202:205], a[140:143], a[176:179], v[202:205]
    ds_read_b128 a[164:167], v4 offset:41984
    buffer_load_dwordx4 v59, s[24:27], s64 offen lds
    v_mfma_f32_16x16x32_bf16 v[230:233], a[180:183], a[144:147], v[230:233]
    ds_read_b128 a[168:171], v4 offset:43008
    v_mfma_f32_16x16x32_bf16 v[238:241], a[184:187], a[144:147], v[238:241]
    ds_read_b128 a[172:175], v4 offset:44032
    buffer_load_dwordx4 v60, s[24:27], s64 offen offset:1024 lds
    v_mfma_f32_16x16x32_bf16 v[222:225], a[176:179], a[144:147], v[222:225]
    v_mfma_f32_16x16x32_bf16 v[234:237], a[180:183], a[148:151], v[234:237]
    v_mfma_f32_16x16x32_bf16 v[242:245], a[184:187], a[148:151], v[242:245]
    buffer_load_dwordx4 v61, s[24:27], s64 offen offset:2048 lds
    v_mfma_f32_16x16x32_bf16 v[226:229], a[176:179], a[148:151], v[226:229]
    ds_read_b32 v24, v4
    s_waitcnt vmcnt(23) lgkmcnt(1)
    s_barrier
    v_mfma_f32_16x16x32_bf16 v[182:185], a[152:155], a[192:195], v[182:185]
    ds_read_b64_tr_b16 a[180:181], v72 offset:32768
    v_mfma_f32_16x16x32_bf16 v[190:193], a[152:155], a[196:199], v[190:193]
    ds_read_b64_tr_b16 a[182:183], v72 offset:33024
    buffer_load_dwordx4 v62, s[24:27], s64 offen offset:3072 lds
    v_mfma_f32_16x16x32_bf16 v[186:189], a[156:159], a[192:195], v[186:189]
    ds_read_b128 a[128:131], v53 offset:32768
    s_add_u32 m0, s58, 32768
    v_mfma_f32_16x16x32_bf16 v[194:197], a[156:159], a[196:199], v[194:197]
    ds_read_b64_tr_b16 a[184:185], v72 offset:33792
    v_mfma_f32_16x16x32_bf16 v[206:209], a[160:163], a[192:195], v[206:209]
    ds_read_b64_tr_b16 a[186:187], v72 offset:34048
    s_add_u32 s64, s64, 524288
    v_mfma_f32_16x16x32_bf16 v[214:217], a[160:163], a[196:199], v[214:217]
    ds_read_b128 a[132:135], v53 offset:33792
    s_cmp_eq_u32 s64, 3670016
    v_mfma_f32_16x16x32_bf16 v[198:201], a[160:163], a[188:191], v[198:201]
    ds_read_b128 a[136:139], v53 offset:34816
    s_cselect_b32 s64, 0, s64
    v_mfma_f32_16x16x32_bf16 v[210:213], a[164:167], a[192:195], v[210:213]
    ds_read_b64_tr_b16 a[176:177], v73 offset:32768
    buffer_load_dwordx4 v59, s[24:27], s64 offen lds
    v_mfma_f32_16x16x32_bf16 v[218:221], a[164:167], a[196:199], v[218:221]
    ds_read_b64_tr_b16 a[178:179], v73 offset:33024
    v_mfma_f32_16x16x32_bf16 v[202:205], a[164:167], a[188:191], v[202:205]
    ds_read_b128 a[140:143], v53 offset:35840
    buffer_load_dwordx4 v60, s[24:27], s64 offen offset:1024 lds
    v_mfma_f32_16x16x32_bf16 v[230:233], a[192:195], a[168:171], v[230:233]
    ds_read_b128 a[144:147], v53 offset:36864
    v_mfma_f32_16x16x32_bf16 v[238:241], a[196:199], a[168:171], v[238:241]
    ds_read_b128 a[148:151], v53 offset:37888
    v_mfma_f32_16x16x32_bf16 v[222:225], a[188:191], a[168:171], v[222:225]
    buffer_load_dwordx4 v61, s[24:27], s64 offen offset:2048 lds
    v_mfma_f32_16x16x32_bf16 v[234:237], a[192:195], a[172:175], v[234:237]
    v_mfma_f32_16x16x32_bf16 v[242:245], a[196:199], a[172:175], v[242:245]
    v_mfma_f32_16x16x32_bf16 v[226:229], a[188:191], a[172:175], v[226:229]
    buffer_load_dwordx4 v62, s[24:27], s64 offen offset:3072 lds
    s_waitcnt lgkmcnt(6)
    v_mfma_f32_16x16x32_bf16 v[182:185], a[128:131], a[180:183], v[182:185]
    ds_read_b64_tr_b16 a[192:193], v72 offset:34816
    s_add_u32 m0, s58, 49152
    v_mfma_f32_16x16x32_bf16 v[190:193], a[128:131], a[184:187], v[190:193]
    ds_read_b64_tr_b16 a[194:195], v72 offset:35072
    s_add_u32 s64, s64, 524288
    v_mfma_f32_16x16x32_bf16 v[186:189], a[132:135], a[180:183], v[186:189]
    ds_read_b128 a[152:155], v53 offset:38912
    s_cmp_eq_u32 s64, 3670016
    v_mfma_f32_16x16x32_bf16 v[194:197], a[132:135], a[184:187], v[194:197]
    ds_read_b64_tr_b16 a[196:197], v72 offset:35840
    s_waitcnt lgkmcnt(4)
    v_mfma_f32_16x16x32_bf16 v[206:209], a[136:139], a[180:183], v[206:209]
    ds_read_b64_tr_b16 a[198:199], v72 offset:36096
    s_cselect_b32 s64, 0, s64
    v_mfma_f32_16x16x32_bf16 v[214:217], a[136:139], a[184:187], v[214:217]
    ds_read_b128 a[156:159], v53 offset:39936
    buffer_load_dwordx4 v59, s[24:27], s64 offen lds
    v_mfma_f32_16x16x32_bf16 v[198:201], a[136:139], a[176:179], v[198:201]
    ds_read_b128 a[160:163], v53 offset:40960
    v_mfma_f32_16x16x32_bf16 v[210:213], a[140:143], a[180:183], v[210:213]
    ds_read_b64_tr_b16 a[188:189], v73 offset:34816
    buffer_load_dwordx4 v60, s[24:27], s64 offen offset:1024 lds
    v_mfma_f32_16x16x32_bf16 v[218:221], a[140:143], a[184:187], v[218:221]
    ds_read_b64_tr_b16 a[190:191], v73 offset:35072
    v_mfma_f32_16x16x32_bf16 v[202:205], a[140:143], a[176:179], v[202:205]
    ds_read_b128 a[164:167], v53 offset:41984
L_pad2:
    s_cbranch_execz L_warm
    v_mfma_f32_16x16x32_bf16 v[230:233], a[180:183], a[144:147], v[230:233]
    ds_read_b128 a[168:171], v53 offset:43008
    buffer_load_dwordx4 v61, s[24:27], s64 offen offset:2048 lds
    v_mfma_f32_16x16x32_bf16 v[238:241], a[184:187], a[144:147], v[238:241]
    ds_read_b128 a[172:175], v53 offset:44032
    v_mfma_f32_16x16x32_bf16 v[222:225], a[176:179], a[144:147], v[222:225]
    v_mfma_f32_16x16x32_bf16 v[234:237], a[180:183], a[148:151], v[234:237]
    buffer_load_dwordx4 v62, s[24:27], s64 offen offset:3072 lds
    v_mfma_f32_16x16x32_bf16 v[242:245], a[184:187], a[148:151], v[242:245]
    v_mfma_f32_16x16x32_bf16 v[226:229], a[176:179], a[148:151], v[226:229]
    ds_read_b32 v24, v4
    s_waitcnt vmcnt(24) lgkmcnt(1)
    s_barrier
    s_mov_b32 s14, 0
    s_load_dword s14, s[28:29], s38
    v_mfma_f32_16x16x32_bf16 v[182:185], a[152:155], a[192:195], v[182:185]
    ds_read_b64_tr_b16 a[180:181], v74 offset:0
    s_add_u32 m0, s58, 98304
    v_mfma_f32_16x16x32_bf16 v[190:193], a[152:155], a[196:199], v[190:193]
    ds_read_b64_tr_b16 a[182:183], v74 offset:256
    s_add_u32 s64, s64, 524288
    v_mfma_f32_16x16x32_bf16 v[186:189], a[156:159], a[192:195], v[186:189]
    ds_read_b128 a[128:131], v54 offset:0
    s_cmp_eq_u32 s64, 3670016
    v_mfma_f32_16x16x32_bf16 v[194:197], a[156:159], a[196:199], v[194:197]
    ds_read_b64_tr_b16 a[184:185], v74 offset:1024
    v_mfma_f32_16x16x32_bf16 v[206:209], a[160:163], a[192:195], v[206:209]
    ds_read_b64_tr_b16 a[186:187], v74 offset:1280
    s_cselect_b32 s64, 0, s64
    v_mfma_f32_16x16x32_bf16 v[214:217], a[160:163], a[196:199], v[214:217]
    ds_read_b128 a[132:135], v54 offset:1024
    buffer_load_dwordx4 v59, s[24:27], s64 offen lds
    v_mfma_f32_16x16x32_bf16 v[198:201], a[160:163], a[188:191], v[198:201]
    ds_read_b128 a[136:139], v54 offset:2048
    v_mfma_f32_16x16x32_bf16 v[210:213], a[164:167], a[192:195], v[210:213]
    ds_read_b64_tr_b16 a[176:177], v75 offset:0
    buffer_load_dwordx4 v60, s[24:27], s64 offen offset:1024 lds
    v_mfma_f32_16x16x32_bf16 v[218:221], a[164:167], a[196:199], v[218:221]
    ds_read_b64_tr_b16 a[178:179], v75 offset:256
    v_mfma_f32_16x16x32_bf16 v[202:205], a[164:167], a[188:191], v[202:205]
    ds_read_b128 a[140:143], v54 offset:3072
    v_mfma_f32_16x16x32_bf16 v[230:233], a[192:195], a[168:171], v[230:233]
    ds_read_b128 a[144:147], v54 offset:4096
    buffer_load_dwordx4 v61, s[24:27], s64 offen offset:2048 lds
    v_mfma_f32_16x16x32_bf16 v[238:241], a[196:199], a[168:171], v[238:241]
    ds_read_b128 a[148:151], v54 offset:5120
    v_mfma_f32_16x16x32_bf16 v[222:225], a[188:191], a[168:171], v[222:225]
    v_mfma_f32_16x16x32_bf16 v[234:237], a[192:195], a[172:175], v[234:237]
    buffer_load_dwordx4 v62, s[24:27], s64 offen offset:3072 lds
    s_add_u32 m0, s58, 114688
    v_mfma_f32_16x16x32_bf16 v[242:245], a[196:199], a[172:175], v[242:245]
    s_add_u32 s64, s64, 524288
    s_cmp_eq_u32 s64, 3670016
    v_mfma_f32_16x16x32_bf16 v[226:229], a[188:191], a[172:175], v[226:229]
    s_cselect_b32 s64, 0, s64
    s_waitcnt lgkmcnt(6)
    v_mfma_f32_16x16x32_bf16 v[182:185], a[128:131], a[180:183], v[182:185]
    ds_read_b64_tr_b16 a[192:193], v74 offset:2048
    buffer_load_dwordx4 v59, s[24:27], s64 offen lds
    v_mfma_f32_16x16x32_bf16 v[190:193], a[128:131], a[184:187], v[190:193]
    ds_read_b64_tr_b16 a[194:195], v74 offset:2304
    v_mfma_f32_16x16x32_bf16 v[186:189], a[132:135], a[180:183], v[186:189]
    ds_read_b128 a[152:155], v54 offset:6144
    v_mfma_f32_16x16x32_bf16 v[194:197], a[132:135], a[184:187], v[194:197]
    ds_read_b64_tr_b16 a[196:197], v74 offset:3072
    s_waitcnt lgkmcnt(4)
    v_mfma_f32_16x16x32_bf16 v[206:209], a[136:139], a[180:183], v[206:209]
    ds_read_b64_tr_b16 a[198:199], v74 offset:3328
    buffer_load_dwordx4 v60, s[24:27], s64 offen offset:1024 lds
    v_mfma_f32_16x16x32_bf16 v[214:217], a[136:139], a[184:187], v[214:217]
    ds_read_b128 a[156:159], v54 offset:7168
    v_mfma_f32_16x16x32_bf16 v[198:201], a[136:139], a[176:179], v[198:201]
    ds_read_b128 a[160:163], v54 offset:8192
    buffer_load_dwordx4 v61, s[24:27], s64 offen offset:2048 lds
    v_mfma_f32_16x16x32_bf16 v[210:213], a[140:143], a[180:183], v[210:213]
    ds_read_b64_tr_b16 a[188:189], v75 offset:2048
    v_mfma_f32_16x16x32_bf16 v[218:221], a[140:143], a[184:187], v[218:221]
    ds_read_b64_tr_b16 a[190:191], v75 offset:2304
    v_mfma_f32_16x16x32_bf16 v[202:205], a[140:143], a[176:179], v[202:205]
    ds_read_b128 a[164:167], v54 offset:9216
    buffer_load_dwordx4 v62, s[24:27], s64 offen offset:3072 lds
    v_mfma_f32_16x16x32_bf16 v[230:233], a[180:183], a[144:147], v[230:233]
    ds_read_b128 a[168:171], v54 offset:10240
    v_mfma_f32_16x16x32_bf16 v[238:241], a[184:187], a[144:147], v[238:241]
    ds_read_b128 a[172:175], v54 offset:11264
    v_mfma_f32_16x16x32_bf16 v[222:225], a[176:179], a[144:147], v[222:225]
    v_mfma_f32_16x16x32_bf16 v[234:237], a[180:183], a[148:151], v[234:237]
    v_mfma_f32_16x16x32_bf16 v[242:245], a[184:187], a[148:151], v[242:245]
    v_mfma_f32_16x16x32_bf16 v[226:229], a[176:179], a[148:151], v[226:229]
    ds_read_b32 v24, v4
    s_waitcnt vmcnt(16) lgkmcnt(1)
    s_barrier
    s_cmp_ge_u32 s14, 7
    s_cbranch_scc0 L_pollin5
L_pollok5:
    v_mfma_f32_16x16x32_bf16 v[182:185], a[152:155], a[192:195], v[182:185]
    ds_read_b64_tr_b16 a[200:201], v31 offset:16384
    buffer_load_dwordx4 a[0:3], v79, s[28:31], s65 offen offset:0 sc1
    v_mfma_f32_16x16x32_bf16 v[190:193], a[152:155], a[196:199], v[190:193]
    ds_read_b64_tr_b16 a[202:203], v31 offset:18432
    v_mfma_f32_16x16x32_bf16 v[186:189], a[156:159], a[192:195], v[186:189]
    ds_read_b64_tr_b16 a[204:205], v33 offset:16384
    buffer_load_dwordx4 a[4:7], v79, s[28:31], s65 offen offset:1024 sc1
    v_mfma_f32_16x16x32_bf16 v[194:197], a[156:159], a[196:199], v[194:197]
    ds_read_b64_tr_b16 a[206:207], v33 offset:18432
    v_mfma_f32_16x16x32_bf16 v[206:209], a[160:163], a[192:195], v[206:209]
    ds_read_b64_tr_b16 a[208:209], v32 offset:16384
    v_mfma_f32_16x16x32_bf16 v[214:217], a[160:163], a[196:199], v[214:217]
    ds_read_b64_tr_b16 a[210:211], v32 offset:18432
    v_mfma_f32_16x16x32_bf16 v[198:201], a[160:163], a[188:191], v[198:201]
    ds_read_b64_tr_b16 a[212:213], v34 offset:16384
    buffer_load_dwordx4 a[8:11], v79, s[28:31], s65 offen offset:2048 sc1
    v_mfma_f32_16x16x32_bf16 v[210:213], a[164:167], a[192:195], v[210:213]
    ds_read_b64_tr_b16 a[214:215], v34 offset:18432
    v_mfma_f32_16x16x32_bf16 v[218:221], a[164:167], a[196:199], v[218:221]
    ds_read_b64_tr_b16 a[216:217], v31 offset:20480
    v_mfma_f32_16x16x32_bf16 v[202:205], a[164:167], a[188:191], v[202:205]
    ds_read_b64_tr_b16 a[218:219], v31 offset:22528
    buffer_load_dwordx4 a[12:15], v79, s[28:31], s65 offen offset:3072 sc1
    v_mfma_f32_16x16x32_bf16 v[230:233], a[192:195], a[168:171], v[230:233]
    ds_read_b64_tr_b16 a[220:221], v33 offset:20480
    s_add_u32 s65, s65, 8192
    v_mfma_f32_16x16x32_bf16 v[238:241], a[196:199], a[168:171], v[238:241]
    ds_read_b64_tr_b16 a[222:223], v33 offset:22528
    s_cmp_eq_u32 s65, 57344
    v_mfma_f32_16x16x32_bf16 v[222:225], a[188:191], a[168:171], v[222:225]
    s_cselect_b32 s65, 0, s65
    v_mfma_f32_16x16x32_bf16 v[234:237], a[192:195], a[172:175], v[234:237]
    buffer_load_dwordx4 a[16:19], v79, s[28:31], s65 offen offset:0 sc1
    v_mfma_f32_16x16x32_bf16 v[242:245], a[196:199], a[172:175], v[242:245]
    v_mfma_f32_16x16x32_bf16 v[226:229], a[188:191], a[172:175], v[226:229]
    v_cvt_pk_bf16_f32 v118, v182, v183
    v_cvt_pk_bf16_f32 v119, v184, v185
    v_cvt_pk_bf16_f32 v120, v186, v187
    buffer_load_dwordx4 a[20:23], v79, s[28:31], s65 offen offset:1024 sc1
    v_cvt_pk_bf16_f32 v121, v188, v189
    v_cvt_pk_bf16_f32 v122, v190, v191
    v_cvt_pk_bf16_f32 v123, v192, v193
    v_cvt_pk_bf16_f32 v124, v194, v195
    v_cvt_pk_bf16_f32 v125, v196, v197
    v_cvt_pk_bf16_f32 v130, v206, v207
    v_cvt_pk_bf16_f32 v131, v208, v209
    v_cvt_pk_bf16_f32 v132, v210, v211
    v_cvt_pk_bf16_f32 v133, v212, v213
    v_cvt_pk_bf16_f32 v134, v214, v215
    v_cvt_pk_bf16_f32 v135, v216, v217
    v_cvt_pk_bf16_f32 v136, v218, v219
    v_cvt_pk_bf16_f32 v137, v220, v221
    v_cvt_pk_bf16_f32 v126, v198, v199
    buffer_load_dwordx4 a[24:27], v79, s[28:31], s65 offen offset:2048 sc1
    v_cvt_pk_bf16_f32 v127, v200, v201
    v_cvt_pk_bf16_f32 v128, v202, v203
    v_cvt_pk_bf16_f32 v129, v204, v205
    v_mfma_f32_16x16x32_bf16 v[154:157], v[130:133], v[118:121], 0
    v_mfma_f32_16x16x32_bf16 v[158:161], v[130:133], v[122:125], 0
    v_mfma_f32_16x16x32_bf16 v[162:165], v[134:137], v[122:125], 0
    buffer_load_dwordx4 a[28:31], v79, s[28:31], s65 offen offset:3072 sc1
    v_mfma_f32_16x16x32_bf16 v[150:153], v[126:129], v[118:121], 0
    v_cvt_pk_bf16_f32 v166, v222, v223
    v_cvt_pk_bf16_f32 v167, v224, v225
    v_cvt_pk_bf16_f32 v168, v230, v231
    v_cvt_pk_bf16_f32 v169, v232, v233
    v_cvt_pk_bf16_f32 v170, v238, v239
    v_cvt_pk_bf16_f32 v171, v240, v241
    v_cndmask_b32 v250, v158, v159, s[70:71]
    v_cndmask_b32 v253, v162, v163, s[70:71]
    v_cndmask_b32 v250, v250, v253, s[72:73]
    s_add_u32 s65, s65, 8192
    s_cmp_eq_u32 s65, 57344
    s_cselect_b32 s65, 0, s65
    buffer_load_dwordx4 a[32:35], v79, s[28:31], s65 offen offset:0 sc1
    v_mul_f32 v250, v250, v29
    v_cndmask_b32 v251, v160, v161, s[70:71]
    v_cndmask_b32 v253, v164, v165, s[70:71]
    v_cndmask_b32 v251, v251, v253, s[74:75]
    v_mul_f32 v251, v251, v30
    v_cndmask_b32 v246, v150, v151, s[70:71]
    v_cndmask_b32 v246, v84, v246, s[76:77]
    v_cndmask_b32 v249, v154, v155, s[70:71]
    v_cndmask_b32 v246, v246, v249, s[72:73]
    v_mul_f32 v246, v246, v27
    v_cndmask_b32 v247, v152, v153, s[70:71]
    v_cndmask_b32 v247, v84, v247, s[76:77]
    v_cndmask_b32 v249, v156, v157, s[70:71]
    v_cndmask_b32 v247, v247, v249, s[74:75]
    buffer_load_dwordx4 a[36:39], v79, s[28:31], s65 offen offset:1024 sc1
    v_mul_f32 v247, v247, v28
    v_max_f32 v248, v246, v247
    v_max_f32 v252, v250, v251
    v_mov_b32 v249, v248
    v_mov_b32 v253, v252
    v_cvt_pk_bf16_f32 v172, v226, v227
    v_permlane16_swap_b32 v248, v249
    v_permlane16_swap_b32 v252, v253
    v_max_f32 v248, v248, v249
    v_max_f32 v252, v252, v253
    v_mov_b32 v249, v248
    v_mov_b32 v253, v252
    v_cvt_pk_bf16_f32 v173, v228, v229
    v_permlane32_swap_b32 v248, v249
    buffer_load_dwordx4 a[40:43], v79, s[28:31], s65 offen offset:2048 sc1
    v_permlane32_swap_b32 v252, v253
    v_max_f32 v248, v248, v249
    v_max_f32 v252, v252, v253
    v_mul_f32 v248, v25, v248
    v_mul_f32 v252, v26, v252
    v_fma_f32 v246, v246, v25, -v248
    v_fma_f32 v247, v247, v25, -v248
    v_fma_f32 v250, v250, v26, -v252
    v_fma_f32 v251, v251, v26, -v252
    v_exp_f32 v246, v246
    v_exp_f32 v247, v247
    v_exp_f32 v250, v250
    buffer_load_dwordx4 a[44:47], v79, s[28:31], s65 offen offset:3072 sc1
    v_exp_f32 v251, v251
    v_add_f32 v248, v246, v247
    v_add_f32 v252, v250, v251
    v_mov_b32 v249, v248
    v_mov_b32 v253, v252
    v_cvt_pk_bf16_f32 v174, v234, v235
    v_permlane16_swap_b32 v248, v249
    v_permlane16_swap_b32 v252, v253
    v_add_f32 v248, v248, v249
    v_add_f32 v252, v252, v253
    v_mov_b32 v249, v248
    v_mov_b32 v253, v252
    s_add_u32 m0, s58, 131072
    s_add_u32 s64, s64, 524288
    s_cmp_eq_u32 s64, 3670016
    s_cselect_b32 s64, 0, s64
    s_add_u32 s64, s64, 524288
    s_cmp_eq_u32 s64, 3670016
    s_cselect_b32 s64, 0, s64
    v_xor_b32 v59, 128, v59
    buffer_load_dwordx4 v59, s[24:27], s64 offen lds
    v_cvt_pk_bf16_f32 v175, v236, v237
    v_permlane32_swap_b32 v248, v249
    v_permlane32_swap_b32 v252, v253
    v_add_f32 v248, v248, v249
    v_add_f32 v252, v252, v253
    v_rcp_f32 v248, v248
    v_rcp_f32 v252, v252
    v_cvt_pk_bf16_f32 v176, v242, v243
    v_cvt_pk_bf16_f32 v177, v244, v245
    v_mul_f32 v246, v246, v27
    v_xor_b32 v60, 128, v60
    buffer_load_dwordx4 v60, s[24:27], s64 offen offset:1024 lds
    v_mul_f32 v247, v247, v28
    v_mul_f32 v250, v250, v29
    v_mul_f32 v251, v251, v30
    v_mul_f32 v246, v246, v248
    v_mul_f32 v247, v247, v248
    v_mul_f32 v250, v250, v252
    v_mul_f32 v251, v251, v252
    v_cvt_pk_bf16_f32 v246, v246, v246
    v_cvt_pk_bf16_f32 v247, v247, v247
    v_cvt_pk_bf16_f32 v250, v250, v250
    v_cvt_pk_bf16_f32 v251, v251, v251
    v_and_b32 v138, v246, v104
    v_and_b32 v139, v247, v105
    v_xor_b32 v61, 128, v61
    buffer_load_dwordx4 v61, s[24:27], s64 offen offset:2048 lds
    v_and_b32 v140, v246, v106
    v_and_b32 v141, v247, v107
    v_and_b32 v142, v250, v104
    v_and_b32 v143, v251, v105
    v_and_b32 v144, v250, v106
    v_and_b32 v145, v251, v107
    v_mfma_f32_16x16x32_bf16 v[182:185], v[166:169], v[138:141], 0
    v_mfma_f32_16x16x32_bf16 v[186:189], v[172:175], v[138:141], 0
    v_xor_b32 v62, 128, v62
    buffer_load_dwordx4 v62, s[24:27], s64 offen offset:3072 lds
    v_mfma_f32_16x16x32_bf16 v[190:193], v[168:171], v[142:145], 0
    v_mfma_f32_16x16x32_bf16 v[194:197], v[174:177], v[142:145], 0
    s_add_u32 s83, s82, 16384
    s_nop 1
    v_cvt_pk_bf16_f32 v110, v182, v183
    v_cvt_pk_bf16_f32 v111, v184, v185
    s_add_u32 m0, s58, 147456
    s_add_u32 s64, s64, 524288
    s_cmp_eq_u32 s64, 3670016
    s_cselect_b32 s64, 0, s64
    buffer_load_dwordx4 v59, s[24:27], s64 offen lds
    v_cvt_pk_bf16_f32 v112, v186, v187
    v_cvt_pk_bf16_f32 v113, v188, v189
    v_cvt_pk_bf16_f32 v114, v190, v191
    v_cvt_pk_bf16_f32 v115, v192, v193
    v_cvt_pk_bf16_f32 v116, v194, v195
    v_cvt_pk_bf16_f32 v117, v196, v197
    buffer_store_dwordx4 v[110:113], v4, s[28:31], s82 offen sc1
    buffer_store_dwordx4 v[114:117], v4, s[28:31], s83 offen sc1
    s_cmp_lg_u32 s56, 0
    s_cbranch_scc0 L_nof
L_f:
    s_waitcnt vmcnt(17) lgkmcnt(8)
    v_mfma_f32_16x16x32_bf16 v[182:185], a[0:3], a[200:203], 0
    ds_read_b64_tr_b16 a[224:225], v32 offset:20480
    s_add_u32 s65, s65, 8192
    s_cmp_eq_u32 s65, 57344
    s_cselect_b32 s65, 0, s65
    buffer_load_dwordx4 a[48:51], v79, s[28:31], s65 offen offset:0 sc1
    v_mfma_f32_16x16x32_bf16 v[186:189], a[4:7], a[200:203], 0
    ds_read_b64_tr_b16 a[226:227], v32 offset:22528
    v_lshlrev_b32 v93, 16, v93
    v_mfma_f32_16x16x32_bf16 v[238:241], a[0:3], a[204:207], 0
    ds_read_b64_tr_b16 a[228:229], v34 offset:20480
    buffer_load_dwordx4 a[52:55], v79, s[28:31], s65 offen offset:1024 sc1
    v_mfma_f32_16x16x32_bf16 v[242:245], a[4:7], a[204:207], 0
    ds_read_b64_tr_b16 a[230:231], v34 offset:22528
    s_waitcnt lgkmcnt(8)
    v_mfma_f32_16x16x32_bf16 v[190:193], a[0:3], a[208:211], 0
    ds_read_b64_tr_b16 a[200:201], v35 offset:0
    v_lshlrev_b32 v222, 16, v96
    v_mfma_f32_16x16x32_bf16 v[194:197], a[4:7], a[208:211], 0
    ds_read_b64_tr_b16 a[202:203], v35 offset:2048
    v_and_b32 v223, 0xffff0000, v96
    v_mfma_f32_16x16x32_bf16 v[246:249], a[0:3], a[212:215], 0
    ds_read_b64_tr_b16 a[204:205], v37 offset:0
    buffer_load_dwordx4 a[56:59], v79, s[28:31], s65 offen offset:2048 sc1
    v_mfma_f32_16x16x32_bf16 v[250:253], a[4:7], a[212:215], 0
    ds_read_b64_tr_b16 a[206:207], v37 offset:2048
    s_waitcnt vmcnt(18) lgkmcnt(8)
    v_mfma_f32_16x16x32_bf16 v[182:185], a[8:11], a[216:219], v[182:185]
    ds_read_b64_tr_b16 a[208:209], v36 offset:0
    v_add_f32 v222, v222, v93
    v_mfma_f32_16x16x32_bf16 v[186:189], a[12:15], a[216:219], v[186:189]
    ds_read_b64_tr_b16 a[210:211], v36 offset:2048
    buffer_load_dwordx4 a[60:63], v79, s[28:31], s65 offen offset:3072 sc1
    v_add_f32 v223, v223, v93
    v_mfma_f32_16x16x32_bf16 v[238:241], a[8:11], a[220:223], v[238:241]
    ds_read_b64_tr_b16 a[212:213], v38 offset:0
    s_add_u32 s65, s65, 8192
    v_mfma_f32_16x16x32_bf16 v[242:245], a[12:15], a[220:223], v[242:245]
    ds_read_b64_tr_b16 a[214:215], v38 offset:2048
    s_waitcnt lgkmcnt(8)
    v_mfma_f32_16x16x32_bf16 v[190:193], a[8:11], a[224:227], v[190:193]
    ds_read_b64_tr_b16 a[216:217], v35 offset:4096
    s_cmp_eq_u32 s65, 57344
    v_mfma_f32_16x16x32_bf16 v[194:197], a[12:15], a[224:227], v[194:197]
    ds_read_b64_tr_b16 a[218:219], v35 offset:6144
    s_cselect_b32 s65, 0, s65
    v_lshlrev_b32 v224, 16, v97
    v_mfma_f32_16x16x32_bf16 v[246:249], a[8:11], a[228:231], v[246:249]
    ds_read_b64_tr_b16 a[220:221], v37 offset:4096
    buffer_load_dwordx4 a[64:67], v79, s[28:31], s65 offen offset:0 sc1
    v_mfma_f32_16x16x32_bf16 v[250:253], a[12:15], a[228:231], v[250:253]
    ds_read_b64_tr_b16 a[222:223], v37 offset:6144
    s_waitcnt vmcnt(18) lgkmcnt(8)
    v_mfma_f32_16x16x32_bf16 v[182:185], a[16:19], a[200:203], v[182:185]
    ds_read_b64_tr_b16 a[224:225], v36 offset:4096
    buffer_load_dwordx4 a[68:71], v79, s[28:31], s65 offen offset:1024 sc1
    v_mfma_f32_16x16x32_bf16 v[186:189], a[20:23], a[200:203], v[186:189]
    ds_read_b64_tr_b16 a[226:227], v36 offset:6144
    v_and_b32 v225, 0xffff0000, v97
    v_mfma_f32_16x16x32_bf16 v[238:241], a[16:19], a[204:207], v[238:241]
    ds_read_b64_tr_b16 a[228:229], v38 offset:4096
    v_add_f32 v224, v224, v93
    v_mfma_f32_16x16x32_bf16 v[242:245], a[20:23], a[204:207], v[242:245]
    ds_read_b64_tr_b16 a[230:231], v38 offset:6144
    s_waitcnt lgkmcnt(8)
    v_mfma_f32_16x16x32_bf16 v[190:193], a[16:19], a[208:211], v[190:193]
    ds_read_b64_tr_b16 a[200:201], v35 offset:16384
    buffer_load_dwordx4 a[72:75], v79, s[28:31], s65 offen offset:2048 sc1
    v_mfma_f32_16x16x32_bf16 v[194:197], a[20:23], a[208:211], v[194:197]
    ds_read_b64_tr_b16 a[202:203], v35 offset:18432
    v_add_f32 v225, v225, v93
    v_mfma_f32_16x16x32_bf16 v[246:249], a[16:19], a[212:215], v[246:249]
    ds_read_b64_tr_b16 a[204:205], v37 offset:16384
    v_lshlrev_b32 v226, 16, v98
    v_mfma_f32_16x16x32_bf16 v[250:253], a[20:23], a[212:215], v[250:253]
    ds_read_b64_tr_b16 a[206:207], v37 offset:18432
    s_waitcnt vmcnt(18) lgkmcnt(8)
    v_mfma_f32_16x16x32_bf16 v[182:185], a[24:27], a[216:219], v[182:185]
    ds_read_b64_tr_b16 a[208:209], v36 offset:16384
    buffer_load_dwordx4 a[76:79], v79, s[28:31], s65 offen offset:3072 sc1
    v_mfma_f32_16x16x32_bf16 v[186:189], a[28:31], a[216:219], v[186:189]
    ds_read_b64_tr_b16 a[210:211], v36 offset:18432
    s_add_u32 s65, s65, 8192
    v_and_b32 v227, 0xffff0000, v98
    v_mfma_f32_16x16x32_bf16 v[238:241], a[24:27], a[220:223], v[238:241]
    ds_read_b64_tr_b16 a[212:213], v38 offset:16384
    s_cmp_eq_u32 s65, 57344
    v_mfma_f32_16x16x32_bf16 v[242:245], a[28:31], a[220:223], v[242:245]
    ds_read_b64_tr_b16 a[214:215], v38 offset:18432
    v_add_f32 v226, v226, v93
    s_waitcnt lgkmcnt(8)
    v_mfma_f32_16x16x32_bf16 v[190:193], a[24:27], a[224:227], v[190:193]
    ds_read_b64_tr_b16 a[216:217], v35 offset:20480
    s_cselect_b32 s65, 0, s65
    buffer_load_dwordx4 a[80:83], v79, s[28:31], s65 offen offset:0 sc1
    v_mfma_f32_16x16x32_bf16 v[194:197], a[28:31], a[224:227], v[194:197]
    ds_read_b64_tr_b16 a[218:219], v35 offset:22528
    v_add_f32 v227, v227, v93
    v_mfma_f32_16x16x32_bf16 v[246:249], a[24:27], a[228:231], v[246:249]
    ds_read_b64_tr_b16 a[220:221], v37 offset:20480
    buffer_load_dwordx4 a[84:87], v79, s[28:31], s65 offen offset:1024 sc1
    v_mfma_f32_16x16x32_bf16 v[250:253], a[28:31], a[228:231], v[250:253]
    ds_read_b64_tr_b16 a[222:223], v37 offset:22528
    v_lshlrev_b32 v228, 16, v99
    s_waitcnt vmcnt(19) lgkmcnt(8)
    v_mfma_f32_16x16x32_bf16 v[182:185], a[32:35], a[200:203], v[182:185]
    ds_read_b64_tr_b16 a[224:225], v36 offset:20480
    v_and_b32 v229, 0xffff0000, v99
    v_mfma_f32_16x16x32_bf16 v[186:189], a[36:39], a[200:203], v[186:189]
    ds_read_b64_tr_b16 a[226:227], v36 offset:22528
    buffer_load_dwordx4 a[88:91], v79, s[28:31], s65 offen offset:2048 sc1
    v_add_f32 v228, v228, v93
    v_mfma_f32_16x16x32_bf16 v[238:241], a[32:35], a[204:207], v[238:241]
    ds_read_b64_tr_b16 a[228:229], v38 offset:20480
    v_add_f32 v229, v229, v93
    v_mfma_f32_16x16x32_bf16 v[242:245], a[36:39], a[204:207], v[242:245]
    ds_read_b64_tr_b16 a[230:231], v38 offset:22528
    s_waitcnt lgkmcnt(8)
    v_mfma_f32_16x16x32_bf16 v[190:193], a[32:35], a[208:211], v[190:193]
    s_waitcnt vmcnt(11)
    s_barrier
    s_cmp_lg_u32 s48, 0
    s_cbranch_scc1 L_sig4
    s_atomic_add s36, s[28:29], s69
L_sig4:
    ds_read_b64_tr_b16 a[200:201], v31 offset:32768
    buffer_load_dwordx4 a[92:95], v79, s[28:31], s65 offen offset:3072 sc1
    v_mfma_f32_16x16x32_bf16 v[194:197], a[36:39], a[208:211], v[194:197]
    ds_read_b64_tr_b16 a[202:203], v31 offset:34816
    s_add_u32 s65, s65, 8192
    v_lshlrev_b32 v94, 16, v94
    v_mfma_f32_16x16x32_bf16 v[246:249], a[32:35], a[212:215], v[246:249]
    ds_read_b64_tr_b16 a[204:205], v33 offset:32768
    s_cmp_eq_u32 s65, 57344
    v_mfma_f32_16x16x32_bf16 v[250:253], a[36:39], a[212:215], v[250:253]
    ds_read_b64_tr_b16 a[206:207], v33 offset:34816
    s_waitcnt lgkmcnt(8)
    v_mfma_f32_16x16x32_bf16 v[182:185], a[40:43], a[216:219], v[182:185]
    ds_read_b64_tr_b16 a[208:209], v32 offset:32768
    s_cselect_b32 s65, 0, s65
    v_mfma_f32_16x16x32_bf16 v[186:189], a[44:47], a[216:219], v[186:189]
    ds_read_b64_tr_b16 a[210:211], v32 offset:34816
    buffer_load_dwordx4 a[96:99], v79, s[28:31], s65 offen offset:0 sc1
    v_lshlrev_b32 v230, 16, v100
    v_mfma_f32_16x16x32_bf16 v[238:241], a[40:43], a[220:223], v[238:241]
    ds_read_b64_tr_b16 a[212:213], v34 offset:32768
    v_and_b32 v231, 0xffff0000, v100
    v_mfma_f32_16x16x32_bf16 v[242:245], a[44:47], a[220:223], v[242:245]
    ds_read_b64_tr_b16 a[214:215], v34 offset:34816
    s_waitcnt lgkmcnt(8)
    v_mfma_f32_16x16x32_bf16 v[190:193], a[40:43], a[224:227], v[190:193]
    ds_read_b64_tr_b16 a[216:217], v31 offset:36864
    buffer_load_dwordx4 a[100:103], v79, s[28:31], s65 offen offset:1024 sc1
    v_mfma_f32_16x16x32_bf16 v[194:197], a[44:47], a[224:227], v[194:197]
    ds_read_b64_tr_b16 a[218:219], v31 offset:38912
    v_add_f32 v230, v230, v94
    v_mfma_f32_16x16x32_bf16 v[246:249], a[40:43], a[228:231], v[246:249]
    ds_read_b64_tr_b16 a[220:221], v33 offset:36864
    buffer_load_dwordx4 a[104:107], v79, s[28:31], s65 offen offset:2048 sc1
    v_mfma_f32_16x16x32_bf16 v[250:253], a[44:47], a[228:231], v[250:253]
    ds_read_b64_tr_b16 a[222:223], v33 offset:38912
    v_add_f32 v231, v231, v94
    s_waitcnt vmcnt(13) lgkmcnt(8)
    v_mfma_f32_16x16x32_bf16 v[182:185], a[48:51], a[200:203], v[182:185]
    ds_read_b64_tr_b16 a[224:225], v32 offset:36864
    v_lshlrev_b32 v232, 16, v101
    v_mfma_f32_16x16x32_bf16 v[186:189], a[52:55], a[200:203], v[186:189]
    ds_read_b64_tr_b16 a[226:227], v32 offset:38912
    v_and_b32 v233, 0xffff0000, v101
    v_mfma_f32_16x16x32_bf16 v[238:241], a[48:51], a[204:207], v[238:241]
    ds_read_b64_tr_b16 a[228:229], v34 offset:36864
    buffer_load_dwordx4 a[108:111], v79, s[28:31], s65 offen offset:3072 sc1
    v_mfma_f32_16x16x32_bf16 v[242:245], a[52:55], a[204:207], v[242:245]
    ds_read_b64_tr_b16 a[230:231], v34 offset:38912
    s_waitcnt lgkmcnt(8)
    v_mfma_f32_16x16x32_bf16 v[190:193], a[48:51], a[208:211], v[190:193]
    ds_read_b64_tr_b16 a[200:201], v31 offset:49152
    v_add_f32 v232, v232, v94
    v_mfma_f32_16x16x32_bf16 v[194:197], a[52:55], a[208:211], v[194:197]
    ds_read_b64_tr_b16 a[202:203], v31 offset:51200
    buffer_load_dwordx4 v60, s[24:27], s64 offen offset:1024 lds
    v_add_f32 v233, v233, v94
    v_mfma_f32_16x16x32_bf16 v[246:249], a[48:51], a[212:215], v[246:249]
    ds_read_b64_tr_b16 a[204:205], v33 offset:49152
    v_lshlrev_b32 v234, 16, v102
    v_mfma_f32_16x16x32_bf16 v[250:253], a[52:55], a[212:215], v[250:253]
    ds_read_b64_tr_b16 a[206:207], v33 offset:51200
    s_waitcnt vmcnt(13) lgkmcnt(8)
    v_mfma_f32_16x16x32_bf16 v[182:185], a[56:59], a[216:219], v[182:185]
    ds_read_b64_tr_b16 a[208:209], v32 offset:49152
    buffer_load_dwordx4 v61, s[24:27], s64 offen offset:2048 lds
    v_mfma_f32_16x16x32_bf16 v[186:189], a[60:63], a[216:219], v[186:189]
    ds_read_b64_tr_b16 a[210:211], v32 offset:51200
    v_and_b32 v235, 0xffff0000, v102
    v_mfma_f32_16x16x32_bf16 v[238:241], a[56:59], a[220:223], v[238:241]
    ds_read_b64_tr_b16 a[212:213], v34 offset:49152
    buffer_load_dwordx4 v62, s[24:27], s64 offen offset:3072 lds
    v_mfma_f32_16x16x32_bf16 v[242:245], a[60:63], a[220:223], v[242:245]
    ds_read_b64_tr_b16 a[214:215], v34 offset:51200
    s_waitcnt lgkmcnt(8)
    v_mfma_f32_16x16x32_bf16 v[190:193], a[56:59], a[224:227], v[190:193]
    ds_read_b64_tr_b16 a[216:217], v31 offset:53248
    s_add_u32 m0, s58, 16384
    v_mfma_f32_16x16x32_bf16 v[194:197], a[60:63], a[224:227], v[194:197]
    ds_read_b64_tr_b16 a[218:219], v31 offset:55296
    s_add_u32 s64, s64, 524288
    v_add_f32 v234, v234, v94
    v_mfma_f32_16x16x32_bf16 v[246:249], a[56:59], a[228:231], v[246:249]
    ds_read_b64_tr_b16 a[220:221], v33 offset:53248
    s_cmp_eq_u32 s64, 3670016
    v_mfma_f32_16x16x32_bf16 v[250:253], a[60:63], a[228:231], v[250:253]
    ds_read_b64_tr_b16 a[222:223], v33 offset:55296
    s_cselect_b32 s64, 0, s64
    buffer_load_dwordx4 v59, s[24:27], s64 offen lds
    v_add_f32 v235, v235, v94
    s_waitcnt vmcnt(14) lgkmcnt(8)
    v_mfma_f32_16x16x32_bf16 v[182:185], a[64:67], a[200:203], v[182:185]
    ds_read_b64_tr_b16 a[224:225], v32 offset:53248
    v_lshlrev_b32 v236, 16, v103
    v_mfma_f32_16x16x32_bf16 v[186:189], a[68:71], a[200:203], v[186:189]
    ds_read_b64_tr_b16 a[226:227], v32 offset:55296
    buffer_load_dwordx4 v60, s[24:27], s64 offen offset:1024 lds
    v_and_b32 v237, 0xffff0000, v103
    v_mfma_f32_16x16x32_bf16 v[238:241], a[64:67], a[204:207], v[238:241]
    ds_read_b64_tr_b16 a[228:229], v34 offset:53248
    v_add_f32 v236, v236, v94
    v_mfma_f32_16x16x32_bf16 v[242:245], a[68:71], a[204:207], v[242:245]
    ds_read_b64_tr_b16 a[230:231], v34 offset:55296
    s_waitcnt lgkmcnt(8)
    v_mfma_f32_16x16x32_bf16 v[190:193], a[64:67], a[208:211], v[190:193]
    s_barrier
    ds_read_b64_tr_b16 a[200:201], v35 offset:32768
    buffer_load_dwordx4 v61, s[24:27], s64 offen offset:2048 lds
    v_mfma_f32_16x16x32_bf16 v[194:197], a[68:71], a[208:211], v[194:197]
    ds_read_b64_tr_b16 a[202:203], v35 offset:34816
    v_add_f32 v237, v237, v94
    v_mfma_f32_16x16x32_bf16 v[246:249], a[64:67], a[212:215], v[246:249]
    ds_read_b64_tr_b16 a[204:205], v37 offset:32768
    v_mfma_f32_16x16x32_bf16 v[250:253], a[68:71], a[212:215], v[250:253]
    ds_read_b64_tr_b16 a[206:207], v37 offset:34816
    s_waitcnt vmcnt(14) lgkmcnt(8)
    v_mfma_f32_16x16x32_bf16 v[182:185], a[72:75], a[216:219], v[182:185]
    ds_read_b64_tr_b16 a[208:209], v36 offset:32768
    buffer_load_dwordx4 v62, s[24:27], s64 offen offset:3072 lds
    v_mfma_f32_16x16x32_bf16 v[186:189], a[76:79], a[216:219], v[186:189]
    ds_read_b64_tr_b16 a[210:211], v36 offset:34816
    s_add_u32 m0, s58, 65536
    v_mfma_f32_16x16x32_bf16 v[238:241], a[72:75], a[220:223], v[238:241]
    ds_read_b64_tr_b16 a[212:213], v38 offset:32768
    s_add_u32 s64, s64, 524288
    v_mfma_f32_16x16x32_bf16 v[242:245], a[76:79], a[220:223], v[242:245]
    ds_read_b64_tr_b16 a[214:215], v38 offset:34816
    s_waitcnt lgkmcnt(8)
    v_mfma_f32_16x16x32_bf16 v[190:193], a[72:75], a[224:227], v[190:193]
    ds_read_b64_tr_b16 a[216:217], v35 offset:36864
    s_cmp_eq_u32 s64, 3670016
    v_mfma_f32_16x16x32_bf16 v[194:197], a[76:79], a[224:227], v[194:197]
    ds_read_b64_tr_b16 a[218:219], v35 offset:38912
    s_cselect_b32 s64, 0, s64
    buffer_load_dwordx4 v59, s[24:27], s64 offen lds
    v_mfma_f32_16x16x32_bf16 v[246:249], a[72:75], a[228:231], v[246:249]
    ds_read_b64_tr_b16 a[220:221], v37 offset:36864
    v_mfma_f32_16x16x32_bf16 v[250:253], a[76:79], a[228:231], v[250:253]
    ds_read_b64_tr_b16 a[222:223], v37 offset:38912
    s_waitcnt vmcnt(14) lgkmcnt(8)
    v_mfma_f32_16x16x32_bf16 v[182:185], a[80:83], a[200:203], v[182:185]
    ds_read_b64_tr_b16 a[224:225], v36 offset:36864
    buffer_load_dwordx4 v60, s[24:27], s64 offen offset:1024 lds
    v_mfma_f32_16x16x32_bf16 v[186:189], a[84:87], a[200:203], v[186:189]
    ds_read_b64_tr_b16 a[226:227], v36 offset:38912
    v_mfma_f32_16x16x32_bf16 v[238:241], a[80:83], a[204:207], v[238:241]
    ds_read_b64_tr_b16 a[228:229], v38 offset:36864
    v_mfma_f32_16x16x32_bf16 v[242:245], a[84:87], a[204:207], v[242:245]
    ds_read_b64_tr_b16 a[230:231], v38 offset:38912
    s_waitcnt lgkmcnt(8)
    v_mfma_f32_16x16x32_bf16 v[190:193], a[80:83], a[208:211], v[190:193]
    ds_read_b64_tr_b16 a[200:201], v35 offset:49152
    buffer_load_dwordx4 v61, s[24:27], s64 offen offset:2048 lds
    v_mfma_f32_16x16x32_bf16 v[194:197], a[84:87], a[208:211], v[194:197]
    ds_read_b64_tr_b16 a[202:203], v35 offset:51200
    v_mfma_f32_16x16x32_bf16 v[246:249], a[80:83], a[212:215], v[246:249]
    ds_read_b64_tr_b16 a[204:205], v37 offset:49152
    v_mfma_f32_16x16x32_bf16 v[250:253], a[84:87], a[212:215], v[250:253]
    ds_read_b64_tr_b16 a[206:207], v37 offset:51200
    s_waitcnt vmcnt(14) lgkmcnt(8)
    v_mfma_f32_16x16x32_bf16 v[182:185], a[88:91], a[216:219], v[182:185]
    ds_read_b64_tr_b16 a[208:209], v36 offset:49152
L_pad3:
    s_cbranch_execz L_warm
    buffer_load_dwordx4 v62, s[24:27], s64 offen offset:3072 lds
    v_mfma_f32_16x16x32_bf16 v[186:189], a[92:95], a[216:219], v[186:189]
    ds_read_b64_tr_b16 a[210:211], v36 offset:51200
    s_add_u32 m0, s58, 81920
    v_mfma_f32_16x16x32_bf16 v[238:241], a[88:91], a[220:223], v[238:241]
    ds_read_b64_tr_b16 a[212:213], v38 offset:49152
    s_add_u32 s64, s64, 524288
    v_mfma_f32_16x16x32_bf16 v[242:245], a[92:95], a[220:223], v[242:245]
    ds_read_b64_tr_b16 a[214:215], v38 offset:51200
    s_waitcnt lgkmcnt(8)
    v_mfma_f32_16x16x32_bf16 v[190:193], a[88:91], a[224:227], v[190:193]
    ds_read_b64_tr_b16 a[216:217], v35 offset:53248
    s_cmp_eq_u32 s64, 3670016
    s_cselect_b32 s64, 0, s64
    buffer_load_dwordx4 v59, s[24:27], s64 offen lds
    v_mfma_f32_16x16x32_bf16 v[194:197], a[92:95], a[224:227], v[194:197]
    ds_read_b64_tr_b16 a[218:219], v35 offset:55296
    v_mfma_f32_16x16x32_bf16 v[246:249], a[88:91], a[228:231], v[246:249]
    ds_read_b64_tr_b16 a[220:221], v37 offset:53248
    buffer_load_dwordx4 v60, s[24:27], s64 offen offset:1024 lds
    v_mfma_f32_16x16x32_bf16 v[250:253], a[92:95], a[228:231], v[250:253]
    ds_read_b64_tr_b16 a[222:223], v37 offset:55296
    s_waitcnt vmcnt(15) lgkmcnt(8)
    v_mfma_f32_16x16x32_bf16 v[182:185], a[96:99], a[200:203], v[182:185]
    ds_read_b64_tr_b16 a[224:225], v36 offset:53248
    v_mfma_f32_16x16x32_bf16 v[186:189], a[100:103], a[200:203], v[186:189]
    ds_read_b64_tr_b16 a[226:227], v36 offset:55296
    v_mfma_f32_16x16x32_bf16 v[238:241], a[96:99], a[204:207], v[238:241]
    ds_read_b64_tr_b16 a[228:229], v38 offset:53248
    buffer_load_dwordx4 v61, s[24:27], s64 offen offset:2048 lds
    v_mfma_f32_16x16x32_bf16 v[242:245], a[100:103], a[204:207], v[242:245]
    ds_read_b64_tr_b16 a[230:231], v38 offset:55296
    s_waitcnt lgkmcnt(8)
    v_mfma_f32_16x16x32_bf16 v[190:193], a[96:99], a[208:211], v[190:193]
    ds_read_b64_tr_b16 a[200:201], v31 offset:0
    v_mfma_f32_16x16x32_bf16 v[194:197], a[100:103], a[208:211], v[194:197]
    ds_read_b64_tr_b16 a[202:203], v31 offset:2048
    v_mfma_f32_16x16x32_bf16 v[246:249], a[96:99], a[212:215], v[246:249]
    ds_read_b64_tr_b16 a[204:205], v33 offset:0
    buffer_load_dwordx4 v62, s[24:27], s64 offen offset:3072 lds
    v_mfma_f32_16x16x32_bf16 v[250:253], a[100:103], a[212:215], v[250:253]
    ds_read_b64_tr_b16 a[206:207], v33 offset:2048
    s_waitcnt vmcnt(15) lgkmcnt(8)
    v_mfma_f32_16x16x32_bf16 v[182:185], a[104:107], a[216:219], v[182:185]
    ds_read_b64_tr_b16 a[208:209], v32 offset:0
    s_add_u32 m0, s58, 32768
    v_mfma_f32_16x16x32_bf16 v[186:189], a[108:111], a[216:219], v[186:189]
    ds_read_b64_tr_b16 a[210:211], v32 offset:2048
    s_add_u32 s64, s64, 524288
    v_mfma_f32_16x16x32_bf16 v[238:241], a[104:107], a[220:223], v[238:241]
    ds_read_b64_tr_b16 a[212:213], v34 offset:0
    s_cmp_eq_u32 s64, 3670016
    v_mfma_f32_16x16x32_bf16 v[242:245], a[108:111], a[220:223], v[242:245]
    ds_read_b64_tr_b16 a[214:215], v34 offset:2048
    s_cselect_b32 s64, 0, s64
    buffer_load_dwordx4 v59, s[24:27], s64 offen lds
    s_waitcnt lgkmcnt(8)
    v_mfma_f32_16x16x32_bf16 v[190:193], a[104:107], a[224:227], v[190:193]
    ds_read_b64_tr_b16 a[216:217], v31 offset:4096
    v_mfma_f32_16x16x32_bf16 v[194:197], a[108:111], a[224:227], v[194:197]
    ds_read_b64_tr_b16 a[218:219], v31 offset:6144
    buffer_load_dwordx4 v60, s[24:27], s64 offen offset:1024 lds
    v_mfma_f32_16x16x32_bf16 v[246:249], a[104:107], a[228:231], v[246:249]
    ds_read_b64_tr_b16 a[220:221], v33 offset:4096
    v_mfma_f32_16x16x32_bf16 v[250:253], a[108:111], a[228:231], v[250:253]
    ds_read_b64_tr_b16 a[222:223], v33 offset:6144
    s_waitcnt lgkmcnt(8)
    v_mfma_f32_16x16x32_bf16 v[150:153], a[0:3], a[200:203], 0
    ds_read_b64_tr_b16 a[224:225], v32 offset:4096
    v_mfma_f32_16x16x32_bf16 v[154:157], a[4:7], a[200:203], 0
    ds_read_b64_tr_b16 a[226:227], v32 offset:6144
    buffer_load_dwordx4 v61, s[24:27], s64 offen offset:2048 lds
    v_mfma_f32_16x16x32_bf16 v[166:169], a[0:3], a[204:207], 0
    ds_read_b64_tr_b16 a[228:229], v34 offset:4096
    v_cvt_pk_bf16_f32 v182, v182, v183
    v_mfma_f32_16x16x32_bf16 v[170:173], a[4:7], a[204:207], 0
    ds_read_b64_tr_b16 a[230:231], v34 offset:6144
    v_cvt_pk_bf16_f32 v183, v184, v185
    v_cvt_pk_bf16_f32 v184, v186, v187
    s_waitcnt lgkmcnt(8)
    v_mfma_f32_16x16x32_bf16 v[158:161], a[0:3], a[208:211], 0
    s_waitcnt vmcnt(15)
    s_barrier
    ds_read_b64_tr_b16 a[200:201], v39 offset:0
    buffer_load_dwordx4 v62, s[24:27], s64 offen offset:3072 lds
    v_mfma_f32_16x16x32_bf16 v[162:165], a[4:7], a[208:211], 0
    ds_read_b64_tr_b16 a[202:203], v39 offset:2048
    s_add_u32 m0, s58, 49152
    v_cvt_pk_bf16_f32 v185, v188, v189
    buffer_store_dwordx4 v[182:185], v21, s[28:31], 0 offen offset:0 sc1
    v_cvt_pk_bf16_f32 v190, v190, v191
    v_cvt_pk_bf16_f32 v191, v192, v193
    v_cvt_pk_bf16_f32 v192, v194, v195
    v_mfma_f32_16x16x32_bf16 v[174:177], a[0:3], a[212:215], 0
    ds_read_b64_tr_b16 a[204:205], v41 offset:0
    s_add_u32 s66, s66, 1
    v_mfma_f32_16x16x32_bf16 v[178:181], a[4:7], a[212:215], 0
    ds_read_b64_tr_b16 a[206:207], v41 offset:2048
    v_cvt_pk_bf16_f32 v193, v196, v197
    buffer_store_dwordx4 v[190:193], v21, s[28:31], 0 offen offset:1024 sc1
    v_cvt_pk_bf16_f32 v238, v238, v239
    v_cvt_pk_bf16_f32 v239, v240, v241
    v_cvt_pk_bf16_f32 v240, v242, v243
    s_waitcnt lgkmcnt(8)
    v_mfma_f32_16x16x32_bf16 v[150:153], a[8:11], a[216:219], v[150:153]
    ds_read_b64_tr_b16 a[208:209], v40 offset:0
    s_and_b32 s66, s66, 3
    v_mfma_f32_16x16x32_bf16 v[154:157], a[12:15], a[216:219], v[154:157]
    ds_read_b64_tr_b16 a[210:211], v40 offset:2048
    s_mul_i32 s61, s66, 100352
    buffer_load_dwordx4 v63, s[16:19], s61 offen lds
    v_cvt_pk_bf16_f32 v241, v244, v245
    buffer_store_dwordx4 v[238:241], v21, s[28:31], 0 offen offset:2048 sc1
    v_cvt_pk_bf16_f32 v246, v246, v247
    v_cvt_pk_bf16_f32 v247, v248, v249
    v_cvt_pk_bf16_f32 v248, v250, v251
    v_mfma_f32_16x16x32_bf16 v[166:169], a[8:11], a[220:223], v[166:169]
    ds_read_b64_tr_b16 a[212:213], v42 offset:0
    v_cvt_pk_bf16_f32 v249, v252, v253
    v_mfma_f32_16x16x32_bf16 v[170:173], a[12:15], a[220:223], v[170:173]
    ds_read_b64_tr_b16 a[214:215], v42 offset:2048
    s_waitcnt lgkmcnt(8)
    v_mfma_f32_16x16x32_bf16 v[158:161], a[8:11], a[224:227], v[158:161]
    ds_read_b64_tr_b16 a[216:217], v39 offset:4096
    buffer_load_dwordx4 v64, s[16:19], s61 offen offset:1024 lds
    v_mfma_f32_16x16x32_bf16 v[162:165], a[12:15], a[224:227], v[162:165]
    ds_read_b64_tr_b16 a[218:219], v39 offset:6144
    s_add_u32 s61, s61, 48128
    buffer_store_dwordx4 v[246:249], v21, s[28:31], 0 offen offset:3072 sc1
    v_mfma_f32_16x16x32_bf16 v[174:177], a[8:11], a[228:231], v[174:177]
    ds_read_b64_tr_b16 a[220:221], v41 offset:4096
    v_mfma_f32_16x16x32_bf16 v[178:181], a[12:15], a[228:231], v[178:181]
    ds_read_b64_tr_b16 a[222:223], v41 offset:6144
    s_waitcnt lgkmcnt(8)
    v_mfma_f32_16x16x32_bf16 v[150:153], a[16:19], a[200:203], v[150:153]
    ds_read_b64_tr_b16 a[224:225], v40 offset:4096
    buffer_load_dwordx4 v63, s[16:19], s61 offen offset:2048 lds
    v_mfma_f32_16x16x32_bf16 v[154:157], a[20:23], a[200:203], v[154:157]
    ds_read_b64_tr_b16 a[226:227], v40 offset:6144
    v_mfma_f32_16x16x32_bf16 v[166:169], a[16:19], a[204:207], v[166:169]
    ds_read_b64_tr_b16 a[228:229], v42 offset:4096
    v_mfma_f32_16x16x32_bf16 v[170:173], a[20:23], a[204:207], v[170:173]
    ds_read_b64_tr_b16 a[230:231], v42 offset:6144
    s_waitcnt lgkmcnt(8)
    v_mfma_f32_16x16x32_bf16 v[158:161], a[16:19], a[208:211], v[158:161]
    s_mov_b32 s14, 0
    s_load_dword s14, s[28:29], s39
    ds_read_b64_tr_b16 a[200:201], v39 offset:16384
    buffer_load_dwordx4 v64, s[16:19], s61 offen offset:3072 lds
    v_mfma_f32_16x16x32_bf16 v[162:165], a[20:23], a[208:211], v[162:165]
    ds_read_b64_tr_b16 a[202:203], v39 offset:18432
    s_add_u32 m0, s58, 98304
    v_mfma_f32_16x16x32_bf16 v[174:177], a[16:19], a[212:215], v[174:177]
    ds_read_b64_tr_b16 a[204:205], v41 offset:16384
    s_add_u32 s66, s66, 1
    v_mfma_f32_16x16x32_bf16 v[178:181], a[20:23], a[212:215], v[178:181]
    ds_read_b64_tr_b16 a[206:207], v41 offset:18432
    s_waitcnt lgkmcnt(8)
    v_mfma_f32_16x16x32_bf16 v[150:153], a[24:27], a[216:219], v[150:153]
    ds_read_b64_tr_b16 a[208:209], v40 offset:16384
    s_and_b32 s66, s66, 3
    s_mul_i32 s61, s66, 100352
    buffer_load_dwordx4 v63, s[16:19], s61 offen lds
    v_mfma_f32_16x16x32_bf16 v[154:157], a[28:31], a[216:219], v[154:157]
    ds_read_b64_tr_b16 a[210:211], v40 offset:18432
    v_mfma_f32_16x16x32_bf16 v[166:169], a[24:27], a[220:223], v[166:169]
    ds_read_b64_tr_b16 a[212:213], v42 offset:16384
    buffer_load_dwordx4 v64, s[16:19], s61 offen offset:1024 lds
    v_mfma_f32_16x16x32_bf16 v[170:173], a[28:31], a[220:223], v[170:173]
    ds_read_b64_tr_b16 a[214:215], v42 offset:18432
    s_waitcnt lgkmcnt(8)
    v_mfma_f32_16x16x32_bf16 v[158:161], a[24:27], a[224:227], v[158:161]
    ds_read_b64_tr_b16 a[216:217], v39 offset:20480
    s_add_u32 s61, s61, 48128
    v_mfma_f32_16x16x32_bf16 v[162:165], a[28:31], a[224:227], v[162:165]
    ds_read_b64_tr_b16 a[218:219], v39 offset:22528
    v_mfma_f32_16x16x32_bf16 v[174:177], a[24:27], a[228:231], v[174:177]
    ds_read_b64_tr_b16 a[220:221], v41 offset:20480
    buffer_load_dwordx4 v63, s[16:19], s61 offen offset:2048 lds
    v_mfma_f32_16x16x32_bf16 v[178:181], a[28:31], a[228:231], v[178:181]
    ds_read_b64_tr_b16 a[222:223], v41 offset:22528
    s_waitcnt lgkmcnt(8)
    v_mfma_f32_16x16x32_bf16 v[150:153], a[32:35], a[200:203], v[150:153]
    ds_read_b64_tr_b16 a[224:225], v40 offset:20480
    v_mfma_f32_16x16x32_bf16 v[154:157], a[36:39], a[200:203], v[154:157]
    ds_read_b64_tr_b16 a[226:227], v40 offset:22528
    v_mfma_f32_16x16x32_bf16 v[166:169], a[32:35], a[204:207], v[166:169]
    ds_read_b64_tr_b16 a[228:229], v42 offset:20480
    buffer_load_dwordx4 v64, s[16:19], s61 offen offset:3072 lds
    v_mfma_f32_16x16x32_bf16 v[170:173], a[36:39], a[204:207], v[170:173]
    ds_read_b64_tr_b16 a[230:231], v42 offset:22528
    s_waitcnt lgkmcnt(8)
    v_mfma_f32_16x16x32_bf16 v[158:161], a[32:35], a[208:211], v[158:161]
    s_waitcnt vmcnt(20)
    s_barrier
    ds_read_b64_tr_b16 a[200:201], v31 offset:16384
    s_add_u32 m0, s58, 114688
    v_mfma_f32_16x16x32_bf16 v[162:165], a[36:39], a[208:211], v[162:165]
    ds_read_b64_tr_b16 a[202:203], v31 offset:18432
    s_add_u32 s66, s66, 1
    v_mfma_f32_16x16x32_bf16 v[174:177], a[32:35], a[212:215], v[174:177]
    ds_read_b64_tr_b16 a[204:205], v33 offset:16384
    s_and_b32 s66, s66, 3
    v_mfma_f32_16x16x32_bf16 v[178:181], a[36:39], a[212:215], v[178:181]
    ds_read_b64_tr_b16 a[206:207], v33 offset:18432
    s_mul_i32 s61, s66, 100352
    buffer_load_dwordx4 v63, s[16:19], s61 offen lds
    s_waitcnt lgkmcnt(8)
    v_mfma_f32_16x16x32_bf16 v[150:153], a[40:43], a[216:219], v[150:153]
    ds_read_b64_tr_b16 a[208:209], v32 offset:16384
    v_mfma_f32_16x16x32_bf16 v[154:157], a[44:47], a[216:219], v[154:157]
    ds_read_b64_tr_b16 a[210:211], v32 offset:18432
    buffer_load_dwordx4 v64, s[16:19], s61 offen offset:1024 lds
    v_mfma_f32_16x16x32_bf16 v[166:169], a[40:43], a[220:223], v[166:169]
    ds_read_b64_tr_b16 a[212:213], v34 offset:16384
    s_add_u32 s61, s61, 48128
    v_mfma_f32_16x16x32_bf16 v[170:173], a[44:47], a[220:223], v[170:173]
    ds_read_b64_tr_b16 a[214:215], v34 offset:18432
    s_waitcnt lgkmcnt(8)
    v_mfma_f32_16x16x32_bf16 v[158:161], a[40:43], a[224:227], v[158:161]
    ds_read_b64_tr_b16 a[216:217], v31 offset:20480
    v_mfma_f32_16x16x32_bf16 v[162:165], a[44:47], a[224:227], v[162:165]
    ds_read_b64_tr_b16 a[218:219], v31 offset:22528
    buffer_load_dwordx4 v63, s[16:19], s61 offen offset:2048 lds
    v_mfma_f32_16x16x32_bf16 v[174:177], a[40:43], a[228:231], v[174:177]
    ds_read_b64_tr_b16 a[220:221], v33 offset:20480
    v_mfma_f32_16x16x32_bf16 v[178:181], a[44:47], a[228:231], v[178:181]
    ds_read_b64_tr_b16 a[222:223], v33 offset:22528
    s_waitcnt lgkmcnt(8)
    v_mfma_f32_16x16x32_bf16 v[150:153], a[48:51], a[200:203], v[150:153]
    ds_read_b64_tr_b16 a[224:225], v32 offset:20480
    v_mfma_f32_16x16x32_bf16 v[154:157], a[52:55], a[200:203], v[154:157]
    ds_read_b64_tr_b16 a[226:227], v32 offset:22528
    buffer_load_dwordx4 v64, s[16:19], s61 offen offset:3072 lds
    v_mfma_f32_16x16x32_bf16 v[166:169], a[48:51], a[204:207], v[166:169]
    ds_read_b64_tr_b16 a[228:229], v34 offset:20480
    v_mfma_f32_16x16x32_bf16 v[170:173], a[52:55], a[204:207], v[170:173]
    ds_read_b64_tr_b16 a[230:231], v34 offset:22528
    s_waitcnt lgkmcnt(8)
    v_mfma_f32_16x16x32_bf16 v[158:161], a[48:51], a[208:211], v[158:161]
    s_waitcnt vmcnt(10)
    s_atomic_add s36, s[28:29], s55
    ds_read_b64_tr_b16 a[200:201], v35 offset:0
    v_mfma_f32_16x16x32_bf16 v[162:165], a[52:55], a[208:211], v[162:165]
    ds_read_b64_tr_b16 a[202:203], v35 offset:2048
    v_mfma_f32_16x16x32_bf16 v[174:177], a[48:51], a[212:215], v[174:177]
    ds_read_b64_tr_b16 a[204:205], v37 offset:0
    v_mfma_f32_16x16x32_bf16 v[178:181], a[52:55], a[212:215], v[178:181]
    ds_read_b64_tr_b16 a[206:207], v37 offset:2048
    s_waitcnt lgkmcnt(8)
    v_mfma_f32_16x16x32_bf16 v[150:153], a[56:59], a[216:219], v[150:153]
    ds_read_b64_tr_b16 a[208:209], v36 offset:0
    v_mfma_f32_16x16x32_bf16 v[154:157], a[60:63], a[216:219], v[154:157]
    ds_read_b64_tr_b16 a[210:211], v36 offset:2048
    v_mfma_f32_16x16x32_bf16 v[166:169], a[56:59], a[220:223], v[166:169]
    ds_read_b64_tr_b16 a[212:213], v38 offset:0
    v_mfma_f32_16x16x32_bf16 v[170:173], a[60:63], a[220:223], v[170:173]
    ds_read_b64_tr_b16 a[214:215], v38 offset:2048
    s_waitcnt lgkmcnt(8)
    v_mfma_f32_16x16x32_bf16 v[158:161], a[56:59], a[224:227], v[158:161]
    ds_read_b64_tr_b16 a[216:217], v35 offset:4096
    v_mfma_f32_16x16x32_bf16 v[162:165], a[60:63], a[224:227], v[162:165]
    ds_read_b64_tr_b16 a[218:219], v35 offset:6144
    v_mfma_f32_16x16x32_bf16 v[174:177], a[56:59], a[228:231], v[174:177]
    ds_read_b64_tr_b16 a[220:221], v37 offset:4096
    v_mfma_f32_16x16x32_bf16 v[178:181], a[60:63], a[228:231], v[178:181]
    ds_read_b64_tr_b16 a[222:223], v37 offset:6144
    s_waitcnt lgkmcnt(8)
    v_mfma_f32_16x16x32_bf16 v[150:153], a[64:67], a[200:203], v[150:153]
    s_cmp_ge_u32 s14, 8
    s_cbranch_scc0 L_pollin6
L_pollok6:
    ds_read_b64_tr_b16 a[224:225], v36 offset:4096
    s_add_u32 m0, s58, 0
    s_add_u32 s51, s51, 1
    s_and_b32 s51, s51, 3
    s_lshl_b32 s61, s51, 12
    buffer_load_dwordx4 v65, s[28:31], s61 offen sc1 lds
    v_mfma_f32_16x16x32_bf16 v[154:157], a[68:71], a[200:203], v[154:157]
    ds_read_b64_tr_b16 a[226:227], v36 offset:6144
    v_mfma_f32_16x16x32_bf16 v[166:169], a[64:67], a[204:207], v[166:169]
    ds_read_b64_tr_b16 a[228:229], v38 offset:4096
    buffer_load_dwordx4 v66, s[28:31], s61 offen offset:1024 sc1 lds
    v_mfma_f32_16x16x32_bf16 v[170:173], a[68:71], a[204:207], v[170:173]
    ds_read_b64_tr_b16 a[230:231], v38 offset:6144
    s_waitcnt lgkmcnt(8)
    v_mfma_f32_16x16x32_bf16 v[158:161], a[64:67], a[208:211], v[158:161]
    s_barrier
    ds_read_b64_tr_b16 a[200:201], v35 offset:16384
    buffer_load_dwordx4 v65, s[28:31], s61 offen offset:2048 sc1 lds
    v_mfma_f32_16x16x32_bf16 v[162:165], a[68:71], a[208:211], v[162:165]
    ds_read_b64_tr_b16 a[202:203], v35 offset:18432
    v_mfma_f32_16x16x32_bf16 v[174:177], a[64:67], a[212:215], v[174:177]
    ds_read_b64_tr_b16 a[204:205], v37 offset:16384
    v_mfma_f32_16x16x32_bf16 v[178:181], a[68:71], a[212:215], v[178:181]
    ds_read_b64_tr_b16 a[206:207], v37 offset:18432
    s_waitcnt lgkmcnt(8)
    v_mfma_f32_16x16x32_bf16 v[150:153], a[72:75], a[216:219], v[150:153]
    ds_read_b64_tr_b16 a[208:209], v36 offset:16384
    buffer_load_dwordx4 v66, s[28:31], s61 offen offset:3072 sc1 lds
    v_mfma_f32_16x16x32_bf16 v[154:157], a[76:79], a[216:219], v[154:157]
    ds_read_b64_tr_b16 a[210:211], v36 offset:18432
    s_add_u32 m0, s58, 131072
    v_mfma_f32_16x16x32_bf16 v[166:169], a[72:75], a[220:223], v[166:169]
    ds_read_b64_tr_b16 a[212:213], v38 offset:16384
    s_add_u32 s51, s51, 1
    v_mfma_f32_16x16x32_bf16 v[170:173], a[76:79], a[220:223], v[170:173]
    ds_read_b64_tr_b16 a[214:215], v38 offset:18432
    s_waitcnt lgkmcnt(8)
    v_mfma_f32_16x16x32_bf16 v[158:161], a[72:75], a[224:227], v[158:161]
    ds_read_b64_tr_b16 a[216:217], v35 offset:20480
    s_and_b32 s51, s51, 3
    s_lshl_b32 s61, s51, 12
    buffer_load_dwordx4 v65, s[28:31], s61 offen sc1 lds
    v_mfma_f32_16x16x32_bf16 v[162:165], a[76:79], a[224:227], v[162:165]
    ds_read_b64_tr_b16 a[218:219], v35 offset:22528
    v_mfma_f32_16x16x32_bf16 v[174:177], a[72:75], a[228:231], v[174:177]
    ds_read_b64_tr_b16 a[220:221], v37 offset:20480
    buffer_load_dwordx4 v66, s[28:31], s61 offen offset:1024 sc1 lds
    v_mfma_f32_16x16x32_bf16 v[178:181], a[76:79], a[228:231], v[178:181]
    ds_read_b64_tr_b16 a[222:223], v37 offset:22528
    s_waitcnt lgkmcnt(8)
    v_mfma_f32_16x16x32_bf16 v[150:153], a[80:83], a[200:203], v[150:153]
    ds_read_b64_tr_b16 a[224:225], v36 offset:20480
    v_mfma_f32_16x16x32_bf16 v[154:157], a[84:87], a[200:203], v[154:157]
    ds_read_b64_tr_b16 a[226:227], v36 offset:22528
    buffer_load_dwordx4 v65, s[28:31], s61 offen offset:2048 sc1 lds
    v_mfma_f32_16x16x32_bf16 v[166:169], a[80:83], a[204:207], v[166:169]
    ds_read_b64_tr_b16 a[228:229], v38 offset:20480
    v_mfma_f32_16x16x32_bf16 v[170:173], a[84:87], a[204:207], v[170:173]
    ds_read_b64_tr_b16 a[230:231], v38 offset:22528
    s_waitcnt lgkmcnt(8)
    v_mfma_f32_16x16x32_bf16 v[158:161], a[80:83], a[208:211], v[158:161]
    s_barrier
    ds_read_b64_tr_b16 a[200:201], v31 offset:32768
    buffer_load_dwordx4 v66, s[28:31], s61 offen offset:3072 sc1 lds
    v_mfma_f32_16x16x32_bf16 v[162:165], a[84:87], a[208:211], v[162:165]
    ds_read_b64_tr_b16 a[202:203], v31 offset:34816
    s_add_u32 m0, s58, 147456
    v_mfma_f32_16x16x32_bf16 v[174:177], a[80:83], a[212:215], v[174:177]
    ds_read_b64_tr_b16 a[204:205], v33 offset:32768
    s_add_u32 s51, s51, 1
    v_mfma_f32_16x16x32_bf16 v[178:181], a[84:87], a[212:215], v[178:181]
    ds_read_b64_tr_b16 a[206:207], v33 offset:34816
    s_waitcnt lgkmcnt(8)
    v_mfma_f32_16x16x32_bf16 v[150:153], a[88:91], a[216:219], v[150:153]
    ds_read_b64_tr_b16 a[208:209], v32 offset:32768
    s_and_b32 s51, s51, 3
    s_lshl_b32 s61, s51, 12
    buffer_load_dwordx4 v65, s[28:31], s61 offen sc1 lds
    v_mfma_f32_16x16x32_bf16 v[154:157], a[92:95], a[216:219], v[154:157]
    ds_read_b64_tr_b16 a[210:211], v32 offset:34816
    v_mfma_f32_16x16x32_bf16 v[166:169], a[88:91], a[220:223], v[166:169]
    ds_read_b64_tr_b16 a[212:213], v34 offset:32768
    buffer_load_dwordx4 v66, s[28:31], s61 offen offset:1024 sc1 lds
    v_mfma_f32_16x16x32_bf16 v[170:173], a[92:95], a[220:223], v[170:173]
    ds_read_b64_tr_b16 a[214:215], v34 offset:34816
    s_waitcnt lgkmcnt(8)
    v_mfma_f32_16x16x32_bf16 v[158:161], a[88:91], a[224:227], v[158:161]
    ds_read_b64_tr_b16 a[216:217], v31 offset:36864
    v_mfma_f32_16x16x32_bf16 v[162:165], a[92:95], a[224:227], v[162:165]
    ds_read_b64_tr_b16 a[218:219], v31 offset:38912
    buffer_load_dwordx4 v65, s[28:31], s61 offen offset:2048 sc1 lds
    v_mfma_f32_16x16x32_bf16 v[174:177], a[88:91], a[228:231], v[174:177]
    ds_read_b64_tr_b16 a[220:221], v33 offset:36864
    v_mfma_f32_16x16x32_bf16 v[178:181], a[92:95], a[228:231], v[178:181]
    ds_read_b64_tr_b16 a[222:223], v33 offset:38912
    s_waitcnt lgkmcnt(8)
    v_mfma_f32_16x16x32_bf16 v[150:153], a[96:99], a[200:203], v[150:153]
    ds_read_b64_tr_b16 a[224:225], v32 offset:36864
    buffer_load_dwordx4 v66, s[28:31], s61 offen offset:3072 sc1 lds
    v_mfma_f32_16x16x32_bf16 v[154:157], a[100:103], a[200:203], v[154:157]
    ds_read_b64_tr_b16 a[226:227], v32 offset:38912
    s_add_u32 m0, s58, 16384
    v_mfma_f32_16x16x32_bf16 v[166:169], a[96:99], a[204:207], v[166:169]
    ds_read_b64_tr_b16 a[228:229], v34 offset:36864
    s_add_u32 s66, s66, 1
    v_mfma_f32_16x16x32_bf16 v[170:173], a[100:103], a[204:207], v[170:173]
    ds_read_b64_tr_b16 a[230:231], v34 offset:38912
    s_waitcnt lgkmcnt(8)
    v_mfma_f32_16x16x32_bf16 v[158:161], a[96:99], a[208:211], v[158:161]
    s_waitcnt vmcnt(8)
    s_barrier
    s_xor_b32 s55, s55, 1024
    s_mov_b32 s14, 0
    s_load_dword s14, s[28:29], s55
    ds_read_b64_tr_b16 v[198:199], v43 offset:49152
    ds_read_b64_tr_b16 v[200:201], v43 offset:53248
    s_and_b32 s66, s66, 3
    s_mul_i32 s61, s66, 100352
    buffer_load_dwordx4 v63, s[16:19], s61 offen lds
    v_mfma_f32_16x16x32_bf16 v[162:165], a[100:103], a[208:211], v[162:165]
    ds_read_b64_tr_b16 v[202:203], v44 offset:49152
    v_mfma_f32_16x16x32_bf16 v[174:177], a[96:99], a[212:215], v[174:177]
    ds_read_b64_tr_b16 v[204:205], v44 offset:53248
    buffer_load_dwordx4 v64, s[16:19], s61 offen offset:1024 lds
    v_mfma_f32_16x16x32_bf16 v[178:181], a[100:103], a[212:215], v[178:181]
    ds_read_b128 a[200:203], v47 offset:0
    s_waitcnt lgkmcnt(9)
    v_mfma_f32_16x16x32_bf16 v[150:153], a[104:107], a[216:219], v[150:153]
    ds_read_b128 a[204:207], v48 offset:0
    s_add_u32 s61, s61, 48128
    v_mfma_f32_16x16x32_bf16 v[154:157], a[108:111], a[216:219], v[154:157]
    ds_read_b128 a[208:211], v47 offset:1024
    buffer_load_dwordx4 v63, s[16:19], s61 offen offset:2048 lds
    v_mfma_f32_16x16x32_bf16 v[166:169], a[104:107], a[220:223], v[166:169]
    ds_read_b128 a[212:215], v48 offset:1024
    v_mfma_f32_16x16x32_bf16 v[170:173], a[108:111], a[220:223], v[170:173]
    s_waitcnt lgkmcnt(8)
    v_mfma_f32_16x16x32_bf16 v[158:161], a[104:107], a[224:227], v[158:161]
    ds_read_b64_tr_b16 v[206:207], v43 offset:51200
    ds_read_b64_tr_b16 v[208:209], v43 offset:55296
    v_mfma_f32_16x16x32_bf16 v[162:165], a[108:111], a[224:227], v[162:165]
    ds_read_b64_tr_b16 v[210:211], v44 offset:51200
    buffer_load_dwordx4 v64, s[16:19], s61 offen offset:3072 lds
    v_mfma_f32_16x16x32_bf16 v[174:177], a[104:107], a[228:231], v[174:177]
    ds_read_b64_tr_b16 v[212:213], v44 offset:55296
    s_add_u32 m0, s58, 65536
    v_mfma_f32_16x16x32_bf16 v[178:181], a[108:111], a[228:231], v[178:181]
    ds_read_b128 a[216:219], v47 offset:2048
    s_waitcnt lgkmcnt(7)
    v_mfma_f32_16x16x32_bf16 v[150:153], v[198:201], a[200:203], v[150:153]
    ds_read_b128 a[220:223], v48 offset:2048
    s_add_u32 s51, s51, 1
    s_and_b32 s51, s51, 3
    s_lshl_b32 s61, s51, 12
    buffer_load_dwordx4 v65, s[28:31], s61 offen sc1 lds
    v_mfma_f32_16x16x32_bf16 v[154:157], v[202:205], a[200:203], v[154:157]
    ds_read_b128 a[224:227], v47 offset:3072
    v_mfma_f32_16x16x32_bf16 v[166:169], v[198:201], a[204:207], v[166:169]
    ds_read_b128 a[228:231], v48 offset:3072
    buffer_load_dwordx4 v66, s[28:31], s61 offen offset:1024 sc1 lds
    v_mfma_f32_16x16x32_bf16 v[170:173], v[202:205], a[204:207], v[170:173]
    s_waitcnt lgkmcnt(8)
    v_mfma_f32_16x16x32_bf16 v[158:161], v[198:201], a[208:211], v[158:161]
    s_waitcnt vmcnt(10)
    s_barrier
    ds_read_b64_tr_b16 v[214:215], v45 offset:32768
    ds_read_b64_tr_b16 v[216:217], v45 offset:36864
    v_mfma_f32_16x16x32_bf16 v[162:165], v[202:205], a[208:211], v[162:165]
    ds_read_b64_tr_b16 v[218:219], v46 offset:32768
    buffer_load_dwordx4 v65, s[28:31], s61 offen offset:2048 sc1 lds
    v_mfma_f32_16x16x32_bf16 v[174:177], v[198:201], a[212:215], v[174:177]
    ds_read_b64_tr_b16 v[220:221], v46 offset:36864
    v_mfma_f32_16x16x32_bf16 v[178:181], v[202:205], a[212:215], v[178:181]
    ds_read_b128 a[200:203], v51 offset:0
    s_waitcnt lgkmcnt(7)
    v_mfma_f32_16x16x32_bf16 v[150:153], v[206:209], a[216:219], v[150:153]
    ds_read_b128 a[204:207], v52 offset:0
    buffer_load_dwordx4 v66, s[28:31], s61 offen offset:3072 sc1 lds
    v_mfma_f32_16x16x32_bf16 v[154:157], v[210:213], a[216:219], v[154:157]
    ds_read_b128 a[208:211], v51 offset:1024
    v_mfma_f32_16x16x32_bf16 v[166:169], v[206:209], a[220:223], v[166:169]
    ds_read_b128 a[212:215], v52 offset:1024
    v_mfma_f32_16x16x32_bf16 v[170:173], v[210:213], a[220:223], v[170:173]
    s_waitcnt lgkmcnt(8)
    v_mfma_f32_16x16x32_bf16 v[158:161], v[206:209], a[224:227], v[158:161]
    s_cmp_ge_u32 s14, 1
    s_cbranch_scc0 L_pollin7
L_pollok7:
    v_xor_b32 v21, 131072, v21
    ds_read_b64_tr_b16 v[198:199], v45 offset:34816
    ds_read_b64_tr_b16 v[200:201], v45 offset:38912
    buffer_load_dwordx4 v[246:249], v21, s[28:31], 0 offen offset:2048 sc1
    v_mfma_f32_16x16x32_bf16 v[162:165], v[210:213], a[224:227], v[162:165]
    ds_read_b64_tr_b16 v[202:203], v46 offset:34816
    buffer_load_dwordx4 v[250:253], v21, s[28:31], 0 offen offset:3072 sc1
    v_mfma_f32_16x16x32_bf16 v[174:177], v[206:209], a[228:231], v[174:177]
    ds_read_b64_tr_b16 v[204:205], v46 offset:38912
    v_mfma_f32_16x16x32_bf16 v[178:181], v[210:213], a[228:231], v[178:181]
    ds_read_b128 a[216:219], v51 offset:2048
    s_waitcnt lgkmcnt(7)
    v_mfma_f32_16x16x32_bf16 v[150:153], v[214:217], a[200:203], v[150:153]
    ds_read_b128 a[220:223], v52 offset:2048
    buffer_load_dwordx4 v[238:241], v21, s[28:31], 0 offen offset:0 sc1
    v_mfma_f32_16x16x32_bf16 v[154:157], v[218:221], a[200:203], v[154:157]
    ds_read_b128 a[224:227], v51 offset:3072
    buffer_load_dwordx4 v[242:245], v21, s[28:31], 0 offen offset:1024 sc1
    v_mfma_f32_16x16x32_bf16 v[166:169], v[214:217], a[204:207], v[166:169]
    ds_read_b128 a[228:231], v52 offset:3072
    v_mfma_f32_16x16x32_bf16 v[170:173], v[218:221], a[204:207], v[170:173]
    s_waitcnt lgkmcnt(8)
    v_mfma_f32_16x16x32_bf16 v[158:161], v[214:217], a[208:211], v[158:161]
    s_waitcnt vmcnt(12)
    s_barrier
    ds_read_b64_tr_b16 v[206:207], v45 offset:49152
    ds_read_b64_tr_b16 v[208:209], v45 offset:53248
    v_mfma_f32_16x16x32_bf16 v[162:165], v[218:221], a[208:211], v[162:165]
    ds_read_b64_tr_b16 v[210:211], v46 offset:49152
    v_mfma_f32_16x16x32_bf16 v[174:177], v[214:217], a[212:215], v[174:177]
    ds_read_b64_tr_b16 v[212:213], v46 offset:53248
    v_mfma_f32_16x16x32_bf16 v[178:181], v[218:221], a[212:215], v[178:181]
    ds_read_b128 a[200:203], v51 offset:16384
    s_waitcnt lgkmcnt(7)
    v_mfma_f32_16x16x32_bf16 v[150:153], v[198:201], a[216:219], v[150:153]
    ds_read_b128 a[204:207], v52 offset:16384
    v_mfma_f32_16x16x32_bf16 v[154:157], v[202:205], a[216:219], v[154:157]
    ds_read_b128 a[208:211], v51 offset:17408
    v_mfma_f32_16x16x32_bf16 v[166:169], v[198:201], a[220:223], v[166:169]
    ds_read_b128 a[212:215], v52 offset:17408
    v_mfma_f32_16x16x32_bf16 v[170:173], v[202:205], a[220:223], v[170:173]
    s_waitcnt lgkmcnt(8)
    v_mfma_f32_16x16x32_bf16 v[158:161], v[198:201], a[224:227], v[158:161]
    ds_read_b64_tr_b16 v[214:215], v45 offset:51200
    ds_read_b64_tr_b16 v[216:217], v45 offset:55296
    v_mfma_f32_16x16x32_bf16 v[162:165], v[202:205], a[224:227], v[162:165]
    ds_read_b64_tr_b16 v[218:219], v46 offset:51200
    v_mfma_f32_16x16x32_bf16 v[174:177], v[198:201], a[228:231], v[174:177]
    ds_read_b64_tr_b16 v[220:221], v46 offset:55296
    v_mfma_f32_16x16x32_bf16 v[178:181], v[202:205], a[228:231], v[178:181]
    ds_read_b128 a[216:219], v51 offset:18432
    s_waitcnt lgkmcnt(7)
    v_mfma_f32_16x16x32_bf16 v[150:153], v[206:209], a[200:203], v[150:153]
    ds_read_b128 a[220:223], v52 offset:18432
    v_mfma_f32_16x16x32_bf16 v[154:157], v[210:213], a[200:203], v[154:157]
    ds_read_b128 a[224:227], v51 offset:19456
    v_mfma_f32_16x16x32_bf16 v[166:169], v[206:209], a[204:207], v[166:169]
    ds_read_b128 a[228:231], v52 offset:19456
    v_mfma_f32_16x16x32_bf16 v[170:173], v[210:213], a[204:207], v[170:173]
    s_waitcnt lgkmcnt(8)
    v_mfma_f32_16x16x32_bf16 v[158:161], v[206:209], a[208:211], v[158:161]
    s_waitcnt vmcnt(4)
    s_barrier
    ds_read_b64_tr_b16 v[198:199], v43 offset:16384
    ds_read_b64_tr_b16 v[200:201], v43 offset:20480
    v_mfma_f32_16x16x32_bf16 v[162:165], v[210:213], a[208:211], v[162:165]
    ds_read_b64_tr_b16 v[202:203], v44 offset:16384
    v_mfma_f32_16x16x32_bf16 v[174:177], v[206:209], a[212:215], v[174:177]
    ds_read_b64_tr_b16 v[204:205], v44 offset:20480
    v_mfma_f32_16x16x32_bf16 v[178:181], v[210:213], a[212:215], v[178:181]
    ds_read_b128 a[200:203], v50 offset:0
    s_waitcnt lgkmcnt(7)
    v_mfma_f32_16x16x32_bf16 v[150:153], v[214:217], a[216:219], v[150:153]
    ds_read_b128 a[204:207], v50 offset:1024
    ds_read_b64_tr_b16 v[206:207], v43 offset:18432
    v_mfma_f32_16x16x32_bf16 v[154:157], v[218:221], a[216:219], v[154:157]
    ds_read_b64_tr_b16 v[208:209], v43 offset:22528
    ds_read_b64_tr_b16 v[210:211], v44 offset:18432
    v_mfma_f32_16x16x32_bf16 v[166:169], v[214:217], a[220:223], v[166:169]
    ds_read_b64_tr_b16 v[212:213], v44 offset:22528
    v_mfma_f32_16x16x32_bf16 v[170:173], v[218:221], a[220:223], v[170:173]
    ds_read_b128 a[208:211], v50 offset:2048
    s_waitcnt lgkmcnt(11)
    v_mfma_f32_16x16x32_bf16 v[158:161], v[214:217], a[224:227], v[158:161]
    ds_read_b128 a[212:215], v50 offset:3072
    v_mfma_f32_16x16x32_bf16 v[162:165], v[218:221], a[224:227], v[162:165]
    v_mfma_f32_16x16x32_bf16 v[174:177], v[214:217], a[228:231], v[174:177]
    v_mfma_f32_16x16x32_bf16 v[178:181], v[218:221], a[228:231], v[178:181]
    s_waitcnt lgkmcnt(6)
    v_mfma_f32_16x16x32_bf16 v[166:169], v[198:201], a[200:203], v[166:169]
    ds_read_b128 a[224:227], v49 offset:0
    v_mfma_f32_16x16x32_bf16 v[170:173], v[202:205], a[200:203], v[170:173]
    v_mfma_f32_16x16x32_bf16 v[174:177], v[198:201], a[204:207], v[174:177]
    ds_read_b128 a[228:231], v49 offset:1024
    v_mfma_f32_16x16x32_bf16 v[178:181], v[202:205], a[204:207], v[178:181]
    s_waitcnt lgkmcnt(2)
    v_mfma_f32_16x16x32_bf16 v[166:169], v[206:209], a[208:211], v[166:169]
    ds_read_b128 a[200:203], v49 offset:2048
    v_mfma_f32_16x16x32_bf16 v[170:173], v[210:213], a[208:211], v[170:173]
L_pad4:
    s_cbranch_execz L_warm
    v_mfma_f32_16x16x32_bf16 v[174:177], v[206:209], a[212:215], v[174:177]
    ds_read_b128 a[204:207], v49 offset:3072
    v_mfma_f32_16x16x32_bf16 v[178:181], v[210:213], a[212:215], v[178:181]
    s_waitcnt vmcnt(3)
    v_mfma_f32_16x16x32_bf16 v[166:169], a[250:253], v[246:249], v[166:169]
    v_mfma_f32_16x16x32_bf16 v[170:173], a[248:251], v[246:249], v[170:173]
    s_waitcnt vmcnt(2)
    v_mfma_f32_16x16x32_bf16 v[174:177], a[250:253], v[250:253], v[174:177]
    v_mfma_f32_16x16x32_bf16 v[178:181], a[248:251], v[250:253], v[178:181]
    s_waitcnt lgkmcnt(2)
    v_mfma_f32_16x16x32_bf16 v[150:153], v[198:201], a[224:227], v[150:153]
    v_mfma_f32_16x16x32_bf16 v[154:157], v[202:205], a[224:227], v[154:157]
    v_mfma_f32_16x16x32_bf16 v[158:161], v[198:201], a[228:231], v[158:161]
    ds_write_b128 v87, v[166:169] offset:8192
    v_mfma_f32_16x16x32_bf16 v[162:165], v[202:205], a[228:231], v[162:165]
    s_waitcnt lgkmcnt(1)
    v_mfma_f32_16x16x32_bf16 v[150:153], v[206:209], a[200:203], v[150:153]
    ds_write_b128 v88, v[170:173] offset:8192
    v_mfma_f32_16x16x32_bf16 v[154:157], v[210:213], a[200:203], v[154:157]
    v_mfma_f32_16x16x32_bf16 v[158:161], v[206:209], a[204:207], v[158:161]
    ds_write_b128 v87, v[174:177] offset:12288
    v_mfma_f32_16x16x32_bf16 v[162:165], v[210:213], a[204:207], v[162:165]
    s_waitcnt vmcnt(1)
    v_mfma_f32_16x16x32_bf16 v[150:153], a[250:253], v[238:241], v[150:153]
    ds_write_b128 v88, v[178:181] offset:12288
    v_mfma_f32_16x16x32_bf16 v[154:157], a[248:251], v[238:241], v[154:157]
    s_waitcnt vmcnt(0)
    v_mfma_f32_16x16x32_bf16 v[158:161], a[250:253], v[242:245], v[158:161]
    v_mfma_f32_16x16x32_bf16 v[162:165], a[248:251], v[242:245], v[162:165]
    s_nop 2
    ds_write_b128 v87, v[150:153] offset:0
    s_nop 0
    ds_write_b128 v88, v[154:157] offset:0
    s_nop 0
    ds_write_b128 v87, v[158:161] offset:4096
    ds_write_b128 v88, v[162:165] offset:4096
    s_waitcnt lgkmcnt(0)
    s_barrier
    ds_read_b128 v[118:121], v89 offset:0
    ds_read_b128 v[122:125], v90 offset:0
    ds_read_b128 v[126:129], v91 offset:0
    ds_read_b128 v[130:133], v92 offset:0
    ds_read_b128 v[134:137], v89 offset:2048
    ds_read_b128 v[138:141], v90 offset:2048
    ds_read_b128 v[142:145], v91 offset:2048
    ds_read_b128 v[146:149], v92 offset:2048
    s_waitcnt lgkmcnt(7)
    v_pk_add_f32 v[222:223], v[222:223], v[118:119]
    v_pk_add_f32 v[224:225], v[224:225], v[120:121]
    s_waitcnt lgkmcnt(6)
    v_pk_add_f32 v[226:227], v[226:227], v[122:123]
    v_pk_add_f32 v[228:229], v[228:229], v[124:125]
    s_waitcnt lgkmcnt(5)
    v_pk_add_f32 v[222:223], v[222:223], v[126:127]
    v_pk_add_f32 v[224:225], v[224:225], v[128:129]
    s_waitcnt lgkmcnt(4)
    v_pk_add_f32 v[226:227], v[226:227], v[130:131]
    v_pk_add_f32 v[228:229], v[228:229], v[132:133]
    v_cvt_pk_bf16_f32 v110, v222, v223
    v_cvt_pk_bf16_f32 v111, v224, v225
    v_cvt_pk_bf16_f32 v112, v226, v227
    v_cvt_pk_bf16_f32 v113, v228, v229
    buffer_store_dwordx4 v[110:113], v85, s[32:35], 0 offen
    s_waitcnt lgkmcnt(3)
    v_pk_add_f32 v[230:231], v[230:231], v[134:135]
    v_pk_add_f32 v[232:233], v[232:233], v[136:137]
    s_waitcnt lgkmcnt(2)
    v_pk_add_f32 v[234:235], v[234:235], v[138:139]
    v_pk_add_f32 v[236:237], v[236:237], v[140:141]
    s_waitcnt lgkmcnt(1)
    v_pk_add_f32 v[230:231], v[230:231], v[142:143]
    v_pk_add_f32 v[232:233], v[232:233], v[144:145]
    s_waitcnt lgkmcnt(0)
    v_pk_add_f32 v[234:235], v[234:235], v[146:147]
    v_pk_add_f32 v[236:237], v[236:237], v[148:149]
    v_cvt_pk_bf16_f32 v114, v230, v231
    v_cvt_pk_bf16_f32 v115, v232, v233
    v_cvt_pk_bf16_f32 v116, v234, v235
    v_cvt_pk_bf16_f32 v117, v236, v237
    buffer_store_dwordx4 v[114:117], v86, s[32:35], 0 offen
L_fin:
L_end:
    s_endpgm
L_nonce:
    buffer_load_dword v12, v16, s[44:47], 0 offen sc1
    s_add_u32 s60, s60, 1
    s_waitcnt vmcnt(0)
    v_readfirstlane_b32 s57, v12
    s_cmp_ge_u32 s60, 20000
    s_cbranch_scc1 L_nonce_ok
    s_cmp_eq_u32 s57, 0
    s_cbranch_scc1 L_nonce
    s_branch L_nonce_ok
L_pollin0:
    s_mov_b32 s60, 0
L_poll0:
    s_sleep 4
    buffer_load_dword v18, v20, s[28:31], 0 offen sc1
    s_add_u32 s60, s60, 1
    s_waitcnt vmcnt(0)
    v_cmp_ne_u32 vcc, s57, v18
    s_cbranch_vccz L_pollok0
    s_cmp_lt_u32 s60, 20000
    s_cbranch_scc1 L_poll0
    s_branch L_pollok0
L_pollin1:
    s_waitcnt lgkmcnt(0)
    s_cmp_ge_u32 s14, 14
    s_cbranch_scc1 L_pollok1
    s_mov_b32 s60, 0
    s_branch L_poll1a
L_poll1:
    s_sleep 8
L_poll1a:
    buffer_load_dword v18, off, s[44:47], s15 sc1
    s_add_u32 s60, s60, 1
    s_waitcnt vmcnt(0)
    v_readfirstlane_b32 s14, v18
    s_nop 0
    s_cmp_ge_u32 s14, 14
    s_cbranch_scc1 L_pollok1
    s_cmp_lt_u32 s60, 20000
    s_cbranch_scc1 L_poll1
    s_branch L_pollok1
L_pollin2:
    s_waitcnt lgkmcnt(0)
    s_cmp_ge_u32 s14, 2
    s_cbranch_scc1 L_pollok2
    s_mov_b32 s60, 0
    s_branch L_poll2a
L_poll2:
    s_sleep 4
L_poll2a:
    buffer_load_dword v18, off, s[28:31], s37 sc1
    s_add_u32 s60, s60, 1
    s_waitcnt vmcnt(0)
    v_readfirstlane_b32 s14, v18
    s_nop 0
    s_cmp_ge_u32 s14, 2
    s_cbranch_scc1 L_pollok2
    s_cmp_lt_u32 s60, 20000
    s_cbranch_scc1 L_poll2
    s_branch L_pollok2
L_nonceh:
    buffer_load_dword v12, v16, s[44:47], 0 offen sc1
    s_add_u32 s60, s60, 1
    s_waitcnt vmcnt(0)
    v_readfirstlane_b32 s57, v12
    s_cmp_ge_u32 s60, 20000
    s_cbranch_scc1 L_nonce_okh
    s_cmp_eq_u32 s57, 0
    s_cbranch_scc1 L_nonceh
    s_branch L_nonce_okh
L_pollin3:
    s_mov_b32 s60, 0
L_poll3:
    s_sleep 8
    buffer_load_dword v18, v20, s[28:31], 0 offen sc1
    s_add_u32 s60, s60, 1
    s_waitcnt vmcnt(0)
    v_cmp_ne_u32 vcc, s57, v18
    s_cbranch_vccz L_pollok3
    s_cmp_lt_u32 s60, 20000
    s_cbranch_scc1 L_poll3
    s_branch L_pollok3
L_pollin4:
    s_waitcnt lgkmcnt(0)
    s_cmp_ge_u32 s14, 14
    s_cbranch_scc1 L_pollok4
    s_mov_b32 s60, 0
    s_branch L_poll4a
L_poll4:
    s_sleep 16
L_poll4a:
    buffer_load_dword v18, off, s[44:47], s15 sc1
    s_add_u32 s60, s60, 1
    s_waitcnt vmcnt(0)
    v_readfirstlane_b32 s14, v18
    s_nop 0
    s_cmp_ge_u32 s14, 14
    s_cbranch_scc1 L_pollok4
    s_cmp_lt_u32 s60, 20000
    s_cbranch_scc1 L_poll4
    s_branch L_pollok4
L_nog1:
    s_nop 1
    s_mov_b32 s14, 1204224
    s_mov_b32 s15, 0x20000
    s_sub_u32 s3, s2, 200
    s_cmp_lt_u32 s3, 42
    s_cselect_b32 s81, 0, 268435456
    s_cselect_b32 s3, s3, 0
    s_mul_i32 s79, s3, 43
    s_lshr_b32 s79, s79, 7
    s_mul_i32 s80, s79, 3
    s_sub_u32 s80, s3, s80
    v_min_u32 v13, 55, v1
    s_lshl_b32 s3, s79, 2
    s_add_u32 s3, s3, s48
    s_mul_i32 s3, s3, 21504
    s_mul_i32 s60, s80, 896
    s_add_u32 s3, s3, s60
    s_add_u32 s3, s3, s81
    v_lshl_add_u32 v242, v13, 4, s3
    s_mul_i32 s60, s48, 8448
    s_add_u32 m0, s60, 0
    s_mov_b32 s3, 0
    buffer_load_dwordx4 v242, s[12:15], s3 offen lds
    s_add_u32 m0, s60, 1056
    s_mov_b32 s3, 2688
    buffer_load_dwordx4 v242, s[12:15], s3 offen lds
    s_add_u32 m0, s60, 2112
    s_mov_b32 s3, 5376
    buffer_load_dwordx4 v242, s[12:15], s3 offen lds
    s_add_u32 m0, s60, 3168
    s_mov_b32 s3, 8064
    buffer_load_dwordx4 v242, s[12:15], s3 offen lds
    s_add_u32 m0, s60, 4224
    s_mov_b32 s3, 10752
    buffer_load_dwordx4 v242, s[12:15], s3 offen lds
    s_add_u32 m0, s60, 5280
    s_mov_b32 s3, 13440
    buffer_load_dwordx4 v242, s[12:15], s3 offen lds
    s_add_u32 m0, s60, 6336
    s_mov_b32 s3, 16128
    buffer_load_dwordx4 v242, s[12:15], s3 offen lds
    s_add_u32 m0, s60, 7392
    s_mov_b32 s3, 18816
    buffer_load_dwordx4 v242, s[12:15], s3 offen lds
    s_mul_i32 s53, s101, 37
    s_lshr_b32 s53, s53, 8
    s_mul_i32 s54, s53, 7
    s_sub_u32 s54, s101, s54
    s_and_b32 s53, s53, 3
    s_xor_b32 s53, s53, 0
    s_lshl_b32 s3, s6, 2
    s_add_u32 s53, s53, s3
    s_lshl_b32 s53, s53, 1
    s_add_u32 s53, s53, s7
    s_mov_b32 s42, 4096
    s_mov_b32 s43, 0x20000
    s_lshl_b32 s3, s53, 2
    s_add_u32 s3, s3, s48
    s_lshl_b32 s60, s3, 5
    v_lshl_add_u32 v82, v5, 1, s60
    s_mul_i32 s3, s3, 14336
    s_lshl_b32 s60, s54, 7
    s_add_u32 s3, s3, s60
    v_mul_u32_u24 v14, 896, v5
    v_lshl_add_u32 v14, v6, 4, v14
    v_add_u32 v85, s3, v14
    v_add_u32 v86, 7168, v85
    s_cmp_lt_u32 s101, 28
    s_cselect_b32 s56, 1, 0
    s_lshl_b32 s50, s7, 3
    s_and_b32 s3, s101, 7
    s_add_u32 s50, s50, s3
    s_lshr_b32 s60, s101, 3
    s_lshl_b32 s49, s6, 2
    s_add_u32 s49, s49, s60
    s_lshl_b32 s49, s49, 2
    s_add_u32 s49, s49, s48
    s_mul_i32 s60, s60, 0
    s_add_u32 s3, s3, s60
    s_sub_u32 s60, s3, 7
    s_cmp_ge_u32 s3, 7
    s_cselect_b32 s3, s60, s3
    s_lshl_b32 s62, s3, 18
    s_mul_i32 s63, s3, 12288
    s_mov_b32 s30, 20971520
    s_mov_b32 s31, 0x20000
    s_mov_b32 s75, 0x3727c5ac
    s_mov_b32 s76, 0x3b124925
    s_mov_b32 s77, 0x3f803f80
    v_lshlrev_b32 v4, 4, v1
    v_bfe_u32 v7, v1, 2, 2
    v_and_b32 v8, 3, v1
    v_mul_u32_u24 v13, 960, v9
    v_lshl_add_u32 v13, v10, 4, v13
    s_mul_i32 s3, s48, 1920
    s_add_u32 s3, s3, 147456
    v_add_u32 v230, s3, v13
    v_mul_u32_u24 v13, 960, v7
    v_lshl_add_u32 v13, v3, 5, v13
    v_lshl_add_u32 v13, v8, 3, v13
    s_lshl_b32 s3, s48, 8
    s_add_u32 s3, s3, 147456
    v_add_u32 v231, s3, v13
    s_lshl_b32 s3, s48, 3
    s_add_u32 s3, s3, 155648
    v_lshl_add_u32 v232, v9, 2, s3
    v_lshlrev_b32 v237, 2, v6
    v_and_b32 v2, 15, v1
    v_lshlrev_b32 v238, 13, v3
    v_add_lshl_u32 v238, v238, v2, 3
    v_add_u32 v237, 155648, v237
    v_lshlrev_b32 v13, 17, v9
    v_lshl_add_u32 v233, v10, 4, v13
    s_cmp_eq_u32 s48, 3
    s_cselect_b32 s60, 268435456, 0
    s_lshl_b32 s70, s48, 10
    s_add_u32 s70, s70, s2
    s_lshl_b32 s70, s70, 9
    s_add_u32 s71, s70, 262144
    s_add_u32 s71, s71, s60
    s_xor_b32 s60, s60, 268435456
    s_lshl_b32 s72, s2, 7
    s_add_u32 s72, s72, s60
    s_add_u32 s72, s72, 6291456
    s_lshr_b32 s74, s2, 2
    s_lshl_b32 s74, s74, 4
    s_and_b32 s3, s2, 3
    s_add_u32 s74, s74, s3
    s_lshl_b32 s74, s74, 2
    s_add_u32 s74, s74, 10485760
    v_cmp_gt_u32 vcc, 8, v0
    v_lshlrev_b32 v236, 13, v0
    v_mov_b32 v13, 268435456
    s_and_b32 s3, s2, 7
    s_lshl_b32 s3, s3, 13
    s_add_u32 s3, s3, 10485760
    v_lshrrev_b32 v14, 2, v0
    v_lshl_add_u32 v14, v14, 6, s3
    v_and_b32 v15, 3, v0
    v_lshl_add_u32 v20, v15, 2, v14
    v_cndmask_b32 v236, v13, v236, vcc
    v_mov_b32 v16, 0
    s_lshl_b32 s3, s48, 14
    s_add_u32 s74, s74, s3
    s_add_u32 s73, s74, 8192
    s_waitcnt vmcnt(10)
    v_dot2_f32_bf16 v226, v182, s77, 0
    v_dot2_f32_bf16 v227, v182, v182, 0
    v_dot2_f32_bf16 v226, v183, s77, v226
    v_dot2_f32_bf16 v227, v183, v183, v227
    v_dot2_f32_bf16 v226, v184, s77, v226
    v_dot2_f32_bf16 v227, v184, v184, v227
    v_dot2_f32_bf16 v226, v185, s77, v226
    v_dot2_f32_bf16 v227, v185, v185, v227
    s_waitcnt vmcnt(9)
    v_dot2_f32_bf16 v226, v186, s77, v226
    v_dot2_f32_bf16 v227, v186, v186, v227
    v_dot2_f32_bf16 v226, v187, s77, v226
    v_dot2_f32_bf16 v227, v187, v187, v227
    v_dot2_f32_bf16 v226, v188, s77, v226
    v_dot2_f32_bf16 v227, v188, v188, v227
    v_dot2_f32_bf16 v226, v189, s77, v226
    v_dot2_f32_bf16 v227, v189, v189, v227
    buffer_load_dword v12, v16, s[44:47], 0 offen sc1
    v_lshlrev_b32 v190, 16, v182
    v_and_b32 v191, 0xffff0000, v182
    v_add_f32_dpp v226, v226, v226 quad_perm:[1,0,3,2] row_mask:0xf bank_mask:0xf
    v_add_f32_dpp v227, v227, v227 quad_perm:[1,0,3,2] row_mask:0xf bank_mask:0xf
    v_lshlrev_b32 v192, 16, v183
    v_add_f32_dpp v226, v226, v226 quad_perm:[2,3,0,1] row_mask:0xf bank_mask:0xf
    v_add_f32_dpp v227, v227, v227 quad_perm:[2,3,0,1] row_mask:0xf bank_mask:0xf
    v_and_b32 v193, 0xffff0000, v183
    v_add_f32_dpp v226, v226, v226 row_half_mirror row_mask:0xf bank_mask:0xf
    v_add_f32_dpp v227, v227, v227 row_half_mirror row_mask:0xf bank_mask:0xf
    v_lshlrev_b32 v194, 16, v184
    v_add_f32_dpp v226, v226, v226 row_mirror row_mask:0xf bank_mask:0xf
    v_add_f32_dpp v227, v227, v227 row_mirror row_mask:0xf bank_mask:0xf
    v_and_b32 v195, 0xffff0000, v184
    v_mov_b32 v228, v226
    v_mov_b32 v229, v227
    v_lshlrev_b32 v196, 16, v185
    v_permlane16_swap_b32 v226, v228
    v_permlane16_swap_b32 v227, v229
    v_add_f32 v226, v226, v228
    v_add_f32 v227, v227, v229
    v_mul_f32_e64 v226, -v226, s76
    v_mul_f32 v228, v226, v226
    v_fma_f32 v227, v227, s76, -v228
    v_max_f32 v227, 0, v227
    v_add_f32 v228, s75, v227
    v_rsq_f32 v222, v228
    v_and_b32 v197, 0xffff0000, v185
    v_mul_f32 v228, v222, v222
    v_fma_f32 v229, v228, v227, s75
    v_rsq_f32 v228, v229
    v_mul_f32 v223, v226, v222
    v_mul_f32 v224, v222, v228
    v_mul_f32 v225, v223, v228
    v_mul_f32 v229, v229, v228
    ds_write_b32 v232, v229
    v_lshlrev_b32 v198, 16, v186
    v_and_b32 v199, 0xffff0000, v186
    v_lshlrev_b32 v200, 16, v187
    v_and_b32 v201, 0xffff0000, v187
    v_lshlrev_b32 v202, 16, v188
    v_and_b32 v203, 0xffff0000, v188
    v_lshlrev_b32 v204, 16, v189
    v_and_b32 v205, 0xffff0000, v189
    v_pk_fma_f32 v[206:207], v[190:191], v[224:225], v[224:225] op_sel:[0,0,1] op_sel_hi:[1,0,1]
    v_pk_fma_f32 v[208:209], v[192:193], v[224:225], v[224:225] op_sel:[0,0,1] op_sel_hi:[1,0,1]
    v_pk_fma_f32 v[210:211], v[194:195], v[224:225], v[224:225] op_sel:[0,0,1] op_sel_hi:[1,0,1]
    v_pk_fma_f32 v[212:213], v[196:197], v[224:225], v[224:225] op_sel:[0,0,1] op_sel_hi:[1,0,1]
    v_cvt_pk_bf16_f32 v182, v206, v207
    v_cvt_pk_bf16_f32 v183, v208, v209
    v_cvt_pk_bf16_f32 v184, v210, v211
    v_cvt_pk_bf16_f32 v185, v212, v213
    ds_write_b128 v230, v[182:185] offset:0
    v_pk_fma_f32 v[214:215], v[198:199], v[224:225], v[224:225] op_sel:[0,0,1] op_sel_hi:[1,0,1]
    v_pk_fma_f32 v[216:217], v[200:201], v[224:225], v[224:225] op_sel:[0,0,1] op_sel_hi:[1,0,1]
    v_pk_fma_f32 v[218:219], v[202:203], v[224:225], v[224:225] op_sel:[0,0,1] op_sel_hi:[1,0,1]
    v_pk_fma_f32 v[220:221], v[204:205], v[224:225], v[224:225] op_sel:[0,0,1] op_sel_hi:[1,0,1]
    v_cvt_pk_bf16_f32 v186, v214, v215
    v_cvt_pk_bf16_f32 v187, v216, v217
    v_cvt_pk_bf16_f32 v188, v218, v219
    v_cvt_pk_bf16_f32 v189, v220, v221
    ds_write_b128 v230, v[186:189] offset:448
    s_waitcnt lgkmcnt(0)
    s_barrier
    ds_read_b64_tr_b16 v[110:111], v231 offset:0
    ds_read_b64_tr_b16 v[112:113], v231 offset:3840
    ds_read_b64_tr_b16 v[114:115], v231 offset:128
    ds_read_b64_tr_b16 v[116:117], v231 offset:3968
    ds_read_b32 v229, v237
    s_waitcnt lgkmcnt(3)
    buffer_store_dwordx4 v[110:113], v233, s[28:31], s70 offen sc1
    s_waitcnt lgkmcnt(1)
    buffer_store_dwordx4 v[114:117], v233, s[28:31], s71 offen sc1
    v_cmp_gt_u32 vcc, 16, v1
    s_waitcnt lgkmcnt(0)
    s_nop 0
    v_cndmask_b32 v229, 0, v229, vcc
    v_mov_b32 v228, v229
    buffer_store_dwordx2 v[228:229], v238, s[28:31], s72 offen sc1
    v_lshrrev_b32 v13, 2, v1
    v_mul_u32_u24 v13, 1056, v13
    v_lshl_add_u32 v13, v8, 3, v13
    s_mul_i32 s3, s48, 224
    v_add_u32 v243, s3, v13
    s_mov_b32 s18, 401408
    s_mov_b32 s19, 0x20000
    s_mov_b32 s26, 7340032
    s_mov_b32 s27, 0x20000
    s_mov_b32 s34, 1835008
    s_mov_b32 s35, 0x20000
    s_mov_b32 s36, 1
    v_lshrrev_b32 v14, 2, v1
    v_lshlrev_b32 v14, 7, v14
    v_lshl_add_u32 v14, v8, 3, v14
    v_and_b32 v15, 3, v5
    v_lshl_add_u32 v14, v15, 5, v14
    s_mul_i32 s3, s4, 8256
    v_xor_b32 v31, s3, v14
    v_xor_b32 v32, 32, v31
    v_xor_b32 v33, 64, v31
    v_xor_b32 v34, 96, v31
    v_add_u32 v35, 65536, v31
    v_add_u32 v36, 65536, v32
    v_add_u32 v37, 65536, v33
    v_add_u32 v38, 65536, v34
    v_add_u32 v39, 131072, v31
    v_add_u32 v40, 131072, v32
    v_add_u32 v41, 131072, v33
    v_add_u32 v42, 131072, v34
    s_lshl_b32 s6, s52, 1
    s_add_u32 s6, s6, s5
    s_lshl_b32 s3, s6, 1
    s_add_u32 s3, s3, s59
    s_lshl_b32 s3, s3, 4
    s_add_u32 s3, s3, s4
    s_lshl_b32 s3, s3, 12
    v_lshl_add_u32 v78, v3, 8, v4
    v_add_u32 v78, s3, v78
    s_xor_b32 s37, s51, 1
    s_lshl_b32 s37, s37, 3
    s_add_u32 s37, s37, s52
    s_lshl_b32 s3, s37, 14
    s_add_u32 s3, s3, s58
    s_add_u32 s3, s3, 16777216
    v_add_u32 v23, s3, v4
    s_lshl_b32 s37, s37, 5
    s_add_u32 s37, s37, s5
    s_lshl_b32 s37, s37, 2
    s_add_u32 s37, s37, 6422528
    s_mul_i32 s67, s6, 56
    s_lshl_b32 s3, s51, 1
    s_add_u32 s3, s3, s4
    s_add_u32 s67, s67, s3
    s_lshl_b32 s67, s67, 11
    s_add_u32 s67, s67, 2097152
    v_add_u32 v81, s58, v4
    s_lshl_b32 s68, s52, 2
    s_and_b32 s3, s51, 1
    s_add_u32 s68, s68, s3
    s_cmp_ge_u32 s51, 14
    s_cselect_b32 s3, 2, 0
    s_add_u32 s68, s68, s3
    s_lshl_b32 s68, s68, 7
    s_add_u32 s68, s68, 6356992
    s_waitcnt vmcnt(3)
    v_readfirstlane_b32 s57, v12
    s_mov_b32 s60, 0
    s_cmp_lg_u32 s57, 0
    s_cbranch_scc0 L_nonceh
L_nonce_okh:
    s_waitcnt vmcnt(0)
    s_barrier
    s_atomic_swap s57, s[28:29], s74
    s_atomic_swap s57, s[28:29], s73
    buffer_load_dwordx4 v[96:99], v85, s[8:11], 0 offen
    buffer_load_dwordx4 v[100:103], v86, s[8:11], 0 offen
    buffer_load_ushort v93, v82, s[40:43], 0 offen offset:0
    buffer_load_ushort v94, v82, s[40:43], 0 offen offset:16
    v_cmp_gt_u32 vcc, 12, v2
    s_mul_i32 s3, s48, 56
    s_add_u32 s3, s3, s79
    s_mul_i32 s3, s3, 3
    s_add_u32 s3, s3, s80
    s_lshl_b32 s3, s3, 11
    s_add_u32 s3, s3, 8388608
    s_add_u32 s3, s3, s81
    ds_read_b64_tr_b16 v[182:183], v243 offset:0
    ds_read_b64_tr_b16 v[184:185], v243 offset:16896
    ds_read_b64_tr_b16 v[186:187], v243 offset:32
    ds_read_b64_tr_b16 v[188:189], v243 offset:16928
    ds_read_b64_tr_b16 v[190:191], v243 offset:56
    ds_read_b64_tr_b16 v[192:193], v243 offset:16952
    ds_read_b64_tr_b16 v[194:195], v243 offset:88
    ds_read_b64_tr_b16 v[196:197], v243 offset:16984
    ds_read_b64_tr_b16 v[198:199], v243 offset:112
    ds_read_b64_tr_b16 v[200:201], v243 offset:17008
    ds_read_b64_tr_b16 v[202:203], v243 offset:144
    ds_read_b64_tr_b16 v[204:205], v243 offset:17040
    ds_read_b64_tr_b16 v[206:207], v243 offset:168
    ds_read_b64_tr_b16 v[208:209], v243 offset:17064
    ds_read_b64_tr_b16 v[210:211], v243 offset:200
    ds_read_b64_tr_b16 v[212:213], v243 offset:17096
    s_waitcnt lgkmcnt(13)
    v_cndmask_b32 v186, 0, v186, vcc
    v_cndmask_b32 v187, 0, v187, vcc
    s_waitcnt lgkmcnt(12)
    v_cndmask_b32 v188, 0, v188, vcc
    v_cndmask_b32 v189, 0, v189, vcc
    buffer_store_dwordx4 v[182:185], v4, s[28:31], s3 offen offset:0 sc1
    buffer_store_dwordx4 v[186:189], v4, s[28:31], s3 offen offset:1024 sc1
    s_add_u32 s3, s3, 86016
    s_waitcnt lgkmcnt(9)
    v_cndmask_b32 v194, 0, v194, vcc
    v_cndmask_b32 v195, 0, v195, vcc
    s_waitcnt lgkmcnt(8)
    v_cndmask_b32 v196, 0, v196, vcc
    v_cndmask_b32 v197, 0, v197, vcc
    buffer_store_dwordx4 v[190:193], v4, s[28:31], s3 offen offset:0 sc1
    buffer_store_dwordx4 v[194:197], v4, s[28:31], s3 offen offset:1024 sc1
    s_add_u32 s3, s3, 86016
    s_waitcnt lgkmcnt(5)
    v_cndmask_b32 v202, 0, v202, vcc
    v_cndmask_b32 v203, 0, v203, vcc
    s_waitcnt lgkmcnt(4)
    v_cndmask_b32 v204, 0, v204, vcc
    v_cndmask_b32 v205, 0, v205, vcc
    buffer_store_dwordx4 v[198:201], v4, s[28:31], s3 offen offset:0 sc1
    buffer_store_dwordx4 v[202:205], v4, s[28:31], s3 offen offset:1024 sc1
    s_add_u32 s3, s3, 86016
    ds_read_b32 v24, v4
    s_waitcnt lgkmcnt(2)
    v_cndmask_b32 v210, 0, v210, vcc
    v_cndmask_b32 v211, 0, v211, vcc
    ds_read_b32 v24, v4
    s_waitcnt lgkmcnt(2)
    v_cndmask_b32 v212, 0, v212, vcc
    v_cndmask_b32 v213, 0, v213, vcc
    buffer_store_dwordx4 v[206:209], v4, s[28:31], s3 offen offset:0 sc1
    buffer_store_dwordx4 v[210:213], v4, s[28:31], s3 offen offset:1024 sc1
    s_add_u32 s3, s3, 86016
    s_lshl_b32 s67, s80, 6
    s_add_u32 s67, s67, 64
    s_cmp_eq_u32 s81, 0
    s_cselect_b32 s37, s48, 1
    s_mov_b32 s68, 6369792
    s_and_b32 s3, s2, 1
    s_mul_i32 s3, s3, 3
    s_bfe_u32 s6, s2, 0x10001
    s_mul_i32 s7, s6, 6
    s_add_u32 s3, s3, s7
    s_add_u32 s3, s3, 1
    v_add_u32 v14, s3, v8
    s_mul_i32 s6, s6, 64
    s_add_u32 s6, s6, 7
    v_cmp_ne_u32 vcc, s6, v14
    v_lshrrev_b32 v15, 2, v1
    v_mul_u32_u24 v15, 3584, v15
    v_cndmask_b32 v14, 0, v14, vcc
    v_lshl_add_u32 v14, v14, 8, v15
    s_lshl_b32 s3, s52, 2
    s_add_u32 s3, s3, s48
    s_mul_i32 s3, s3, 37
    s_min_u32 s3, s3, 987
    s_mul_i32 s3, s3, 3584
    s_mul_i32 s6, s59, 3670144
    s_add_u32 s3, s3, s6
    buffer_load_dword v226, v14, s[20:23], s3 offen
    s_add_u32 s3, s3, 57344
    buffer_load_dword v227, v14, s[20:23], s3 offen
    s_add_u32 s3, s3, 57344
    v_cmp_gt_u32 vcc, 20, v1
    v_mov_b32 v15, 268435456
    s_nop 0
    v_cndmask_b32 v14, v15, v14, vcc
    buffer_load_dword v228, v14, s[20:23], s3 offen
    s_add_u32 s3, s3, 57344
    v_add_u32 v53, 65536, v4
    v_add_u32 v54, 131072, v4
    s_mul_i32 s59, s48, 3072
    s_mul_i32 s3, s50, 86016
    s_add_u32 s3, s3, s59
    s_add_u32 s3, s3, 8388608
    v_add_u32 v80, s3, v4
    v_lshlrev_b32 v14, 7, v9
    v_xor_b32 v14, v14, v4
    s_lshl_b32 s3, s49, 11
    v_add_u32 v67, s3, v14
    v_add_u32 v68, 129024, v67
    s_lshr_b32 s3, s49, 2
    s_lshl_b32 s3, s3, 3
    s_max_u32 s3, s3, 1
    s_sub_u32 s3, s3, 1
    s_lshl_b32 s3, s3, 10
    s_lshl_b32 s6, s5, 17
    s_add_u32 s3, s3, s6
    s_lshl_b32 s6, s4, 28
    s_add_u32 s3, s3, s6
    v_add_u32 v69, s3, v14
    s_lshl_b32 s100, s5, 1
    s_add_u32 s100, s100, s4
    s_lshl_b32 s100, s100, 10
    v_and_b32 v14, 1, v1
    v_mul_u32_u24 v14, 640, v14
    v_lshrrev_b32 v15, 2, v1
    v_lshlrev_b32 v15, 4, v15
    v_xor_b32 v14, v14, v15
    v_bfe_u32 v15, v1, 1, 1
    v_lshl_add_u32 v14, v15, 3, v14
    s_add_u32 s3, s58, 12288
    v_add_u32 v70, s3, v14
    s_sub_u32 s3, s3, 3072
    s_cmp_eq_u32 s48, 0
    s_cselect_b32 s3, 28672, s3
    v_add_u32 v71, s3, v14
    v_add_u32 v72, 65536, v70
    v_add_u32 v73, 65536, v71
    v_add_u32 v74, 131072, v70
    v_add_u32 v75, 131072, v71
    s_lshl_b32 s3, s49, 1
    v_min_u32 v14, 2, v3
    v_add_u32 v14, s3, v14
    v_max_u32 v14, 1, v14
    v_lshlrev_b32 v14, 1, v14
    v_and_b32 v15, 1, v7
    v_add_lshl_u32 v14, v14, v15, 7
    v_lshrrev_b32 v15, 1, v7
    v_lshl_add_u32 v15, v15, 2, v8
    v_lshl_add_u32 v14, v15, 3, v14
    v_add_u32 v77, 6291200, v14
    s_min_u32 s15, s48, 2
    s_lshl_b32 s15, s15, 6
    s_add_u32 s15, s15, 64
    s_lshl_b32 s82, s49, 5
    s_add_u32 s82, s82, s50
    s_lshl_b32 s82, s82, 10
    s_add_u32 s82, s82, 4194304
    s_lshr_b32 s69, s49, 2
    s_lshl_b32 s69, s69, 1
    s_and_b32 s3, s50, 1
    s_add_u32 s69, s69, s3
    s_lshl_b32 s69, s69, 7
    s_add_u32 s69, s69, 6361088
    s_and_b32 s7, s53, 1
    s_mul_i32 s3, s7, 28
    s_add_u32 s3, s3, s48
    s_lshl_b32 s3, s3, 17
    s_xor_b32 s6, s53, 1
    s_lshl_b32 s55, s6, 3
    s_lshl_b32 s6, s53, 7
    s_add_u32 s3, s3, s6
    v_lshlrev_b32 v14, 12, v5
    v_add3_u32 v59, v14, v83, s3
    v_add_u32 v60, 31744, v59
    v_add_u32 v61, 63488, v59
    v_add_u32 v62, 95232, v59
    v_mul_u32_u24 v14, 896, v5
    s_mul_i32 s3, s4, 25088
    s_mul_i32 s6, s5, 14336
    s_add_u32 s3, s3, s6
    s_lshl_b32 s6, s54, 7
    s_add_u32 s3, s3, s6
    v_add3_u32 v63, v14, v83, s3
    v_add_u32 v64, 6144, v63
    s_lshl_b32 s6, s53, 1
    s_add_u32 s6, s6, s5
    s_and_b32 s3, s53, 30
    s_add_u32 s3, s3, s4
    s_lshl_b32 s3, s3, 7
    s_add_u32 s39, s3, 6361088
    s_lshl_b32 s3, s6, 5
    s_add_u32 s3, s3, s4
    s_lshl_b32 s3, s3, 10
    s_add_u32 s3, s3, 4194304
    v_add_u32 v65, s3, v4
    v_add_u32 v66, 15360, v65
    s_xor_b32 s3, s4, s5
    s_lshl_b32 s3, s3, 6
    v_xor_b32 v43, s3, v31
    v_xor_b32 v44, 32, v43
    v_add_u32 v45, 65536, v43
    v_add_u32 v46, 65536, v44
    s_mul_i32 s3, s4, 12288
    v_add_u32 v47, s3, v4
    v_xor_b32 v48, 4096, v47
    v_add_u32 v49, 65536, v47
    v_add_u32 v50, 65536, v48
    v_add_u32 v51, 131072, v47
    v_add_u32 v52, 131072, v48
    s_lshl_b32 s6, s54, 1
    s_add_u32 s6, s6, s5
    s_lshl_b32 s3, s6, 1
    s_add_u32 s3, s3, s7
    s_mul_i32 s3, s3, 14
    s_add_u32 s3, s3, s4
    s_lshl_b32 s3, s3, 12
    s_add_u32 s3, s3, 2097152
    v_add_u32 v79, s3, v4
    s_lshl_b32 s3, s54, 1
    s_add_u32 s3, s3, s7
    s_lshl_b32 s3, s3, 1
    s_add_u32 s3, s3, s4
    s_lshl_b32 s3, s3, 7
    s_add_u32 s38, s3, 6356992
    s_and_b32 s3, s2, 6
    s_add_u32 s3, s3, s54
    s_sub_u32 s6, s3, 7
    s_cmp_ge_u32 s3, 7
    s_cselect_b32 s3, s6, s3
    s_lshl_b32 s64, s3, 19
    s_lshl_b32 s65, s3, 13
    s_add_u32 s55, s55, s54
    s_lshl_b32 s3, s55, 14
    s_add_u32 s3, s3, s58
    s_add_u32 s3, s3, 12582912
    v_add_u32 v21, s3, v4
    s_lshl_b32 s55, s55, 5
    s_add_u32 s55, s55, s48
    s_lshl_b32 s55, s55, 2
    s_add_u32 s55, s55, 6488064
    s_lshl_b32 s3, s5, 3
    v_add_u32 v13, s3, v3
    v_xor_b32 v13, v13, v6
    v_lshlrev_b32 v13, 4, v13
    v_lshl_add_u32 v13, v2, 8, v13
    s_lshl_b32 s3, s4, 14
    s_add_u32 s3, s3, 32768
    v_add_u32 v87, s3, v13
    v_xor_b32 v88, 64, v87
    s_lshr_b32 s3, s53, 1
    s_add_u32 s66, s3, s54
    s_mov_b32 s51, s66
    v_lshlrev_b32 v13, 1, v6
    v_xor_b32 v13, v13, v5
    v_lshlrev_b32 v13, 4, v13
    v_lshl_add_u32 v13, v5, 8, v13
    s_add_u32 s3, s58, 32768
    v_add_u32 v89, s3, v13
    v_xor_b32 v90, 16, v89
    v_xor_b32 v91, 24576, v89
    v_xor_b32 v92, 24592, v89
    s_mov_b32 s70, 0xaaaaaaaa
    s_mov_b32 s71, 0xaaaaaaaa
    s_mov_b32 s72, 0xfff0ffff
    s_mov_b32 s73, 0xf000ff00
    s_mov_b32 s74, 0xffc0fffc
    s_mov_b32 s75, 0xc000fc00
    s_cmp_eq_u32 s49, 0
    s_cselect_b64 s[76:77], 0, -1
    v_mov_b32 v13, 0xffff
    v_mov_b32 v14, 0xffff0000
    v_cndmask_b32 v13, v13, v14, s[70:71]
    v_cndmask_b32 v104, v13, 0, s[72:73]
    v_cndmask_b32 v106, 0, v13, s[72:73]
    v_cndmask_b32 v105, v13, 0, s[74:75]
    v_cndmask_b32 v107, 0, v13, s[74:75]
    v_mov_b32 v84, 0xf149f2ca
    s_mov_b32 s83, 0x3e8b97f6
    s_mov_b32 s78, 0xbdd2d3e8
    s_mov_b32 s79, 0xbdd2d3e8
    s_mov_b32 s80, 1.0
    s_mov_b32 s81, 1.0
    v_mov_b32 v108, 0xc0135761
    v_mov_b32 v109, 0xc0135761
    v_lshrrev_b32 v13, 1, v2
    v_lshlrev_b32 v14, 1, v3
    v_sub_u32 v13, v13, v14
    v_mov_b32 v14, 0x3f80
    v_cndmask_b32 v14, v14, 1.0, s[70:71]
    v_cmp_eq_i32 vcc, 0, v13
    v_accvgpr_write_b32 a248, 0
    v_accvgpr_write_b32 a252, 0
    v_cndmask_b32 v15, 0, v14, vcc
    v_accvgpr_write_b32 a250, v15
    v_cmp_eq_i32 vcc, 1, v13
    v_accvgpr_write_b32 a249, 0
    v_accvgpr_write_b32 a253, 0
    v_cndmask_b32 v15, 0, v14, vcc
    v_accvgpr_write_b32 a251, v15
    s_waitcnt vmcnt(3)
    s_barrier
    s_cmp_lg_u32 s37, 0
    s_cbranch_scc1 L_nowsig
    s_atomic_add s36, s[44:45], s67
L_nowsig:
    buffer_load_dword v18, v20, s[28:31], 0 offen sc1
    s_mov_b32 s26, 7340032
    s_and_b32 s3, s2, 1
    s_mul_i32 s3, s3, 7
    s_add_u32 s3, s3, s52
    s_lshl_b32 s3, s3, 2
    s_add_u32 s3, s3, s48
    s_lshl_b32 s3, s3, 17
    s_and_b32 s6, s2, 6
    s_lshl_b32 s6, s6, 9
    s_add_u32 s3, s3, s6
    v_lshlrev_b32 v242, 12, v10
    v_mul_u32_u24 v243, 128, v9
    v_add_u32 v243, v242, v243
    buffer_load_dword v232, v243, s[24:27], s3 offen offset:256
    s_cmp_eq_u32 s56, 0
    s_cselect_b32 s26, 0, s26
    s_cmp_eq_u32 s56, 0
    s_cselect_b32 s26, 0, s26
    v_and_b32 v13, 0xfffff000, v78
    v_lshl_add_u32 v13, v10, 7, v13
    s_add_u32 s3, s1, 8192
    v_lshl_add_u32 v14, v9, 13, s3
    s_waitcnt vmcnt(1)
    v_cmp_ne_u32 vcc, s57, v18
    s_cbranch_vccnz L_pollin3
L_pollok3:
    s_mov_b32 s14, 0
    s_load_dword s14, s[44:45], s15
    s_barrier
    buffer_load_dword v76, v77, s[28:31], 0 offen sc1
    s_cmp_ge_u32 s14, 14
    s_cbranch_scc0 L_pollin4
L_pollok4:
    s_barrier
    s_cmp_eq_u32 s56, 0
    s_cselect_b32 s3, 268435456, 0
    v_add_u32 v79, s3, v79
    s_mov_b32 s26, 7340032
    s_and_b32 s3, s54, 1
    s_lshl_b32 s3, s3, 2
    s_lshr_b32 s6, s54, 1
    s_add_u32 s3, s3, s6
    s_lshl_b32 s3, s3, 7
    s_cmp_eq_u32 s56, 0
    s_cselect_b32 s3, s3, 0
    v_xor_b32 v59, s3, v59
    v_xor_b32 v60, s3, v60
    v_xor_b32 v61, s3, v61
    v_xor_b32 v62, s3, v62
    s_add_u32 m0, s59, 98304
    s_nop 0
    buffer_load_dwordx4 v80, s[28:31], s63 offen sc1 lds
    buffer_load_dwordx4 v80, s[28:31], s63 offen offset:1024 sc1 lds
    buffer_load_dwordx4 v80, s[28:31], s63 offen offset:2048 sc1 lds
    s_add_u32 m0, s100, 126976
    s_nop 0
    buffer_load_dwordx4 v69, s[28:31], s62 offen sc1 lds
    s_add_u32 m0, s58, 110592
    s_nop 0
    buffer_load_dwordx4 v67, s[28:31], s62 offen sc1 lds
    buffer_load_dwordx4 v67, s[28:31], s62 offen offset:1024 sc1 lds
    buffer_load_dwordx4 v68, s[28:31], s62 offen offset:2048 sc1 lds
    buffer_load_dwordx4 v68, s[28:31], s62 offen offset:3072 sc1 lds
    s_add_u32 m0, s59, 131072
    s_add_u32 s63, s63, 12288
    s_cmp_eq_u32 s63, 86016
    s_cselect_b32 s63, 0, s63
    buffer_load_dwordx4 v80, s[28:31], s63 offen sc1 lds
    buffer_load_dwordx4 v80, s[28:31], s63 offen offset:1024 sc1 lds
    buffer_load_dwordx4 v80, s[28:31], s63 offen offset:2048 sc1 lds
    s_add_u32 m0, s100, 159744
    s_add_u32 s62, s62, 262144
    s_cmp_eq_u32 s62, 1835008
    s_cselect_b32 s62, 0, s62
    buffer_load_dwordx4 v69, s[28:31], s62 offen sc1 lds
    s_add_u32 m0, s58, 143360
    s_nop 0
    buffer_load_dwordx4 v67, s[28:31], s62 offen sc1 lds
    buffer_load_dwordx4 v67, s[28:31], s62 offen offset:1024 sc1 lds
    buffer_load_dwordx4 v68, s[28:31], s62 offen offset:2048 sc1 lds
    buffer_load_dwordx4 v68, s[28:31], s62 offen offset:3072 sc1 lds
    s_add_u32 m0, s59, 0
    s_add_u32 s63, s63, 12288
    s_cmp_eq_u32 s63, 86016
    s_cselect_b32 s63, 0, s63
    buffer_load_dwordx4 v80, s[28:31], s63 offen sc1 lds
    buffer_load_dwordx4 v80, s[28:31], s63 offen offset:1024 sc1 lds
    buffer_load_dwordx4 v80, s[28:31], s63 offen offset:2048 sc1 lds
    s_add_u32 m0, s100, 28672
    s_add_u32 s62, s62, 262144
    s_cmp_eq_u32 s62, 1835008
    s_cselect_b32 s62, 0, s62
    buffer_load_dwordx4 v69, s[28:31], s62 offen sc1 lds
    s_add_u32 m0, s58, 12288
    s_nop 0
    buffer_load_dwordx4 v67, s[28:31], s62 offen sc1 lds
    buffer_load_dwordx4 v67, s[28:31], s62 offen offset:1024 sc1 lds
    buffer_load_dwordx4 v68, s[28:31], s62 offen offset:2048 sc1 lds
    buffer_load_dwordx4 v68, s[28:31], s62 offen offset:3072 sc1 lds
    s_add_u32 m0, s59, 65536
    s_add_u32 s63, s63, 12288
    s_cmp_eq_u32 s63, 86016
    s_cselect_b32 s63, 0, s63
    buffer_load_dwordx4 v80, s[28:31], s63 offen sc1 lds
    buffer_load_dwordx4 v80, s[28:31], s63 offen offset:1024 sc1 lds
    buffer_load_dwordx4 v80, s[28:31], s63 offen offset:2048 sc1 lds
    s_add_u32 m0, s100, 94208
    s_add_u32 s62, s62, 262144
    s_cmp_eq_u32 s62, 1835008
    s_cselect_b32 s62, 0, s62
    buffer_load_dwordx4 v69, s[28:31], s62 offen sc1 lds
    s_add_u32 m0, s58, 77824
    s_nop 0
    buffer_load_dwordx4 v67, s[28:31], s62 offen sc1 lds
    buffer_load_dwordx4 v67, s[28:31], s62 offen offset:1024 sc1 lds
    buffer_load_dwordx4 v68, s[28:31], s62 offen offset:2048 sc1 lds
    buffer_load_dwordx4 v68, s[28:31], s62 offen offset:3072 sc1 lds
    s_mov_b32 s3, 268435456
    buffer_store_dword v12, v11, s[28:31], s3 offen
    buffer_store_dword v12, v11, s[28:31], s3 offen
    v_lshlrev_b32 v13, 2, v2
    v_and_b32 v14, 1, v1
    v_lshl_add_u32 v14, v3, 2, v14
    v_lshlrev_b32 v14, 2, v14
    v_add_u32 v15, 64, v14
    v_cndmask_b32 v16, v14, v15, s[72:73]
    v_cndmask_b32 v14, v14, v15, s[74:75]
    s_waitcnt vmcnt(34)
    ds_bpermute_b32 v25, v13, v76 offset:64
    ds_bpermute_b32 v27, v16, v76 offset:0
    ds_bpermute_b32 v28, v14, v76 offset:8
    ds_bpermute_b32 v26, v13, v76 offset:128
    ds_bpermute_b32 v29, v16, v76 offset:64
    ds_bpermute_b32 v30, v14, v76 offset:72
    s_waitcnt lgkmcnt(5)
    v_mul_f32 v25, s83, v25
    ds_read_b32 v24, v4
    s_waitcnt lgkmcnt(3)
    v_mul_f32 v26, s83, v26
    ds_read_b32 v24, v4
    ds_read_b32 v24, v4
    ds_read_b32 v24, v4
    s_waitcnt vmcnt(18) lgkmcnt(3)
    s_barrier
    ds_read_b64_tr_b16 a[180:181], v72 offset:32768
    ds_read_b64_tr_b16 a[182:183], v72 offset:33024
    ds_read_b128 a[128:131], v53 offset:32768
    ds_read_b64_tr_b16 a[184:185], v72 offset:33792
    ds_read_b64_tr_b16 a[186:187], v72 offset:34048
    ds_read_b128 a[132:135], v53 offset:33792
    ds_read_b128 a[136:139], v53 offset:34816
    ds_read_b64_tr_b16 a[176:177], v73 offset:32768
    ds_read_b64_tr_b16 a[178:179], v73 offset:33024
    ds_read_b128 a[140:143], v53 offset:35840
    ds_read_b128 a[144:147], v53 offset:36864
    ds_read_b128 a[148:151], v53 offset:37888
    s_waitcnt lgkmcnt(0)
    s_nop 3
    s_branch L_q
L_pollin5:
    s_waitcnt lgkmcnt(0)
    s_cmp_ge_u32 s14, 7
    s_cbranch_scc1 L_pollok5
    s_cmp_eq_u32 s56, 0
    s_cbranch_scc1 L_pollok5
    s_mov_b32 s60, 0
    s_branch L_poll5a
L_poll5:
    s_sleep 8
L_poll5a:
    buffer_load_dword v18, off, s[28:31], s38 sc1
    s_add_u32 s60, s60, 1
    s_waitcnt vmcnt(0)
    v_readfirstlane_b32 s14, v18
    s_nop 0
    s_cmp_ge_u32 s14, 7
    s_cbranch_scc1 L_pollok5
    s_cmp_lt_u32 s60, 20000
    s_cbranch_scc1 L_poll5
    s_branch L_pollok5
L_nof:
    v_min_u32 v14, 48, v1
    s_lshl_b32 s3, s54, 2
    s_add_u32 s3, s3, s48
    s_mul_i32 s3, s3, 25088
    v_lshl_add_u32 v14, v14, 7, s3
    s_add_u32 s3, s2, 0
    s_and_b32 s3, s3, 3
    s_mul_i32 s3, s3, 6272
    buffer_load_dword v182, v14, s[16:19], s3 offen
    s_waitcnt vmcnt(1)
    s_barrier
    s_cmp_lg_u32 s48, 0
    s_cbranch_scc1 L_sig3
    s_atomic_add s36, s[28:29], s69
L_sig3:
    s_add_u32 s3, s2, 1
    s_and_b32 s3, s3, 3
    s_mul_i32 s3, s3, 6272
    buffer_load_dword v183, v14, s[16:19], s3 offen
    s_add_u32 s3, s2, 2
    s_and_b32 s3, s3, 3
    s_mul_i32 s3, s3, 6272
    buffer_load_dword v184, v14, s[16:19], s3 offen
    s_add_u32 s3, s2, 3
    s_and_b32 s3, s3, 3
    s_mul_i32 s3, s3, 6272
    buffer_load_dword v185, v14, s[16:19], s3 offen
    s_branch L_fin
L_pollin6:
    s_waitcnt lgkmcnt(0)
    s_cmp_ge_u32 s14, 8
    s_cbranch_scc1 L_pollok6
    s_mov_b32 s60, 0
    s_branch L_poll6a
L_poll6:
    s_sleep 8
L_poll6a:
    buffer_load_dword v18, off, s[28:31], s39 sc1
    s_add_u32 s60, s60, 1
    s_waitcnt vmcnt(0)
    v_readfirstlane_b32 s14, v18
    s_nop 0
    s_cmp_ge_u32 s14, 8
    s_cbranch_scc1 L_pollok6
    s_cmp_lt_u32 s60, 20000
    s_cbranch_scc1 L_poll6
    s_branch L_pollok6
L_pollin7:
    s_waitcnt lgkmcnt(0)
    s_cmp_ge_u32 s14, 1
    s_cbranch_scc1 L_pollok7
    s_mov_b32 s60, 0
    s_branch L_poll7a
L_poll7:
    s_sleep 4
L_poll7a:
    buffer_load_dword v18, off, s[28:31], s55 sc1
    s_add_u32 s60, s60, 1
    s_waitcnt vmcnt(0)
    v_readfirstlane_b32 s14, v18
    s_nop 0
    s_cmp_ge_u32 s14, 1
    s_cbranch_scc1 L_pollok7
    s_cmp_lt_u32 s60, 20000
    s_cbranch_scc1 L_poll7
    s_branch L_pollok7
L_last:
    s_endpgm
.section .rodata,"a"
.p2align 6
.amdhsa_kernel parallel_sum__sliding_local_dilated__mixer_token_mlp__prompt_kernel
  .amdhsa_next_free_vgpr 512
  .amdhsa_next_free_sgpr 102
  .amdhsa_accum_offset 256
  .amdhsa_group_segment_fixed_size 0
  .amdhsa_kernarg_size 88
  .amdhsa_user_sgpr_count 2
  .amdhsa_user_sgpr_kernarg_segment_ptr 1
  .amdhsa_system_sgpr_workgroup_id_x 1
.end_amdhsa_kernel
```
